```python
import torch

def _softmax(x, axis=-1):
    return torch.softmax(x, dim=axis)

def _gelu(x):
    return torch.nn.functional.gelu(x, approximate='tanh')

def _silu(x):
    return torch.nn.functional.silu(x)

def _sigmoid(x):
    return torch.sigmoid(x)

def _layernorm(x, axis=-1, eps=1e-05):
    m = x.mean(dim=axis, keepdim=True)
    v = x.var(dim=axis, keepdim=True, unbiased=False)
    return (x - m) / torch.sqrt(v + eps)

def _scatter_add(tgt, idx, src, axis=0):
    return tgt.clone().index_add_(axis, idx, src)

def _segment_sum(src, seg, n):
    out = torch.zeros((n,) + src.shape[1:], dtype=src.dtype)
    return out.index_add_(0, seg, src)

def _pad(x, pw):
    flat = tuple((v for pair in reversed(pw) for v in pair))
    return torch.nn.functional.pad(x, flat)
kernel_name = 'adaLN_cond__spectral_gfnet__mixer_token_mlp__prompt'

def setup_inputs():

    _w = lambda a: (lambda t: t.to(torch.bfloat16) if t.is_floating_point() else t)(torch.as_tensor(a))

    def _A_setup():
        B, S, D = (1, 2048, 576)
        Df = D // 2 + 1
        return {'x': _w((lambda *s: torch.randn(*s, dtype=torch.bfloat16) * 0.05)(B, S, D)), 'w_r': _w((lambda *s: torch.randn(*s, dtype=torch.bfloat16) * 1.6)(S, Df) * 0.02), 'w_i': _w((lambda *s: torch.randn(*s, dtype=torch.bfloat16) * 1.6)(S, Df) * 0.02)}
    _A_in = _A_setup()

    def _B_setup():
        B, S, D, F = (1, 2048, 576, 4608)
        return {'x': _w((lambda *s: torch.randn(*s, dtype=torch.bfloat16) * 0.05)(B, S, D)), 'w1': _w((lambda *s: torch.randn(*s, dtype=torch.bfloat16) * 0.8)(S, F) * S ** (-0.5)), 'b1': _w((lambda *s: torch.randn(*s, dtype=torch.bfloat16) * 12.8)(F) * 0.02), 'w2': _w((lambda *s: torch.randn(*s, dtype=torch.bfloat16) * 0.2)(F, S) * F ** (-0.5)), 'b2': _w((lambda *s: torch.randn(*s, dtype=torch.bfloat16) * 1.6)(S) * 0.02)}
    _B_in = _B_setup()
    return {'A_x': _A_in['x'], 'A_w_r': _A_in['w_r'], 'A_w_i': _A_in['w_i'], 'B_x': _B_in['x'], 'B_w1': _B_in['w1'], 'B_b1': _B_in['b1'], 'B_w2': _B_in['w2'], 'B_b2': _B_in['b2'], 'c': _w((lambda *s: torch.randn(*s, dtype=torch.bfloat16) * 0.1)(1, 576) * 8.0), 'w_mod': _w((lambda *s: torch.randn(*s, dtype=torch.bfloat16) * 0.1)(576, 6 * 576) * 576 ** (-0.5) * 8.0)}

def reference(A_x, A_w_r, A_w_i, B_x, B_w1, B_b1, B_w2, B_b2, c, w_mod):

    def _A_ref(x, w_r, w_i):
        B, S, D = x.shape
        X = (lambda x, axes=(-2, -1): torch.fft.rfft2(x.float(), dim=axes))(x, axes=(-2, -1))
        W = w_r + 1j * w_i
        X = X * W
        y = (lambda x, s, axes=(-2, -1): torch.fft.irfft2(x, s=s, dim=axes).to(torch.bfloat16))(X, (S, D), axes=(-2, -1))
        return y

    def _B_ref(x, w1, b1, w2, b2):
        B, S, D = x.shape
        h = _layernorm(x, axis=-1)
        u = torch.einsum('bsd,sf->bdf', h, w1) + b1
        u = _gelu(u)
        y = torch.einsum('bdf,fs->bds', u, w2) + b2
        return (lambda x, *d: x.permute(*d))(y, 0, 2, 1)
    x = A_x
    mod = (_silu(c) @ w_mod).reshape(c.shape[0], 6, 1, -1)
    sa, ca, ga, sb, cb, gb = (mod[:, 0].clone(), mod[:, 1].clone(), mod[:, 2].clone(), mod[:, 3].clone(), mod[:, 4].clone(), mod[:, 5].clone())
    h = _layernorm(x, axis=-1) * (1 + ca) + sa
    x = x + ga * _A_ref(h, A_w_r, A_w_i)
    h = _layernorm(x, axis=-1) * (1 + cb) + sb
    x = x + gb * _B_ref(h, B_w1, B_b1, B_w2, B_b2)
    return x
```

```asm
; @launch grid=(256,1,1) block=(512,1,1) lds=163840
.amdgcn_target "amdgcn-amd-amdhsa--gfx950"
.text
.globl adaLN_cond__spectral_gfnet__mixer_token_mlp__prompt_kernel
.p2align 8
.type adaLN_cond__spectral_gfnet__mixer_token_mlp__prompt_kernel,@function
adaLN_cond__spectral_gfnet__mixer_token_mlp__prompt_kernel:
    s_cmp_ge_u32 s2, 256
    s_cbranch_scc1 L_exit
    s_load_dwordx16 s[8:23], s[0:1], 0
    s_load_dwordx8 s[24:31], s[0:1], 64
    s_load_dwordx2 s[32:33], s[0:1], 96
    v_readfirstlane_b32 s4, v0
    s_lshr_b32 s5, s2, 3
    s_lshr_b32 s4, s4, 6
    s_cmp_lg_u32 s4, s5
    s_cbranch_scc1 L_nopf
    s_getpc_b64 s[52:53]
L_pc:
    s_sub_u32 s52, s52, L_pc-adaLN_cond__spectral_gfnet__mixer_token_mlp__prompt_kernel
    s_subb_u32 s53, s53, 0
    s_mov_b32 s54, L_code_end-adaLN_cond__spectral_gfnet__mixer_token_mlp__prompt_kernel
    s_mov_b32 s55, 0x20000
    v_lshlrev_b32 v1, 7, v0
    buffer_load_dword v255, v1, s[52:55], 0 offen
    v_add_u32 v1, 65536, v1
    buffer_load_dword v255, v1, s[52:55], 0 offen
L_nopf:
    v_lshrrev_b32 v1, 6, v0
    v_and_b32 v0, 63, v0
    v_readfirstlane_b32 s34, v1
    v_and_b32 v1, 15, v0
    v_lshrrev_b32 v2, 4, v0
    s_and_b32 s4, s2, 7
    s_lshr_b32 s5, s2, 3
    s_lshl_b32 s6, s4, 5
    s_add_u32 s6, s6, s5
    s_mov_b32 s7, 100000
    s_and_b32 s3, s34, 3
    s_cmp_ge_u32 s34, 4
    s_cbranch_scc0 L_C
L_H:
    v_lshlrev_b32 v16, 4, v0
    v_mov_b32 v30, 2146435072
    v_mov_b32 v12, 2146435072
    v_mov_b32 v18, 2146435072
    s_sub_u32 s63, 255, s2
    s_mul_i32 s62, s63, 171
    s_lshr_b32 s62, s62, 9
    s_mul_i32 s48, s62, 3
    s_sub_u32 s61, s63, s48
    s_cmp_ge_u32 s63, 54
    s_cbranch_scc1 L_m_30
    v_lshrrev_b32 v4, 3, v0
    v_and_b32 v5, 7, v0
    v_and_b32 v6, 6, v4
    v_xor_b32 v5, v5, v6
    v_mul_u32_u24 v4, 6912, v4
    v_lshl_add_u32 v12, v5, 4, v4
    s_lshl_b32 s48, s61, 2
    s_add_u32 s48, s48, s3
    s_mul_i32 s48, s48, 331776
    s_lshl_b32 s49, s62, 7
    s_add_u32 s47, s48, s49
    s_lshl_b32 s50, s3, 8
    v_lshl_add_u32 v27, v0, 2, s50
    s_mul_i32 s49, s61, 384
    v_add_u32 v9, s49, v27
    v_add_u32 v12, s47, v12
    s_waitcnt lgkmcnt(0)
    s_mov_b32 s40, s26
    s_mov_b32 s41, s27
    s_mov_b32 s42, 3981312
    s_mov_b32 s43, 0x20000
    s_mul_i32 m0, s3, 6144
    s_mov_b32 s59, 0
    buffer_load_dwordx4 v12, s[40:43], s59 offen lds
    s_add_u32 m0, m0, 1024
    s_add_u32 s59, s59, 55296
    buffer_load_dwordx4 v12, s[40:43], s59 offen lds
    s_add_u32 m0, m0, 1024
    s_add_u32 s59, s59, 55296
    buffer_load_dwordx4 v12, s[40:43], s59 offen lds
    s_add_u32 m0, m0, 1024
    s_add_u32 s59, s59, 55296
    buffer_load_dwordx4 v12, s[40:43], s59 offen lds
    s_add_u32 m0, m0, 1024
    s_add_u32 s59, s59, 55296
    buffer_load_dwordx4 v12, s[40:43], s59 offen lds
    s_add_u32 m0, m0, 1024
    s_add_u32 s59, s59, 55296
    buffer_load_dwordx4 v12, s[40:43], s59 offen lds
    s_mov_b32 s44, s24
    s_mov_b32 s45, s25
    s_mov_b32 s46, 1152
    s_mov_b32 s47, 0x20000
    buffer_load_dword v26, v9, s[44:47], 0 offen
    s_mov_b32 s36, s32
    s_mov_b32 s37, s33
    s_mov_b32 s38, 50331648
    s_mov_b32 s39, 0x20000
    v_mov_b32 v7, 32768
    buffer_load_dword v3, v7, s[36:39], 0 offen sc1
    v_lshrrev_b32 v4, 2, v0
    v_bfe_u32 v5, v4, 1, 2
    v_xor_b32 v5, s3, v5
    v_lshlrev_b32 v5, 5, v5
    v_lshlrev_b32 v4, 7, v4
    v_and_b32 v6, 3, v0
    v_lshlrev_b32 v6, 3, v6
    v_add3_u32 v28, v4, v5, v6
    v_lshlrev_b32 v29, 3, v2
    v_add_u32 v29, 90112, v29
    s_mul_i32 s48, s3, 3456
    s_mul_i32 s49, s61, 1152
    s_add_u32 s48, s48, s49
    s_lshl_b32 s49, s62, 6
    s_add_u32 s48, s48, s49
    s_add_u32 s48, s48, 15204352
    v_mul_u32_u24 v4, 13824, v2
    v_lshl_add_u32 v4, v1, 2, v4
    v_add_u32 v30, s48, v4
    v_add_u32 v31, 55296, v30
    v_mov_b32 v5, 0
    s_mov_b32 s48, 0
    buffer_store_dword v5, v30, s[36:39], s48 offen sc1
    buffer_store_dword v5, v31, s[36:39], s48 offen sc1
    s_lshr_b32 s51, s5, 2
    s_lshl_b32 s51, s51, 3
    s_add_u32 s51, s51, s4
    s_and_b32 s60, s5, 3
    s_lshl_b32 s35, s51, 2
    s_add_u32 s35, s35, s60
    s_lshl_b32 s35, s35, 14
    s_bfe_u32 s48, s6, 0x20002
    s_lshl_b32 s48, s48, 6
    s_lshr_b32 s49, s6, 4
    s_lshl_b32 s49, s49, 2
    s_add_u32 s48, s48, s49
    s_and_b32 s49, s6, 3
    s_add_u32 s48, s48, s49
    s_lshl_b32 s48, s48, 4
    s_lshl_b32 s49, s3, 16
    s_add_u32 s48, s48, s49
    s_add_u32 s48, s48, 15728640
    v_mov_b32 v17, 2146435072
    v_writelane_b32 v17, s48, 0
    s_add_u32 s48, s48, 16384
    s_add_u32 s48, s2, 160
    s_lshl_b32 s48, s48, 7
    s_add_u32 s48, s48, 557056
    s_lshl_b32 s49, s3, 8
    s_add_u32 s49, s49, s5
    s_cmp_lt_u32 s49, 12
    s_cselect_b32 s48, s48, 2146435072
    v_mov_b32 v19, 2146435072
    v_writelane_b32 v19, s48, 0
    s_or_b32 s48, s2, s3
    s_cmp_eq_u32 s48, 0
    s_cselect_b32 s48, 0, 2146435072
    s_add_u32 s48, s48, 32768
    v_writelane_b32 v19, s48, 1
    buffer_load_dword v220, v17, s[36:39], 0 offen
    s_waitcnt vmcnt(3)
    s_setprio 2
    v_lshlrev_b32 v4, 16, v26
    v_and_b32 v5, 0xffff0000, v26
    v_mul_f32 v6, 0xbfb8aa3b, v4
    v_mul_f32 v7, 0xbfb8aa3b, v5
    v_exp_f32 v6, v6
    v_exp_f32 v7, v7
    v_add_f32 v6, 1.0, v6
    v_add_f32 v7, 1.0, v7
    v_rcp_f32 v6, v6
    v_rcp_f32 v7, v7
    v_mul_f32 v4, v4, v6
    v_mul_f32 v5, v5, v7
    v_cvt_pk_bf16_f32 v26, v4, v5
    v_add_u32 v27, 90112, v27
    ds_write_b32 v27, v26
    s_mov_b32 s48, 0x9e3779b1
    v_mul_lo_u32 v3, v3, s48
    v_add_u32 v3, 0x7f4a7c15, v3
    v_or_b32 v3, 0x01010101, v3
    s_waitcnt lgkmcnt(0)
    s_barrier
    ds_read_b64_tr_b16 v[132:133], v28 offset:0
    ds_read_b64_tr_b16 v[134:135], v28 offset:2048
    ds_read2_b64 v[136:139], v29 offset0:0 offset1:4
    ds_read_b64_tr_b16 v[140:141], v28 offset:4096
    ds_read_b64_tr_b16 v[142:143], v28 offset:6144
    ds_read2_b64 v[144:147], v29 offset0:8 offset1:12
    ds_read_b64_tr_b16 v[148:149], v28 offset:8192
    ds_read_b64_tr_b16 v[150:151], v28 offset:10240
    ds_read2_b64 v[152:155], v29 offset0:16 offset1:20
    ds_read_b64_tr_b16 v[156:157], v28 offset:12288
    ds_read_b64_tr_b16 v[158:159], v28 offset:14336
    ds_read2_b64 v[160:163], v29 offset0:24 offset1:28
    ds_read_b64_tr_b16 v[164:165], v28 offset:16384
    ds_read_b64_tr_b16 v[166:167], v28 offset:18432
    ds_read2_b64 v[168:171], v29 offset0:32 offset1:36
    ds_read_b64_tr_b16 v[172:173], v28 offset:20480
    ds_read_b64_tr_b16 v[174:175], v28 offset:22528
    ds_read2_b64 v[176:179], v29 offset0:40 offset1:44
    v_and_b32 v4, 3, v1
    v_or_b32 v4, 0x07060500, v4
    s_waitcnt lgkmcnt(14)
    v_mfma_f32_16x16x32_bf16 v[36:39], v[136:139], v[132:135], 0
    s_waitcnt lgkmcnt(12)
    v_mfma_f32_16x16x32_bf16 v[36:39], v[144:147], v[140:143], v[36:39]
    s_waitcnt lgkmcnt(9)
    v_mfma_f32_16x16x32_bf16 v[36:39], v[152:155], v[148:151], v[36:39]
    s_waitcnt lgkmcnt(6)
    v_mfma_f32_16x16x32_bf16 v[36:39], v[160:163], v[156:159], v[36:39]
    s_waitcnt lgkmcnt(3)
    v_mfma_f32_16x16x32_bf16 v[36:39], v[168:171], v[164:167], v[36:39]
    s_waitcnt lgkmcnt(0)
    v_mfma_f32_16x16x32_bf16 v[36:39], v[176:179], v[172:175], v[36:39]
    s_nop 7
    v_add_u32 v40, 0x80, v36
    v_perm_b32 v40, v40, v3, v4
    s_waitcnt vmcnt(1)
    s_mov_b32 s48, 0
    buffer_store_dword v40, v30, s[36:39], s48 offen sc1
    buffer_store_dword v40, v31, s[36:39], s48 offen sc1
    s_setprio 0
    s_mov_b32 s63, 999
    s_branch L_m_34
L_C:
    v_lshrrev_b32 v18, 5, v0
    v_and_b32 v19, 31, v0
    v_mul_u32_u24 v20, 294912, v18
    v_lshl_add_u32 v20, v19, 2, v20
    s_mul_i32 s62, s3, 589824
    s_mul_i32 s48, s6, 1152
    s_add_u32 s62, s62, s48
    s_waitcnt lgkmcnt(0)
    s_mov_b32 s40, s8
    s_mov_b32 s41, s9
    s_mov_b32 s42, 2359296
    s_mov_b32 s43, 0x20000
    buffer_load_dword v9, v20, s[40:43], s62 offen offset:0
    buffer_load_dword v10, v20, s[40:43], s62 offen offset:128
    buffer_load_dword v11, v20, s[40:43], s62 offen offset:256
    buffer_load_dword v12, v20, s[40:43], s62 offen offset:384
    buffer_load_dword v13, v20, s[40:43], s62 offen offset:512
    buffer_load_dword v14, v20, s[40:43], s62 offen offset:640
    buffer_load_dword v15, v20, s[40:43], s62 offen offset:768
    buffer_load_dword v16, v20, s[40:43], s62 offen offset:896
    buffer_load_dword v17, v20, s[40:43], s62 offen offset:1024
    s_mov_b32 s36, s32
    s_mov_b32 s37, s33
    s_mov_b32 s38, 50331648
    s_mov_b32 s39, 0x20000
    v_mov_b32 v21, 32768
    buffer_load_dword v3, v21, s[36:39], 0 offen sc1
    s_mul_i32 s52, s4, 27
    s_add_u32 s52, s52, s5
    s_mul_i32 s51, s52, 171
    s_lshr_b32 s51, s51, 10
    s_mul_i32 s48, s51, 6
    s_sub_u32 s52, s52, s48
    s_lshr_b32 s53, s4, 1
    s_and_b32 s54, s4, 1
    s_lshl_b32 s54, s54, 3
    s_lshr_b32 s48, s5, 2
    s_add_u32 s54, s54, s48
    s_and_b32 s55, s5, 3
    s_mov_b32 s44, s18
    s_mov_b32 s45, s19
    s_mov_b32 s46, 9216
    s_mov_b32 s47, 0x20000
    s_mov_b32 s64, s22
    s_mov_b32 s65, s23
    s_mov_b32 s66, 4096
    s_mov_b32 s67, 0x20000
    s_lshl_b32 s48, s51, 8
    s_lshl_b32 s49, s3, 6
    s_add_u32 s48, s48, s49
    v_lshl_add_u32 v22, v2, 3, s48
    buffer_load_dwordx2 v[4:5], v22, s[44:47], 0 offen
    buffer_load_dwordx2 v[6:7], v22, s[44:47], 0 offen offset:32
    s_lshl_b32 s48, s54, 8
    s_add_u32 s48, s48, s49
    s_lshr_b32 s49, s53, 1
    s_lshl_b32 s49, s49, 5
    s_add_u32 s48, s48, s49
    v_lshl_add_u32 v23, v1, 1, s48
    buffer_load_ushort v8, v23, s[64:67], 0 offen
    s_bfe_u32 s56, s6, 0x10002
    s_lshl_b32 s56, s56, 7
    s_lshr_b32 s57, s6, 3
    s_lshl_b32 s57, s57, 2
    s_add_u32 s56, s56, s57
    s_and_b32 s57, s6, 3
    s_add_u32 s56, s56, s57
    s_lshl_b32 s48, s56, 4
    s_lshl_b32 s49, s3, 16
    s_add_u32 s48, s48, s49
    s_add_u32 s48, s48, 16252928
    v_mov_b32 v24, 2146435072
    v_writelane_b32 v24, s48, 0
    s_add_u32 s48, s48, 16384
    s_lshl_b32 s56, s52, 6
    s_add_u32 s56, s56, s51
    s_lshl_b32 s48, s56, 4
    s_lshl_b32 s49, s3, 16
    s_add_u32 s48, s48, s49
    s_add_u32 s48, s48, 16515072
    v_mov_b32 v25, 2146435072
    v_writelane_b32 v25, s48, 0
    s_add_u32 s48, s48, 16384
    s_add_u32 s48, s2, 216
    s_lshl_b32 s48, s48, 7
    s_add_u32 s48, s48, 622592
    s_lshl_b32 s49, s3, 8
    s_add_u32 s49, s49, s5
    s_cmp_lt_u32 s49, 5
    s_cselect_b32 s48, s48, 2146435072
    v_writelane_b32 v25, s48, 8
    buffer_load_dword v90, v24, s[36:39], 0 offen
    buffer_load_dword v91, v25, s[36:39], 0 offen
    s_branch L_aligned
.p2align 12
L_aligned:
    v_lshlrev_b32 v36, 4, v0
    v_mul_u32_u24 v148, 1184, v18
    v_lshl_add_u32 v148, v19, 2, v148
    s_mul_i32 s48, s3, 2368
    s_add_u32 s48, s48, 100352
    v_add_u32 v148, s48, v148
    v_lshrrev_b32 v220, 1, v1
    v_and_b32 v221, 1, v1
    v_and_b32 v222, 1, v220
    v_cvt_f32_u32 v220, v220
    v_cvt_f32_u32 v221, v221
    v_mul_f32 v220, 0x3e000000, v220
    v_mul_f32 v221, 0x3e800000, v221
    v_mul_u32_u24 v222, 0x8000, v222
    v_lshl_or_b32 v222, v222, 16, v222
    s_lshl_b32 s48, s3, 10
    s_add_u32 s48, s48, 109952
    v_add_u32 v223, s48, v36
    s_mov_b32 s63, 0x3de38e39
    s_add_u32 s48, s3, 0
    s_mul_i32 s49, s48, 43
    s_lshr_b32 s49, s49, 7
    s_mul_i32 s50, s49, 3
    s_sub_u32 s50, s48, s50
    s_lshl_b32 s50, s50, 2
    v_add_u32 v224, s50, v2
    v_cmp_gt_u32 vcc, 9, v224
    v_mul_u32_u24 v224, s49, v224
    v_cvt_f32_u32 v224, v224
    v_fma_f32 v224, v224, s63, v221
    v_add_f32 v225, v224, v220
    v_fma_f32 v226, v220, 2.0, v224
    v_add_f32 v227, v226, v220
    v_cos_f32 v224, v224
    v_cos_f32 v225, v225
    v_cos_f32 v226, v226
    v_cos_f32 v227, v227
    v_cvt_pk_bf16_f32 v232, v224, v225
    v_cvt_pk_bf16_f32 v233, v226, v227
    v_cndmask_b32 v232, 0, v232, vcc
    v_cndmask_b32 v233, 0, v233, vcc
    v_xor_b32 v234, v222, v232
    v_xor_b32 v235, v222, v233
    ds_write_b128 v223, v[232:235] offset:0
    s_add_u32 s48, s3, 4
    s_mul_i32 s49, s48, 43
    s_lshr_b32 s49, s49, 7
    s_mul_i32 s50, s49, 3
    s_sub_u32 s50, s48, s50
    s_lshl_b32 s50, s50, 2
    v_add_u32 v224, s50, v2
    v_cmp_gt_u32 vcc, 9, v224
    v_mul_u32_u24 v224, s49, v224
    v_cvt_f32_u32 v224, v224
    v_fma_f32 v224, v224, s63, v221
    v_add_f32 v225, v224, v220
    v_fma_f32 v226, v220, 2.0, v224
    v_add_f32 v227, v226, v220
    v_cos_f32 v224, v224
    v_cos_f32 v225, v225
    v_cos_f32 v226, v226
    v_cos_f32 v227, v227
    v_cvt_pk_bf16_f32 v236, v224, v225
    v_cvt_pk_bf16_f32 v237, v226, v227
    v_cndmask_b32 v236, 0, v236, vcc
    v_cndmask_b32 v237, 0, v237, vcc
    v_xor_b32 v238, v222, v236
    v_xor_b32 v239, v222, v237
    ds_write_b128 v223, v[236:239] offset:4096
    s_add_u32 s48, s3, 8
    s_mul_i32 s49, s48, 43
    s_lshr_b32 s49, s49, 7
    s_mul_i32 s50, s49, 3
    s_sub_u32 s50, s48, s50
    s_lshl_b32 s50, s50, 2
    v_add_u32 v224, s50, v2
    v_cmp_gt_u32 vcc, 9, v224
    v_mul_u32_u24 v224, s49, v224
    v_cvt_f32_u32 v224, v224
    v_fma_f32 v224, v224, s63, v221
    v_add_f32 v225, v224, v220
    v_fma_f32 v226, v220, 2.0, v224
    v_add_f32 v227, v226, v220
    v_cos_f32 v224, v224
    v_cos_f32 v225, v225
    v_cos_f32 v226, v226
    v_cos_f32 v227, v227
    v_cvt_pk_bf16_f32 v232, v224, v225
    v_cvt_pk_bf16_f32 v233, v226, v227
    v_cndmask_b32 v232, 0, v232, vcc
    v_cndmask_b32 v233, 0, v233, vcc
    v_xor_b32 v234, v222, v232
    v_xor_b32 v235, v222, v233
    ds_write_b128 v223, v[232:235] offset:8192
    s_add_u32 s48, s3, 12
    s_mul_i32 s49, s48, 43
    s_lshr_b32 s49, s49, 7
    s_mul_i32 s50, s49, 3
    s_sub_u32 s50, s48, s50
    s_lshl_b32 s50, s50, 2
    v_add_u32 v224, s50, v2
    v_cmp_gt_u32 vcc, 9, v224
    v_mul_u32_u24 v224, s49, v224
    v_cvt_f32_u32 v224, v224
    v_fma_f32 v224, v224, s63, v221
    v_add_f32 v225, v224, v220
    v_fma_f32 v226, v220, 2.0, v224
    v_add_f32 v227, v226, v220
    v_cos_f32 v224, v224
    v_cos_f32 v225, v225
    v_cos_f32 v226, v226
    v_cos_f32 v227, v227
    v_cvt_pk_bf16_f32 v236, v224, v225
    v_cvt_pk_bf16_f32 v237, v226, v227
    v_cndmask_b32 v236, 0, v236, vcc
    v_cndmask_b32 v237, 0, v237, vcc
    v_xor_b32 v238, v222, v236
    v_xor_b32 v239, v222, v237
    ds_write_b128 v223, v[236:239] offset:12288
    v_lshrrev_b32 v22, 5, v0
    v_lshlrev_b32 v22, 2, v22
    s_lshl_b32 s48, s3, 3
    s_add_u32 s48, s48, 109824
    v_add_u32 v22, s48, v22
    v_bfe_u32 v18, v0, 2, 2
    v_mul_u32_u24 v18, 1184, v18
    v_and_b32 v19, 3, v0
    v_lshl_add_u32 v18, v19, 3, v18
    s_lshl_b32 s48, s3, 5
    s_add_u32 s48, s48, 100352
    v_add_u32 v19, s48, v18
    v_lshl_add_u32 v18, v2, 7, v19
    v_mov_b32 v20, 109824
    v_add_u32 v21, 109952, v36
    s_waitcnt vmcnt(14)
    ds_write_b32 v148, v9 offset:0
    v_lshlrev_b32 v106, 16, v9
    v_and_b32 v107, 0xffff0000, v9
    s_waitcnt vmcnt(13)
    ds_write_b32 v148, v10 offset:128
    v_lshlrev_b32 v108, 16, v10
    v_and_b32 v109, 0xffff0000, v10
    s_waitcnt vmcnt(12)
    ds_write_b32 v148, v11 offset:256
    v_lshlrev_b32 v110, 16, v11
    v_and_b32 v111, 0xffff0000, v11
    s_waitcnt vmcnt(11)
    ds_write_b32 v148, v12 offset:384
    v_lshlrev_b32 v112, 16, v12
    v_and_b32 v113, 0xffff0000, v12
    s_waitcnt vmcnt(10)
    ds_write_b32 v148, v13 offset:512
    v_lshlrev_b32 v114, 16, v13
    v_and_b32 v115, 0xffff0000, v13
    s_waitcnt vmcnt(9)
    ds_write_b32 v148, v14 offset:640
    v_lshlrev_b32 v116, 16, v14
    v_and_b32 v117, 0xffff0000, v14
    s_waitcnt vmcnt(8)
    ds_write_b32 v148, v15 offset:768
    v_lshlrev_b32 v118, 16, v15
    v_and_b32 v119, 0xffff0000, v15
    s_waitcnt vmcnt(7)
    ds_write_b32 v148, v16 offset:896
    v_lshlrev_b32 v120, 16, v16
    v_and_b32 v121, 0xffff0000, v16
    s_waitcnt vmcnt(6)
    ds_write_b32 v148, v17 offset:1024
    v_lshlrev_b32 v122, 16, v17
    v_and_b32 v123, 0xffff0000, v17
    v_pk_add_f32 v[24:25], v[106:107], v[108:109]
    v_pk_mul_f32 v[26:27], v[106:107], v[106:107]
    v_pk_fma_f32 v[26:27], v[108:109], v[108:109], v[26:27]
    v_pk_add_f32 v[24:25], v[24:25], v[110:111]
    v_pk_fma_f32 v[26:27], v[110:111], v[110:111], v[26:27]
    v_pk_add_f32 v[24:25], v[24:25], v[112:113]
    v_pk_fma_f32 v[26:27], v[112:113], v[112:113], v[26:27]
    v_pk_add_f32 v[24:25], v[24:25], v[114:115]
    v_pk_fma_f32 v[26:27], v[114:115], v[114:115], v[26:27]
    v_pk_add_f32 v[24:25], v[24:25], v[116:117]
    v_pk_fma_f32 v[26:27], v[116:117], v[116:117], v[26:27]
    v_pk_add_f32 v[24:25], v[24:25], v[118:119]
    v_pk_fma_f32 v[26:27], v[118:119], v[118:119], v[26:27]
    v_pk_add_f32 v[24:25], v[24:25], v[120:121]
    v_pk_fma_f32 v[26:27], v[120:121], v[120:121], v[26:27]
    v_pk_add_f32 v[24:25], v[24:25], v[122:123]
    v_pk_fma_f32 v[26:27], v[122:123], v[122:123], v[26:27]
    v_add_f32 v24, v24, v25
    v_add_f32 v25, v26, v27
    s_nop 0
    v_add_f32_dpp v24, v24, v24 quad_perm:[1,0,3,2] row_mask:0xf bank_mask:0xf
    v_add_f32_dpp v25, v25, v25 quad_perm:[1,0,3,2] row_mask:0xf bank_mask:0xf
    s_nop 0
    v_add_f32_dpp v24, v24, v24 quad_perm:[2,3,0,1] row_mask:0xf bank_mask:0xf
    v_add_f32_dpp v25, v25, v25 quad_perm:[2,3,0,1] row_mask:0xf bank_mask:0xf
    s_nop 0
    v_add_f32_dpp v24, v24, v24 row_half_mirror row_mask:0xf bank_mask:0xf
    v_add_f32_dpp v25, v25, v25 row_half_mirror row_mask:0xf bank_mask:0xf
    s_nop 0
    v_add_f32_dpp v24, v24, v24 row_mirror row_mask:0xf bank_mask:0xf
    v_add_f32_dpp v25, v25, v25 row_mirror row_mask:0xf bank_mask:0xf
    v_mov_b32 v26, v24
    v_mov_b32 v27, v25
    s_nop 0
    v_permlane16_swap_b32 v24, v26
    v_permlane16_swap_b32 v25, v27
    v_add_f32 v24, v24, v26
    v_add_f32 v25, v25, v27
    v_mul_f32 v24, 0xbae38e39, v24
    v_mul_f32 v25, 0x3ae38e39, v25
    v_fma_f32 v25, -v24, v24, v25
    v_max_f32 v25, 0, v25
    v_add_f32 v25, 0x3727c5ac, v25
    v_rsq_f32 v26, v25
    s_nop 0
    v_mul_f32 v24, v24, v26
    ds_write_b32 v22, v26
    ds_write_b32 v22, v24 offset:32
    s_waitcnt lgkmcnt(0)
    s_barrier
    ds_read_b128 v[132:135], v20 offset:0
    ds_read_b128 v[136:139], v20 offset:16
    ds_read_b128 v[140:143], v20 offset:32
    ds_read_b128 v[144:147], v20 offset:48
    ds_read_b64_tr_b16 v[148:149], v18 offset:0
    ds_read_b64_tr_b16 v[150:151], v18 offset:4736
    ds_read_b64_tr_b16 v[152:153], v18 offset:512
    ds_read_b64_tr_b16 v[154:155], v18 offset:5248
    ds_read_b64_tr_b16 v[156:157], v19 offset:1024
    ds_read_b64_tr_b16 v[158:159], v19 offset:5760
    ds_read_b128 v[160:163], v21 offset:0
    ds_read_b128 v[164:167], v21 offset:1024
    ds_read_b128 v[168:171], v21 offset:2048
    ds_read_b128 v[172:175], v21 offset:3072
    ds_read_b128 v[176:179], v21 offset:4096
    ds_read_b128 v[180:183], v21 offset:5120
    ds_read_b128 v[184:187], v21 offset:6144
    ds_read_b128 v[188:191], v21 offset:7168
    ds_read_b128 v[192:195], v21 offset:8192
    ds_read_b128 v[196:199], v21 offset:9216
    ds_read_b128 v[200:203], v21 offset:10240
    ds_read_b128 v[204:207], v21 offset:11264
    ds_read_b128 v[208:211], v21 offset:12288
    ds_read_b128 v[212:215], v21 offset:13312
    ds_read_b128 v[216:219], v21 offset:14336
    s_lshl_b32 s48, s3, 4
    v_add_u32 v24, s48, v1
    v_cvt_f32_u32 v24, v24
    v_mul_f32 v24, 0x3c800000, v24
    v_cvt_f32_u32 v26, v2
    v_mul_f32 v26, 4.0, v26
    v_mul_f32 v25, v26, v24
    v_cos_f32 v19, v25
    v_sin_f32 v20, v25
    s_nop 0
    v_cvt_pk_bf16_f32 v40, v19, v20
    v_cvt_pk_bf16_f32 v44, -v20, v19
    v_fma_f32 v21, v24, 1.0, v25
    v_cos_f32 v22, v21
    v_sin_f32 v23, v21
    s_nop 0
    v_cvt_pk_bf16_f32 v41, v22, v23
    v_cvt_pk_bf16_f32 v45, -v23, v22
    v_fma_f32 v18, v24, 2.0, v25
    v_cos_f32 v19, v18
    v_sin_f32 v20, v18
    s_nop 0
    v_cvt_pk_bf16_f32 v42, v19, v20
    v_cvt_pk_bf16_f32 v46, -v20, v19
    v_add_f32 v21, v18, v24
    v_cos_f32 v22, v21
    v_sin_f32 v23, v21
    s_nop 0
    v_cvt_pk_bf16_f32 v43, v22, v23
    v_cvt_pk_bf16_f32 v47, -v23, v22
    v_add_f32 v26, 0x41800000, v26
    v_mul_f32 v25, v26, v24
    v_cos_f32 v19, v25
    v_sin_f32 v20, v25
    s_nop 0
    v_cvt_pk_bf16_f32 v48, v19, v20
    v_cvt_pk_bf16_f32 v52, -v20, v19
    v_fma_f32 v21, v24, 1.0, v25
    v_cos_f32 v22, v21
    v_sin_f32 v23, v21
    s_nop 0
    v_cvt_pk_bf16_f32 v49, v22, v23
    v_cvt_pk_bf16_f32 v53, -v23, v22
    v_fma_f32 v18, v24, 2.0, v25
    v_cos_f32 v19, v18
    v_sin_f32 v20, v18
    s_nop 0
    v_cvt_pk_bf16_f32 v50, v19, v20
    v_cvt_pk_bf16_f32 v54, -v20, v19
    v_add_f32 v21, v18, v24
    v_cos_f32 v22, v21
    v_sin_f32 v23, v21
    s_nop 0
    v_cvt_pk_bf16_f32 v51, v22, v23
    v_cvt_pk_bf16_f32 v55, -v23, v22
    v_add_f32 v26, 0x41800000, v26
    v_mul_f32 v25, v26, v24
    v_cos_f32 v19, v25
    v_sin_f32 v20, v25
    s_nop 0
    v_cvt_pk_bf16_f32 v56, v19, v20
    v_cvt_pk_bf16_f32 v60, -v20, v19
    v_fma_f32 v21, v24, 1.0, v25
    v_cos_f32 v22, v21
    v_sin_f32 v23, v21
    s_nop 0
    v_cvt_pk_bf16_f32 v57, v22, v23
    v_cvt_pk_bf16_f32 v61, -v23, v22
    v_fma_f32 v18, v24, 2.0, v25
    v_cos_f32 v19, v18
    v_sin_f32 v20, v18
    s_nop 0
    v_cvt_pk_bf16_f32 v58, v19, v20
    v_cvt_pk_bf16_f32 v62, -v20, v19
    v_add_f32 v21, v18, v24
    v_cos_f32 v22, v21
    v_sin_f32 v23, v21
    s_nop 0
    v_cvt_pk_bf16_f32 v59, v22, v23
    v_cvt_pk_bf16_f32 v63, -v23, v22
    v_add_f32 v26, 0x41800000, v26
    v_mul_f32 v25, v26, v24
    v_cos_f32 v19, v25
    v_sin_f32 v20, v25
    s_nop 0
    v_cvt_pk_bf16_f32 v64, v19, v20
    v_cvt_pk_bf16_f32 v68, -v20, v19
    v_fma_f32 v21, v24, 1.0, v25
    v_cos_f32 v22, v21
    v_sin_f32 v23, v21
    s_nop 0
    v_cvt_pk_bf16_f32 v65, v22, v23
    v_cvt_pk_bf16_f32 v69, -v23, v22
    v_fma_f32 v18, v24, 2.0, v25
    v_cos_f32 v19, v18
    v_sin_f32 v20, v18
    s_nop 0
    v_cvt_pk_bf16_f32 v66, v19, v20
    v_cvt_pk_bf16_f32 v70, -v20, v19
    v_add_f32 v21, v18, v24
    v_cos_f32 v22, v21
    v_sin_f32 v23, v21
    s_nop 0
    v_cvt_pk_bf16_f32 v67, v22, v23
    v_cvt_pk_bf16_f32 v71, -v23, v22
    v_mul_f32 v37, 0x3de38e39, v24
    v_mul_f32 v22, 0x3f800000, v37
    v_cos_f32 v98, v22
    v_sin_f32 v99, v22
    v_mul_f32 v22, 0x40000000, v37
    v_cos_f32 v100, v22
    v_sin_f32 v101, v22
    v_mul_f32 v22, 0x40400000, v37
    v_cos_f32 v102, v22
    v_sin_f32 v103, v22
    v_mul_f32 v22, 0x40800000, v37
    v_cos_f32 v104, v22
    v_sin_f32 v105, v22
L_m_1:
    s_waitcnt lgkmcnt(14)
    v_lshlrev_b32 v106, 16, v148
    v_and_b32 v107, 0xffff0000, v148
    v_pk_fma_f32 v[106:107], v[106:107], v[132:133], v[140:141]
    v_lshlrev_b32 v108, 16, v149
    v_and_b32 v109, 0xffff0000, v149
    v_pk_fma_f32 v[108:109], v[108:109], v[134:135], v[142:143]
    v_lshlrev_b32 v110, 16, v150
    v_and_b32 v111, 0xffff0000, v150
    v_pk_fma_f32 v[110:111], v[110:111], v[136:137], v[144:145]
    v_lshlrev_b32 v112, 16, v151
    v_and_b32 v113, 0xffff0000, v151
    v_pk_fma_f32 v[112:113], v[112:113], v[138:139], v[146:147]
    v_lshlrev_b32 v114, 16, v152
    v_and_b32 v115, 0xffff0000, v152
    v_pk_fma_f32 v[114:115], v[114:115], v[132:133], v[140:141]
    v_lshlrev_b32 v116, 16, v153
    v_and_b32 v117, 0xffff0000, v153
    v_pk_fma_f32 v[116:117], v[116:117], v[134:135], v[142:143]
    v_lshlrev_b32 v118, 16, v154
    v_and_b32 v119, 0xffff0000, v154
    v_pk_fma_f32 v[118:119], v[118:119], v[136:137], v[144:145]
    v_lshlrev_b32 v120, 16, v155
    v_and_b32 v121, 0xffff0000, v155
    v_pk_fma_f32 v[120:121], v[120:121], v[138:139], v[146:147]
    v_lshlrev_b32 v122, 16, v156
    v_and_b32 v123, 0xffff0000, v156
    v_pk_fma_f32 v[122:123], v[122:123], v[132:133], v[140:141]
    v_lshlrev_b32 v124, 16, v157
    v_and_b32 v125, 0xffff0000, v157
    v_pk_fma_f32 v[124:125], v[124:125], v[134:135], v[142:143]
    v_lshlrev_b32 v126, 16, v158
    v_and_b32 v127, 0xffff0000, v158
    v_pk_fma_f32 v[126:127], v[126:127], v[136:137], v[144:145]
    v_lshlrev_b32 v128, 16, v159
    v_and_b32 v129, 0xffff0000, v159
    v_pk_fma_f32 v[128:129], v[128:129], v[138:139], v[146:147]
    s_waitcnt lgkmcnt(0)
    s_cmp_ge_u32 s2, 202
    s_cbranch_scc1 L_m_2
    v_and_b32 v220, 7, v1
    v_cvt_f32_u32 v220, v220
    v_mul_f32 v220, 0x3e000000, v220
    v_and_b32 v221, 1, v2
    v_cvt_f32_u32 v221, v221
    v_mul_f32 v221, 4.0, v221
    v_mul_f32 v221, v221, v220
    v_lshrrev_b32 v222, 3, v1
    v_lshrrev_b32 v223, 1, v2
    s_lshl_b32 s48, s3, 10
    s_add_u32 s48, s48, 147456
    v_add_u32 v224, s48, v36
    s_add_u32 s48, s3, 0
    s_mul_i32 s49, s48, 43
    s_lshr_b32 s49, s49, 7
    s_mul_i32 s50, s49, 3
    s_sub_u32 s50, s48, s50
    s_lshl_b32 s50, s50, 1
    s_lshl_b32 s49, s49, 1
    v_add_u32 v225, s49, v222
    v_add_u32 v226, s50, v223
    v_cmp_gt_u32 vcc, 9, v225
    v_cmp_gt_u32 s[48:49], 5, v226
    v_mul_u32_u24 v225, v225, v226
    v_cvt_f32_u32 v225, v225
    s_and_b64 vcc, vcc, s[48:49]
    v_fma_f32 v225, v225, s63, v221
    v_cos_f32 v226, v225
    v_sin_f32 v227, v225
    s_nop 0
    v_cvt_pk_bf16_f32 v232, v226, -v227
    v_add_f32 v225, v225, v220
    v_cos_f32 v228, v225
    v_sin_f32 v229, v225
    s_nop 0
    v_cvt_pk_bf16_f32 v233, v228, -v229
    v_add_f32 v225, v225, v220
    v_cos_f32 v226, v225
    v_sin_f32 v227, v225
    s_nop 0
    v_cvt_pk_bf16_f32 v234, v226, -v227
    v_add_f32 v225, v225, v220
    v_cos_f32 v228, v225
    v_sin_f32 v229, v225
    s_nop 0
    v_cvt_pk_bf16_f32 v235, v228, -v229
    v_cndmask_b32 v232, 0, v232, vcc
    v_cndmask_b32 v233, 0, v233, vcc
    v_cndmask_b32 v234, 0, v234, vcc
    v_cndmask_b32 v235, 0, v235, vcc
    ds_write_b128 v224, v[232:235] offset:0
    s_add_u32 s48, s3, 4
    s_mul_i32 s49, s48, 43
    s_lshr_b32 s49, s49, 7
    s_mul_i32 s50, s49, 3
    s_sub_u32 s50, s48, s50
    s_lshl_b32 s50, s50, 1
    s_lshl_b32 s49, s49, 1
    v_add_u32 v225, s49, v222
    v_add_u32 v226, s50, v223
    v_cmp_gt_u32 vcc, 9, v225
    v_cmp_gt_u32 s[48:49], 5, v226
    v_mul_u32_u24 v225, v225, v226
    v_cvt_f32_u32 v225, v225
    s_and_b64 vcc, vcc, s[48:49]
    v_fma_f32 v225, v225, s63, v221
    v_cos_f32 v226, v225
    v_sin_f32 v227, v225
    s_nop 0
    v_cvt_pk_bf16_f32 v236, v226, -v227
    v_add_f32 v225, v225, v220
    v_cos_f32 v228, v225
    v_sin_f32 v229, v225
    s_nop 0
    v_cvt_pk_bf16_f32 v237, v228, -v229
    v_add_f32 v225, v225, v220
    v_cos_f32 v226, v225
    v_sin_f32 v227, v225
    s_nop 0
    v_cvt_pk_bf16_f32 v238, v226, -v227
    v_add_f32 v225, v225, v220
    v_cos_f32 v228, v225
    v_sin_f32 v229, v225
    s_nop 0
    v_cvt_pk_bf16_f32 v239, v228, -v229
    v_cndmask_b32 v236, 0, v236, vcc
    v_cndmask_b32 v237, 0, v237, vcc
    v_cndmask_b32 v238, 0, v238, vcc
    v_cndmask_b32 v239, 0, v239, vcc
    ds_write_b128 v224, v[236:239] offset:4096
    s_add_u32 s48, s3, 8
    s_mul_i32 s49, s48, 43
    s_lshr_b32 s49, s49, 7
    s_mul_i32 s50, s49, 3
    s_sub_u32 s50, s48, s50
    s_lshl_b32 s50, s50, 1
    s_lshl_b32 s49, s49, 1
    v_add_u32 v225, s49, v222
    v_add_u32 v226, s50, v223
    v_cmp_gt_u32 vcc, 9, v225
    v_cmp_gt_u32 s[48:49], 5, v226
    v_mul_u32_u24 v225, v225, v226
    v_cvt_f32_u32 v225, v225
    s_and_b64 vcc, vcc, s[48:49]
    v_fma_f32 v225, v225, s63, v221
    v_cos_f32 v226, v225
    v_sin_f32 v227, v225
    s_nop 0
    v_cvt_pk_bf16_f32 v232, v226, -v227
    v_add_f32 v225, v225, v220
    v_cos_f32 v228, v225
    v_sin_f32 v229, v225
    s_nop 0
    v_cvt_pk_bf16_f32 v233, v228, -v229
    v_add_f32 v225, v225, v220
    v_cos_f32 v226, v225
    v_sin_f32 v227, v225
    s_nop 0
    v_cvt_pk_bf16_f32 v234, v226, -v227
    v_add_f32 v225, v225, v220
    v_cos_f32 v228, v225
    v_sin_f32 v229, v225
    s_nop 0
    v_cvt_pk_bf16_f32 v235, v228, -v229
    v_cndmask_b32 v232, 0, v232, vcc
    v_cndmask_b32 v233, 0, v233, vcc
    v_cndmask_b32 v234, 0, v234, vcc
    v_cndmask_b32 v235, 0, v235, vcc
    ds_write_b128 v224, v[232:235] offset:8192
    s_add_u32 s48, s3, 12
    s_mul_i32 s49, s48, 43
    s_lshr_b32 s49, s49, 7
    s_mul_i32 s50, s49, 3
    s_sub_u32 s50, s48, s50
    s_lshl_b32 s50, s50, 1
    s_lshl_b32 s49, s49, 1
    v_add_u32 v225, s49, v222
    v_add_u32 v226, s50, v223
    v_cmp_gt_u32 vcc, 9, v225
    v_cmp_gt_u32 s[48:49], 5, v226
    v_mul_u32_u24 v225, v225, v226
    v_cvt_f32_u32 v225, v225
    s_and_b64 vcc, vcc, s[48:49]
    v_fma_f32 v225, v225, s63, v221
    v_cos_f32 v226, v225
    v_sin_f32 v227, v225
    s_nop 0
    v_cvt_pk_bf16_f32 v236, v226, -v227
    v_add_f32 v225, v225, v220
    v_cos_f32 v228, v225
    v_sin_f32 v229, v225
    s_nop 0
    v_cvt_pk_bf16_f32 v237, v228, -v229
    v_add_f32 v225, v225, v220
    v_cos_f32 v226, v225
    v_sin_f32 v227, v225
    s_nop 0
    v_cvt_pk_bf16_f32 v238, v226, -v227
    v_add_f32 v225, v225, v220
    v_cos_f32 v228, v225
    v_sin_f32 v229, v225
    s_nop 0
    v_cvt_pk_bf16_f32 v239, v228, -v229
    v_cndmask_b32 v236, 0, v236, vcc
    v_cndmask_b32 v237, 0, v237, vcc
    v_cndmask_b32 v238, 0, v238, vcc
    v_cndmask_b32 v239, 0, v239, vcc
    ds_write_b128 v224, v[236:239] offset:12288
L_m_2:
    v_lshrrev_b32 v22, 1, v2
    v_cvt_f32_u32 v22, v22
    v_add_f32 v23, 1.0, v22
    v_mul_f32 v23, 0x35638e39, v23
    v_mul_f32 v24, v22, v37
    v_cos_f32 v25, v24
    v_sin_f32 v26, v24
    v_mul_f32 v30, v23, v25
    v_mul_f32 v31, v23, v26
    v_add_f32 v22, 2.0, v22
    v_mul_f32 v24, v22, v37
    v_cos_f32 v25, v24
    v_sin_f32 v26, v24
    v_mul_f32 v32, 0x35e38e39, v25
    v_mul_f32 v33, 0x35e38e39, v26
    v_add_f32 v22, 2.0, v22
    v_mul_f32 v24, v22, v37
    v_cos_f32 v25, v24
    v_sin_f32 v26, v24
    v_mul_f32 v34, 0x35e38e39, v25
    v_mul_f32 v35, 0x35e38e39, v26
    s_mov_b32 s48, 0x9e3779b1
    s_waitcnt vmcnt(5)
    v_mul_lo_u32 v3, v3, s48
    v_add_u32 v3, 0x7f4a7c15, v3
    v_or_b32 v3, 0x01010101, v3
    s_lshl_b32 s48, s3, 6
    s_add_u32 s48, s48, 126336
    v_mul_u32_u24 v18, 576, v2
    v_lshl_add_u32 v18, v1, 2, v18
    v_add_u32 v18, s48, v18
    v_mul_u32_u24 v19, 288, v1
    v_lshl_add_u32 v19, v2, 4, v19
    v_add_u32 v19, 126336, v19
    v_bfe_u32 v27, v1, 1, 2
    v_xor_b32 v27, v27, v2
    v_lshl_add_u32 v27, v1, 2, v27
    s_mul_i32 s48, s3, 3072
    s_add_u32 s48, s48, 77824
    v_lshl_add_u32 v27, v27, 4, s48
    v_add_u32 v28, s48, v36
    v_lshrrev_b32 v20, 3, v0
    v_xor_b32 v20, v20, v0
    v_and_b32 v20, 3, v20
    v_lshlrev_b32 v20, 4, v20
    v_lshrrev_b32 v21, 2, v0
    v_lshl_add_u32 v20, v21, 16, v20
    s_lshl_b32 s48, s3, 14
    s_lshl_b32 s49, s6, 6
    s_add_u32 s48, s48, s49
    s_add_u32 s48, s48, 4194304
    v_add_u32 v20, s48, v20
    v_add_u32 v21, 1048576, v20
    v_add_u32 v22, 2097152, v20
    v_cmp_gt_u32 vcc, 32, v0
    v_mov_b32 v23, 2146435072
    s_nop 0
    v_cndmask_b32 v22, v23, v22, vcc
    s_lshl_b32 s58, s3, 12
    s_add_u32 s58, s58, 61440
    v_lshl_add_u32 v93, v1, 2, s58
    s_waitcnt vmcnt(1)
    v_lshl_add_u32 v90, v2, 6, v93
    v_add_u32 v93, 512, v93
    s_waitcnt vmcnt(0)
    v_add_u32 v91, 1152, v90
    v_add_u32 v92, 2304, v90
    v_add_u32 v94, 1152, v93
    v_add_u32 v95, 2304, v93
    v_cmp_gt_u32 vcc, 24, v0
    s_nop 1
    v_cndmask_b32 v96, v23, v36, vcc
    s_mul_i32 s59, s4, 13824
    s_mul_i32 s48, s3, 3456
    s_add_u32 s59, s59, s48
    s_add_u32 s59, s59, 15204352
    v_min_u32 v97, 496, v36
    s_mul_i32 s48, s3, 2560
    s_mul_i32 s60, s6, 10240
    s_add_u32 s60, s60, s48
    s_add_u32 s60, s60, 8388608
    v_mov_b64 v[144:145], -1
    v_mov_b64 v[146:147], -1
    v_and_b32 v24, 3, v1
    v_lshlrev_b32 v24, 3, v24
    v_bfe_u32 v24, v3, v24, 8
    s_mov_b32 m0, s58
    s_branch L_stub_1
L_back_c1:
    s_waitcnt vmcnt(0) lgkmcnt(0)
Lp_m_3:
    buffer_load_dwordx4 v36, s[36:39], s59 offen offset:0 sc1 lds
    buffer_load_dwordx4 v36, s[36:39], s59 offen offset:1024 sc1 lds
    buffer_load_dwordx4 v36, s[36:39], s59 offen offset:2048 sc1 lds
    buffer_load_dwordx4 v96, s[36:39], s59 offen offset:3072 sc1 lds
    s_waitcnt vmcnt(0)
    ds_read2_b32 v[72:73], v90 offset0:0 offset1:144
    ds_read2_b32 v[74:75], v90 offset0:64 offset1:208
    ds_read2_b32 v[76:77], v93 offset0:0 offset1:144
    ds_read2_b32 v[78:79], v91 offset0:0 offset1:144
    ds_read2_b32 v[80:81], v91 offset0:64 offset1:208
    ds_read2_b32 v[82:83], v94 offset0:0 offset1:144
    ds_read2_b32 v[84:85], v92 offset0:0 offset1:144
    ds_read2_b32 v[86:87], v92 offset0:64 offset1:208
    ds_read2_b32 v[88:89], v95 offset0:0 offset1:144
    s_waitcnt lgkmcnt(8)
    v_xor_b32 v72, v72, v24
    v_xor_b32 v73, v73, v24
    v_or_b32 v26, v72, v73
    s_waitcnt lgkmcnt(7)
    v_xor_b32 v74, v74, v24
    v_xor_b32 v75, v75, v24
    v_or3_b32 v26, v74, v75, v26
    s_waitcnt lgkmcnt(6)
    v_xor_b32 v76, v76, v24
    v_xor_b32 v77, v77, v24
    v_or3_b32 v26, v76, v77, v26
    s_waitcnt lgkmcnt(5)
    v_xor_b32 v78, v78, v24
    v_xor_b32 v79, v79, v24
    v_or3_b32 v26, v78, v79, v26
    s_waitcnt lgkmcnt(4)
    v_xor_b32 v80, v80, v24
    v_xor_b32 v81, v81, v24
    v_or3_b32 v26, v80, v81, v26
    s_waitcnt lgkmcnt(3)
    v_xor_b32 v82, v82, v24
    v_xor_b32 v83, v83, v24
    v_or3_b32 v26, v82, v83, v26
    s_waitcnt lgkmcnt(2)
    v_xor_b32 v84, v84, v24
    v_xor_b32 v85, v85, v24
    v_or3_b32 v26, v84, v85, v26
    s_waitcnt lgkmcnt(1)
    v_xor_b32 v86, v86, v24
    v_xor_b32 v87, v87, v24
    v_or3_b32 v26, v86, v87, v26
    s_waitcnt lgkmcnt(0)
    v_xor_b32 v88, v88, v24
    v_xor_b32 v89, v89, v24
    v_or3_b32 v26, v88, v89, v26
    v_and_b32 v26, 0xff, v26
    v_cmp_ne_u32 vcc, 0, v26
    s_nop 0
    s_cbranch_vccz Le_m_4
    s_sub_u32 s7, s7, 1
    s_cbranch_scc1 Le_m_4
    s_sleep 1
    s_branch Lp_m_3
Le_m_4:
    s_max_i32 s7, s7, 0
    buffer_store_dwordx4 v[144:147], v36, s[36:39], s60 offen offset:0 sc1
    buffer_store_dwordx4 v[144:147], v36, s[36:39], s60 offen offset:1024 sc1
    buffer_store_dwordx4 v[144:147], v97, s[36:39], s60 offen offset:2048 sc1
    v_pk_add_f32 v[72:73], v[72:73], v[78:79]
    v_pk_add_f32 v[74:75], v[74:75], v[80:81]
    v_pk_add_f32 v[76:77], v[76:77], v[82:83]
    v_pk_add_f32 v[72:73], v[72:73], v[84:85]
    v_pk_add_f32 v[74:75], v[74:75], v[86:87]
    v_pk_add_f32 v[76:77], v[76:77], v[88:89]
    v_cvt_pk_bf16_f32 v78, v72, v73
    v_and_b32 v73, 0xffff0000, v78
    v_add_f32 v73, 1.0, v73
    v_lshlrev_b32 v72, 16, v78
    v_cvt_pk_bf16_f32 v73, 0, v73
    v_pk_fma_f32 v[106:107], v[106:107], v[72:73], v[72:73] op_sel:[0,1,0] op_sel_hi:[1,1,0]
    s_branch L_skip_1
L_stub_1:
    s_branch L_stub_2
L_skip_1:
    v_pk_fma_f32 v[108:109], v[108:109], v[72:73], v[72:73] op_sel:[0,1,0] op_sel_hi:[1,1,0]
    v_pk_fma_f32 v[110:111], v[110:111], v[72:73], v[72:73] op_sel:[0,1,0] op_sel_hi:[1,1,0]
    v_pk_fma_f32 v[112:113], v[112:113], v[72:73], v[72:73] op_sel:[0,1,0] op_sel_hi:[1,1,0]
    v_cvt_pk_bf16_f32 v148, v106, v107
    v_cvt_pk_bf16_f32 v149, v108, v109
    v_cvt_pk_bf16_f32 v150, v110, v111
    v_cvt_pk_bf16_f32 v151, v112, v113
    v_cvt_pk_bf16_f32 v80, v74, v75
    v_and_b32 v75, 0xffff0000, v80
    v_add_f32 v75, 1.0, v75
    v_lshlrev_b32 v74, 16, v80
    v_cvt_pk_bf16_f32 v75, 0, v75
    v_pk_fma_f32 v[114:115], v[114:115], v[74:75], v[74:75] op_sel:[0,1,0] op_sel_hi:[1,1,0]
    v_pk_fma_f32 v[116:117], v[116:117], v[74:75], v[74:75] op_sel:[0,1,0] op_sel_hi:[1,1,0]
    v_pk_fma_f32 v[118:119], v[118:119], v[74:75], v[74:75] op_sel:[0,1,0] op_sel_hi:[1,1,0]
    v_pk_fma_f32 v[120:121], v[120:121], v[74:75], v[74:75] op_sel:[0,1,0] op_sel_hi:[1,1,0]
    v_cvt_pk_bf16_f32 v152, v114, v115
    v_cvt_pk_bf16_f32 v153, v116, v117
    v_cvt_pk_bf16_f32 v154, v118, v119
    v_cvt_pk_bf16_f32 v155, v120, v121
    v_cvt_pk_bf16_f32 v82, v76, v77
    v_and_b32 v77, 0xffff0000, v82
    v_add_f32 v77, 1.0, v77
    v_lshlrev_b32 v76, 16, v82
    v_cvt_pk_bf16_f32 v77, 0, v77
    v_pk_fma_f32 v[122:123], v[122:123], v[76:77], v[76:77] op_sel:[0,1,0] op_sel_hi:[1,1,0]
    v_pk_fma_f32 v[124:125], v[124:125], v[76:77], v[76:77] op_sel:[0,1,0] op_sel_hi:[1,1,0]
    v_pk_fma_f32 v[126:127], v[126:127], v[76:77], v[76:77] op_sel:[0,1,0] op_sel_hi:[1,1,0]
    v_pk_fma_f32 v[128:129], v[128:129], v[76:77], v[76:77] op_sel:[0,1,0] op_sel_hi:[1,1,0]
    v_cvt_pk_bf16_f32 v156, v122, v123
    v_cvt_pk_bf16_f32 v157, v124, v125
    v_cvt_pk_bf16_f32 v158, v126, v127
    v_cvt_pk_bf16_f32 v159, v128, v129
    v_mfma_f32_16x16x32_bf16 v[224:227], v[172:175], v[148:151], 0
    v_mfma_f32_16x16x32_bf16 v[224:227], v[176:179], v[152:155], v[224:227]
    v_mfma_f32_16x16x32_bf16 v[224:227], v[180:183], v[156:159], v[224:227]
    v_mfma_f32_16x16x32_bf16 v[228:231], v[184:187], v[148:151], 0
    v_mfma_f32_16x16x32_bf16 v[228:231], v[188:191], v[152:155], v[228:231]
    v_mfma_f32_16x16x32_bf16 v[228:231], v[192:195], v[156:159], v[228:231]
    v_mfma_f32_16x16x32_bf16 v[232:235], v[196:199], v[148:151], 0
    s_nop 3
    v_mul_f32 v114, v224, v98
    v_mul_f32 v115, v225, v98
    v_mfma_f32_16x16x32_bf16 v[232:235], v[200:203], v[152:155], v[232:235]
    v_fmac_f32 v114, v225, v99
    v_fma_f32 v115, -v224, v99, v115
    v_mfma_f32_16x16x32_bf16 v[232:235], v[204:207], v[156:159], v[232:235]
    v_cvt_pk_bf16_f32 v116, v114, v115
    ds_write_b32 v18, v116 offset:2304
    v_mfma_f32_16x16x32_bf16 v[236:239], v[208:211], v[148:151], 0
    v_mul_f32 v118, v226, v98
    v_mul_f32 v119, v227, v98
    v_mfma_f32_16x16x32_bf16 v[236:239], v[212:215], v[152:155], v[236:239]
    v_fmac_f32 v118, v227, v99
    v_fma_f32 v119, -v226, v99, v119
    v_mfma_f32_16x16x32_bf16 v[236:239], v[216:219], v[156:159], v[236:239]
    v_cvt_pk_bf16_f32 v120, v118, v119
    ds_write_b32 v18, v120 offset:2592
    v_mfma_f32_16x16x32_bf16 v[220:223], v[160:163], v[148:151], 0
    v_mul_f32 v106, v228, v100
    v_mul_f32 v107, v229, v100
    v_mfma_f32_16x16x32_bf16 v[220:223], v[164:167], v[152:155], v[220:223]
    v_fmac_f32 v106, v229, v101
    v_fma_f32 v107, -v228, v101, v107
    v_mfma_f32_16x16x32_bf16 v[220:223], v[168:171], v[156:159], v[220:223]
    v_cvt_pk_bf16_f32 v108, v106, v107
    ds_write_b32 v18, v108 offset:4608
    v_mul_f32 v110, v230, v100
    v_mul_f32 v111, v231, v100
    v_fmac_f32 v110, v231, v101
    v_fma_f32 v111, -v230, v101, v111
    v_cvt_pk_bf16_f32 v112, v110, v111
    ds_write_b32 v18, v112 offset:4896
    v_mul_f32 v114, v232, v102
    v_mul_f32 v115, v233, v102
    v_fmac_f32 v114, v233, v103
    v_fma_f32 v115, -v232, v103, v115
    v_cvt_pk_bf16_f32 v116, v114, v115
    ds_write_b32 v18, v116 offset:6912
    v_mul_f32 v118, v234, v102
    v_mul_f32 v119, v235, v102
    v_fmac_f32 v118, v235, v103
    v_fma_f32 v119, -v234, v103, v119
    v_cvt_pk_bf16_f32 v120, v118, v119
    ds_write_b32 v18, v120 offset:7200
    v_mul_f32 v106, v236, v104
    v_mul_f32 v107, v237, v104
    v_fmac_f32 v106, v237, v105
    v_fma_f32 v107, -v236, v105, v107
    v_cvt_pk_bf16_f32 v108, v106, v107
    ds_write_b32 v18, v108 offset:9216
    v_mul_f32 v110, v238, v104
    v_mul_f32 v111, v239, v104
    v_fmac_f32 v110, v239, v105
    v_fma_f32 v111, -v238, v105, v111
    v_cvt_pk_bf16_f32 v112, v110, v111
    ds_write_b32 v18, v112 offset:9504
    v_cvt_pk_bf16_f32 v108, v220, v221
    ds_write_b32 v18, v108 offset:0
    v_cvt_pk_bf16_f32 v112, v222, v223
    ds_write_b32 v18, v112 offset:288
    s_waitcnt lgkmcnt(0)
    s_barrier
    ds_read_b128 v[160:163], v19 offset:0
    ds_read_b128 v[164:167], v19 offset:64
    ds_read_b128 v[168:171], v19 offset:128
    ds_read_b128 v[172:175], v19 offset:192
    ds_read_b128 v[176:179], v19 offset:4608
    ds_read_b128 v[180:183], v19 offset:4672
    ds_read_b128 v[184:187], v19 offset:4736
    ds_read_b128 v[188:191], v19 offset:4800
    ds_read_b128 v[192:195], v19 offset:9216
    ds_read_b128 v[196:199], v19 offset:9280
    ds_read_b128 v[200:203], v19 offset:9344
    ds_read_b128 v[204:207], v19 offset:9408
    s_waitcnt lgkmcnt(11)
    v_mfma_f32_16x16x32_bf16 v[220:223], v[40:43], v[160:163], 0
    v_mfma_f32_16x16x32_bf16 v[224:227], v[44:47], v[160:163], 0
    s_waitcnt lgkmcnt(10)
    v_mfma_f32_16x16x32_bf16 v[220:223], v[48:51], v[164:167], v[220:223]
    v_mfma_f32_16x16x32_bf16 v[224:227], v[52:55], v[164:167], v[224:227]
    s_waitcnt lgkmcnt(9)
    v_mfma_f32_16x16x32_bf16 v[220:223], v[56:59], v[168:171], v[220:223]
    v_mfma_f32_16x16x32_bf16 v[224:227], v[60:63], v[168:171], v[224:227]
    s_waitcnt lgkmcnt(8)
    v_mfma_f32_16x16x32_bf16 v[220:223], v[64:67], v[172:175], v[220:223]
    v_mfma_f32_16x16x32_bf16 v[224:227], v[68:71], v[172:175], v[224:227]
    s_waitcnt lgkmcnt(7)
    v_mfma_f32_16x16x32_bf16 v[228:231], v[40:43], v[176:179], 0
    v_mfma_f32_16x16x32_bf16 v[232:235], v[44:47], v[176:179], 0
    s_waitcnt lgkmcnt(6)
    v_mfma_f32_16x16x32_bf16 v[228:231], v[48:51], v[180:183], v[228:231]
    v_mfma_f32_16x16x32_bf16 v[232:235], v[52:55], v[180:183], v[232:235]
    s_waitcnt lgkmcnt(5)
    v_mfma_f32_16x16x32_bf16 v[228:231], v[56:59], v[184:187], v[228:231]
    v_cvt_pk_bf16_f32 v148, v220, v224
    v_mfma_f32_16x16x32_bf16 v[232:235], v[60:63], v[184:187], v[232:235]
    v_cvt_pk_bf16_f32 v149, v221, v225
    s_waitcnt lgkmcnt(4)
    v_mfma_f32_16x16x32_bf16 v[228:231], v[64:67], v[188:191], v[228:231]
    v_cvt_pk_bf16_f32 v150, v222, v226
    v_mfma_f32_16x16x32_bf16 v[232:235], v[68:71], v[188:191], v[232:235]
    v_cvt_pk_bf16_f32 v151, v223, v227
    ds_write_b128 v27, v[148:151] offset:0
    ds_read_b128 v[132:135], v28 offset:0
    s_waitcnt lgkmcnt(5)
    v_mfma_f32_16x16x32_bf16 v[236:239], v[40:43], v[192:195], 0
    v_mfma_f32_16x16x32_bf16 v[240:243], v[44:47], v[192:195], 0
    s_waitcnt lgkmcnt(4)
    v_mfma_f32_16x16x32_bf16 v[236:239], v[48:51], v[196:199], v[236:239]
    v_mfma_f32_16x16x32_bf16 v[240:243], v[52:55], v[196:199], v[240:243]
    s_waitcnt lgkmcnt(3)
    v_mfma_f32_16x16x32_bf16 v[236:239], v[56:59], v[200:203], v[236:239]
    v_cvt_pk_bf16_f32 v152, v228, v232
    v_mfma_f32_16x16x32_bf16 v[240:243], v[60:63], v[200:203], v[240:243]
    v_cvt_pk_bf16_f32 v153, v229, v233
    s_waitcnt lgkmcnt(2)
    v_mfma_f32_16x16x32_bf16 v[236:239], v[64:67], v[204:207], v[236:239]
    v_cvt_pk_bf16_f32 v154, v230, v234
    v_mfma_f32_16x16x32_bf16 v[240:243], v[68:71], v[204:207], v[240:243]
    v_cvt_pk_bf16_f32 v155, v231, v235
    ds_write_b128 v27, v[152:155] offset:1024
    ds_read_b128 v[136:139], v28 offset:1024
    s_waitcnt lgkmcnt(2)
    buffer_store_dwordx4 v[132:135], v20, s[36:39], 0 offen sc1
    s_nop 2
    v_cvt_pk_bf16_f32 v156, v236, v240
    v_cvt_pk_bf16_f32 v157, v237, v241
    v_cvt_pk_bf16_f32 v158, v238, v242
    v_cvt_pk_bf16_f32 v159, v239, v243
    ds_write_b128 v27, v[156:159] offset:2048
    ds_read_b128 v[140:143], v28 offset:2048
    s_waitcnt lgkmcnt(2)
    buffer_store_dwordx4 v[136:139], v21, s[36:39], 0 offen sc1
    s_waitcnt lgkmcnt(0)
    buffer_store_dwordx4 v[140:143], v22, s[36:39], 0 offen sc1
    v_lshrrev_b32 v18, 2, v1
    v_and_b32 v18, 2, v18
    v_xor_b32 v18, v18, v2
    v_lshlrev_b32 v18, 4, v18
    v_lshl_add_u32 v18, v1, 8, v18
    v_add_u32 v18, 98304, v18
    v_and_b32 v19, 7, v1
    v_lshlrev_b32 v19, 8, v19
    v_lshl_add_u32 v19, v2, 4, v19
    v_add_u32 v19, 98304, v19
    v_and_b32 v23, 3, v1
    v_xor_b32 v24, 0, v23
    v_lshl_add_u32 v72, v24, 6, v18
    v_lshl_add_u32 v76, v24, 6, v19
    v_xor_b32 v24, 1, v23
    v_lshl_add_u32 v73, v24, 6, v18
    v_lshl_add_u32 v77, v24, 6, v19
    v_xor_b32 v24, 2, v23
    v_lshl_add_u32 v74, v24, 6, v18
    v_lshl_add_u32 v78, v24, 6, v19
    v_xor_b32 v24, 3, v23
    v_lshl_add_u32 v75, v24, 6, v18
    v_lshl_add_u32 v79, v24, 6, v19
    v_and_b32 v18, 7, v1
    v_mul_u32_u24 v18, 2320, v18
    v_lshl_add_u32 v18, v2, 4, v18
    s_lshl_b32 s48, s3, 6
    s_add_u32 s48, s48, 116736
    v_add_u32 v18, s48, v18
    v_lshrrev_b32 v19, 3, v1
    v_lshl_add_u32 v225, v19, 8, v18
    v_cmp_gt_u32 vcc, 8, v1
    v_mov_b32 v23, 133248
    s_nop 0
    v_cndmask_b32 v224, v23, v18, vcc
    v_lshrrev_b32 v23, 5, v0
    s_lshl_b32 s48, s3, 1
    v_add_u32 v23, s48, v23
    v_and_b32 v24, 31, v0
    v_mul_u32_u24 v18, 2320, v23
    v_lshl_add_u32 v18, v24, 3, v18
    v_add_u32 v226, 116736, v18
    v_mul_u32_u24 v18, 1184, v23
    v_lshl_add_u32 v18, v24, 2, v18
    v_add_u32 v227, 135808, v18
    v_mul_u32_u24 v18, 1152, v23
    v_lshl_add_u32 v18, v24, 2, v18
    v_add_u32 v231, 98304, v18
    v_lshlrev_b32 v18, 3, v24
    v_add_u32 v228, 108544, v18
    v_add_u32 v37, 108800, v18
    v_bfe_u32 v18, v0, 2, 2
    v_mul_u32_u24 v18, 1184, v18
    v_and_b32 v19, 3, v0
    v_lshl_add_u32 v18, v19, 3, v18
    v_lshl_add_u32 v18, v2, 5, v18
    s_lshl_b32 s48, s3, 7
    s_add_u32 s48, s48, 135808
    v_add_u32 v229, s48, v18
    v_add_u32 v230, 147456, v36
    v_min_u32 v232, 496, v36
    s_mul_i32 s48, s3, 2560
    s_mul_i32 s66, s6, 10240
    s_add_u32 s66, s66, s48
    s_add_u32 s66, s66, 8388608
    s_add_u32 s48, s48, 98304
    v_add_u32 v233, s48, v36
    v_add_u32 v234, s48, v232
    s_lshr_b32 s48, s4, 1
    s_lshl_b32 s48, s48, 12
    s_mul_i32 s49, s3, 640
    s_add_u32 s48, s48, s49
    s_add_u32 s48, s48, 294912
    v_min_u32 v235, 624, v36
    v_add_u32 v235, s48, v235
    s_waitcnt vmcnt(0)
    s_waitcnt vmcnt(0)
    s_barrier
    s_cmp_lt_u32 s2, 202
    s_cbranch_scc1 L_m_5
    v_and_b32 v188, 7, v1
    v_cvt_f32_u32 v188, v188
    v_mul_f32 v188, 0x3e000000, v188
    v_and_b32 v189, 1, v2
    v_cvt_f32_u32 v189, v189
    v_mul_f32 v189, 4.0, v189
    v_mul_f32 v189, v189, v188
    v_lshrrev_b32 v190, 3, v1
    v_lshrrev_b32 v191, 1, v2
    s_lshl_b32 s48, s3, 10
    s_add_u32 s48, s48, 147456
    v_add_u32 v192, s48, v36
    s_add_u32 s48, s3, 0
    s_mul_i32 s49, s48, 43
    s_lshr_b32 s49, s49, 7
    s_mul_i32 s50, s49, 3
    s_sub_u32 s50, s48, s50
    s_lshl_b32 s50, s50, 1
    s_lshl_b32 s49, s49, 1
    v_add_u32 v193, s49, v190
    v_add_u32 v194, s50, v191
    v_cmp_gt_u32 vcc, 9, v193
    v_cmp_gt_u32 s[48:49], 5, v194
    v_mul_u32_u24 v193, v193, v194
    v_cvt_f32_u32 v193, v193
    s_and_b64 vcc, vcc, s[48:49]
    v_fma_f32 v193, v193, s63, v189
    v_cos_f32 v194, v193
    v_sin_f32 v195, v193
    s_nop 0
    v_cvt_pk_bf16_f32 v200, v194, -v195
    v_add_f32 v193, v193, v188
    v_cos_f32 v196, v193
    v_sin_f32 v197, v193
    s_nop 0
    v_cvt_pk_bf16_f32 v201, v196, -v197
    v_add_f32 v193, v193, v188
    v_cos_f32 v194, v193
    v_sin_f32 v195, v193
    s_nop 0
    v_cvt_pk_bf16_f32 v202, v194, -v195
    v_add_f32 v193, v193, v188
    v_cos_f32 v196, v193
    v_sin_f32 v197, v193
    s_nop 0
    v_cvt_pk_bf16_f32 v203, v196, -v197
    v_cndmask_b32 v200, 0, v200, vcc
    v_cndmask_b32 v201, 0, v201, vcc
    v_cndmask_b32 v202, 0, v202, vcc
    v_cndmask_b32 v203, 0, v203, vcc
    ds_write_b128 v192, v[200:203] offset:0
    s_add_u32 s48, s3, 4
    s_mul_i32 s49, s48, 43
    s_lshr_b32 s49, s49, 7
    s_mul_i32 s50, s49, 3
    s_sub_u32 s50, s48, s50
    s_lshl_b32 s50, s50, 1
    s_lshl_b32 s49, s49, 1
    v_add_u32 v193, s49, v190
    v_add_u32 v194, s50, v191
    v_cmp_gt_u32 vcc, 9, v193
    v_cmp_gt_u32 s[48:49], 5, v194
    v_mul_u32_u24 v193, v193, v194
    v_cvt_f32_u32 v193, v193
    s_and_b64 vcc, vcc, s[48:49]
    v_fma_f32 v193, v193, s63, v189
    v_cos_f32 v194, v193
    v_sin_f32 v195, v193
    s_nop 0
    v_cvt_pk_bf16_f32 v204, v194, -v195
    v_add_f32 v193, v193, v188
    v_cos_f32 v196, v193
    v_sin_f32 v197, v193
    s_nop 0
    v_cvt_pk_bf16_f32 v205, v196, -v197
    v_add_f32 v193, v193, v188
    v_cos_f32 v194, v193
    v_sin_f32 v195, v193
    s_nop 0
    v_cvt_pk_bf16_f32 v206, v194, -v195
    v_add_f32 v193, v193, v188
    v_cos_f32 v196, v193
    v_sin_f32 v197, v193
    s_nop 0
    v_cvt_pk_bf16_f32 v207, v196, -v197
    v_cndmask_b32 v204, 0, v204, vcc
    v_cndmask_b32 v205, 0, v205, vcc
    v_cndmask_b32 v206, 0, v206, vcc
    v_cndmask_b32 v207, 0, v207, vcc
    ds_write_b128 v192, v[204:207] offset:4096
    s_add_u32 s48, s3, 8
    s_mul_i32 s49, s48, 43
    s_lshr_b32 s49, s49, 7
    s_mul_i32 s50, s49, 3
    s_sub_u32 s50, s48, s50
    s_lshl_b32 s50, s50, 1
    s_lshl_b32 s49, s49, 1
    v_add_u32 v193, s49, v190
    v_add_u32 v194, s50, v191
    v_cmp_gt_u32 vcc, 9, v193
    v_cmp_gt_u32 s[48:49], 5, v194
    v_mul_u32_u24 v193, v193, v194
    v_cvt_f32_u32 v193, v193
    s_and_b64 vcc, vcc, s[48:49]
    v_fma_f32 v193, v193, s63, v189
    v_cos_f32 v194, v193
    v_sin_f32 v195, v193
    s_nop 0
    v_cvt_pk_bf16_f32 v200, v194, -v195
    v_add_f32 v193, v193, v188
    v_cos_f32 v196, v193
    v_sin_f32 v197, v193
    s_nop 0
    v_cvt_pk_bf16_f32 v201, v196, -v197
    v_add_f32 v193, v193, v188
    v_cos_f32 v194, v193
    v_sin_f32 v195, v193
    s_nop 0
    v_cvt_pk_bf16_f32 v202, v194, -v195
    v_add_f32 v193, v193, v188
    v_cos_f32 v196, v193
    v_sin_f32 v197, v193
    s_nop 0
    v_cvt_pk_bf16_f32 v203, v196, -v197
    v_cndmask_b32 v200, 0, v200, vcc
    v_cndmask_b32 v201, 0, v201, vcc
    v_cndmask_b32 v202, 0, v202, vcc
    v_cndmask_b32 v203, 0, v203, vcc
    ds_write_b128 v192, v[200:203] offset:8192
    s_add_u32 s48, s3, 12
    s_mul_i32 s49, s48, 43
    s_lshr_b32 s49, s49, 7
    s_mul_i32 s50, s49, 3
    s_sub_u32 s50, s48, s50
    s_lshl_b32 s50, s50, 1
    s_lshl_b32 s49, s49, 1
    v_add_u32 v193, s49, v190
    v_add_u32 v194, s50, v191
    v_cmp_gt_u32 vcc, 9, v193
    v_cmp_gt_u32 s[48:49], 5, v194
    v_mul_u32_u24 v193, v193, v194
    v_cvt_f32_u32 v193, v193
    s_and_b64 vcc, vcc, s[48:49]
    v_fma_f32 v193, v193, s63, v189
    v_cos_f32 v194, v193
    v_sin_f32 v195, v193
    s_nop 0
    v_cvt_pk_bf16_f32 v204, v194, -v195
    v_add_f32 v193, v193, v188
    v_cos_f32 v196, v193
    v_sin_f32 v197, v193
    s_nop 0
    v_cvt_pk_bf16_f32 v205, v196, -v197
    v_add_f32 v193, v193, v188
    v_cos_f32 v194, v193
    v_sin_f32 v195, v193
    s_nop 0
    v_cvt_pk_bf16_f32 v206, v194, -v195
    v_add_f32 v193, v193, v188
    v_cos_f32 v196, v193
    v_sin_f32 v197, v193
    s_nop 0
    v_cvt_pk_bf16_f32 v207, v196, -v197
    v_cndmask_b32 v204, 0, v204, vcc
    v_cndmask_b32 v205, 0, v205, vcc
    v_cndmask_b32 v206, 0, v206, vcc
    v_cndmask_b32 v207, 0, v207, vcc
    ds_write_b128 v192, v[204:207] offset:12288
L_m_5:
    s_lshl_b32 s58, s3, 10
    v_add_u32 v18, s58, v36
    v_add_u32 v19, 4096, v18
    v_min_u32 v19, 6896, v19
    v_min_u32 v20, 2288, v18
    v_add_u32 v20, 6912, v20
    s_mov_b32 s56, 0x0c0c0400
    s_mov_b32 s57, 0x04000c0c
    s_mov_b32 s58, 196608
    s_mov_b32 s59, 205824
    s_mov_b32 s60, 215040
    s_waitcnt lgkmcnt(0)
    s_cmp_ge_u32 s5, 20
    s_cbranch_scc1 L_m_6
    s_barrier
L_m_6:
    buffer_load_dwordx4 v[80:83], v18, s[36:39], s58 offen sc1
    buffer_load_dwordx4 v[84:87], v18, s[36:39], s59 offen sc1
    buffer_load_dwordx4 v[92:95], v19, s[36:39], s58 offen sc1
    buffer_load_dwordx4 v[96:99], v19, s[36:39], s59 offen sc1
    s_cmp_ge_u32 s5, 20
    s_cbranch_scc1 L_m_7
    s_barrier
L_m_7:
    s_waitcnt vmcnt(0)
    v_perm_b32 v22, v81, v80, s56
    v_perm_b32 v23, v83, v82, s57
    v_or_b32 v22, v22, v23
    v_cmp_ne_u32 vcc, v3, v22
    v_perm_b32 v22, v85, v84, s56
    v_perm_b32 v23, v87, v86, s57
    v_or_b32 v22, v22, v23
    v_cmp_ne_u32 s[48:49], v3, v22
    s_nop 0
    s_or_b64 vcc, vcc, s[48:49]
    v_perm_b32 v22, v93, v92, s56
    v_perm_b32 v23, v95, v94, s57
    v_or_b32 v22, v22, v23
    v_cmp_ne_u32 s[48:49], v3, v22
    s_nop 0
    s_or_b64 vcc, vcc, s[48:49]
    v_perm_b32 v22, v97, v96, s56
    v_perm_b32 v23, v99, v98, s57
    v_or_b32 v22, v22, v23
    v_cmp_ne_u32 s[48:49], v3, v22
    s_nop 0
    s_or_b64 vcc, vcc, s[48:49]
    s_cbranch_vccz L_m_8
Lp_m_9:
    buffer_load_dwordx4 v[80:83], v18, s[36:39], s58 offen sc1
    buffer_load_dwordx4 v[84:87], v18, s[36:39], s59 offen sc1
    buffer_load_dwordx4 v[92:95], v19, s[36:39], s58 offen sc1
    buffer_load_dwordx4 v[96:99], v19, s[36:39], s59 offen sc1
    s_waitcnt vmcnt(0)
    v_perm_b32 v22, v81, v80, s56
    v_perm_b32 v23, v83, v82, s57
    v_or_b32 v22, v22, v23
    v_cmp_ne_u32 vcc, v3, v22
    v_perm_b32 v22, v85, v84, s56
    v_perm_b32 v23, v87, v86, s57
    v_or_b32 v22, v22, v23
    v_cmp_ne_u32 s[48:49], v3, v22
    s_nop 0
    s_or_b64 vcc, vcc, s[48:49]
    v_perm_b32 v22, v93, v92, s56
    v_perm_b32 v23, v95, v94, s57
    v_or_b32 v22, v22, v23
    v_cmp_ne_u32 s[48:49], v3, v22
    s_nop 0
    s_or_b64 vcc, vcc, s[48:49]
    v_perm_b32 v22, v97, v96, s56
    v_perm_b32 v23, v99, v98, s57
    v_or_b32 v22, v22, v23
    v_cmp_ne_u32 s[48:49], v3, v22
    s_nop 0
    s_or_b64 vcc, vcc, s[48:49]
    s_cbranch_vccz Le_m_10
    s_sub_u32 s7, s7, 1
    s_cbranch_scc1 Le_m_10
    s_sleep 1
    s_branch Lp_m_9
Le_m_10:
    s_max_i32 s7, s7, 0
L_m_8:
    v_cmp_le_u32 vcc, 4608, v19
    s_nop 1
    v_cndmask_b32 v22, 0, 1.0, vcc
    v_and_b32 v80, 0xffffff00, v80
    v_and_b32 v81, 0xffffff00, v81
    v_and_b32 v82, 0xffffff00, v82
    v_and_b32 v83, 0xffffff00, v83
    v_and_b32 v84, 0xffffff00, v84
    v_and_b32 v85, 0xffffff00, v85
    v_and_b32 v86, 0xffffff00, v86
    v_and_b32 v87, 0xffffff00, v87
    v_pk_add_f32 v[80:81], v[80:81], v[84:85]
    v_pk_add_f32 v[82:83], v[82:83], v[86:87]
    v_cvt_pk_bf16_f32 v80, 0, v80
    v_cvt_pk_bf16_f32 v81, 0, v81
    v_cvt_pk_bf16_f32 v82, 0, v82
    v_cvt_pk_bf16_f32 v83, 0, v83
    v_and_b32 v92, 0xffffff00, v92
    v_and_b32 v93, 0xffffff00, v93
    v_and_b32 v94, 0xffffff00, v94
    v_and_b32 v95, 0xffffff00, v95
    v_and_b32 v96, 0xffffff00, v96
    v_and_b32 v97, 0xffffff00, v97
    v_and_b32 v98, 0xffffff00, v98
    v_and_b32 v99, 0xffffff00, v99
    v_pk_add_f32 v[92:93], v[92:93], v[96:97]
    v_pk_add_f32 v[94:95], v[94:95], v[98:99]
    v_cvt_pk_bf16_f32 v92, 0, v92
    v_cvt_pk_bf16_f32 v93, 0, v93
    v_cvt_pk_bf16_f32 v94, 0, v94
    v_cvt_pk_bf16_f32 v95, 0, v95
    v_add_f32 v92, v92, v22
    v_add_f32 v93, v93, v22
    v_add_f32 v94, v94, v22
    v_add_f32 v95, v95, v22
    v_cvt_pk_bf16_f32 v92, 0, v92
    v_cvt_pk_bf16_f32 v93, 0, v93
    v_cvt_pk_bf16_f32 v94, 0, v94
    v_cvt_pk_bf16_f32 v95, 0, v95
    v_add_u32 v22, 108544, v18
    v_add_u32 v23, 108544, v19
    ds_write_b128 v22, v[80:83]
    ds_write_b128 v23, v[92:95]
    s_cmp_lg_u32 s2, 255
    s_cbranch_scc1 L_m_11
    s_mov_b32 s50, 4608
    buffer_store_dwordx4 v[80:83], v18, s[36:39], s50 offen sc1
    buffer_store_dwordx4 v[92:95], v19, s[36:39], s50 offen sc1
Lp_m_12:
    buffer_load_dwordx4 v[104:107], v20, s[36:39], s58 offen sc1
    buffer_load_dwordx4 v[108:111], v20, s[36:39], s59 offen sc1
    s_waitcnt vmcnt(0)
    v_perm_b32 v22, v105, v104, s56
    v_perm_b32 v23, v107, v106, s57
    v_or_b32 v22, v22, v23
    v_cmp_ne_u32 vcc, v3, v22
    v_perm_b32 v22, v109, v108, s56
    v_perm_b32 v23, v111, v110, s57
    v_or_b32 v22, v22, v23
    v_cmp_ne_u32 s[48:49], v3, v22
    s_nop 0
    s_or_b64 vcc, vcc, s[48:49]
    s_cbranch_vccz Le_m_13
    s_sub_u32 s7, s7, 1
    s_cbranch_scc1 Le_m_13
    s_sleep 1
    s_branch Lp_m_12
Le_m_13:
    s_max_i32 s7, s7, 0
    v_and_b32 v104, 0xffffff00, v104
    v_and_b32 v105, 0xffffff00, v105
    v_and_b32 v106, 0xffffff00, v106
    v_and_b32 v107, 0xffffff00, v107
    v_and_b32 v108, 0xffffff00, v108
    v_and_b32 v109, 0xffffff00, v109
    v_and_b32 v110, 0xffffff00, v110
    v_and_b32 v111, 0xffffff00, v111
    v_pk_add_f32 v[104:105], v[104:105], v[108:109]
    v_pk_add_f32 v[106:107], v[106:107], v[110:111]
    v_cvt_pk_bf16_f32 v104, 0, v104
    v_cvt_pk_bf16_f32 v105, 0, v105
    v_cvt_pk_bf16_f32 v106, 0, v106
    v_cvt_pk_bf16_f32 v107, 0, v107
    buffer_store_dwordx4 v[104:107], v20, s[36:39], s50 offen sc1
L_m_11:
    v_lshlrev_b32 v236, 16, v9
    v_and_b32 v237, 0xffff0000, v9
    v_lshlrev_b32 v238, 16, v10
    v_and_b32 v239, 0xffff0000, v10
    v_lshlrev_b32 v240, 16, v11
    v_and_b32 v241, 0xffff0000, v11
    v_lshlrev_b32 v242, 16, v12
    v_and_b32 v243, 0xffff0000, v12
    v_lshlrev_b32 v244, 16, v13
    v_and_b32 v245, 0xffff0000, v13
    v_lshlrev_b32 v246, 16, v14
    v_and_b32 v247, 0xffff0000, v14
    v_lshlrev_b32 v248, 16, v15
    v_and_b32 v249, 0xffff0000, v15
    v_lshlrev_b32 v250, 16, v16
    v_and_b32 v251, 0xffff0000, v16
    v_lshlrev_b32 v252, 16, v17
    v_and_b32 v253, 0xffff0000, v17
    s_cmp_ge_u32 s5, 20
    s_cbranch_scc1 L_m_14
    ds_read_b128 v[128:131], v230 offset:0
    ds_read_b128 v[132:135], v230 offset:1024
    ds_read_b128 v[136:139], v230 offset:2048
    ds_read_b128 v[140:143], v230 offset:3072
    ds_read_b128 v[144:147], v230 offset:4096
    ds_read_b128 v[148:151], v230 offset:5120
    ds_read_b128 v[152:155], v230 offset:6144
    ds_read_b128 v[156:159], v230 offset:7168
    ds_read_b128 v[160:163], v230 offset:8192
    ds_read_b128 v[164:167], v230 offset:9216
    ds_read_b128 v[168:171], v230 offset:10240
    ds_read_b128 v[172:175], v230 offset:11264
    ds_read_b128 v[176:179], v230 offset:12288
    ds_read_b128 v[180:183], v230 offset:13312
    ds_read_b128 v[184:187], v230 offset:14336
    s_waitcnt lgkmcnt(0)
    s_barrier
    s_branch L_m_15
L_m_14:
    s_waitcnt lgkmcnt(0)
    s_barrier
    ds_read_b128 v[128:131], v230 offset:0
    ds_read_b128 v[132:135], v230 offset:1024
    ds_read_b128 v[136:139], v230 offset:2048
    ds_read_b128 v[140:143], v230 offset:3072
    ds_read_b128 v[144:147], v230 offset:4096
    ds_read_b128 v[148:151], v230 offset:5120
    ds_read_b128 v[152:155], v230 offset:6144
    ds_read_b128 v[156:159], v230 offset:7168
    ds_read_b128 v[160:163], v230 offset:8192
    ds_read_b128 v[164:167], v230 offset:9216
    ds_read_b128 v[168:171], v230 offset:10240
    ds_read_b128 v[172:175], v230 offset:11264
    ds_read_b128 v[176:179], v230 offset:12288
    ds_read_b128 v[180:183], v230 offset:13312
    ds_read_b128 v[184:187], v230 offset:14336
    s_lshl_b32 s50, s2, 7
    s_add_u32 s50, s50, 557056
    v_mov_b32 v18, 0
Lp_m_16:
    buffer_load_dword v19, v18, s[36:39], s50 offen sc1
    s_waitcnt vmcnt(0)
    v_cmp_ne_u32 vcc, v3, v19
    s_nop 0
    s_cbranch_vccz Le_m_17
    s_sub_u32 s7, s7, 1
    s_cbranch_scc1 Le_m_17
    s_sleep 4
    s_branch Lp_m_16
Le_m_17:
    s_max_i32 s7, s7, 0
    s_waitcnt lgkmcnt(0)
L_m_15:
Lp_m_18:
    buffer_load_dwordx4 v[212:215], v36, s[36:39], s66 offen offset:0 sc1
    buffer_load_dwordx4 v[216:219], v36, s[36:39], s66 offen offset:1024 sc1
    buffer_load_dwordx4 v[220:223], v232, s[36:39], s66 offen offset:2048 sc1
    s_waitcnt vmcnt(0)
    v_max3_u32 v18, v212, v216, v220
    v_cmp_eq_u32 vcc, -1, v18
    s_nop 0
    s_cbranch_vccz Le_m_19
    s_sub_u32 s7, s7, 1
    s_cbranch_scc1 Le_m_19
    s_mov_b64 exec, vcc
    s_sleep 1
    s_branch Lp_m_18
Le_m_19:
    s_mov_b64 exec, -1
    s_max_i32 s7, s7, 0
    ds_write_b128 v233, v[212:215] offset:0
    s_branch L_skip_2
    s_nop 0
L_stub_2:
    s_branch L_back_c1
L_skip_2:
    ds_write_b128 v233, v[216:219] offset:1024
    ds_write_b128 v234, v[220:223] offset:2048
    s_waitcnt lgkmcnt(0)
    s_barrier
    ds_read_b128 v[80:83], v72 offset:0
    ds_read_b128 v[84:87], v73 offset:0
    ds_read_b128 v[88:91], v74 offset:0
    ds_read_b128 v[92:95], v75 offset:0
    ds_read_b128 v[96:99], v72 offset:4096
    ds_read_b128 v[100:103], v73 offset:4096
    ds_read_b128 v[104:107], v74 offset:4096
    ds_read_b128 v[108:111], v75 offset:4096
    ds_read_b128 v[112:115], v76 offset:8192
    ds_read_b128 v[116:119], v77 offset:8192
    ds_read_b128 v[120:123], v78 offset:8192
    ds_read_b128 v[124:127], v79 offset:8192
    s_waitcnt lgkmcnt(11)
    v_mfma_f32_16x16x32_bf16 v[188:191], v[80:83], v[44:47], 0
    v_mfma_f32_16x16x32_bf16 v[192:195], v[80:83], v[40:43], 0
    s_waitcnt lgkmcnt(10)
    v_mfma_f32_16x16x32_bf16 v[188:191], v[84:87], v[52:55], v[188:191]
    v_mfma_f32_16x16x32_bf16 v[192:195], v[84:87], v[48:51], v[192:195]
    s_waitcnt lgkmcnt(9)
    v_mfma_f32_16x16x32_bf16 v[188:191], v[88:91], v[60:63], v[188:191]
    v_mfma_f32_16x16x32_bf16 v[192:195], v[88:91], v[56:59], v[192:195]
    s_waitcnt lgkmcnt(8)
    v_mfma_f32_16x16x32_bf16 v[188:191], v[92:95], v[68:71], v[188:191]
    v_mfma_f32_16x16x32_bf16 v[192:195], v[92:95], v[64:67], v[192:195]
    s_waitcnt lgkmcnt(7)
    v_mfma_f32_16x16x32_bf16 v[196:199], v[96:99], v[44:47], 0
    v_mfma_f32_16x16x32_bf16 v[200:203], v[96:99], v[40:43], 0
    s_waitcnt lgkmcnt(6)
    v_mfma_f32_16x16x32_bf16 v[196:199], v[100:103], v[52:55], v[196:199]
    v_mfma_f32_16x16x32_bf16 v[200:203], v[100:103], v[48:51], v[200:203]
    s_waitcnt lgkmcnt(5)
    v_mfma_f32_16x16x32_bf16 v[196:199], v[104:107], v[60:63], v[196:199]
    v_mul_f32 v18, v188, v30
    v_mul_f32 v19, v192, v30
    v_mfma_f32_16x16x32_bf16 v[200:203], v[104:107], v[56:59], v[200:203]
    v_fma_f32 v18, -v192, v31, v18
    v_fmac_f32 v19, v188, v31
    s_waitcnt lgkmcnt(4)
    v_mfma_f32_16x16x32_bf16 v[196:199], v[108:111], v[68:71], v[196:199]
    v_cvt_pk_bf16_f32 v212, v18, v19
    v_mul_f32 v20, v189, v30
    v_mfma_f32_16x16x32_bf16 v[200:203], v[108:111], v[64:67], v[200:203]
    v_mul_f32 v21, v193, v30
    v_fma_f32 v20, -v193, v31, v20
    s_waitcnt lgkmcnt(3)
    v_mfma_f32_16x16x32_bf16 v[204:207], v[112:115], v[44:47], 0
    v_fmac_f32 v21, v189, v31
    v_cvt_pk_bf16_f32 v213, v20, v21
    v_mfma_f32_16x16x32_bf16 v[208:211], v[112:115], v[40:43], 0
    v_mul_f32 v22, v190, v30
    v_mul_f32 v23, v194, v30
    s_waitcnt lgkmcnt(2)
    v_mfma_f32_16x16x32_bf16 v[204:207], v[116:119], v[52:55], v[204:207]
    v_fma_f32 v22, -v194, v31, v22
    v_fmac_f32 v23, v190, v31
    v_mfma_f32_16x16x32_bf16 v[208:211], v[116:119], v[48:51], v[208:211]
    v_cvt_pk_bf16_f32 v214, v22, v23
    v_mul_f32 v24, v191, v30
    s_waitcnt lgkmcnt(1)
    v_mfma_f32_16x16x32_bf16 v[204:207], v[120:123], v[60:63], v[204:207]
    v_mul_f32 v25, v195, v30
    v_fma_f32 v24, -v195, v31, v24
    v_mfma_f32_16x16x32_bf16 v[208:211], v[120:123], v[56:59], v[208:211]
    v_fmac_f32 v25, v191, v31
    v_cvt_pk_bf16_f32 v215, v24, v25
    s_waitcnt lgkmcnt(0)
    v_mfma_f32_16x16x32_bf16 v[204:207], v[124:127], v[68:71], v[204:207]
    v_mul_f32 v18, v196, v32
    v_mul_f32 v19, v200, v32
    v_mfma_f32_16x16x32_bf16 v[208:211], v[124:127], v[64:67], v[208:211]
    v_fma_f32 v18, -v200, v33, v18
    v_fmac_f32 v19, v196, v33
    v_mfma_f32_16x16x32_bf16 v[80:83], v[212:215], v[128:131], 0
    v_cvt_pk_bf16_f32 v216, v18, v19
    v_mul_f32 v20, v197, v32
    v_mfma_f32_16x16x32_bf16 v[84:87], v[212:215], v[140:143], 0
    v_mul_f32 v21, v201, v32
    v_fma_f32 v20, -v201, v33, v20
    v_mfma_f32_16x16x32_bf16 v[88:91], v[212:215], v[152:155], 0
    v_fmac_f32 v21, v197, v33
    v_cvt_pk_bf16_f32 v217, v20, v21
    v_mfma_f32_16x16x32_bf16 v[92:95], v[212:215], v[164:167], 0
    v_mul_f32 v22, v198, v32
    v_mul_f32 v23, v202, v32
    v_mfma_f32_16x16x32_bf16 v[96:99], v[212:215], v[176:179], 0
    v_fma_f32 v22, -v202, v33, v22
    v_fmac_f32 v23, v198, v33
    v_cvt_pk_bf16_f32 v218, v22, v23
    v_mul_f32 v24, v199, v32
    v_mul_f32 v25, v203, v32
    v_fma_f32 v24, -v203, v33, v24
    v_fmac_f32 v25, v199, v33
    v_cvt_pk_bf16_f32 v219, v24, v25
    s_nop 1
    v_mfma_f32_16x16x32_bf16 v[80:83], v[216:219], v[132:135], v[80:83]
    v_mul_f32 v18, v204, v34
    v_mul_f32 v19, v208, v34
    v_mfma_f32_16x16x32_bf16 v[84:87], v[216:219], v[144:147], v[84:87]
    v_fma_f32 v18, -v208, v35, v18
    v_fmac_f32 v19, v204, v35
    v_mfma_f32_16x16x32_bf16 v[88:91], v[216:219], v[156:159], v[88:91]
    v_cvt_pk_bf16_f32 v220, v18, v19
    v_mul_f32 v20, v205, v34
    v_mfma_f32_16x16x32_bf16 v[92:95], v[216:219], v[168:171], v[92:95]
    v_mul_f32 v21, v209, v34
    v_fma_f32 v20, -v209, v35, v20
    v_mfma_f32_16x16x32_bf16 v[96:99], v[216:219], v[180:183], v[96:99]
    v_fmac_f32 v21, v205, v35
    v_cvt_pk_bf16_f32 v221, v20, v21
    v_mul_f32 v22, v206, v34
    v_mul_f32 v23, v210, v34
    v_fma_f32 v22, -v210, v35, v22
    v_fmac_f32 v23, v206, v35
    v_cvt_pk_bf16_f32 v222, v22, v23
    v_mul_f32 v24, v207, v34
    v_mul_f32 v25, v211, v34
    v_fma_f32 v24, -v211, v35, v24
    v_fmac_f32 v25, v207, v35
    v_cvt_pk_bf16_f32 v223, v24, v25
    s_nop 1
    v_mfma_f32_16x16x32_bf16 v[80:83], v[220:223], v[136:139], v[80:83]
    v_mfma_f32_16x16x32_bf16 v[84:87], v[220:223], v[148:151], v[84:87]
    v_mfma_f32_16x16x32_bf16 v[88:91], v[220:223], v[160:163], v[88:91]
    v_mfma_f32_16x16x32_bf16 v[92:95], v[220:223], v[172:175], v[92:95]
    v_mfma_f32_16x16x32_bf16 v[96:99], v[220:223], v[184:187], v[96:99]
    ds_read2st64_b64 v[40:43], v228 offset0:0 offset1:1
    ds_read2st64_b64 v[44:47], v37 offset0:0 offset1:1
    ds_read2st64_b64 v[48:51], v228 offset0:2 offset1:3
    ds_read2st64_b64 v[52:55], v37 offset0:2 offset1:3
    ds_read_b64 v[56:57], v228 offset:2048
    ds_write_b128 v225, v[80:83] offset:0
    ds_write_b128 v225, v[84:87] offset:512
    ds_write_b128 v225, v[88:91] offset:1024
    ds_write_b128 v225, v[92:95] offset:1536
    ds_write_b128 v224, v[96:99] offset:2048
    ds_read2st64_b64 v[188:191], v228 offset0:9 offset1:10
    ds_read2st64_b64 v[192:195], v37 offset0:9 offset1:10
    ds_read2st64_b64 v[196:199], v228 offset0:11 offset1:12
    ds_read2st64_b64 v[200:203], v37 offset0:11 offset1:12
    ds_read_b64 v[204:205], v228 offset:6656
    ds_read2st64_b64 v[128:131], v37 offset0:4 offset1:5
    ds_read2st64_b64 v[132:135], v228 offset0:5 offset1:6
    ds_read2st64_b64 v[136:139], v37 offset0:6 offset1:7
    ds_read2st64_b64 v[140:143], v228 offset0:7 offset1:8
    ds_read_b64 v[144:145], v228 offset:4352
    s_waitcnt lgkmcnt(10)
    s_barrier
    ds_read_b64 v[100:101], v226 offset:0
    ds_read_b64 v[102:103], v226 offset:256
    ds_read_b64 v[104:105], v226 offset:512
    ds_read_b64 v[106:107], v226 offset:768
    ds_read_b64 v[108:109], v226 offset:1024
    ds_read_b64 v[110:111], v226 offset:1280
    ds_read_b64 v[112:113], v226 offset:1536
    ds_read_b64 v[114:115], v226 offset:1792
    ds_read_b64 v[116:117], v226 offset:2048
    s_mul_i32 s48, s6, 9216
    s_lshl_b32 s49, s3, 10
    s_add_u32 s48, s48, s49
    s_add_u32 s48, s48, 16777216
    s_add_u32 s49, s48, 4096
    s_add_u32 s50, s48, 8192
    s_waitcnt lgkmcnt(8)
    v_pk_fma_f32 v[236:237], v[100:101], v[40:41], v[236:237]
    s_waitcnt lgkmcnt(7)
    v_pk_fma_f32 v[238:239], v[102:103], v[44:45], v[238:239]
    s_waitcnt lgkmcnt(6)
    v_pk_fma_f32 v[240:241], v[104:105], v[42:43], v[240:241]
    s_waitcnt lgkmcnt(5)
    v_pk_fma_f32 v[242:243], v[106:107], v[46:47], v[242:243]
    s_waitcnt lgkmcnt(4)
    v_pk_fma_f32 v[244:245], v[108:109], v[48:49], v[244:245]
    s_waitcnt lgkmcnt(3)
    v_pk_fma_f32 v[246:247], v[110:111], v[52:53], v[246:247]
    s_waitcnt lgkmcnt(2)
    v_pk_fma_f32 v[248:249], v[112:113], v[50:51], v[248:249]
    s_waitcnt lgkmcnt(1)
    v_pk_fma_f32 v[250:251], v[114:115], v[54:55], v[250:251]
    s_waitcnt lgkmcnt(0)
    v_pk_fma_f32 v[252:253], v[116:117], v[56:57], v[252:253]
    v_pk_add_f32 v[24:25], v[236:237], v[238:239]
    v_pk_mul_f32 v[26:27], v[236:237], v[236:237]
    v_pk_fma_f32 v[26:27], v[238:239], v[238:239], v[26:27]
    v_pk_add_f32 v[24:25], v[24:25], v[240:241]
    v_pk_fma_f32 v[26:27], v[240:241], v[240:241], v[26:27]
    v_pk_add_f32 v[24:25], v[24:25], v[242:243]
    v_pk_fma_f32 v[26:27], v[242:243], v[242:243], v[26:27]
    v_pk_add_f32 v[24:25], v[24:25], v[244:245]
    v_pk_fma_f32 v[26:27], v[244:245], v[244:245], v[26:27]
    v_pk_add_f32 v[24:25], v[24:25], v[246:247]
    v_pk_fma_f32 v[26:27], v[246:247], v[246:247], v[26:27]
    v_pk_add_f32 v[24:25], v[24:25], v[248:249]
    v_pk_fma_f32 v[26:27], v[248:249], v[248:249], v[26:27]
    v_pk_add_f32 v[24:25], v[24:25], v[250:251]
    v_pk_fma_f32 v[26:27], v[250:251], v[250:251], v[26:27]
    v_pk_add_f32 v[24:25], v[24:25], v[252:253]
    v_pk_fma_f32 v[26:27], v[252:253], v[252:253], v[26:27]
    v_add_f32 v24, v24, v25
    v_add_f32 v25, v26, v27
    s_nop 0
    v_add_f32_dpp v24, v24, v24 quad_perm:[1,0,3,2] row_mask:0xf bank_mask:0xf
    v_add_f32_dpp v25, v25, v25 quad_perm:[1,0,3,2] row_mask:0xf bank_mask:0xf
    s_nop 0
    v_add_f32_dpp v24, v24, v24 quad_perm:[2,3,0,1] row_mask:0xf bank_mask:0xf
    v_add_f32_dpp v25, v25, v25 quad_perm:[2,3,0,1] row_mask:0xf bank_mask:0xf
    s_nop 0
    v_add_f32_dpp v24, v24, v24 row_half_mirror row_mask:0xf bank_mask:0xf
    v_add_f32_dpp v25, v25, v25 row_half_mirror row_mask:0xf bank_mask:0xf
    s_nop 0
    v_add_f32_dpp v24, v24, v24 row_mirror row_mask:0xf bank_mask:0xf
    v_add_f32_dpp v25, v25, v25 row_mirror row_mask:0xf bank_mask:0xf
    v_mov_b32 v26, v24
    v_mov_b32 v27, v25
    s_nop 0
    v_permlane16_swap_b32 v24, v26
    v_permlane16_swap_b32 v25, v27
    v_add_f32 v24, v24, v26
    v_add_f32 v25, v25, v27
    v_mul_f32 v24, 0xbae38e39, v24
    v_mul_f32 v25, 0x3ae38e39, v25
    v_fma_f32 v25, -v24, v24, v25
    v_max_f32 v25, 0, v25
    v_add_f32 v25, 0x3727c5ac, v25
    v_rsq_f32 v26, v25
    s_nop 0
    v_mul_f32 v24, v24, v26
    v_pk_fma_f32 v[100:101], v[236:237], v[26:27], v[24:25] op_sel_hi:[1,0,0]
    v_pk_fma_f32 v[102:103], v[238:239], v[26:27], v[24:25] op_sel_hi:[1,0,0]
    v_pk_fma_f32 v[104:105], v[240:241], v[26:27], v[24:25] op_sel_hi:[1,0,0]
    v_pk_fma_f32 v[106:107], v[242:243], v[26:27], v[24:25] op_sel_hi:[1,0,0]
    v_pk_fma_f32 v[108:109], v[244:245], v[26:27], v[24:25] op_sel_hi:[1,0,0]
    v_pk_fma_f32 v[110:111], v[246:247], v[26:27], v[24:25] op_sel_hi:[1,0,0]
    v_pk_fma_f32 v[112:113], v[248:249], v[26:27], v[24:25] op_sel_hi:[1,0,0]
    v_pk_fma_f32 v[114:115], v[250:251], v[26:27], v[24:25] op_sel_hi:[1,0,0]
    v_pk_fma_f32 v[116:117], v[252:253], v[26:27], v[24:25] op_sel_hi:[1,0,0]
    v_pk_fma_f32 v[100:101], v[100:101], v[188:189], v[128:129]
    v_pk_fma_f32 v[102:103], v[102:103], v[192:193], v[132:133]
    v_pk_fma_f32 v[104:105], v[104:105], v[190:191], v[130:131]
    v_pk_fma_f32 v[106:107], v[106:107], v[194:195], v[134:135]
    v_pk_fma_f32 v[108:109], v[108:109], v[196:197], v[136:137]
    v_pk_fma_f32 v[110:111], v[110:111], v[200:201], v[140:141]
    v_pk_fma_f32 v[112:113], v[112:113], v[198:199], v[138:139]
    v_pk_fma_f32 v[114:115], v[114:115], v[202:203], v[142:143]
    v_pk_fma_f32 v[116:117], v[116:117], v[204:205], v[144:145]
    v_pk_add_f32 v[24:25], v[100:101], v[102:103]
    v_pk_mul_f32 v[26:27], v[100:101], v[100:101]
    v_pk_fma_f32 v[26:27], v[102:103], v[102:103], v[26:27]
    v_pk_add_f32 v[24:25], v[24:25], v[104:105]
    v_pk_fma_f32 v[26:27], v[104:105], v[104:105], v[26:27]
    v_pk_add_f32 v[24:25], v[24:25], v[106:107]
    v_pk_fma_f32 v[26:27], v[106:107], v[106:107], v[26:27]
    v_pk_add_f32 v[24:25], v[24:25], v[108:109]
    v_pk_fma_f32 v[26:27], v[108:109], v[108:109], v[26:27]
    v_pk_add_f32 v[24:25], v[24:25], v[110:111]
    v_pk_fma_f32 v[26:27], v[110:111], v[110:111], v[26:27]
    v_pk_add_f32 v[24:25], v[24:25], v[112:113]
    v_pk_fma_f32 v[26:27], v[112:113], v[112:113], v[26:27]
    v_pk_add_f32 v[24:25], v[24:25], v[114:115]
    v_pk_fma_f32 v[26:27], v[114:115], v[114:115], v[26:27]
    v_pk_add_f32 v[24:25], v[24:25], v[116:117]
    v_pk_fma_f32 v[26:27], v[116:117], v[116:117], v[26:27]
    v_add_f32 v24, v24, v25
    v_add_f32 v25, v26, v27
    s_nop 0
    v_add_f32_dpp v24, v24, v24 quad_perm:[1,0,3,2] row_mask:0xf bank_mask:0xf
    v_add_f32_dpp v25, v25, v25 quad_perm:[1,0,3,2] row_mask:0xf bank_mask:0xf
    s_nop 0
    v_add_f32_dpp v24, v24, v24 quad_perm:[2,3,0,1] row_mask:0xf bank_mask:0xf
    v_add_f32_dpp v25, v25, v25 quad_perm:[2,3,0,1] row_mask:0xf bank_mask:0xf
    s_nop 0
    v_add_f32_dpp v24, v24, v24 row_half_mirror row_mask:0xf bank_mask:0xf
    v_add_f32_dpp v25, v25, v25 row_half_mirror row_mask:0xf bank_mask:0xf
    s_nop 0
    v_add_f32_dpp v24, v24, v24 row_mirror row_mask:0xf bank_mask:0xf
    v_add_f32_dpp v25, v25, v25 row_mirror row_mask:0xf bank_mask:0xf
    v_mov_b32 v26, v24
    v_mov_b32 v27, v25
    s_nop 0
    v_permlane16_swap_b32 v24, v26
    v_permlane16_swap_b32 v25, v27
    v_add_f32 v24, v24, v26
    v_add_f32 v25, v25, v27
    v_mul_f32 v24, 0xbae38e39, v24
    v_mul_f32 v25, 0x3ae38e39, v25
    v_fma_f32 v25, -v24, v24, v25
    v_max_f32 v25, 0, v25
    v_add_f32 v25, 0x3727c5ac, v25
    v_rsq_f32 v26, v25
    s_nop 0
    v_mul_f32 v24, v24, v26
    v_pk_fma_f32 v[100:101], v[100:101], v[26:27], v[24:25] op_sel_hi:[1,0,0]
    v_cvt_pk_bf16_f32 v9, v100, v101
    v_pk_fma_f32 v[102:103], v[102:103], v[26:27], v[24:25] op_sel_hi:[1,0,0]
    v_cvt_pk_bf16_f32 v10, v102, v103
    ds_write2_b32 v227, v9, v10 offset0:0 offset1:32
    v_pk_fma_f32 v[104:105], v[104:105], v[26:27], v[24:25] op_sel_hi:[1,0,0]
    v_cvt_pk_bf16_f32 v11, v104, v105
    v_pk_fma_f32 v[106:107], v[106:107], v[26:27], v[24:25] op_sel_hi:[1,0,0]
    v_cvt_pk_bf16_f32 v12, v106, v107
    ds_write2_b32 v227, v11, v12 offset0:64 offset1:96
    v_pk_fma_f32 v[108:109], v[108:109], v[26:27], v[24:25] op_sel_hi:[1,0,0]
    v_cvt_pk_bf16_f32 v13, v108, v109
    v_pk_fma_f32 v[110:111], v[110:111], v[26:27], v[24:25] op_sel_hi:[1,0,0]
    v_cvt_pk_bf16_f32 v14, v110, v111
    ds_write2_b32 v227, v13, v14 offset0:128 offset1:160
    v_pk_fma_f32 v[112:113], v[112:113], v[26:27], v[24:25] op_sel_hi:[1,0,0]
    v_cvt_pk_bf16_f32 v15, v112, v113
    v_pk_fma_f32 v[114:115], v[114:115], v[26:27], v[24:25] op_sel_hi:[1,0,0]
    v_cvt_pk_bf16_f32 v16, v114, v115
    ds_write2_b32 v227, v15, v16 offset0:192 offset1:224
    v_pk_fma_f32 v[116:117], v[116:117], v[26:27], v[24:25] op_sel_hi:[1,0,0]
    v_cvt_pk_bf16_f32 v17, v116, v117
    ds_write_b32 v227, v17 offset:1024
    s_waitcnt lgkmcnt(0)
    s_barrier
    ds_read_b64_tr_b16 v[188:189], v229 offset:0
    ds_read_b64_tr_b16 v[190:191], v229 offset:4736
    ds_read_b64_tr_b16 v[192:193], v229 offset:512
    ds_read_b64_tr_b16 v[194:195], v229 offset:5248
    ds_read_b64_tr_b16 v[196:197], v229 offset:1024
    ds_read_b64_tr_b16 v[198:199], v229 offset:5760
    s_waitcnt lgkmcnt(4)
    buffer_store_dwordx4 v[188:191], v36, s[36:39], s48 offen sc1
    s_waitcnt lgkmcnt(2)
    buffer_store_dwordx4 v[192:195], v36, s[36:39], s49 offen sc1
    s_waitcnt lgkmcnt(0)
    s_cmp_lg_u32 s3, 0
    s_cbranch_scc1 L_m_20
    buffer_store_dwordx4 v[196:199], v36, s[36:39], s50 offen sc1
L_m_20:
    v_cvt_pk_bf16_f32 v9, v236, v237
    v_cvt_pk_bf16_f32 v10, v238, v239
    v_cvt_pk_bf16_f32 v11, v240, v241
    v_cvt_pk_bf16_f32 v12, v242, v243
    v_cvt_pk_bf16_f32 v13, v244, v245
    v_cvt_pk_bf16_f32 v14, v246, v247
    v_cvt_pk_bf16_f32 v15, v248, v249
    v_cvt_pk_bf16_f32 v16, v250, v251
    v_cvt_pk_bf16_f32 v17, v252, v253
    ds_write2_b32 v231, v9, v10 offset0:0 offset1:32
    ds_write2_b32 v231, v11, v12 offset0:64 offset1:96
    ds_write2_b32 v231, v13, v14 offset0:128 offset1:160
    ds_write2_b32 v231, v15, v16 offset0:192 offset1:224
    ds_write_b32 v231, v17 offset:1024
    s_waitcnt lgkmcnt(0)
    s_barrier
    s_cmp_ge_u32 s5, 27
    s_cbranch_scc1 L_m_21
    v_lshrrev_b32 v10, 2, v0
    v_and_b32 v11, 7, v10
    s_lshl_b32 s59, s3, 1
    s_add_u32 s59, s59, 0
    v_xor_b32 v11, s59, v11
    v_xor_b32 v12, 1, v11
    v_and_b32 v13, 3, v0
    v_lshlrev_b32 v13, 3, v13
    v_lshl_add_u32 v10, v10, 8, v13
    v_lshl_add_u32 v20, v11, 5, v10
    v_lshl_add_u32 v21, v12, 5, v10
    v_add_u32 v24, 0, v20
    v_add_u32 v25, 0, v21
    ds_read_b64_tr_b16 v[92:93], v24 offset:0
    ds_read_b64_tr_b16 v[94:95], v24 offset:4096
    ds_read_b64_tr_b16 v[96:97], v25 offset:0
    ds_read_b64_tr_b16 v[98:99], v25 offset:4096
    ds_read_b64_tr_b16 v[100:101], v24 offset:8192
    ds_read_b64_tr_b16 v[102:103], v24 offset:12288
    ds_read_b64_tr_b16 v[104:105], v25 offset:8192
    ds_read_b64_tr_b16 v[106:107], v25 offset:12288
    ds_read_b64_tr_b16 v[108:109], v24 offset:16384
    ds_read_b64_tr_b16 v[110:111], v24 offset:20480
    ds_read_b64_tr_b16 v[112:113], v25 offset:16384
    ds_read_b64_tr_b16 v[114:115], v25 offset:20480
    ds_read_b64_tr_b16 v[116:117], v24 offset:24576
    ds_read_b64_tr_b16 v[118:119], v24 offset:28672
    ds_read_b64_tr_b16 v[120:121], v25 offset:24576
    ds_read_b64_tr_b16 v[122:123], v25 offset:28672
    ds_read_b64_tr_b16 v[124:125], v24 offset:32768
    ds_read_b64_tr_b16 v[126:127], v24 offset:36864
    ds_read_b64_tr_b16 v[128:129], v25 offset:32768
    ds_read_b64_tr_b16 v[130:131], v25 offset:36864
    ds_read_b64_tr_b16 v[132:133], v24 offset:40960
    ds_read_b64_tr_b16 v[134:135], v24 offset:45056
    ds_read_b64_tr_b16 v[136:137], v25 offset:40960
    ds_read_b64_tr_b16 v[138:139], v25 offset:45056
    v_add_u32 v24, 49152, v20
    v_add_u32 v25, 49152, v21
    ds_read_b64_tr_b16 v[140:141], v24 offset:0
    ds_read_b64_tr_b16 v[142:143], v24 offset:4096
    ds_read_b64_tr_b16 v[144:145], v25 offset:0
    ds_read_b64_tr_b16 v[146:147], v25 offset:4096
    ds_read_b64_tr_b16 v[148:149], v24 offset:8192
    ds_read_b64_tr_b16 v[150:151], v24 offset:12288
    ds_read_b64_tr_b16 v[152:153], v25 offset:8192
    ds_read_b64_tr_b16 v[154:155], v25 offset:12288
    ds_read_b64_tr_b16 v[156:157], v24 offset:16384
    ds_read_b64_tr_b16 v[158:159], v24 offset:20480
    ds_read_b64_tr_b16 v[160:161], v25 offset:16384
    ds_read_b64_tr_b16 v[162:163], v25 offset:20480
    ds_read_b64_tr_b16 v[164:165], v24 offset:24576
    ds_read_b64_tr_b16 v[166:167], v24 offset:28672
    ds_read_b64_tr_b16 v[168:169], v25 offset:24576
    ds_read_b64_tr_b16 v[170:171], v25 offset:28672
    ds_read_b64_tr_b16 v[172:173], v24 offset:32768
    ds_read_b64_tr_b16 v[174:175], v24 offset:36864
    ds_read_b64_tr_b16 v[176:177], v25 offset:32768
    ds_read_b64_tr_b16 v[178:179], v25 offset:36864
    ds_read_b64_tr_b16 v[180:181], v24 offset:40960
    ds_read_b64_tr_b16 v[182:183], v24 offset:45056
    ds_read_b64_tr_b16 v[184:185], v25 offset:40960
    ds_read_b64_tr_b16 v[186:187], v25 offset:45056
    s_waitcnt vmcnt(0) lgkmcnt(0)
    s_barrier
    v_mul_u32_u24 v18, 1536, v2
    v_lshl_add_u32 v18, v1, 4, v18
    v_add_u32 v18, 98304, v18
    v_lshlrev_b32 v204, 16, v4
    v_and_b32 v205, 0xffff0000, v4
    v_lshlrev_b32 v206, 16, v5
    v_and_b32 v207, 0xffff0000, v5
    v_lshlrev_b32 v208, 16, v6
    v_and_b32 v209, 0xffff0000, v6
    v_lshlrev_b32 v210, 16, v7
    v_and_b32 v211, 0xffff0000, v7
    v_mov_b64 v[212:213], v[204:205]
    v_mov_b64 v[214:215], v[206:207]
    v_mov_b64 v[216:217], v[208:209]
    v_mov_b64 v[218:219], v[210:211]
    v_mov_b64 v[220:221], v[204:205]
    v_mov_b64 v[222:223], v[206:207]
    v_mov_b64 v[224:225], v[208:209]
    v_mov_b64 v[226:227], v[210:211]
    v_mov_b64 v[228:229], v[204:205]
    v_mov_b64 v[230:231], v[206:207]
    v_mov_b64 v[232:233], v[208:209]
    v_mov_b64 v[234:235], v[210:211]
    v_mov_b64 v[236:237], v[204:205]
    v_mov_b64 v[238:239], v[206:207]
    v_mov_b64 v[240:241], v[208:209]
    v_mov_b64 v[242:243], v[210:211]
    v_mov_b64 v[244:245], v[204:205]
    v_mov_b64 v[246:247], v[206:207]
    v_mov_b64 v[248:249], v[208:209]
    v_mov_b64 v[250:251], v[210:211]
    s_branch L_stub_3
L_back_c2:
    v_add_u32 v24, 49152, v20
    v_add_u32 v25, 49152, v21
    s_barrier
    ds_read_b64_tr_b16 v[76:77], v20 offset:0
    ds_read_b128 v[28:31], v18 offset:0
    ds_read_b64_tr_b16 v[78:79], v20 offset:4096
    ds_read_b128 v[32:35], v18 offset:256
    ds_read_b64_tr_b16 v[80:81], v21 offset:0
    ds_read_b128 v[36:39], v18 offset:512
    ds_read_b64_tr_b16 v[82:83], v21 offset:4096
    ds_read_b128 v[40:43], v18 offset:768
    ds_read_b128 v[44:47], v18 offset:1024
    ds_read_b128 v[48:51], v18 offset:1280
    s_waitcnt lgkmcnt(7)
    v_mfma_f32_16x16x32_bf16 v[204:207], v[76:79], v[28:31], v[204:207]
    ds_read_b64_tr_b16 v[84:85], v20 offset:8192
    s_waitcnt lgkmcnt(7)
    v_mfma_f32_16x16x32_bf16 v[212:215], v[76:79], v[32:35], v[212:215]
    ds_read_b128 v[52:55], v18 offset:6144
    s_waitcnt lgkmcnt(6)
    v_mfma_f32_16x16x32_bf16 v[220:223], v[76:79], v[36:39], v[220:223]
    ds_read_b64_tr_b16 v[86:87], v20 offset:12288
    s_waitcnt lgkmcnt(6)
    v_mfma_f32_16x16x32_bf16 v[208:211], v[80:83], v[28:31], v[208:211]
    ds_read_b128 v[56:59], v18 offset:6400
    v_mfma_f32_16x16x32_bf16 v[216:219], v[80:83], v[32:35], v[216:219]
    ds_read_b64_tr_b16 v[88:89], v21 offset:8192
    v_mfma_f32_16x16x32_bf16 v[224:227], v[80:83], v[36:39], v[224:227]
    ds_read_b128 v[60:63], v18 offset:6656
    s_waitcnt lgkmcnt(6)
    v_mfma_f32_16x16x32_bf16 v[228:231], v[76:79], v[40:43], v[228:231]
    ds_read_b64_tr_b16 v[90:91], v21 offset:12288
    v_mfma_f32_16x16x32_bf16 v[232:235], v[80:83], v[40:43], v[232:235]
    ds_read_b128 v[64:67], v18 offset:6912
    v_mfma_f32_16x16x32_bf16 v[236:239], v[76:79], v[44:47], v[236:239]
    ds_read_b128 v[68:71], v18 offset:7168
    v_mfma_f32_16x16x32_bf16 v[240:243], v[80:83], v[44:47], v[240:243]
    ds_read_b128 v[72:75], v18 offset:7424
    v_mfma_f32_16x16x32_bf16 v[244:247], v[76:79], v[48:51], v[244:247]
    v_mfma_f32_16x16x32_bf16 v[248:251], v[80:83], v[48:51], v[248:251]
    s_waitcnt lgkmcnt(3)
    v_mfma_f32_16x16x32_bf16 v[204:207], v[84:87], v[52:55], v[204:207]
    s_barrier
    ds_read_b64_tr_b16 v[76:77], v20 offset:16384
    v_mfma_f32_16x16x32_bf16 v[212:215], v[84:87], v[56:59], v[212:215]
    ds_read_b128 v[28:31], v18 offset:12288
    v_mfma_f32_16x16x32_bf16 v[220:223], v[84:87], v[60:63], v[220:223]
    ds_read_b64_tr_b16 v[78:79], v20 offset:20480
    v_mfma_f32_16x16x32_bf16 v[208:211], v[88:91], v[52:55], v[208:211]
    ds_read_b128 v[32:35], v18 offset:12544
    v_mfma_f32_16x16x32_bf16 v[216:219], v[88:91], v[56:59], v[216:219]
    ds_read_b64_tr_b16 v[80:81], v21 offset:16384
    v_mfma_f32_16x16x32_bf16 v[224:227], v[88:91], v[60:63], v[224:227]
    ds_read_b128 v[36:39], v18 offset:12800
    s_waitcnt lgkmcnt(6)
    v_mfma_f32_16x16x32_bf16 v[228:231], v[84:87], v[64:67], v[228:231]
    ds_read_b64_tr_b16 v[82:83], v21 offset:20480
    v_mfma_f32_16x16x32_bf16 v[232:235], v[88:91], v[64:67], v[232:235]
    ds_read_b128 v[40:43], v18 offset:13056
    v_mfma_f32_16x16x32_bf16 v[236:239], v[84:87], v[68:71], v[236:239]
    ds_read_b128 v[44:47], v18 offset:13312
    v_mfma_f32_16x16x32_bf16 v[240:243], v[88:91], v[68:71], v[240:243]
    ds_read_b128 v[48:51], v18 offset:13568
    v_mfma_f32_16x16x32_bf16 v[244:247], v[84:87], v[72:75], v[244:247]
    v_mfma_f32_16x16x32_bf16 v[248:251], v[88:91], v[72:75], v[248:251]
    s_waitcnt lgkmcnt(3)
    v_mfma_f32_16x16x32_bf16 v[204:207], v[76:79], v[28:31], v[204:207]
    ds_read_b64_tr_b16 v[84:85], v20 offset:24576
    v_mfma_f32_16x16x32_bf16 v[212:215], v[76:79], v[32:35], v[212:215]
    ds_read_b128 v[52:55], v18 offset:18432
    v_mfma_f32_16x16x32_bf16 v[220:223], v[76:79], v[36:39], v[220:223]
    ds_read_b64_tr_b16 v[86:87], v20 offset:28672
    v_mfma_f32_16x16x32_bf16 v[208:211], v[80:83], v[28:31], v[208:211]
    ds_read_b128 v[56:59], v18 offset:18688
    v_mfma_f32_16x16x32_bf16 v[216:219], v[80:83], v[32:35], v[216:219]
    ds_read_b64_tr_b16 v[88:89], v21 offset:24576
    v_mfma_f32_16x16x32_bf16 v[224:227], v[80:83], v[36:39], v[224:227]
    ds_read_b128 v[60:63], v18 offset:18944
    s_waitcnt lgkmcnt(6)
    v_mfma_f32_16x16x32_bf16 v[228:231], v[76:79], v[40:43], v[228:231]
    ds_read_b64_tr_b16 v[90:91], v21 offset:28672
    v_mfma_f32_16x16x32_bf16 v[232:235], v[80:83], v[40:43], v[232:235]
    ds_read_b128 v[64:67], v18 offset:19200
    v_mfma_f32_16x16x32_bf16 v[236:239], v[76:79], v[44:47], v[236:239]
    ds_read_b128 v[68:71], v18 offset:19456
    v_mfma_f32_16x16x32_bf16 v[240:243], v[80:83], v[44:47], v[240:243]
    ds_read_b128 v[72:75], v18 offset:19712
    v_mfma_f32_16x16x32_bf16 v[244:247], v[76:79], v[48:51], v[244:247]
    v_mfma_f32_16x16x32_bf16 v[248:251], v[80:83], v[48:51], v[248:251]
    s_waitcnt lgkmcnt(3)
    v_mfma_f32_16x16x32_bf16 v[204:207], v[84:87], v[52:55], v[204:207]
    s_barrier
    ds_read_b64_tr_b16 v[76:77], v20 offset:32768
    v_mfma_f32_16x16x32_bf16 v[212:215], v[84:87], v[56:59], v[212:215]
    ds_read_b128 v[28:31], v18 offset:24576
    v_mfma_f32_16x16x32_bf16 v[220:223], v[84:87], v[60:63], v[220:223]
    ds_read_b64_tr_b16 v[78:79], v20 offset:36864
    v_mfma_f32_16x16x32_bf16 v[208:211], v[88:91], v[52:55], v[208:211]
    ds_read_b128 v[32:35], v18 offset:24832
    v_mfma_f32_16x16x32_bf16 v[216:219], v[88:91], v[56:59], v[216:219]
    ds_read_b64_tr_b16 v[80:81], v21 offset:32768
    v_mfma_f32_16x16x32_bf16 v[224:227], v[88:91], v[60:63], v[224:227]
    ds_read_b128 v[36:39], v18 offset:25088
    s_waitcnt lgkmcnt(6)
    v_mfma_f32_16x16x32_bf16 v[228:231], v[84:87], v[64:67], v[228:231]
    ds_read_b64_tr_b16 v[82:83], v21 offset:36864
    v_mfma_f32_16x16x32_bf16 v[232:235], v[88:91], v[64:67], v[232:235]
    ds_read_b128 v[40:43], v18 offset:25344
    v_mfma_f32_16x16x32_bf16 v[236:239], v[84:87], v[68:71], v[236:239]
    ds_read_b128 v[44:47], v18 offset:25600
    v_mfma_f32_16x16x32_bf16 v[240:243], v[88:91], v[68:71], v[240:243]
    ds_read_b128 v[48:51], v18 offset:25856
    v_mfma_f32_16x16x32_bf16 v[244:247], v[84:87], v[72:75], v[244:247]
    v_mfma_f32_16x16x32_bf16 v[248:251], v[88:91], v[72:75], v[248:251]
    s_waitcnt lgkmcnt(3)
    v_mfma_f32_16x16x32_bf16 v[204:207], v[76:79], v[28:31], v[204:207]
    ds_read_b64_tr_b16 v[84:85], v20 offset:40960
    v_mfma_f32_16x16x32_bf16 v[212:215], v[76:79], v[32:35], v[212:215]
    ds_read_b128 v[52:55], v18 offset:30720
    v_mfma_f32_16x16x32_bf16 v[220:223], v[76:79], v[36:39], v[220:223]
    ds_read_b64_tr_b16 v[86:87], v20 offset:45056
    v_mfma_f32_16x16x32_bf16 v[208:211], v[80:83], v[28:31], v[208:211]
    ds_read_b128 v[56:59], v18 offset:30976
    v_mfma_f32_16x16x32_bf16 v[216:219], v[80:83], v[32:35], v[216:219]
    ds_read_b64_tr_b16 v[88:89], v21 offset:40960
    v_mfma_f32_16x16x32_bf16 v[224:227], v[80:83], v[36:39], v[224:227]
    ds_read_b128 v[60:63], v18 offset:31232
    s_waitcnt lgkmcnt(6)
    v_mfma_f32_16x16x32_bf16 v[228:231], v[76:79], v[40:43], v[228:231]
    ds_read_b64_tr_b16 v[90:91], v21 offset:45056
    v_mfma_f32_16x16x32_bf16 v[232:235], v[80:83], v[40:43], v[232:235]
    ds_read_b128 v[64:67], v18 offset:31488
    v_mfma_f32_16x16x32_bf16 v[236:239], v[76:79], v[44:47], v[236:239]
    ds_read_b128 v[68:71], v18 offset:31744
    v_mfma_f32_16x16x32_bf16 v[240:243], v[80:83], v[44:47], v[240:243]
    ds_read_b128 v[72:75], v18 offset:32000
    v_mfma_f32_16x16x32_bf16 v[244:247], v[76:79], v[48:51], v[244:247]
    v_mfma_f32_16x16x32_bf16 v[248:251], v[80:83], v[48:51], v[248:251]
    s_waitcnt lgkmcnt(3)
    v_mfma_f32_16x16x32_bf16 v[204:207], v[84:87], v[52:55], v[204:207]
    s_barrier
    ds_read_b64_tr_b16 v[76:77], v24 offset:0
    v_mfma_f32_16x16x32_bf16 v[212:215], v[84:87], v[56:59], v[212:215]
    ds_read_b128 v[28:31], v18 offset:36864
    v_mfma_f32_16x16x32_bf16 v[220:223], v[84:87], v[60:63], v[220:223]
    s_branch L_skip_3
    s_nop 0
L_stub_3:
    s_branch L_stub_4
L_skip_3:
    ds_read_b64_tr_b16 v[78:79], v24 offset:4096
    v_mfma_f32_16x16x32_bf16 v[208:211], v[88:91], v[52:55], v[208:211]
    ds_read_b128 v[32:35], v18 offset:37120
    v_mfma_f32_16x16x32_bf16 v[216:219], v[88:91], v[56:59], v[216:219]
    ds_read_b64_tr_b16 v[80:81], v25 offset:0
    v_mfma_f32_16x16x32_bf16 v[224:227], v[88:91], v[60:63], v[224:227]
    ds_read_b128 v[36:39], v18 offset:37376
    s_waitcnt lgkmcnt(6)
    v_mfma_f32_16x16x32_bf16 v[228:231], v[84:87], v[64:67], v[228:231]
    ds_read_b64_tr_b16 v[82:83], v25 offset:4096
    v_mfma_f32_16x16x32_bf16 v[232:235], v[88:91], v[64:67], v[232:235]
    ds_read_b128 v[40:43], v18 offset:37632
    v_mfma_f32_16x16x32_bf16 v[236:239], v[84:87], v[68:71], v[236:239]
    ds_read_b128 v[44:47], v18 offset:37888
    v_mfma_f32_16x16x32_bf16 v[240:243], v[88:91], v[68:71], v[240:243]
    ds_read_b128 v[48:51], v18 offset:38144
    v_mfma_f32_16x16x32_bf16 v[244:247], v[84:87], v[72:75], v[244:247]
    v_mfma_f32_16x16x32_bf16 v[248:251], v[88:91], v[72:75], v[248:251]
    s_waitcnt lgkmcnt(3)
    v_mfma_f32_16x16x32_bf16 v[204:207], v[76:79], v[28:31], v[204:207]
    ds_read_b64_tr_b16 v[84:85], v24 offset:8192
    v_mfma_f32_16x16x32_bf16 v[212:215], v[76:79], v[32:35], v[212:215]
    ds_read_b128 v[52:55], v18 offset:43008
    v_mfma_f32_16x16x32_bf16 v[220:223], v[76:79], v[36:39], v[220:223]
    ds_read_b64_tr_b16 v[86:87], v24 offset:12288
    v_mfma_f32_16x16x32_bf16 v[208:211], v[80:83], v[28:31], v[208:211]
    ds_read_b128 v[56:59], v18 offset:43264
    v_mfma_f32_16x16x32_bf16 v[216:219], v[80:83], v[32:35], v[216:219]
    ds_read_b64_tr_b16 v[88:89], v25 offset:8192
    v_mfma_f32_16x16x32_bf16 v[224:227], v[80:83], v[36:39], v[224:227]
    ds_read_b128 v[60:63], v18 offset:43520
    s_waitcnt lgkmcnt(6)
    v_mfma_f32_16x16x32_bf16 v[228:231], v[76:79], v[40:43], v[228:231]
    ds_read_b64_tr_b16 v[90:91], v25 offset:12288
    v_mfma_f32_16x16x32_bf16 v[232:235], v[80:83], v[40:43], v[232:235]
    ds_read_b128 v[64:67], v18 offset:43776
    v_mfma_f32_16x16x32_bf16 v[236:239], v[76:79], v[44:47], v[236:239]
    ds_read_b128 v[68:71], v18 offset:44032
    v_mfma_f32_16x16x32_bf16 v[240:243], v[80:83], v[44:47], v[240:243]
    ds_read_b128 v[72:75], v18 offset:44288
    v_mfma_f32_16x16x32_bf16 v[244:247], v[76:79], v[48:51], v[244:247]
    v_mfma_f32_16x16x32_bf16 v[248:251], v[80:83], v[48:51], v[248:251]
    s_waitcnt lgkmcnt(3)
    v_mfma_f32_16x16x32_bf16 v[204:207], v[84:87], v[52:55], v[204:207]
    s_barrier
    ds_read_b64_tr_b16 v[76:77], v24 offset:16384
    v_mfma_f32_16x16x32_bf16 v[212:215], v[84:87], v[56:59], v[212:215]
    ds_read_b128 v[28:31], v18 offset:49152
    v_mfma_f32_16x16x32_bf16 v[220:223], v[84:87], v[60:63], v[220:223]
    ds_read_b64_tr_b16 v[78:79], v24 offset:20480
    v_mfma_f32_16x16x32_bf16 v[208:211], v[88:91], v[52:55], v[208:211]
    ds_read_b128 v[32:35], v18 offset:49408
    v_mfma_f32_16x16x32_bf16 v[216:219], v[88:91], v[56:59], v[216:219]
    ds_read_b64_tr_b16 v[80:81], v25 offset:16384
    v_mfma_f32_16x16x32_bf16 v[224:227], v[88:91], v[60:63], v[224:227]
    ds_read_b128 v[36:39], v18 offset:49664
    s_waitcnt lgkmcnt(6)
    v_mfma_f32_16x16x32_bf16 v[228:231], v[84:87], v[64:67], v[228:231]
    ds_read_b64_tr_b16 v[82:83], v25 offset:20480
    v_mfma_f32_16x16x32_bf16 v[232:235], v[88:91], v[64:67], v[232:235]
    ds_read_b128 v[40:43], v18 offset:49920
    v_mfma_f32_16x16x32_bf16 v[236:239], v[84:87], v[68:71], v[236:239]
    ds_read_b128 v[44:47], v18 offset:50176
    v_mfma_f32_16x16x32_bf16 v[240:243], v[88:91], v[68:71], v[240:243]
    ds_read_b128 v[48:51], v18 offset:50432
    v_mfma_f32_16x16x32_bf16 v[244:247], v[84:87], v[72:75], v[244:247]
    v_mfma_f32_16x16x32_bf16 v[248:251], v[88:91], v[72:75], v[248:251]
    s_waitcnt lgkmcnt(3)
    v_mfma_f32_16x16x32_bf16 v[204:207], v[76:79], v[28:31], v[204:207]
    ds_read_b64_tr_b16 v[84:85], v24 offset:24576
    v_mfma_f32_16x16x32_bf16 v[212:215], v[76:79], v[32:35], v[212:215]
    ds_read_b128 v[52:55], v18 offset:55296
    v_mfma_f32_16x16x32_bf16 v[220:223], v[76:79], v[36:39], v[220:223]
    ds_read_b64_tr_b16 v[86:87], v24 offset:28672
    v_mfma_f32_16x16x32_bf16 v[208:211], v[80:83], v[28:31], v[208:211]
    ds_read_b128 v[56:59], v18 offset:55552
    v_mfma_f32_16x16x32_bf16 v[216:219], v[80:83], v[32:35], v[216:219]
    ds_read_b64_tr_b16 v[88:89], v25 offset:24576
    v_mfma_f32_16x16x32_bf16 v[224:227], v[80:83], v[36:39], v[224:227]
    ds_read_b128 v[60:63], v18 offset:55808
    s_waitcnt lgkmcnt(6)
    v_mfma_f32_16x16x32_bf16 v[228:231], v[76:79], v[40:43], v[228:231]
    ds_read_b64_tr_b16 v[90:91], v25 offset:28672
    v_mfma_f32_16x16x32_bf16 v[232:235], v[80:83], v[40:43], v[232:235]
    ds_read_b128 v[64:67], v18 offset:56064
    v_mfma_f32_16x16x32_bf16 v[236:239], v[76:79], v[44:47], v[236:239]
    ds_read_b128 v[68:71], v18 offset:56320
    v_mfma_f32_16x16x32_bf16 v[240:243], v[80:83], v[44:47], v[240:243]
    ds_read_b128 v[72:75], v18 offset:56576
    v_mfma_f32_16x16x32_bf16 v[244:247], v[76:79], v[48:51], v[244:247]
    v_mfma_f32_16x16x32_bf16 v[248:251], v[80:83], v[48:51], v[248:251]
    s_waitcnt lgkmcnt(3)
    v_mfma_f32_16x16x32_bf16 v[204:207], v[84:87], v[52:55], v[204:207]
    s_barrier
    ds_read_b64_tr_b16 v[76:77], v24 offset:32768
    v_mfma_f32_16x16x32_bf16 v[212:215], v[84:87], v[56:59], v[212:215]
    ds_read_b128 v[28:31], v18 offset:0
    v_mfma_f32_16x16x32_bf16 v[220:223], v[84:87], v[60:63], v[220:223]
    ds_read_b64_tr_b16 v[78:79], v24 offset:36864
    v_mfma_f32_16x16x32_bf16 v[208:211], v[88:91], v[52:55], v[208:211]
    ds_read_b128 v[32:35], v18 offset:256
    v_mfma_f32_16x16x32_bf16 v[216:219], v[88:91], v[56:59], v[216:219]
    ds_read_b64_tr_b16 v[80:81], v25 offset:32768
    v_mfma_f32_16x16x32_bf16 v[224:227], v[88:91], v[60:63], v[224:227]
    ds_read_b128 v[36:39], v18 offset:512
    s_waitcnt lgkmcnt(6)
    v_mfma_f32_16x16x32_bf16 v[228:231], v[84:87], v[64:67], v[228:231]
    ds_read_b64_tr_b16 v[82:83], v25 offset:36864
    v_mfma_f32_16x16x32_bf16 v[232:235], v[88:91], v[64:67], v[232:235]
    ds_read_b128 v[40:43], v18 offset:768
    v_mfma_f32_16x16x32_bf16 v[236:239], v[84:87], v[68:71], v[236:239]
    ds_read_b128 v[44:47], v18 offset:1024
    v_mfma_f32_16x16x32_bf16 v[240:243], v[88:91], v[68:71], v[240:243]
    ds_read_b128 v[48:51], v18 offset:1280
    v_mfma_f32_16x16x32_bf16 v[244:247], v[84:87], v[72:75], v[244:247]
    v_mfma_f32_16x16x32_bf16 v[248:251], v[88:91], v[72:75], v[248:251]
    s_waitcnt lgkmcnt(3)
    v_mfma_f32_16x16x32_bf16 v[204:207], v[76:79], v[28:31], v[204:207]
    ds_read_b64_tr_b16 v[84:85], v24 offset:40960
    v_mfma_f32_16x16x32_bf16 v[212:215], v[76:79], v[32:35], v[212:215]
    ds_read_b128 v[52:55], v18 offset:6144
    v_mfma_f32_16x16x32_bf16 v[220:223], v[76:79], v[36:39], v[220:223]
    ds_read_b64_tr_b16 v[86:87], v24 offset:45056
    v_mfma_f32_16x16x32_bf16 v[208:211], v[80:83], v[28:31], v[208:211]
    ds_read_b128 v[56:59], v18 offset:6400
    v_mfma_f32_16x16x32_bf16 v[216:219], v[80:83], v[32:35], v[216:219]
    ds_read_b64_tr_b16 v[88:89], v25 offset:40960
    v_mfma_f32_16x16x32_bf16 v[224:227], v[80:83], v[36:39], v[224:227]
    ds_read_b128 v[60:63], v18 offset:6656
    s_waitcnt lgkmcnt(6)
    v_mfma_f32_16x16x32_bf16 v[228:231], v[76:79], v[40:43], v[228:231]
    ds_read_b64_tr_b16 v[90:91], v25 offset:45056
    v_mfma_f32_16x16x32_bf16 v[232:235], v[80:83], v[40:43], v[232:235]
    ds_read_b128 v[64:67], v18 offset:6912
    v_mfma_f32_16x16x32_bf16 v[236:239], v[76:79], v[44:47], v[236:239]
    ds_read_b128 v[68:71], v18 offset:7168
    v_mfma_f32_16x16x32_bf16 v[240:243], v[80:83], v[44:47], v[240:243]
    ds_read_b128 v[72:75], v18 offset:7424
    v_mfma_f32_16x16x32_bf16 v[244:247], v[76:79], v[48:51], v[244:247]
    v_mfma_f32_16x16x32_bf16 v[248:251], v[80:83], v[48:51], v[248:251]
    s_waitcnt lgkmcnt(3)
    v_mfma_f32_16x16x32_bf16 v[204:207], v[84:87], v[52:55], v[204:207]
    s_barrier
    v_mfma_f32_16x16x32_bf16 v[212:215], v[84:87], v[56:59], v[212:215]
    ds_read_b128 v[28:31], v18 offset:12288
    v_mfma_f32_16x16x32_bf16 v[220:223], v[84:87], v[60:63], v[220:223]
    v_mfma_f32_16x16x32_bf16 v[208:211], v[88:91], v[52:55], v[208:211]
    ds_read_b128 v[32:35], v18 offset:12544
    v_mfma_f32_16x16x32_bf16 v[216:219], v[88:91], v[56:59], v[216:219]
    v_mfma_f32_16x16x32_bf16 v[224:227], v[88:91], v[60:63], v[224:227]
    ds_read_b128 v[36:39], v18 offset:12800
    s_waitcnt lgkmcnt(3)
    v_mfma_f32_16x16x32_bf16 v[228:231], v[84:87], v[64:67], v[228:231]
    v_mfma_f32_16x16x32_bf16 v[232:235], v[88:91], v[64:67], v[232:235]
    ds_read_b128 v[40:43], v18 offset:13056
    v_mfma_f32_16x16x32_bf16 v[236:239], v[84:87], v[68:71], v[236:239]
    ds_read_b128 v[44:47], v18 offset:13312
    v_mfma_f32_16x16x32_bf16 v[240:243], v[88:91], v[68:71], v[240:243]
    ds_read_b128 v[48:51], v18 offset:13568
    v_mfma_f32_16x16x32_bf16 v[244:247], v[84:87], v[72:75], v[244:247]
    v_mfma_f32_16x16x32_bf16 v[248:251], v[88:91], v[72:75], v[248:251]
    s_waitcnt lgkmcnt(3)
    v_mfma_f32_16x16x32_bf16 v[204:207], v[92:95], v[28:31], v[204:207]
    v_mfma_f32_16x16x32_bf16 v[212:215], v[92:95], v[32:35], v[212:215]
    ds_read_b128 v[52:55], v18 offset:18432
    v_mfma_f32_16x16x32_bf16 v[220:223], v[92:95], v[36:39], v[220:223]
    v_mfma_f32_16x16x32_bf16 v[208:211], v[96:99], v[28:31], v[208:211]
    ds_read_b128 v[56:59], v18 offset:18688
    v_mfma_f32_16x16x32_bf16 v[216:219], v[96:99], v[32:35], v[216:219]
    v_mfma_f32_16x16x32_bf16 v[224:227], v[96:99], v[36:39], v[224:227]
    ds_read_b128 v[60:63], v18 offset:18944
    s_waitcnt lgkmcnt(3)
    v_mfma_f32_16x16x32_bf16 v[228:231], v[92:95], v[40:43], v[228:231]
    v_mfma_f32_16x16x32_bf16 v[232:235], v[96:99], v[40:43], v[232:235]
    ds_read_b128 v[64:67], v18 offset:19200
    v_mfma_f32_16x16x32_bf16 v[236:239], v[92:95], v[44:47], v[236:239]
    ds_read_b128 v[68:71], v18 offset:19456
    v_mfma_f32_16x16x32_bf16 v[240:243], v[96:99], v[44:47], v[240:243]
    ds_read_b128 v[72:75], v18 offset:19712
    v_mfma_f32_16x16x32_bf16 v[244:247], v[92:95], v[48:51], v[244:247]
    v_mfma_f32_16x16x32_bf16 v[248:251], v[96:99], v[48:51], v[248:251]
    s_waitcnt lgkmcnt(3)
    v_mfma_f32_16x16x32_bf16 v[204:207], v[100:103], v[52:55], v[204:207]
    s_barrier
    ds_read_b64_tr_b16 v[76:77], v20 offset:0
    v_mfma_f32_16x16x32_bf16 v[212:215], v[100:103], v[56:59], v[212:215]
    ds_read_b128 v[28:31], v18 offset:24576
    v_mfma_f32_16x16x32_bf16 v[220:223], v[100:103], v[60:63], v[220:223]
    ds_read_b64_tr_b16 v[78:79], v20 offset:4096
    v_mfma_f32_16x16x32_bf16 v[208:211], v[104:107], v[52:55], v[208:211]
    ds_read_b128 v[32:35], v18 offset:24832
    v_mfma_f32_16x16x32_bf16 v[216:219], v[104:107], v[56:59], v[216:219]
    ds_read_b64_tr_b16 v[80:81], v21 offset:0
    v_mfma_f32_16x16x32_bf16 v[224:227], v[104:107], v[60:63], v[224:227]
    ds_read_b128 v[36:39], v18 offset:25088
    s_waitcnt lgkmcnt(6)
    v_mfma_f32_16x16x32_bf16 v[228:231], v[100:103], v[64:67], v[228:231]
    ds_read_b64_tr_b16 v[82:83], v21 offset:4096
    v_mfma_f32_16x16x32_bf16 v[232:235], v[104:107], v[64:67], v[232:235]
    ds_read_b128 v[40:43], v18 offset:25344
    v_mfma_f32_16x16x32_bf16 v[236:239], v[100:103], v[68:71], v[236:239]
    ds_read_b128 v[44:47], v18 offset:25600
    v_mfma_f32_16x16x32_bf16 v[240:243], v[104:107], v[68:71], v[240:243]
    ds_read_b128 v[48:51], v18 offset:25856
    v_mfma_f32_16x16x32_bf16 v[244:247], v[100:103], v[72:75], v[244:247]
    v_mfma_f32_16x16x32_bf16 v[248:251], v[104:107], v[72:75], v[248:251]
    s_waitcnt lgkmcnt(3)
    v_mfma_f32_16x16x32_bf16 v[204:207], v[76:79], v[28:31], v[204:207]
    ds_read_b64_tr_b16 v[84:85], v20 offset:8192
    v_mfma_f32_16x16x32_bf16 v[212:215], v[76:79], v[32:35], v[212:215]
    ds_read_b128 v[52:55], v18 offset:30720
    v_mfma_f32_16x16x32_bf16 v[220:223], v[76:79], v[36:39], v[220:223]
    ds_read_b64_tr_b16 v[86:87], v20 offset:12288
    v_mfma_f32_16x16x32_bf16 v[208:211], v[80:83], v[28:31], v[208:211]
    ds_read_b128 v[56:59], v18 offset:30976
    v_mfma_f32_16x16x32_bf16 v[216:219], v[80:83], v[32:35], v[216:219]
    ds_read_b64_tr_b16 v[88:89], v21 offset:8192
    v_mfma_f32_16x16x32_bf16 v[224:227], v[80:83], v[36:39], v[224:227]
    ds_read_b128 v[60:63], v18 offset:31232
    s_waitcnt lgkmcnt(6)
    v_mfma_f32_16x16x32_bf16 v[228:231], v[76:79], v[40:43], v[228:231]
    ds_read_b64_tr_b16 v[90:91], v21 offset:12288
    v_mfma_f32_16x16x32_bf16 v[232:235], v[80:83], v[40:43], v[232:235]
    ds_read_b128 v[64:67], v18 offset:31488
    v_mfma_f32_16x16x32_bf16 v[236:239], v[76:79], v[44:47], v[236:239]
    ds_read_b128 v[68:71], v18 offset:31744
    v_mfma_f32_16x16x32_bf16 v[240:243], v[80:83], v[44:47], v[240:243]
    ds_read_b128 v[72:75], v18 offset:32000
    v_mfma_f32_16x16x32_bf16 v[244:247], v[76:79], v[48:51], v[244:247]
    v_mfma_f32_16x16x32_bf16 v[248:251], v[80:83], v[48:51], v[248:251]
    s_waitcnt lgkmcnt(3)
    v_mfma_f32_16x16x32_bf16 v[204:207], v[84:87], v[52:55], v[204:207]
    s_barrier
    ds_read_b64_tr_b16 v[76:77], v20 offset:16384
    v_mfma_f32_16x16x32_bf16 v[212:215], v[84:87], v[56:59], v[212:215]
    ds_read_b128 v[28:31], v18 offset:36864
    v_mfma_f32_16x16x32_bf16 v[220:223], v[84:87], v[60:63], v[220:223]
    ds_read_b64_tr_b16 v[78:79], v20 offset:20480
    v_mfma_f32_16x16x32_bf16 v[208:211], v[88:91], v[52:55], v[208:211]
    ds_read_b128 v[32:35], v18 offset:37120
    v_mfma_f32_16x16x32_bf16 v[216:219], v[88:91], v[56:59], v[216:219]
    ds_read_b64_tr_b16 v[80:81], v21 offset:16384
    v_mfma_f32_16x16x32_bf16 v[224:227], v[88:91], v[60:63], v[224:227]
    ds_read_b128 v[36:39], v18 offset:37376
    s_waitcnt lgkmcnt(6)
    v_mfma_f32_16x16x32_bf16 v[228:231], v[84:87], v[64:67], v[228:231]
    ds_read_b64_tr_b16 v[82:83], v21 offset:20480
    v_mfma_f32_16x16x32_bf16 v[232:235], v[88:91], v[64:67], v[232:235]
    ds_read_b128 v[40:43], v18 offset:37632
    v_mfma_f32_16x16x32_bf16 v[236:239], v[84:87], v[68:71], v[236:239]
    ds_read_b128 v[44:47], v18 offset:37888
    v_mfma_f32_16x16x32_bf16 v[240:243], v[88:91], v[68:71], v[240:243]
    ds_read_b128 v[48:51], v18 offset:38144
    v_mfma_f32_16x16x32_bf16 v[244:247], v[84:87], v[72:75], v[244:247]
    v_mfma_f32_16x16x32_bf16 v[248:251], v[88:91], v[72:75], v[248:251]
    s_waitcnt lgkmcnt(3)
    v_mfma_f32_16x16x32_bf16 v[204:207], v[76:79], v[28:31], v[204:207]
    ds_read_b64_tr_b16 v[84:85], v20 offset:24576
    v_mfma_f32_16x16x32_bf16 v[212:215], v[76:79], v[32:35], v[212:215]
    ds_read_b128 v[52:55], v18 offset:43008
    v_mfma_f32_16x16x32_bf16 v[220:223], v[76:79], v[36:39], v[220:223]
    ds_read_b64_tr_b16 v[86:87], v20 offset:28672
    v_mfma_f32_16x16x32_bf16 v[208:211], v[80:83], v[28:31], v[208:211]
    ds_read_b128 v[56:59], v18 offset:43264
    v_mfma_f32_16x16x32_bf16 v[216:219], v[80:83], v[32:35], v[216:219]
    ds_read_b64_tr_b16 v[88:89], v21 offset:24576
    v_mfma_f32_16x16x32_bf16 v[224:227], v[80:83], v[36:39], v[224:227]
    ds_read_b128 v[60:63], v18 offset:43520
    s_waitcnt lgkmcnt(6)
    v_mfma_f32_16x16x32_bf16 v[228:231], v[76:79], v[40:43], v[228:231]
    ds_read_b64_tr_b16 v[90:91], v21 offset:28672
    v_mfma_f32_16x16x32_bf16 v[232:235], v[80:83], v[40:43], v[232:235]
    ds_read_b128 v[64:67], v18 offset:43776
    v_mfma_f32_16x16x32_bf16 v[236:239], v[76:79], v[44:47], v[236:239]
    ds_read_b128 v[68:71], v18 offset:44032
    v_mfma_f32_16x16x32_bf16 v[240:243], v[80:83], v[44:47], v[240:243]
    ds_read_b128 v[72:75], v18 offset:44288
    v_mfma_f32_16x16x32_bf16 v[244:247], v[76:79], v[48:51], v[244:247]
    v_mfma_f32_16x16x32_bf16 v[248:251], v[80:83], v[48:51], v[248:251]
    s_waitcnt lgkmcnt(3)
    v_mfma_f32_16x16x32_bf16 v[204:207], v[84:87], v[52:55], v[204:207]
    s_barrier
    ds_read_b64_tr_b16 v[76:77], v20 offset:32768
    v_mfma_f32_16x16x32_bf16 v[212:215], v[84:87], v[56:59], v[212:215]
    ds_read_b128 v[28:31], v18 offset:49152
    v_mfma_f32_16x16x32_bf16 v[220:223], v[84:87], v[60:63], v[220:223]
    ds_read_b64_tr_b16 v[78:79], v20 offset:36864
    v_mfma_f32_16x16x32_bf16 v[208:211], v[88:91], v[52:55], v[208:211]
    ds_read_b128 v[32:35], v18 offset:49408
    v_mfma_f32_16x16x32_bf16 v[216:219], v[88:91], v[56:59], v[216:219]
    ds_read_b64_tr_b16 v[80:81], v21 offset:32768
    v_mfma_f32_16x16x32_bf16 v[224:227], v[88:91], v[60:63], v[224:227]
    ds_read_b128 v[36:39], v18 offset:49664
    s_waitcnt lgkmcnt(6)
    v_mfma_f32_16x16x32_bf16 v[228:231], v[84:87], v[64:67], v[228:231]
    ds_read_b64_tr_b16 v[82:83], v21 offset:36864
    v_mfma_f32_16x16x32_bf16 v[232:235], v[88:91], v[64:67], v[232:235]
    ds_read_b128 v[40:43], v18 offset:49920
    v_mfma_f32_16x16x32_bf16 v[236:239], v[84:87], v[68:71], v[236:239]
    ds_read_b128 v[44:47], v18 offset:50176
    v_mfma_f32_16x16x32_bf16 v[240:243], v[88:91], v[68:71], v[240:243]
    ds_read_b128 v[48:51], v18 offset:50432
    v_mfma_f32_16x16x32_bf16 v[244:247], v[84:87], v[72:75], v[244:247]
    v_mfma_f32_16x16x32_bf16 v[248:251], v[88:91], v[72:75], v[248:251]
    s_waitcnt lgkmcnt(3)
    v_mfma_f32_16x16x32_bf16 v[204:207], v[76:79], v[28:31], v[204:207]
    ds_read_b64_tr_b16 v[84:85], v20 offset:40960
    v_mfma_f32_16x16x32_bf16 v[212:215], v[76:79], v[32:35], v[212:215]
    ds_read_b128 v[52:55], v18 offset:55296
    v_mfma_f32_16x16x32_bf16 v[220:223], v[76:79], v[36:39], v[220:223]
    ds_read_b64_tr_b16 v[86:87], v20 offset:45056
    v_mfma_f32_16x16x32_bf16 v[208:211], v[80:83], v[28:31], v[208:211]
    ds_read_b128 v[56:59], v18 offset:55552
    v_mfma_f32_16x16x32_bf16 v[216:219], v[80:83], v[32:35], v[216:219]
    ds_read_b64_tr_b16 v[88:89], v21 offset:40960
    v_mfma_f32_16x16x32_bf16 v[224:227], v[80:83], v[36:39], v[224:227]
    ds_read_b128 v[60:63], v18 offset:55808
    s_waitcnt lgkmcnt(6)
    v_mfma_f32_16x16x32_bf16 v[228:231], v[76:79], v[40:43], v[228:231]
    ds_read_b64_tr_b16 v[90:91], v21 offset:45056
    v_mfma_f32_16x16x32_bf16 v[232:235], v[80:83], v[40:43], v[232:235]
    ds_read_b128 v[64:67], v18 offset:56064
    v_mfma_f32_16x16x32_bf16 v[236:239], v[76:79], v[44:47], v[236:239]
    ds_read_b128 v[68:71], v18 offset:56320
    v_mfma_f32_16x16x32_bf16 v[240:243], v[80:83], v[44:47], v[240:243]
    ds_read_b128 v[72:75], v18 offset:56576
    v_mfma_f32_16x16x32_bf16 v[244:247], v[76:79], v[48:51], v[244:247]
    v_mfma_f32_16x16x32_bf16 v[248:251], v[80:83], v[48:51], v[248:251]
    s_waitcnt lgkmcnt(3)
    v_mfma_f32_16x16x32_bf16 v[204:207], v[84:87], v[52:55], v[204:207]
    s_barrier
    v_mfma_f32_16x16x32_bf16 v[212:215], v[84:87], v[56:59], v[212:215]
    ds_read_b128 v[28:31], v18 offset:0
    v_mfma_f32_16x16x32_bf16 v[220:223], v[84:87], v[60:63], v[220:223]
    v_mfma_f32_16x16x32_bf16 v[208:211], v[88:91], v[52:55], v[208:211]
    ds_read_b128 v[32:35], v18 offset:256
    v_mfma_f32_16x16x32_bf16 v[216:219], v[88:91], v[56:59], v[216:219]
    v_mfma_f32_16x16x32_bf16 v[224:227], v[88:91], v[60:63], v[224:227]
    ds_read_b128 v[36:39], v18 offset:512
    s_waitcnt lgkmcnt(3)
    v_mfma_f32_16x16x32_bf16 v[228:231], v[84:87], v[64:67], v[228:231]
    v_mfma_f32_16x16x32_bf16 v[232:235], v[88:91], v[64:67], v[232:235]
    ds_read_b128 v[40:43], v18 offset:768
    v_mfma_f32_16x16x32_bf16 v[236:239], v[84:87], v[68:71], v[236:239]
    ds_read_b128 v[44:47], v18 offset:1024
    v_mfma_f32_16x16x32_bf16 v[240:243], v[88:91], v[68:71], v[240:243]
    ds_read_b128 v[48:51], v18 offset:1280
    v_mfma_f32_16x16x32_bf16 v[244:247], v[84:87], v[72:75], v[244:247]
    v_mfma_f32_16x16x32_bf16 v[248:251], v[88:91], v[72:75], v[248:251]
    s_waitcnt lgkmcnt(3)
    v_mfma_f32_16x16x32_bf16 v[204:207], v[108:111], v[28:31], v[204:207]
    v_mfma_f32_16x16x32_bf16 v[212:215], v[108:111], v[32:35], v[212:215]
    ds_read_b128 v[52:55], v18 offset:6144
    v_mfma_f32_16x16x32_bf16 v[220:223], v[108:111], v[36:39], v[220:223]
    v_mfma_f32_16x16x32_bf16 v[208:211], v[112:115], v[28:31], v[208:211]
    ds_read_b128 v[56:59], v18 offset:6400
    v_mfma_f32_16x16x32_bf16 v[216:219], v[112:115], v[32:35], v[216:219]
    v_mfma_f32_16x16x32_bf16 v[224:227], v[112:115], v[36:39], v[224:227]
    ds_read_b128 v[60:63], v18 offset:6656
    s_waitcnt lgkmcnt(3)
    v_mfma_f32_16x16x32_bf16 v[228:231], v[108:111], v[40:43], v[228:231]
    v_mfma_f32_16x16x32_bf16 v[232:235], v[112:115], v[40:43], v[232:235]
    ds_read_b128 v[64:67], v18 offset:6912
    v_mfma_f32_16x16x32_bf16 v[236:239], v[108:111], v[44:47], v[236:239]
    ds_read_b128 v[68:71], v18 offset:7168
    v_mfma_f32_16x16x32_bf16 v[240:243], v[112:115], v[44:47], v[240:243]
    ds_read_b128 v[72:75], v18 offset:7424
    v_mfma_f32_16x16x32_bf16 v[244:247], v[108:111], v[48:51], v[244:247]
    v_mfma_f32_16x16x32_bf16 v[248:251], v[112:115], v[48:51], v[248:251]
    s_waitcnt lgkmcnt(3)
    v_mfma_f32_16x16x32_bf16 v[204:207], v[116:119], v[52:55], v[204:207]
    s_barrier
    ds_read_b64_tr_b16 v[76:77], v24 offset:0
    v_mfma_f32_16x16x32_bf16 v[212:215], v[116:119], v[56:59], v[212:215]
    ds_read_b128 v[28:31], v18 offset:12288
    v_mfma_f32_16x16x32_bf16 v[220:223], v[116:119], v[60:63], v[220:223]
    ds_read_b64_tr_b16 v[78:79], v24 offset:4096
    v_mfma_f32_16x16x32_bf16 v[208:211], v[120:123], v[52:55], v[208:211]
    ds_read_b128 v[32:35], v18 offset:12544
    v_mfma_f32_16x16x32_bf16 v[216:219], v[120:123], v[56:59], v[216:219]
    ds_read_b64_tr_b16 v[80:81], v25 offset:0
    v_mfma_f32_16x16x32_bf16 v[224:227], v[120:123], v[60:63], v[224:227]
    ds_read_b128 v[36:39], v18 offset:12800
    s_waitcnt lgkmcnt(6)
    v_mfma_f32_16x16x32_bf16 v[228:231], v[116:119], v[64:67], v[228:231]
    ds_read_b64_tr_b16 v[82:83], v25 offset:4096
    v_mfma_f32_16x16x32_bf16 v[232:235], v[120:123], v[64:67], v[232:235]
    ds_read_b128 v[40:43], v18 offset:13056
    v_mfma_f32_16x16x32_bf16 v[236:239], v[116:119], v[68:71], v[236:239]
    ds_read_b128 v[44:47], v18 offset:13312
    v_mfma_f32_16x16x32_bf16 v[240:243], v[120:123], v[68:71], v[240:243]
    ds_read_b128 v[48:51], v18 offset:13568
    v_mfma_f32_16x16x32_bf16 v[244:247], v[116:119], v[72:75], v[244:247]
    v_mfma_f32_16x16x32_bf16 v[248:251], v[120:123], v[72:75], v[248:251]
    s_waitcnt lgkmcnt(3)
    v_mfma_f32_16x16x32_bf16 v[204:207], v[76:79], v[28:31], v[204:207]
    ds_read_b64_tr_b16 v[84:85], v24 offset:8192
    v_mfma_f32_16x16x32_bf16 v[212:215], v[76:79], v[32:35], v[212:215]
    ds_read_b128 v[52:55], v18 offset:18432
    v_mfma_f32_16x16x32_bf16 v[220:223], v[76:79], v[36:39], v[220:223]
    ds_read_b64_tr_b16 v[86:87], v24 offset:12288
    v_mfma_f32_16x16x32_bf16 v[208:211], v[80:83], v[28:31], v[208:211]
    ds_read_b128 v[56:59], v18 offset:18688
    v_mfma_f32_16x16x32_bf16 v[216:219], v[80:83], v[32:35], v[216:219]
    ds_read_b64_tr_b16 v[88:89], v25 offset:8192
    v_mfma_f32_16x16x32_bf16 v[224:227], v[80:83], v[36:39], v[224:227]
    ds_read_b128 v[60:63], v18 offset:18944
    s_waitcnt lgkmcnt(6)
    v_mfma_f32_16x16x32_bf16 v[228:231], v[76:79], v[40:43], v[228:231]
    ds_read_b64_tr_b16 v[90:91], v25 offset:12288
    v_mfma_f32_16x16x32_bf16 v[232:235], v[80:83], v[40:43], v[232:235]
    ds_read_b128 v[64:67], v18 offset:19200
    v_mfma_f32_16x16x32_bf16 v[236:239], v[76:79], v[44:47], v[236:239]
    ds_read_b128 v[68:71], v18 offset:19456
    v_mfma_f32_16x16x32_bf16 v[240:243], v[80:83], v[44:47], v[240:243]
    ds_read_b128 v[72:75], v18 offset:19712
    v_mfma_f32_16x16x32_bf16 v[244:247], v[76:79], v[48:51], v[244:247]
    v_mfma_f32_16x16x32_bf16 v[248:251], v[80:83], v[48:51], v[248:251]
    s_waitcnt lgkmcnt(3)
    v_mfma_f32_16x16x32_bf16 v[204:207], v[84:87], v[52:55], v[204:207]
    s_barrier
    ds_read_b64_tr_b16 v[76:77], v24 offset:16384
    v_mfma_f32_16x16x32_bf16 v[212:215], v[84:87], v[56:59], v[212:215]
    ds_read_b128 v[28:31], v18 offset:24576
    v_mfma_f32_16x16x32_bf16 v[220:223], v[84:87], v[60:63], v[220:223]
    ds_read_b64_tr_b16 v[78:79], v24 offset:20480
    v_mfma_f32_16x16x32_bf16 v[208:211], v[88:91], v[52:55], v[208:211]
    ds_read_b128 v[32:35], v18 offset:24832
    v_mfma_f32_16x16x32_bf16 v[216:219], v[88:91], v[56:59], v[216:219]
    ds_read_b64_tr_b16 v[80:81], v25 offset:16384
    v_mfma_f32_16x16x32_bf16 v[224:227], v[88:91], v[60:63], v[224:227]
    ds_read_b128 v[36:39], v18 offset:25088
    s_waitcnt lgkmcnt(6)
    v_mfma_f32_16x16x32_bf16 v[228:231], v[84:87], v[64:67], v[228:231]
    ds_read_b64_tr_b16 v[82:83], v25 offset:20480
    v_mfma_f32_16x16x32_bf16 v[232:235], v[88:91], v[64:67], v[232:235]
    ds_read_b128 v[40:43], v18 offset:25344
    v_mfma_f32_16x16x32_bf16 v[236:239], v[84:87], v[68:71], v[236:239]
    ds_read_b128 v[44:47], v18 offset:25600
    v_mfma_f32_16x16x32_bf16 v[240:243], v[88:91], v[68:71], v[240:243]
    ds_read_b128 v[48:51], v18 offset:25856
    v_mfma_f32_16x16x32_bf16 v[244:247], v[84:87], v[72:75], v[244:247]
    v_mfma_f32_16x16x32_bf16 v[248:251], v[88:91], v[72:75], v[248:251]
    s_waitcnt lgkmcnt(3)
    v_mfma_f32_16x16x32_bf16 v[204:207], v[76:79], v[28:31], v[204:207]
    ds_read_b64_tr_b16 v[84:85], v24 offset:24576
    v_mfma_f32_16x16x32_bf16 v[212:215], v[76:79], v[32:35], v[212:215]
    ds_read_b128 v[52:55], v18 offset:30720
    v_mfma_f32_16x16x32_bf16 v[220:223], v[76:79], v[36:39], v[220:223]
    ds_read_b64_tr_b16 v[86:87], v24 offset:28672
    v_mfma_f32_16x16x32_bf16 v[208:211], v[80:83], v[28:31], v[208:211]
    ds_read_b128 v[56:59], v18 offset:30976
    v_mfma_f32_16x16x32_bf16 v[216:219], v[80:83], v[32:35], v[216:219]
    ds_read_b64_tr_b16 v[88:89], v25 offset:24576
    v_mfma_f32_16x16x32_bf16 v[224:227], v[80:83], v[36:39], v[224:227]
    ds_read_b128 v[60:63], v18 offset:31232
    s_waitcnt lgkmcnt(6)
    v_mfma_f32_16x16x32_bf16 v[228:231], v[76:79], v[40:43], v[228:231]
    ds_read_b64_tr_b16 v[90:91], v25 offset:28672
    v_mfma_f32_16x16x32_bf16 v[232:235], v[80:83], v[40:43], v[232:235]
    ds_read_b128 v[64:67], v18 offset:31488
    v_mfma_f32_16x16x32_bf16 v[236:239], v[76:79], v[44:47], v[236:239]
    ds_read_b128 v[68:71], v18 offset:31744
    v_mfma_f32_16x16x32_bf16 v[240:243], v[80:83], v[44:47], v[240:243]
    ds_read_b128 v[72:75], v18 offset:32000
    v_mfma_f32_16x16x32_bf16 v[244:247], v[76:79], v[48:51], v[244:247]
    v_mfma_f32_16x16x32_bf16 v[248:251], v[80:83], v[48:51], v[248:251]
    s_waitcnt lgkmcnt(3)
    v_mfma_f32_16x16x32_bf16 v[204:207], v[84:87], v[52:55], v[204:207]
    s_barrier
    ds_read_b64_tr_b16 v[76:77], v24 offset:32768
    v_mfma_f32_16x16x32_bf16 v[212:215], v[84:87], v[56:59], v[212:215]
    ds_read_b128 v[28:31], v18 offset:36864
    v_mfma_f32_16x16x32_bf16 v[220:223], v[84:87], v[60:63], v[220:223]
    ds_read_b64_tr_b16 v[78:79], v24 offset:36864
    v_mfma_f32_16x16x32_bf16 v[208:211], v[88:91], v[52:55], v[208:211]
    ds_read_b128 v[32:35], v18 offset:37120
    v_mfma_f32_16x16x32_bf16 v[216:219], v[88:91], v[56:59], v[216:219]
    ds_read_b64_tr_b16 v[80:81], v25 offset:32768
    v_mfma_f32_16x16x32_bf16 v[224:227], v[88:91], v[60:63], v[224:227]
    ds_read_b128 v[36:39], v18 offset:37376
    s_waitcnt lgkmcnt(6)
    v_mfma_f32_16x16x32_bf16 v[228:231], v[84:87], v[64:67], v[228:231]
    ds_read_b64_tr_b16 v[82:83], v25 offset:36864
    v_mfma_f32_16x16x32_bf16 v[232:235], v[88:91], v[64:67], v[232:235]
    ds_read_b128 v[40:43], v18 offset:37632
    v_mfma_f32_16x16x32_bf16 v[236:239], v[84:87], v[68:71], v[236:239]
    ds_read_b128 v[44:47], v18 offset:37888
    v_mfma_f32_16x16x32_bf16 v[240:243], v[88:91], v[68:71], v[240:243]
    ds_read_b128 v[48:51], v18 offset:38144
    v_mfma_f32_16x16x32_bf16 v[244:247], v[84:87], v[72:75], v[244:247]
    v_mfma_f32_16x16x32_bf16 v[248:251], v[88:91], v[72:75], v[248:251]
    s_waitcnt lgkmcnt(3)
    v_mfma_f32_16x16x32_bf16 v[204:207], v[76:79], v[28:31], v[204:207]
    ds_read_b64_tr_b16 v[84:85], v24 offset:40960
    v_mfma_f32_16x16x32_bf16 v[212:215], v[76:79], v[32:35], v[212:215]
    ds_read_b128 v[52:55], v18 offset:43008
    v_mfma_f32_16x16x32_bf16 v[220:223], v[76:79], v[36:39], v[220:223]
    ds_read_b64_tr_b16 v[86:87], v24 offset:45056
    v_mfma_f32_16x16x32_bf16 v[208:211], v[80:83], v[28:31], v[208:211]
    ds_read_b128 v[56:59], v18 offset:43264
    v_mfma_f32_16x16x32_bf16 v[216:219], v[80:83], v[32:35], v[216:219]
    ds_read_b64_tr_b16 v[88:89], v25 offset:40960
    v_mfma_f32_16x16x32_bf16 v[224:227], v[80:83], v[36:39], v[224:227]
    ds_read_b128 v[60:63], v18 offset:43520
    s_waitcnt lgkmcnt(6)
    v_mfma_f32_16x16x32_bf16 v[228:231], v[76:79], v[40:43], v[228:231]
    ds_read_b64_tr_b16 v[90:91], v25 offset:45056
    v_mfma_f32_16x16x32_bf16 v[232:235], v[80:83], v[40:43], v[232:235]
    ds_read_b128 v[64:67], v18 offset:43776
    v_mfma_f32_16x16x32_bf16 v[236:239], v[76:79], v[44:47], v[236:239]
    ds_read_b128 v[68:71], v18 offset:44032
    v_mfma_f32_16x16x32_bf16 v[240:243], v[80:83], v[44:47], v[240:243]
    ds_read_b128 v[72:75], v18 offset:44288
    v_mfma_f32_16x16x32_bf16 v[244:247], v[76:79], v[48:51], v[244:247]
    v_mfma_f32_16x16x32_bf16 v[248:251], v[80:83], v[48:51], v[248:251]
    s_waitcnt lgkmcnt(3)
    v_mfma_f32_16x16x32_bf16 v[204:207], v[84:87], v[52:55], v[204:207]
    s_barrier
    v_mfma_f32_16x16x32_bf16 v[212:215], v[84:87], v[56:59], v[212:215]
    ds_read_b128 v[28:31], v18 offset:49152
    v_mfma_f32_16x16x32_bf16 v[220:223], v[84:87], v[60:63], v[220:223]
    v_mfma_f32_16x16x32_bf16 v[208:211], v[88:91], v[52:55], v[208:211]
    ds_read_b128 v[32:35], v18 offset:49408
    v_mfma_f32_16x16x32_bf16 v[216:219], v[88:91], v[56:59], v[216:219]
    v_mfma_f32_16x16x32_bf16 v[224:227], v[88:91], v[60:63], v[224:227]
    ds_read_b128 v[36:39], v18 offset:49664
    s_waitcnt lgkmcnt(3)
    v_mfma_f32_16x16x32_bf16 v[228:231], v[84:87], v[64:67], v[228:231]
    v_mfma_f32_16x16x32_bf16 v[232:235], v[88:91], v[64:67], v[232:235]
    ds_read_b128 v[40:43], v18 offset:49920
    v_mfma_f32_16x16x32_bf16 v[236:239], v[84:87], v[68:71], v[236:239]
    ds_read_b128 v[44:47], v18 offset:50176
    v_mfma_f32_16x16x32_bf16 v[240:243], v[88:91], v[68:71], v[240:243]
    ds_read_b128 v[48:51], v18 offset:50432
    v_mfma_f32_16x16x32_bf16 v[244:247], v[84:87], v[72:75], v[244:247]
    v_mfma_f32_16x16x32_bf16 v[248:251], v[88:91], v[72:75], v[248:251]
    s_waitcnt lgkmcnt(3)
    v_mfma_f32_16x16x32_bf16 v[204:207], v[124:127], v[28:31], v[204:207]
    s_branch L_skip_4
    s_nop 0
L_stub_4:
    s_branch L_stub_5
L_skip_4:
    v_mfma_f32_16x16x32_bf16 v[212:215], v[124:127], v[32:35], v[212:215]
    ds_read_b128 v[52:55], v18 offset:55296
    v_mfma_f32_16x16x32_bf16 v[220:223], v[124:127], v[36:39], v[220:223]
    v_mfma_f32_16x16x32_bf16 v[208:211], v[128:131], v[28:31], v[208:211]
    ds_read_b128 v[56:59], v18 offset:55552
    v_mfma_f32_16x16x32_bf16 v[216:219], v[128:131], v[32:35], v[216:219]
    v_mfma_f32_16x16x32_bf16 v[224:227], v[128:131], v[36:39], v[224:227]
    ds_read_b128 v[60:63], v18 offset:55808
    s_waitcnt lgkmcnt(3)
    v_mfma_f32_16x16x32_bf16 v[228:231], v[124:127], v[40:43], v[228:231]
    v_mfma_f32_16x16x32_bf16 v[232:235], v[128:131], v[40:43], v[232:235]
    ds_read_b128 v[64:67], v18 offset:56064
    v_mfma_f32_16x16x32_bf16 v[236:239], v[124:127], v[44:47], v[236:239]
    ds_read_b128 v[68:71], v18 offset:56320
    v_mfma_f32_16x16x32_bf16 v[240:243], v[128:131], v[44:47], v[240:243]
    ds_read_b128 v[72:75], v18 offset:56576
    v_mfma_f32_16x16x32_bf16 v[244:247], v[124:127], v[48:51], v[244:247]
    v_mfma_f32_16x16x32_bf16 v[248:251], v[128:131], v[48:51], v[248:251]
    s_waitcnt lgkmcnt(3)
    v_mfma_f32_16x16x32_bf16 v[204:207], v[132:135], v[52:55], v[204:207]
    s_barrier
    ds_read_b64_tr_b16 v[76:77], v20 offset:0
    v_mfma_f32_16x16x32_bf16 v[212:215], v[132:135], v[56:59], v[212:215]
    ds_read_b128 v[28:31], v18 offset:0
    v_mfma_f32_16x16x32_bf16 v[220:223], v[132:135], v[60:63], v[220:223]
    ds_read_b64_tr_b16 v[78:79], v20 offset:4096
    v_mfma_f32_16x16x32_bf16 v[208:211], v[136:139], v[52:55], v[208:211]
    ds_read_b128 v[32:35], v18 offset:256
    v_mfma_f32_16x16x32_bf16 v[216:219], v[136:139], v[56:59], v[216:219]
    ds_read_b64_tr_b16 v[80:81], v21 offset:0
    v_mfma_f32_16x16x32_bf16 v[224:227], v[136:139], v[60:63], v[224:227]
    ds_read_b128 v[36:39], v18 offset:512
    s_waitcnt lgkmcnt(6)
    v_mfma_f32_16x16x32_bf16 v[228:231], v[132:135], v[64:67], v[228:231]
    ds_read_b64_tr_b16 v[82:83], v21 offset:4096
    v_mfma_f32_16x16x32_bf16 v[232:235], v[136:139], v[64:67], v[232:235]
    ds_read_b128 v[40:43], v18 offset:768
    v_mfma_f32_16x16x32_bf16 v[236:239], v[132:135], v[68:71], v[236:239]
    ds_read_b128 v[44:47], v18 offset:1024
    v_mfma_f32_16x16x32_bf16 v[240:243], v[136:139], v[68:71], v[240:243]
    ds_read_b128 v[48:51], v18 offset:1280
    v_mfma_f32_16x16x32_bf16 v[244:247], v[132:135], v[72:75], v[244:247]
    v_mfma_f32_16x16x32_bf16 v[248:251], v[136:139], v[72:75], v[248:251]
    s_waitcnt lgkmcnt(3)
    v_mfma_f32_16x16x32_bf16 v[204:207], v[76:79], v[28:31], v[204:207]
    ds_read_b64_tr_b16 v[84:85], v20 offset:8192
    v_mfma_f32_16x16x32_bf16 v[212:215], v[76:79], v[32:35], v[212:215]
    ds_read_b128 v[52:55], v18 offset:6144
    v_mfma_f32_16x16x32_bf16 v[220:223], v[76:79], v[36:39], v[220:223]
    ds_read_b64_tr_b16 v[86:87], v20 offset:12288
    v_mfma_f32_16x16x32_bf16 v[208:211], v[80:83], v[28:31], v[208:211]
    ds_read_b128 v[56:59], v18 offset:6400
    v_mfma_f32_16x16x32_bf16 v[216:219], v[80:83], v[32:35], v[216:219]
    ds_read_b64_tr_b16 v[88:89], v21 offset:8192
    v_mfma_f32_16x16x32_bf16 v[224:227], v[80:83], v[36:39], v[224:227]
    ds_read_b128 v[60:63], v18 offset:6656
    s_waitcnt lgkmcnt(6)
    v_mfma_f32_16x16x32_bf16 v[228:231], v[76:79], v[40:43], v[228:231]
    ds_read_b64_tr_b16 v[90:91], v21 offset:12288
    v_mfma_f32_16x16x32_bf16 v[232:235], v[80:83], v[40:43], v[232:235]
    ds_read_b128 v[64:67], v18 offset:6912
    v_mfma_f32_16x16x32_bf16 v[236:239], v[76:79], v[44:47], v[236:239]
    ds_read_b128 v[68:71], v18 offset:7168
    v_mfma_f32_16x16x32_bf16 v[240:243], v[80:83], v[44:47], v[240:243]
    ds_read_b128 v[72:75], v18 offset:7424
    v_mfma_f32_16x16x32_bf16 v[244:247], v[76:79], v[48:51], v[244:247]
    v_mfma_f32_16x16x32_bf16 v[248:251], v[80:83], v[48:51], v[248:251]
    s_waitcnt lgkmcnt(3)
    v_mfma_f32_16x16x32_bf16 v[204:207], v[84:87], v[52:55], v[204:207]
    s_barrier
    ds_read_b64_tr_b16 v[76:77], v20 offset:16384
    v_mfma_f32_16x16x32_bf16 v[212:215], v[84:87], v[56:59], v[212:215]
    ds_read_b128 v[28:31], v18 offset:12288
    v_mfma_f32_16x16x32_bf16 v[220:223], v[84:87], v[60:63], v[220:223]
    ds_read_b64_tr_b16 v[78:79], v20 offset:20480
    v_mfma_f32_16x16x32_bf16 v[208:211], v[88:91], v[52:55], v[208:211]
    ds_read_b128 v[32:35], v18 offset:12544
    v_mfma_f32_16x16x32_bf16 v[216:219], v[88:91], v[56:59], v[216:219]
    ds_read_b64_tr_b16 v[80:81], v21 offset:16384
    v_mfma_f32_16x16x32_bf16 v[224:227], v[88:91], v[60:63], v[224:227]
    ds_read_b128 v[36:39], v18 offset:12800
    s_waitcnt lgkmcnt(6)
    v_mfma_f32_16x16x32_bf16 v[228:231], v[84:87], v[64:67], v[228:231]
    ds_read_b64_tr_b16 v[82:83], v21 offset:20480
    v_mfma_f32_16x16x32_bf16 v[232:235], v[88:91], v[64:67], v[232:235]
    ds_read_b128 v[40:43], v18 offset:13056
    v_mfma_f32_16x16x32_bf16 v[236:239], v[84:87], v[68:71], v[236:239]
    ds_read_b128 v[44:47], v18 offset:13312
    v_mfma_f32_16x16x32_bf16 v[240:243], v[88:91], v[68:71], v[240:243]
    ds_read_b128 v[48:51], v18 offset:13568
    v_mfma_f32_16x16x32_bf16 v[244:247], v[84:87], v[72:75], v[244:247]
    v_mfma_f32_16x16x32_bf16 v[248:251], v[88:91], v[72:75], v[248:251]
    s_waitcnt lgkmcnt(3)
    v_mfma_f32_16x16x32_bf16 v[204:207], v[76:79], v[28:31], v[204:207]
    ds_read_b64_tr_b16 v[84:85], v20 offset:24576
    v_mfma_f32_16x16x32_bf16 v[212:215], v[76:79], v[32:35], v[212:215]
    ds_read_b128 v[52:55], v18 offset:18432
    v_mfma_f32_16x16x32_bf16 v[220:223], v[76:79], v[36:39], v[220:223]
    ds_read_b64_tr_b16 v[86:87], v20 offset:28672
    v_mfma_f32_16x16x32_bf16 v[208:211], v[80:83], v[28:31], v[208:211]
    ds_read_b128 v[56:59], v18 offset:18688
    v_mfma_f32_16x16x32_bf16 v[216:219], v[80:83], v[32:35], v[216:219]
    ds_read_b64_tr_b16 v[88:89], v21 offset:24576
    v_mfma_f32_16x16x32_bf16 v[224:227], v[80:83], v[36:39], v[224:227]
    ds_read_b128 v[60:63], v18 offset:18944
    s_waitcnt lgkmcnt(6)
    v_mfma_f32_16x16x32_bf16 v[228:231], v[76:79], v[40:43], v[228:231]
    ds_read_b64_tr_b16 v[90:91], v21 offset:28672
    v_mfma_f32_16x16x32_bf16 v[232:235], v[80:83], v[40:43], v[232:235]
    ds_read_b128 v[64:67], v18 offset:19200
    v_mfma_f32_16x16x32_bf16 v[236:239], v[76:79], v[44:47], v[236:239]
    ds_read_b128 v[68:71], v18 offset:19456
    v_mfma_f32_16x16x32_bf16 v[240:243], v[80:83], v[44:47], v[240:243]
    ds_read_b128 v[72:75], v18 offset:19712
    v_mfma_f32_16x16x32_bf16 v[244:247], v[76:79], v[48:51], v[244:247]
    v_mfma_f32_16x16x32_bf16 v[248:251], v[80:83], v[48:51], v[248:251]
    s_waitcnt lgkmcnt(3)
    v_mfma_f32_16x16x32_bf16 v[204:207], v[84:87], v[52:55], v[204:207]
    s_barrier
    ds_read_b64_tr_b16 v[76:77], v20 offset:32768
    v_mfma_f32_16x16x32_bf16 v[212:215], v[84:87], v[56:59], v[212:215]
    ds_read_b128 v[28:31], v18 offset:24576
    v_mfma_f32_16x16x32_bf16 v[220:223], v[84:87], v[60:63], v[220:223]
    ds_read_b64_tr_b16 v[78:79], v20 offset:36864
    v_mfma_f32_16x16x32_bf16 v[208:211], v[88:91], v[52:55], v[208:211]
    ds_read_b128 v[32:35], v18 offset:24832
    v_mfma_f32_16x16x32_bf16 v[216:219], v[88:91], v[56:59], v[216:219]
    ds_read_b64_tr_b16 v[80:81], v21 offset:32768
    v_mfma_f32_16x16x32_bf16 v[224:227], v[88:91], v[60:63], v[224:227]
    ds_read_b128 v[36:39], v18 offset:25088
    s_waitcnt lgkmcnt(6)
    v_mfma_f32_16x16x32_bf16 v[228:231], v[84:87], v[64:67], v[228:231]
    ds_read_b64_tr_b16 v[82:83], v21 offset:36864
    v_mfma_f32_16x16x32_bf16 v[232:235], v[88:91], v[64:67], v[232:235]
    ds_read_b128 v[40:43], v18 offset:25344
    v_mfma_f32_16x16x32_bf16 v[236:239], v[84:87], v[68:71], v[236:239]
    ds_read_b128 v[44:47], v18 offset:25600
    v_mfma_f32_16x16x32_bf16 v[240:243], v[88:91], v[68:71], v[240:243]
    ds_read_b128 v[48:51], v18 offset:25856
    v_mfma_f32_16x16x32_bf16 v[244:247], v[84:87], v[72:75], v[244:247]
    v_mfma_f32_16x16x32_bf16 v[248:251], v[88:91], v[72:75], v[248:251]
    s_waitcnt lgkmcnt(3)
    v_mfma_f32_16x16x32_bf16 v[204:207], v[76:79], v[28:31], v[204:207]
    ds_read_b64_tr_b16 v[84:85], v20 offset:40960
    v_mfma_f32_16x16x32_bf16 v[212:215], v[76:79], v[32:35], v[212:215]
    ds_read_b128 v[52:55], v18 offset:30720
    v_mfma_f32_16x16x32_bf16 v[220:223], v[76:79], v[36:39], v[220:223]
    ds_read_b64_tr_b16 v[86:87], v20 offset:45056
    v_mfma_f32_16x16x32_bf16 v[208:211], v[80:83], v[28:31], v[208:211]
    ds_read_b128 v[56:59], v18 offset:30976
    v_mfma_f32_16x16x32_bf16 v[216:219], v[80:83], v[32:35], v[216:219]
    ds_read_b64_tr_b16 v[88:89], v21 offset:40960
    v_mfma_f32_16x16x32_bf16 v[224:227], v[80:83], v[36:39], v[224:227]
    ds_read_b128 v[60:63], v18 offset:31232
    s_waitcnt lgkmcnt(6)
    v_mfma_f32_16x16x32_bf16 v[228:231], v[76:79], v[40:43], v[228:231]
    ds_read_b64_tr_b16 v[90:91], v21 offset:45056
    v_mfma_f32_16x16x32_bf16 v[232:235], v[80:83], v[40:43], v[232:235]
    ds_read_b128 v[64:67], v18 offset:31488
    v_mfma_f32_16x16x32_bf16 v[236:239], v[76:79], v[44:47], v[236:239]
    ds_read_b128 v[68:71], v18 offset:31744
    v_mfma_f32_16x16x32_bf16 v[240:243], v[80:83], v[44:47], v[240:243]
    ds_read_b128 v[72:75], v18 offset:32000
    v_mfma_f32_16x16x32_bf16 v[244:247], v[76:79], v[48:51], v[244:247]
    v_mfma_f32_16x16x32_bf16 v[248:251], v[80:83], v[48:51], v[248:251]
    s_waitcnt lgkmcnt(3)
    v_mfma_f32_16x16x32_bf16 v[204:207], v[84:87], v[52:55], v[204:207]
    s_barrier
    v_mfma_f32_16x16x32_bf16 v[212:215], v[84:87], v[56:59], v[212:215]
    ds_read_b128 v[28:31], v18 offset:36864
    v_mfma_f32_16x16x32_bf16 v[220:223], v[84:87], v[60:63], v[220:223]
    v_mfma_f32_16x16x32_bf16 v[208:211], v[88:91], v[52:55], v[208:211]
    ds_read_b128 v[32:35], v18 offset:37120
    v_mfma_f32_16x16x32_bf16 v[216:219], v[88:91], v[56:59], v[216:219]
    v_mfma_f32_16x16x32_bf16 v[224:227], v[88:91], v[60:63], v[224:227]
    ds_read_b128 v[36:39], v18 offset:37376
    s_waitcnt lgkmcnt(3)
    v_mfma_f32_16x16x32_bf16 v[228:231], v[84:87], v[64:67], v[228:231]
    v_mfma_f32_16x16x32_bf16 v[232:235], v[88:91], v[64:67], v[232:235]
    ds_read_b128 v[40:43], v18 offset:37632
    v_mfma_f32_16x16x32_bf16 v[236:239], v[84:87], v[68:71], v[236:239]
    ds_read_b128 v[44:47], v18 offset:37888
    v_mfma_f32_16x16x32_bf16 v[240:243], v[88:91], v[68:71], v[240:243]
    ds_read_b128 v[48:51], v18 offset:38144
    v_mfma_f32_16x16x32_bf16 v[244:247], v[84:87], v[72:75], v[244:247]
    v_mfma_f32_16x16x32_bf16 v[248:251], v[88:91], v[72:75], v[248:251]
    s_waitcnt lgkmcnt(3)
    v_mfma_f32_16x16x32_bf16 v[204:207], v[140:143], v[28:31], v[204:207]
    v_mfma_f32_16x16x32_bf16 v[212:215], v[140:143], v[32:35], v[212:215]
    ds_read_b128 v[52:55], v18 offset:43008
    v_mfma_f32_16x16x32_bf16 v[220:223], v[140:143], v[36:39], v[220:223]
    v_mfma_f32_16x16x32_bf16 v[208:211], v[144:147], v[28:31], v[208:211]
    ds_read_b128 v[56:59], v18 offset:43264
    v_mfma_f32_16x16x32_bf16 v[216:219], v[144:147], v[32:35], v[216:219]
    v_mfma_f32_16x16x32_bf16 v[224:227], v[144:147], v[36:39], v[224:227]
    ds_read_b128 v[60:63], v18 offset:43520
    s_waitcnt lgkmcnt(3)
    v_mfma_f32_16x16x32_bf16 v[228:231], v[140:143], v[40:43], v[228:231]
    v_mfma_f32_16x16x32_bf16 v[232:235], v[144:147], v[40:43], v[232:235]
    ds_read_b128 v[64:67], v18 offset:43776
    v_mfma_f32_16x16x32_bf16 v[236:239], v[140:143], v[44:47], v[236:239]
    ds_read_b128 v[68:71], v18 offset:44032
    v_mfma_f32_16x16x32_bf16 v[240:243], v[144:147], v[44:47], v[240:243]
    ds_read_b128 v[72:75], v18 offset:44288
    v_mfma_f32_16x16x32_bf16 v[244:247], v[140:143], v[48:51], v[244:247]
    v_mfma_f32_16x16x32_bf16 v[248:251], v[144:147], v[48:51], v[248:251]
    s_waitcnt lgkmcnt(3)
    v_mfma_f32_16x16x32_bf16 v[204:207], v[148:151], v[52:55], v[204:207]
    s_barrier
    ds_read_b64_tr_b16 v[76:77], v24 offset:0
    v_mfma_f32_16x16x32_bf16 v[212:215], v[148:151], v[56:59], v[212:215]
    ds_read_b128 v[28:31], v18 offset:49152
    v_mfma_f32_16x16x32_bf16 v[220:223], v[148:151], v[60:63], v[220:223]
    ds_read_b64_tr_b16 v[78:79], v24 offset:4096
    v_mfma_f32_16x16x32_bf16 v[208:211], v[152:155], v[52:55], v[208:211]
    ds_read_b128 v[32:35], v18 offset:49408
    v_mfma_f32_16x16x32_bf16 v[216:219], v[152:155], v[56:59], v[216:219]
    ds_read_b64_tr_b16 v[80:81], v25 offset:0
    v_mfma_f32_16x16x32_bf16 v[224:227], v[152:155], v[60:63], v[224:227]
    ds_read_b128 v[36:39], v18 offset:49664
    s_waitcnt lgkmcnt(6)
    v_mfma_f32_16x16x32_bf16 v[228:231], v[148:151], v[64:67], v[228:231]
    ds_read_b64_tr_b16 v[82:83], v25 offset:4096
    v_mfma_f32_16x16x32_bf16 v[232:235], v[152:155], v[64:67], v[232:235]
    ds_read_b128 v[40:43], v18 offset:49920
    v_mfma_f32_16x16x32_bf16 v[236:239], v[148:151], v[68:71], v[236:239]
    ds_read_b128 v[44:47], v18 offset:50176
    v_mfma_f32_16x16x32_bf16 v[240:243], v[152:155], v[68:71], v[240:243]
    ds_read_b128 v[48:51], v18 offset:50432
    v_mfma_f32_16x16x32_bf16 v[244:247], v[148:151], v[72:75], v[244:247]
    v_mfma_f32_16x16x32_bf16 v[248:251], v[152:155], v[72:75], v[248:251]
    s_waitcnt lgkmcnt(3)
    v_mfma_f32_16x16x32_bf16 v[204:207], v[76:79], v[28:31], v[204:207]
    ds_read_b64_tr_b16 v[84:85], v24 offset:8192
    v_mfma_f32_16x16x32_bf16 v[212:215], v[76:79], v[32:35], v[212:215]
    ds_read_b128 v[52:55], v18 offset:55296
    v_mfma_f32_16x16x32_bf16 v[220:223], v[76:79], v[36:39], v[220:223]
    ds_read_b64_tr_b16 v[86:87], v24 offset:12288
    v_mfma_f32_16x16x32_bf16 v[208:211], v[80:83], v[28:31], v[208:211]
    ds_read_b128 v[56:59], v18 offset:55552
    v_mfma_f32_16x16x32_bf16 v[216:219], v[80:83], v[32:35], v[216:219]
    ds_read_b64_tr_b16 v[88:89], v25 offset:8192
    v_mfma_f32_16x16x32_bf16 v[224:227], v[80:83], v[36:39], v[224:227]
    ds_read_b128 v[60:63], v18 offset:55808
    s_waitcnt lgkmcnt(6)
    v_mfma_f32_16x16x32_bf16 v[228:231], v[76:79], v[40:43], v[228:231]
    ds_read_b64_tr_b16 v[90:91], v25 offset:12288
    v_mfma_f32_16x16x32_bf16 v[232:235], v[80:83], v[40:43], v[232:235]
    ds_read_b128 v[64:67], v18 offset:56064
    v_mfma_f32_16x16x32_bf16 v[236:239], v[76:79], v[44:47], v[236:239]
    ds_read_b128 v[68:71], v18 offset:56320
    v_mfma_f32_16x16x32_bf16 v[240:243], v[80:83], v[44:47], v[240:243]
    ds_read_b128 v[72:75], v18 offset:56576
    v_mfma_f32_16x16x32_bf16 v[244:247], v[76:79], v[48:51], v[244:247]
    v_mfma_f32_16x16x32_bf16 v[248:251], v[80:83], v[48:51], v[248:251]
    s_waitcnt lgkmcnt(3)
    v_mfma_f32_16x16x32_bf16 v[204:207], v[84:87], v[52:55], v[204:207]
    s_barrier
    ds_read_b64_tr_b16 v[76:77], v24 offset:16384
    v_mfma_f32_16x16x32_bf16 v[212:215], v[84:87], v[56:59], v[212:215]
    ds_read_b128 v[28:31], v18 offset:0
    v_mfma_f32_16x16x32_bf16 v[220:223], v[84:87], v[60:63], v[220:223]
    ds_read_b64_tr_b16 v[78:79], v24 offset:20480
    v_mfma_f32_16x16x32_bf16 v[208:211], v[88:91], v[52:55], v[208:211]
    ds_read_b128 v[32:35], v18 offset:256
    v_mfma_f32_16x16x32_bf16 v[216:219], v[88:91], v[56:59], v[216:219]
    ds_read_b64_tr_b16 v[80:81], v25 offset:16384
    v_mfma_f32_16x16x32_bf16 v[224:227], v[88:91], v[60:63], v[224:227]
    ds_read_b128 v[36:39], v18 offset:512
    s_waitcnt lgkmcnt(6)
    v_mfma_f32_16x16x32_bf16 v[228:231], v[84:87], v[64:67], v[228:231]
    ds_read_b64_tr_b16 v[82:83], v25 offset:20480
    v_mfma_f32_16x16x32_bf16 v[232:235], v[88:91], v[64:67], v[232:235]
    ds_read_b128 v[40:43], v18 offset:768
    v_mfma_f32_16x16x32_bf16 v[236:239], v[84:87], v[68:71], v[236:239]
    ds_read_b128 v[44:47], v18 offset:1024
    v_mfma_f32_16x16x32_bf16 v[240:243], v[88:91], v[68:71], v[240:243]
    ds_read_b128 v[48:51], v18 offset:1280
    v_mfma_f32_16x16x32_bf16 v[244:247], v[84:87], v[72:75], v[244:247]
    v_mfma_f32_16x16x32_bf16 v[248:251], v[88:91], v[72:75], v[248:251]
    s_waitcnt lgkmcnt(3)
    v_mfma_f32_16x16x32_bf16 v[204:207], v[76:79], v[28:31], v[204:207]
    ds_read_b64_tr_b16 v[84:85], v24 offset:24576
    v_mfma_f32_16x16x32_bf16 v[212:215], v[76:79], v[32:35], v[212:215]
    ds_read_b128 v[52:55], v18 offset:6144
    v_mfma_f32_16x16x32_bf16 v[220:223], v[76:79], v[36:39], v[220:223]
    ds_read_b64_tr_b16 v[86:87], v24 offset:28672
    v_mfma_f32_16x16x32_bf16 v[208:211], v[80:83], v[28:31], v[208:211]
    ds_read_b128 v[56:59], v18 offset:6400
    v_mfma_f32_16x16x32_bf16 v[216:219], v[80:83], v[32:35], v[216:219]
    ds_read_b64_tr_b16 v[88:89], v25 offset:24576
    v_mfma_f32_16x16x32_bf16 v[224:227], v[80:83], v[36:39], v[224:227]
    ds_read_b128 v[60:63], v18 offset:6656
    s_waitcnt lgkmcnt(6)
    v_mfma_f32_16x16x32_bf16 v[228:231], v[76:79], v[40:43], v[228:231]
    ds_read_b64_tr_b16 v[90:91], v25 offset:28672
    v_mfma_f32_16x16x32_bf16 v[232:235], v[80:83], v[40:43], v[232:235]
    ds_read_b128 v[64:67], v18 offset:6912
    v_mfma_f32_16x16x32_bf16 v[236:239], v[76:79], v[44:47], v[236:239]
    ds_read_b128 v[68:71], v18 offset:7168
    v_mfma_f32_16x16x32_bf16 v[240:243], v[80:83], v[44:47], v[240:243]
    ds_read_b128 v[72:75], v18 offset:7424
    v_mfma_f32_16x16x32_bf16 v[244:247], v[76:79], v[48:51], v[244:247]
    v_mfma_f32_16x16x32_bf16 v[248:251], v[80:83], v[48:51], v[248:251]
    s_waitcnt lgkmcnt(3)
    v_mfma_f32_16x16x32_bf16 v[204:207], v[84:87], v[52:55], v[204:207]
    s_barrier
    ds_read_b64_tr_b16 v[76:77], v24 offset:32768
    v_mfma_f32_16x16x32_bf16 v[212:215], v[84:87], v[56:59], v[212:215]
    ds_read_b128 v[28:31], v18 offset:12288
    v_mfma_f32_16x16x32_bf16 v[220:223], v[84:87], v[60:63], v[220:223]
    ds_read_b64_tr_b16 v[78:79], v24 offset:36864
    v_mfma_f32_16x16x32_bf16 v[208:211], v[88:91], v[52:55], v[208:211]
    ds_read_b128 v[32:35], v18 offset:12544
    v_mfma_f32_16x16x32_bf16 v[216:219], v[88:91], v[56:59], v[216:219]
    ds_read_b64_tr_b16 v[80:81], v25 offset:32768
    v_mfma_f32_16x16x32_bf16 v[224:227], v[88:91], v[60:63], v[224:227]
    ds_read_b128 v[36:39], v18 offset:12800
    s_waitcnt lgkmcnt(6)
    v_mfma_f32_16x16x32_bf16 v[228:231], v[84:87], v[64:67], v[228:231]
    ds_read_b64_tr_b16 v[82:83], v25 offset:36864
    v_mfma_f32_16x16x32_bf16 v[232:235], v[88:91], v[64:67], v[232:235]
    ds_read_b128 v[40:43], v18 offset:13056
    v_mfma_f32_16x16x32_bf16 v[236:239], v[84:87], v[68:71], v[236:239]
    ds_read_b128 v[44:47], v18 offset:13312
    v_mfma_f32_16x16x32_bf16 v[240:243], v[88:91], v[68:71], v[240:243]
    ds_read_b128 v[48:51], v18 offset:13568
    v_mfma_f32_16x16x32_bf16 v[244:247], v[84:87], v[72:75], v[244:247]
    v_mfma_f32_16x16x32_bf16 v[248:251], v[88:91], v[72:75], v[248:251]
    s_waitcnt lgkmcnt(3)
    v_mfma_f32_16x16x32_bf16 v[204:207], v[76:79], v[28:31], v[204:207]
    ds_read_b64_tr_b16 v[84:85], v24 offset:40960
    v_mfma_f32_16x16x32_bf16 v[212:215], v[76:79], v[32:35], v[212:215]
    ds_read_b128 v[52:55], v18 offset:18432
    v_mfma_f32_16x16x32_bf16 v[220:223], v[76:79], v[36:39], v[220:223]
    ds_read_b64_tr_b16 v[86:87], v24 offset:45056
    v_mfma_f32_16x16x32_bf16 v[208:211], v[80:83], v[28:31], v[208:211]
    ds_read_b128 v[56:59], v18 offset:18688
    v_mfma_f32_16x16x32_bf16 v[216:219], v[80:83], v[32:35], v[216:219]
    ds_read_b64_tr_b16 v[88:89], v25 offset:40960
    v_mfma_f32_16x16x32_bf16 v[224:227], v[80:83], v[36:39], v[224:227]
    ds_read_b128 v[60:63], v18 offset:18944
    s_waitcnt lgkmcnt(6)
    v_mfma_f32_16x16x32_bf16 v[228:231], v[76:79], v[40:43], v[228:231]
    ds_read_b64_tr_b16 v[90:91], v25 offset:45056
    v_mfma_f32_16x16x32_bf16 v[232:235], v[80:83], v[40:43], v[232:235]
    ds_read_b128 v[64:67], v18 offset:19200
    v_mfma_f32_16x16x32_bf16 v[236:239], v[76:79], v[44:47], v[236:239]
    ds_read_b128 v[68:71], v18 offset:19456
    v_mfma_f32_16x16x32_bf16 v[240:243], v[80:83], v[44:47], v[240:243]
    ds_read_b128 v[72:75], v18 offset:19712
    v_mfma_f32_16x16x32_bf16 v[244:247], v[76:79], v[48:51], v[244:247]
    v_mfma_f32_16x16x32_bf16 v[248:251], v[80:83], v[48:51], v[248:251]
    s_waitcnt lgkmcnt(3)
    v_mfma_f32_16x16x32_bf16 v[204:207], v[84:87], v[52:55], v[204:207]
    s_barrier
    v_mfma_f32_16x16x32_bf16 v[212:215], v[84:87], v[56:59], v[212:215]
    ds_read_b128 v[28:31], v18 offset:24576
    v_mfma_f32_16x16x32_bf16 v[220:223], v[84:87], v[60:63], v[220:223]
    v_mfma_f32_16x16x32_bf16 v[208:211], v[88:91], v[52:55], v[208:211]
    ds_read_b128 v[32:35], v18 offset:24832
    v_mfma_f32_16x16x32_bf16 v[216:219], v[88:91], v[56:59], v[216:219]
    v_mfma_f32_16x16x32_bf16 v[224:227], v[88:91], v[60:63], v[224:227]
    ds_read_b128 v[36:39], v18 offset:25088
    s_waitcnt lgkmcnt(3)
    v_mfma_f32_16x16x32_bf16 v[228:231], v[84:87], v[64:67], v[228:231]
    v_mfma_f32_16x16x32_bf16 v[232:235], v[88:91], v[64:67], v[232:235]
    ds_read_b128 v[40:43], v18 offset:25344
    v_mfma_f32_16x16x32_bf16 v[236:239], v[84:87], v[68:71], v[236:239]
    ds_read_b128 v[44:47], v18 offset:25600
    v_mfma_f32_16x16x32_bf16 v[240:243], v[88:91], v[68:71], v[240:243]
    ds_read_b128 v[48:51], v18 offset:25856
    v_mfma_f32_16x16x32_bf16 v[244:247], v[84:87], v[72:75], v[244:247]
    v_mfma_f32_16x16x32_bf16 v[248:251], v[88:91], v[72:75], v[248:251]
    s_waitcnt lgkmcnt(3)
    v_mfma_f32_16x16x32_bf16 v[204:207], v[156:159], v[28:31], v[204:207]
    v_mfma_f32_16x16x32_bf16 v[212:215], v[156:159], v[32:35], v[212:215]
    ds_read_b128 v[52:55], v18 offset:30720
    v_mfma_f32_16x16x32_bf16 v[220:223], v[156:159], v[36:39], v[220:223]
    v_mfma_f32_16x16x32_bf16 v[208:211], v[160:163], v[28:31], v[208:211]
    ds_read_b128 v[56:59], v18 offset:30976
    v_mfma_f32_16x16x32_bf16 v[216:219], v[160:163], v[32:35], v[216:219]
    v_mfma_f32_16x16x32_bf16 v[224:227], v[160:163], v[36:39], v[224:227]
    ds_read_b128 v[60:63], v18 offset:31232
    s_waitcnt lgkmcnt(3)
    v_mfma_f32_16x16x32_bf16 v[228:231], v[156:159], v[40:43], v[228:231]
    v_mfma_f32_16x16x32_bf16 v[232:235], v[160:163], v[40:43], v[232:235]
    ds_read_b128 v[64:67], v18 offset:31488
    v_mfma_f32_16x16x32_bf16 v[236:239], v[156:159], v[44:47], v[236:239]
    ds_read_b128 v[68:71], v18 offset:31744
    v_mfma_f32_16x16x32_bf16 v[240:243], v[160:163], v[44:47], v[240:243]
    ds_read_b128 v[72:75], v18 offset:32000
    v_mfma_f32_16x16x32_bf16 v[244:247], v[156:159], v[48:51], v[244:247]
    v_mfma_f32_16x16x32_bf16 v[248:251], v[160:163], v[48:51], v[248:251]
    s_waitcnt lgkmcnt(3)
    v_mfma_f32_16x16x32_bf16 v[204:207], v[164:167], v[52:55], v[204:207]
    s_barrier
    ds_read_b64_tr_b16 v[76:77], v20 offset:0
    v_mfma_f32_16x16x32_bf16 v[212:215], v[164:167], v[56:59], v[212:215]
    ds_read_b128 v[28:31], v18 offset:36864
    v_mfma_f32_16x16x32_bf16 v[220:223], v[164:167], v[60:63], v[220:223]
    ds_read_b64_tr_b16 v[78:79], v20 offset:4096
    v_mfma_f32_16x16x32_bf16 v[208:211], v[168:171], v[52:55], v[208:211]
    ds_read_b128 v[32:35], v18 offset:37120
    v_mfma_f32_16x16x32_bf16 v[216:219], v[168:171], v[56:59], v[216:219]
    ds_read_b64_tr_b16 v[80:81], v21 offset:0
    v_mfma_f32_16x16x32_bf16 v[224:227], v[168:171], v[60:63], v[224:227]
    ds_read_b128 v[36:39], v18 offset:37376
    s_waitcnt lgkmcnt(6)
    v_mfma_f32_16x16x32_bf16 v[228:231], v[164:167], v[64:67], v[228:231]
    ds_read_b64_tr_b16 v[82:83], v21 offset:4096
    v_mfma_f32_16x16x32_bf16 v[232:235], v[168:171], v[64:67], v[232:235]
    ds_read_b128 v[40:43], v18 offset:37632
    v_mfma_f32_16x16x32_bf16 v[236:239], v[164:167], v[68:71], v[236:239]
    ds_read_b128 v[44:47], v18 offset:37888
    v_mfma_f32_16x16x32_bf16 v[240:243], v[168:171], v[68:71], v[240:243]
    ds_read_b128 v[48:51], v18 offset:38144
    v_mfma_f32_16x16x32_bf16 v[244:247], v[164:167], v[72:75], v[244:247]
    v_mfma_f32_16x16x32_bf16 v[248:251], v[168:171], v[72:75], v[248:251]
    s_waitcnt lgkmcnt(3)
    v_mfma_f32_16x16x32_bf16 v[204:207], v[76:79], v[28:31], v[204:207]
    ds_read_b64_tr_b16 v[84:85], v20 offset:8192
    v_mfma_f32_16x16x32_bf16 v[212:215], v[76:79], v[32:35], v[212:215]
    ds_read_b128 v[52:55], v18 offset:43008
    v_mfma_f32_16x16x32_bf16 v[220:223], v[76:79], v[36:39], v[220:223]
    ds_read_b64_tr_b16 v[86:87], v20 offset:12288
    v_mfma_f32_16x16x32_bf16 v[208:211], v[80:83], v[28:31], v[208:211]
    ds_read_b128 v[56:59], v18 offset:43264
    v_mfma_f32_16x16x32_bf16 v[216:219], v[80:83], v[32:35], v[216:219]
    ds_read_b64_tr_b16 v[88:89], v21 offset:8192
    v_mfma_f32_16x16x32_bf16 v[224:227], v[80:83], v[36:39], v[224:227]
    ds_read_b128 v[60:63], v18 offset:43520
    s_waitcnt lgkmcnt(6)
    v_mfma_f32_16x16x32_bf16 v[228:231], v[76:79], v[40:43], v[228:231]
    ds_read_b64_tr_b16 v[90:91], v21 offset:12288
    v_mfma_f32_16x16x32_bf16 v[232:235], v[80:83], v[40:43], v[232:235]
    ds_read_b128 v[64:67], v18 offset:43776
    v_mfma_f32_16x16x32_bf16 v[236:239], v[76:79], v[44:47], v[236:239]
    ds_read_b128 v[68:71], v18 offset:44032
    v_mfma_f32_16x16x32_bf16 v[240:243], v[80:83], v[44:47], v[240:243]
    ds_read_b128 v[72:75], v18 offset:44288
    v_mfma_f32_16x16x32_bf16 v[244:247], v[76:79], v[48:51], v[244:247]
    v_mfma_f32_16x16x32_bf16 v[248:251], v[80:83], v[48:51], v[248:251]
    s_waitcnt lgkmcnt(3)
    v_mfma_f32_16x16x32_bf16 v[204:207], v[84:87], v[52:55], v[204:207]
    s_barrier
    ds_read_b64_tr_b16 v[76:77], v20 offset:16384
    v_mfma_f32_16x16x32_bf16 v[212:215], v[84:87], v[56:59], v[212:215]
    ds_read_b128 v[28:31], v18 offset:49152
    v_mfma_f32_16x16x32_bf16 v[220:223], v[84:87], v[60:63], v[220:223]
    ds_read_b64_tr_b16 v[78:79], v20 offset:20480
    v_mfma_f32_16x16x32_bf16 v[208:211], v[88:91], v[52:55], v[208:211]
    ds_read_b128 v[32:35], v18 offset:49408
    v_mfma_f32_16x16x32_bf16 v[216:219], v[88:91], v[56:59], v[216:219]
    ds_read_b64_tr_b16 v[80:81], v21 offset:16384
    v_mfma_f32_16x16x32_bf16 v[224:227], v[88:91], v[60:63], v[224:227]
    ds_read_b128 v[36:39], v18 offset:49664
    s_waitcnt lgkmcnt(6)
    v_mfma_f32_16x16x32_bf16 v[228:231], v[84:87], v[64:67], v[228:231]
    ds_read_b64_tr_b16 v[82:83], v21 offset:20480
    v_mfma_f32_16x16x32_bf16 v[232:235], v[88:91], v[64:67], v[232:235]
    ds_read_b128 v[40:43], v18 offset:49920
    v_mfma_f32_16x16x32_bf16 v[236:239], v[84:87], v[68:71], v[236:239]
    ds_read_b128 v[44:47], v18 offset:50176
    v_mfma_f32_16x16x32_bf16 v[240:243], v[88:91], v[68:71], v[240:243]
    ds_read_b128 v[48:51], v18 offset:50432
    v_mfma_f32_16x16x32_bf16 v[244:247], v[84:87], v[72:75], v[244:247]
    v_mfma_f32_16x16x32_bf16 v[248:251], v[88:91], v[72:75], v[248:251]
    s_waitcnt lgkmcnt(3)
    v_mfma_f32_16x16x32_bf16 v[204:207], v[76:79], v[28:31], v[204:207]
    ds_read_b64_tr_b16 v[84:85], v20 offset:24576
    v_mfma_f32_16x16x32_bf16 v[212:215], v[76:79], v[32:35], v[212:215]
    ds_read_b128 v[52:55], v18 offset:55296
    v_mfma_f32_16x16x32_bf16 v[220:223], v[76:79], v[36:39], v[220:223]
    ds_read_b64_tr_b16 v[86:87], v20 offset:28672
    v_mfma_f32_16x16x32_bf16 v[208:211], v[80:83], v[28:31], v[208:211]
    ds_read_b128 v[56:59], v18 offset:55552
    v_mfma_f32_16x16x32_bf16 v[216:219], v[80:83], v[32:35], v[216:219]
    ds_read_b64_tr_b16 v[88:89], v21 offset:24576
    v_mfma_f32_16x16x32_bf16 v[224:227], v[80:83], v[36:39], v[224:227]
    ds_read_b128 v[60:63], v18 offset:55808
    s_waitcnt lgkmcnt(6)
    v_mfma_f32_16x16x32_bf16 v[228:231], v[76:79], v[40:43], v[228:231]
    ds_read_b64_tr_b16 v[90:91], v21 offset:28672
    v_mfma_f32_16x16x32_bf16 v[232:235], v[80:83], v[40:43], v[232:235]
    ds_read_b128 v[64:67], v18 offset:56064
    v_mfma_f32_16x16x32_bf16 v[236:239], v[76:79], v[44:47], v[236:239]
    ds_read_b128 v[68:71], v18 offset:56320
    v_mfma_f32_16x16x32_bf16 v[240:243], v[80:83], v[44:47], v[240:243]
    ds_read_b128 v[72:75], v18 offset:56576
    v_mfma_f32_16x16x32_bf16 v[244:247], v[76:79], v[48:51], v[244:247]
    v_mfma_f32_16x16x32_bf16 v[248:251], v[80:83], v[48:51], v[248:251]
    s_waitcnt lgkmcnt(3)
    v_mfma_f32_16x16x32_bf16 v[204:207], v[84:87], v[52:55], v[204:207]
    s_barrier
    ds_read_b64_tr_b16 v[76:77], v20 offset:32768
    v_mfma_f32_16x16x32_bf16 v[212:215], v[84:87], v[56:59], v[212:215]
    ds_read_b128 v[28:31], v18 offset:0
    v_mfma_f32_16x16x32_bf16 v[220:223], v[84:87], v[60:63], v[220:223]
    ds_read_b64_tr_b16 v[78:79], v20 offset:36864
    v_mfma_f32_16x16x32_bf16 v[208:211], v[88:91], v[52:55], v[208:211]
    ds_read_b128 v[32:35], v18 offset:256
    v_mfma_f32_16x16x32_bf16 v[216:219], v[88:91], v[56:59], v[216:219]
    ds_read_b64_tr_b16 v[80:81], v21 offset:32768
    v_mfma_f32_16x16x32_bf16 v[224:227], v[88:91], v[60:63], v[224:227]
    ds_read_b128 v[36:39], v18 offset:512
    s_waitcnt lgkmcnt(6)
    v_mfma_f32_16x16x32_bf16 v[228:231], v[84:87], v[64:67], v[228:231]
    ds_read_b64_tr_b16 v[82:83], v21 offset:36864
    v_mfma_f32_16x16x32_bf16 v[232:235], v[88:91], v[64:67], v[232:235]
    ds_read_b128 v[40:43], v18 offset:768
    v_mfma_f32_16x16x32_bf16 v[236:239], v[84:87], v[68:71], v[236:239]
    ds_read_b128 v[44:47], v18 offset:1024
    v_mfma_f32_16x16x32_bf16 v[240:243], v[88:91], v[68:71], v[240:243]
    ds_read_b128 v[48:51], v18 offset:1280
    v_mfma_f32_16x16x32_bf16 v[244:247], v[84:87], v[72:75], v[244:247]
    v_mfma_f32_16x16x32_bf16 v[248:251], v[88:91], v[72:75], v[248:251]
    s_waitcnt lgkmcnt(3)
    v_mfma_f32_16x16x32_bf16 v[204:207], v[76:79], v[28:31], v[204:207]
    ds_read_b64_tr_b16 v[84:85], v20 offset:40960
    v_mfma_f32_16x16x32_bf16 v[212:215], v[76:79], v[32:35], v[212:215]
    ds_read_b128 v[52:55], v18 offset:6144
    v_mfma_f32_16x16x32_bf16 v[220:223], v[76:79], v[36:39], v[220:223]
    ds_read_b64_tr_b16 v[86:87], v20 offset:45056
    v_mfma_f32_16x16x32_bf16 v[208:211], v[80:83], v[28:31], v[208:211]
    ds_read_b128 v[56:59], v18 offset:6400
    v_mfma_f32_16x16x32_bf16 v[216:219], v[80:83], v[32:35], v[216:219]
    ds_read_b64_tr_b16 v[88:89], v21 offset:40960
    v_mfma_f32_16x16x32_bf16 v[224:227], v[80:83], v[36:39], v[224:227]
    ds_read_b128 v[60:63], v18 offset:6656
    s_waitcnt lgkmcnt(6)
    v_mfma_f32_16x16x32_bf16 v[228:231], v[76:79], v[40:43], v[228:231]
    ds_read_b64_tr_b16 v[90:91], v21 offset:45056
    v_mfma_f32_16x16x32_bf16 v[232:235], v[80:83], v[40:43], v[232:235]
    ds_read_b128 v[64:67], v18 offset:6912
    v_mfma_f32_16x16x32_bf16 v[236:239], v[76:79], v[44:47], v[236:239]
    ds_read_b128 v[68:71], v18 offset:7168
    v_mfma_f32_16x16x32_bf16 v[240:243], v[80:83], v[44:47], v[240:243]
    ds_read_b128 v[72:75], v18 offset:7424
    s_branch L_skip_5
L_stub_5:
    s_branch L_stub_6
L_skip_5:
    v_mfma_f32_16x16x32_bf16 v[244:247], v[76:79], v[48:51], v[244:247]
    v_mfma_f32_16x16x32_bf16 v[248:251], v[80:83], v[48:51], v[248:251]
    s_waitcnt lgkmcnt(3)
    v_mfma_f32_16x16x32_bf16 v[204:207], v[84:87], v[52:55], v[204:207]
    s_barrier
    v_mfma_f32_16x16x32_bf16 v[212:215], v[84:87], v[56:59], v[212:215]
    ds_read_b128 v[28:31], v18 offset:12288
    v_mfma_f32_16x16x32_bf16 v[220:223], v[84:87], v[60:63], v[220:223]
    v_mfma_f32_16x16x32_bf16 v[208:211], v[88:91], v[52:55], v[208:211]
    ds_read_b128 v[32:35], v18 offset:12544
    v_mfma_f32_16x16x32_bf16 v[216:219], v[88:91], v[56:59], v[216:219]
    v_mfma_f32_16x16x32_bf16 v[224:227], v[88:91], v[60:63], v[224:227]
    ds_read_b128 v[36:39], v18 offset:12800
    s_waitcnt lgkmcnt(3)
    v_mfma_f32_16x16x32_bf16 v[228:231], v[84:87], v[64:67], v[228:231]
    v_mfma_f32_16x16x32_bf16 v[232:235], v[88:91], v[64:67], v[232:235]
    ds_read_b128 v[40:43], v18 offset:13056
    v_mfma_f32_16x16x32_bf16 v[236:239], v[84:87], v[68:71], v[236:239]
    ds_read_b128 v[44:47], v18 offset:13312
    v_mfma_f32_16x16x32_bf16 v[240:243], v[88:91], v[68:71], v[240:243]
    ds_read_b128 v[48:51], v18 offset:13568
    v_mfma_f32_16x16x32_bf16 v[244:247], v[84:87], v[72:75], v[244:247]
    v_mfma_f32_16x16x32_bf16 v[248:251], v[88:91], v[72:75], v[248:251]
    s_waitcnt lgkmcnt(3)
    v_mfma_f32_16x16x32_bf16 v[204:207], v[172:175], v[28:31], v[204:207]
    v_mfma_f32_16x16x32_bf16 v[212:215], v[172:175], v[32:35], v[212:215]
    ds_read_b128 v[52:55], v18 offset:18432
    v_mfma_f32_16x16x32_bf16 v[220:223], v[172:175], v[36:39], v[220:223]
    v_mfma_f32_16x16x32_bf16 v[208:211], v[176:179], v[28:31], v[208:211]
    ds_read_b128 v[56:59], v18 offset:18688
    v_mfma_f32_16x16x32_bf16 v[216:219], v[176:179], v[32:35], v[216:219]
    v_mfma_f32_16x16x32_bf16 v[224:227], v[176:179], v[36:39], v[224:227]
    ds_read_b128 v[60:63], v18 offset:18944
    s_waitcnt lgkmcnt(3)
    v_mfma_f32_16x16x32_bf16 v[228:231], v[172:175], v[40:43], v[228:231]
    v_mfma_f32_16x16x32_bf16 v[232:235], v[176:179], v[40:43], v[232:235]
    ds_read_b128 v[64:67], v18 offset:19200
    v_mfma_f32_16x16x32_bf16 v[236:239], v[172:175], v[44:47], v[236:239]
    ds_read_b128 v[68:71], v18 offset:19456
    v_mfma_f32_16x16x32_bf16 v[240:243], v[176:179], v[44:47], v[240:243]
    ds_read_b128 v[72:75], v18 offset:19712
    v_mfma_f32_16x16x32_bf16 v[244:247], v[172:175], v[48:51], v[244:247]
    v_mfma_f32_16x16x32_bf16 v[248:251], v[176:179], v[48:51], v[248:251]
    s_waitcnt lgkmcnt(3)
    v_mfma_f32_16x16x32_bf16 v[204:207], v[180:183], v[52:55], v[204:207]
    s_barrier
    ds_read_b64_tr_b16 v[76:77], v24 offset:0
    v_mfma_f32_16x16x32_bf16 v[212:215], v[180:183], v[56:59], v[212:215]
    ds_read_b128 v[28:31], v18 offset:24576
    v_mfma_f32_16x16x32_bf16 v[220:223], v[180:183], v[60:63], v[220:223]
    ds_read_b64_tr_b16 v[78:79], v24 offset:4096
    v_mfma_f32_16x16x32_bf16 v[208:211], v[184:187], v[52:55], v[208:211]
    ds_read_b128 v[32:35], v18 offset:24832
    v_mfma_f32_16x16x32_bf16 v[216:219], v[184:187], v[56:59], v[216:219]
    ds_read_b64_tr_b16 v[80:81], v25 offset:0
    v_mfma_f32_16x16x32_bf16 v[224:227], v[184:187], v[60:63], v[224:227]
    ds_read_b128 v[36:39], v18 offset:25088
    s_waitcnt lgkmcnt(6)
    v_mfma_f32_16x16x32_bf16 v[228:231], v[180:183], v[64:67], v[228:231]
    ds_read_b64_tr_b16 v[82:83], v25 offset:4096
    v_mfma_f32_16x16x32_bf16 v[232:235], v[184:187], v[64:67], v[232:235]
    ds_read_b128 v[40:43], v18 offset:25344
    v_mfma_f32_16x16x32_bf16 v[236:239], v[180:183], v[68:71], v[236:239]
    ds_read_b128 v[44:47], v18 offset:25600
    v_mfma_f32_16x16x32_bf16 v[240:243], v[184:187], v[68:71], v[240:243]
    ds_read_b128 v[48:51], v18 offset:25856
    v_mfma_f32_16x16x32_bf16 v[244:247], v[180:183], v[72:75], v[244:247]
    v_mfma_f32_16x16x32_bf16 v[248:251], v[184:187], v[72:75], v[248:251]
    s_waitcnt lgkmcnt(3)
    v_mfma_f32_16x16x32_bf16 v[204:207], v[76:79], v[28:31], v[204:207]
    ds_read_b64_tr_b16 v[84:85], v24 offset:8192
    v_mfma_f32_16x16x32_bf16 v[212:215], v[76:79], v[32:35], v[212:215]
    ds_read_b128 v[52:55], v18 offset:30720
    v_mfma_f32_16x16x32_bf16 v[220:223], v[76:79], v[36:39], v[220:223]
    ds_read_b64_tr_b16 v[86:87], v24 offset:12288
    v_mfma_f32_16x16x32_bf16 v[208:211], v[80:83], v[28:31], v[208:211]
    ds_read_b128 v[56:59], v18 offset:30976
    v_mfma_f32_16x16x32_bf16 v[216:219], v[80:83], v[32:35], v[216:219]
    ds_read_b64_tr_b16 v[88:89], v25 offset:8192
    v_mfma_f32_16x16x32_bf16 v[224:227], v[80:83], v[36:39], v[224:227]
    ds_read_b128 v[60:63], v18 offset:31232
    s_waitcnt lgkmcnt(6)
    v_mfma_f32_16x16x32_bf16 v[228:231], v[76:79], v[40:43], v[228:231]
    ds_read_b64_tr_b16 v[90:91], v25 offset:12288
    v_mfma_f32_16x16x32_bf16 v[232:235], v[80:83], v[40:43], v[232:235]
    ds_read_b128 v[64:67], v18 offset:31488
    v_mfma_f32_16x16x32_bf16 v[236:239], v[76:79], v[44:47], v[236:239]
    ds_read_b128 v[68:71], v18 offset:31744
    v_mfma_f32_16x16x32_bf16 v[240:243], v[80:83], v[44:47], v[240:243]
    ds_read_b128 v[72:75], v18 offset:32000
    v_mfma_f32_16x16x32_bf16 v[244:247], v[76:79], v[48:51], v[244:247]
    v_mfma_f32_16x16x32_bf16 v[248:251], v[80:83], v[48:51], v[248:251]
    s_waitcnt lgkmcnt(3)
    v_mfma_f32_16x16x32_bf16 v[204:207], v[84:87], v[52:55], v[204:207]
    s_barrier
    ds_read_b64_tr_b16 v[76:77], v24 offset:16384
    v_mfma_f32_16x16x32_bf16 v[212:215], v[84:87], v[56:59], v[212:215]
    ds_read_b128 v[28:31], v18 offset:36864
    v_mfma_f32_16x16x32_bf16 v[220:223], v[84:87], v[60:63], v[220:223]
    ds_read_b64_tr_b16 v[78:79], v24 offset:20480
    v_mfma_f32_16x16x32_bf16 v[208:211], v[88:91], v[52:55], v[208:211]
    ds_read_b128 v[32:35], v18 offset:37120
    v_mfma_f32_16x16x32_bf16 v[216:219], v[88:91], v[56:59], v[216:219]
    ds_read_b64_tr_b16 v[80:81], v25 offset:16384
    v_mfma_f32_16x16x32_bf16 v[224:227], v[88:91], v[60:63], v[224:227]
    ds_read_b128 v[36:39], v18 offset:37376
    s_waitcnt lgkmcnt(6)
    v_mfma_f32_16x16x32_bf16 v[228:231], v[84:87], v[64:67], v[228:231]
    ds_read_b64_tr_b16 v[82:83], v25 offset:20480
    v_mfma_f32_16x16x32_bf16 v[232:235], v[88:91], v[64:67], v[232:235]
    ds_read_b128 v[40:43], v18 offset:37632
    v_mfma_f32_16x16x32_bf16 v[236:239], v[84:87], v[68:71], v[236:239]
    ds_read_b128 v[44:47], v18 offset:37888
    v_mfma_f32_16x16x32_bf16 v[240:243], v[88:91], v[68:71], v[240:243]
    ds_read_b128 v[48:51], v18 offset:38144
    v_mfma_f32_16x16x32_bf16 v[244:247], v[84:87], v[72:75], v[244:247]
    v_mfma_f32_16x16x32_bf16 v[248:251], v[88:91], v[72:75], v[248:251]
    s_waitcnt lgkmcnt(3)
    v_mfma_f32_16x16x32_bf16 v[204:207], v[76:79], v[28:31], v[204:207]
    ds_read_b64_tr_b16 v[84:85], v24 offset:24576
    v_mfma_f32_16x16x32_bf16 v[212:215], v[76:79], v[32:35], v[212:215]
    ds_read_b128 v[52:55], v18 offset:43008
    v_mfma_f32_16x16x32_bf16 v[220:223], v[76:79], v[36:39], v[220:223]
    ds_read_b64_tr_b16 v[86:87], v24 offset:28672
    v_mfma_f32_16x16x32_bf16 v[208:211], v[80:83], v[28:31], v[208:211]
    ds_read_b128 v[56:59], v18 offset:43264
    v_mfma_f32_16x16x32_bf16 v[216:219], v[80:83], v[32:35], v[216:219]
    ds_read_b64_tr_b16 v[88:89], v25 offset:24576
    v_mfma_f32_16x16x32_bf16 v[224:227], v[80:83], v[36:39], v[224:227]
    ds_read_b128 v[60:63], v18 offset:43520
    s_waitcnt lgkmcnt(6)
    v_mfma_f32_16x16x32_bf16 v[228:231], v[76:79], v[40:43], v[228:231]
    ds_read_b64_tr_b16 v[90:91], v25 offset:28672
    v_mfma_f32_16x16x32_bf16 v[232:235], v[80:83], v[40:43], v[232:235]
    ds_read_b128 v[64:67], v18 offset:43776
    v_mfma_f32_16x16x32_bf16 v[236:239], v[76:79], v[44:47], v[236:239]
    ds_read_b128 v[68:71], v18 offset:44032
    v_mfma_f32_16x16x32_bf16 v[240:243], v[80:83], v[44:47], v[240:243]
    ds_read_b128 v[72:75], v18 offset:44288
    v_mfma_f32_16x16x32_bf16 v[244:247], v[76:79], v[48:51], v[244:247]
    v_mfma_f32_16x16x32_bf16 v[248:251], v[80:83], v[48:51], v[248:251]
    s_waitcnt lgkmcnt(3)
    v_mfma_f32_16x16x32_bf16 v[204:207], v[84:87], v[52:55], v[204:207]
    s_barrier
    ds_read_b64_tr_b16 v[76:77], v24 offset:32768
    v_mfma_f32_16x16x32_bf16 v[212:215], v[84:87], v[56:59], v[212:215]
    ds_read_b128 v[28:31], v18 offset:49152
    v_mfma_f32_16x16x32_bf16 v[220:223], v[84:87], v[60:63], v[220:223]
    ds_read_b64_tr_b16 v[78:79], v24 offset:36864
    v_mfma_f32_16x16x32_bf16 v[208:211], v[88:91], v[52:55], v[208:211]
    ds_read_b128 v[32:35], v18 offset:49408
    v_mfma_f32_16x16x32_bf16 v[216:219], v[88:91], v[56:59], v[216:219]
    ds_read_b64_tr_b16 v[80:81], v25 offset:32768
    v_mfma_f32_16x16x32_bf16 v[224:227], v[88:91], v[60:63], v[224:227]
    ds_read_b128 v[36:39], v18 offset:49664
    s_waitcnt lgkmcnt(6)
    v_mfma_f32_16x16x32_bf16 v[228:231], v[84:87], v[64:67], v[228:231]
    ds_read_b64_tr_b16 v[82:83], v25 offset:36864
    v_mfma_f32_16x16x32_bf16 v[232:235], v[88:91], v[64:67], v[232:235]
    ds_read_b128 v[40:43], v18 offset:49920
    v_mfma_f32_16x16x32_bf16 v[236:239], v[84:87], v[68:71], v[236:239]
    ds_read_b128 v[44:47], v18 offset:50176
    v_mfma_f32_16x16x32_bf16 v[240:243], v[88:91], v[68:71], v[240:243]
    ds_read_b128 v[48:51], v18 offset:50432
    v_mfma_f32_16x16x32_bf16 v[244:247], v[84:87], v[72:75], v[244:247]
    v_mfma_f32_16x16x32_bf16 v[248:251], v[88:91], v[72:75], v[248:251]
    s_waitcnt lgkmcnt(3)
    v_mfma_f32_16x16x32_bf16 v[204:207], v[76:79], v[28:31], v[204:207]
    ds_read_b64_tr_b16 v[84:85], v24 offset:40960
    v_mfma_f32_16x16x32_bf16 v[212:215], v[76:79], v[32:35], v[212:215]
    ds_read_b128 v[52:55], v18 offset:55296
    v_mfma_f32_16x16x32_bf16 v[220:223], v[76:79], v[36:39], v[220:223]
    ds_read_b64_tr_b16 v[86:87], v24 offset:45056
    v_mfma_f32_16x16x32_bf16 v[208:211], v[80:83], v[28:31], v[208:211]
    ds_read_b128 v[56:59], v18 offset:55552
    v_mfma_f32_16x16x32_bf16 v[216:219], v[80:83], v[32:35], v[216:219]
    ds_read_b64_tr_b16 v[88:89], v25 offset:40960
    v_mfma_f32_16x16x32_bf16 v[224:227], v[80:83], v[36:39], v[224:227]
    ds_read_b128 v[60:63], v18 offset:55808
    s_waitcnt lgkmcnt(6)
    v_mfma_f32_16x16x32_bf16 v[228:231], v[76:79], v[40:43], v[228:231]
    ds_read_b64_tr_b16 v[90:91], v25 offset:45056
    v_mfma_f32_16x16x32_bf16 v[232:235], v[80:83], v[40:43], v[232:235]
    ds_read_b128 v[64:67], v18 offset:56064
    v_mfma_f32_16x16x32_bf16 v[236:239], v[76:79], v[44:47], v[236:239]
    ds_read_b128 v[68:71], v18 offset:56320
    v_mfma_f32_16x16x32_bf16 v[240:243], v[80:83], v[44:47], v[240:243]
    ds_read_b128 v[72:75], v18 offset:56576
    v_mfma_f32_16x16x32_bf16 v[244:247], v[76:79], v[48:51], v[244:247]
    v_mfma_f32_16x16x32_bf16 v[248:251], v[80:83], v[48:51], v[248:251]
    s_waitcnt lgkmcnt(3)
    v_mfma_f32_16x16x32_bf16 v[204:207], v[84:87], v[52:55], v[204:207]
    s_barrier
    ds_read_b64_tr_b16 v[76:77], v20 offset:0
    v_mfma_f32_16x16x32_bf16 v[212:215], v[84:87], v[56:59], v[212:215]
    ds_read_b128 v[28:31], v18 offset:0
    v_mfma_f32_16x16x32_bf16 v[220:223], v[84:87], v[60:63], v[220:223]
    ds_read_b64_tr_b16 v[78:79], v20 offset:4096
    v_mfma_f32_16x16x32_bf16 v[208:211], v[88:91], v[52:55], v[208:211]
    ds_read_b128 v[32:35], v18 offset:256
    v_mfma_f32_16x16x32_bf16 v[216:219], v[88:91], v[56:59], v[216:219]
    ds_read_b64_tr_b16 v[80:81], v21 offset:0
    v_mfma_f32_16x16x32_bf16 v[224:227], v[88:91], v[60:63], v[224:227]
    ds_read_b128 v[36:39], v18 offset:512
    s_waitcnt lgkmcnt(6)
    v_mfma_f32_16x16x32_bf16 v[228:231], v[84:87], v[64:67], v[228:231]
    ds_read_b64_tr_b16 v[82:83], v21 offset:4096
    v_mfma_f32_16x16x32_bf16 v[232:235], v[88:91], v[64:67], v[232:235]
    ds_read_b128 v[40:43], v18 offset:768
    v_mfma_f32_16x16x32_bf16 v[236:239], v[84:87], v[68:71], v[236:239]
    ds_read_b128 v[44:47], v18 offset:1024
    v_mfma_f32_16x16x32_bf16 v[240:243], v[88:91], v[68:71], v[240:243]
    ds_read_b128 v[48:51], v18 offset:1280
    v_mfma_f32_16x16x32_bf16 v[244:247], v[84:87], v[72:75], v[244:247]
    v_mfma_f32_16x16x32_bf16 v[248:251], v[88:91], v[72:75], v[248:251]
    s_waitcnt lgkmcnt(3)
    v_mfma_f32_16x16x32_bf16 v[204:207], v[76:79], v[28:31], v[204:207]
    ds_read_b64_tr_b16 v[84:85], v20 offset:8192
    v_mfma_f32_16x16x32_bf16 v[212:215], v[76:79], v[32:35], v[212:215]
    ds_read_b128 v[52:55], v18 offset:6144
    v_mfma_f32_16x16x32_bf16 v[220:223], v[76:79], v[36:39], v[220:223]
    ds_read_b64_tr_b16 v[86:87], v20 offset:12288
    v_mfma_f32_16x16x32_bf16 v[208:211], v[80:83], v[28:31], v[208:211]
    ds_read_b128 v[56:59], v18 offset:6400
    v_mfma_f32_16x16x32_bf16 v[216:219], v[80:83], v[32:35], v[216:219]
    ds_read_b64_tr_b16 v[88:89], v21 offset:8192
    v_mfma_f32_16x16x32_bf16 v[224:227], v[80:83], v[36:39], v[224:227]
    ds_read_b128 v[60:63], v18 offset:6656
    s_waitcnt lgkmcnt(6)
    v_mfma_f32_16x16x32_bf16 v[228:231], v[76:79], v[40:43], v[228:231]
    ds_read_b64_tr_b16 v[90:91], v21 offset:12288
    v_mfma_f32_16x16x32_bf16 v[232:235], v[80:83], v[40:43], v[232:235]
    ds_read_b128 v[64:67], v18 offset:6912
    v_mfma_f32_16x16x32_bf16 v[236:239], v[76:79], v[44:47], v[236:239]
    ds_read_b128 v[68:71], v18 offset:7168
    v_mfma_f32_16x16x32_bf16 v[240:243], v[80:83], v[44:47], v[240:243]
    ds_read_b128 v[72:75], v18 offset:7424
    v_mfma_f32_16x16x32_bf16 v[244:247], v[76:79], v[48:51], v[244:247]
    v_mfma_f32_16x16x32_bf16 v[248:251], v[80:83], v[48:51], v[248:251]
    s_waitcnt lgkmcnt(3)
    v_mfma_f32_16x16x32_bf16 v[204:207], v[84:87], v[52:55], v[204:207]
    s_barrier
    ds_read_b64_tr_b16 v[76:77], v20 offset:16384
    v_mfma_f32_16x16x32_bf16 v[212:215], v[84:87], v[56:59], v[212:215]
    ds_read_b128 v[28:31], v18 offset:12288
    v_mfma_f32_16x16x32_bf16 v[220:223], v[84:87], v[60:63], v[220:223]
    ds_read_b64_tr_b16 v[78:79], v20 offset:20480
    v_mfma_f32_16x16x32_bf16 v[208:211], v[88:91], v[52:55], v[208:211]
    ds_read_b128 v[32:35], v18 offset:12544
    v_mfma_f32_16x16x32_bf16 v[216:219], v[88:91], v[56:59], v[216:219]
    ds_read_b64_tr_b16 v[80:81], v21 offset:16384
    v_mfma_f32_16x16x32_bf16 v[224:227], v[88:91], v[60:63], v[224:227]
    ds_read_b128 v[36:39], v18 offset:12800
    s_waitcnt lgkmcnt(6)
    v_mfma_f32_16x16x32_bf16 v[228:231], v[84:87], v[64:67], v[228:231]
    ds_read_b64_tr_b16 v[82:83], v21 offset:20480
    v_mfma_f32_16x16x32_bf16 v[232:235], v[88:91], v[64:67], v[232:235]
    ds_read_b128 v[40:43], v18 offset:13056
    v_mfma_f32_16x16x32_bf16 v[236:239], v[84:87], v[68:71], v[236:239]
    ds_read_b128 v[44:47], v18 offset:13312
    v_mfma_f32_16x16x32_bf16 v[240:243], v[88:91], v[68:71], v[240:243]
    ds_read_b128 v[48:51], v18 offset:13568
    v_mfma_f32_16x16x32_bf16 v[244:247], v[84:87], v[72:75], v[244:247]
    v_mfma_f32_16x16x32_bf16 v[248:251], v[88:91], v[72:75], v[248:251]
    s_waitcnt lgkmcnt(3)
    v_mfma_f32_16x16x32_bf16 v[204:207], v[76:79], v[28:31], v[204:207]
    ds_read_b64_tr_b16 v[84:85], v20 offset:24576
    v_mfma_f32_16x16x32_bf16 v[212:215], v[76:79], v[32:35], v[212:215]
    ds_read_b128 v[52:55], v18 offset:18432
    v_mfma_f32_16x16x32_bf16 v[220:223], v[76:79], v[36:39], v[220:223]
    ds_read_b64_tr_b16 v[86:87], v20 offset:28672
    v_mfma_f32_16x16x32_bf16 v[208:211], v[80:83], v[28:31], v[208:211]
    ds_read_b128 v[56:59], v18 offset:18688
    v_mfma_f32_16x16x32_bf16 v[216:219], v[80:83], v[32:35], v[216:219]
    ds_read_b64_tr_b16 v[88:89], v21 offset:24576
    v_mfma_f32_16x16x32_bf16 v[224:227], v[80:83], v[36:39], v[224:227]
    ds_read_b128 v[60:63], v18 offset:18944
    s_waitcnt lgkmcnt(6)
    v_mfma_f32_16x16x32_bf16 v[228:231], v[76:79], v[40:43], v[228:231]
    ds_read_b64_tr_b16 v[90:91], v21 offset:28672
    v_mfma_f32_16x16x32_bf16 v[232:235], v[80:83], v[40:43], v[232:235]
    ds_read_b128 v[64:67], v18 offset:19200
    v_mfma_f32_16x16x32_bf16 v[236:239], v[76:79], v[44:47], v[236:239]
    ds_read_b128 v[68:71], v18 offset:19456
    v_mfma_f32_16x16x32_bf16 v[240:243], v[80:83], v[44:47], v[240:243]
    ds_read_b128 v[72:75], v18 offset:19712
    v_mfma_f32_16x16x32_bf16 v[244:247], v[76:79], v[48:51], v[244:247]
    v_mfma_f32_16x16x32_bf16 v[248:251], v[80:83], v[48:51], v[248:251]
    s_waitcnt lgkmcnt(0)
    s_barrier
    v_mfma_f32_16x16x32_bf16 v[204:207], v[84:87], v[52:55], v[204:207]
    v_mfma_f32_16x16x32_bf16 v[212:215], v[84:87], v[56:59], v[212:215]
    v_mfma_f32_16x16x32_bf16 v[220:223], v[84:87], v[60:63], v[220:223]
    v_mfma_f32_16x16x32_bf16 v[208:211], v[88:91], v[52:55], v[208:211]
    v_mfma_f32_16x16x32_bf16 v[216:219], v[88:91], v[56:59], v[216:219]
    v_mfma_f32_16x16x32_bf16 v[224:227], v[88:91], v[60:63], v[224:227]
    v_mfma_f32_16x16x32_bf16 v[228:231], v[84:87], v[64:67], v[228:231]
    v_mfma_f32_16x16x32_bf16 v[232:235], v[88:91], v[64:67], v[232:235]
    v_mfma_f32_16x16x32_bf16 v[236:239], v[84:87], v[68:71], v[236:239]
    v_mfma_f32_16x16x32_bf16 v[240:243], v[88:91], v[68:71], v[240:243]
    v_mfma_f32_16x16x32_bf16 v[244:247], v[84:87], v[72:75], v[244:247]
    v_mfma_f32_16x16x32_bf16 v[248:251], v[88:91], v[72:75], v[248:251]
    s_lshl_b32 s48, s51, 2
    s_add_u32 s48, s48, s3
    s_mul_i32 s48, s48, 36864
    s_mul_i32 s49, s52, 1536
    s_add_u32 s48, s48, s49
    s_add_u32 s48, s48, 20971520
    v_mul_u32_u24 v22, 9216, v2
    v_lshl_add_u32 v22, v1, 4, v22
    s_mov_b32 s60, 0xbdd2d3e8
    v_mov_b32 v4, 0xc0135761
    v_pk_mul_f32 v[28:29], v[204:205], v[204:205]
    v_pk_mul_f32 v[30:31], v[206:207], v[206:207]
    v_pk_mul_f32 v[32:33], v[208:209], v[208:209]
    v_pk_mul_f32 v[34:35], v[210:211], v[210:211]
    v_pk_fma_f32 v[28:29], v[28:29], s[60:61], v[4:5] op_sel_hi:[1,0,0]
    v_pk_fma_f32 v[30:31], v[30:31], s[60:61], v[4:5] op_sel_hi:[1,0,0]
    v_pk_fma_f32 v[32:33], v[32:33], s[60:61], v[4:5] op_sel_hi:[1,0,0]
    v_pk_fma_f32 v[34:35], v[34:35], s[60:61], v[4:5] op_sel_hi:[1,0,0]
    v_pk_mul_f32 v[28:29], v[28:29], v[204:205]
    v_pk_mul_f32 v[30:31], v[30:31], v[206:207]
    v_pk_mul_f32 v[32:33], v[32:33], v[208:209]
    v_pk_mul_f32 v[34:35], v[34:35], v[210:211]
    v_exp_f32 v28, v28
    v_exp_f32 v29, v29
    v_exp_f32 v30, v30
    v_exp_f32 v31, v31
    v_exp_f32 v32, v32
    v_exp_f32 v33, v33
    v_exp_f32 v34, v34
    v_exp_f32 v35, v35
    v_pk_add_f32 v[28:29], v[28:29], 1.0 op_sel_hi:[1,0]
    v_pk_add_f32 v[30:31], v[30:31], 1.0 op_sel_hi:[1,0]
    v_pk_add_f32 v[32:33], v[32:33], 1.0 op_sel_hi:[1,0]
    v_pk_add_f32 v[34:35], v[34:35], 1.0 op_sel_hi:[1,0]
    v_rcp_f32 v28, v28
    v_rcp_f32 v29, v29
    v_rcp_f32 v30, v30
    v_rcp_f32 v31, v31
    v_rcp_f32 v32, v32
    v_rcp_f32 v33, v33
    v_rcp_f32 v34, v34
    v_rcp_f32 v35, v35
    v_pk_mul_f32 v[28:29], v[28:29], v[204:205]
    v_pk_mul_f32 v[30:31], v[30:31], v[206:207]
    v_pk_mul_f32 v[32:33], v[32:33], v[208:209]
    v_pk_mul_f32 v[34:35], v[34:35], v[210:211]
    v_cvt_pk_bf16_f32 v76, v28, v29
    v_cvt_pk_bf16_f32 v77, v30, v31
    v_cvt_pk_bf16_f32 v78, v32, v33
    v_cvt_pk_bf16_f32 v79, v34, v35
    buffer_store_dwordx4 v[76:79], v22, s[36:39], s48 offen offset:0 sc1
    v_pk_mul_f32 v[36:37], v[212:213], v[212:213]
    v_pk_mul_f32 v[38:39], v[214:215], v[214:215]
    v_pk_mul_f32 v[40:41], v[216:217], v[216:217]
    v_pk_mul_f32 v[42:43], v[218:219], v[218:219]
    v_pk_fma_f32 v[36:37], v[36:37], s[60:61], v[4:5] op_sel_hi:[1,0,0]
    v_pk_fma_f32 v[38:39], v[38:39], s[60:61], v[4:5] op_sel_hi:[1,0,0]
    v_pk_fma_f32 v[40:41], v[40:41], s[60:61], v[4:5] op_sel_hi:[1,0,0]
    v_pk_fma_f32 v[42:43], v[42:43], s[60:61], v[4:5] op_sel_hi:[1,0,0]
    v_pk_mul_f32 v[36:37], v[36:37], v[212:213]
    v_pk_mul_f32 v[38:39], v[38:39], v[214:215]
    v_pk_mul_f32 v[40:41], v[40:41], v[216:217]
    v_pk_mul_f32 v[42:43], v[42:43], v[218:219]
    v_exp_f32 v36, v36
    v_exp_f32 v37, v37
    v_exp_f32 v38, v38
    v_exp_f32 v39, v39
    v_exp_f32 v40, v40
    v_exp_f32 v41, v41
    v_exp_f32 v42, v42
    v_exp_f32 v43, v43
    v_pk_add_f32 v[36:37], v[36:37], 1.0 op_sel_hi:[1,0]
    v_pk_add_f32 v[38:39], v[38:39], 1.0 op_sel_hi:[1,0]
    v_pk_add_f32 v[40:41], v[40:41], 1.0 op_sel_hi:[1,0]
    v_pk_add_f32 v[42:43], v[42:43], 1.0 op_sel_hi:[1,0]
    v_rcp_f32 v36, v36
    v_rcp_f32 v37, v37
    v_rcp_f32 v38, v38
    v_rcp_f32 v39, v39
    v_rcp_f32 v40, v40
    v_rcp_f32 v41, v41
    v_rcp_f32 v42, v42
    v_rcp_f32 v43, v43
    v_pk_mul_f32 v[36:37], v[36:37], v[212:213]
    v_pk_mul_f32 v[38:39], v[38:39], v[214:215]
    v_pk_mul_f32 v[40:41], v[40:41], v[216:217]
    v_pk_mul_f32 v[42:43], v[42:43], v[218:219]
    v_cvt_pk_bf16_f32 v80, v36, v37
    v_cvt_pk_bf16_f32 v81, v38, v39
    v_cvt_pk_bf16_f32 v82, v40, v41
    v_cvt_pk_bf16_f32 v83, v42, v43
    buffer_store_dwordx4 v[80:83], v22, s[36:39], s48 offen offset:256 sc1
    v_pk_mul_f32 v[28:29], v[220:221], v[220:221]
    v_pk_mul_f32 v[30:31], v[222:223], v[222:223]
    v_pk_mul_f32 v[32:33], v[224:225], v[224:225]
    v_pk_mul_f32 v[34:35], v[226:227], v[226:227]
    v_pk_fma_f32 v[28:29], v[28:29], s[60:61], v[4:5] op_sel_hi:[1,0,0]
    v_pk_fma_f32 v[30:31], v[30:31], s[60:61], v[4:5] op_sel_hi:[1,0,0]
    v_pk_fma_f32 v[32:33], v[32:33], s[60:61], v[4:5] op_sel_hi:[1,0,0]
    v_pk_fma_f32 v[34:35], v[34:35], s[60:61], v[4:5] op_sel_hi:[1,0,0]
    v_pk_mul_f32 v[28:29], v[28:29], v[220:221]
    v_pk_mul_f32 v[30:31], v[30:31], v[222:223]
    v_pk_mul_f32 v[32:33], v[32:33], v[224:225]
    v_pk_mul_f32 v[34:35], v[34:35], v[226:227]
    v_exp_f32 v28, v28
    v_exp_f32 v29, v29
    v_exp_f32 v30, v30
    v_exp_f32 v31, v31
    v_exp_f32 v32, v32
    v_exp_f32 v33, v33
    v_exp_f32 v34, v34
    v_exp_f32 v35, v35
    v_pk_add_f32 v[28:29], v[28:29], 1.0 op_sel_hi:[1,0]
    v_pk_add_f32 v[30:31], v[30:31], 1.0 op_sel_hi:[1,0]
    v_pk_add_f32 v[32:33], v[32:33], 1.0 op_sel_hi:[1,0]
    v_pk_add_f32 v[34:35], v[34:35], 1.0 op_sel_hi:[1,0]
    v_rcp_f32 v28, v28
    v_rcp_f32 v29, v29
    v_rcp_f32 v30, v30
    v_rcp_f32 v31, v31
    v_rcp_f32 v32, v32
    v_rcp_f32 v33, v33
    v_rcp_f32 v34, v34
    v_rcp_f32 v35, v35
    v_pk_mul_f32 v[28:29], v[28:29], v[220:221]
    v_pk_mul_f32 v[30:31], v[30:31], v[222:223]
    v_pk_mul_f32 v[32:33], v[32:33], v[224:225]
    v_pk_mul_f32 v[34:35], v[34:35], v[226:227]
    v_cvt_pk_bf16_f32 v76, v28, v29
    v_cvt_pk_bf16_f32 v77, v30, v31
    v_cvt_pk_bf16_f32 v78, v32, v33
    v_cvt_pk_bf16_f32 v79, v34, v35
    buffer_store_dwordx4 v[76:79], v22, s[36:39], s48 offen offset:512 sc1
    v_pk_mul_f32 v[36:37], v[228:229], v[228:229]
    v_pk_mul_f32 v[38:39], v[230:231], v[230:231]
    v_pk_mul_f32 v[40:41], v[232:233], v[232:233]
    v_pk_mul_f32 v[42:43], v[234:235], v[234:235]
    v_pk_fma_f32 v[36:37], v[36:37], s[60:61], v[4:5] op_sel_hi:[1,0,0]
    v_pk_fma_f32 v[38:39], v[38:39], s[60:61], v[4:5] op_sel_hi:[1,0,0]
    v_pk_fma_f32 v[40:41], v[40:41], s[60:61], v[4:5] op_sel_hi:[1,0,0]
    v_pk_fma_f32 v[42:43], v[42:43], s[60:61], v[4:5] op_sel_hi:[1,0,0]
    v_pk_mul_f32 v[36:37], v[36:37], v[228:229]
    v_pk_mul_f32 v[38:39], v[38:39], v[230:231]
    v_pk_mul_f32 v[40:41], v[40:41], v[232:233]
    v_pk_mul_f32 v[42:43], v[42:43], v[234:235]
    v_exp_f32 v36, v36
    v_exp_f32 v37, v37
    v_exp_f32 v38, v38
    v_exp_f32 v39, v39
    v_exp_f32 v40, v40
    v_exp_f32 v41, v41
    v_exp_f32 v42, v42
    v_exp_f32 v43, v43
    v_pk_add_f32 v[36:37], v[36:37], 1.0 op_sel_hi:[1,0]
    v_pk_add_f32 v[38:39], v[38:39], 1.0 op_sel_hi:[1,0]
    v_pk_add_f32 v[40:41], v[40:41], 1.0 op_sel_hi:[1,0]
    v_pk_add_f32 v[42:43], v[42:43], 1.0 op_sel_hi:[1,0]
    v_rcp_f32 v36, v36
    v_rcp_f32 v37, v37
    v_rcp_f32 v38, v38
    v_rcp_f32 v39, v39
    v_rcp_f32 v40, v40
    v_rcp_f32 v41, v41
    v_rcp_f32 v42, v42
    v_rcp_f32 v43, v43
    v_pk_mul_f32 v[36:37], v[36:37], v[228:229]
    v_pk_mul_f32 v[38:39], v[38:39], v[230:231]
    v_pk_mul_f32 v[40:41], v[40:41], v[232:233]
    v_pk_mul_f32 v[42:43], v[42:43], v[234:235]
    v_cvt_pk_bf16_f32 v80, v36, v37
    v_cvt_pk_bf16_f32 v81, v38, v39
    v_cvt_pk_bf16_f32 v82, v40, v41
    v_cvt_pk_bf16_f32 v83, v42, v43
    buffer_store_dwordx4 v[80:83], v22, s[36:39], s48 offen offset:768 sc1
    v_pk_mul_f32 v[28:29], v[236:237], v[236:237]
    v_pk_mul_f32 v[30:31], v[238:239], v[238:239]
    v_pk_mul_f32 v[32:33], v[240:241], v[240:241]
    v_pk_mul_f32 v[34:35], v[242:243], v[242:243]
    v_pk_fma_f32 v[28:29], v[28:29], s[60:61], v[4:5] op_sel_hi:[1,0,0]
    v_pk_fma_f32 v[30:31], v[30:31], s[60:61], v[4:5] op_sel_hi:[1,0,0]
    v_pk_fma_f32 v[32:33], v[32:33], s[60:61], v[4:5] op_sel_hi:[1,0,0]
    v_pk_fma_f32 v[34:35], v[34:35], s[60:61], v[4:5] op_sel_hi:[1,0,0]
    v_pk_mul_f32 v[28:29], v[28:29], v[236:237]
    v_pk_mul_f32 v[30:31], v[30:31], v[238:239]
    v_pk_mul_f32 v[32:33], v[32:33], v[240:241]
    v_pk_mul_f32 v[34:35], v[34:35], v[242:243]
    v_exp_f32 v28, v28
    v_exp_f32 v29, v29
    v_exp_f32 v30, v30
    v_exp_f32 v31, v31
    v_exp_f32 v32, v32
    v_exp_f32 v33, v33
    v_exp_f32 v34, v34
    v_exp_f32 v35, v35
    v_pk_add_f32 v[28:29], v[28:29], 1.0 op_sel_hi:[1,0]
    v_pk_add_f32 v[30:31], v[30:31], 1.0 op_sel_hi:[1,0]
    v_pk_add_f32 v[32:33], v[32:33], 1.0 op_sel_hi:[1,0]
    v_pk_add_f32 v[34:35], v[34:35], 1.0 op_sel_hi:[1,0]
    v_rcp_f32 v28, v28
    v_rcp_f32 v29, v29
    v_rcp_f32 v30, v30
    v_rcp_f32 v31, v31
    v_rcp_f32 v32, v32
    v_rcp_f32 v33, v33
    v_rcp_f32 v34, v34
    v_rcp_f32 v35, v35
    v_pk_mul_f32 v[28:29], v[28:29], v[236:237]
    v_pk_mul_f32 v[30:31], v[30:31], v[238:239]
    v_pk_mul_f32 v[32:33], v[32:33], v[240:241]
    v_pk_mul_f32 v[34:35], v[34:35], v[242:243]
    v_cvt_pk_bf16_f32 v76, v28, v29
    v_cvt_pk_bf16_f32 v77, v30, v31
    v_cvt_pk_bf16_f32 v78, v32, v33
    v_cvt_pk_bf16_f32 v79, v34, v35
    buffer_store_dwordx4 v[76:79], v22, s[36:39], s48 offen offset:1024 sc1
    v_pk_mul_f32 v[36:37], v[244:245], v[244:245]
    v_pk_mul_f32 v[38:39], v[246:247], v[246:247]
    v_pk_mul_f32 v[40:41], v[248:249], v[248:249]
    v_pk_mul_f32 v[42:43], v[250:251], v[250:251]
    v_pk_fma_f32 v[36:37], v[36:37], s[60:61], v[4:5] op_sel_hi:[1,0,0]
    v_pk_fma_f32 v[38:39], v[38:39], s[60:61], v[4:5] op_sel_hi:[1,0,0]
    v_pk_fma_f32 v[40:41], v[40:41], s[60:61], v[4:5] op_sel_hi:[1,0,0]
    v_pk_fma_f32 v[42:43], v[42:43], s[60:61], v[4:5] op_sel_hi:[1,0,0]
    v_pk_mul_f32 v[36:37], v[36:37], v[244:245]
    v_pk_mul_f32 v[38:39], v[38:39], v[246:247]
    v_pk_mul_f32 v[40:41], v[40:41], v[248:249]
    v_pk_mul_f32 v[42:43], v[42:43], v[250:251]
    v_exp_f32 v36, v36
    v_exp_f32 v37, v37
    v_exp_f32 v38, v38
    v_exp_f32 v39, v39
    v_exp_f32 v40, v40
    v_exp_f32 v41, v41
    v_exp_f32 v42, v42
    v_exp_f32 v43, v43
    v_pk_add_f32 v[36:37], v[36:37], 1.0 op_sel_hi:[1,0]
    v_pk_add_f32 v[38:39], v[38:39], 1.0 op_sel_hi:[1,0]
    v_pk_add_f32 v[40:41], v[40:41], 1.0 op_sel_hi:[1,0]
    v_pk_add_f32 v[42:43], v[42:43], 1.0 op_sel_hi:[1,0]
    v_rcp_f32 v36, v36
    v_rcp_f32 v37, v37
    v_rcp_f32 v38, v38
    v_rcp_f32 v39, v39
    v_rcp_f32 v40, v40
    v_rcp_f32 v41, v41
    v_rcp_f32 v42, v42
    v_rcp_f32 v43, v43
    v_pk_mul_f32 v[36:37], v[36:37], v[244:245]
    v_pk_mul_f32 v[38:39], v[38:39], v[246:247]
    v_pk_mul_f32 v[40:41], v[40:41], v[248:249]
    v_pk_mul_f32 v[42:43], v[42:43], v[250:251]
    v_cvt_pk_bf16_f32 v80, v36, v37
    v_cvt_pk_bf16_f32 v81, v38, v39
    v_cvt_pk_bf16_f32 v82, v40, v41
    v_cvt_pk_bf16_f32 v83, v42, v43
    buffer_store_dwordx4 v[80:83], v22, s[36:39], s48 offen offset:1280 sc1
    s_branch L_m_22
L_m_21:
    s_waitcnt vmcnt(0)
    s_barrier
    s_mov_b32 s40, s16
    s_mov_b32 s41, s17
    s_mov_b32 s42, 18874368
    s_mov_b32 s43, 0x20000
    s_mov_b32 s44, s20
    s_mov_b32 s45, s21
    s_mov_b32 s46, 18874368
    s_mov_b32 s47, 0x20000
    s_mul_i32 s56, s3, 5
    s_add_u32 s56, s56, s5
    s_sub_u32 s56, s56, 27
    s_add_u32 s57, s56, 116
    s_add_u32 s56, s56, 0
L_m_23:
    s_cmp_ge_u32 s57, 320
    s_cbranch_scc1 L_m_24
    s_mul_i32 s48, s57, 820
    s_lshr_b32 s48, s48, 13
    s_mul_i32 s49, s48, 10
    s_sub_u32 s49, s57, s49
    s_lshl_b32 s49, s49, 6
    v_add_u32 v10, s49, v0
    s_and_b32 s49, s4, 7
    s_mul_i32 s49, s49, 4
    s_add_u32 s48, s48, s49
    s_add_u32 s48, s48, 26
    s_and_b32 s48, s48, 31
    s_mul_i32 s48, s48, 73728
    s_mul_i32 s49, s4, 1152
    s_and_b32 s49, s49, -256
    s_add_u32 s48, s48, s49
    v_mul_u32_u24 v11, 820, v10
    v_lshrrev_b32 v11, 13, v11
    v_mul_u32_u24 v12, 10, v11
    v_sub_u32 v12, v10, v12
    v_and_b32 v10, 7, v11
    v_lshrrev_b32 v11, 3, v11
    v_lshl_add_u32 v10, v10, 8, v11
    v_mul_u32_u24 v10, 9216, v10
    v_lshl_add_u32 v10, v12, 7, v10
    buffer_load_dword v13, v10, s[40:43], s48 offen
    s_add_u32 s57, s57, 20
    s_branch L_m_23
L_m_24:
    v_lshrrev_b32 v14, 4, v0
    v_and_b32 v15, 15, v0
    v_lshlrev_b32 v14, 12, v14
    v_lshl_add_u32 v14, v15, 7, v14
    s_lshr_b32 s48, s4, 1
    s_mul_i32 s48, s48, 4718592
    s_and_b32 s49, s4, 1
    s_lshl_b32 s49, s49, 11
    s_add_u32 s48, s48, s49
    v_add_u32 v14, s48, v14
    s_mov_b32 s50, 0
L_m_25:
    s_cmp_ge_u32 s56, 52
    s_cbranch_scc1 L_m_26
    s_add_u32 s48, s56, s50
    s_cmp_ge_u32 s48, 288
    s_cselect_b32 s49, 288, 0
    s_sub_u32 s48, s48, s49
    s_lshl_b32 s48, s48, 14
    buffer_load_dword v17, v14, s[44:47], s48 offen
    s_add_u32 s56, s56, 20
    s_branch L_m_25
L_m_26:
    s_waitcnt vmcnt(0)
    s_waitcnt vmcnt(0)
    s_barrier
    s_branch L_skip_6
L_stub_6:
    s_branch L_back_c2
L_skip_6:
L_m_22:
    s_lshr_b32 s58, s53, 1
    v_lshrrev_b32 v10, 2, v0
    v_and_b32 v11, 7, v10
    s_lshl_b32 s59, s3, 1
    s_add_u32 s59, s59, s58
    v_xor_b32 v11, s59, v11
    v_xor_b32 v12, 1, v11
    v_and_b32 v13, 3, v0
    v_lshlrev_b32 v13, 3, v13
    v_lshl_add_u32 v10, v10, 8, v13
    v_lshl_add_u32 v20, v11, 5, v10
    v_lshl_add_u32 v21, v12, 5, v10
    s_barrier
    v_add_u32 v24, 0, v20
    v_add_u32 v25, 0, v21
    ds_read_b64_tr_b16 v[92:93], v24 offset:32768
    ds_read_b64_tr_b16 v[94:95], v24 offset:36864
    ds_read_b64_tr_b16 v[96:97], v25 offset:32768
    ds_read_b64_tr_b16 v[98:99], v25 offset:36864
    ds_read_b64_tr_b16 v[100:101], v24 offset:40960
    ds_read_b64_tr_b16 v[102:103], v24 offset:45056
    ds_read_b64_tr_b16 v[104:105], v25 offset:40960
    ds_read_b64_tr_b16 v[106:107], v25 offset:45056
    ds_read_b64_tr_b16 v[156:157], v24 offset:0
    ds_read_b64_tr_b16 v[158:159], v24 offset:4096
    ds_read_b64_tr_b16 v[160:161], v25 offset:0
    ds_read_b64_tr_b16 v[162:163], v25 offset:4096
    ds_read_b64_tr_b16 v[164:165], v24 offset:8192
    ds_read_b64_tr_b16 v[166:167], v24 offset:12288
    ds_read_b64_tr_b16 v[168:169], v25 offset:8192
    ds_read_b64_tr_b16 v[170:171], v25 offset:12288
    ds_read_b64_tr_b16 v[172:173], v24 offset:16384
    ds_read_b64_tr_b16 v[174:175], v24 offset:20480
    ds_read_b64_tr_b16 v[176:177], v25 offset:16384
    ds_read_b64_tr_b16 v[178:179], v25 offset:20480
    ds_read_b64_tr_b16 v[180:181], v24 offset:24576
    ds_read_b64_tr_b16 v[182:183], v24 offset:28672
    ds_read_b64_tr_b16 v[184:185], v25 offset:24576
    ds_read_b64_tr_b16 v[186:187], v25 offset:28672
    v_add_u32 v24, 49152, v20
    v_add_u32 v25, 49152, v21
    ds_read_b64_tr_b16 v[108:109], v24 offset:0
    ds_read_b64_tr_b16 v[110:111], v24 offset:4096
    ds_read_b64_tr_b16 v[112:113], v25 offset:0
    ds_read_b64_tr_b16 v[114:115], v25 offset:4096
    ds_read_b64_tr_b16 v[116:117], v24 offset:8192
    ds_read_b64_tr_b16 v[118:119], v24 offset:12288
    ds_read_b64_tr_b16 v[120:121], v25 offset:8192
    ds_read_b64_tr_b16 v[122:123], v25 offset:12288
    ds_read_b64_tr_b16 v[124:125], v24 offset:16384
    ds_read_b64_tr_b16 v[126:127], v24 offset:20480
    ds_read_b64_tr_b16 v[128:129], v25 offset:16384
    ds_read_b64_tr_b16 v[130:131], v25 offset:20480
    ds_read_b64_tr_b16 v[132:133], v24 offset:24576
    ds_read_b64_tr_b16 v[134:135], v24 offset:28672
    ds_read_b64_tr_b16 v[136:137], v25 offset:24576
    ds_read_b64_tr_b16 v[138:139], v25 offset:28672
    ds_read_b64_tr_b16 v[140:141], v24 offset:32768
    ds_read_b64_tr_b16 v[142:143], v24 offset:36864
    ds_read_b64_tr_b16 v[144:145], v25 offset:32768
    ds_read_b64_tr_b16 v[146:147], v25 offset:36864
    ds_read_b64_tr_b16 v[148:149], v24 offset:40960
    ds_read_b64_tr_b16 v[150:151], v24 offset:45056
    ds_read_b64_tr_b16 v[152:153], v25 offset:40960
    ds_read_b64_tr_b16 v[154:155], v25 offset:45056
    s_waitcnt lgkmcnt(0)
    s_barrier
    s_waitcnt vmcnt(0)
    s_barrier
    s_and_b32 s58, s53, 1
    s_mul_i32 s48, s58, 1280
    s_sub_u32 s49, 1280, s48
    v_mul_u32_u24 v10, 2304, v2
    v_add_u32 v10, 90112, v10
    v_lshl_add_u32 v12, v1, 4, v10
    v_add_u32 v18, s48, v12
    v_add_u32 v22, s49, v12
    s_lshl_b32 s48, s58, 3
    v_xor_b32 v11, s48, v1
    v_lshl_add_u32 v19, v11, 4, v10
    v_add_u32 v19, 1024, v19
    v_lshlrev_b32 v9, 4, v0
    v_lshlrev_b32 v8, 16, v8
    v_cmp_gt_u32 vcc, 32, v0
    s_nop 1
    v_cndmask_b32 v10, 0, v8, vcc
    v_mov_b32 v188, v8
    v_mov_b32 v189, v8
    v_mov_b32 v190, v8
    v_mov_b32 v191, v8
    v_mov_b64 v[192:193], 0
    v_mov_b64 v[194:195], 0
    v_mov_b32 v196, v8
    v_mov_b32 v197, v8
    v_mov_b32 v198, v8
    v_mov_b32 v199, v8
    v_mov_b64 v[200:201], 0
    v_mov_b64 v[202:203], 0
    v_mov_b32 v204, v8
    v_mov_b32 v205, v8
    v_mov_b32 v206, v8
    v_mov_b32 v207, v8
    v_mov_b64 v[208:209], 0
    v_mov_b64 v[210:211], 0
    v_mov_b32 v212, v8
    v_mov_b32 v213, v8
    v_mov_b32 v214, v8
    v_mov_b32 v215, v8
    v_mov_b64 v[216:217], 0
    v_mov_b64 v[218:219], 0
    v_mov_b32 v220, v10
    v_mov_b32 v221, v10
    v_mov_b32 v222, v10
    v_mov_b32 v223, v10
    v_mov_b64 v[224:225], 0
    v_mov_b64 v[226:227], 0
    v_mov_b64 v[228:229], 0
    v_mov_b64 v[230:231], 0
    v_mov_b64 v[232:233], 0
    v_mov_b64 v[234:235], 0
    v_mov_b64 v[236:237], 0
    v_mov_b64 v[238:239], 0
    v_mov_b64 v[240:241], 0
    v_mov_b64 v[242:243], 0
    v_mov_b64 v[244:245], 0
    v_mov_b64 v[246:247], 0
    v_mov_b64 v[248:249], 0
    v_mov_b64 v[250:251], 0
    v_mov_b64 v[252:253], 0
    v_mov_b64 v[254:255], 0
    v_mov_b64 v[64:65], 0
    v_mov_b64 v[66:67], 0
    s_mov_b32 s44, s28
    s_mov_b32 s45, s29
    s_mov_b32 s46, 2359296
    s_mov_b32 s47, 0x20000
    s_mul_i32 s48, s3, 2304
    s_add_u32 s48, s48, 32768
    v_mul_u32_u24 v10, 144, v1
    v_lshl_add_u32 v10, v2, 3, v10
    v_add_u32 v10, s48, v10
    v_add_u32 v7, s48, v9
    s_lshl_b32 s49, s58, 4
    v_add_u32 v4, s49, v10
    s_lshl_b32 s49, s58, 7
    s_sub_u32 s49, 128, s49
    v_add_u32 v10, s49, v10
    v_cmp_gt_u32 vcc, 32, v0
    v_mov_b32 v11, 82432
    s_nop 0
    v_cndmask_b32 v5, v11, v10, vcc
    v_lshlrev_b32 v10, 4, v2
    v_add_u32 v10, 81920, v10
    s_lshl_b32 s49, s58, 5
    v_add_u32 v6, s49, v10
    s_lshl_b32 s49, s58, 8
    s_sub_u32 s49, 256, s49
    v_add_u32 v23, s49, v10
    s_lshl_b32 s48, s59, 4
    s_lshl_b32 s49, s54, 7
    s_add_u32 s48, s48, s49
    s_mul_i32 s48, s48, 1152
    s_mul_i32 s49, s55, 288
    s_add_u32 s62, s48, s49
    s_mul_i32 s49, s58, 144
    s_add_u32 s62, s62, s49
    v_add_u32 v10, 0, v0
    v_mul_u32_u24 v11, 911, v10
    v_lshrrev_b32 v11, 13, v11
    v_mul_u32_u24 v11, 1008, v11
    v_lshl_add_u32 v68, v10, 4, v11
    v_add_u32 v10, 64, v0
    v_mul_u32_u24 v11, 911, v10
    v_lshrrev_b32 v11, 13, v11
    v_mul_u32_u24 v11, 1008, v11
    v_lshl_add_u32 v69, v10, 4, v11
    v_add_u32 v10, 128, v0
    v_mul_u32_u24 v11, 911, v10
    v_lshrrev_b32 v11, 13, v11
    v_mul_u32_u24 v11, 1008, v11
    v_lshl_add_u32 v70, v10, 4, v11
    v_cmp_gt_u32 vcc, 16, v0
    v_mov_b32 v11, 2146435072
    s_nop 0
    v_cndmask_b32 v70, v11, v70, vcc
    s_mul_i32 s48, s3, 2304
    s_add_u32 s48, s48, 27262976
    s_mul_i32 s64, s2, 27648
    s_add_u32 s64, s64, s48
    v_and_b32 v10, 3, v0
    v_cmp_eq_u32 vcc, 0, v10
    v_lshlrev_b32 v27, 2, v0
    s_nop 0
    v_cndmask_b32 v26, v11, v27, vcc
    s_mul_i32 s49, s3, 4608
    s_add_u32 s49, s49, 49152
    v_add_u32 v71, s49, v9
    v_add_u32 v72, 73728, v18
    v_add_u32 v75, 73728, v19
    v_add_u32 v74, 73728, v22
    s_xor_b32 s65, s2, 2
    s_mul_i32 s65, s65, 27648
    s_add_u32 s65, s65, s48
    s_add_u32 s65, s65, 0
    s_xor_b32 s66, s2, 4
    s_mul_i32 s66, s66, 27648
    s_add_u32 s66, s66, s48
    s_add_u32 s66, s66, 9216
    s_xor_b32 s67, s2, 6
    s_mul_i32 s67, s67, 27648
    s_add_u32 s67, s67, s48
    s_add_u32 s67, s67, 18432
    s_branch L_stub_7
L_back_c3:
    v_add_u32 v24, 49152, v20
    v_add_u32 v25, 49152, v21
    s_barrier
    ds_read_b64_tr_b16 v[80:81], v21 offset:0
    ds_read_b64_tr_b16 v[82:83], v21 offset:4096
    ds_read_b64_tr_b16 v[76:77], v20 offset:0
    ds_read_b64_tr_b16 v[78:79], v20 offset:4096
    ds_read_b128 v[28:31], v18 offset:0
    ds_read_b128 v[32:35], v18 offset:256
    ds_read_b128 v[36:39], v18 offset:512
    ds_read_b128 v[40:43], v18 offset:768
    ds_read_b128 v[44:47], v19 offset:0
    ds_read_b128 v[48:51], v22 offset:0
    ds_read_b128 v[52:55], v22 offset:256
    ds_read_b128 v[56:59], v22 offset:512
    ds_read_b128 v[60:63], v22 offset:768
    s_waitcnt lgkmcnt(6)
    v_mfma_f32_16x16x32_bf16 v[192:195], v[28:31], v[80:83], v[192:195]
    ds_read_b64_tr_b16 v[88:89], v21 offset:8192
    v_mfma_f32_16x16x32_bf16 v[188:191], v[28:31], v[76:79], v[188:191]
    ds_read_b128 v[28:31], v18 offset:9216
    v_mfma_f32_16x16x32_bf16 v[200:203], v[32:35], v[80:83], v[200:203]
    ds_read_b64_tr_b16 v[90:91], v21 offset:12288
    v_mfma_f32_16x16x32_bf16 v[196:199], v[32:35], v[76:79], v[196:199]
    ds_read_b128 v[32:35], v18 offset:9472
    v_mfma_f32_16x16x32_bf16 v[208:211], v[36:39], v[80:83], v[208:211]
    ds_read_b64_tr_b16 v[84:85], v20 offset:8192
    v_mfma_f32_16x16x32_bf16 v[204:207], v[36:39], v[76:79], v[204:207]
    ds_read_b128 v[36:39], v18 offset:9728
    s_waitcnt lgkmcnt(9)
    v_mfma_f32_16x16x32_bf16 v[216:219], v[40:43], v[80:83], v[216:219]
    ds_read_b64_tr_b16 v[86:87], v20 offset:12288
    v_mfma_f32_16x16x32_bf16 v[212:215], v[40:43], v[76:79], v[212:215]
    ds_read_b128 v[40:43], v18 offset:9984
    v_mfma_f32_16x16x32_bf16 v[224:227], v[44:47], v[80:83], v[224:227]
    v_mfma_f32_16x16x32_bf16 v[220:223], v[44:47], v[76:79], v[220:223]
    ds_read_b128 v[44:47], v19 offset:9216
    v_mfma_f32_16x16x32_bf16 v[232:235], v[48:51], v[80:83], v[232:235]
    v_mfma_f32_16x16x32_bf16 v[228:231], v[48:51], v[76:79], v[228:231]
    ds_read_b128 v[48:51], v22 offset:9216
    s_waitcnt lgkmcnt(10)
    v_mfma_f32_16x16x32_bf16 v[240:243], v[52:55], v[80:83], v[240:243]
    v_mfma_f32_16x16x32_bf16 v[236:239], v[52:55], v[76:79], v[236:239]
    ds_read_b128 v[52:55], v22 offset:9472
    v_mfma_f32_16x16x32_bf16 v[248:251], v[56:59], v[80:83], v[248:251]
    v_mfma_f32_16x16x32_bf16 v[244:247], v[56:59], v[76:79], v[244:247]
    ds_read_b128 v[56:59], v22 offset:9728
    v_mfma_f32_16x16x32_bf16 v[64:67], v[60:63], v[80:83], v[64:67]
    v_mfma_f32_16x16x32_bf16 v[252:255], v[60:63], v[76:79], v[252:255]
    ds_read_b128 v[60:63], v22 offset:9984
    s_waitcnt lgkmcnt(6)
    v_mfma_f32_16x16x32_bf16 v[192:195], v[28:31], v[88:91], v[192:195]
    s_barrier
    ds_read_b64_tr_b16 v[80:81], v21 offset:16384
    v_mfma_f32_16x16x32_bf16 v[188:191], v[28:31], v[84:87], v[188:191]
    ds_read_b128 v[28:31], v18 offset:18432
    v_mfma_f32_16x16x32_bf16 v[200:203], v[32:35], v[88:91], v[200:203]
    ds_read_b64_tr_b16 v[82:83], v21 offset:20480
    v_mfma_f32_16x16x32_bf16 v[196:199], v[32:35], v[84:87], v[196:199]
    ds_read_b128 v[32:35], v18 offset:18688
    v_mfma_f32_16x16x32_bf16 v[208:211], v[36:39], v[88:91], v[208:211]
    ds_read_b64_tr_b16 v[76:77], v20 offset:16384
    v_mfma_f32_16x16x32_bf16 v[204:207], v[36:39], v[84:87], v[204:207]
    ds_read_b128 v[36:39], v18 offset:18944
    s_waitcnt lgkmcnt(9)
    v_mfma_f32_16x16x32_bf16 v[216:219], v[40:43], v[88:91], v[216:219]
    ds_read_b64_tr_b16 v[78:79], v20 offset:20480
    v_mfma_f32_16x16x32_bf16 v[212:215], v[40:43], v[84:87], v[212:215]
    ds_read_b128 v[40:43], v18 offset:19200
    v_mfma_f32_16x16x32_bf16 v[224:227], v[44:47], v[88:91], v[224:227]
    v_mfma_f32_16x16x32_bf16 v[220:223], v[44:47], v[84:87], v[220:223]
    ds_read_b128 v[44:47], v19 offset:18432
    v_mfma_f32_16x16x32_bf16 v[232:235], v[48:51], v[88:91], v[232:235]
    v_mfma_f32_16x16x32_bf16 v[228:231], v[48:51], v[84:87], v[228:231]
    ds_read_b128 v[48:51], v22 offset:18432
    s_waitcnt lgkmcnt(10)
    v_mfma_f32_16x16x32_bf16 v[240:243], v[52:55], v[88:91], v[240:243]
    v_mfma_f32_16x16x32_bf16 v[236:239], v[52:55], v[84:87], v[236:239]
    ds_read_b128 v[52:55], v22 offset:18688
    v_mfma_f32_16x16x32_bf16 v[248:251], v[56:59], v[88:91], v[248:251]
    v_mfma_f32_16x16x32_bf16 v[244:247], v[56:59], v[84:87], v[244:247]
    ds_read_b128 v[56:59], v22 offset:18944
    v_mfma_f32_16x16x32_bf16 v[64:67], v[60:63], v[88:91], v[64:67]
    v_mfma_f32_16x16x32_bf16 v[252:255], v[60:63], v[84:87], v[252:255]
    ds_read_b128 v[60:63], v22 offset:19200
    s_waitcnt lgkmcnt(6)
    v_mfma_f32_16x16x32_bf16 v[192:195], v[28:31], v[80:83], v[192:195]
    ds_read_b64_tr_b16 v[88:89], v21 offset:24576
    v_mfma_f32_16x16x32_bf16 v[188:191], v[28:31], v[76:79], v[188:191]
    ds_read_b128 v[28:31], v18 offset:27648
    v_mfma_f32_16x16x32_bf16 v[200:203], v[32:35], v[80:83], v[200:203]
    ds_read_b64_tr_b16 v[90:91], v21 offset:28672
    v_mfma_f32_16x16x32_bf16 v[196:199], v[32:35], v[76:79], v[196:199]
    ds_read_b128 v[32:35], v18 offset:27904
    v_mfma_f32_16x16x32_bf16 v[208:211], v[36:39], v[80:83], v[208:211]
    ds_read_b64_tr_b16 v[84:85], v20 offset:24576
    v_mfma_f32_16x16x32_bf16 v[204:207], v[36:39], v[76:79], v[204:207]
    ds_read_b128 v[36:39], v18 offset:28160
    s_waitcnt lgkmcnt(9)
    v_mfma_f32_16x16x32_bf16 v[216:219], v[40:43], v[80:83], v[216:219]
    ds_read_b64_tr_b16 v[86:87], v20 offset:28672
    v_mfma_f32_16x16x32_bf16 v[212:215], v[40:43], v[76:79], v[212:215]
    ds_read_b128 v[40:43], v18 offset:28416
    v_mfma_f32_16x16x32_bf16 v[224:227], v[44:47], v[80:83], v[224:227]
    v_mfma_f32_16x16x32_bf16 v[220:223], v[44:47], v[76:79], v[220:223]
    ds_read_b128 v[44:47], v19 offset:27648
    v_mfma_f32_16x16x32_bf16 v[232:235], v[48:51], v[80:83], v[232:235]
    v_mfma_f32_16x16x32_bf16 v[228:231], v[48:51], v[76:79], v[228:231]
    ds_read_b128 v[48:51], v22 offset:27648
    s_waitcnt lgkmcnt(10)
    v_mfma_f32_16x16x32_bf16 v[240:243], v[52:55], v[80:83], v[240:243]
    v_mfma_f32_16x16x32_bf16 v[236:239], v[52:55], v[76:79], v[236:239]
    ds_read_b128 v[52:55], v22 offset:27904
    v_mfma_f32_16x16x32_bf16 v[248:251], v[56:59], v[80:83], v[248:251]
    v_mfma_f32_16x16x32_bf16 v[244:247], v[56:59], v[76:79], v[244:247]
    ds_read_b128 v[56:59], v22 offset:28160
    v_mfma_f32_16x16x32_bf16 v[64:67], v[60:63], v[80:83], v[64:67]
    v_mfma_f32_16x16x32_bf16 v[252:255], v[60:63], v[76:79], v[252:255]
    ds_read_b128 v[60:63], v22 offset:28416
    s_waitcnt lgkmcnt(6)
    v_mfma_f32_16x16x32_bf16 v[192:195], v[28:31], v[88:91], v[192:195]
    s_barrier
    ds_read_b64_tr_b16 v[80:81], v21 offset:32768
    v_mfma_f32_16x16x32_bf16 v[188:191], v[28:31], v[84:87], v[188:191]
    ds_read_b128 v[28:31], v18 offset:36864
    v_mfma_f32_16x16x32_bf16 v[200:203], v[32:35], v[88:91], v[200:203]
    ds_read_b64_tr_b16 v[82:83], v21 offset:36864
    v_mfma_f32_16x16x32_bf16 v[196:199], v[32:35], v[84:87], v[196:199]
    ds_read_b128 v[32:35], v18 offset:37120
    v_mfma_f32_16x16x32_bf16 v[208:211], v[36:39], v[88:91], v[208:211]
    ds_read_b64_tr_b16 v[76:77], v20 offset:32768
    v_mfma_f32_16x16x32_bf16 v[204:207], v[36:39], v[84:87], v[204:207]
    ds_read_b128 v[36:39], v18 offset:37376
    s_waitcnt lgkmcnt(9)
    v_mfma_f32_16x16x32_bf16 v[216:219], v[40:43], v[88:91], v[216:219]
    ds_read_b64_tr_b16 v[78:79], v20 offset:36864
    v_mfma_f32_16x16x32_bf16 v[212:215], v[40:43], v[84:87], v[212:215]
    ds_read_b128 v[40:43], v18 offset:37632
    v_mfma_f32_16x16x32_bf16 v[224:227], v[44:47], v[88:91], v[224:227]
    v_mfma_f32_16x16x32_bf16 v[220:223], v[44:47], v[84:87], v[220:223]
    ds_read_b128 v[44:47], v19 offset:36864
    v_mfma_f32_16x16x32_bf16 v[232:235], v[48:51], v[88:91], v[232:235]
    v_mfma_f32_16x16x32_bf16 v[228:231], v[48:51], v[84:87], v[228:231]
    ds_read_b128 v[48:51], v22 offset:36864
    s_waitcnt lgkmcnt(10)
    v_mfma_f32_16x16x32_bf16 v[240:243], v[52:55], v[88:91], v[240:243]
    v_mfma_f32_16x16x32_bf16 v[236:239], v[52:55], v[84:87], v[236:239]
    ds_read_b128 v[52:55], v22 offset:37120
    v_mfma_f32_16x16x32_bf16 v[248:251], v[56:59], v[88:91], v[248:251]
    v_mfma_f32_16x16x32_bf16 v[244:247], v[56:59], v[84:87], v[244:247]
    ds_read_b128 v[56:59], v22 offset:37376
    v_mfma_f32_16x16x32_bf16 v[64:67], v[60:63], v[88:91], v[64:67]
    v_mfma_f32_16x16x32_bf16 v[252:255], v[60:63], v[84:87], v[252:255]
    ds_read_b128 v[60:63], v22 offset:37632
    s_waitcnt lgkmcnt(6)
    v_mfma_f32_16x16x32_bf16 v[192:195], v[28:31], v[80:83], v[192:195]
    ds_read_b64_tr_b16 v[88:89], v21 offset:40960
    v_mfma_f32_16x16x32_bf16 v[188:191], v[28:31], v[76:79], v[188:191]
    ds_read_b128 v[28:31], v18 offset:46080
    v_mfma_f32_16x16x32_bf16 v[200:203], v[32:35], v[80:83], v[200:203]
    ds_read_b64_tr_b16 v[90:91], v21 offset:45056
    v_mfma_f32_16x16x32_bf16 v[196:199], v[32:35], v[76:79], v[196:199]
    ds_read_b128 v[32:35], v18 offset:46336
    v_mfma_f32_16x16x32_bf16 v[208:211], v[36:39], v[80:83], v[208:211]
    ds_read_b64_tr_b16 v[84:85], v20 offset:40960
    v_mfma_f32_16x16x32_bf16 v[204:207], v[36:39], v[76:79], v[204:207]
    ds_read_b128 v[36:39], v18 offset:46592
    s_waitcnt lgkmcnt(9)
    v_mfma_f32_16x16x32_bf16 v[216:219], v[40:43], v[80:83], v[216:219]
    ds_read_b64_tr_b16 v[86:87], v20 offset:45056
    v_mfma_f32_16x16x32_bf16 v[212:215], v[40:43], v[76:79], v[212:215]
    ds_read_b128 v[40:43], v18 offset:46848
    v_mfma_f32_16x16x32_bf16 v[224:227], v[44:47], v[80:83], v[224:227]
    v_mfma_f32_16x16x32_bf16 v[220:223], v[44:47], v[76:79], v[220:223]
    ds_read_b128 v[44:47], v19 offset:46080
    v_mfma_f32_16x16x32_bf16 v[232:235], v[48:51], v[80:83], v[232:235]
    v_mfma_f32_16x16x32_bf16 v[228:231], v[48:51], v[76:79], v[228:231]
    ds_read_b128 v[48:51], v22 offset:46080
    s_waitcnt lgkmcnt(10)
    v_mfma_f32_16x16x32_bf16 v[240:243], v[52:55], v[80:83], v[240:243]
    v_mfma_f32_16x16x32_bf16 v[236:239], v[52:55], v[76:79], v[236:239]
    ds_read_b128 v[52:55], v22 offset:46336
    v_mfma_f32_16x16x32_bf16 v[248:251], v[56:59], v[80:83], v[248:251]
    v_mfma_f32_16x16x32_bf16 v[244:247], v[56:59], v[76:79], v[244:247]
    ds_read_b128 v[56:59], v22 offset:46592
    v_mfma_f32_16x16x32_bf16 v[64:67], v[60:63], v[80:83], v[64:67]
    v_mfma_f32_16x16x32_bf16 v[252:255], v[60:63], v[76:79], v[252:255]
    ds_read_b128 v[60:63], v22 offset:46848
    s_waitcnt lgkmcnt(6)
    v_mfma_f32_16x16x32_bf16 v[192:195], v[28:31], v[88:91], v[192:195]
    s_barrier
    ds_read_b64_tr_b16 v[80:81], v25 offset:0
    v_mfma_f32_16x16x32_bf16 v[188:191], v[28:31], v[84:87], v[188:191]
    ds_read_b128 v[28:31], v18 offset:55296
    v_mfma_f32_16x16x32_bf16 v[200:203], v[32:35], v[88:91], v[200:203]
    ds_read_b64_tr_b16 v[82:83], v25 offset:4096
    v_mfma_f32_16x16x32_bf16 v[196:199], v[32:35], v[84:87], v[196:199]
    ds_read_b128 v[32:35], v18 offset:55552
    v_mfma_f32_16x16x32_bf16 v[208:211], v[36:39], v[88:91], v[208:211]
    ds_read_b64_tr_b16 v[76:77], v24 offset:0
    v_mfma_f32_16x16x32_bf16 v[204:207], v[36:39], v[84:87], v[204:207]
    ds_read_b128 v[36:39], v18 offset:55808
    s_waitcnt lgkmcnt(9)
    v_mfma_f32_16x16x32_bf16 v[216:219], v[40:43], v[88:91], v[216:219]
    ds_read_b64_tr_b16 v[78:79], v24 offset:4096
    v_mfma_f32_16x16x32_bf16 v[212:215], v[40:43], v[84:87], v[212:215]
    ds_read_b128 v[40:43], v18 offset:56064
    v_mfma_f32_16x16x32_bf16 v[224:227], v[44:47], v[88:91], v[224:227]
    v_mfma_f32_16x16x32_bf16 v[220:223], v[44:47], v[84:87], v[220:223]
    ds_read_b128 v[44:47], v19 offset:55296
    v_mfma_f32_16x16x32_bf16 v[232:235], v[48:51], v[88:91], v[232:235]
    v_mfma_f32_16x16x32_bf16 v[228:231], v[48:51], v[84:87], v[228:231]
    ds_read_b128 v[48:51], v22 offset:55296
    s_waitcnt lgkmcnt(10)
    v_mfma_f32_16x16x32_bf16 v[240:243], v[52:55], v[88:91], v[240:243]
    v_mfma_f32_16x16x32_bf16 v[236:239], v[52:55], v[84:87], v[236:239]
    ds_read_b128 v[52:55], v22 offset:55552
    v_mfma_f32_16x16x32_bf16 v[248:251], v[56:59], v[88:91], v[248:251]
    v_mfma_f32_16x16x32_bf16 v[244:247], v[56:59], v[84:87], v[244:247]
    ds_read_b128 v[56:59], v22 offset:55808
    v_mfma_f32_16x16x32_bf16 v[64:67], v[60:63], v[88:91], v[64:67]
    v_mfma_f32_16x16x32_bf16 v[252:255], v[60:63], v[84:87], v[252:255]
    ds_read_b128 v[60:63], v22 offset:56064
    s_waitcnt lgkmcnt(6)
    v_mfma_f32_16x16x32_bf16 v[192:195], v[28:31], v[80:83], v[192:195]
    ds_read_b64_tr_b16 v[88:89], v25 offset:8192
    v_mfma_f32_16x16x32_bf16 v[188:191], v[28:31], v[76:79], v[188:191]
    ds_read_b128 v[28:31], v18 offset:64512
    v_mfma_f32_16x16x32_bf16 v[200:203], v[32:35], v[80:83], v[200:203]
    ds_read_b64_tr_b16 v[90:91], v25 offset:12288
    v_mfma_f32_16x16x32_bf16 v[196:199], v[32:35], v[76:79], v[196:199]
    ds_read_b128 v[32:35], v18 offset:64768
    v_mfma_f32_16x16x32_bf16 v[208:211], v[36:39], v[80:83], v[208:211]
    ds_read_b64_tr_b16 v[84:85], v24 offset:8192
    v_mfma_f32_16x16x32_bf16 v[204:207], v[36:39], v[76:79], v[204:207]
    ds_read_b128 v[36:39], v18 offset:65024
    s_waitcnt lgkmcnt(9)
    v_mfma_f32_16x16x32_bf16 v[216:219], v[40:43], v[80:83], v[216:219]
    ds_read_b64_tr_b16 v[86:87], v24 offset:12288
    v_mfma_f32_16x16x32_bf16 v[212:215], v[40:43], v[76:79], v[212:215]
    ds_read_b128 v[40:43], v18 offset:65280
    v_mfma_f32_16x16x32_bf16 v[224:227], v[44:47], v[80:83], v[224:227]
    v_mfma_f32_16x16x32_bf16 v[220:223], v[44:47], v[76:79], v[220:223]
    ds_read_b128 v[44:47], v19 offset:64512
    v_mfma_f32_16x16x32_bf16 v[232:235], v[48:51], v[80:83], v[232:235]
    v_mfma_f32_16x16x32_bf16 v[228:231], v[48:51], v[76:79], v[228:231]
    ds_read_b128 v[48:51], v22 offset:64512
    s_waitcnt lgkmcnt(10)
    v_mfma_f32_16x16x32_bf16 v[240:243], v[52:55], v[80:83], v[240:243]
    v_mfma_f32_16x16x32_bf16 v[236:239], v[52:55], v[76:79], v[236:239]
    ds_read_b128 v[52:55], v22 offset:64768
    v_mfma_f32_16x16x32_bf16 v[248:251], v[56:59], v[80:83], v[248:251]
    v_mfma_f32_16x16x32_bf16 v[244:247], v[56:59], v[76:79], v[244:247]
    ds_read_b128 v[56:59], v22 offset:65024
    v_mfma_f32_16x16x32_bf16 v[64:67], v[60:63], v[80:83], v[64:67]
    v_mfma_f32_16x16x32_bf16 v[252:255], v[60:63], v[76:79], v[252:255]
    ds_read_b128 v[60:63], v22 offset:65280
    s_waitcnt lgkmcnt(6)
    v_mfma_f32_16x16x32_bf16 v[192:195], v[28:31], v[88:91], v[192:195]
    s_barrier
    v_mfma_f32_16x16x32_bf16 v[188:191], v[28:31], v[84:87], v[188:191]
    ds_read_b128 v[28:31], v18 offset:0
    v_mfma_f32_16x16x32_bf16 v[200:203], v[32:35], v[88:91], v[200:203]
    v_mfma_f32_16x16x32_bf16 v[196:199], v[32:35], v[84:87], v[196:199]
    ds_read_b128 v[32:35], v18 offset:256
    v_mfma_f32_16x16x32_bf16 v[208:211], v[36:39], v[88:91], v[208:211]
    v_mfma_f32_16x16x32_bf16 v[204:207], v[36:39], v[84:87], v[204:207]
    ds_read_b128 v[36:39], v18 offset:512
    s_waitcnt lgkmcnt(6)
    v_mfma_f32_16x16x32_bf16 v[216:219], v[40:43], v[88:91], v[216:219]
    v_mfma_f32_16x16x32_bf16 v[212:215], v[40:43], v[84:87], v[212:215]
    ds_read_b128 v[40:43], v18 offset:768
    v_mfma_f32_16x16x32_bf16 v[224:227], v[44:47], v[88:91], v[224:227]
    v_mfma_f32_16x16x32_bf16 v[220:223], v[44:47], v[84:87], v[220:223]
    ds_read_b128 v[44:47], v19 offset:0
    v_mfma_f32_16x16x32_bf16 v[232:235], v[48:51], v[88:91], v[232:235]
    v_mfma_f32_16x16x32_bf16 v[228:231], v[48:51], v[84:87], v[228:231]
    ds_read_b128 v[48:51], v22 offset:0
    s_waitcnt lgkmcnt(6)
    v_mfma_f32_16x16x32_bf16 v[240:243], v[52:55], v[88:91], v[240:243]
    v_mfma_f32_16x16x32_bf16 v[236:239], v[52:55], v[84:87], v[236:239]
    ds_read_b128 v[52:55], v22 offset:256
    v_mfma_f32_16x16x32_bf16 v[248:251], v[56:59], v[88:91], v[248:251]
    v_mfma_f32_16x16x32_bf16 v[244:247], v[56:59], v[84:87], v[244:247]
    ds_read_b128 v[56:59], v22 offset:512
    v_mfma_f32_16x16x32_bf16 v[64:67], v[60:63], v[88:91], v[64:67]
    v_mfma_f32_16x16x32_bf16 v[252:255], v[60:63], v[84:87], v[252:255]
    ds_read_b128 v[60:63], v22 offset:768
    s_waitcnt lgkmcnt(6)
    v_mfma_f32_16x16x32_bf16 v[192:195], v[28:31], v[96:99], v[192:195]
    v_mfma_f32_16x16x32_bf16 v[188:191], v[28:31], v[92:95], v[188:191]
    ds_read_b128 v[28:31], v18 offset:9216
    v_mfma_f32_16x16x32_bf16 v[200:203], v[32:35], v[96:99], v[200:203]
    v_mfma_f32_16x16x32_bf16 v[196:199], v[32:35], v[92:95], v[196:199]
    ds_read_b128 v[32:35], v18 offset:9472
    v_mfma_f32_16x16x32_bf16 v[208:211], v[36:39], v[96:99], v[208:211]
    v_mfma_f32_16x16x32_bf16 v[204:207], v[36:39], v[92:95], v[204:207]
    ds_read_b128 v[36:39], v18 offset:9728
    s_waitcnt lgkmcnt(6)
    v_mfma_f32_16x16x32_bf16 v[216:219], v[40:43], v[96:99], v[216:219]
    v_mfma_f32_16x16x32_bf16 v[212:215], v[40:43], v[92:95], v[212:215]
    ds_read_b128 v[40:43], v18 offset:9984
    v_mfma_f32_16x16x32_bf16 v[224:227], v[44:47], v[96:99], v[224:227]
    v_mfma_f32_16x16x32_bf16 v[220:223], v[44:47], v[92:95], v[220:223]
    ds_read_b128 v[44:47], v19 offset:9216
    v_mfma_f32_16x16x32_bf16 v[232:235], v[48:51], v[96:99], v[232:235]
    v_mfma_f32_16x16x32_bf16 v[228:231], v[48:51], v[92:95], v[228:231]
    ds_read_b128 v[48:51], v22 offset:9216
    s_waitcnt lgkmcnt(6)
    v_mfma_f32_16x16x32_bf16 v[240:243], v[52:55], v[96:99], v[240:243]
    v_mfma_f32_16x16x32_bf16 v[236:239], v[52:55], v[92:95], v[236:239]
    ds_read_b128 v[52:55], v22 offset:9472
    v_mfma_f32_16x16x32_bf16 v[248:251], v[56:59], v[96:99], v[248:251]
    v_mfma_f32_16x16x32_bf16 v[244:247], v[56:59], v[92:95], v[244:247]
    ds_read_b128 v[56:59], v22 offset:9728
    v_mfma_f32_16x16x32_bf16 v[64:67], v[60:63], v[96:99], v[64:67]
    v_mfma_f32_16x16x32_bf16 v[252:255], v[60:63], v[92:95], v[252:255]
    ds_read_b128 v[60:63], v22 offset:9984
    s_waitcnt lgkmcnt(6)
    v_mfma_f32_16x16x32_bf16 v[192:195], v[28:31], v[104:107], v[192:195]
    s_barrier
    ds_read_b64_tr_b16 v[80:81], v25 offset:16384
    v_mfma_f32_16x16x32_bf16 v[188:191], v[28:31], v[100:103], v[188:191]
    ds_read_b128 v[28:31], v18 offset:18432
    v_mfma_f32_16x16x32_bf16 v[200:203], v[32:35], v[104:107], v[200:203]
    ds_read_b64_tr_b16 v[82:83], v25 offset:20480
    v_mfma_f32_16x16x32_bf16 v[196:199], v[32:35], v[100:103], v[196:199]
    ds_read_b128 v[32:35], v18 offset:18688
    v_mfma_f32_16x16x32_bf16 v[208:211], v[36:39], v[104:107], v[208:211]
    ds_read_b64_tr_b16 v[76:77], v24 offset:16384
    v_mfma_f32_16x16x32_bf16 v[204:207], v[36:39], v[100:103], v[204:207]
    ds_read_b128 v[36:39], v18 offset:18944
    s_waitcnt lgkmcnt(9)
    v_mfma_f32_16x16x32_bf16 v[216:219], v[40:43], v[104:107], v[216:219]
    ds_read_b64_tr_b16 v[78:79], v24 offset:20480
    v_mfma_f32_16x16x32_bf16 v[212:215], v[40:43], v[100:103], v[212:215]
    ds_read_b128 v[40:43], v18 offset:19200
    v_mfma_f32_16x16x32_bf16 v[224:227], v[44:47], v[104:107], v[224:227]
    v_mfma_f32_16x16x32_bf16 v[220:223], v[44:47], v[100:103], v[220:223]
    ds_read_b128 v[44:47], v19 offset:18432
    v_mfma_f32_16x16x32_bf16 v[232:235], v[48:51], v[104:107], v[232:235]
    v_mfma_f32_16x16x32_bf16 v[228:231], v[48:51], v[100:103], v[228:231]
    ds_read_b128 v[48:51], v22 offset:18432
    s_waitcnt lgkmcnt(10)
    v_mfma_f32_16x16x32_bf16 v[240:243], v[52:55], v[104:107], v[240:243]
    v_mfma_f32_16x16x32_bf16 v[236:239], v[52:55], v[100:103], v[236:239]
    ds_read_b128 v[52:55], v22 offset:18688
    v_mfma_f32_16x16x32_bf16 v[248:251], v[56:59], v[104:107], v[248:251]
    s_branch L_skip_7
L_stub_7:
    s_branch L_stub_8
L_skip_7:
    v_mfma_f32_16x16x32_bf16 v[244:247], v[56:59], v[100:103], v[244:247]
    ds_read_b128 v[56:59], v22 offset:18944
    v_mfma_f32_16x16x32_bf16 v[64:67], v[60:63], v[104:107], v[64:67]
    v_mfma_f32_16x16x32_bf16 v[252:255], v[60:63], v[100:103], v[252:255]
    ds_read_b128 v[60:63], v22 offset:19200
    s_waitcnt lgkmcnt(6)
    v_mfma_f32_16x16x32_bf16 v[192:195], v[28:31], v[80:83], v[192:195]
    ds_read_b64_tr_b16 v[88:89], v25 offset:24576
    v_mfma_f32_16x16x32_bf16 v[188:191], v[28:31], v[76:79], v[188:191]
    ds_read_b128 v[28:31], v18 offset:27648
    v_mfma_f32_16x16x32_bf16 v[200:203], v[32:35], v[80:83], v[200:203]
    ds_read_b64_tr_b16 v[90:91], v25 offset:28672
    v_mfma_f32_16x16x32_bf16 v[196:199], v[32:35], v[76:79], v[196:199]
    ds_read_b128 v[32:35], v18 offset:27904
    v_mfma_f32_16x16x32_bf16 v[208:211], v[36:39], v[80:83], v[208:211]
    ds_read_b64_tr_b16 v[84:85], v24 offset:24576
    v_mfma_f32_16x16x32_bf16 v[204:207], v[36:39], v[76:79], v[204:207]
    ds_read_b128 v[36:39], v18 offset:28160
    s_waitcnt lgkmcnt(9)
    v_mfma_f32_16x16x32_bf16 v[216:219], v[40:43], v[80:83], v[216:219]
    ds_read_b64_tr_b16 v[86:87], v24 offset:28672
    v_mfma_f32_16x16x32_bf16 v[212:215], v[40:43], v[76:79], v[212:215]
    ds_read_b128 v[40:43], v18 offset:28416
    v_mfma_f32_16x16x32_bf16 v[224:227], v[44:47], v[80:83], v[224:227]
    v_mfma_f32_16x16x32_bf16 v[220:223], v[44:47], v[76:79], v[220:223]
    ds_read_b128 v[44:47], v19 offset:27648
    v_mfma_f32_16x16x32_bf16 v[232:235], v[48:51], v[80:83], v[232:235]
    v_mfma_f32_16x16x32_bf16 v[228:231], v[48:51], v[76:79], v[228:231]
    ds_read_b128 v[48:51], v22 offset:27648
    s_waitcnt lgkmcnt(10)
    v_mfma_f32_16x16x32_bf16 v[240:243], v[52:55], v[80:83], v[240:243]
    v_mfma_f32_16x16x32_bf16 v[236:239], v[52:55], v[76:79], v[236:239]
    ds_read_b128 v[52:55], v22 offset:27904
    v_mfma_f32_16x16x32_bf16 v[248:251], v[56:59], v[80:83], v[248:251]
    v_mfma_f32_16x16x32_bf16 v[244:247], v[56:59], v[76:79], v[244:247]
    ds_read_b128 v[56:59], v22 offset:28160
    v_mfma_f32_16x16x32_bf16 v[64:67], v[60:63], v[80:83], v[64:67]
    v_mfma_f32_16x16x32_bf16 v[252:255], v[60:63], v[76:79], v[252:255]
    ds_read_b128 v[60:63], v22 offset:28416
    s_waitcnt lgkmcnt(6)
    v_mfma_f32_16x16x32_bf16 v[192:195], v[28:31], v[88:91], v[192:195]
    s_barrier
    v_mfma_f32_16x16x32_bf16 v[188:191], v[28:31], v[84:87], v[188:191]
    ds_read_b128 v[28:31], v18 offset:36864
    v_mfma_f32_16x16x32_bf16 v[200:203], v[32:35], v[88:91], v[200:203]
    v_mfma_f32_16x16x32_bf16 v[196:199], v[32:35], v[84:87], v[196:199]
    ds_read_b128 v[32:35], v18 offset:37120
    v_mfma_f32_16x16x32_bf16 v[208:211], v[36:39], v[88:91], v[208:211]
    v_mfma_f32_16x16x32_bf16 v[204:207], v[36:39], v[84:87], v[204:207]
    ds_read_b128 v[36:39], v18 offset:37376
    s_waitcnt lgkmcnt(6)
    v_mfma_f32_16x16x32_bf16 v[216:219], v[40:43], v[88:91], v[216:219]
    v_mfma_f32_16x16x32_bf16 v[212:215], v[40:43], v[84:87], v[212:215]
    ds_read_b128 v[40:43], v18 offset:37632
    v_mfma_f32_16x16x32_bf16 v[224:227], v[44:47], v[88:91], v[224:227]
    v_mfma_f32_16x16x32_bf16 v[220:223], v[44:47], v[84:87], v[220:223]
    ds_read_b128 v[44:47], v19 offset:36864
    v_mfma_f32_16x16x32_bf16 v[232:235], v[48:51], v[88:91], v[232:235]
    v_mfma_f32_16x16x32_bf16 v[228:231], v[48:51], v[84:87], v[228:231]
    ds_read_b128 v[48:51], v22 offset:36864
    s_waitcnt lgkmcnt(6)
    v_mfma_f32_16x16x32_bf16 v[240:243], v[52:55], v[88:91], v[240:243]
    v_mfma_f32_16x16x32_bf16 v[236:239], v[52:55], v[84:87], v[236:239]
    ds_read_b128 v[52:55], v22 offset:37120
    v_mfma_f32_16x16x32_bf16 v[248:251], v[56:59], v[88:91], v[248:251]
    v_mfma_f32_16x16x32_bf16 v[244:247], v[56:59], v[84:87], v[244:247]
    ds_read_b128 v[56:59], v22 offset:37376
    v_mfma_f32_16x16x32_bf16 v[64:67], v[60:63], v[88:91], v[64:67]
    v_mfma_f32_16x16x32_bf16 v[252:255], v[60:63], v[84:87], v[252:255]
    ds_read_b128 v[60:63], v22 offset:37632
    s_waitcnt lgkmcnt(6)
    v_mfma_f32_16x16x32_bf16 v[192:195], v[28:31], v[112:115], v[192:195]
    v_mfma_f32_16x16x32_bf16 v[188:191], v[28:31], v[108:111], v[188:191]
    ds_read_b128 v[28:31], v18 offset:46080
    v_mfma_f32_16x16x32_bf16 v[200:203], v[32:35], v[112:115], v[200:203]
    v_mfma_f32_16x16x32_bf16 v[196:199], v[32:35], v[108:111], v[196:199]
    ds_read_b128 v[32:35], v18 offset:46336
    v_mfma_f32_16x16x32_bf16 v[208:211], v[36:39], v[112:115], v[208:211]
    v_mfma_f32_16x16x32_bf16 v[204:207], v[36:39], v[108:111], v[204:207]
    ds_read_b128 v[36:39], v18 offset:46592
    s_waitcnt lgkmcnt(6)
    v_mfma_f32_16x16x32_bf16 v[216:219], v[40:43], v[112:115], v[216:219]
    v_mfma_f32_16x16x32_bf16 v[212:215], v[40:43], v[108:111], v[212:215]
    ds_read_b128 v[40:43], v18 offset:46848
    v_mfma_f32_16x16x32_bf16 v[224:227], v[44:47], v[112:115], v[224:227]
    v_mfma_f32_16x16x32_bf16 v[220:223], v[44:47], v[108:111], v[220:223]
    ds_read_b128 v[44:47], v19 offset:46080
    v_mfma_f32_16x16x32_bf16 v[232:235], v[48:51], v[112:115], v[232:235]
    v_mfma_f32_16x16x32_bf16 v[228:231], v[48:51], v[108:111], v[228:231]
    ds_read_b128 v[48:51], v22 offset:46080
    s_waitcnt lgkmcnt(6)
    v_mfma_f32_16x16x32_bf16 v[240:243], v[52:55], v[112:115], v[240:243]
    v_mfma_f32_16x16x32_bf16 v[236:239], v[52:55], v[108:111], v[236:239]
    ds_read_b128 v[52:55], v22 offset:46336
    v_mfma_f32_16x16x32_bf16 v[248:251], v[56:59], v[112:115], v[248:251]
    v_mfma_f32_16x16x32_bf16 v[244:247], v[56:59], v[108:111], v[244:247]
    ds_read_b128 v[56:59], v22 offset:46592
    v_mfma_f32_16x16x32_bf16 v[64:67], v[60:63], v[112:115], v[64:67]
    v_mfma_f32_16x16x32_bf16 v[252:255], v[60:63], v[108:111], v[252:255]
    ds_read_b128 v[60:63], v22 offset:46848
    s_waitcnt lgkmcnt(6)
    v_mfma_f32_16x16x32_bf16 v[192:195], v[28:31], v[120:123], v[192:195]
    s_barrier
    ds_read_b64_tr_b16 v[80:81], v21 offset:0
    v_mfma_f32_16x16x32_bf16 v[188:191], v[28:31], v[116:119], v[188:191]
    ds_read_b128 v[28:31], v18 offset:55296
    v_mfma_f32_16x16x32_bf16 v[200:203], v[32:35], v[120:123], v[200:203]
    ds_read_b64_tr_b16 v[82:83], v21 offset:4096
    v_mfma_f32_16x16x32_bf16 v[196:199], v[32:35], v[116:119], v[196:199]
    ds_read_b128 v[32:35], v18 offset:55552
    v_mfma_f32_16x16x32_bf16 v[208:211], v[36:39], v[120:123], v[208:211]
    ds_read_b64_tr_b16 v[76:77], v20 offset:0
    v_mfma_f32_16x16x32_bf16 v[204:207], v[36:39], v[116:119], v[204:207]
    ds_read_b128 v[36:39], v18 offset:55808
    s_waitcnt lgkmcnt(9)
    v_mfma_f32_16x16x32_bf16 v[216:219], v[40:43], v[120:123], v[216:219]
    ds_read_b64_tr_b16 v[78:79], v20 offset:4096
    v_mfma_f32_16x16x32_bf16 v[212:215], v[40:43], v[116:119], v[212:215]
    ds_read_b128 v[40:43], v18 offset:56064
    v_mfma_f32_16x16x32_bf16 v[224:227], v[44:47], v[120:123], v[224:227]
    v_mfma_f32_16x16x32_bf16 v[220:223], v[44:47], v[116:119], v[220:223]
    ds_read_b128 v[44:47], v19 offset:55296
    v_mfma_f32_16x16x32_bf16 v[232:235], v[48:51], v[120:123], v[232:235]
    v_mfma_f32_16x16x32_bf16 v[228:231], v[48:51], v[116:119], v[228:231]
    ds_read_b128 v[48:51], v22 offset:55296
    s_waitcnt lgkmcnt(10)
    v_mfma_f32_16x16x32_bf16 v[240:243], v[52:55], v[120:123], v[240:243]
    v_mfma_f32_16x16x32_bf16 v[236:239], v[52:55], v[116:119], v[236:239]
    ds_read_b128 v[52:55], v22 offset:55552
    v_mfma_f32_16x16x32_bf16 v[248:251], v[56:59], v[120:123], v[248:251]
    v_mfma_f32_16x16x32_bf16 v[244:247], v[56:59], v[116:119], v[244:247]
    ds_read_b128 v[56:59], v22 offset:55808
    v_mfma_f32_16x16x32_bf16 v[64:67], v[60:63], v[120:123], v[64:67]
    v_mfma_f32_16x16x32_bf16 v[252:255], v[60:63], v[116:119], v[252:255]
    ds_read_b128 v[60:63], v22 offset:56064
    s_waitcnt lgkmcnt(6)
    v_mfma_f32_16x16x32_bf16 v[192:195], v[28:31], v[80:83], v[192:195]
    ds_read_b64_tr_b16 v[88:89], v21 offset:8192
    v_mfma_f32_16x16x32_bf16 v[188:191], v[28:31], v[76:79], v[188:191]
    ds_read_b128 v[28:31], v18 offset:64512
    v_mfma_f32_16x16x32_bf16 v[200:203], v[32:35], v[80:83], v[200:203]
    ds_read_b64_tr_b16 v[90:91], v21 offset:12288
    v_mfma_f32_16x16x32_bf16 v[196:199], v[32:35], v[76:79], v[196:199]
    ds_read_b128 v[32:35], v18 offset:64768
    v_mfma_f32_16x16x32_bf16 v[208:211], v[36:39], v[80:83], v[208:211]
    ds_read_b64_tr_b16 v[84:85], v20 offset:8192
    v_mfma_f32_16x16x32_bf16 v[204:207], v[36:39], v[76:79], v[204:207]
    ds_read_b128 v[36:39], v18 offset:65024
    s_waitcnt lgkmcnt(9)
    v_mfma_f32_16x16x32_bf16 v[216:219], v[40:43], v[80:83], v[216:219]
    ds_read_b64_tr_b16 v[86:87], v20 offset:12288
    v_mfma_f32_16x16x32_bf16 v[212:215], v[40:43], v[76:79], v[212:215]
    ds_read_b128 v[40:43], v18 offset:65280
    v_mfma_f32_16x16x32_bf16 v[224:227], v[44:47], v[80:83], v[224:227]
    v_mfma_f32_16x16x32_bf16 v[220:223], v[44:47], v[76:79], v[220:223]
    ds_read_b128 v[44:47], v19 offset:64512
    v_mfma_f32_16x16x32_bf16 v[232:235], v[48:51], v[80:83], v[232:235]
    v_mfma_f32_16x16x32_bf16 v[228:231], v[48:51], v[76:79], v[228:231]
    ds_read_b128 v[48:51], v22 offset:64512
    s_waitcnt lgkmcnt(10)
    v_mfma_f32_16x16x32_bf16 v[240:243], v[52:55], v[80:83], v[240:243]
    v_mfma_f32_16x16x32_bf16 v[236:239], v[52:55], v[76:79], v[236:239]
    ds_read_b128 v[52:55], v22 offset:64768
    v_mfma_f32_16x16x32_bf16 v[248:251], v[56:59], v[80:83], v[248:251]
    v_mfma_f32_16x16x32_bf16 v[244:247], v[56:59], v[76:79], v[244:247]
    ds_read_b128 v[56:59], v22 offset:65024
    v_mfma_f32_16x16x32_bf16 v[64:67], v[60:63], v[80:83], v[64:67]
    v_mfma_f32_16x16x32_bf16 v[252:255], v[60:63], v[76:79], v[252:255]
    ds_read_b128 v[60:63], v22 offset:65280
    s_waitcnt lgkmcnt(6)
    v_mfma_f32_16x16x32_bf16 v[192:195], v[28:31], v[88:91], v[192:195]
    s_barrier
    v_mfma_f32_16x16x32_bf16 v[188:191], v[28:31], v[84:87], v[188:191]
    ds_read_b128 v[28:31], v18 offset:0
    v_mfma_f32_16x16x32_bf16 v[200:203], v[32:35], v[88:91], v[200:203]
    v_mfma_f32_16x16x32_bf16 v[196:199], v[32:35], v[84:87], v[196:199]
    ds_read_b128 v[32:35], v18 offset:256
    v_mfma_f32_16x16x32_bf16 v[208:211], v[36:39], v[88:91], v[208:211]
    v_mfma_f32_16x16x32_bf16 v[204:207], v[36:39], v[84:87], v[204:207]
    ds_read_b128 v[36:39], v18 offset:512
    s_waitcnt lgkmcnt(6)
    v_mfma_f32_16x16x32_bf16 v[216:219], v[40:43], v[88:91], v[216:219]
    v_mfma_f32_16x16x32_bf16 v[212:215], v[40:43], v[84:87], v[212:215]
    ds_read_b128 v[40:43], v18 offset:768
    v_mfma_f32_16x16x32_bf16 v[224:227], v[44:47], v[88:91], v[224:227]
    v_mfma_f32_16x16x32_bf16 v[220:223], v[44:47], v[84:87], v[220:223]
    ds_read_b128 v[44:47], v19 offset:0
    v_mfma_f32_16x16x32_bf16 v[232:235], v[48:51], v[88:91], v[232:235]
    v_mfma_f32_16x16x32_bf16 v[228:231], v[48:51], v[84:87], v[228:231]
    ds_read_b128 v[48:51], v22 offset:0
    s_waitcnt lgkmcnt(6)
    v_mfma_f32_16x16x32_bf16 v[240:243], v[52:55], v[88:91], v[240:243]
    v_mfma_f32_16x16x32_bf16 v[236:239], v[52:55], v[84:87], v[236:239]
    ds_read_b128 v[52:55], v22 offset:256
    v_mfma_f32_16x16x32_bf16 v[248:251], v[56:59], v[88:91], v[248:251]
    v_mfma_f32_16x16x32_bf16 v[244:247], v[56:59], v[84:87], v[244:247]
    ds_read_b128 v[56:59], v22 offset:512
    v_mfma_f32_16x16x32_bf16 v[64:67], v[60:63], v[88:91], v[64:67]
    v_mfma_f32_16x16x32_bf16 v[252:255], v[60:63], v[84:87], v[252:255]
    ds_read_b128 v[60:63], v22 offset:768
    s_waitcnt lgkmcnt(6)
    v_mfma_f32_16x16x32_bf16 v[192:195], v[28:31], v[128:131], v[192:195]
    v_mfma_f32_16x16x32_bf16 v[188:191], v[28:31], v[124:127], v[188:191]
    ds_read_b128 v[28:31], v18 offset:9216
    v_mfma_f32_16x16x32_bf16 v[200:203], v[32:35], v[128:131], v[200:203]
    v_mfma_f32_16x16x32_bf16 v[196:199], v[32:35], v[124:127], v[196:199]
    ds_read_b128 v[32:35], v18 offset:9472
    v_mfma_f32_16x16x32_bf16 v[208:211], v[36:39], v[128:131], v[208:211]
    v_mfma_f32_16x16x32_bf16 v[204:207], v[36:39], v[124:127], v[204:207]
    ds_read_b128 v[36:39], v18 offset:9728
    s_waitcnt lgkmcnt(6)
    v_mfma_f32_16x16x32_bf16 v[216:219], v[40:43], v[128:131], v[216:219]
    v_mfma_f32_16x16x32_bf16 v[212:215], v[40:43], v[124:127], v[212:215]
    ds_read_b128 v[40:43], v18 offset:9984
    v_mfma_f32_16x16x32_bf16 v[224:227], v[44:47], v[128:131], v[224:227]
    v_mfma_f32_16x16x32_bf16 v[220:223], v[44:47], v[124:127], v[220:223]
    ds_read_b128 v[44:47], v19 offset:9216
    v_mfma_f32_16x16x32_bf16 v[232:235], v[48:51], v[128:131], v[232:235]
    v_mfma_f32_16x16x32_bf16 v[228:231], v[48:51], v[124:127], v[228:231]
    ds_read_b128 v[48:51], v22 offset:9216
    s_waitcnt lgkmcnt(6)
    v_mfma_f32_16x16x32_bf16 v[240:243], v[52:55], v[128:131], v[240:243]
    v_mfma_f32_16x16x32_bf16 v[236:239], v[52:55], v[124:127], v[236:239]
    ds_read_b128 v[52:55], v22 offset:9472
    v_mfma_f32_16x16x32_bf16 v[248:251], v[56:59], v[128:131], v[248:251]
    v_mfma_f32_16x16x32_bf16 v[244:247], v[56:59], v[124:127], v[244:247]
    ds_read_b128 v[56:59], v22 offset:9728
    v_mfma_f32_16x16x32_bf16 v[64:67], v[60:63], v[128:131], v[64:67]
    v_mfma_f32_16x16x32_bf16 v[252:255], v[60:63], v[124:127], v[252:255]
    ds_read_b128 v[60:63], v22 offset:9984
    s_waitcnt lgkmcnt(6)
    v_mfma_f32_16x16x32_bf16 v[192:195], v[28:31], v[136:139], v[192:195]
    s_barrier
    ds_read_b64_tr_b16 v[80:81], v21 offset:16384
    v_mfma_f32_16x16x32_bf16 v[188:191], v[28:31], v[132:135], v[188:191]
    ds_read_b128 v[28:31], v18 offset:18432
    v_mfma_f32_16x16x32_bf16 v[200:203], v[32:35], v[136:139], v[200:203]
    ds_read_b64_tr_b16 v[82:83], v21 offset:20480
    v_mfma_f32_16x16x32_bf16 v[196:199], v[32:35], v[132:135], v[196:199]
    ds_read_b128 v[32:35], v18 offset:18688
    v_mfma_f32_16x16x32_bf16 v[208:211], v[36:39], v[136:139], v[208:211]
    ds_read_b64_tr_b16 v[76:77], v20 offset:16384
    v_mfma_f32_16x16x32_bf16 v[204:207], v[36:39], v[132:135], v[204:207]
    ds_read_b128 v[36:39], v18 offset:18944
    s_waitcnt lgkmcnt(9)
    v_mfma_f32_16x16x32_bf16 v[216:219], v[40:43], v[136:139], v[216:219]
    ds_read_b64_tr_b16 v[78:79], v20 offset:20480
    v_mfma_f32_16x16x32_bf16 v[212:215], v[40:43], v[132:135], v[212:215]
    ds_read_b128 v[40:43], v18 offset:19200
    v_mfma_f32_16x16x32_bf16 v[224:227], v[44:47], v[136:139], v[224:227]
    v_mfma_f32_16x16x32_bf16 v[220:223], v[44:47], v[132:135], v[220:223]
    ds_read_b128 v[44:47], v19 offset:18432
    v_mfma_f32_16x16x32_bf16 v[232:235], v[48:51], v[136:139], v[232:235]
    v_mfma_f32_16x16x32_bf16 v[228:231], v[48:51], v[132:135], v[228:231]
    ds_read_b128 v[48:51], v22 offset:18432
    s_waitcnt lgkmcnt(10)
    v_mfma_f32_16x16x32_bf16 v[240:243], v[52:55], v[136:139], v[240:243]
    v_mfma_f32_16x16x32_bf16 v[236:239], v[52:55], v[132:135], v[236:239]
    ds_read_b128 v[52:55], v22 offset:18688
    v_mfma_f32_16x16x32_bf16 v[248:251], v[56:59], v[136:139], v[248:251]
    v_mfma_f32_16x16x32_bf16 v[244:247], v[56:59], v[132:135], v[244:247]
    ds_read_b128 v[56:59], v22 offset:18944
    v_mfma_f32_16x16x32_bf16 v[64:67], v[60:63], v[136:139], v[64:67]
    v_mfma_f32_16x16x32_bf16 v[252:255], v[60:63], v[132:135], v[252:255]
    ds_read_b128 v[60:63], v22 offset:19200
    s_waitcnt lgkmcnt(6)
    v_mfma_f32_16x16x32_bf16 v[192:195], v[28:31], v[80:83], v[192:195]
    ds_read_b64_tr_b16 v[88:89], v21 offset:24576
    v_mfma_f32_16x16x32_bf16 v[188:191], v[28:31], v[76:79], v[188:191]
    ds_read_b128 v[28:31], v18 offset:27648
    v_mfma_f32_16x16x32_bf16 v[200:203], v[32:35], v[80:83], v[200:203]
    ds_read_b64_tr_b16 v[90:91], v21 offset:28672
    v_mfma_f32_16x16x32_bf16 v[196:199], v[32:35], v[76:79], v[196:199]
    ds_read_b128 v[32:35], v18 offset:27904
    v_mfma_f32_16x16x32_bf16 v[208:211], v[36:39], v[80:83], v[208:211]
    ds_read_b64_tr_b16 v[84:85], v20 offset:24576
    v_mfma_f32_16x16x32_bf16 v[204:207], v[36:39], v[76:79], v[204:207]
    ds_read_b128 v[36:39], v18 offset:28160
    s_waitcnt lgkmcnt(9)
    v_mfma_f32_16x16x32_bf16 v[216:219], v[40:43], v[80:83], v[216:219]
    ds_read_b64_tr_b16 v[86:87], v20 offset:28672
    v_mfma_f32_16x16x32_bf16 v[212:215], v[40:43], v[76:79], v[212:215]
    ds_read_b128 v[40:43], v18 offset:28416
    v_mfma_f32_16x16x32_bf16 v[224:227], v[44:47], v[80:83], v[224:227]
    v_mfma_f32_16x16x32_bf16 v[220:223], v[44:47], v[76:79], v[220:223]
    ds_read_b128 v[44:47], v19 offset:27648
    v_mfma_f32_16x16x32_bf16 v[232:235], v[48:51], v[80:83], v[232:235]
    v_mfma_f32_16x16x32_bf16 v[228:231], v[48:51], v[76:79], v[228:231]
    ds_read_b128 v[48:51], v22 offset:27648
    s_waitcnt lgkmcnt(10)
    v_mfma_f32_16x16x32_bf16 v[240:243], v[52:55], v[80:83], v[240:243]
    v_mfma_f32_16x16x32_bf16 v[236:239], v[52:55], v[76:79], v[236:239]
    ds_read_b128 v[52:55], v22 offset:27904
    v_mfma_f32_16x16x32_bf16 v[248:251], v[56:59], v[80:83], v[248:251]
    v_mfma_f32_16x16x32_bf16 v[244:247], v[56:59], v[76:79], v[244:247]
    ds_read_b128 v[56:59], v22 offset:28160
    v_mfma_f32_16x16x32_bf16 v[64:67], v[60:63], v[80:83], v[64:67]
    v_mfma_f32_16x16x32_bf16 v[252:255], v[60:63], v[76:79], v[252:255]
    ds_read_b128 v[60:63], v22 offset:28416
    s_waitcnt lgkmcnt(6)
    v_mfma_f32_16x16x32_bf16 v[192:195], v[28:31], v[88:91], v[192:195]
    s_barrier
    v_mfma_f32_16x16x32_bf16 v[188:191], v[28:31], v[84:87], v[188:191]
    ds_read_b128 v[28:31], v18 offset:36864
    v_mfma_f32_16x16x32_bf16 v[200:203], v[32:35], v[88:91], v[200:203]
    v_mfma_f32_16x16x32_bf16 v[196:199], v[32:35], v[84:87], v[196:199]
    ds_read_b128 v[32:35], v18 offset:37120
    v_mfma_f32_16x16x32_bf16 v[208:211], v[36:39], v[88:91], v[208:211]
    v_mfma_f32_16x16x32_bf16 v[204:207], v[36:39], v[84:87], v[204:207]
    ds_read_b128 v[36:39], v18 offset:37376
    s_waitcnt lgkmcnt(6)
    v_mfma_f32_16x16x32_bf16 v[216:219], v[40:43], v[88:91], v[216:219]
    v_mfma_f32_16x16x32_bf16 v[212:215], v[40:43], v[84:87], v[212:215]
    ds_read_b128 v[40:43], v18 offset:37632
    v_mfma_f32_16x16x32_bf16 v[224:227], v[44:47], v[88:91], v[224:227]
    v_mfma_f32_16x16x32_bf16 v[220:223], v[44:47], v[84:87], v[220:223]
    ds_read_b128 v[44:47], v19 offset:36864
    v_mfma_f32_16x16x32_bf16 v[232:235], v[48:51], v[88:91], v[232:235]
    v_mfma_f32_16x16x32_bf16 v[228:231], v[48:51], v[84:87], v[228:231]
    ds_read_b128 v[48:51], v22 offset:36864
    s_waitcnt lgkmcnt(6)
    v_mfma_f32_16x16x32_bf16 v[240:243], v[52:55], v[88:91], v[240:243]
    v_mfma_f32_16x16x32_bf16 v[236:239], v[52:55], v[84:87], v[236:239]
    ds_read_b128 v[52:55], v22 offset:37120
    v_mfma_f32_16x16x32_bf16 v[248:251], v[56:59], v[88:91], v[248:251]
    v_mfma_f32_16x16x32_bf16 v[244:247], v[56:59], v[84:87], v[244:247]
    ds_read_b128 v[56:59], v22 offset:37376
    v_mfma_f32_16x16x32_bf16 v[64:67], v[60:63], v[88:91], v[64:67]
    v_mfma_f32_16x16x32_bf16 v[252:255], v[60:63], v[84:87], v[252:255]
    ds_read_b128 v[60:63], v22 offset:37632
    s_waitcnt lgkmcnt(6)
    v_mfma_f32_16x16x32_bf16 v[192:195], v[28:31], v[144:147], v[192:195]
    v_mfma_f32_16x16x32_bf16 v[188:191], v[28:31], v[140:143], v[188:191]
    ds_read_b128 v[28:31], v18 offset:46080
    v_mfma_f32_16x16x32_bf16 v[200:203], v[32:35], v[144:147], v[200:203]
    v_mfma_f32_16x16x32_bf16 v[196:199], v[32:35], v[140:143], v[196:199]
    ds_read_b128 v[32:35], v18 offset:46336
    v_mfma_f32_16x16x32_bf16 v[208:211], v[36:39], v[144:147], v[208:211]
    v_mfma_f32_16x16x32_bf16 v[204:207], v[36:39], v[140:143], v[204:207]
    ds_read_b128 v[36:39], v18 offset:46592
    s_waitcnt lgkmcnt(6)
    v_mfma_f32_16x16x32_bf16 v[216:219], v[40:43], v[144:147], v[216:219]
    v_mfma_f32_16x16x32_bf16 v[212:215], v[40:43], v[140:143], v[212:215]
    ds_read_b128 v[40:43], v18 offset:46848
    v_mfma_f32_16x16x32_bf16 v[224:227], v[44:47], v[144:147], v[224:227]
    v_mfma_f32_16x16x32_bf16 v[220:223], v[44:47], v[140:143], v[220:223]
    ds_read_b128 v[44:47], v19 offset:46080
    v_mfma_f32_16x16x32_bf16 v[232:235], v[48:51], v[144:147], v[232:235]
    v_mfma_f32_16x16x32_bf16 v[228:231], v[48:51], v[140:143], v[228:231]
    ds_read_b128 v[48:51], v22 offset:46080
    s_waitcnt lgkmcnt(6)
    v_mfma_f32_16x16x32_bf16 v[240:243], v[52:55], v[144:147], v[240:243]
    v_mfma_f32_16x16x32_bf16 v[236:239], v[52:55], v[140:143], v[236:239]
    ds_read_b128 v[52:55], v22 offset:46336
    v_mfma_f32_16x16x32_bf16 v[248:251], v[56:59], v[144:147], v[248:251]
    v_mfma_f32_16x16x32_bf16 v[244:247], v[56:59], v[140:143], v[244:247]
    ds_read_b128 v[56:59], v22 offset:46592
    v_mfma_f32_16x16x32_bf16 v[64:67], v[60:63], v[144:147], v[64:67]
    v_mfma_f32_16x16x32_bf16 v[252:255], v[60:63], v[140:143], v[252:255]
    ds_read_b128 v[60:63], v22 offset:46848
    s_waitcnt lgkmcnt(6)
    v_mfma_f32_16x16x32_bf16 v[192:195], v[28:31], v[152:155], v[192:195]
    s_barrier
    v_mfma_f32_16x16x32_bf16 v[188:191], v[28:31], v[148:151], v[188:191]
    ds_read_b128 v[28:31], v18 offset:55296
    v_mfma_f32_16x16x32_bf16 v[200:203], v[32:35], v[152:155], v[200:203]
    v_mfma_f32_16x16x32_bf16 v[196:199], v[32:35], v[148:151], v[196:199]
    ds_read_b128 v[32:35], v18 offset:55552
    v_mfma_f32_16x16x32_bf16 v[208:211], v[36:39], v[152:155], v[208:211]
    v_mfma_f32_16x16x32_bf16 v[204:207], v[36:39], v[148:151], v[204:207]
    ds_read_b128 v[36:39], v18 offset:55808
    s_waitcnt lgkmcnt(6)
    v_mfma_f32_16x16x32_bf16 v[216:219], v[40:43], v[152:155], v[216:219]
    v_mfma_f32_16x16x32_bf16 v[212:215], v[40:43], v[148:151], v[212:215]
    ds_read_b128 v[40:43], v18 offset:56064
    v_mfma_f32_16x16x32_bf16 v[224:227], v[44:47], v[152:155], v[224:227]
    v_mfma_f32_16x16x32_bf16 v[220:223], v[44:47], v[148:151], v[220:223]
    ds_read_b128 v[44:47], v19 offset:55296
    v_mfma_f32_16x16x32_bf16 v[232:235], v[48:51], v[152:155], v[232:235]
    v_mfma_f32_16x16x32_bf16 v[228:231], v[48:51], v[148:151], v[228:231]
    ds_read_b128 v[48:51], v22 offset:55296
    s_waitcnt lgkmcnt(6)
    v_mfma_f32_16x16x32_bf16 v[240:243], v[52:55], v[152:155], v[240:243]
    v_mfma_f32_16x16x32_bf16 v[236:239], v[52:55], v[148:151], v[236:239]
    ds_read_b128 v[52:55], v22 offset:55552
    v_mfma_f32_16x16x32_bf16 v[248:251], v[56:59], v[152:155], v[248:251]
    v_mfma_f32_16x16x32_bf16 v[244:247], v[56:59], v[148:151], v[244:247]
    ds_read_b128 v[56:59], v22 offset:55808
    v_mfma_f32_16x16x32_bf16 v[64:67], v[60:63], v[152:155], v[64:67]
    v_mfma_f32_16x16x32_bf16 v[252:255], v[60:63], v[148:151], v[252:255]
    ds_read_b128 v[60:63], v22 offset:56064
    s_waitcnt lgkmcnt(6)
    v_mfma_f32_16x16x32_bf16 v[192:195], v[28:31], v[160:163], v[192:195]
    v_mfma_f32_16x16x32_bf16 v[188:191], v[28:31], v[156:159], v[188:191]
    ds_read_b128 v[28:31], v18 offset:64512
    v_mfma_f32_16x16x32_bf16 v[200:203], v[32:35], v[160:163], v[200:203]
    v_mfma_f32_16x16x32_bf16 v[196:199], v[32:35], v[156:159], v[196:199]
    ds_read_b128 v[32:35], v18 offset:64768
    v_mfma_f32_16x16x32_bf16 v[208:211], v[36:39], v[160:163], v[208:211]
    v_mfma_f32_16x16x32_bf16 v[204:207], v[36:39], v[156:159], v[204:207]
    ds_read_b128 v[36:39], v18 offset:65024
    s_waitcnt lgkmcnt(6)
    v_mfma_f32_16x16x32_bf16 v[216:219], v[40:43], v[160:163], v[216:219]
    v_mfma_f32_16x16x32_bf16 v[212:215], v[40:43], v[156:159], v[212:215]
    ds_read_b128 v[40:43], v18 offset:65280
    v_mfma_f32_16x16x32_bf16 v[224:227], v[44:47], v[160:163], v[224:227]
    v_mfma_f32_16x16x32_bf16 v[220:223], v[44:47], v[156:159], v[220:223]
    ds_read_b128 v[44:47], v19 offset:64512
    v_mfma_f32_16x16x32_bf16 v[232:235], v[48:51], v[160:163], v[232:235]
    v_mfma_f32_16x16x32_bf16 v[228:231], v[48:51], v[156:159], v[228:231]
    ds_read_b128 v[48:51], v22 offset:64512
    s_waitcnt lgkmcnt(6)
    v_mfma_f32_16x16x32_bf16 v[240:243], v[52:55], v[160:163], v[240:243]
    v_mfma_f32_16x16x32_bf16 v[236:239], v[52:55], v[156:159], v[236:239]
    ds_read_b128 v[52:55], v22 offset:64768
    v_mfma_f32_16x16x32_bf16 v[248:251], v[56:59], v[160:163], v[248:251]
    v_mfma_f32_16x16x32_bf16 v[244:247], v[56:59], v[156:159], v[244:247]
    ds_read_b128 v[56:59], v22 offset:65024
    v_mfma_f32_16x16x32_bf16 v[64:67], v[60:63], v[160:163], v[64:67]
    v_mfma_f32_16x16x32_bf16 v[252:255], v[60:63], v[156:159], v[252:255]
    ds_read_b128 v[60:63], v22 offset:65280
    s_waitcnt lgkmcnt(6)
    v_mfma_f32_16x16x32_bf16 v[192:195], v[28:31], v[168:171], v[192:195]
    s_barrier
    v_mfma_f32_16x16x32_bf16 v[188:191], v[28:31], v[164:167], v[188:191]
    ds_read_b128 v[28:31], v18 offset:0
    v_mfma_f32_16x16x32_bf16 v[200:203], v[32:35], v[168:171], v[200:203]
    v_mfma_f32_16x16x32_bf16 v[196:199], v[32:35], v[164:167], v[196:199]
    ds_read_b128 v[32:35], v18 offset:256
    v_mfma_f32_16x16x32_bf16 v[208:211], v[36:39], v[168:171], v[208:211]
    v_mfma_f32_16x16x32_bf16 v[204:207], v[36:39], v[164:167], v[204:207]
    ds_read_b128 v[36:39], v18 offset:512
    s_waitcnt lgkmcnt(6)
    v_mfma_f32_16x16x32_bf16 v[216:219], v[40:43], v[168:171], v[216:219]
    v_mfma_f32_16x16x32_bf16 v[212:215], v[40:43], v[164:167], v[212:215]
    ds_read_b128 v[40:43], v18 offset:768
    v_mfma_f32_16x16x32_bf16 v[224:227], v[44:47], v[168:171], v[224:227]
    v_mfma_f32_16x16x32_bf16 v[220:223], v[44:47], v[164:167], v[220:223]
    ds_read_b128 v[44:47], v19 offset:0
    v_mfma_f32_16x16x32_bf16 v[232:235], v[48:51], v[168:171], v[232:235]
    v_mfma_f32_16x16x32_bf16 v[228:231], v[48:51], v[164:167], v[228:231]
    ds_read_b128 v[48:51], v22 offset:0
    s_waitcnt lgkmcnt(6)
    v_mfma_f32_16x16x32_bf16 v[240:243], v[52:55], v[168:171], v[240:243]
    v_mfma_f32_16x16x32_bf16 v[236:239], v[52:55], v[164:167], v[236:239]
    ds_read_b128 v[52:55], v22 offset:256
    v_mfma_f32_16x16x32_bf16 v[248:251], v[56:59], v[168:171], v[248:251]
    v_mfma_f32_16x16x32_bf16 v[244:247], v[56:59], v[164:167], v[244:247]
    ds_read_b128 v[56:59], v22 offset:512
    v_mfma_f32_16x16x32_bf16 v[64:67], v[60:63], v[168:171], v[64:67]
    v_mfma_f32_16x16x32_bf16 v[252:255], v[60:63], v[164:167], v[252:255]
    ds_read_b128 v[60:63], v22 offset:768
    s_waitcnt lgkmcnt(6)
    v_mfma_f32_16x16x32_bf16 v[192:195], v[28:31], v[176:179], v[192:195]
    v_mfma_f32_16x16x32_bf16 v[188:191], v[28:31], v[172:175], v[188:191]
    ds_read_b128 v[28:31], v18 offset:9216
    v_mfma_f32_16x16x32_bf16 v[200:203], v[32:35], v[176:179], v[200:203]
    v_mfma_f32_16x16x32_bf16 v[196:199], v[32:35], v[172:175], v[196:199]
    ds_read_b128 v[32:35], v18 offset:9472
    v_mfma_f32_16x16x32_bf16 v[208:211], v[36:39], v[176:179], v[208:211]
    v_mfma_f32_16x16x32_bf16 v[204:207], v[36:39], v[172:175], v[204:207]
    ds_read_b128 v[36:39], v18 offset:9728
    s_waitcnt lgkmcnt(6)
    v_mfma_f32_16x16x32_bf16 v[216:219], v[40:43], v[176:179], v[216:219]
    v_mfma_f32_16x16x32_bf16 v[212:215], v[40:43], v[172:175], v[212:215]
    ds_read_b128 v[40:43], v18 offset:9984
    v_mfma_f32_16x16x32_bf16 v[224:227], v[44:47], v[176:179], v[224:227]
    v_mfma_f32_16x16x32_bf16 v[220:223], v[44:47], v[172:175], v[220:223]
    ds_read_b128 v[44:47], v19 offset:9216
    v_mfma_f32_16x16x32_bf16 v[232:235], v[48:51], v[176:179], v[232:235]
    v_mfma_f32_16x16x32_bf16 v[228:231], v[48:51], v[172:175], v[228:231]
    ds_read_b128 v[48:51], v22 offset:9216
    s_waitcnt lgkmcnt(6)
    v_mfma_f32_16x16x32_bf16 v[240:243], v[52:55], v[176:179], v[240:243]
    v_mfma_f32_16x16x32_bf16 v[236:239], v[52:55], v[172:175], v[236:239]
    ds_read_b128 v[52:55], v22 offset:9472
    v_mfma_f32_16x16x32_bf16 v[248:251], v[56:59], v[176:179], v[248:251]
    v_mfma_f32_16x16x32_bf16 v[244:247], v[56:59], v[172:175], v[244:247]
    ds_read_b128 v[56:59], v22 offset:9728
    v_mfma_f32_16x16x32_bf16 v[64:67], v[60:63], v[176:179], v[64:67]
    v_mfma_f32_16x16x32_bf16 v[252:255], v[60:63], v[172:175], v[252:255]
    ds_read_b128 v[60:63], v22 offset:9984
    s_waitcnt lgkmcnt(6)
    v_mfma_f32_16x16x32_bf16 v[192:195], v[28:31], v[184:187], v[192:195]
    s_barrier
    ds_read_b64_tr_b16 v[80:81], v21 offset:32768
    v_mfma_f32_16x16x32_bf16 v[188:191], v[28:31], v[180:183], v[188:191]
    ds_read_b128 v[28:31], v18 offset:18432
    v_mfma_f32_16x16x32_bf16 v[200:203], v[32:35], v[184:187], v[200:203]
    ds_read_b64_tr_b16 v[82:83], v21 offset:36864
    v_mfma_f32_16x16x32_bf16 v[196:199], v[32:35], v[180:183], v[196:199]
    ds_read_b128 v[32:35], v18 offset:18688
    v_mfma_f32_16x16x32_bf16 v[208:211], v[36:39], v[184:187], v[208:211]
    ds_read_b64_tr_b16 v[76:77], v20 offset:32768
    v_mfma_f32_16x16x32_bf16 v[204:207], v[36:39], v[180:183], v[204:207]
    ds_read_b128 v[36:39], v18 offset:18944
    s_waitcnt lgkmcnt(9)
    v_mfma_f32_16x16x32_bf16 v[216:219], v[40:43], v[184:187], v[216:219]
    ds_read_b64_tr_b16 v[78:79], v20 offset:36864
    v_mfma_f32_16x16x32_bf16 v[212:215], v[40:43], v[180:183], v[212:215]
    ds_read_b128 v[40:43], v18 offset:19200
    v_mfma_f32_16x16x32_bf16 v[224:227], v[44:47], v[184:187], v[224:227]
    v_mfma_f32_16x16x32_bf16 v[220:223], v[44:47], v[180:183], v[220:223]
    ds_read_b128 v[44:47], v19 offset:18432
    v_mfma_f32_16x16x32_bf16 v[232:235], v[48:51], v[184:187], v[232:235]
    v_mfma_f32_16x16x32_bf16 v[228:231], v[48:51], v[180:183], v[228:231]
    ds_read_b128 v[48:51], v22 offset:18432
    s_waitcnt lgkmcnt(10)
    v_mfma_f32_16x16x32_bf16 v[240:243], v[52:55], v[184:187], v[240:243]
    v_mfma_f32_16x16x32_bf16 v[236:239], v[52:55], v[180:183], v[236:239]
    ds_read_b128 v[52:55], v22 offset:18688
    v_mfma_f32_16x16x32_bf16 v[248:251], v[56:59], v[184:187], v[248:251]
    v_mfma_f32_16x16x32_bf16 v[244:247], v[56:59], v[180:183], v[244:247]
    ds_read_b128 v[56:59], v22 offset:18944
    v_mfma_f32_16x16x32_bf16 v[64:67], v[60:63], v[184:187], v[64:67]
    v_mfma_f32_16x16x32_bf16 v[252:255], v[60:63], v[180:183], v[252:255]
    ds_read_b128 v[60:63], v22 offset:19200
    s_waitcnt lgkmcnt(6)
    v_mfma_f32_16x16x32_bf16 v[192:195], v[28:31], v[80:83], v[192:195]
    ds_read_b64_tr_b16 v[88:89], v21 offset:40960
    v_mfma_f32_16x16x32_bf16 v[188:191], v[28:31], v[76:79], v[188:191]
    ds_read_b128 v[28:31], v18 offset:27648
    v_mfma_f32_16x16x32_bf16 v[200:203], v[32:35], v[80:83], v[200:203]
    ds_read_b64_tr_b16 v[90:91], v21 offset:45056
    v_mfma_f32_16x16x32_bf16 v[196:199], v[32:35], v[76:79], v[196:199]
    ds_read_b128 v[32:35], v18 offset:27904
    v_mfma_f32_16x16x32_bf16 v[208:211], v[36:39], v[80:83], v[208:211]
    ds_read_b64_tr_b16 v[84:85], v20 offset:40960
    v_mfma_f32_16x16x32_bf16 v[204:207], v[36:39], v[76:79], v[204:207]
    ds_read_b128 v[36:39], v18 offset:28160
    s_waitcnt lgkmcnt(9)
    v_mfma_f32_16x16x32_bf16 v[216:219], v[40:43], v[80:83], v[216:219]
    ds_read_b64_tr_b16 v[86:87], v20 offset:45056
    v_mfma_f32_16x16x32_bf16 v[212:215], v[40:43], v[76:79], v[212:215]
    ds_read_b128 v[40:43], v18 offset:28416
    v_mfma_f32_16x16x32_bf16 v[224:227], v[44:47], v[80:83], v[224:227]
    v_mfma_f32_16x16x32_bf16 v[220:223], v[44:47], v[76:79], v[220:223]
    ds_read_b128 v[44:47], v19 offset:27648
    v_mfma_f32_16x16x32_bf16 v[232:235], v[48:51], v[80:83], v[232:235]
    v_mfma_f32_16x16x32_bf16 v[228:231], v[48:51], v[76:79], v[228:231]
    s_branch L_skip_8
L_stub_8:
    s_branch L_stub_9
L_skip_8:
    ds_read_b128 v[48:51], v22 offset:27648
    s_waitcnt lgkmcnt(10)
    v_mfma_f32_16x16x32_bf16 v[240:243], v[52:55], v[80:83], v[240:243]
    v_mfma_f32_16x16x32_bf16 v[236:239], v[52:55], v[76:79], v[236:239]
    ds_read_b128 v[52:55], v22 offset:27904
    v_mfma_f32_16x16x32_bf16 v[248:251], v[56:59], v[80:83], v[248:251]
    v_mfma_f32_16x16x32_bf16 v[244:247], v[56:59], v[76:79], v[244:247]
    ds_read_b128 v[56:59], v22 offset:28160
    v_mfma_f32_16x16x32_bf16 v[64:67], v[60:63], v[80:83], v[64:67]
    v_mfma_f32_16x16x32_bf16 v[252:255], v[60:63], v[76:79], v[252:255]
    ds_read_b128 v[60:63], v22 offset:28416
    s_waitcnt lgkmcnt(6)
    v_mfma_f32_16x16x32_bf16 v[192:195], v[28:31], v[88:91], v[192:195]
    s_barrier
    ds_read_b64_tr_b16 v[80:81], v25 offset:0
    v_mfma_f32_16x16x32_bf16 v[188:191], v[28:31], v[84:87], v[188:191]
    ds_read_b128 v[28:31], v18 offset:36864
    v_mfma_f32_16x16x32_bf16 v[200:203], v[32:35], v[88:91], v[200:203]
    ds_read_b64_tr_b16 v[82:83], v25 offset:4096
    v_mfma_f32_16x16x32_bf16 v[196:199], v[32:35], v[84:87], v[196:199]
    ds_read_b128 v[32:35], v18 offset:37120
    v_mfma_f32_16x16x32_bf16 v[208:211], v[36:39], v[88:91], v[208:211]
    ds_read_b64_tr_b16 v[92:93], v24 offset:0
    v_mfma_f32_16x16x32_bf16 v[204:207], v[36:39], v[84:87], v[204:207]
    ds_read_b128 v[36:39], v18 offset:37376
    s_waitcnt lgkmcnt(9)
    v_mfma_f32_16x16x32_bf16 v[216:219], v[40:43], v[88:91], v[216:219]
    ds_read_b64_tr_b16 v[94:95], v24 offset:4096
    v_mfma_f32_16x16x32_bf16 v[212:215], v[40:43], v[84:87], v[212:215]
    ds_read_b128 v[40:43], v18 offset:37632
    v_mfma_f32_16x16x32_bf16 v[224:227], v[44:47], v[88:91], v[224:227]
    v_mfma_f32_16x16x32_bf16 v[220:223], v[44:47], v[84:87], v[220:223]
    ds_read_b128 v[44:47], v19 offset:36864
    v_mfma_f32_16x16x32_bf16 v[232:235], v[48:51], v[88:91], v[232:235]
    v_mfma_f32_16x16x32_bf16 v[228:231], v[48:51], v[84:87], v[228:231]
    ds_read_b128 v[48:51], v22 offset:36864
    s_waitcnt lgkmcnt(10)
    v_mfma_f32_16x16x32_bf16 v[240:243], v[52:55], v[88:91], v[240:243]
    v_mfma_f32_16x16x32_bf16 v[236:239], v[52:55], v[84:87], v[236:239]
    ds_read_b128 v[52:55], v22 offset:37120
    v_mfma_f32_16x16x32_bf16 v[248:251], v[56:59], v[88:91], v[248:251]
    v_mfma_f32_16x16x32_bf16 v[244:247], v[56:59], v[84:87], v[244:247]
    ds_read_b128 v[56:59], v22 offset:37376
    v_mfma_f32_16x16x32_bf16 v[64:67], v[60:63], v[88:91], v[64:67]
    v_mfma_f32_16x16x32_bf16 v[252:255], v[60:63], v[84:87], v[252:255]
    ds_read_b128 v[60:63], v22 offset:37632
    s_waitcnt lgkmcnt(7)
    v_mfma_f32_16x16x32_bf16 v[192:195], v[28:31], v[80:83], v[192:195]
    ds_read_b128 v[28:31], v18 offset:46080
    ds_read_b64_tr_b16 v[88:89], v25 offset:8192
    v_mfma_f32_16x16x32_bf16 v[200:203], v[32:35], v[80:83], v[200:203]
    ds_read_b128 v[32:35], v18 offset:46336
    ds_read_b64_tr_b16 v[90:91], v25 offset:12288
    v_mfma_f32_16x16x32_bf16 v[208:211], v[36:39], v[80:83], v[208:211]
    ds_read_b128 v[36:39], v18 offset:46592
    s_waitcnt lgkmcnt(8)
    v_mfma_f32_16x16x32_bf16 v[216:219], v[40:43], v[80:83], v[216:219]
    ds_read_b128 v[40:43], v18 offset:46848
    v_mfma_f32_16x16x32_bf16 v[224:227], v[44:47], v[80:83], v[224:227]
    ds_read_b128 v[44:47], v19 offset:46080
    v_mfma_f32_16x16x32_bf16 v[232:235], v[48:51], v[80:83], v[232:235]
    ds_read_b128 v[48:51], v22 offset:46080
    ds_read_b64_tr_b16 v[96:97], v24 offset:8192
    s_waitcnt lgkmcnt(9)
    v_mfma_f32_16x16x32_bf16 v[240:243], v[52:55], v[80:83], v[240:243]
    ds_read_b128 v[52:55], v22 offset:46336
    ds_read_b64_tr_b16 v[98:99], v24 offset:12288
    v_mfma_f32_16x16x32_bf16 v[248:251], v[56:59], v[80:83], v[248:251]
    ds_read_b128 v[56:59], v22 offset:46592
    v_mfma_f32_16x16x32_bf16 v[64:67], v[60:63], v[80:83], v[64:67]
    ds_read_b128 v[60:63], v22 offset:46848
    s_waitcnt lgkmcnt(8)
    v_mfma_f32_16x16x32_bf16 v[192:195], v[28:31], v[88:91], v[192:195]
    s_barrier
    ds_read_b128 v[28:31], v18 offset:55296
    ds_read_b64_tr_b16 v[80:81], v25 offset:16384
    v_mfma_f32_16x16x32_bf16 v[200:203], v[32:35], v[88:91], v[200:203]
    ds_read_b128 v[32:35], v18 offset:55552
    ds_read_b64_tr_b16 v[82:83], v25 offset:20480
    v_mfma_f32_16x16x32_bf16 v[208:211], v[36:39], v[88:91], v[208:211]
    ds_read_b128 v[36:39], v18 offset:55808
    s_waitcnt lgkmcnt(10)
    v_mfma_f32_16x16x32_bf16 v[216:219], v[40:43], v[88:91], v[216:219]
    ds_read_b128 v[40:43], v18 offset:56064
    v_mfma_f32_16x16x32_bf16 v[224:227], v[44:47], v[88:91], v[224:227]
    ds_read_b128 v[44:47], v19 offset:55296
    v_mfma_f32_16x16x32_bf16 v[232:235], v[48:51], v[88:91], v[232:235]
    ds_read_b128 v[48:51], v22 offset:55296
    ds_read_b64_tr_b16 v[100:101], v24 offset:16384
    s_waitcnt lgkmcnt(9)
    v_mfma_f32_16x16x32_bf16 v[240:243], v[52:55], v[88:91], v[240:243]
    ds_read_b128 v[52:55], v22 offset:55552
    ds_read_b64_tr_b16 v[102:103], v24 offset:20480
    v_mfma_f32_16x16x32_bf16 v[248:251], v[56:59], v[88:91], v[248:251]
    ds_read_b128 v[56:59], v22 offset:55808
    v_mfma_f32_16x16x32_bf16 v[64:67], v[60:63], v[88:91], v[64:67]
    ds_read_b128 v[60:63], v22 offset:56064
    s_waitcnt lgkmcnt(8)
    v_mfma_f32_16x16x32_bf16 v[192:195], v[28:31], v[80:83], v[192:195]
    ds_read_b128 v[28:31], v18 offset:64512
    ds_read_b64_tr_b16 v[88:89], v25 offset:24576
    v_mfma_f32_16x16x32_bf16 v[200:203], v[32:35], v[80:83], v[200:203]
    ds_read_b128 v[32:35], v18 offset:64768
    ds_read_b64_tr_b16 v[90:91], v25 offset:28672
    v_mfma_f32_16x16x32_bf16 v[208:211], v[36:39], v[80:83], v[208:211]
    ds_read_b128 v[36:39], v18 offset:65024
    s_waitcnt lgkmcnt(10)
    v_mfma_f32_16x16x32_bf16 v[216:219], v[40:43], v[80:83], v[216:219]
    ds_read_b128 v[40:43], v18 offset:65280
    v_mfma_f32_16x16x32_bf16 v[224:227], v[44:47], v[80:83], v[224:227]
    ds_read_b128 v[44:47], v19 offset:64512
    v_mfma_f32_16x16x32_bf16 v[232:235], v[48:51], v[80:83], v[232:235]
    ds_read_b128 v[48:51], v22 offset:64512
    ds_read_b64_tr_b16 v[104:105], v24 offset:24576
    s_waitcnt lgkmcnt(9)
    v_mfma_f32_16x16x32_bf16 v[240:243], v[52:55], v[80:83], v[240:243]
    ds_read_b128 v[52:55], v22 offset:64768
    ds_read_b64_tr_b16 v[106:107], v24 offset:28672
    v_mfma_f32_16x16x32_bf16 v[248:251], v[56:59], v[80:83], v[248:251]
    ds_read_b128 v[56:59], v22 offset:65024
    v_mfma_f32_16x16x32_bf16 v[64:67], v[60:63], v[80:83], v[64:67]
    ds_read_b128 v[60:63], v22 offset:65280
    s_waitcnt lgkmcnt(8)
    v_mfma_f32_16x16x32_bf16 v[192:195], v[28:31], v[88:91], v[192:195]
    s_barrier
    ds_read_b128 v[28:31], v18 offset:0
    ds_read_b64_tr_b16 v[80:81], v21 offset:0
    v_mfma_f32_16x16x32_bf16 v[200:203], v[32:35], v[88:91], v[200:203]
    ds_read_b128 v[32:35], v18 offset:256
    ds_read_b64_tr_b16 v[82:83], v21 offset:4096
    v_mfma_f32_16x16x32_bf16 v[208:211], v[36:39], v[88:91], v[208:211]
    ds_read_b128 v[36:39], v18 offset:512
    s_waitcnt lgkmcnt(10)
    v_mfma_f32_16x16x32_bf16 v[216:219], v[40:43], v[88:91], v[216:219]
    ds_read_b128 v[40:43], v18 offset:768
    v_mfma_f32_16x16x32_bf16 v[224:227], v[44:47], v[88:91], v[224:227]
    ds_read_b128 v[44:47], v19 offset:0
    v_mfma_f32_16x16x32_bf16 v[232:235], v[48:51], v[88:91], v[232:235]
    ds_read_b128 v[48:51], v22 offset:0
    ds_read_b64_tr_b16 v[108:109], v20 offset:0
    s_waitcnt lgkmcnt(9)
    v_mfma_f32_16x16x32_bf16 v[240:243], v[52:55], v[88:91], v[240:243]
    ds_read_b128 v[52:55], v22 offset:256
    ds_read_b64_tr_b16 v[110:111], v20 offset:4096
    v_mfma_f32_16x16x32_bf16 v[248:251], v[56:59], v[88:91], v[248:251]
    ds_read_b128 v[56:59], v22 offset:512
    v_mfma_f32_16x16x32_bf16 v[64:67], v[60:63], v[88:91], v[64:67]
    ds_read_b128 v[60:63], v22 offset:768
    s_waitcnt lgkmcnt(8)
    v_mfma_f32_16x16x32_bf16 v[192:195], v[28:31], v[80:83], v[192:195]
    ds_read_b128 v[28:31], v18 offset:9216
    ds_read_b64_tr_b16 v[88:89], v21 offset:8192
    v_mfma_f32_16x16x32_bf16 v[200:203], v[32:35], v[80:83], v[200:203]
    ds_read_b128 v[32:35], v18 offset:9472
    ds_read_b64_tr_b16 v[90:91], v21 offset:12288
    v_mfma_f32_16x16x32_bf16 v[208:211], v[36:39], v[80:83], v[208:211]
    ds_read_b128 v[36:39], v18 offset:9728
    s_waitcnt lgkmcnt(10)
    v_mfma_f32_16x16x32_bf16 v[216:219], v[40:43], v[80:83], v[216:219]
    ds_read_b128 v[40:43], v18 offset:9984
    v_mfma_f32_16x16x32_bf16 v[224:227], v[44:47], v[80:83], v[224:227]
    ds_read_b128 v[44:47], v19 offset:9216
    v_mfma_f32_16x16x32_bf16 v[232:235], v[48:51], v[80:83], v[232:235]
    ds_read_b128 v[48:51], v22 offset:9216
    ds_read_b64_tr_b16 v[112:113], v20 offset:8192
    s_waitcnt lgkmcnt(9)
    v_mfma_f32_16x16x32_bf16 v[240:243], v[52:55], v[80:83], v[240:243]
    ds_read_b128 v[52:55], v22 offset:9472
    ds_read_b64_tr_b16 v[114:115], v20 offset:12288
    v_mfma_f32_16x16x32_bf16 v[248:251], v[56:59], v[80:83], v[248:251]
    ds_read_b128 v[56:59], v22 offset:9728
    v_mfma_f32_16x16x32_bf16 v[64:67], v[60:63], v[80:83], v[64:67]
    ds_read_b128 v[60:63], v22 offset:9984
    s_waitcnt lgkmcnt(8)
    v_mfma_f32_16x16x32_bf16 v[192:195], v[28:31], v[88:91], v[192:195]
    s_barrier
    ds_read_b128 v[28:31], v18 offset:18432
    ds_read_b64_tr_b16 v[80:81], v21 offset:16384
    v_mfma_f32_16x16x32_bf16 v[200:203], v[32:35], v[88:91], v[200:203]
    ds_read_b128 v[32:35], v18 offset:18688
    ds_read_b64_tr_b16 v[82:83], v21 offset:20480
    v_mfma_f32_16x16x32_bf16 v[208:211], v[36:39], v[88:91], v[208:211]
    ds_read_b128 v[36:39], v18 offset:18944
    s_waitcnt lgkmcnt(10)
    v_mfma_f32_16x16x32_bf16 v[216:219], v[40:43], v[88:91], v[216:219]
    ds_read_b128 v[40:43], v18 offset:19200
    v_mfma_f32_16x16x32_bf16 v[224:227], v[44:47], v[88:91], v[224:227]
    ds_read_b128 v[44:47], v19 offset:18432
    v_mfma_f32_16x16x32_bf16 v[232:235], v[48:51], v[88:91], v[232:235]
    ds_read_b128 v[48:51], v22 offset:18432
    ds_read_b64_tr_b16 v[116:117], v20 offset:16384
    s_waitcnt lgkmcnt(9)
    v_mfma_f32_16x16x32_bf16 v[240:243], v[52:55], v[88:91], v[240:243]
    ds_read_b128 v[52:55], v22 offset:18688
    ds_read_b64_tr_b16 v[118:119], v20 offset:20480
    v_mfma_f32_16x16x32_bf16 v[248:251], v[56:59], v[88:91], v[248:251]
    ds_read_b128 v[56:59], v22 offset:18944
    v_mfma_f32_16x16x32_bf16 v[64:67], v[60:63], v[88:91], v[64:67]
    ds_read_b128 v[60:63], v22 offset:19200
    s_waitcnt lgkmcnt(8)
    v_mfma_f32_16x16x32_bf16 v[192:195], v[28:31], v[80:83], v[192:195]
    ds_read_b128 v[28:31], v18 offset:27648
    ds_read_b64_tr_b16 v[88:89], v21 offset:24576
    v_mfma_f32_16x16x32_bf16 v[200:203], v[32:35], v[80:83], v[200:203]
    ds_read_b128 v[32:35], v18 offset:27904
    ds_read_b64_tr_b16 v[90:91], v21 offset:28672
    v_mfma_f32_16x16x32_bf16 v[208:211], v[36:39], v[80:83], v[208:211]
    ds_read_b128 v[36:39], v18 offset:28160
    s_waitcnt lgkmcnt(10)
    v_mfma_f32_16x16x32_bf16 v[216:219], v[40:43], v[80:83], v[216:219]
    ds_read_b128 v[40:43], v18 offset:28416
    v_mfma_f32_16x16x32_bf16 v[224:227], v[44:47], v[80:83], v[224:227]
    ds_read_b128 v[44:47], v19 offset:27648
    v_mfma_f32_16x16x32_bf16 v[232:235], v[48:51], v[80:83], v[232:235]
    ds_read_b128 v[48:51], v22 offset:27648
    ds_read_b64_tr_b16 v[120:121], v20 offset:24576
    s_waitcnt lgkmcnt(9)
    v_mfma_f32_16x16x32_bf16 v[240:243], v[52:55], v[80:83], v[240:243]
    ds_read_b128 v[52:55], v22 offset:27904
    ds_read_b64_tr_b16 v[122:123], v20 offset:28672
    v_mfma_f32_16x16x32_bf16 v[248:251], v[56:59], v[80:83], v[248:251]
    ds_read_b128 v[56:59], v22 offset:28160
    v_mfma_f32_16x16x32_bf16 v[64:67], v[60:63], v[80:83], v[64:67]
    ds_read_b128 v[60:63], v22 offset:28416
    s_waitcnt lgkmcnt(8)
    v_mfma_f32_16x16x32_bf16 v[192:195], v[28:31], v[88:91], v[192:195]
    v_mfma_f32_16x16x32_bf16 v[200:203], v[32:35], v[88:91], v[200:203]
    v_mfma_f32_16x16x32_bf16 v[208:211], v[36:39], v[88:91], v[208:211]
    s_waitcnt lgkmcnt(5)
    v_mfma_f32_16x16x32_bf16 v[216:219], v[40:43], v[88:91], v[216:219]
    v_mfma_f32_16x16x32_bf16 v[224:227], v[44:47], v[88:91], v[224:227]
    v_mfma_f32_16x16x32_bf16 v[232:235], v[48:51], v[88:91], v[232:235]
    s_waitcnt lgkmcnt(0)
    v_mfma_f32_16x16x32_bf16 v[240:243], v[52:55], v[88:91], v[240:243]
    v_mfma_f32_16x16x32_bf16 v[248:251], v[56:59], v[88:91], v[248:251]
    v_mfma_f32_16x16x32_bf16 v[64:67], v[60:63], v[88:91], v[64:67]
    v_mfma_f32_16x16x32_bf16 v[220:223], v[44:47], v[120:123], v[220:223]
    ds_read_b128 v[44:47], v19 offset:36864
    v_mfma_f32_16x16x32_bf16 v[228:231], v[48:51], v[120:123], v[228:231]
    ds_read_b128 v[48:51], v22 offset:36864
    v_mfma_f32_16x16x32_bf16 v[236:239], v[52:55], v[120:123], v[236:239]
    ds_read_b128 v[52:55], v22 offset:37120
    v_mfma_f32_16x16x32_bf16 v[244:247], v[56:59], v[120:123], v[244:247]
    ds_read_b128 v[56:59], v22 offset:37376
    v_mfma_f32_16x16x32_bf16 v[252:255], v[60:63], v[120:123], v[252:255]
    ds_read_b128 v[60:63], v22 offset:37632
    v_mfma_f32_16x16x32_bf16 v[188:191], v[28:31], v[120:123], v[188:191]
    ds_read_b128 v[28:31], v18 offset:36864
    v_mfma_f32_16x16x32_bf16 v[196:199], v[32:35], v[120:123], v[196:199]
    ds_read_b128 v[32:35], v18 offset:37120
    v_mfma_f32_16x16x32_bf16 v[204:207], v[36:39], v[120:123], v[204:207]
    ds_read_b128 v[36:39], v18 offset:37376
    v_mfma_f32_16x16x32_bf16 v[212:215], v[40:43], v[120:123], v[212:215]
    ds_read_b128 v[40:43], v18 offset:37632
    s_waitcnt lgkmcnt(4)
    v_mfma_f32_16x16x32_bf16 v[220:223], v[44:47], v[92:95], v[220:223]
    ds_read_b128 v[44:47], v19 offset:46080
    v_cvt_pk_bf16_f32 v144, v224, v225
    v_cvt_pk_bf16_f32 v156, v226, v227
    v_mfma_f32_16x16x32_bf16 v[228:231], v[48:51], v[92:95], v[228:231]
    ds_read_b128 v[48:51], v22 offset:46080
    v_permlane32_swap_b32 v144, v156
    s_nop 1
    v_mov_b32_dpp v157, v156 quad_perm:[1,1,1,1] row_mask:0xf bank_mask:0xf
    v_mfma_f32_16x16x32_bf16 v[236:239], v[52:55], v[92:95], v[236:239]
    ds_read_b128 v[52:55], v22 offset:46336
    v_mov_b32_dpp v158, v156 quad_perm:[2,2,2,2] row_mask:0xf bank_mask:0xf
    v_mov_b32_dpp v159, v156 quad_perm:[3,3,3,3] row_mask:0xf bank_mask:0xf
    v_mfma_f32_16x16x32_bf16 v[244:247], v[56:59], v[92:95], v[244:247]
    ds_read_b128 v[56:59], v22 offset:46592
    v_cvt_pk_bf16_f32 v148, v232, v233
    v_cvt_pk_bf16_f32 v149, v234, v235
    v_mfma_f32_16x16x32_bf16 v[252:255], v[60:63], v[92:95], v[252:255]
    ds_read_b128 v[60:63], v22 offset:46848
    v_cvt_pk_bf16_f32 v150, v240, v241
    v_cvt_pk_bf16_f32 v151, v242, v243
    s_waitcnt lgkmcnt(0)
    v_mfma_f32_16x16x32_bf16 v[220:223], v[44:47], v[96:99], v[220:223]
    ds_read_b128 v[44:47], v19 offset:55296
    buffer_store_dwordx4 v[148:151], v9, s[36:39], s67 offen offset:0 sc1
    v_cvt_pk_bf16_f32 v152, v248, v249
    v_mfma_f32_16x16x32_bf16 v[228:231], v[48:51], v[96:99], v[228:231]
    ds_read_b128 v[48:51], v22 offset:55296
    v_cvt_pk_bf16_f32 v153, v250, v251
    v_cvt_pk_bf16_f32 v154, v64, v65
    v_mfma_f32_16x16x32_bf16 v[236:239], v[52:55], v[96:99], v[236:239]
    ds_read_b128 v[52:55], v22 offset:55552
    v_cvt_pk_bf16_f32 v155, v66, v67
    buffer_store_dwordx4 v[152:155], v9, s[36:39], s67 offen offset:1024 sc1
    v_mfma_f32_16x16x32_bf16 v[244:247], v[56:59], v[96:99], v[244:247]
    ds_read_b128 v[56:59], v22 offset:55808
    buffer_store_dwordx4 v[156:159], v26, s[36:39], s67 offen offset:2048 sc1
    v_mov_b32_dpp v145, v144 quad_perm:[1,1,1,1] row_mask:0xf bank_mask:0xf
    v_mfma_f32_16x16x32_bf16 v[252:255], v[60:63], v[96:99], v[252:255]
    ds_read_b128 v[60:63], v22 offset:56064
    v_mov_b32_dpp v146, v144 quad_perm:[2,2,2,2] row_mask:0xf bank_mask:0xf
    v_mov_b32_dpp v147, v144 quad_perm:[3,3,3,3] row_mask:0xf bank_mask:0xf
    s_waitcnt lgkmcnt(0)
    v_mfma_f32_16x16x32_bf16 v[220:223], v[44:47], v[100:103], v[220:223]
    ds_read_b128 v[44:47], v19 offset:64512
    v_cvt_pk_bf16_f32 v136, v192, v193
    v_cvt_pk_bf16_f32 v137, v194, v195
    v_mfma_f32_16x16x32_bf16 v[228:231], v[48:51], v[100:103], v[228:231]
    ds_read_b128 v[48:51], v22 offset:64512
    v_cvt_pk_bf16_f32 v138, v200, v201
    v_cvt_pk_bf16_f32 v139, v202, v203
    v_mfma_f32_16x16x32_bf16 v[236:239], v[52:55], v[100:103], v[236:239]
    ds_read_b128 v[52:55], v22 offset:64768
    buffer_store_dwordx4 v[136:139], v9, s[36:39], s66 offen offset:0 sc1
    v_cvt_pk_bf16_f32 v140, v208, v209
    v_mfma_f32_16x16x32_bf16 v[244:247], v[56:59], v[100:103], v[244:247]
    ds_read_b128 v[56:59], v22 offset:65024
    v_cvt_pk_bf16_f32 v141, v210, v211
    v_cvt_pk_bf16_f32 v142, v216, v217
    v_mfma_f32_16x16x32_bf16 v[252:255], v[60:63], v[100:103], v[252:255]
    ds_read_b128 v[60:63], v22 offset:65280
    v_cvt_pk_bf16_f32 v143, v218, v219
    buffer_store_dwordx4 v[140:143], v9, s[36:39], s66 offen offset:1024 sc1
    s_waitcnt lgkmcnt(0)
    v_mfma_f32_16x16x32_bf16 v[220:223], v[44:47], v[104:107], v[220:223]
    ds_read_b128 v[44:47], v19 offset:0
    buffer_store_dwordx4 v[144:147], v26, s[36:39], s66 offen offset:2048 sc1
    v_mfma_f32_16x16x32_bf16 v[228:231], v[48:51], v[104:107], v[228:231]
    ds_read_b128 v[48:51], v22 offset:0
    v_mfma_f32_16x16x32_bf16 v[236:239], v[52:55], v[104:107], v[236:239]
    ds_read_b128 v[52:55], v22 offset:256
    v_mfma_f32_16x16x32_bf16 v[244:247], v[56:59], v[104:107], v[244:247]
    ds_read_b128 v[56:59], v22 offset:512
    v_mfma_f32_16x16x32_bf16 v[252:255], v[60:63], v[104:107], v[252:255]
    ds_read_b128 v[60:63], v22 offset:768
    s_waitcnt lgkmcnt(0)
    v_mfma_f32_16x16x32_bf16 v[220:223], v[44:47], v[108:111], v[220:223]
    ds_read_b128 v[44:47], v19 offset:9216
    v_mfma_f32_16x16x32_bf16 v[228:231], v[48:51], v[108:111], v[228:231]
    ds_read_b128 v[48:51], v22 offset:9216
    v_mfma_f32_16x16x32_bf16 v[236:239], v[52:55], v[108:111], v[236:239]
    ds_read_b128 v[52:55], v22 offset:9472
    v_mfma_f32_16x16x32_bf16 v[244:247], v[56:59], v[108:111], v[244:247]
    ds_read_b128 v[56:59], v22 offset:9728
    v_mfma_f32_16x16x32_bf16 v[252:255], v[60:63], v[108:111], v[252:255]
    ds_read_b128 v[60:63], v22 offset:9984
    s_waitcnt lgkmcnt(0)
    v_mfma_f32_16x16x32_bf16 v[220:223], v[44:47], v[112:115], v[220:223]
    ds_read_b128 v[44:47], v19 offset:18432
    v_mfma_f32_16x16x32_bf16 v[228:231], v[48:51], v[112:115], v[228:231]
    ds_read_b128 v[48:51], v22 offset:18432
    v_mfma_f32_16x16x32_bf16 v[236:239], v[52:55], v[112:115], v[236:239]
    ds_read_b128 v[52:55], v22 offset:18688
    v_mfma_f32_16x16x32_bf16 v[244:247], v[56:59], v[112:115], v[244:247]
    ds_read_b128 v[56:59], v22 offset:18944
    v_mfma_f32_16x16x32_bf16 v[252:255], v[60:63], v[112:115], v[252:255]
    ds_read_b128 v[60:63], v22 offset:19200
    s_waitcnt lgkmcnt(0)
    v_mfma_f32_16x16x32_bf16 v[220:223], v[44:47], v[116:119], v[220:223]
    v_mfma_f32_16x16x32_bf16 v[228:231], v[48:51], v[116:119], v[228:231]
    v_mfma_f32_16x16x32_bf16 v[236:239], v[52:55], v[116:119], v[236:239]
    v_mfma_f32_16x16x32_bf16 v[244:247], v[56:59], v[116:119], v[244:247]
    v_mfma_f32_16x16x32_bf16 v[252:255], v[60:63], v[116:119], v[252:255]
    v_mfma_f32_16x16x32_bf16 v[188:191], v[28:31], v[92:95], v[188:191]
    ds_read_b128 v[28:31], v18 offset:46080
    v_mfma_f32_16x16x32_bf16 v[196:199], v[32:35], v[92:95], v[196:199]
    ds_read_b128 v[32:35], v18 offset:46336
    v_mfma_f32_16x16x32_bf16 v[204:207], v[36:39], v[92:95], v[204:207]
    ds_read_b128 v[36:39], v18 offset:46592
    v_mfma_f32_16x16x32_bf16 v[212:215], v[40:43], v[92:95], v[212:215]
    ds_read_b128 v[40:43], v18 offset:46848
    s_waitcnt lgkmcnt(0)
    v_mfma_f32_16x16x32_bf16 v[188:191], v[28:31], v[96:99], v[188:191]
    ds_read_b128 v[28:31], v18 offset:55296
    v_cvt_pk_bf16_f32 v13, v220, v221
    v_cvt_pk_bf16_f32 v132, v222, v223
    v_mfma_f32_16x16x32_bf16 v[196:199], v[32:35], v[96:99], v[196:199]
    ds_read_b128 v[32:35], v18 offset:55552
    v_permlane32_swap_b32 v13, v132
    s_nop 1
    v_mov_b32_dpp v133, v132 quad_perm:[1,1,1,1] row_mask:0xf bank_mask:0xf
    v_mfma_f32_16x16x32_bf16 v[204:207], v[36:39], v[96:99], v[204:207]
    ds_read_b128 v[36:39], v18 offset:55808
    v_mov_b32_dpp v134, v132 quad_perm:[2,2,2,2] row_mask:0xf bank_mask:0xf
    v_mov_b32_dpp v135, v132 quad_perm:[3,3,3,3] row_mask:0xf bank_mask:0xf
    v_mfma_f32_16x16x32_bf16 v[212:215], v[40:43], v[96:99], v[212:215]
    ds_read_b128 v[40:43], v18 offset:56064
    v_cvt_pk_bf16_f32 v124, v228, v229
    v_cvt_pk_bf16_f32 v125, v230, v231
    s_waitcnt lgkmcnt(0)
    v_mfma_f32_16x16x32_bf16 v[188:191], v[28:31], v[100:103], v[188:191]
    ds_read_b128 v[28:31], v18 offset:64512
    v_cvt_pk_bf16_f32 v126, v236, v237
    v_cvt_pk_bf16_f32 v127, v238, v239
    v_mfma_f32_16x16x32_bf16 v[196:199], v[32:35], v[100:103], v[196:199]
    ds_read_b128 v[32:35], v18 offset:64768
    buffer_store_dwordx4 v[124:127], v9, s[36:39], s65 offen offset:0 sc1
    v_cvt_pk_bf16_f32 v128, v244, v245
    v_mfma_f32_16x16x32_bf16 v[204:207], v[36:39], v[100:103], v[204:207]
    ds_read_b128 v[36:39], v18 offset:65024
    v_cvt_pk_bf16_f32 v129, v246, v247
    v_cvt_pk_bf16_f32 v130, v252, v253
    v_mfma_f32_16x16x32_bf16 v[212:215], v[40:43], v[100:103], v[212:215]
    ds_read_b128 v[40:43], v18 offset:65280
    v_cvt_pk_bf16_f32 v131, v254, v255
    buffer_store_dwordx4 v[128:131], v9, s[36:39], s65 offen offset:1024 sc1
    s_waitcnt lgkmcnt(0)
    v_mfma_f32_16x16x32_bf16 v[188:191], v[28:31], v[104:107], v[188:191]
    ds_read_b128 v[28:31], v18 offset:0
    buffer_store_dwordx4 v[132:135], v26, s[36:39], s65 offen offset:2048 sc1
    v_lshrrev_b32 v10, 2, v1
    v_mfma_f32_16x16x32_bf16 v[196:199], v[32:35], v[104:107], v[196:199]
    ds_read_b128 v[32:35], v18 offset:256
    v_and_b32 v11, 1, v1
    v_lshlrev_b32 v11, 4, v11
    v_mfma_f32_16x16x32_bf16 v[204:207], v[36:39], v[104:107], v[204:207]
    ds_read_b128 v[36:39], v18 offset:512
    v_mov_b32 v12, 0x3f80
    v_lshlrev_b32 v11, v11, v12
    v_mfma_f32_16x16x32_bf16 v[212:215], v[40:43], v[104:107], v[212:215]
    ds_read_b128 v[40:43], v18 offset:768
    v_and_b32 v12, 2, v1
    v_add_u32 v13, v10, v12
    s_waitcnt lgkmcnt(0)
    v_mfma_f32_16x16x32_bf16 v[188:191], v[28:31], v[108:111], v[188:191]
    ds_read_b128 v[28:31], v18 offset:9216
    v_cmp_eq_u32 vcc, v10, v2
    s_nop 1
    v_cndmask_b32 v80, 0, v11, vcc
    v_mfma_f32_16x16x32_bf16 v[196:199], v[32:35], v[108:111], v[196:199]
    ds_read_b128 v[32:35], v18 offset:9472
    v_cmp_eq_u32 vcc, v13, v2
    s_nop 1
    v_cndmask_b32 v76, 0, v11, vcc
    v_mfma_f32_16x16x32_bf16 v[204:207], v[36:39], v[108:111], v[204:207]
    ds_read_b128 v[36:39], v18 offset:9728
    v_cmp_gt_u32 vcc, 8, v1
    s_nop 1
    v_cndmask_b32 v76, 0, v76, vcc
    v_mfma_f32_16x16x32_bf16 v[212:215], v[40:43], v[108:111], v[212:215]
    ds_read_b128 v[40:43], v18 offset:9984
    v_cmp_eq_u32 vcc, 0, v12
    s_nop 1
    v_cndmask_b32 v81, v80, 0, vcc
    s_waitcnt lgkmcnt(0)
    v_mfma_f32_16x16x32_bf16 v[188:191], v[28:31], v[112:115], v[188:191]
    ds_read_b128 v[28:31], v18 offset:18432
    v_cndmask_b32 v80, 0, v80, vcc
    v_mov_b32 v77, v76
    v_mfma_f32_16x16x32_bf16 v[196:199], v[32:35], v[112:115], v[196:199]
    ds_read_b128 v[32:35], v18 offset:18688
    v_mov_b64 v[78:79], 0
    v_mov_b64 v[82:83], 0
    s_nop 0
    v_mfma_f32_16x16x32_bf16 v[204:207], v[36:39], v[112:115], v[204:207]
    ds_read_b128 v[36:39], v18 offset:18944
    v_mfma_f32_16x16x32_bf16 v[212:215], v[40:43], v[112:115], v[212:215]
    ds_read_b128 v[40:43], v18 offset:19200
    s_waitcnt lgkmcnt(0)
    v_mfma_f32_16x16x32_bf16 v[188:191], v[28:31], v[116:119], v[188:191]
    v_mfma_f32_16x16x32_bf16 v[196:199], v[32:35], v[116:119], v[196:199]
    v_mfma_f32_16x16x32_bf16 v[204:207], v[36:39], v[116:119], v[204:207]
    v_mfma_f32_16x16x32_bf16 v[212:215], v[40:43], v[116:119], v[212:215]
    s_barrier
    ds_read_b64 v[28:29], v4 offset:0
    ds_read_b128 v[160:163], v6 offset:0
    ds_read_b64 v[30:31], v4 offset:32
    ds_read_b128 v[164:167], v6 offset:64
    ds_read_b64 v[32:33], v4 offset:64
    ds_read_b128 v[168:171], v6 offset:128
    ds_read_b64 v[34:35], v4 offset:96
    ds_read_b128 v[172:175], v6 offset:192
    ds_read_b64 v[36:37], v5
    ds_read_b128 v[176:179], v23
    s_mul_i32 s49, s3, 4608
    s_add_u32 s49, s49, 49152
    v_add_u32 v73, s49, v27
    s_waitcnt lgkmcnt(9)
    v_lshlrev_b32 v44, 16, v28
    v_and_b32 v45, 0xffff0000, v28
    v_lshlrev_b32 v46, 16, v29
    v_and_b32 v47, 0xffff0000, v29
    s_waitcnt lgkmcnt(7)
    v_lshlrev_b32 v48, 16, v30
    v_and_b32 v49, 0xffff0000, v30
    v_lshlrev_b32 v50, 16, v31
    v_and_b32 v51, 0xffff0000, v31
    s_waitcnt lgkmcnt(5)
    v_lshlrev_b32 v52, 16, v32
    v_and_b32 v53, 0xffff0000, v32
    v_lshlrev_b32 v54, 16, v33
    v_and_b32 v55, 0xffff0000, v33
    s_waitcnt lgkmcnt(3)
    v_lshlrev_b32 v56, 16, v34
    v_and_b32 v57, 0xffff0000, v34
    v_lshlrev_b32 v58, 16, v35
    v_and_b32 v59, 0xffff0000, v35
    s_waitcnt lgkmcnt(1)
    v_lshlrev_b32 v60, 16, v36
    v_and_b32 v61, 0xffff0000, v36
    v_lshlrev_b32 v62, 16, v37
    v_and_b32 v63, 0xffff0000, v37
    s_waitcnt vmcnt(0)
    v_mov_b32 v133, 0
    v_mov_b64 v[134:135], 0
    v_mov_b64 v[146:147], 0
    buffer_load_dwordx4 v[124:127], v9, s[36:39], s64 offen offset:0 sc1
    buffer_load_dwordx4 v[128:131], v9, s[36:39], s64 offen offset:1024 sc1
    buffer_load_dword v132, v27, s[36:39], s64 offen offset:2048 sc1
    s_barrier
    ds_read_b128 v[136:139], v71 offset:0
    ds_read_b128 v[140:143], v71 offset:1024
    ds_read_b128 v[148:151], v71 offset:2304
    ds_read_b128 v[152:155], v71 offset:3328
    ds_read_b32 v144, v73 offset:2048
    ds_read_b32 v145, v73 offset:4352
    s_waitcnt lgkmcnt(5)
    v_mfma_f32_16x16x32_bf16 v[188:191], v[80:83], v[136:139], v[188:191]
    v_mfma_f32_16x16x32_bf16 v[196:199], v[78:81], v[136:139], v[196:199]
    s_waitcnt lgkmcnt(4)
    v_mfma_f32_16x16x32_bf16 v[204:207], v[80:83], v[140:143], v[204:207]
    v_mfma_f32_16x16x32_bf16 v[212:215], v[78:81], v[140:143], v[212:215]
    s_waitcnt lgkmcnt(3)
    v_mfma_f32_16x16x32_bf16 v[188:191], v[80:83], v[148:151], v[188:191]
    v_mfma_f32_16x16x32_bf16 v[196:199], v[78:81], v[148:151], v[196:199]
    s_waitcnt lgkmcnt(2)
    v_mfma_f32_16x16x32_bf16 v[204:207], v[80:83], v[152:155], v[204:207]
    v_mfma_f32_16x16x32_bf16 v[212:215], v[78:81], v[152:155], v[212:215]
    s_waitcnt lgkmcnt(0)
    v_mfma_f32_16x16x32_bf16 v[220:223], v[76:79], v[144:147], v[220:223]
    s_waitcnt vmcnt(0)
    v_max3_u32 v10, v124, v128, v132
    v_cmp_eq_u32 vcc, -1, v10
    s_nop 0
    s_cbranch_vccz L_m_27
Lp_m_28:
    buffer_load_dwordx4 v[124:127], v9, s[36:39], s64 offen offset:0 sc1
    buffer_load_dwordx4 v[128:131], v9, s[36:39], s64 offen offset:1024 sc1
    buffer_load_dword v132, v27, s[36:39], s64 offen offset:2048 sc1
    s_waitcnt vmcnt(0)
    v_max3_u32 v10, v124, v128, v132
    v_cmp_eq_u32 vcc, -1, v10
    s_nop 0
    s_cbranch_vccz Le_m_29
    s_sub_u32 s7, s7, 1
    s_cbranch_scc1 Le_m_29
    s_mov_b64 exec, vcc
    s_sleep 1
    s_branch Lp_m_28
Le_m_29:
    s_mov_b64 exec, -1
    s_max_i32 s7, s7, 0
L_m_27:
    v_mfma_f32_16x16x32_bf16 v[188:191], v[80:83], v[124:127], v[188:191]
    v_mfma_f32_16x16x32_bf16 v[196:199], v[78:81], v[124:127], v[196:199]
    v_mfma_f32_16x16x32_bf16 v[204:207], v[80:83], v[128:131], v[204:207]
    v_mfma_f32_16x16x32_bf16 v[212:215], v[78:81], v[128:131], v[212:215]
    v_mfma_f32_16x16x32_bf16 v[220:223], v[76:79], v[132:135], v[220:223]
    s_nop 3
    v_pk_fma_f32 v[44:45], v[188:189], v[160:161], v[44:45]
    v_pk_fma_f32 v[46:47], v[190:191], v[162:163], v[46:47]
    v_cvt_pk_bf16_f32 v28, v44, v45
    v_cvt_pk_bf16_f32 v29, v46, v47
    ds_write_b64 v4, v[28:29] offset:0
    v_pk_fma_f32 v[48:49], v[196:197], v[164:165], v[48:49]
    v_pk_fma_f32 v[50:51], v[198:199], v[166:167], v[50:51]
    v_cvt_pk_bf16_f32 v30, v48, v49
    v_cvt_pk_bf16_f32 v31, v50, v51
    ds_write_b64 v4, v[30:31] offset:32
    v_pk_fma_f32 v[52:53], v[204:205], v[168:169], v[52:53]
    v_pk_fma_f32 v[54:55], v[206:207], v[170:171], v[54:55]
    v_cvt_pk_bf16_f32 v32, v52, v53
    v_cvt_pk_bf16_f32 v33, v54, v55
    ds_write_b64 v4, v[32:33] offset:64
    v_pk_fma_f32 v[56:57], v[212:213], v[172:173], v[56:57]
    v_pk_fma_f32 v[58:59], v[214:215], v[174:175], v[58:59]
    s_branch L_skip_9
L_stub_9:
    s_branch L_back_c3
L_skip_9:
    v_cvt_pk_bf16_f32 v34, v56, v57
    v_cvt_pk_bf16_f32 v35, v58, v59
    ds_write_b64 v4, v[34:35] offset:96
    v_pk_fma_f32 v[60:61], v[220:221], v[176:177], v[60:61]
    v_pk_fma_f32 v[62:63], v[222:223], v[178:179], v[62:63]
    v_cvt_pk_bf16_f32 v36, v60, v61
    v_cvt_pk_bf16_f32 v37, v62, v63
    ds_write_b64 v5, v[36:37]
    ds_read_b128 v[160:163], v7 offset:0
    ds_read_b128 v[164:167], v7 offset:1024
    ds_read_b128 v[168:171], v7 offset:2048
    s_waitcnt lgkmcnt(2)
    buffer_store_dwordx4 v[160:163], v68, s[44:47], s62 offen sc1
    s_waitcnt lgkmcnt(1)
    buffer_store_dwordx4 v[164:167], v69, s[44:47], s62 offen sc1
    s_waitcnt lgkmcnt(0)
    buffer_store_dwordx4 v[168:171], v70, s[44:47], s62 offen sc1
    s_branch L_end
L_m_30:
    s_sub_u32 s61, s63, 54
    s_lshr_b32 s62, s61, 1
    s_add_u32 s62, s62, 18
    s_and_b32 s61, s61, 1
    s_cmp_ge_u32 s5, 16
    s_cbranch_scc1 L_m_35
    s_lshl_b32 s67, s4, 4
    s_add_u32 s67, s67, s5
    s_and_b32 s67, s67, 127
    s_lshl_b32 s48, s3, 9
    s_add_u32 s48, s48, s67
    s_mul_i32 s69, s3, 6144
    s_add_u32 s69, s69, 36864
    s_cmp_eq_u32 s67, 0
    s_cselect_b32 s68, 38, 0
    s_add_u32 s68, s68, 152
    v_mov_b32 v8, 2146435072
    v_add_u32 v4, 0, v0
    v_mul_u32_u24 v5, 1725, v4
    v_lshrrev_b32 v5, 16, v5
    v_mul_u32_u24 v6, 38, v5
    v_sub_u32 v6, v4, v6
    v_cmp_gt_u32 vcc, s68, v4
    v_lshl_add_u32 v5, v5, 7, s48
    v_and_b32 v5, 2047, v5
    v_mul_u32_u24 v5, 578, v5
    v_and_b32 v5, 0xfffffff0, v5
    v_lshl_add_u32 v5, v6, 4, v5
    v_cndmask_b32 v20, v8, v5, vcc
    v_add_u32 v4, 64, v0
    v_mul_u32_u24 v5, 1725, v4
    v_lshrrev_b32 v5, 16, v5
    v_mul_u32_u24 v6, 38, v5
    v_sub_u32 v6, v4, v6
    v_cmp_gt_u32 vcc, s68, v4
    v_lshl_add_u32 v5, v5, 7, s48
    v_and_b32 v5, 2047, v5
    v_mul_u32_u24 v5, 578, v5
    v_and_b32 v5, 0xfffffff0, v5
    v_lshl_add_u32 v5, v6, 4, v5
    v_cndmask_b32 v21, v8, v5, vcc
    v_add_u32 v4, 128, v0
    v_mul_u32_u24 v5, 1725, v4
    v_lshrrev_b32 v5, 16, v5
    v_mul_u32_u24 v6, 38, v5
    v_sub_u32 v6, v4, v6
    v_cmp_gt_u32 vcc, s68, v4
    v_lshl_add_u32 v5, v5, 7, s48
    v_and_b32 v5, 2047, v5
    v_mul_u32_u24 v5, 578, v5
    v_and_b32 v5, 0xfffffff0, v5
    v_lshl_add_u32 v5, v6, 4, v5
    v_cndmask_b32 v22, v8, v5, vcc
    s_waitcnt lgkmcnt(0)
    s_mov_b32 s36, s32
    s_mov_b32 s37, s33
    s_mov_b32 s38, 50331648
    s_mov_b32 s39, 0x20000
    s_mov_b32 s40, s26
    s_mov_b32 s41, s27
    s_mov_b32 s42, 3981312
    s_mov_b32 s43, 0x20000
    v_mov_b32 v4, 32768
    buffer_load_dword v3, v4, s[36:39], 0 offen sc1
    s_lshr_b32 s51, s5, 2
    s_lshl_b32 s51, s51, 3
    s_add_u32 s51, s51, s4
    s_and_b32 s60, s5, 3
    s_lshl_b32 s35, s51, 2
    s_add_u32 s35, s35, s60
    s_lshl_b32 s35, s35, 14
    s_bfe_u32 s48, s6, 0x20002
    s_lshl_b32 s48, s48, 6
    s_lshr_b32 s49, s6, 4
    s_lshl_b32 s49, s49, 2
    s_add_u32 s48, s48, s49
    s_and_b32 s49, s6, 3
    s_add_u32 s48, s48, s49
    s_lshl_b32 s48, s48, 4
    s_lshl_b32 s49, s3, 16
    s_add_u32 s48, s48, s49
    s_add_u32 s48, s48, 15728640
    v_mov_b32 v17, 2146435072
    v_writelane_b32 v17, s48, 0
    s_add_u32 s48, s48, 16384
    s_add_u32 s48, s2, 160
    s_lshl_b32 s48, s48, 7
    s_add_u32 s48, s48, 557056
    s_lshl_b32 s49, s3, 8
    s_add_u32 s49, s49, s5
    s_cmp_lt_u32 s49, 12
    s_cselect_b32 s48, s48, 2146435072
    v_mov_b32 v19, 2146435072
    v_writelane_b32 v19, s48, 0
    s_or_b32 s48, s2, s3
    s_cmp_eq_u32 s48, 0
    s_cselect_b32 s48, 0, 2146435072
    s_add_u32 s48, s48, 32768
    v_writelane_b32 v19, s48, 1
    buffer_load_dword v220, v17, s[36:39], 0 offen
    buffer_load_dword v221, v19, s[36:39], 0 offen
    v_cvt_f32_u32 v218, v2
    v_mul_f32 v218, 4.0, v218
    v_cvt_f32_u32 v219, v1
    v_cvt_f32_u32 v13, s4
    v_mul_f32 v10, 0x3d800000, v219
    v_fmac_f32 v10, 0x3c000000, v13
    v_mul_f32 v11, v218, v10
    v_cos_f32 v5, v11
    v_sin_f32 v6, v11
    s_nop 0
    v_cvt_pk_bf16_f32 v52, v5, v6
    v_cvt_pk_bf16_f32 v56, -v6, v5
    v_fma_f32 v7, v10, 1.0, v11
    v_cos_f32 v8, v7
    v_sin_f32 v9, v7
    s_nop 0
    v_cvt_pk_bf16_f32 v53, v8, v9
    v_cvt_pk_bf16_f32 v57, -v9, v8
    v_fma_f32 v4, v10, 2.0, v11
    v_cos_f32 v5, v4
    v_sin_f32 v6, v4
    s_nop 0
    v_cvt_pk_bf16_f32 v54, v5, v6
    v_cvt_pk_bf16_f32 v58, -v6, v5
    v_add_f32 v7, v4, v10
    v_cos_f32 v8, v7
    v_sin_f32 v9, v7
    s_nop 0
    v_cvt_pk_bf16_f32 v55, v8, v9
    v_cvt_pk_bf16_f32 v59, -v9, v8
    s_lshl_b32 s48, s3, 5
    s_add_u32 s48, s48, s4
    v_cvt_f32_u32 v14, s48
    v_mul_f32 v14, 0x3a000000, v14
    v_mul_f32 v10, 0x3d800000, v219
    v_add_f32 v10, v10, v14
    v_mul_f32 v11, v218, v10
    v_cos_f32 v5, v11
    v_sin_f32 v6, v11
    s_nop 0
    v_cvt_pk_bf16_f32 v68, v5, v6
    v_cvt_pk_bf16_f32 v72, -v6, v5
    v_fma_f32 v7, v10, 1.0, v11
    v_cos_f32 v8, v7
    v_sin_f32 v9, v7
    s_nop 0
    v_cvt_pk_bf16_f32 v69, v8, v9
    v_cvt_pk_bf16_f32 v73, -v9, v8
    v_fma_f32 v4, v10, 2.0, v11
    v_cos_f32 v5, v4
    v_sin_f32 v6, v4
    s_nop 0
    v_cvt_pk_bf16_f32 v70, v5, v6
    v_cvt_pk_bf16_f32 v74, -v6, v5
    v_add_f32 v7, v4, v10
    v_cos_f32 v8, v7
    v_sin_f32 v9, v7
    s_nop 0
    v_cvt_pk_bf16_f32 v71, v8, v9
    v_cvt_pk_bf16_f32 v75, -v9, v8
    v_add_f32 v10, 0x3b800000, v10
    v_mul_f32 v11, v218, v10
    v_cos_f32 v5, v11
    v_sin_f32 v6, v11
    s_nop 0
    v_cvt_pk_bf16_f32 v76, v5, v6
    v_cvt_pk_bf16_f32 v80, -v6, v5
    v_fma_f32 v7, v10, 1.0, v11
    v_cos_f32 v8, v7
    v_sin_f32 v9, v7
    s_nop 0
    v_cvt_pk_bf16_f32 v77, v8, v9
    v_cvt_pk_bf16_f32 v81, -v9, v8
    v_fma_f32 v4, v10, 2.0, v11
    v_cos_f32 v5, v4
    v_sin_f32 v6, v4
    s_nop 0
    v_cvt_pk_bf16_f32 v78, v5, v6
    v_cvt_pk_bf16_f32 v82, -v6, v5
    v_add_f32 v7, v4, v10
    v_cos_f32 v8, v7
    v_sin_f32 v9, v7
    s_nop 0
    v_cvt_pk_bf16_f32 v79, v8, v9
    v_cvt_pk_bf16_f32 v83, -v9, v8
    v_add_f32 v10, 0x3b800000, v10
    v_mul_f32 v11, v218, v10
    v_cos_f32 v5, v11
    v_sin_f32 v6, v11
    s_nop 0
    v_cvt_pk_bf16_f32 v84, v5, v6
    v_cvt_pk_bf16_f32 v88, -v6, v5
    v_fma_f32 v7, v10, 1.0, v11
    v_cos_f32 v8, v7
    v_sin_f32 v9, v7
    s_nop 0
    v_cvt_pk_bf16_f32 v85, v8, v9
    v_cvt_pk_bf16_f32 v89, -v9, v8
    v_fma_f32 v4, v10, 2.0, v11
    v_cos_f32 v5, v4
    v_sin_f32 v6, v4
    s_nop 0
    v_cvt_pk_bf16_f32 v86, v5, v6
    v_cvt_pk_bf16_f32 v90, -v6, v5
    v_add_f32 v7, v4, v10
    v_cos_f32 v8, v7
    v_sin_f32 v9, v7
    s_nop 0
    v_cvt_pk_bf16_f32 v87, v8, v9
    v_cvt_pk_bf16_f32 v91, -v9, v8
    v_add_f32 v10, 0x3b800000, v10
    v_mul_f32 v11, v218, v10
    v_cos_f32 v5, v11
    v_sin_f32 v6, v11
    s_nop 0
    v_cvt_pk_bf16_f32 v92, v5, v6
    v_cvt_pk_bf16_f32 v96, -v6, v5
    v_fma_f32 v7, v10, 1.0, v11
    v_cos_f32 v8, v7
    v_sin_f32 v9, v7
    s_nop 0
    v_cvt_pk_bf16_f32 v93, v8, v9
    v_cvt_pk_bf16_f32 v97, -v9, v8
    v_fma_f32 v4, v10, 2.0, v11
    v_cos_f32 v5, v4
    v_sin_f32 v6, v4
    s_nop 0
    v_cvt_pk_bf16_f32 v94, v5, v6
    v_cvt_pk_bf16_f32 v98, -v6, v5
    v_add_f32 v7, v4, v10
    v_cos_f32 v8, v7
    v_sin_f32 v9, v7
    s_nop 0
    v_cvt_pk_bf16_f32 v95, v8, v9
    v_cvt_pk_bf16_f32 v99, -v9, v8
    s_barrier
    s_mov_b32 s52, s10
    s_mov_b32 s53, s11
    s_mov_b32 s54, 1183744
    s_mov_b32 s55, 0x20000
    s_mov_b32 s56, s12
    s_mov_b32 s57, s13
    s_mov_b32 s58, 1183744
    s_mov_b32 s59, 0x20000
    s_add_u32 m0, s69, 0
    s_nop 0
    buffer_load_dwordx4 v20, s[52:55], 0 offen lds
    s_add_u32 m0, s69, 1024
    s_nop 0
    buffer_load_dwordx4 v21, s[52:55], 0 offen lds
    s_add_u32 m0, s69, 2048
    s_nop 0
    buffer_load_dwordx4 v22, s[52:55], 0 offen lds
    s_add_u32 m0, s69, 3072
    s_nop 0
    buffer_load_dwordx4 v20, s[56:59], 0 offen lds
    s_add_u32 m0, s69, 4096
    s_nop 0
    buffer_load_dwordx4 v21, s[56:59], 0 offen lds
    s_add_u32 m0, s69, 5120
    s_nop 0
    buffer_load_dwordx4 v22, s[56:59], 0 offen lds
    s_lshl_b32 s48, s67, 1
    s_and_b32 s48, s48, 15
    s_add_u32 s48, s48, s69
    v_and_b32 v4, 1, v2
    v_lshrrev_b32 v5, 1, v2
    v_mul_u32_u24 v6, 144, v4
    v_mad_u32_u24 v6, v1, 9, v6
    v_add_lshl_u32 v6, v6, v5, 1
    v_add_u32 v20, s48, v6
    s_cmp_eq_u32 s67, 0
    s_cselect_b32 s49, 608, 0
    s_add_u32 s48, s48, s49
    s_add_u32 s48, s48, 568
    v_sub_u32 v21, s48, v6
    v_lshl_add_u32 v4, v5, 5, v4
    v_lshlrev_b32 v4, 14, v4
    v_lshl_add_u32 v23, v1, 4, v4
    v_add_u32 v24, 1048576, v23
    v_add_u32 v25, 2097152, v23
    v_cmp_gt_u32 vcc, 32, v0
    v_mov_b32 v8, 2146435072
    s_nop 0
    v_cndmask_b32 v25, v8, v25, vcc
    s_lshl_b32 s48, s67, 2
    s_add_u32 s48, s48, s3
    s_lshl_b32 s48, s48, 4
    s_add_u32 s48, s48, 262144
    v_writelane_b32 v18, s48, 0
    buffer_load_dword v222, v18, s[36:39], 0 offen
    s_mov_b32 s48, s67
    s_mov_b32 s49, s3
    s_and_b32 s50, s48, 7
    s_lshr_b32 s48, s48, 3
    s_lshl_b32 s58, s50, 16
    s_lshl_b32 s59, s48, 10
    s_add_u32 s58, s58, s59
    s_lshl_b32 s59, s49, 8
    s_add_u32 s58, s58, s59
    s_add_u32 s56, s58, 1048576
    s_sub_u32 s48, 128, s67
    s_and_b32 s48, s48, 127
    s_sub_u32 s49, 3, s3
    s_and_b32 s50, s48, 7
    s_lshr_b32 s48, s48, 3
    s_lshl_b32 s58, s50, 16
    s_lshl_b32 s59, s48, 10
    s_add_u32 s58, s58, s59
    s_lshl_b32 s59, s49, 8
    s_add_u32 s58, s58, s59
    s_add_u32 s57, s58, 1081344
    s_waitcnt vmcnt(0)
    s_mov_b32 s48, 0x9e3779b1
    v_mul_lo_u32 v3, v3, s48
    v_add_u32 v3, 0x7f4a7c15, v3
    v_or_b32 v3, 0x01010101, v3
    ds_read_u16 v132, v20 offset:0
    ds_read_u16 v136, v20 offset:3072
    ds_read_u16 v133, v20 offset:608
    ds_read_u16 v137, v20 offset:3680
    ds_read_u16 v134, v20 offset:1216
    ds_read_u16 v138, v20 offset:4288
    ds_read_u16 v135, v20 offset:1824
    ds_read_u16 v139, v20 offset:4896
    ds_read_u16 v140, v20 offset:4
    ds_read_u16 v144, v20 offset:3076
    ds_read_u16 v141, v20 offset:612
    ds_read_u16 v145, v20 offset:3684
    ds_read_u16 v142, v20 offset:1220
    ds_read_u16 v146, v20 offset:4292
    ds_read_u16 v143, v20 offset:1828
    ds_read_u16 v147, v20 offset:4900
    ds_read_u16 v148, v20 offset:8
    ds_read_u16 v152, v20 offset:3080
    ds_read_u16 v149, v20 offset:616
    ds_read_u16 v153, v20 offset:3688
    ds_read_u16 v150, v20 offset:1224
    ds_read_u16 v154, v20 offset:4296
    ds_read_u16 v151, v20 offset:1832
    ds_read_u16 v155, v20 offset:4904
    ds_read_u16 v156, v21 offset:1832
    ds_read_u16 v160, v21 offset:4904
    ds_read_u16 v157, v21 offset:1224
    ds_read_u16 v161, v21 offset:4296
    ds_read_u16 v158, v21 offset:616
    ds_read_u16 v162, v21 offset:3688
    ds_read_u16 v159, v21 offset:8
    ds_read_u16 v163, v21 offset:3080
    ds_read_u16 v164, v21 offset:1828
    ds_read_u16 v168, v21 offset:4900
    ds_read_u16 v165, v21 offset:1220
    ds_read_u16 v169, v21 offset:4292
    ds_read_u16 v166, v21 offset:612
    ds_read_u16 v170, v21 offset:3684
    ds_read_u16 v167, v21 offset:4
    ds_read_u16 v171, v21 offset:3076
    ds_read_u16 v172, v21 offset:1824
    ds_read_u16 v176, v21 offset:4896
    ds_read_u16 v173, v21 offset:1216
    ds_read_u16 v177, v21 offset:4288
    ds_read_u16 v174, v21 offset:608
    ds_read_u16 v178, v21 offset:3680
    ds_read_u16 v175, v21 offset:0
    ds_read_u16 v179, v21 offset:3072
    s_waitcnt lgkmcnt(14)
    v_lshl_or_b32 v132, v136, 16, v132
    v_lshl_or_b32 v133, v137, 16, v133
    v_lshl_or_b32 v134, v138, 16, v134
    v_lshl_or_b32 v135, v139, 16, v135
    buffer_store_dwordx4 v[132:135], v23, s[36:39], s56 offen sc1
    v_lshl_or_b32 v140, v144, 16, v140
    v_lshl_or_b32 v141, v145, 16, v141
    v_lshl_or_b32 v142, v146, 16, v142
    v_lshl_or_b32 v143, v147, 16, v143
    buffer_store_dwordx4 v[140:143], v24, s[36:39], s56 offen sc1
    v_lshl_or_b32 v148, v152, 16, v148
    v_lshl_or_b32 v149, v153, 16, v149
    v_lshl_or_b32 v150, v154, 16, v150
    v_lshl_or_b32 v151, v155, 16, v151
    buffer_store_dwordx4 v[148:151], v25, s[36:39], s56 offen sc1
    v_lshl_or_b32 v156, v160, 16, v156
    v_lshl_or_b32 v157, v161, 16, v157
    v_lshl_or_b32 v158, v162, 16, v158
    v_lshl_or_b32 v159, v163, 16, v159
    v_xor_b32 v156, 0x80000000, v156
    v_xor_b32 v157, 0x80000000, v157
    v_xor_b32 v158, 0x80000000, v158
    v_xor_b32 v159, 0x80000000, v159
    buffer_store_dwordx4 v[156:159], v23, s[36:39], s57 offen sc1
    v_lshl_or_b32 v164, v168, 16, v164
    s_waitcnt lgkmcnt(12)
    v_lshl_or_b32 v165, v169, 16, v165
    s_waitcnt lgkmcnt(10)
    v_lshl_or_b32 v166, v170, 16, v166
    s_waitcnt lgkmcnt(8)
    v_lshl_or_b32 v167, v171, 16, v167
    v_xor_b32 v164, 0x80000000, v164
    v_xor_b32 v165, 0x80000000, v165
    v_xor_b32 v166, 0x80000000, v166
    v_xor_b32 v167, 0x80000000, v167
    buffer_store_dwordx4 v[164:167], v24, s[36:39], s57 offen sc1
    s_waitcnt lgkmcnt(6)
    v_lshl_or_b32 v172, v176, 16, v172
    s_waitcnt lgkmcnt(4)
    v_lshl_or_b32 v173, v177, 16, v173
    s_waitcnt lgkmcnt(2)
    v_lshl_or_b32 v174, v178, 16, v174
    s_waitcnt lgkmcnt(0)
    v_lshl_or_b32 v175, v179, 16, v175
    v_xor_b32 v172, 0x80000000, v172
    v_xor_b32 v173, 0x80000000, v173
    v_xor_b32 v174, 0x80000000, v174
    v_xor_b32 v175, 0x80000000, v175
    buffer_store_dwordx4 v[172:175], v25, s[36:39], s57 offen sc1
    s_branch L_m_34
L_m_35:
    v_lshrrev_b32 v4, 3, v0
    v_and_b32 v5, 7, v0
    v_and_b32 v6, 6, v4
    v_xor_b32 v5, v5, v6
    v_mul_u32_u24 v4, 6912, v4
    v_lshl_add_u32 v12, v5, 4, v4
    s_lshl_b32 s48, s61, 2
    s_add_u32 s48, s48, s3
    s_mul_i32 s48, s48, 497664
    s_lshl_b32 s49, s62, 7
    s_add_u32 s47, s48, s49
    s_lshl_b32 s50, s3, 8
    v_lshl_add_u32 v27, v0, 2, s50
    s_mul_i32 s49, s61, 576
    v_add_u32 v9, s49, v27
    v_add_u32 v12, s47, v12
    v_lshrrev_b32 v4, 2, v0
    v_bfe_u32 v5, v4, 1, 2
    v_xor_b32 v5, s3, v5
    v_lshlrev_b32 v5, 5, v5
    v_lshlrev_b32 v4, 7, v4
    v_and_b32 v6, 3, v0
    v_lshlrev_b32 v6, 3, v6
    v_add3_u32 v28, v4, v5, v6
    v_lshlrev_b32 v29, 3, v2
    v_add_u32 v29, 90112, v29
    s_mul_i32 s49, s61, 9216
    s_lshl_b32 s50, s62, 8
    s_add_u32 s49, s49, s50
    s_lshl_b32 s50, s3, 6
    s_add_u32 s49, s49, s50
    s_add_u32 s49, s49, 192000
    v_lshl_add_u32 v4, v1, 2, s49
    v_cmp_gt_u32 vcc, 16, v0
    v_mov_b32 v5, 2146435072
    s_nop 0
    v_cndmask_b32 v30, v5, v4, vcc
    s_waitcnt lgkmcnt(0)
    s_mov_b32 s36, s32
    s_mov_b32 s37, s33
    s_mov_b32 s38, 50331648
    s_mov_b32 s39, 0x20000
    s_mov_b32 s40, s26
    s_mov_b32 s41, s27
    s_mov_b32 s42, 3981312
    s_mov_b32 s43, 0x20000
    v_mov_b32 v4, 32768
    buffer_load_dword v3, v4, s[36:39], 0 offen sc1
    s_mov_b32 s44, s24
    s_mov_b32 s45, s25
    s_mov_b32 s46, 1152
    s_mov_b32 s47, 0x20000
    buffer_load_dword v26, v9, s[44:47], 0 offen
    s_lshr_b32 s51, s5, 2
    s_lshl_b32 s51, s51, 3
    s_add_u32 s51, s51, s4
    s_and_b32 s60, s5, 3
    s_lshl_b32 s35, s51, 2
    s_add_u32 s35, s35, s60
    s_lshl_b32 s35, s35, 14
    s_bfe_u32 s48, s6, 0x20002
    s_lshl_b32 s48, s48, 6
    s_lshr_b32 s49, s6, 4
    s_lshl_b32 s49, s49, 2
    s_add_u32 s48, s48, s49
    s_and_b32 s49, s6, 3
    s_add_u32 s48, s48, s49
    s_lshl_b32 s48, s48, 4
    s_lshl_b32 s49, s3, 16
    s_add_u32 s48, s48, s49
    s_add_u32 s48, s48, 15728640
    v_mov_b32 v17, 2146435072
    v_writelane_b32 v17, s48, 0
    s_add_u32 s48, s48, 16384
    s_add_u32 s48, s2, 160
    s_lshl_b32 s48, s48, 7
    s_add_u32 s48, s48, 557056
    s_lshl_b32 s49, s3, 8
    s_add_u32 s49, s49, s5
    s_cmp_lt_u32 s49, 12
    s_cselect_b32 s48, s48, 2146435072
    v_mov_b32 v19, 2146435072
    v_writelane_b32 v19, s48, 0
    s_or_b32 s48, s2, s3
    s_cmp_eq_u32 s48, 0
    s_cselect_b32 s48, 0, 2146435072
    s_add_u32 s48, s48, 32768
    v_writelane_b32 v19, s48, 1
    buffer_load_dword v220, v17, s[36:39], 0 offen
    buffer_load_dword v221, v19, s[36:39], 0 offen
    buffer_load_dword v222, v30, s[36:39], 0 offen
    s_cmp_ge_u32 s63, 126
    s_cbranch_scc1 L_m_37
    s_mul_i32 m0, s3, 9216
    s_mov_b32 s59, 0
    buffer_load_dwordx4 v12, s[40:43], s59 offen lds
    s_add_u32 m0, m0, 1024
    s_add_u32 s59, s59, 55296
    buffer_load_dwordx4 v12, s[40:43], s59 offen lds
    s_add_u32 m0, m0, 1024
    s_add_u32 s59, s59, 55296
L_m_37:
    s_barrier
    s_waitcnt vmcnt(0)
    s_cmp_ge_u32 s63, 126
    s_cbranch_scc1 L_m_38
    buffer_load_dwordx4 v12, s[40:43], s59 offen lds
    s_add_u32 m0, m0, 1024
    s_add_u32 s59, s59, 55296
    buffer_load_dwordx4 v12, s[40:43], s59 offen lds
    s_add_u32 m0, m0, 1024
    s_add_u32 s59, s59, 55296
    buffer_load_dwordx4 v12, s[40:43], s59 offen lds
    s_add_u32 m0, m0, 1024
    s_add_u32 s59, s59, 55296
    buffer_load_dwordx4 v12, s[40:43], s59 offen lds
    s_add_u32 m0, m0, 1024
    s_add_u32 s59, s59, 55296
    buffer_load_dwordx4 v12, s[40:43], s59 offen lds
    s_add_u32 m0, m0, 1024
    s_add_u32 s59, s59, 55296
    buffer_load_dwordx4 v12, s[40:43], s59 offen lds
    s_add_u32 m0, m0, 1024
    s_add_u32 s59, s59, 55296
    buffer_load_dwordx4 v12, s[40:43], s59 offen lds
L_m_38:
    s_mov_b32 s48, 0x9e3779b1
    v_mul_lo_u32 v3, v3, s48
    v_add_u32 v3, 0x7f4a7c15, v3
    v_or_b32 v3, 0x01010101, v3
    v_lshlrev_b32 v4, 16, v26
    v_and_b32 v5, 0xffff0000, v26
    v_mul_f32 v6, 0xbfb8aa3b, v4
    v_mul_f32 v7, 0xbfb8aa3b, v5
    v_exp_f32 v6, v6
    v_exp_f32 v7, v7
    v_add_f32 v6, 1.0, v6
    v_add_f32 v7, 1.0, v7
    v_rcp_f32 v6, v6
    v_rcp_f32 v7, v7
    v_mul_f32 v4, v4, v6
    v_mul_f32 v5, v5, v7
    v_cvt_pk_bf16_f32 v26, v4, v5
    v_add_u32 v27, 90112, v27
    ds_write_b32 v27, v26
    s_cmp_ge_u32 s5, 20
    s_cbranch_scc1 L_m_39
    v_cvt_f32_u32 v218, v2
    v_mul_f32 v218, 4.0, v218
    v_cvt_f32_u32 v219, v1
    v_cvt_f32_u32 v13, s4
    v_mul_f32 v10, 0x3d800000, v219
    v_fmac_f32 v10, 0x3c000000, v13
    v_mul_f32 v11, v218, v10
    v_cos_f32 v5, v11
    v_sin_f32 v6, v11
    s_nop 0
    v_cvt_pk_bf16_f32 v52, v5, v6
    v_cvt_pk_bf16_f32 v56, -v6, v5
    v_fma_f32 v7, v10, 1.0, v11
    v_cos_f32 v8, v7
    v_sin_f32 v9, v7
    s_nop 0
    v_cvt_pk_bf16_f32 v53, v8, v9
    v_cvt_pk_bf16_f32 v57, -v9, v8
    v_fma_f32 v4, v10, 2.0, v11
    v_cos_f32 v5, v4
    v_sin_f32 v6, v4
    s_nop 0
    v_cvt_pk_bf16_f32 v54, v5, v6
    v_cvt_pk_bf16_f32 v58, -v6, v5
    v_add_f32 v7, v4, v10
    v_cos_f32 v8, v7
    v_sin_f32 v9, v7
    s_nop 0
    v_cvt_pk_bf16_f32 v55, v8, v9
    v_cvt_pk_bf16_f32 v59, -v9, v8
    s_lshl_b32 s48, s3, 5
    s_add_u32 s48, s48, s4
    v_cvt_f32_u32 v14, s48
    v_mul_f32 v14, 0x3a000000, v14
    v_mul_f32 v10, 0x3d800000, v219
    v_add_f32 v10, v10, v14
    v_mul_f32 v11, v218, v10
    v_cos_f32 v5, v11
    v_sin_f32 v6, v11
    s_nop 0
    v_cvt_pk_bf16_f32 v68, v5, v6
    v_cvt_pk_bf16_f32 v72, -v6, v5
    v_fma_f32 v7, v10, 1.0, v11
    v_cos_f32 v8, v7
    v_sin_f32 v9, v7
    s_nop 0
    v_cvt_pk_bf16_f32 v69, v8, v9
    v_cvt_pk_bf16_f32 v73, -v9, v8
    v_fma_f32 v4, v10, 2.0, v11
    v_cos_f32 v5, v4
    v_sin_f32 v6, v4
    s_nop 0
    v_cvt_pk_bf16_f32 v70, v5, v6
    v_cvt_pk_bf16_f32 v74, -v6, v5
    v_add_f32 v7, v4, v10
    v_cos_f32 v8, v7
    v_sin_f32 v9, v7
    s_nop 0
    v_cvt_pk_bf16_f32 v71, v8, v9
    v_cvt_pk_bf16_f32 v75, -v9, v8
    v_add_f32 v10, 0x3b800000, v10
    v_mul_f32 v11, v218, v10
    v_cos_f32 v5, v11
    v_sin_f32 v6, v11
    s_nop 0
    v_cvt_pk_bf16_f32 v76, v5, v6
    v_cvt_pk_bf16_f32 v80, -v6, v5
    v_fma_f32 v7, v10, 1.0, v11
    v_cos_f32 v8, v7
    v_sin_f32 v9, v7
    s_nop 0
    v_cvt_pk_bf16_f32 v77, v8, v9
    v_cvt_pk_bf16_f32 v81, -v9, v8
    v_fma_f32 v4, v10, 2.0, v11
    v_cos_f32 v5, v4
    v_sin_f32 v6, v4
    s_nop 0
    v_cvt_pk_bf16_f32 v78, v5, v6
    v_cvt_pk_bf16_f32 v82, -v6, v5
    v_add_f32 v7, v4, v10
    v_cos_f32 v8, v7
    v_sin_f32 v9, v7
    s_nop 0
    v_cvt_pk_bf16_f32 v79, v8, v9
    v_cvt_pk_bf16_f32 v83, -v9, v8
    v_add_f32 v10, 0x3b800000, v10
    v_mul_f32 v11, v218, v10
    v_cos_f32 v5, v11
    v_sin_f32 v6, v11
    s_nop 0
    v_cvt_pk_bf16_f32 v84, v5, v6
    v_cvt_pk_bf16_f32 v88, -v6, v5
    v_fma_f32 v7, v10, 1.0, v11
    v_cos_f32 v8, v7
    v_sin_f32 v9, v7
    s_nop 0
    v_cvt_pk_bf16_f32 v85, v8, v9
    v_cvt_pk_bf16_f32 v89, -v9, v8
    v_fma_f32 v4, v10, 2.0, v11
    v_cos_f32 v5, v4
    v_sin_f32 v6, v4
    s_nop 0
    v_cvt_pk_bf16_f32 v86, v5, v6
    v_cvt_pk_bf16_f32 v90, -v6, v5
    v_add_f32 v7, v4, v10
    v_cos_f32 v8, v7
    v_sin_f32 v9, v7
    s_nop 0
    v_cvt_pk_bf16_f32 v87, v8, v9
    v_cvt_pk_bf16_f32 v91, -v9, v8
    v_add_f32 v10, 0x3b800000, v10
    v_mul_f32 v11, v218, v10
    v_cos_f32 v5, v11
    v_sin_f32 v6, v11
    s_nop 0
    v_cvt_pk_bf16_f32 v92, v5, v6
    v_cvt_pk_bf16_f32 v96, -v6, v5
    v_fma_f32 v7, v10, 1.0, v11
    v_cos_f32 v8, v7
    v_sin_f32 v9, v7
    s_nop 0
    v_cvt_pk_bf16_f32 v93, v8, v9
    v_cvt_pk_bf16_f32 v97, -v9, v8
    v_fma_f32 v4, v10, 2.0, v11
    v_cos_f32 v5, v4
    v_sin_f32 v6, v4
    s_nop 0
    v_cvt_pk_bf16_f32 v94, v5, v6
    v_cvt_pk_bf16_f32 v98, -v6, v5
    v_add_f32 v7, v4, v10
    v_cos_f32 v8, v7
    v_sin_f32 v9, v7
    s_nop 0
    v_cvt_pk_bf16_f32 v95, v8, v9
    v_cvt_pk_bf16_f32 v99, -v9, v8
L_m_39:
L_m_34:
    s_waitcnt lgkmcnt(0)
    s_barrier
    s_cmp_ge_u32 s5, 20
    s_cbranch_scc1 L_m_40
    s_waitcnt vmcnt(0)
    buffer_store_dword v3, v18, s[36:39], 0 offen sc1
    v_mul_f32 v10, 0x3d800000, v219
    v_fmac_f32 v14, 0x3d800000, v218
    v_mul_f32 v11, v219, v14
    v_cos_f32 v5, v11
    v_sin_f32 v6, v11
    s_nop 0
    v_cvt_pk_bf16_f32 v100, v5, -v6
    v_cvt_pk_bf16_f32 v104, v6, v5
    v_fma_f32 v7, v10, 1.0, v11
    v_cos_f32 v8, v7
    v_sin_f32 v9, v7
    s_nop 0
    v_cvt_pk_bf16_f32 v101, v8, -v9
    v_cvt_pk_bf16_f32 v105, v9, v8
    v_fma_f32 v4, v10, 2.0, v11
    v_cos_f32 v5, v4
    v_sin_f32 v6, v4
    s_nop 0
    v_cvt_pk_bf16_f32 v102, v5, -v6
    v_cvt_pk_bf16_f32 v106, v6, v5
    v_add_f32 v7, v4, v10
    v_cos_f32 v8, v7
    v_sin_f32 v9, v7
    s_nop 0
    v_cvt_pk_bf16_f32 v103, v8, -v9
    v_cvt_pk_bf16_f32 v107, v9, v8
    v_add_f32 v14, 0x3b800000, v14
    v_mul_f32 v11, v219, v14
    v_cos_f32 v5, v11
    v_sin_f32 v6, v11
    s_nop 0
    v_cvt_pk_bf16_f32 v108, v5, -v6
    v_cvt_pk_bf16_f32 v112, v6, v5
    v_fma_f32 v7, v10, 1.0, v11
    v_cos_f32 v8, v7
    v_sin_f32 v9, v7
    s_nop 0
    v_cvt_pk_bf16_f32 v109, v8, -v9
    v_cvt_pk_bf16_f32 v113, v9, v8
    v_fma_f32 v4, v10, 2.0, v11
    v_cos_f32 v5, v4
    v_sin_f32 v6, v4
    s_nop 0
    v_cvt_pk_bf16_f32 v110, v5, -v6
    v_cvt_pk_bf16_f32 v114, v6, v5
    v_add_f32 v7, v4, v10
    v_cos_f32 v8, v7
    v_sin_f32 v9, v7
    s_nop 0
    v_cvt_pk_bf16_f32 v111, v8, -v9
    v_cvt_pk_bf16_f32 v115, v9, v8
    v_add_f32 v14, 0x3b800000, v14
    v_mul_f32 v11, v219, v14
    v_cos_f32 v5, v11
    v_sin_f32 v6, v11
    s_nop 0
    v_cvt_pk_bf16_f32 v116, v5, -v6
    v_cvt_pk_bf16_f32 v120, v6, v5
    v_fma_f32 v7, v10, 1.0, v11
    v_cos_f32 v8, v7
    v_sin_f32 v9, v7
    s_nop 0
    v_cvt_pk_bf16_f32 v117, v8, -v9
    v_cvt_pk_bf16_f32 v121, v9, v8
    v_fma_f32 v4, v10, 2.0, v11
    v_cos_f32 v5, v4
    v_sin_f32 v6, v4
    s_nop 0
    v_cvt_pk_bf16_f32 v118, v5, -v6
    v_cvt_pk_bf16_f32 v122, v6, v5
    v_add_f32 v7, v4, v10
    v_cos_f32 v8, v7
    v_sin_f32 v9, v7
    s_nop 0
    v_cvt_pk_bf16_f32 v119, v8, -v9
    v_cvt_pk_bf16_f32 v123, v9, v8
    v_add_f32 v14, 0x3b800000, v14
    v_mul_f32 v11, v219, v14
    v_cos_f32 v5, v11
    v_sin_f32 v6, v11
    s_nop 0
    v_cvt_pk_bf16_f32 v124, v5, -v6
    v_cvt_pk_bf16_f32 v128, v6, v5
    v_fma_f32 v7, v10, 1.0, v11
    v_cos_f32 v8, v7
    v_sin_f32 v9, v7
    s_nop 0
    v_cvt_pk_bf16_f32 v125, v8, -v9
    v_cvt_pk_bf16_f32 v129, v9, v8
    v_fma_f32 v4, v10, 2.0, v11
    v_cos_f32 v5, v4
    v_sin_f32 v6, v4
    s_nop 0
    v_cvt_pk_bf16_f32 v126, v5, -v6
    v_cvt_pk_bf16_f32 v130, v6, v5
    v_add_f32 v7, v4, v10
    v_cos_f32 v8, v7
    v_sin_f32 v9, v7
    s_nop 0
    v_cvt_pk_bf16_f32 v127, v8, -v9
    v_cvt_pk_bf16_f32 v131, v9, v8
    v_mul_f32 v13, 0x3c000000, v13
    v_fmac_f32 v13, 0x3d800000, v218
    v_mul_f32 v11, v219, v13
    v_cos_f32 v5, v11
    v_sin_f32 v6, v11
    s_nop 0
    v_cvt_pk_bf16_f32 v60, v5, -v6
    v_cvt_pk_bf16_f32 v64, v6, v5
    v_fma_f32 v7, v10, 1.0, v11
    v_cos_f32 v8, v7
    v_sin_f32 v9, v7
    s_nop 0
    v_cvt_pk_bf16_f32 v61, v8, -v9
    v_cvt_pk_bf16_f32 v65, v9, v8
    v_fma_f32 v4, v10, 2.0, v11
    v_cos_f32 v5, v4
    v_sin_f32 v6, v4
    s_nop 0
    v_cvt_pk_bf16_f32 v62, v5, -v6
    v_cvt_pk_bf16_f32 v66, v6, v5
    v_add_f32 v7, v4, v10
    v_cos_f32 v8, v7
    v_sin_f32 v9, v7
    s_nop 0
    v_cvt_pk_bf16_f32 v63, v8, -v9
    v_cvt_pk_bf16_f32 v67, v9, v8
L_m_40:
    s_branch L_stub_10
L_back_h1:
    s_waitcnt vmcnt(0)
    s_lshl_b32 s48, s3, 5
    s_add_u32 s48, s48, s4
    v_lshrrev_b32 v8, 2, v1
    v_lshl_add_u32 v8, v8, 3, s48
    s_cmp_lt_u32 s60, 2
    s_cselect_b32 s48, 1, -1
    v_mul_i32_i24 v8, s48, v8
    v_and_b32 v8, 127, v8
    v_and_b32 v7, 3, v1
    v_lshl_add_u32 v8, v8, 2, v7
    v_lshlrev_b32 v15, 4, v8
    s_mov_b32 s64, 262144
    s_cmp_ge_u32 s5, 20
    s_cbranch_scc1 L_m_41
    buffer_load_dword v18, v15, s[36:39], s64 offen sc1
L_m_41:
    s_barrier
    buffer_store_dword v3, v17, s[36:39], 0 offen sc1
    s_cmp_ge_u32 s63, 126
    s_cbranch_scc1 L_m_42
    ds_read_b64_tr_b16 v[132:133], v28 offset:0
    ds_read_b64_tr_b16 v[134:135], v28 offset:2048
    ds_read2_b64 v[136:139], v29 offset0:0 offset1:4
    ds_read_b64_tr_b16 v[140:141], v28 offset:4096
    ds_read_b64_tr_b16 v[142:143], v28 offset:6144
    ds_read2_b64 v[144:147], v29 offset0:8 offset1:12
    ds_read_b64_tr_b16 v[148:149], v28 offset:8192
    ds_read_b64_tr_b16 v[150:151], v28 offset:10240
    ds_read2_b64 v[152:155], v29 offset0:16 offset1:20
    ds_read_b64_tr_b16 v[156:157], v28 offset:12288
    ds_read_b64_tr_b16 v[158:159], v28 offset:14336
    ds_read2_b64 v[160:163], v29 offset0:24 offset1:28
    ds_read_b64_tr_b16 v[164:165], v28 offset:16384
    ds_read_b64_tr_b16 v[166:167], v28 offset:18432
    ds_read2_b64 v[168:171], v29 offset0:32 offset1:36
    ds_read_b64_tr_b16 v[172:173], v28 offset:20480
    ds_read_b64_tr_b16 v[174:175], v28 offset:22528
    ds_read2_b64 v[176:179], v29 offset0:40 offset1:44
    ds_read_b64_tr_b16 v[180:181], v28 offset:24576
    ds_read_b64_tr_b16 v[182:183], v28 offset:26624
    ds_read2_b64 v[184:187], v29 offset0:48 offset1:52
    ds_read_b64_tr_b16 v[188:189], v28 offset:28672
    ds_read_b64_tr_b16 v[190:191], v28 offset:30720
    ds_read2_b64 v[192:195], v29 offset0:56 offset1:60
    ds_read_b64_tr_b16 v[196:197], v28 offset:32768
    ds_read_b64_tr_b16 v[198:199], v28 offset:34816
    ds_read2_b64 v[200:203], v29 offset0:64 offset1:68
    v_and_b32 v4, 3, v1
    v_or_b32 v4, 0x07060500, v4
    s_waitcnt lgkmcnt(14)
    v_mfma_f32_16x16x32_bf16 v[36:39], v[136:139], v[132:135], 0
    v_mfma_f32_16x16x32_bf16 v[36:39], v[144:147], v[140:143], v[36:39]
    v_mfma_f32_16x16x32_bf16 v[36:39], v[152:155], v[148:151], v[36:39]
    v_mfma_f32_16x16x32_bf16 v[36:39], v[160:163], v[156:159], v[36:39]
    s_waitcnt lgkmcnt(12)
    v_mfma_f32_16x16x32_bf16 v[36:39], v[168:171], v[164:167], v[36:39]
    s_waitcnt lgkmcnt(9)
    v_mfma_f32_16x16x32_bf16 v[36:39], v[176:179], v[172:175], v[36:39]
    s_waitcnt lgkmcnt(6)
    v_mfma_f32_16x16x32_bf16 v[36:39], v[184:187], v[180:183], v[36:39]
    s_waitcnt lgkmcnt(3)
    v_mfma_f32_16x16x32_bf16 v[36:39], v[192:195], v[188:191], v[36:39]
    s_waitcnt lgkmcnt(0)
    v_mfma_f32_16x16x32_bf16 v[36:39], v[200:203], v[196:199], v[36:39]
    s_nop 7
    v_add_u32 v40, 0x80, v36
    v_perm_b32 v40, v40, v3, v4
    s_mov_b32 s48, 0
    buffer_store_dword v40, v30, s[36:39], s48 offen sc1
L_m_42:
    s_cmp_lt_u32 s5, 20
    s_cbranch_scc1 L_m_32
    s_mov_b32 s52, s16
    s_mov_b32 s53, s17
    s_mov_b32 s54, 18874368
    s_mov_b32 s55, 0x20000
    s_mul_i32 s58, s3, 12
    s_add_u32 s58, s58, s5
    s_add_u32 s58, s58, -20
L_m_43:
    s_cmp_ge_u32 s58, 96
    s_cbranch_scc1 L_m_44
    s_mul_i32 s48, s58, 820
    s_lshr_b32 s48, s48, 13
    s_mul_i32 s49, s48, 10
    s_sub_u32 s49, s58, s49
    s_lshl_b32 s49, s49, 6
    v_add_u32 v220, s49, v0
    s_and_b32 s49, s4, 7
    s_mul_i32 s49, s49, 4
    s_add_u32 s48, s48, s49
    s_add_u32 s48, s48, 26
    s_and_b32 s48, s48, 31
    s_mul_i32 s48, s48, 73728
    s_mul_i32 s49, s4, 1152
    s_and_b32 s49, s49, -256
    s_add_u32 s48, s48, s49
    v_mul_u32_u24 v221, 820, v220
    v_lshrrev_b32 v221, 13, v221
    v_mul_u32_u24 v222, 10, v221
    v_sub_u32 v222, v220, v222
    v_and_b32 v220, 7, v221
    v_lshrrev_b32 v221, 3, v221
    v_lshl_add_u32 v220, v220, 8, v221
    v_mul_u32_u24 v220, 9216, v220
    v_lshl_add_u32 v220, v222, 7, v220
    buffer_load_dword v223, v220, s[52:55], s48 offen
    s_add_u32 s58, s58, 48
    s_branch L_m_43
L_m_44:
    s_waitcnt vmcnt(0)
    s_barrier
    s_branch L_m_33
    s_branch L_skip_10
L_stub_10:
    s_branch L_back_h1
L_skip_10:
L_m_32:
    s_setprio 1
    s_lshl_b32 s54, s3, 8
    s_add_u32 s52, s35, s54
    s_add_u32 s52, s52, 4194304
    s_lshl_b32 s53, s3, 12
    s_add_u32 s53, s53, s35
    s_add_u32 s53, s53, 1048576
    v_and_b32 v4, 3, v1
    v_lshrrev_b32 v5, 2, v1
    v_lshlrev_b32 v6, 6, v4
    v_lshl_add_u32 v6, v5, 4, v6
    v_lshl_add_u32 v217, v2, 12, v6
    v_mul_u32_u24 v212, 1040, v1
    v_lshl_add_u32 v212, v2, 6, v212
    v_add_u32 v212, s54, v212
    s_mul_i32 s48, s3, 4160
    v_add_u32 v214, s48, v16
    v_lshl_add_u32 v6, v2, 2, v4
    v_mul_u32_u24 v215, 1056, v6
    v_lshl_add_u32 v215, v5, 4, v215
    v_add_u32 v215, s54, v215
    s_mul_i32 s48, s3, 4224
    v_add_u32 v213, s48, v16
    s_and_b32 s66, s51, 3
    s_xor_b32 s66, s66, s60
    s_lshl_b32 s66, s66, 6
    s_lshl_b32 s48, s51, 8
    s_add_u32 s66, s66, s48
    s_mul_i32 s48, s3, 40960
    s_add_u32 s66, s66, s48
    s_add_u32 s66, s66, 8388608
    s_add_u32 s67, s66, 163840
    s_add_u32 s68, s66, 327680
    s_add_u32 s69, s66, 491520
    s_lshr_b32 s48, s51, 2
    s_and_b32 s48, s48, 2
    v_xor_b32 v4, s48, v4
    v_lshl_add_u32 v5, v2, 6, v5
    v_mul_u32_u24 v216, 10240, v5
    v_lshl_add_u32 v216, v4, 4, v216
    s_lshr_b32 s65, s4, 1
    s_lshl_b32 s65, s65, 16
    s_add_u32 s65, s65, 15728640
    s_lshl_b32 s48, s3, 10
    s_add_u32 s65, s65, s48
    v_lshlrev_b32 v218, 4, v0
    s_waitcnt vmcnt(1)
    v_cmp_ne_u32 vcc, v3, v18
    s_nop 0
    s_cbranch_vccz L_m_45
Lp_m_46:
    buffer_load_dword v18, v15, s[36:39], s64 offen sc1
    s_waitcnt vmcnt(0)
    v_cmp_ne_u32 vcc, v3, v18
    s_nop 0
    s_cbranch_vccz Le_m_47
    s_sub_u32 s7, s7, 1
    s_cbranch_scc1 Le_m_47
    s_sleep 1
    s_branch Lp_m_46
Le_m_47:
    s_max_i32 s7, s7, 0
L_m_45:
    buffer_load_dwordx4 v[224:227], v16, s[36:39], s53 offen offset:0 sc1
    buffer_load_dwordx4 v[228:231], v16, s[36:39], s53 offen offset:1024 sc1
    buffer_load_dwordx4 v[232:235], v16, s[36:39], s53 offen offset:2048 sc1
    buffer_load_dwordx4 v[236:239], v16, s[36:39], s53 offen offset:3072 sc1
    s_waitcnt vmcnt(0)
Lp_m_48:
    buffer_load_dword v4, v218, s[36:39], s65 offen sc1
    s_waitcnt vmcnt(0)
    v_cmp_ne_u32 vcc, v3, v4
    s_nop 0
    s_cbranch_vccz Le_m_49
    s_sub_u32 s7, s7, 1
    s_cbranch_scc1 Le_m_49
    s_mov_b64 exec, vcc
    s_sleep 1
    s_branch Lp_m_48
Le_m_49:
    s_mov_b64 exec, -1
    s_max_i32 s7, s7, 0
    buffer_load_dwordx4 v[36:39], v217, s[36:39], s52 offen offset:0 sc1
    buffer_load_dwordx4 v[40:43], v217, s[36:39], s52 offen offset:1024 sc1
    buffer_load_dwordx4 v[44:47], v217, s[36:39], s52 offen offset:2048 sc1
    buffer_load_dwordx4 v[48:51], v217, s[36:39], s52 offen offset:3072 sc1
    v_lshlrev_b32 v132, 16, v224
    v_and_b32 v136, 0xffff0000, v224
    v_lshlrev_b32 v133, 16, v225
    v_and_b32 v137, 0xffff0000, v225
    v_lshlrev_b32 v134, 16, v226
    v_and_b32 v138, 0xffff0000, v226
    v_lshlrev_b32 v135, 16, v227
    v_and_b32 v139, 0xffff0000, v227
    v_lshlrev_b32 v140, 16, v228
    v_and_b32 v144, 0xffff0000, v228
    v_lshlrev_b32 v141, 16, v229
    v_and_b32 v145, 0xffff0000, v229
    v_lshlrev_b32 v142, 16, v230
    v_and_b32 v146, 0xffff0000, v230
    v_lshlrev_b32 v143, 16, v231
    v_and_b32 v147, 0xffff0000, v231
    v_lshlrev_b32 v148, 16, v232
    v_and_b32 v152, 0xffff0000, v232
    v_lshlrev_b32 v149, 16, v233
    v_and_b32 v153, 0xffff0000, v233
    v_lshlrev_b32 v150, 16, v234
    v_and_b32 v154, 0xffff0000, v234
    v_lshlrev_b32 v151, 16, v235
    v_and_b32 v155, 0xffff0000, v235
    v_lshlrev_b32 v156, 16, v236
    v_and_b32 v160, 0xffff0000, v236
    v_lshlrev_b32 v157, 16, v237
    v_and_b32 v161, 0xffff0000, v237
    v_lshlrev_b32 v158, 16, v238
    v_and_b32 v162, 0xffff0000, v238
    v_lshlrev_b32 v159, 16, v239
    v_and_b32 v163, 0xffff0000, v239
    s_waitcnt vmcnt(2)
    v_swap_b32 v37, v40
    s_waitcnt vmcnt(1)
    v_swap_b32 v38, v44
    s_waitcnt vmcnt(0)
    v_swap_b32 v39, v48
    s_nop 1
    v_mfma_f32_16x16x32_bf16 v[164:167], v[36:39], v[52:55], 0
    v_mfma_f32_16x16x32_bf16 v[168:171], v[36:39], v[56:59], 0
    v_swap_b32 v42, v45
    v_swap_b32 v43, v49
    s_nop 1
    v_mfma_f32_16x16x32_bf16 v[172:175], v[40:43], v[52:55], 0
    v_mfma_f32_16x16x32_bf16 v[176:179], v[40:43], v[56:59], 0
    v_swap_b32 v47, v50
    s_nop 1
    v_mfma_f32_16x16x32_bf16 v[180:183], v[44:47], v[52:55], 0
    v_mfma_f32_16x16x32_bf16 v[184:187], v[44:47], v[56:59], 0
    v_mfma_f32_16x16x32_bf16 v[188:191], v[48:51], v[52:55], 0
    v_mfma_f32_16x16x32_bf16 v[192:195], v[48:51], v[56:59], 0
    v_cvt_pk_bf16_f32 v196, v164, v168
    v_cvt_pk_bf16_f32 v197, v165, v169
    v_cvt_pk_bf16_f32 v198, v166, v170
    v_cvt_pk_bf16_f32 v199, v167, v171
    ds_write_b128 v212, v[196:199] offset:36864
    v_cvt_pk_bf16_f32 v200, v172, v176
    v_cvt_pk_bf16_f32 v201, v173, v177
    v_cvt_pk_bf16_f32 v202, v174, v178
    v_cvt_pk_bf16_f32 v203, v175, v179
    ds_write_b128 v212, v[200:203] offset:36880
    v_cvt_pk_bf16_f32 v204, v180, v184
    v_cvt_pk_bf16_f32 v205, v181, v185
    v_cvt_pk_bf16_f32 v206, v182, v186
    v_cvt_pk_bf16_f32 v207, v183, v187
    ds_write_b128 v212, v[204:207] offset:36896
    v_cvt_pk_bf16_f32 v208, v188, v192
    v_cvt_pk_bf16_f32 v209, v189, v193
    v_cvt_pk_bf16_f32 v210, v190, v194
    v_cvt_pk_bf16_f32 v211, v191, v195
    ds_write_b128 v212, v[208:211] offset:36912
    s_waitcnt lgkmcnt(0)
    s_barrier
    ds_read_b128 v[36:39], v214 offset:36864
    ds_read_b128 v[40:43], v214 offset:37904
    ds_read_b128 v[44:47], v214 offset:38944
    ds_read_b128 v[48:51], v214 offset:39984
    s_waitcnt lgkmcnt(3)
    v_mfma_f32_16x16x32_bf16 v[164:167], v[68:71], v[36:39], 0
    v_mfma_f32_16x16x32_bf16 v[168:171], v[72:75], v[36:39], 0
    s_waitcnt lgkmcnt(2)
    v_mfma_f32_16x16x32_bf16 v[172:175], v[76:79], v[40:43], 0
    v_mfma_f32_16x16x32_bf16 v[176:179], v[80:83], v[40:43], 0
    s_waitcnt lgkmcnt(1)
    v_mfma_f32_16x16x32_bf16 v[180:183], v[84:87], v[44:47], 0
    v_mfma_f32_16x16x32_bf16 v[184:187], v[88:91], v[44:47], 0
    s_waitcnt lgkmcnt(0)
    v_mfma_f32_16x16x32_bf16 v[188:191], v[92:95], v[48:51], 0
    v_mfma_f32_16x16x32_bf16 v[192:195], v[96:99], v[48:51], 0
    v_pk_mul_f32 v[4:5], v[164:165], v[132:133]
    v_pk_mul_f32 v[6:7], v[168:169], v[132:133]
    v_pk_fma_f32 v[4:5], v[168:169], v[136:137], v[4:5] neg_lo:[1,0,0] neg_hi:[1,0,0]
    v_pk_fma_f32 v[6:7], v[164:165], v[136:137], v[6:7]
    v_cvt_pk_bf16_f32 v196, v4, v6
    v_cvt_pk_bf16_f32 v197, v5, v7
    v_pk_mul_f32 v[8:9], v[166:167], v[134:135]
    v_pk_mul_f32 v[10:11], v[170:171], v[134:135]
    v_pk_fma_f32 v[8:9], v[170:171], v[138:139], v[8:9] neg_lo:[1,0,0] neg_hi:[1,0,0]
    v_pk_fma_f32 v[10:11], v[166:167], v[138:139], v[10:11]
    v_cvt_pk_bf16_f32 v198, v8, v10
    v_cvt_pk_bf16_f32 v199, v9, v11
    v_pk_mul_f32 v[4:5], v[172:173], v[140:141]
    v_pk_mul_f32 v[6:7], v[176:177], v[140:141]
    v_pk_fma_f32 v[4:5], v[176:177], v[144:145], v[4:5] neg_lo:[1,0,0] neg_hi:[1,0,0]
    v_pk_fma_f32 v[6:7], v[172:173], v[144:145], v[6:7]
    v_cvt_pk_bf16_f32 v200, v4, v6
    v_cvt_pk_bf16_f32 v201, v5, v7
    v_mfma_f32_16x16x32_bf16 v[164:167], v[100:103], v[196:199], 0
    v_pk_mul_f32 v[8:9], v[174:175], v[142:143]
    v_pk_mul_f32 v[10:11], v[178:179], v[142:143]
    v_pk_fma_f32 v[8:9], v[178:179], v[146:147], v[8:9] neg_lo:[1,0,0] neg_hi:[1,0,0]
    v_pk_fma_f32 v[10:11], v[174:175], v[146:147], v[10:11]
    v_cvt_pk_bf16_f32 v202, v8, v10
    v_cvt_pk_bf16_f32 v203, v9, v11
    v_mfma_f32_16x16x32_bf16 v[168:171], v[104:107], v[196:199], 0
    v_pk_mul_f32 v[4:5], v[180:181], v[148:149]
    v_pk_mul_f32 v[6:7], v[184:185], v[148:149]
    v_pk_fma_f32 v[4:5], v[184:185], v[152:153], v[4:5] neg_lo:[1,0,0] neg_hi:[1,0,0]
    v_pk_fma_f32 v[6:7], v[180:181], v[152:153], v[6:7]
    v_cvt_pk_bf16_f32 v204, v4, v6
    v_cvt_pk_bf16_f32 v205, v5, v7
    v_mfma_f32_16x16x32_bf16 v[172:175], v[108:111], v[200:203], 0
    v_pk_mul_f32 v[8:9], v[182:183], v[150:151]
    v_pk_mul_f32 v[10:11], v[186:187], v[150:151]
    v_pk_fma_f32 v[8:9], v[186:187], v[154:155], v[8:9] neg_lo:[1,0,0] neg_hi:[1,0,0]
    v_pk_fma_f32 v[10:11], v[182:183], v[154:155], v[10:11]
    v_cvt_pk_bf16_f32 v206, v8, v10
    v_cvt_pk_bf16_f32 v207, v9, v11
    v_mfma_f32_16x16x32_bf16 v[176:179], v[112:115], v[200:203], 0
    v_pk_mul_f32 v[4:5], v[188:189], v[156:157]
    v_pk_mul_f32 v[6:7], v[192:193], v[156:157]
    v_pk_fma_f32 v[4:5], v[192:193], v[160:161], v[4:5] neg_lo:[1,0,0] neg_hi:[1,0,0]
    v_pk_fma_f32 v[6:7], v[188:189], v[160:161], v[6:7]
    v_cvt_pk_bf16_f32 v208, v4, v6
    v_cvt_pk_bf16_f32 v209, v5, v7
    v_mfma_f32_16x16x32_bf16 v[180:183], v[116:119], v[204:207], 0
    v_pk_mul_f32 v[8:9], v[190:191], v[158:159]
    v_pk_mul_f32 v[10:11], v[194:195], v[158:159]
    v_pk_fma_f32 v[8:9], v[194:195], v[162:163], v[8:9] neg_lo:[1,0,0] neg_hi:[1,0,0]
    v_pk_fma_f32 v[10:11], v[190:191], v[162:163], v[10:11]
    v_cvt_pk_bf16_f32 v210, v8, v10
    v_cvt_pk_bf16_f32 v211, v9, v11
    v_mfma_f32_16x16x32_bf16 v[184:187], v[120:123], v[204:207], 0
    v_cvt_pk_bf16_f32 v36, v164, v168
    v_cvt_pk_bf16_f32 v40, v165, v169
    v_cvt_pk_bf16_f32 v44, v166, v170
    v_cvt_pk_bf16_f32 v48, v167, v171
    v_mfma_f32_16x16x32_bf16 v[188:191], v[124:127], v[208:211], 0
    v_mfma_f32_16x16x32_bf16 v[192:195], v[128:131], v[208:211], 0
    v_cvt_pk_bf16_f32 v37, v172, v176
    v_cvt_pk_bf16_f32 v41, v173, v177
    v_cvt_pk_bf16_f32 v45, v174, v178
    v_cvt_pk_bf16_f32 v49, v175, v179
    v_cvt_pk_bf16_f32 v38, v180, v184
    v_cvt_pk_bf16_f32 v42, v181, v185
    v_cvt_pk_bf16_f32 v46, v182, v186
    v_cvt_pk_bf16_f32 v50, v183, v187
    v_cvt_pk_bf16_f32 v39, v188, v192
    ds_write_b128 v215, v[36:39] offset:53504
    v_cvt_pk_bf16_f32 v43, v189, v193
    ds_write_b128 v215, v[40:43] offset:53568
    v_cvt_pk_bf16_f32 v47, v190, v194
    ds_write_b128 v215, v[44:47] offset:53632
    v_cvt_pk_bf16_f32 v51, v191, v195
    ds_write_b128 v215, v[48:51] offset:53696
    s_waitcnt lgkmcnt(0)
    s_barrier
    ds_read_b128 v[196:199], v213 offset:53504
    ds_read_b128 v[200:203], v213 offset:54560
    ds_read_b128 v[204:207], v213 offset:55616
    ds_read_b128 v[208:211], v213 offset:56672
    s_waitcnt lgkmcnt(3)
    v_mfma_f32_16x16x32_bf16 v[164:167], v[60:63], v[196:199], 0
    v_mfma_f32_16x16x32_bf16 v[168:171], v[64:67], v[196:199], 0
    s_waitcnt lgkmcnt(2)
    v_mfma_f32_16x16x32_bf16 v[172:175], v[60:63], v[200:203], 0
    v_mfma_f32_16x16x32_bf16 v[176:179], v[64:67], v[200:203], 0
    s_waitcnt lgkmcnt(1)
    v_mfma_f32_16x16x32_bf16 v[180:183], v[60:63], v[204:207], 0
    v_mfma_f32_16x16x32_bf16 v[184:187], v[64:67], v[204:207], 0
    s_waitcnt lgkmcnt(0)
    v_mfma_f32_16x16x32_bf16 v[188:191], v[60:63], v[208:211], 0
    v_mfma_f32_16x16x32_bf16 v[192:195], v[64:67], v[208:211], 0
    v_cvt_pk_bf16_f32 v36, v168, v164
    v_cvt_pk_bf16_f32 v40, v169, v165
    v_cvt_pk_bf16_f32 v44, v170, v166
    v_cvt_pk_bf16_f32 v48, v171, v167
    v_cvt_pk_bf16_f32 v37, v176, v172
    v_cvt_pk_bf16_f32 v41, v177, v173
    v_cvt_pk_bf16_f32 v45, v178, v174
    v_cvt_pk_bf16_f32 v49, v179, v175
    v_cvt_pk_bf16_f32 v38, v184, v180
    v_cvt_pk_bf16_f32 v42, v185, v181
    v_cvt_pk_bf16_f32 v46, v186, v182
    v_cvt_pk_bf16_f32 v50, v187, v183
    v_cvt_pk_bf16_f32 v39, v192, v188
    buffer_store_dwordx4 v[36:39], v216, s[36:39], s66 offen sc1
    v_cvt_pk_bf16_f32 v43, v193, v189
    buffer_store_dwordx4 v[40:43], v216, s[36:39], s67 offen sc1
    v_cvt_pk_bf16_f32 v47, v194, v190
    buffer_store_dwordx4 v[44:47], v216, s[36:39], s68 offen sc1
    v_cvt_pk_bf16_f32 v51, v195, v191
    buffer_store_dwordx4 v[48:51], v216, s[36:39], s69 offen sc1
    buffer_store_dword v3, v19, s[36:39], 0 offen sc1
    s_setprio 0
    s_waitcnt vmcnt(0)
    s_barrier
L_m_33:
    v_lshlrev_b32 v8, 4, v0
    s_mul_i32 s52, s4, 27
    s_add_u32 s52, s52, s5
    s_mul_i32 s51, s52, 171
    s_lshr_b32 s51, s51, 10
    s_mul_i32 s48, s51, 6
    s_sub_u32 s52, s52, s48
    s_lshr_b32 s53, s4, 1
    s_and_b32 s54, s4, 1
    s_lshl_b32 s54, s54, 3
    s_lshr_b32 s48, s5, 2
    s_add_u32 s54, s54, s48
    s_and_b32 s55, s5, 3
    s_mov_b32 s40, s16
    s_mov_b32 s41, s17
    s_mov_b32 s42, 18874368
    s_mov_b32 s43, 0x20000
    s_mov_b32 s44, s20
    s_mov_b32 s45, s21
    s_mov_b32 s46, 18874368
    s_mov_b32 s47, 0x20000
    s_and_b32 s62, s3, 1
    s_and_b32 s63, s4, 7
    s_mul_i32 s63, s63, 4
    s_add_u32 s63, s63, 26
    s_mul_i32 s48, s51, 0
    s_add_u32 s63, s63, s48
    s_and_b32 s63, s63, 31
    s_mov_b32 s64, 0
    s_lshl_b32 s68, s62, 13
    s_cmp_ge_u32 s3, 2
    s_cbranch_scc1 L_m_50
    s_branch L_stub_11
L_back_a1:
    s_mul_i32 s56, s62, 27
    s_add_u32 s56, s56, s5
    s_add_u32 s56, s56, 116
    s_cmp_lt_u32 s5, 27
    s_cselect_b32 s56, s56, 999
    s_barrier
    v_mov_b64 v[28:29], -1
    v_mov_b64 v[30:31], -1
    s_lshl_b32 s56, s2, 1
    s_add_u32 s56, s56, s62
    s_add_u32 s48, s56, 0
    s_cmp_ge_u32 s48, 1152
    s_cbranch_scc1 L_m_51
    s_mov_b32 s49, s48
    s_cmp_ge_u32 s49, 288
    s_cselect_b32 s50, 1008, 0
    s_add_u32 s48, s48, s50
    s_cmp_ge_u32 s49, 576
    s_cselect_b32 s50, 1008, 0
    s_add_u32 s48, s48, s50
    s_cmp_ge_u32 s49, 864
    s_cselect_b32 s50, 1008, 0
    s_add_u32 s48, s48, s50
    s_lshl_b32 s48, s48, 10
    s_add_u32 s48, s48, 21413888
    buffer_store_dwordx4 v[28:31], v8, s[36:39], s48 offen sc1
L_m_51:
    s_add_u32 s48, s56, 512
    s_cmp_ge_u32 s48, 1152
    s_cbranch_scc1 L_m_52
    s_mov_b32 s49, s48
    s_cmp_ge_u32 s49, 288
    s_cselect_b32 s50, 1008, 0
    s_add_u32 s48, s48, s50
    s_cmp_ge_u32 s49, 576
    s_cselect_b32 s50, 1008, 0
    s_add_u32 s48, s48, s50
    s_cmp_ge_u32 s49, 864
    s_cselect_b32 s50, 1008, 0
    s_add_u32 s48, s48, s50
    s_lshl_b32 s48, s48, 10
    s_add_u32 s48, s48, 21413888
    buffer_store_dwordx4 v[28:31], v8, s[36:39], s48 offen sc1
L_m_52:
    s_add_u32 s48, s56, 1024
    s_cmp_ge_u32 s48, 1152
    s_cbranch_scc1 L_m_53
    s_mov_b32 s49, s48
    s_cmp_ge_u32 s49, 288
    s_cselect_b32 s50, 1008, 0
    s_add_u32 s48, s48, s50
    s_branch L_skip_11
L_stub_11:
    s_branch L_stub_12
L_skip_11:
    s_cmp_ge_u32 s49, 576
    s_cselect_b32 s50, 1008, 0
    s_add_u32 s48, s48, s50
    s_cmp_ge_u32 s49, 864
    s_cselect_b32 s50, 1008, 0
    s_add_u32 s48, s48, s50
    s_lshl_b32 s48, s48, 10
    s_add_u32 s48, s48, 21413888
    buffer_store_dwordx4 v[28:31], v8, s[36:39], s48 offen sc1
L_m_53:
    s_bfe_u32 s56, s6, 0x10002
    s_lshl_b32 s56, s56, 7
    s_lshr_b32 s57, s6, 3
    s_lshl_b32 s57, s57, 2
    s_add_u32 s56, s56, s57
    s_and_b32 s57, s6, 3
    s_add_u32 s56, s56, s57
    s_lshl_b32 s48, s56, 4
    s_lshl_b32 s49, s3, 16
    s_add_u32 s48, s48, s49
    s_add_u32 s48, s48, 16252928
    v_mov_b32 v10, 2146435072
    v_writelane_b32 v10, s48, 0
    s_add_u32 s48, s48, 16384
    s_lshl_b32 s56, s52, 6
    s_add_u32 s56, s56, s51
    s_lshl_b32 s48, s56, 4
    s_lshl_b32 s49, s3, 16
    s_add_u32 s48, s48, s49
    s_add_u32 s48, s48, 16515072
    v_mov_b32 v11, 2146435072
    v_writelane_b32 v11, s48, 0
    s_add_u32 s48, s48, 16384
    s_add_u32 s48, s2, 216
    s_lshl_b32 s48, s48, 7
    s_add_u32 s48, s48, 622592
    s_lshl_b32 s49, s3, 8
    s_add_u32 s49, s49, s5
    s_cmp_lt_u32 s49, 5
    s_cselect_b32 s48, s48, 2146435072
    v_writelane_b32 v11, s48, 8
    s_lshr_b32 s65, s4, 2
    s_lshl_b32 s65, s65, 16
    s_add_u32 s66, s65, 16515072
    s_lshl_b32 s48, s62, 11
    s_add_u32 s65, s65, s48
    s_add_u32 s65, s65, 16252928
    s_add_u32 s69, s65, 1024
    v_lshlrev_b32 v27, 4, v0
    s_mul_i32 s67, s52, 1536
    s_mul_i32 s48, s62, 36864
    s_add_u32 s67, s67, s48
    s_add_u32 s67, s67, 16777216
    v_add_u32 v14, 7680, v8
    v_cmp_gt_u32 vcc, 32, v0
    s_nop 1
    v_cndmask_b32 v13, v14, v8, vcc
    v_add_u32 v15, 18432, v8
    v_add_u32 v16, 18432, v13
    v_add_u32 v17, 18432, v14
    s_mul_i32 s68, s62, 6144
    s_mul_i32 s58, s63, 73728
    s_add_u32 s58, s58, s67
    s_add_u32 s59, s67, 2359296
    s_barrier
    s_mul_i32 s56, s62, 288
    s_mul_i32 s57, s6, 1152
    s_add_u32 s57, s57, 12582912
    v_add_u32 v4, 0, v0
    v_min_u32 v4, 287, v4
    v_add_u32 v4, s56, v4
    v_mul_u32_u24 v5, 911, v4
    v_lshrrev_b32 v5, 16, v5
    v_mul_u32_u24 v5, 293760, v5
    v_lshl_add_u32 v22, v4, 4, v5
    v_lshlrev_b32 v4, 4, v4
    v_add_u32 v6, 98304, v4
    v_add_u32 v4, 64, v0
    v_min_u32 v4, 287, v4
    v_add_u32 v4, s56, v4
    v_mul_u32_u24 v5, 911, v4
    v_lshrrev_b32 v5, 16, v5
    v_mul_u32_u24 v5, 293760, v5
    v_lshl_add_u32 v23, v4, 4, v5
    v_add_u32 v4, 128, v0
    v_min_u32 v4, 287, v4
    v_add_u32 v4, s56, v4
    v_mul_u32_u24 v5, 911, v4
    v_lshrrev_b32 v5, 16, v5
    v_mul_u32_u24 v5, 293760, v5
    v_lshl_add_u32 v24, v4, 4, v5
    v_add_u32 v4, 192, v0
    v_min_u32 v4, 287, v4
    v_add_u32 v4, s56, v4
    v_mul_u32_u24 v5, 911, v4
    v_lshrrev_b32 v5, 16, v5
    v_mul_u32_u24 v5, 293760, v5
    v_lshl_add_u32 v25, v4, 4, v5
    v_add_u32 v4, 256, v0
    v_min_u32 v4, 287, v4
    v_add_u32 v4, s56, v4
    v_mul_u32_u24 v5, 911, v4
    v_lshrrev_b32 v5, 16, v5
    v_mul_u32_u24 v5, 293760, v5
    v_lshl_add_u32 v26, v4, 4, v5
    v_lshlrev_b32 v4, 4, v4
    v_add_u32 v7, 98304, v4
    s_barrier
    s_barrier
    ds_read_b128 v[28:31], v6 offset:0
    ds_read_b128 v[32:35], v6 offset:1024
    ds_read_b128 v[36:39], v6 offset:2048
    ds_read_b128 v[40:43], v6 offset:3072
    ds_read_b128 v[44:47], v7 offset:0
    s_lshl_b32 s48, s62, 8
    s_add_u32 s48, s48, s6
    s_lshl_b32 s48, s48, 7
    s_add_u32 s48, s48, 15990784
    v_add_u32 v54, s48, v8
    v_cmp_gt_u32 vcc, 8, v0
    v_mov_b32 v4, 2146435072
    s_nop 0
    v_cndmask_b32 v54, v4, v54, vcc
    s_waitcnt vmcnt(0)
    v_mov_b32 v48, v3
    v_mov_b32 v49, v3
    v_mov_b32 v50, v3
    v_mov_b32 v51, v3
    s_cmp_ge_u32 s5, 27
    s_cbranch_scc1 L_m_54
    v_lshrrev_b32 v52, 4, v0
    v_and_b32 v53, 15, v0
    v_lshlrev_b32 v52, 12, v52
    v_lshl_add_u32 v52, v53, 7, v52
    s_lshr_b32 s48, s4, 1
    s_mul_i32 s48, s48, 4718592
    s_and_b32 s49, s4, 1
    s_lshl_b32 s49, s49, 11
    s_add_u32 s48, s48, s49
    v_add_u32 v52, s48, v52
    s_mov_b32 s35, 0
    s_mov_b32 s49, s35
    s_mul_i32 s48, s62, 1
    s_add_u32 s49, s49, s48
    s_bfm_b32 s48, s5, 0
    s_and_b32 s48, s48, 0
    s_bcnt1_i32_b32 s48, s48
    s_sub_u32 s12, s5, s48
    s_mul_i32 s35, s12, 4
    s_add_u32 s35, s35, 52
    s_add_u32 s35, s35, s49
    s_min_u32 s35, s35, 159
    s_lshl_b32 s8, s35, 14
    s_mul_i32 s35, s12, 4
    s_add_u32 s35, s35, 54
    s_add_u32 s35, s35, s49
    s_min_u32 s35, s35, 159
    s_lshl_b32 s9, s35, 14
    s_mul_i32 s35, s12, 132
    s_lshr_b32 s35, s35, 8
    s_add_u32 s35, s35, 0
    s_mov_b32 s48, 0
    s_bitcmp1_b32 s48, s5
    s_cselect_b32 s35, 999, s35
    s_add_u32 s50, s58, 442368
    s_cmp_ge_u32 s50, s59
    s_cselect_b32 s48, 2359296, 0
    s_sub_u32 s50, s50, s48
    s_waitcnt lgkmcnt(0)
    s_barrier
    buffer_store_dword v3, v10, s[36:39], 0 offen sc1
    v_add_u32 v76, 0, v0
    v_mul_u32_u24 v77, 1821, v76
    v_lshrrev_b32 v77, 18, v77
    v_mul_u32_u24 v77, 6912, v77
    v_lshl_add_u32 v77, v76, 4, v77
    v_subrev_u32 v56, 0, v77
    v_add_u32 v76, 64, v0
    v_mul_u32_u24 v77, 1821, v76
    v_lshrrev_b32 v77, 18, v77
    v_mul_u32_u24 v77, 6912, v77
    v_lshl_add_u32 v77, v76, 4, v77
    v_subrev_u32 v57, 1024, v77
    v_add_u32 v76, 128, v0
    v_mul_u32_u24 v77, 1821, v76
    v_lshrrev_b32 v77, 18, v77
    v_mul_u32_u24 v77, 6912, v77
    v_lshl_add_u32 v77, v76, 4, v77
    v_subrev_u32 v58, 2048, v77
    v_add_u32 v76, 192, v0
    v_mul_u32_u24 v77, 1821, v76
    v_lshrrev_b32 v77, 18, v77
    v_mul_u32_u24 v77, 6912, v77
    v_lshl_add_u32 v77, v76, 4, v77
    v_subrev_u32 v59, 3072, v77
    v_add_u32 v76, 256, v0
    v_mul_u32_u24 v77, 1821, v76
    v_lshrrev_b32 v77, 18, v77
    v_mul_u32_u24 v77, 6912, v77
    v_lshl_add_u32 v77, v76, 4, v77
    v_subrev_u32 v60, 0, v77
    v_add_u32 v76, 320, v0
    v_mul_u32_u24 v77, 1821, v76
    v_lshrrev_b32 v77, 18, v77
    v_mul_u32_u24 v77, 6912, v77
    v_lshl_add_u32 v77, v76, 4, v77
    v_subrev_u32 v61, 1024, v77
    v_add_u32 v76, 384, v0
    v_mul_u32_u24 v77, 1821, v76
    v_lshrrev_b32 v77, 18, v77
    v_mul_u32_u24 v77, 6912, v77
    v_lshl_add_u32 v77, v76, 4, v77
    v_subrev_u32 v62, 2048, v77
    v_add_u32 v76, 448, v0
    v_mul_u32_u24 v77, 1821, v76
    v_lshrrev_b32 v77, 18, v77
    v_mul_u32_u24 v77, 6912, v77
    v_lshl_add_u32 v77, v76, 4, v77
    v_subrev_u32 v63, 3072, v77
    v_add_u32 v76, 512, v0
    v_mul_u32_u24 v77, 1821, v76
    v_lshrrev_b32 v77, 18, v77
    v_mul_u32_u24 v77, 6912, v77
    v_lshl_add_u32 v77, v76, 4, v77
    v_subrev_u32 v64, 0, v77
    s_mul_i32 s48, s55, 3
    s_add_u32 s49, s48, 2
    s_lshr_b32 s48, s48, 1
    s_lshr_b32 s49, s49, 1
    v_mov_b32 v76, s48
    v_mov_b32 v77, s49
    v_cmp_gt_u32 vcc, 32, v0
    s_nop 1
    v_cndmask_b32 v76, v77, v76, vcc
    v_and_b32 v77, 31, v0
    v_min_u32 v77, 8, v77
    v_lshl_add_u32 v76, v76, 6, v77
    s_mul_i32 s48, s53, 9
    v_add_u32 v76, s48, v76
    v_lshlrev_b32 v66, 4, v76
    s_lshr_b32 s48, s54, 3
    s_lshl_b32 s48, s48, 2
    s_and_b32 s49, s54, 1
    s_lshl_b32 s49, s49, 1
    s_add_u32 s48, s48, s49
    s_add_u32 s48, s48, s62
    s_lshl_b32 s48, s48, 13
    s_add_u32 s48, s48, 15990784
    v_lshl_add_u32 v67, v0, 7, s48
    v_mov_b32 v68, 0
    s_lshl_b32 s48, s54, 7
    s_lshr_b32 s49, s53, 1
    s_lshl_b32 s49, s49, 4
    s_add_u32 s48, s48, s49
    s_mul_i32 s48, s48, 1152
    s_mul_i32 s49, s55, 288
    s_add_u32 s48, s48, s49
    s_and_b32 s49, s53, 1
    s_mul_i32 s49, s49, 144
    s_add_u32 s48, s48, s49
    s_add_u32 s12, s48, 12582912
    s_lshl_b32 s13, s62, 6
    v_add_u32 v76, s13, v0
    v_mul_u32_u24 v77, 911, v76
    v_lshrrev_b32 v77, 13, v77
    v_mul_u32_u24 v78, 9, v77
    v_sub_u32 v78, v76, v78
    v_and_b32 v76, 48, v77
    v_add_u32 v77, v77, v76
    v_mul_u32_u24 v77, 1152, v77
    v_lshl_add_u32 v77, v78, 4, v77
    v_add_u32 v70, s12, v77
    s_add_u32 s13, s13, 128
    v_add_u32 v76, s13, v0
    v_mul_u32_u24 v77, 911, v76
    v_lshrrev_b32 v77, 13, v77
    v_mul_u32_u24 v78, 9, v77
    v_sub_u32 v78, v76, v78
    v_and_b32 v76, 48, v77
    v_add_u32 v77, v77, v76
    v_mul_u32_u24 v77, 1152, v77
    v_lshl_add_u32 v77, v78, 4, v77
    v_add_u32 v71, s12, v77
    s_add_u32 s13, s13, 128
    v_add_u32 v76, s13, v0
    v_mul_u32_u24 v77, 911, v76
    v_lshrrev_b32 v77, 13, v77
    v_mul_u32_u24 v78, 9, v77
    v_sub_u32 v78, v76, v78
    v_and_b32 v76, 48, v77
    v_add_u32 v77, v77, v76
    v_mul_u32_u24 v77, 1152, v77
    v_lshl_add_u32 v77, v78, 4, v77
    v_add_u32 v72, s12, v77
    s_add_u32 s13, s13, 128
    v_add_u32 v76, s13, v0
    v_mul_u32_u24 v77, 911, v76
    v_lshrrev_b32 v77, 13, v77
    v_mul_u32_u24 v78, 9, v77
    v_sub_u32 v78, v76, v78
    v_and_b32 v76, 48, v77
    v_add_u32 v77, v77, v76
    v_mul_u32_u24 v77, 1152, v77
    v_lshl_add_u32 v77, v78, 4, v77
    v_add_u32 v73, s12, v77
    s_add_u32 s13, s13, 128
    v_add_u32 v76, s13, v0
    v_mul_u32_u24 v77, 911, v76
    v_lshrrev_b32 v77, 13, v77
    v_mul_u32_u24 v78, 9, v77
    v_sub_u32 v78, v76, v78
    v_and_b32 v76, 48, v77
    v_add_u32 v77, v77, v76
    v_mul_u32_u24 v77, 1152, v77
    v_lshl_add_u32 v77, v78, 4, v77
    v_add_u32 v74, s12, v77
    s_add_u32 s13, s13, 128
    s_mul_i32 s48, s55, 576
    s_and_b32 s49, s53, 1
    s_mul_i32 s49, s49, 288
    s_add_u32 s48, s48, s49
    s_add_u32 s48, s48, 11520
    v_min_u32 v76, 272, v8
    v_add_u32 v76, s48, v76
    s_cmp_eq_u32 s62, 1
    s_cselect_b64 vcc, -1, 0
    v_cndmask_b32 v74, v74, v76, vcc
    s_waitcnt vmcnt(0)
    buffer_store_dwordx4 v[28:31], v22, s[36:39], s57 offen sc1
    buffer_store_dwordx4 v[32:35], v23, s[36:39], s57 offen sc1
    buffer_store_dwordx4 v[36:39], v24, s[36:39], s57 offen sc1
    buffer_store_dwordx4 v[40:43], v25, s[36:39], s57 offen sc1
    buffer_store_dwordx4 v[44:47], v26, s[36:39], s57 offen sc1
    s_waitcnt vmcnt(0)
    buffer_store_dwordx4 v[48:51], v54, s[36:39], 0 offen sc1
Lp_m_56:
    buffer_load_dword v4, v27, s[36:39], s65 offen sc1
    buffer_load_dword v5, v27, s[36:39], s69 offen sc1
    s_waitcnt vmcnt(0)
    v_cmp_ne_u32 vcc, v3, v4
    v_cmp_ne_u32 s[48:49], v3, v5
    s_nop 0
    s_or_b64 vcc, vcc, s[48:49]
    s_cbranch_vccz Le_m_57
    s_sub_u32 s7, s7, 1
    s_cbranch_scc1 Le_m_57
    s_mov_b64 exec, vcc
    s_sleep 1
    s_branch Lp_m_56
Le_m_57:
    s_mov_b64 exec, -1
    s_max_i32 s7, s7, 0
    s_add_u32 m0, s68, 98304
    s_nop 0
    buffer_load_dwordx4 v8, s[36:39], s50 offen offset:0 sc1 lds
    buffer_load_dwordx4 v13, s[36:39], s50 offen offset:1024 sc1 lds
    buffer_load_dwordx4 v14, s[36:39], s50 offen offset:2048 sc1 lds
    s_add_u32 m0, s68, 101376
    s_nop 0
    buffer_load_dwordx4 v15, s[36:39], s50 offen offset:0 sc1 lds
    buffer_load_dwordx4 v16, s[36:39], s50 offen offset:1024 sc1 lds
    buffer_load_dwordx4 v17, s[36:39], s50 offen offset:2048 sc1 lds
    s_add_u32 s50, s58, 516096
    s_cmp_ge_u32 s50, s59
    s_cselect_b32 s48, 2359296, 0
    s_sub_u32 s50, s50, s48
    s_add_u32 m0, s68, 110592
    s_nop 0
    buffer_load_dwordx4 v8, s[36:39], s50 offen offset:0 sc1 lds
    buffer_load_dwordx4 v13, s[36:39], s50 offen offset:1024 sc1 lds
    buffer_load_dwordx4 v14, s[36:39], s50 offen offset:2048 sc1 lds
    s_add_u32 m0, s68, 113664
    s_nop 0
    buffer_load_dwordx4 v15, s[36:39], s50 offen offset:0 sc1 lds
    buffer_load_dwordx4 v16, s[36:39], s50 offen offset:1024 sc1 lds
    buffer_load_dwordx4 v17, s[36:39], s50 offen offset:2048 sc1 lds
    s_add_u32 s50, s58, 589824
    s_cmp_ge_u32 s50, s59
    s_cselect_b32 s48, 2359296, 0
    s_sub_u32 s50, s50, s48
    s_waitcnt vmcnt(6)
    s_barrier
    s_add_u32 m0, s68, 122880
    s_nop 0
    buffer_load_dwordx4 v8, s[36:39], s50 offen offset:0 sc1 lds
    buffer_load_dwordx4 v13, s[36:39], s50 offen offset:1024 sc1 lds
    buffer_load_dwordx4 v14, s[36:39], s50 offen offset:2048 sc1 lds
    s_add_u32 m0, s68, 125952
    s_nop 0
    buffer_load_dwordx4 v15, s[36:39], s50 offen offset:0 sc1 lds
    buffer_load_dwordx4 v16, s[36:39], s50 offen offset:1024 sc1 lds
    buffer_load_dwordx4 v17, s[36:39], s50 offen offset:2048 sc1 lds
    s_add_u32 s50, s58, 663552
    s_cmp_ge_u32 s50, s59
    s_cselect_b32 s48, 2359296, 0
    s_sub_u32 s50, s50, s48
    s_add_u32 m0, s68, 135168
    s_nop 0
    buffer_load_dwordx4 v8, s[36:39], s50 offen offset:0 sc1 lds
    buffer_load_dwordx4 v13, s[36:39], s50 offen offset:1024 sc1 lds
    buffer_load_dwordx4 v14, s[36:39], s50 offen offset:2048 sc1 lds
    s_add_u32 m0, s68, 138240
    s_nop 0
    buffer_load_dwordx4 v15, s[36:39], s50 offen offset:0 sc1 lds
    buffer_load_dwordx4 v16, s[36:39], s50 offen offset:1024 sc1 lds
    buffer_load_dwordx4 v17, s[36:39], s50 offen offset:2048 sc1 lds
    s_add_u32 s50, s58, 737280
    s_cmp_ge_u32 s50, s59
    s_cselect_b32 s48, 2359296, 0
    s_sub_u32 s50, s50, s48
    s_cmp_lg_u32 s35, 0
    s_cbranch_scc1 L_m_58
    buffer_load_dword v53, v52, s[44:47], s8 offen
    buffer_load_dword v53, v52, s[44:47], s9 offen
L_m_58:
    s_waitcnt vmcnt(12)
    s_barrier
    s_add_u32 m0, s68, 147456
    s_nop 0
    buffer_load_dwordx4 v8, s[36:39], s50 offen offset:0 sc1 lds
    buffer_load_dwordx4 v13, s[36:39], s50 offen offset:1024 sc1 lds
    buffer_load_dwordx4 v14, s[36:39], s50 offen offset:2048 sc1 lds
    s_add_u32 m0, s68, 150528
    s_nop 0
    buffer_load_dwordx4 v15, s[36:39], s50 offen offset:0 sc1 lds
    buffer_load_dwordx4 v16, s[36:39], s50 offen offset:1024 sc1 lds
    buffer_load_dwordx4 v17, s[36:39], s50 offen offset:2048 sc1 lds
    s_add_u32 s50, s58, 811008
    s_cmp_ge_u32 s50, s59
    s_cselect_b32 s48, 2359296, 0
    s_sub_u32 s50, s50, s48
    s_cmp_lg_u32 s35, 1
    s_cbranch_scc1 L_m_59
    buffer_load_dword v53, v52, s[44:47], s8 offen
    buffer_load_dword v53, v52, s[44:47], s9 offen
L_m_59:
    s_waitcnt vmcnt(12)
    s_barrier
    s_add_u32 m0, s68, 98304
    s_nop 0
    buffer_load_dwordx4 v8, s[36:39], s50 offen offset:0 sc1 lds
    buffer_load_dwordx4 v13, s[36:39], s50 offen offset:1024 sc1 lds
    buffer_load_dwordx4 v14, s[36:39], s50 offen offset:2048 sc1 lds
    s_add_u32 m0, s68, 101376
    s_nop 0
    buffer_load_dwordx4 v15, s[36:39], s50 offen offset:0 sc1 lds
    buffer_load_dwordx4 v16, s[36:39], s50 offen offset:1024 sc1 lds
    buffer_load_dwordx4 v17, s[36:39], s50 offen offset:2048 sc1 lds
    s_add_u32 s50, s58, 0
    s_cmp_ge_u32 s50, s59
    s_cselect_b32 s48, 2359296, 0
    s_sub_u32 s50, s50, s48
    s_cmp_lg_u32 s35, 2
    s_cbranch_scc1 L_m_60
    buffer_load_dword v53, v52, s[44:47], s8 offen
    buffer_load_dword v53, v52, s[44:47], s9 offen
L_m_60:
    s_waitcnt vmcnt(12)
    s_barrier
    s_add_u32 m0, s68, 110592
    s_nop 0
    buffer_load_dwordx4 v8, s[36:39], s50 offen offset:0 sc1 lds
    buffer_load_dwordx4 v13, s[36:39], s50 offen offset:1024 sc1 lds
    buffer_load_dwordx4 v14, s[36:39], s50 offen offset:2048 sc1 lds
    s_add_u32 m0, s68, 113664
    s_nop 0
    buffer_load_dwordx4 v15, s[36:39], s50 offen offset:0 sc1 lds
    buffer_load_dwordx4 v16, s[36:39], s50 offen offset:1024 sc1 lds
    buffer_load_dwordx4 v17, s[36:39], s50 offen offset:2048 sc1 lds
    s_add_u32 s50, s58, 884736
    s_cmp_ge_u32 s50, s59
    s_cselect_b32 s48, 2359296, 0
    s_sub_u32 s50, s50, s48
    s_cmp_lg_u32 s35, 3
    s_cbranch_scc1 L_m_61
    buffer_load_dword v53, v52, s[44:47], s8 offen
    buffer_load_dword v53, v52, s[44:47], s9 offen
L_m_61:
    s_waitcnt vmcnt(12)
    s_barrier
    s_add_u32 m0, s68, 122880
    s_nop 0
    buffer_load_dwordx4 v8, s[36:39], s50 offen offset:0 sc1 lds
    buffer_load_dwordx4 v13, s[36:39], s50 offen offset:1024 sc1 lds
    buffer_load_dwordx4 v14, s[36:39], s50 offen offset:2048 sc1 lds
    s_add_u32 m0, s68, 125952
    s_nop 0
    buffer_load_dwordx4 v15, s[36:39], s50 offen offset:0 sc1 lds
    buffer_load_dwordx4 v16, s[36:39], s50 offen offset:1024 sc1 lds
    buffer_load_dwordx4 v17, s[36:39], s50 offen offset:2048 sc1 lds
    s_add_u32 s50, s58, 958464
    s_cmp_ge_u32 s50, s59
    s_cselect_b32 s48, 2359296, 0
    s_sub_u32 s50, s50, s48
    s_cmp_lg_u32 s35, 4
    s_cbranch_scc1 L_m_62
    buffer_load_dword v53, v52, s[44:47], s8 offen
    buffer_load_dword v53, v52, s[44:47], s9 offen
L_m_62:
    s_waitcnt vmcnt(12)
    s_barrier
    s_add_u32 m0, s68, 135168
    s_nop 0
    buffer_load_dwordx4 v8, s[36:39], s50 offen offset:0 sc1 lds
    buffer_load_dwordx4 v13, s[36:39], s50 offen offset:1024 sc1 lds
    buffer_load_dwordx4 v14, s[36:39], s50 offen offset:2048 sc1 lds
    s_add_u32 m0, s68, 138240
    s_nop 0
    buffer_load_dwordx4 v15, s[36:39], s50 offen offset:0 sc1 lds
    buffer_load_dwordx4 v16, s[36:39], s50 offen offset:1024 sc1 lds
    buffer_load_dwordx4 v17, s[36:39], s50 offen offset:2048 sc1 lds
    s_add_u32 s50, s58, 1032192
    s_cmp_ge_u32 s50, s59
    s_cselect_b32 s48, 2359296, 0
    s_sub_u32 s50, s50, s48
    s_cmp_lg_u32 s35, 5
    s_cbranch_scc1 L_m_63
    buffer_load_dword v53, v52, s[44:47], s8 offen
    buffer_load_dword v53, v52, s[44:47], s9 offen
L_m_63:
    s_waitcnt vmcnt(12)
    s_barrier
    s_add_u32 m0, s68, 147456
    s_nop 0
    buffer_load_dwordx4 v8, s[36:39], s50 offen offset:0 sc1 lds
    buffer_load_dwordx4 v13, s[36:39], s50 offen offset:1024 sc1 lds
    buffer_load_dwordx4 v14, s[36:39], s50 offen offset:2048 sc1 lds
    s_add_u32 m0, s68, 150528
    s_nop 0
    buffer_load_dwordx4 v15, s[36:39], s50 offen offset:0 sc1 lds
    buffer_load_dwordx4 v16, s[36:39], s50 offen offset:1024 sc1 lds
    buffer_load_dwordx4 v17, s[36:39], s50 offen offset:2048 sc1 lds
    s_add_u32 s50, s58, 73728
    s_cmp_ge_u32 s50, s59
    s_cselect_b32 s48, 2359296, 0
    s_sub_u32 s50, s50, s48
    s_cmp_lg_u32 s35, 6
    s_cbranch_scc1 L_m_64
    buffer_load_dword v53, v52, s[44:47], s8 offen
    buffer_load_dword v53, v52, s[44:47], s9 offen
L_m_64:
    s_waitcnt vmcnt(12)
    s_barrier
    s_add_u32 m0, s68, 98304
    s_nop 0
    buffer_load_dwordx4 v8, s[36:39], s50 offen offset:0 sc1 lds
    buffer_load_dwordx4 v13, s[36:39], s50 offen offset:1024 sc1 lds
    buffer_load_dwordx4 v14, s[36:39], s50 offen offset:2048 sc1 lds
    s_add_u32 m0, s68, 101376
    s_nop 0
    buffer_load_dwordx4 v15, s[36:39], s50 offen offset:0 sc1 lds
    buffer_load_dwordx4 v16, s[36:39], s50 offen offset:1024 sc1 lds
    buffer_load_dwordx4 v17, s[36:39], s50 offen offset:2048 sc1 lds
    s_add_u32 s50, s58, 1105920
    s_cmp_ge_u32 s50, s59
    s_cselect_b32 s48, 2359296, 0
    s_sub_u32 s50, s50, s48
    s_cmp_lg_u32 s35, 7
    s_cbranch_scc1 L_m_65
    buffer_load_dword v53, v52, s[44:47], s8 offen
    buffer_load_dword v53, v52, s[44:47], s9 offen
L_m_65:
    s_waitcnt vmcnt(12)
    s_barrier
    s_add_u32 m0, s68, 110592
    s_nop 0
    buffer_load_dwordx4 v8, s[36:39], s50 offen offset:0 sc1 lds
    buffer_load_dwordx4 v13, s[36:39], s50 offen offset:1024 sc1 lds
    buffer_load_dwordx4 v14, s[36:39], s50 offen offset:2048 sc1 lds
    s_add_u32 m0, s68, 113664
    s_nop 0
    buffer_load_dwordx4 v15, s[36:39], s50 offen offset:0 sc1 lds
    buffer_load_dwordx4 v16, s[36:39], s50 offen offset:1024 sc1 lds
    buffer_load_dwordx4 v17, s[36:39], s50 offen offset:2048 sc1 lds
    s_add_u32 s50, s58, 1179648
    s_cmp_ge_u32 s50, s59
    s_cselect_b32 s48, 2359296, 0
    s_sub_u32 s50, s50, s48
    s_cmp_lg_u32 s35, 8
    s_cbranch_scc1 L_m_66
    buffer_load_dword v53, v52, s[44:47], s8 offen
    buffer_load_dword v53, v52, s[44:47], s9 offen
L_m_66:
    s_waitcnt vmcnt(12)
    s_barrier
    s_add_u32 m0, s68, 122880
    s_nop 0
    buffer_load_dwordx4 v8, s[36:39], s50 offen offset:0 sc1 lds
    buffer_load_dwordx4 v13, s[36:39], s50 offen offset:1024 sc1 lds
    buffer_load_dwordx4 v14, s[36:39], s50 offen offset:2048 sc1 lds
    s_add_u32 m0, s68, 125952
    s_nop 0
    buffer_load_dwordx4 v15, s[36:39], s50 offen offset:0 sc1 lds
    buffer_load_dwordx4 v16, s[36:39], s50 offen offset:1024 sc1 lds
    buffer_load_dwordx4 v17, s[36:39], s50 offen offset:2048 sc1 lds
    s_add_u32 s50, s58, 1253376
    s_cmp_ge_u32 s50, s59
    s_cselect_b32 s48, 2359296, 0
    s_sub_u32 s50, s50, s48
    s_cmp_lg_u32 s35, 9
    s_cbranch_scc1 L_m_67
    buffer_load_dword v53, v52, s[44:47], s8 offen
    buffer_load_dword v53, v52, s[44:47], s9 offen
L_m_67:
    s_waitcnt vmcnt(12)
    s_barrier
    s_add_u32 m0, s68, 135168
    s_nop 0
    buffer_load_dwordx4 v8, s[36:39], s50 offen offset:0 sc1 lds
    buffer_load_dwordx4 v13, s[36:39], s50 offen offset:1024 sc1 lds
    buffer_load_dwordx4 v14, s[36:39], s50 offen offset:2048 sc1 lds
    s_add_u32 m0, s68, 138240
    s_nop 0
    buffer_load_dwordx4 v15, s[36:39], s50 offen offset:0 sc1 lds
    buffer_load_dwordx4 v16, s[36:39], s50 offen offset:1024 sc1 lds
    buffer_load_dwordx4 v17, s[36:39], s50 offen offset:2048 sc1 lds
    s_add_u32 s50, s58, 147456
    s_cmp_ge_u32 s50, s59
    s_cselect_b32 s48, 2359296, 0
    s_sub_u32 s50, s50, s48
    s_cmp_lg_u32 s35, 10
    s_cbranch_scc1 L_m_68
    buffer_load_dword v53, v52, s[44:47], s8 offen
    buffer_load_dword v53, v52, s[44:47], s9 offen
L_m_68:
    s_waitcnt vmcnt(12)
    s_barrier
    s_add_u32 m0, s68, 147456
    s_nop 0
    buffer_load_dwordx4 v8, s[36:39], s50 offen offset:0 sc1 lds
    buffer_load_dwordx4 v13, s[36:39], s50 offen offset:1024 sc1 lds
    buffer_load_dwordx4 v14, s[36:39], s50 offen offset:2048 sc1 lds
    s_add_u32 m0, s68, 150528
    s_nop 0
    buffer_load_dwordx4 v15, s[36:39], s50 offen offset:0 sc1 lds
    buffer_load_dwordx4 v16, s[36:39], s50 offen offset:1024 sc1 lds
    buffer_load_dwordx4 v17, s[36:39], s50 offen offset:2048 sc1 lds
    s_add_u32 s50, s58, 1327104
    s_cmp_ge_u32 s50, s59
    s_cselect_b32 s48, 2359296, 0
    s_sub_u32 s50, s50, s48
    s_cmp_lg_u32 s35, 11
    s_cbranch_scc1 L_m_69
    buffer_load_dword v53, v52, s[44:47], s8 offen
    buffer_load_dword v53, v52, s[44:47], s9 offen
L_m_69:
    s_waitcnt vmcnt(12)
    s_barrier
    s_add_u32 m0, s68, 98304
    s_nop 0
    buffer_load_dwordx4 v8, s[36:39], s50 offen offset:0 sc1 lds
    buffer_load_dwordx4 v13, s[36:39], s50 offen offset:1024 sc1 lds
    buffer_load_dwordx4 v14, s[36:39], s50 offen offset:2048 sc1 lds
    s_add_u32 m0, s68, 101376
    s_nop 0
    buffer_load_dwordx4 v15, s[36:39], s50 offen offset:0 sc1 lds
    buffer_load_dwordx4 v16, s[36:39], s50 offen offset:1024 sc1 lds
    buffer_load_dwordx4 v17, s[36:39], s50 offen offset:2048 sc1 lds
    s_add_u32 s50, s58, 1400832
    s_cmp_ge_u32 s50, s59
    s_cselect_b32 s48, 2359296, 0
    s_sub_u32 s50, s50, s48
    s_cmp_lg_u32 s35, 12
    s_cbranch_scc1 L_m_70
    buffer_load_dword v53, v52, s[44:47], s8 offen
    buffer_load_dword v53, v52, s[44:47], s9 offen
L_m_70:
    s_waitcnt vmcnt(12)
    s_barrier
    s_add_u32 m0, s68, 110592
    s_nop 0
    buffer_load_dwordx4 v8, s[36:39], s50 offen offset:0 sc1 lds
    buffer_load_dwordx4 v13, s[36:39], s50 offen offset:1024 sc1 lds
    buffer_load_dwordx4 v14, s[36:39], s50 offen offset:2048 sc1 lds
    s_add_u32 m0, s68, 113664
    s_nop 0
    buffer_load_dwordx4 v15, s[36:39], s50 offen offset:0 sc1 lds
    buffer_load_dwordx4 v16, s[36:39], s50 offen offset:1024 sc1 lds
    buffer_load_dwordx4 v17, s[36:39], s50 offen offset:2048 sc1 lds
    s_add_u32 s50, s58, 1474560
    s_cmp_ge_u32 s50, s59
    s_cselect_b32 s48, 2359296, 0
    s_sub_u32 s50, s50, s48
    s_cmp_lg_u32 s35, 13
    s_cbranch_scc1 L_m_71
    buffer_load_dword v53, v52, s[44:47], s8 offen
    s_branch L_skip_12
L_stub_12:
    s_branch L_back_a1
L_skip_12:
    buffer_load_dword v53, v52, s[44:47], s9 offen
L_m_71:
    s_waitcnt vmcnt(12)
    s_barrier
    s_add_u32 m0, s68, 122880
    s_nop 0
    buffer_load_dwordx4 v8, s[36:39], s50 offen offset:0 sc1 lds
    buffer_load_dwordx4 v13, s[36:39], s50 offen offset:1024 sc1 lds
    buffer_load_dwordx4 v14, s[36:39], s50 offen offset:2048 sc1 lds
    s_add_u32 m0, s68, 125952
    s_nop 0
    buffer_load_dwordx4 v15, s[36:39], s50 offen offset:0 sc1 lds
    buffer_load_dwordx4 v16, s[36:39], s50 offen offset:1024 sc1 lds
    buffer_load_dwordx4 v17, s[36:39], s50 offen offset:2048 sc1 lds
    s_add_u32 s50, s58, 221184
    s_cmp_ge_u32 s50, s59
    s_cselect_b32 s48, 2359296, 0
    s_sub_u32 s50, s50, s48
    s_waitcnt vmcnt(12)
    s_barrier
    s_add_u32 m0, s68, 135168
    s_nop 0
    buffer_load_dwordx4 v8, s[36:39], s50 offen offset:0 sc1 lds
    buffer_load_dwordx4 v13, s[36:39], s50 offen offset:1024 sc1 lds
    buffer_load_dwordx4 v14, s[36:39], s50 offen offset:2048 sc1 lds
    s_add_u32 m0, s68, 138240
    s_nop 0
    buffer_load_dwordx4 v15, s[36:39], s50 offen offset:0 sc1 lds
    buffer_load_dwordx4 v16, s[36:39], s50 offen offset:1024 sc1 lds
    buffer_load_dwordx4 v17, s[36:39], s50 offen offset:2048 sc1 lds
    s_add_u32 s50, s58, 1548288
    s_cmp_ge_u32 s50, s59
    s_cselect_b32 s48, 2359296, 0
    s_sub_u32 s50, s50, s48
    s_waitcnt vmcnt(12)
    s_barrier
    s_add_u32 m0, s68, 147456
    s_nop 0
    buffer_load_dwordx4 v8, s[36:39], s50 offen offset:0 sc1 lds
    buffer_load_dwordx4 v13, s[36:39], s50 offen offset:1024 sc1 lds
    buffer_load_dwordx4 v14, s[36:39], s50 offen offset:2048 sc1 lds
    s_add_u32 m0, s68, 150528
    s_nop 0
    buffer_load_dwordx4 v15, s[36:39], s50 offen offset:0 sc1 lds
    buffer_load_dwordx4 v16, s[36:39], s50 offen offset:1024 sc1 lds
    buffer_load_dwordx4 v17, s[36:39], s50 offen offset:2048 sc1 lds
    s_add_u32 s50, s58, 1622016
    s_cmp_ge_u32 s50, s59
    s_cselect_b32 s48, 2359296, 0
    s_sub_u32 s50, s50, s48
    s_waitcnt vmcnt(12)
    s_barrier
    s_add_u32 m0, s68, 98304
    s_nop 0
    buffer_load_dwordx4 v8, s[36:39], s50 offen offset:0 sc1 lds
    buffer_load_dwordx4 v13, s[36:39], s50 offen offset:1024 sc1 lds
    buffer_load_dwordx4 v14, s[36:39], s50 offen offset:2048 sc1 lds
    s_add_u32 m0, s68, 101376
    s_nop 0
    buffer_load_dwordx4 v15, s[36:39], s50 offen offset:0 sc1 lds
    buffer_load_dwordx4 v16, s[36:39], s50 offen offset:1024 sc1 lds
    buffer_load_dwordx4 v17, s[36:39], s50 offen offset:2048 sc1 lds
    s_add_u32 s50, s58, 1695744
    s_cmp_ge_u32 s50, s59
    s_cselect_b32 s48, 2359296, 0
    s_sub_u32 s50, s50, s48
    s_waitcnt vmcnt(12)
    s_barrier
    s_add_u32 m0, s68, 110592
    s_nop 0
    buffer_load_dwordx4 v8, s[36:39], s50 offen offset:0 sc1 lds
    buffer_load_dwordx4 v13, s[36:39], s50 offen offset:1024 sc1 lds
    buffer_load_dwordx4 v14, s[36:39], s50 offen offset:2048 sc1 lds
    s_add_u32 m0, s68, 113664
    s_nop 0
    buffer_load_dwordx4 v15, s[36:39], s50 offen offset:0 sc1 lds
    buffer_load_dwordx4 v16, s[36:39], s50 offen offset:1024 sc1 lds
    buffer_load_dwordx4 v17, s[36:39], s50 offen offset:2048 sc1 lds
    s_add_u32 s50, s58, 294912
    s_cmp_ge_u32 s50, s59
    s_cselect_b32 s48, 2359296, 0
    s_sub_u32 s50, s50, s48
    s_waitcnt vmcnt(12)
    s_barrier
    s_add_u32 m0, s68, 122880
    s_nop 0
    buffer_load_dwordx4 v8, s[36:39], s50 offen offset:0 sc1 lds
    buffer_load_dwordx4 v13, s[36:39], s50 offen offset:1024 sc1 lds
    buffer_load_dwordx4 v14, s[36:39], s50 offen offset:2048 sc1 lds
    s_add_u32 m0, s68, 125952
    s_nop 0
    buffer_load_dwordx4 v15, s[36:39], s50 offen offset:0 sc1 lds
    buffer_load_dwordx4 v16, s[36:39], s50 offen offset:1024 sc1 lds
    buffer_load_dwordx4 v17, s[36:39], s50 offen offset:2048 sc1 lds
    s_add_u32 s50, s58, 1769472
    s_cmp_ge_u32 s50, s59
    s_cselect_b32 s48, 2359296, 0
    s_sub_u32 s50, s50, s48
    s_waitcnt vmcnt(12)
    s_barrier
    s_add_u32 m0, s68, 135168
    s_nop 0
    buffer_load_dwordx4 v8, s[36:39], s50 offen offset:0 sc1 lds
    buffer_load_dwordx4 v13, s[36:39], s50 offen offset:1024 sc1 lds
    buffer_load_dwordx4 v14, s[36:39], s50 offen offset:2048 sc1 lds
    s_add_u32 m0, s68, 138240
    s_nop 0
    buffer_load_dwordx4 v15, s[36:39], s50 offen offset:0 sc1 lds
    buffer_load_dwordx4 v16, s[36:39], s50 offen offset:1024 sc1 lds
    buffer_load_dwordx4 v17, s[36:39], s50 offen offset:2048 sc1 lds
    s_add_u32 s50, s58, 1843200
    s_cmp_ge_u32 s50, s59
    s_cselect_b32 s48, 2359296, 0
    s_sub_u32 s50, s50, s48
    s_waitcnt vmcnt(12)
    s_barrier
    s_add_u32 m0, s68, 147456
    s_nop 0
    buffer_load_dwordx4 v8, s[36:39], s50 offen offset:0 sc1 lds
    buffer_load_dwordx4 v13, s[36:39], s50 offen offset:1024 sc1 lds
    buffer_load_dwordx4 v14, s[36:39], s50 offen offset:2048 sc1 lds
    s_add_u32 m0, s68, 150528
    s_nop 0
    buffer_load_dwordx4 v15, s[36:39], s50 offen offset:0 sc1 lds
    buffer_load_dwordx4 v16, s[36:39], s50 offen offset:1024 sc1 lds
    buffer_load_dwordx4 v17, s[36:39], s50 offen offset:2048 sc1 lds
    s_add_u32 s50, s58, 1916928
    s_cmp_ge_u32 s50, s59
    s_cselect_b32 s48, 2359296, 0
    s_sub_u32 s50, s50, s48
    s_waitcnt vmcnt(12)
    s_barrier
    s_add_u32 m0, s68, 98304
    s_nop 0
    buffer_load_dwordx4 v8, s[36:39], s50 offen offset:0 sc1 lds
    buffer_load_dwordx4 v13, s[36:39], s50 offen offset:1024 sc1 lds
    buffer_load_dwordx4 v14, s[36:39], s50 offen offset:2048 sc1 lds
    s_add_u32 m0, s68, 101376
    s_nop 0
    buffer_load_dwordx4 v15, s[36:39], s50 offen offset:0 sc1 lds
    buffer_load_dwordx4 v16, s[36:39], s50 offen offset:1024 sc1 lds
    buffer_load_dwordx4 v17, s[36:39], s50 offen offset:2048 sc1 lds
    s_add_u32 s50, s58, 368640
    s_cmp_ge_u32 s50, s59
    s_cselect_b32 s48, 2359296, 0
    s_sub_u32 s50, s50, s48
    s_waitcnt vmcnt(12)
    s_barrier
    s_add_u32 m0, s68, 110592
    s_nop 0
    buffer_load_dwordx4 v8, s[36:39], s50 offen offset:0 sc1 lds
    buffer_load_dwordx4 v13, s[36:39], s50 offen offset:1024 sc1 lds
    buffer_load_dwordx4 v14, s[36:39], s50 offen offset:2048 sc1 lds
    s_add_u32 m0, s68, 113664
    s_nop 0
    buffer_load_dwordx4 v15, s[36:39], s50 offen offset:0 sc1 lds
    buffer_load_dwordx4 v16, s[36:39], s50 offen offset:1024 sc1 lds
    buffer_load_dwordx4 v17, s[36:39], s50 offen offset:2048 sc1 lds
    s_add_u32 s50, s58, 1990656
    s_cmp_ge_u32 s50, s59
    s_cselect_b32 s48, 2359296, 0
    s_sub_u32 s50, s50, s48
    s_waitcnt vmcnt(12)
    s_barrier
    s_add_u32 m0, s68, 122880
    s_nop 0
    buffer_load_dwordx4 v8, s[36:39], s50 offen offset:0 sc1 lds
    buffer_load_dwordx4 v13, s[36:39], s50 offen offset:1024 sc1 lds
    buffer_load_dwordx4 v14, s[36:39], s50 offen offset:2048 sc1 lds
    s_add_u32 m0, s68, 125952
    s_nop 0
    buffer_load_dwordx4 v15, s[36:39], s50 offen offset:0 sc1 lds
    buffer_load_dwordx4 v16, s[36:39], s50 offen offset:1024 sc1 lds
    buffer_load_dwordx4 v17, s[36:39], s50 offen offset:2048 sc1 lds
    s_add_u32 s50, s58, 2064384
    s_cmp_ge_u32 s50, s59
    s_cselect_b32 s48, 2359296, 0
    s_sub_u32 s50, s50, s48
    s_waitcnt vmcnt(12)
    s_barrier
    s_add_u32 m0, s68, 135168
    s_nop 0
    buffer_load_dwordx4 v8, s[36:39], s50 offen offset:0 sc1 lds
    buffer_load_dwordx4 v13, s[36:39], s50 offen offset:1024 sc1 lds
    buffer_load_dwordx4 v14, s[36:39], s50 offen offset:2048 sc1 lds
    s_add_u32 m0, s68, 138240
    s_nop 0
    buffer_load_dwordx4 v15, s[36:39], s50 offen offset:0 sc1 lds
    buffer_load_dwordx4 v16, s[36:39], s50 offen offset:1024 sc1 lds
    buffer_load_dwordx4 v17, s[36:39], s50 offen offset:2048 sc1 lds
    s_add_u32 s50, s58, 2138112
    s_cmp_ge_u32 s50, s59
    s_cselect_b32 s48, 2359296, 0
    s_sub_u32 s50, s50, s48
    s_waitcnt vmcnt(12)
    s_barrier
    s_add_u32 m0, s68, 147456
    s_nop 0
    buffer_load_dwordx4 v8, s[36:39], s50 offen offset:0 sc1 lds
    buffer_load_dwordx4 v13, s[36:39], s50 offen offset:1024 sc1 lds
    buffer_load_dwordx4 v14, s[36:39], s50 offen offset:2048 sc1 lds
    s_add_u32 m0, s68, 150528
    s_nop 0
    buffer_load_dwordx4 v15, s[36:39], s50 offen offset:0 sc1 lds
    buffer_load_dwordx4 v16, s[36:39], s50 offen offset:1024 sc1 lds
    buffer_load_dwordx4 v17, s[36:39], s50 offen offset:2048 sc1 lds
    s_add_u32 s50, s58, 2211840
    s_cmp_ge_u32 s50, s59
    s_cselect_b32 s48, 2359296, 0
    s_sub_u32 s50, s50, s48
    s_waitcnt vmcnt(12)
    s_barrier
    s_add_u32 m0, s68, 98304
    s_nop 0
    buffer_load_dwordx4 v8, s[36:39], s50 offen offset:0 sc1 lds
    buffer_load_dwordx4 v13, s[36:39], s50 offen offset:1024 sc1 lds
    buffer_load_dwordx4 v14, s[36:39], s50 offen offset:2048 sc1 lds
    s_add_u32 m0, s68, 101376
    s_nop 0
    buffer_load_dwordx4 v15, s[36:39], s50 offen offset:0 sc1 lds
    buffer_load_dwordx4 v16, s[36:39], s50 offen offset:1024 sc1 lds
    buffer_load_dwordx4 v17, s[36:39], s50 offen offset:2048 sc1 lds
    s_add_u32 s50, s58, 2285568
    s_cmp_ge_u32 s50, s59
    s_cselect_b32 s48, 2359296, 0
    s_sub_u32 s50, s50, s48
    s_waitcnt vmcnt(12)
    s_barrier
    s_add_u32 m0, s68, 110592
    s_nop 0
    buffer_load_dwordx4 v8, s[36:39], s50 offen offset:0 sc1 lds
    buffer_load_dwordx4 v13, s[36:39], s50 offen offset:1024 sc1 lds
    buffer_load_dwordx4 v14, s[36:39], s50 offen offset:2048 sc1 lds
    s_add_u32 m0, s68, 113664
    s_nop 0
    buffer_load_dwordx4 v15, s[36:39], s50 offen offset:0 sc1 lds
    buffer_load_dwordx4 v16, s[36:39], s50 offen offset:1024 sc1 lds
    buffer_load_dwordx4 v17, s[36:39], s50 offen offset:2048 sc1 lds
    buffer_load_dword v68, v67, s[36:39], 0 offen sc1
    s_waitcnt vmcnt(12)
    s_barrier
    s_waitcnt vmcnt(6)
    s_barrier
    s_waitcnt vmcnt(0)
    s_barrier
    s_branch L_m_55
L_m_54:
    s_waitcnt lgkmcnt(0)
    buffer_store_dwordx4 v[28:31], v22, s[36:39], s57 offen sc1
    buffer_store_dwordx4 v[32:35], v23, s[36:39], s57 offen sc1
    buffer_store_dwordx4 v[36:39], v24, s[36:39], s57 offen sc1
    buffer_store_dwordx4 v[40:43], v25, s[36:39], s57 offen sc1
    buffer_store_dwordx4 v[44:47], v26, s[36:39], s57 offen sc1
    s_waitcnt vmcnt(0)
    s_barrier
    buffer_store_dword v3, v10, s[36:39], 0 offen sc1
    buffer_store_dwordx4 v[48:51], v54, s[36:39], 0 offen sc1
    v_add_u32 v76, 0, v0
    v_mul_u32_u24 v77, 1821, v76
    v_lshrrev_b32 v77, 18, v77
    v_mul_u32_u24 v77, 6912, v77
    v_lshl_add_u32 v77, v76, 4, v77
    v_subrev_u32 v56, 0, v77
    v_add_u32 v76, 64, v0
    v_mul_u32_u24 v77, 1821, v76
    v_lshrrev_b32 v77, 18, v77
    v_mul_u32_u24 v77, 6912, v77
    v_lshl_add_u32 v77, v76, 4, v77
    v_subrev_u32 v57, 1024, v77
    v_add_u32 v76, 128, v0
    v_mul_u32_u24 v77, 1821, v76
    v_lshrrev_b32 v77, 18, v77
    v_mul_u32_u24 v77, 6912, v77
    v_lshl_add_u32 v77, v76, 4, v77
    v_subrev_u32 v58, 2048, v77
    v_add_u32 v76, 192, v0
    v_mul_u32_u24 v77, 1821, v76
    v_lshrrev_b32 v77, 18, v77
    v_mul_u32_u24 v77, 6912, v77
    v_lshl_add_u32 v77, v76, 4, v77
    v_subrev_u32 v59, 3072, v77
    v_add_u32 v76, 256, v0
    v_mul_u32_u24 v77, 1821, v76
    v_lshrrev_b32 v77, 18, v77
    v_mul_u32_u24 v77, 6912, v77
    v_lshl_add_u32 v77, v76, 4, v77
    v_subrev_u32 v60, 0, v77
    v_add_u32 v76, 320, v0
    v_mul_u32_u24 v77, 1821, v76
    v_lshrrev_b32 v77, 18, v77
    v_mul_u32_u24 v77, 6912, v77
    v_lshl_add_u32 v77, v76, 4, v77
    v_subrev_u32 v61, 1024, v77
    v_add_u32 v76, 384, v0
    v_mul_u32_u24 v77, 1821, v76
    v_lshrrev_b32 v77, 18, v77
    v_mul_u32_u24 v77, 6912, v77
    v_lshl_add_u32 v77, v76, 4, v77
    v_subrev_u32 v62, 2048, v77
    v_add_u32 v76, 448, v0
    v_mul_u32_u24 v77, 1821, v76
    v_lshrrev_b32 v77, 18, v77
    v_mul_u32_u24 v77, 6912, v77
    v_lshl_add_u32 v77, v76, 4, v77
    v_subrev_u32 v63, 3072, v77
    v_add_u32 v76, 512, v0
    v_mul_u32_u24 v77, 1821, v76
    v_lshrrev_b32 v77, 18, v77
    v_mul_u32_u24 v77, 6912, v77
    v_lshl_add_u32 v77, v76, 4, v77
    v_subrev_u32 v64, 0, v77
    s_mul_i32 s48, s55, 3
    s_add_u32 s49, s48, 2
    s_lshr_b32 s48, s48, 1
    s_lshr_b32 s49, s49, 1
    v_mov_b32 v76, s48
    v_mov_b32 v77, s49
    v_cmp_gt_u32 vcc, 32, v0
    s_nop 1
    v_cndmask_b32 v76, v77, v76, vcc
    v_and_b32 v77, 31, v0
    v_min_u32 v77, 8, v77
    v_lshl_add_u32 v76, v76, 6, v77
    s_mul_i32 s48, s53, 9
    v_add_u32 v76, s48, v76
    v_lshlrev_b32 v66, 4, v76
    s_lshr_b32 s48, s54, 3
    s_lshl_b32 s48, s48, 2
    s_and_b32 s49, s54, 1
    s_lshl_b32 s49, s49, 1
    s_add_u32 s48, s48, s49
    s_add_u32 s48, s48, s62
    s_lshl_b32 s48, s48, 13
    s_add_u32 s48, s48, 15990784
    v_lshl_add_u32 v67, v0, 7, s48
    v_mov_b32 v68, 0
    s_lshl_b32 s48, s54, 7
    s_lshr_b32 s49, s53, 1
    s_lshl_b32 s49, s49, 4
    s_add_u32 s48, s48, s49
    s_mul_i32 s48, s48, 1152
    s_mul_i32 s49, s55, 288
    s_add_u32 s48, s48, s49
    s_and_b32 s49, s53, 1
    s_mul_i32 s49, s49, 144
    s_add_u32 s48, s48, s49
    s_add_u32 s12, s48, 12582912
    s_lshl_b32 s13, s62, 6
    v_add_u32 v76, s13, v0
    v_mul_u32_u24 v77, 911, v76
    v_lshrrev_b32 v77, 13, v77
    v_mul_u32_u24 v78, 9, v77
    v_sub_u32 v78, v76, v78
    v_and_b32 v76, 48, v77
    v_add_u32 v77, v77, v76
    v_mul_u32_u24 v77, 1152, v77
    v_lshl_add_u32 v77, v78, 4, v77
    v_add_u32 v70, s12, v77
    s_add_u32 s13, s13, 128
    v_add_u32 v76, s13, v0
    v_mul_u32_u24 v77, 911, v76
    v_lshrrev_b32 v77, 13, v77
    v_mul_u32_u24 v78, 9, v77
    v_sub_u32 v78, v76, v78
    v_and_b32 v76, 48, v77
    v_add_u32 v77, v77, v76
    v_mul_u32_u24 v77, 1152, v77
    v_lshl_add_u32 v77, v78, 4, v77
    v_add_u32 v71, s12, v77
    s_add_u32 s13, s13, 128
    v_add_u32 v76, s13, v0
    v_mul_u32_u24 v77, 911, v76
    v_lshrrev_b32 v77, 13, v77
    v_mul_u32_u24 v78, 9, v77
    v_sub_u32 v78, v76, v78
    v_and_b32 v76, 48, v77
    v_add_u32 v77, v77, v76
    v_mul_u32_u24 v77, 1152, v77
    v_lshl_add_u32 v77, v78, 4, v77
    v_add_u32 v72, s12, v77
    s_add_u32 s13, s13, 128
    v_add_u32 v76, s13, v0
    v_mul_u32_u24 v77, 911, v76
    v_lshrrev_b32 v77, 13, v77
    v_mul_u32_u24 v78, 9, v77
    v_sub_u32 v78, v76, v78
    v_and_b32 v76, 48, v77
    v_add_u32 v77, v77, v76
    v_mul_u32_u24 v77, 1152, v77
    v_lshl_add_u32 v77, v78, 4, v77
    v_add_u32 v73, s12, v77
    s_add_u32 s13, s13, 128
    v_add_u32 v76, s13, v0
    v_mul_u32_u24 v77, 911, v76
    v_lshrrev_b32 v77, 13, v77
    v_mul_u32_u24 v78, 9, v77
    v_sub_u32 v78, v76, v78
    v_and_b32 v76, 48, v77
    v_add_u32 v77, v77, v76
    v_mul_u32_u24 v77, 1152, v77
    v_lshl_add_u32 v77, v78, 4, v77
    v_add_u32 v74, s12, v77
    s_add_u32 s13, s13, 128
    s_mul_i32 s48, s55, 576
    s_and_b32 s49, s53, 1
    s_mul_i32 s49, s49, 288
    s_add_u32 s48, s48, s49
    s_add_u32 s48, s48, 11520
    v_min_u32 v76, 272, v8
    v_add_u32 v76, s48, v76
    s_cmp_eq_u32 s62, 1
    s_cselect_b64 vcc, -1, 0
    v_cndmask_b32 v74, v74, v76, vcc
    s_waitcnt vmcnt(0)
Lp_m_72:
    buffer_load_dword v4, v27, s[36:39], s65 offen sc1
    buffer_load_dword v5, v27, s[36:39], s69 offen sc1
    s_waitcnt vmcnt(0)
    v_cmp_ne_u32 vcc, v3, v4
    v_cmp_ne_u32 s[48:49], v3, v5
    s_nop 0
    s_or_b64 vcc, vcc, s[48:49]
    s_cbranch_vccz Le_m_73
    s_sub_u32 s7, s7, 1
    s_cbranch_scc1 Le_m_73
    s_mov_b64 exec, vcc
    s_sleep 1
    s_branch Lp_m_72
Le_m_73:
    s_mov_b64 exec, -1
    s_max_i32 s7, s7, 0
L_m_55:
    s_mul_i32 s67, s55, 2304
    s_mul_i32 s48, s53, 1327104
    s_add_u32 s67, s67, s48
    s_mul_i32 s48, s62, 36864
    s_add_u32 s67, s67, s48
    s_add_u32 s67, s67, 20971520
    s_mul_i32 s57, s62, 9216
    s_add_u32 s48, s57, 90112
    v_add_u32 v85, s48, v8
    v_add_u32 v90, 73728, v85
    s_mul_i32 s58, s64, 73728
    s_add_u32 s58, s58, s67
    s_add_u32 s59, s67, 1327104
    s_waitcnt vmcnt(0)
    v_cmp_ne_u32 vcc, v3, v68
    s_nop 0
    s_cbranch_vccz L_m_74
Lp_m_75:
    buffer_load_dword v68, v67, s[36:39], 0 offen sc1
    s_waitcnt vmcnt(0)
    v_cmp_ne_u32 vcc, v3, v68
    s_nop 0
    s_cbranch_vccz Le_m_76
    s_sub_u32 s7, s7, 1
    s_cbranch_scc1 Le_m_76
    s_mov_b64 exec, vcc
    s_sleep 1
    s_branch Lp_m_75
Le_m_76:
    s_mov_b64 exec, -1
    s_max_i32 s7, s7, 0
L_m_74:
    v_lshrrev_b32 v52, 4, v0
    v_and_b32 v53, 15, v0
    v_lshlrev_b32 v52, 12, v52
    v_lshl_add_u32 v52, v53, 7, v52
    s_lshr_b32 s48, s4, 1
    s_mul_i32 s48, s48, 4718592
    s_and_b32 s49, s4, 1
    s_lshl_b32 s49, s49, 11
    s_add_u32 s48, s48, s49
    v_add_u32 v52, s48, v52
    s_mov_b32 s35, 0
    s_mov_b32 s49, s35
    s_mul_i32 s48, s62, 1
    s_add_u32 s49, s49, s48
    s_bfm_b32 s48, s5, 0
    s_and_b32 s48, s48, 0
    s_bcnt1_i32_b32 s48, s48
    s_sub_u32 s12, s5, s48
    s_mul_i32 s35, s12, 4
    s_add_u32 s35, s35, 160
    s_add_u32 s35, s35, s49
    s_min_u32 s35, s35, 287
    s_lshl_b32 s8, s35, 14
    s_mul_i32 s35, s12, 4
    s_add_u32 s35, s35, 162
    s_add_u32 s35, s35, s49
    s_min_u32 s35, s35, 287
    s_lshl_b32 s9, s35, 14
    s_mul_i32 s35, s12, 64
    s_lshr_b32 s35, s35, 8
    s_add_u32 s35, s35, 0
    s_mov_b32 s48, 0
    s_bitcmp1_b32 s48, s5
    s_cselect_b32 s35, 999, s35
    s_barrier
    s_branch L_stub_13
L_back_a2:
    s_barrier
    s_barrier
    s_barrier
    s_cmp_ge_u32 s5, 27
    s_cbranch_scc1 L_m_77
    buffer_store_dword v3, v11, s[36:39], 0 offen sc1
    s_branch L_m_78
L_m_77:
    s_lshl_b32 s50, s2, 7
    s_add_u32 s50, s50, 622592
    v_mov_b32 v28, 0
Lp_m_79:
    buffer_load_dword v29, v28, s[36:39], s50 offen sc1
    s_waitcnt vmcnt(0)
    v_cmp_ne_u32 vcc, v3, v29
    s_nop 0
    s_cbranch_vccz Le_m_80
    s_sub_u32 s7, s7, 1
    s_cbranch_scc1 Le_m_80
    s_sleep 4
    s_branch Lp_m_79
Le_m_80:
    s_max_i32 s7, s7, 0
L_m_78:
    s_add_u32 s50, s58, 442368
    s_cmp_ge_u32 s50, s59
    s_cselect_b32 s48, 1327104, 0
    s_sub_u32 s50, s50, s48
    s_add_u32 m0, s57, 90112
    s_nop 0
    buffer_load_dwordx4 v56, s[36:39], s50 offen offset:0 sc1 lds
    buffer_load_dwordx4 v57, s[36:39], s50 offen offset:1024 sc1 lds
    buffer_load_dwordx4 v58, s[36:39], s50 offen offset:2048 sc1 lds
    buffer_load_dwordx4 v59, s[36:39], s50 offen offset:3072 sc1 lds
    s_add_u32 m0, s57, 94208
    s_nop 0
    buffer_load_dwordx4 v60, s[36:39], s50 offen offset:0 sc1 lds
    buffer_load_dwordx4 v61, s[36:39], s50 offen offset:1024 sc1 lds
    buffer_load_dwordx4 v62, s[36:39], s50 offen offset:2048 sc1 lds
    buffer_load_dwordx4 v63, s[36:39], s50 offen offset:3072 sc1 lds
    s_add_u32 m0, s57, 98304
    s_nop 0
    buffer_load_dwordx4 v64, s[36:39], s50 offen offset:0 sc1 lds
    s_add_u32 s50, s58, 516096
    s_cmp_ge_u32 s50, s59
    s_cselect_b32 s48, 1327104, 0
    s_sub_u32 s50, s50, s48
    s_add_u32 m0, s57, 108544
    s_nop 0
    buffer_load_dwordx4 v56, s[36:39], s50 offen offset:0 sc1 lds
    buffer_load_dwordx4 v57, s[36:39], s50 offen offset:1024 sc1 lds
    buffer_load_dwordx4 v58, s[36:39], s50 offen offset:2048 sc1 lds
    buffer_load_dwordx4 v59, s[36:39], s50 offen offset:3072 sc1 lds
    s_add_u32 m0, s57, 112640
    s_nop 0
    buffer_load_dwordx4 v60, s[36:39], s50 offen offset:0 sc1 lds
    buffer_load_dwordx4 v61, s[36:39], s50 offen offset:1024 sc1 lds
    buffer_load_dwordx4 v62, s[36:39], s50 offen offset:2048 sc1 lds
    buffer_load_dwordx4 v63, s[36:39], s50 offen offset:3072 sc1 lds
    s_add_u32 m0, s57, 116736
    s_nop 0
    buffer_load_dwordx4 v64, s[36:39], s50 offen offset:0 sc1 lds
    s_add_u32 s50, s58, 589824
    s_cmp_ge_u32 s50, s59
    s_cselect_b32 s48, 1327104, 0
    s_sub_u32 s50, s50, s48
    s_add_u32 m0, s57, 126976
    s_nop 0
    buffer_load_dwordx4 v56, s[36:39], s50 offen offset:0 sc1 lds
    buffer_load_dwordx4 v57, s[36:39], s50 offen offset:1024 sc1 lds
    buffer_load_dwordx4 v58, s[36:39], s50 offen offset:2048 sc1 lds
    buffer_load_dwordx4 v59, s[36:39], s50 offen offset:3072 sc1 lds
    s_add_u32 m0, s57, 131072
    s_nop 0
    buffer_load_dwordx4 v60, s[36:39], s50 offen offset:0 sc1 lds
    buffer_load_dwordx4 v61, s[36:39], s50 offen offset:1024 sc1 lds
    buffer_load_dwordx4 v62, s[36:39], s50 offen offset:2048 sc1 lds
    buffer_load_dwordx4 v63, s[36:39], s50 offen offset:3072 sc1 lds
    s_add_u32 m0, s57, 135168
    s_nop 0
    buffer_load_dwordx4 v64, s[36:39], s50 offen offset:0 sc1 lds
    s_add_u32 s50, s58, 663552
    s_cmp_ge_u32 s50, s59
    s_cselect_b32 s48, 1327104, 0
    s_sub_u32 s50, s50, s48
    s_waitcnt vmcnt(18)
L_m_81:
    ds_read_b32 v76, v85 offset:0
    ds_read_b32 v77, v85 offset:1024
    ds_read_b32 v78, v85 offset:2048
    ds_read_b32 v79, v85 offset:3072
    ds_read_b32 v80, v85 offset:4096
    ds_read_b32 v81, v85 offset:5120
    ds_read_b32 v82, v85 offset:6144
    ds_read_b32 v83, v85 offset:7168
    ds_read_b32 v84, v85 offset:8192
    s_waitcnt lgkmcnt(6)
    v_max3_u32 v76, v76, v77, v78
    s_waitcnt lgkmcnt(4)
    v_max3_u32 v76, v76, v79, v80
    s_waitcnt lgkmcnt(2)
    v_max3_u32 v76, v76, v81, v82
    s_waitcnt lgkmcnt(0)
    v_max3_u32 v76, v76, v83, v84
    v_cmp_eq_u32 vcc, -1, v76
    s_nop 0
    s_cbranch_vccz L_m_82
    s_sub_u32 s7, s7, 1
    s_cbranch_scc1 L_m_82
    s_mov_b32 s14, m0
    s_sleep 2
    s_add_u32 s15, s58, 442368
    s_cmp_ge_u32 s15, s59
    s_cselect_b32 s48, 1327104, 0
    s_sub_u32 s15, s15, s48
    s_add_u32 m0, s57, 90112
    s_nop 0
    buffer_load_dwordx4 v56, s[36:39], s15 offen offset:0 sc1 lds
    buffer_load_dwordx4 v57, s[36:39], s15 offen offset:1024 sc1 lds
    buffer_load_dwordx4 v58, s[36:39], s15 offen offset:2048 sc1 lds
    buffer_load_dwordx4 v59, s[36:39], s15 offen offset:3072 sc1 lds
    s_add_u32 m0, s57, 94208
    s_nop 0
    buffer_load_dwordx4 v60, s[36:39], s15 offen offset:0 sc1 lds
    buffer_load_dwordx4 v61, s[36:39], s15 offen offset:1024 sc1 lds
    buffer_load_dwordx4 v62, s[36:39], s15 offen offset:2048 sc1 lds
    buffer_load_dwordx4 v63, s[36:39], s15 offen offset:3072 sc1 lds
    s_add_u32 m0, s57, 98304
    s_nop 0
    buffer_load_dwordx4 v64, s[36:39], s15 offen offset:0 sc1 lds
    s_mov_b32 m0, s14
    s_waitcnt vmcnt(0)
    s_branch L_m_81
L_m_82:
    s_max_i32 s7, s7, 0
    s_barrier
    s_add_u32 m0, s57, 145408
    s_nop 0
    buffer_load_dwordx4 v56, s[36:39], s50 offen offset:0 sc1 lds
    buffer_load_dwordx4 v57, s[36:39], s50 offen offset:1024 sc1 lds
    buffer_load_dwordx4 v58, s[36:39], s50 offen offset:2048 sc1 lds
    buffer_load_dwordx4 v59, s[36:39], s50 offen offset:3072 sc1 lds
    s_add_u32 m0, s57, 149504
    s_nop 0
    buffer_load_dwordx4 v60, s[36:39], s50 offen offset:0 sc1 lds
    buffer_load_dwordx4 v61, s[36:39], s50 offen offset:1024 sc1 lds
    buffer_load_dwordx4 v62, s[36:39], s50 offen offset:2048 sc1 lds
    buffer_load_dwordx4 v63, s[36:39], s50 offen offset:3072 sc1 lds
    s_add_u32 m0, s57, 153600
    s_nop 0
    buffer_load_dwordx4 v64, s[36:39], s50 offen offset:0 sc1 lds
    s_add_u32 s50, s58, 0
    s_cmp_ge_u32 s50, s59
    s_cselect_b32 s48, 1327104, 0
    s_sub_u32 s50, s50, s48
    s_cmp_lg_u32 s35, 0
    s_cbranch_scc1 L_m_83
    buffer_load_dword v53, v52, s[44:47], s8 offen
    buffer_load_dword v53, v52, s[44:47], s9 offen
L_m_83:
    s_waitcnt vmcnt(18)
L_m_84:
    ds_read_b32 v76, v85 offset:18432
    ds_read_b32 v77, v85 offset:19456
    ds_read_b32 v78, v85 offset:20480
    ds_read_b32 v79, v85 offset:21504
    ds_read_b32 v80, v85 offset:22528
    ds_read_b32 v81, v85 offset:23552
    ds_read_b32 v82, v85 offset:24576
    ds_read_b32 v83, v85 offset:25600
    ds_read_b32 v84, v85 offset:26624
    s_waitcnt lgkmcnt(6)
    v_max3_u32 v76, v76, v77, v78
    s_waitcnt lgkmcnt(4)
    v_max3_u32 v76, v76, v79, v80
    s_waitcnt lgkmcnt(2)
    v_max3_u32 v76, v76, v81, v82
    s_waitcnt lgkmcnt(0)
    v_max3_u32 v76, v76, v83, v84
    v_cmp_eq_u32 vcc, -1, v76
    s_nop 0
    s_cbranch_vccz L_m_85
    s_sub_u32 s7, s7, 1
    s_cbranch_scc1 L_m_85
    s_mov_b32 s14, m0
    s_sleep 2
    s_add_u32 s15, s58, 516096
    s_branch L_skip_13
L_stub_13:
    s_branch L_back_a2
L_skip_13:
    s_cmp_ge_u32 s15, s59
    s_cselect_b32 s48, 1327104, 0
    s_sub_u32 s15, s15, s48
    s_add_u32 m0, s57, 108544
    s_nop 0
    buffer_load_dwordx4 v56, s[36:39], s15 offen offset:0 sc1 lds
    buffer_load_dwordx4 v57, s[36:39], s15 offen offset:1024 sc1 lds
    buffer_load_dwordx4 v58, s[36:39], s15 offen offset:2048 sc1 lds
    buffer_load_dwordx4 v59, s[36:39], s15 offen offset:3072 sc1 lds
    s_add_u32 m0, s57, 112640
    s_nop 0
    buffer_load_dwordx4 v60, s[36:39], s15 offen offset:0 sc1 lds
    buffer_load_dwordx4 v61, s[36:39], s15 offen offset:1024 sc1 lds
    buffer_load_dwordx4 v62, s[36:39], s15 offen offset:2048 sc1 lds
    buffer_load_dwordx4 v63, s[36:39], s15 offen offset:3072 sc1 lds
    s_add_u32 m0, s57, 116736
    s_nop 0
    buffer_load_dwordx4 v64, s[36:39], s15 offen offset:0 sc1 lds
    s_mov_b32 m0, s14
    s_waitcnt vmcnt(0)
    s_branch L_m_84
L_m_85:
    s_max_i32 s7, s7, 0
    s_barrier
    buffer_load_dword v28, v66, s[36:39], s66 offen sc1
    s_cmp_lg_u32 s35, 1
    s_cbranch_scc1 L_m_86
    buffer_load_dword v53, v52, s[44:47], s8 offen
    buffer_load_dword v53, v52, s[44:47], s9 offen
L_m_86:
    s_waitcnt vmcnt(10)
L_m_87:
    ds_read_b32 v76, v85 offset:36864
    ds_read_b32 v77, v85 offset:37888
    ds_read_b32 v78, v85 offset:38912
    ds_read_b32 v79, v85 offset:39936
    ds_read_b32 v80, v85 offset:40960
    ds_read_b32 v81, v85 offset:41984
    ds_read_b32 v82, v85 offset:43008
    ds_read_b32 v83, v85 offset:44032
    ds_read_b32 v84, v85 offset:45056
    s_waitcnt lgkmcnt(6)
    v_max3_u32 v76, v76, v77, v78
    s_waitcnt lgkmcnt(4)
    v_max3_u32 v76, v76, v79, v80
    s_waitcnt lgkmcnt(2)
    v_max3_u32 v76, v76, v81, v82
    s_waitcnt lgkmcnt(0)
    v_max3_u32 v76, v76, v83, v84
    v_cmp_eq_u32 vcc, -1, v76
    s_nop 0
    s_cbranch_vccz L_m_88
    s_sub_u32 s7, s7, 1
    s_cbranch_scc1 L_m_88
    s_mov_b32 s14, m0
    s_sleep 2
    s_add_u32 s15, s58, 589824
    s_cmp_ge_u32 s15, s59
    s_cselect_b32 s48, 1327104, 0
    s_sub_u32 s15, s15, s48
    s_add_u32 m0, s57, 126976
    s_nop 0
    buffer_load_dwordx4 v56, s[36:39], s15 offen offset:0 sc1 lds
    buffer_load_dwordx4 v57, s[36:39], s15 offen offset:1024 sc1 lds
    buffer_load_dwordx4 v58, s[36:39], s15 offen offset:2048 sc1 lds
    buffer_load_dwordx4 v59, s[36:39], s15 offen offset:3072 sc1 lds
    s_add_u32 m0, s57, 131072
    s_nop 0
    buffer_load_dwordx4 v60, s[36:39], s15 offen offset:0 sc1 lds
    buffer_load_dwordx4 v61, s[36:39], s15 offen offset:1024 sc1 lds
    buffer_load_dwordx4 v62, s[36:39], s15 offen offset:2048 sc1 lds
    buffer_load_dwordx4 v63, s[36:39], s15 offen offset:3072 sc1 lds
    s_add_u32 m0, s57, 135168
    s_nop 0
    buffer_load_dwordx4 v64, s[36:39], s15 offen offset:0 sc1 lds
    s_mov_b32 m0, s14
    s_waitcnt vmcnt(0)
    s_branch L_m_87
L_m_88:
    s_max_i32 s7, s7, 0
    s_barrier
    s_waitcnt vmcnt(0)
    v_cmp_ne_u32 vcc, v3, v28
    s_nop 0
    s_cbranch_vccz L_m_89
Lp_m_90:
    buffer_load_dword v28, v66, s[36:39], s66 offen sc1
    s_waitcnt vmcnt(0)
    v_cmp_ne_u32 vcc, v3, v28
    s_nop 0
    s_cbranch_vccz Le_m_91
    s_sub_u32 s7, s7, 1
    s_cbranch_scc1 Le_m_91
    s_mov_b64 exec, vcc
    s_sleep 1
    s_branch Lp_m_90
Le_m_91:
    s_mov_b64 exec, -1
    s_max_i32 s7, s7, 0
L_m_89:
    s_add_u32 m0, s57, 90112
    s_nop 0
    buffer_load_dwordx4 v56, s[36:39], s50 offen offset:0 sc1 lds
    buffer_load_dwordx4 v57, s[36:39], s50 offen offset:1024 sc1 lds
    buffer_load_dwordx4 v58, s[36:39], s50 offen offset:2048 sc1 lds
    buffer_load_dwordx4 v59, s[36:39], s50 offen offset:3072 sc1 lds
    s_add_u32 m0, s57, 94208
    s_nop 0
    buffer_load_dwordx4 v60, s[36:39], s50 offen offset:0 sc1 lds
    buffer_load_dwordx4 v61, s[36:39], s50 offen offset:1024 sc1 lds
    buffer_load_dwordx4 v62, s[36:39], s50 offen offset:2048 sc1 lds
    buffer_load_dwordx4 v63, s[36:39], s50 offen offset:3072 sc1 lds
    s_add_u32 m0, s57, 98304
    s_nop 0
    buffer_load_dwordx4 v64, s[36:39], s50 offen offset:0 sc1 lds
    s_add_u32 s50, s58, 737280
    s_cmp_ge_u32 s50, s59
    s_cselect_b32 s48, 1327104, 0
    s_sub_u32 s50, s50, s48
    s_cmp_lg_u32 s35, 2
    s_cbranch_scc1 L_m_92
    buffer_load_dword v53, v52, s[44:47], s8 offen
    buffer_load_dword v53, v52, s[44:47], s9 offen
L_m_92:
    s_waitcnt vmcnt(10)
L_m_93:
    ds_read_b32 v76, v85 offset:55296
    ds_read_b32 v77, v85 offset:56320
    ds_read_b32 v78, v85 offset:57344
    ds_read_b32 v79, v85 offset:58368
    ds_read_b32 v80, v85 offset:59392
    ds_read_b32 v81, v85 offset:60416
    ds_read_b32 v82, v85 offset:61440
    ds_read_b32 v83, v85 offset:62464
    ds_read_b32 v84, v85 offset:63488
    s_waitcnt lgkmcnt(6)
    v_max3_u32 v76, v76, v77, v78
    s_waitcnt lgkmcnt(4)
    v_max3_u32 v76, v76, v79, v80
    s_waitcnt lgkmcnt(2)
    v_max3_u32 v76, v76, v81, v82
    s_waitcnt lgkmcnt(0)
    v_max3_u32 v76, v76, v83, v84
    v_cmp_eq_u32 vcc, -1, v76
    s_nop 0
    s_cbranch_vccz L_m_94
    s_sub_u32 s7, s7, 1
    s_cbranch_scc1 L_m_94
    s_mov_b32 s14, m0
    s_sleep 2
    s_add_u32 s15, s58, 663552
    s_cmp_ge_u32 s15, s59
    s_cselect_b32 s48, 1327104, 0
    s_sub_u32 s15, s15, s48
    s_add_u32 m0, s57, 145408
    s_nop 0
    buffer_load_dwordx4 v56, s[36:39], s15 offen offset:0 sc1 lds
    buffer_load_dwordx4 v57, s[36:39], s15 offen offset:1024 sc1 lds
    buffer_load_dwordx4 v58, s[36:39], s15 offen offset:2048 sc1 lds
    buffer_load_dwordx4 v59, s[36:39], s15 offen offset:3072 sc1 lds
    s_add_u32 m0, s57, 149504
    s_nop 0
    buffer_load_dwordx4 v60, s[36:39], s15 offen offset:0 sc1 lds
    buffer_load_dwordx4 v61, s[36:39], s15 offen offset:1024 sc1 lds
    buffer_load_dwordx4 v62, s[36:39], s15 offen offset:2048 sc1 lds
    buffer_load_dwordx4 v63, s[36:39], s15 offen offset:3072 sc1 lds
    s_add_u32 m0, s57, 153600
    s_nop 0
    buffer_load_dwordx4 v64, s[36:39], s15 offen offset:0 sc1 lds
    s_mov_b32 m0, s14
    s_waitcnt vmcnt(0)
    s_branch L_m_93
L_m_94:
    s_max_i32 s7, s7, 0
    s_barrier
    s_add_u32 m0, s57, 108544
    s_nop 0
    buffer_load_dwordx4 v56, s[36:39], s50 offen offset:0 sc1 lds
    buffer_load_dwordx4 v57, s[36:39], s50 offen offset:1024 sc1 lds
    buffer_load_dwordx4 v58, s[36:39], s50 offen offset:2048 sc1 lds
    buffer_load_dwordx4 v59, s[36:39], s50 offen offset:3072 sc1 lds
    s_add_u32 m0, s57, 112640
    s_nop 0
    buffer_load_dwordx4 v60, s[36:39], s50 offen offset:0 sc1 lds
    buffer_load_dwordx4 v61, s[36:39], s50 offen offset:1024 sc1 lds
    buffer_load_dwordx4 v62, s[36:39], s50 offen offset:2048 sc1 lds
    buffer_load_dwordx4 v63, s[36:39], s50 offen offset:3072 sc1 lds
    s_add_u32 m0, s57, 116736
    s_nop 0
    buffer_load_dwordx4 v64, s[36:39], s50 offen offset:0 sc1 lds
    s_add_u32 s50, s58, 73728
    s_cmp_ge_u32 s50, s59
    s_cselect_b32 s48, 1327104, 0
    s_sub_u32 s50, s50, s48
    s_cmp_lg_u32 s35, 3
    s_cbranch_scc1 L_m_95
    buffer_load_dword v53, v52, s[44:47], s8 offen
    buffer_load_dword v53, v52, s[44:47], s9 offen
L_m_95:
    s_waitcnt vmcnt(9)
    s_barrier
    s_add_u32 m0, s57, 126976
    s_nop 0
    buffer_load_dwordx4 v56, s[36:39], s50 offen offset:0 sc1 lds
    buffer_load_dwordx4 v57, s[36:39], s50 offen offset:1024 sc1 lds
    buffer_load_dwordx4 v58, s[36:39], s50 offen offset:2048 sc1 lds
    buffer_load_dwordx4 v59, s[36:39], s50 offen offset:3072 sc1 lds
    s_add_u32 m0, s57, 131072
    s_nop 0
    buffer_load_dwordx4 v60, s[36:39], s50 offen offset:0 sc1 lds
    buffer_load_dwordx4 v61, s[36:39], s50 offen offset:1024 sc1 lds
    buffer_load_dwordx4 v62, s[36:39], s50 offen offset:2048 sc1 lds
    buffer_load_dwordx4 v63, s[36:39], s50 offen offset:3072 sc1 lds
    s_add_u32 m0, s57, 135168
    s_nop 0
    buffer_load_dwordx4 v64, s[36:39], s50 offen offset:0 sc1 lds
    s_add_u32 s50, s58, 811008
    s_cmp_ge_u32 s50, s59
    s_cselect_b32 s48, 1327104, 0
    s_sub_u32 s50, s50, s48
    s_cmp_lg_u32 s35, 4
    s_cbranch_scc1 L_m_96
    buffer_load_dword v53, v52, s[44:47], s8 offen
    buffer_load_dword v53, v52, s[44:47], s9 offen
L_m_96:
    s_waitcnt vmcnt(9)
    s_barrier
    s_add_u32 m0, s57, 145408
    s_nop 0
    buffer_load_dwordx4 v56, s[36:39], s50 offen offset:0 sc1 lds
    buffer_load_dwordx4 v57, s[36:39], s50 offen offset:1024 sc1 lds
    buffer_load_dwordx4 v58, s[36:39], s50 offen offset:2048 sc1 lds
    buffer_load_dwordx4 v59, s[36:39], s50 offen offset:3072 sc1 lds
    s_add_u32 m0, s57, 149504
    s_nop 0
    buffer_load_dwordx4 v60, s[36:39], s50 offen offset:0 sc1 lds
    buffer_load_dwordx4 v61, s[36:39], s50 offen offset:1024 sc1 lds
    buffer_load_dwordx4 v62, s[36:39], s50 offen offset:2048 sc1 lds
    buffer_load_dwordx4 v63, s[36:39], s50 offen offset:3072 sc1 lds
    s_add_u32 m0, s57, 153600
    s_nop 0
    buffer_load_dwordx4 v64, s[36:39], s50 offen offset:0 sc1 lds
    s_add_u32 s50, s58, 147456
    s_cmp_ge_u32 s50, s59
    s_cselect_b32 s48, 1327104, 0
    s_sub_u32 s50, s50, s48
    s_cmp_lg_u32 s35, 5
    s_cbranch_scc1 L_m_97
    buffer_load_dword v53, v52, s[44:47], s8 offen
    buffer_load_dword v53, v52, s[44:47], s9 offen
L_m_97:
    s_waitcnt vmcnt(9)
    s_barrier
    s_add_u32 m0, s57, 90112
    s_nop 0
    buffer_load_dwordx4 v56, s[36:39], s50 offen offset:0 sc1 lds
    buffer_load_dwordx4 v57, s[36:39], s50 offen offset:1024 sc1 lds
    buffer_load_dwordx4 v58, s[36:39], s50 offen offset:2048 sc1 lds
    buffer_load_dwordx4 v59, s[36:39], s50 offen offset:3072 sc1 lds
    s_add_u32 m0, s57, 94208
    s_nop 0
    buffer_load_dwordx4 v60, s[36:39], s50 offen offset:0 sc1 lds
    buffer_load_dwordx4 v61, s[36:39], s50 offen offset:1024 sc1 lds
    buffer_load_dwordx4 v62, s[36:39], s50 offen offset:2048 sc1 lds
    buffer_load_dwordx4 v63, s[36:39], s50 offen offset:3072 sc1 lds
    s_add_u32 m0, s57, 98304
    s_nop 0
    buffer_load_dwordx4 v64, s[36:39], s50 offen offset:0 sc1 lds
    s_add_u32 s50, s58, 884736
    s_cmp_ge_u32 s50, s59
    s_cselect_b32 s48, 1327104, 0
    s_sub_u32 s50, s50, s48
    s_cmp_lg_u32 s35, 6
    s_cbranch_scc1 L_m_98
    buffer_load_dword v53, v52, s[44:47], s8 offen
    buffer_load_dword v53, v52, s[44:47], s9 offen
L_m_98:
    s_waitcnt vmcnt(9)
    s_barrier
    s_add_u32 m0, s57, 108544
    s_nop 0
    buffer_load_dwordx4 v56, s[36:39], s50 offen offset:0 sc1 lds
    buffer_load_dwordx4 v57, s[36:39], s50 offen offset:1024 sc1 lds
    buffer_load_dwordx4 v58, s[36:39], s50 offen offset:2048 sc1 lds
    buffer_load_dwordx4 v59, s[36:39], s50 offen offset:3072 sc1 lds
    s_add_u32 m0, s57, 112640
    s_nop 0
    buffer_load_dwordx4 v60, s[36:39], s50 offen offset:0 sc1 lds
    buffer_load_dwordx4 v61, s[36:39], s50 offen offset:1024 sc1 lds
    buffer_load_dwordx4 v62, s[36:39], s50 offen offset:2048 sc1 lds
    buffer_load_dwordx4 v63, s[36:39], s50 offen offset:3072 sc1 lds
    s_add_u32 m0, s57, 116736
    s_nop 0
    buffer_load_dwordx4 v64, s[36:39], s50 offen offset:0 sc1 lds
    s_add_u32 s50, s58, 221184
    s_cmp_ge_u32 s50, s59
    s_cselect_b32 s48, 1327104, 0
    s_sub_u32 s50, s50, s48
    s_cmp_lg_u32 s35, 7
    s_cbranch_scc1 L_m_99
    buffer_load_dword v53, v52, s[44:47], s8 offen
    buffer_load_dword v53, v52, s[44:47], s9 offen
L_m_99:
    s_waitcnt vmcnt(9)
    s_barrier
    s_add_u32 m0, s57, 126976
    s_nop 0
    buffer_load_dwordx4 v56, s[36:39], s50 offen offset:0 sc1 lds
    buffer_load_dwordx4 v57, s[36:39], s50 offen offset:1024 sc1 lds
    buffer_load_dwordx4 v58, s[36:39], s50 offen offset:2048 sc1 lds
    buffer_load_dwordx4 v59, s[36:39], s50 offen offset:3072 sc1 lds
    s_add_u32 m0, s57, 131072
    s_nop 0
    buffer_load_dwordx4 v60, s[36:39], s50 offen offset:0 sc1 lds
    buffer_load_dwordx4 v61, s[36:39], s50 offen offset:1024 sc1 lds
    buffer_load_dwordx4 v62, s[36:39], s50 offen offset:2048 sc1 lds
    buffer_load_dwordx4 v63, s[36:39], s50 offen offset:3072 sc1 lds
    s_add_u32 m0, s57, 135168
    s_nop 0
    buffer_load_dwordx4 v64, s[36:39], s50 offen offset:0 sc1 lds
    s_add_u32 s50, s58, 294912
    s_cmp_ge_u32 s50, s59
    s_cselect_b32 s48, 1327104, 0
    s_sub_u32 s50, s50, s48
    s_waitcnt vmcnt(9)
    s_barrier
    s_add_u32 m0, s57, 145408
    s_nop 0
    buffer_load_dwordx4 v56, s[36:39], s50 offen offset:0 sc1 lds
    buffer_load_dwordx4 v57, s[36:39], s50 offen offset:1024 sc1 lds
    buffer_load_dwordx4 v58, s[36:39], s50 offen offset:2048 sc1 lds
    buffer_load_dwordx4 v59, s[36:39], s50 offen offset:3072 sc1 lds
    s_add_u32 m0, s57, 149504
    s_nop 0
    buffer_load_dwordx4 v60, s[36:39], s50 offen offset:0 sc1 lds
    buffer_load_dwordx4 v61, s[36:39], s50 offen offset:1024 sc1 lds
    buffer_load_dwordx4 v62, s[36:39], s50 offen offset:2048 sc1 lds
    buffer_load_dwordx4 v63, s[36:39], s50 offen offset:3072 sc1 lds
    s_add_u32 m0, s57, 153600
    s_nop 0
    buffer_load_dwordx4 v64, s[36:39], s50 offen offset:0 sc1 lds
    s_add_u32 s50, s58, 368640
    s_cmp_ge_u32 s50, s59
    s_cselect_b32 s48, 1327104, 0
    s_sub_u32 s50, s50, s48
    s_waitcnt vmcnt(9)
    s_barrier
    s_add_u32 m0, s57, 90112
    s_nop 0
    buffer_load_dwordx4 v56, s[36:39], s50 offen offset:0 sc1 lds
    buffer_load_dwordx4 v57, s[36:39], s50 offen offset:1024 sc1 lds
    buffer_load_dwordx4 v58, s[36:39], s50 offen offset:2048 sc1 lds
    buffer_load_dwordx4 v59, s[36:39], s50 offen offset:3072 sc1 lds
    s_add_u32 m0, s57, 94208
    s_nop 0
    buffer_load_dwordx4 v60, s[36:39], s50 offen offset:0 sc1 lds
    buffer_load_dwordx4 v61, s[36:39], s50 offen offset:1024 sc1 lds
    buffer_load_dwordx4 v62, s[36:39], s50 offen offset:2048 sc1 lds
    buffer_load_dwordx4 v63, s[36:39], s50 offen offset:3072 sc1 lds
    s_add_u32 m0, s57, 98304
    s_nop 0
    buffer_load_dwordx4 v64, s[36:39], s50 offen offset:0 sc1 lds
    s_add_u32 s50, s58, 958464
    s_cmp_ge_u32 s50, s59
    s_cselect_b32 s48, 1327104, 0
    s_sub_u32 s50, s50, s48
    s_waitcnt vmcnt(9)
    s_barrier
    s_add_u32 m0, s57, 108544
    s_nop 0
    buffer_load_dwordx4 v56, s[36:39], s50 offen offset:0 sc1 lds
    buffer_load_dwordx4 v57, s[36:39], s50 offen offset:1024 sc1 lds
    buffer_load_dwordx4 v58, s[36:39], s50 offen offset:2048 sc1 lds
    buffer_load_dwordx4 v59, s[36:39], s50 offen offset:3072 sc1 lds
    s_add_u32 m0, s57, 112640
    s_nop 0
    buffer_load_dwordx4 v60, s[36:39], s50 offen offset:0 sc1 lds
    buffer_load_dwordx4 v61, s[36:39], s50 offen offset:1024 sc1 lds
    buffer_load_dwordx4 v62, s[36:39], s50 offen offset:2048 sc1 lds
    buffer_load_dwordx4 v63, s[36:39], s50 offen offset:3072 sc1 lds
    s_add_u32 m0, s57, 116736
    s_nop 0
    buffer_load_dwordx4 v64, s[36:39], s50 offen offset:0 sc1 lds
    s_add_u32 s50, s58, 1032192
    s_cmp_ge_u32 s50, s59
    s_cselect_b32 s48, 1327104, 0
    s_sub_u32 s50, s50, s48
    s_waitcnt vmcnt(9)
    s_barrier
    s_add_u32 m0, s57, 126976
    s_nop 0
    buffer_load_dwordx4 v56, s[36:39], s50 offen offset:0 sc1 lds
    buffer_load_dwordx4 v57, s[36:39], s50 offen offset:1024 sc1 lds
    buffer_load_dwordx4 v58, s[36:39], s50 offen offset:2048 sc1 lds
    buffer_load_dwordx4 v59, s[36:39], s50 offen offset:3072 sc1 lds
    s_add_u32 m0, s57, 131072
    s_nop 0
    buffer_load_dwordx4 v60, s[36:39], s50 offen offset:0 sc1 lds
    buffer_load_dwordx4 v61, s[36:39], s50 offen offset:1024 sc1 lds
    buffer_load_dwordx4 v62, s[36:39], s50 offen offset:2048 sc1 lds
    buffer_load_dwordx4 v63, s[36:39], s50 offen offset:3072 sc1 lds
    s_add_u32 m0, s57, 135168
    s_nop 0
    buffer_load_dwordx4 v64, s[36:39], s50 offen offset:0 sc1 lds
    s_add_u32 s50, s58, 1105920
    s_cmp_ge_u32 s50, s59
    s_cselect_b32 s48, 1327104, 0
    s_sub_u32 s50, s50, s48
    s_waitcnt vmcnt(9)
    s_barrier
    s_add_u32 m0, s57, 145408
    s_nop 0
    buffer_load_dwordx4 v56, s[36:39], s50 offen offset:0 sc1 lds
    buffer_load_dwordx4 v57, s[36:39], s50 offen offset:1024 sc1 lds
    buffer_load_dwordx4 v58, s[36:39], s50 offen offset:2048 sc1 lds
    buffer_load_dwordx4 v59, s[36:39], s50 offen offset:3072 sc1 lds
    s_add_u32 m0, s57, 149504
    s_nop 0
    buffer_load_dwordx4 v60, s[36:39], s50 offen offset:0 sc1 lds
    buffer_load_dwordx4 v61, s[36:39], s50 offen offset:1024 sc1 lds
    buffer_load_dwordx4 v62, s[36:39], s50 offen offset:2048 sc1 lds
    buffer_load_dwordx4 v63, s[36:39], s50 offen offset:3072 sc1 lds
    s_add_u32 m0, s57, 153600
    s_nop 0
    buffer_load_dwordx4 v64, s[36:39], s50 offen offset:0 sc1 lds
    s_add_u32 s50, s58, 1179648
    s_cmp_ge_u32 s50, s59
    s_cselect_b32 s48, 1327104, 0
    s_sub_u32 s50, s50, s48
    s_waitcnt vmcnt(9)
    s_barrier
    s_add_u32 m0, s57, 90112
    s_nop 0
    buffer_load_dwordx4 v56, s[36:39], s50 offen offset:0 sc1 lds
    buffer_load_dwordx4 v57, s[36:39], s50 offen offset:1024 sc1 lds
    buffer_load_dwordx4 v58, s[36:39], s50 offen offset:2048 sc1 lds
    buffer_load_dwordx4 v59, s[36:39], s50 offen offset:3072 sc1 lds
    s_add_u32 m0, s57, 94208
    s_nop 0
    buffer_load_dwordx4 v60, s[36:39], s50 offen offset:0 sc1 lds
    buffer_load_dwordx4 v61, s[36:39], s50 offen offset:1024 sc1 lds
    buffer_load_dwordx4 v62, s[36:39], s50 offen offset:2048 sc1 lds
    buffer_load_dwordx4 v63, s[36:39], s50 offen offset:3072 sc1 lds
    s_add_u32 m0, s57, 98304
    s_nop 0
    buffer_load_dwordx4 v64, s[36:39], s50 offen offset:0 sc1 lds
    s_add_u32 s50, s58, 1253376
    s_cmp_ge_u32 s50, s59
    s_cselect_b32 s48, 1327104, 0
    s_sub_u32 s50, s50, s48
    s_waitcnt vmcnt(9)
    s_barrier
    s_add_u32 m0, s57, 108544
    s_nop 0
    buffer_load_dwordx4 v56, s[36:39], s50 offen offset:0 sc1 lds
    buffer_load_dwordx4 v57, s[36:39], s50 offen offset:1024 sc1 lds
    buffer_load_dwordx4 v58, s[36:39], s50 offen offset:2048 sc1 lds
    buffer_load_dwordx4 v59, s[36:39], s50 offen offset:3072 sc1 lds
    s_add_u32 m0, s57, 112640
    s_nop 0
    buffer_load_dwordx4 v60, s[36:39], s50 offen offset:0 sc1 lds
    buffer_load_dwordx4 v61, s[36:39], s50 offen offset:1024 sc1 lds
    buffer_load_dwordx4 v62, s[36:39], s50 offen offset:2048 sc1 lds
    buffer_load_dwordx4 v63, s[36:39], s50 offen offset:3072 sc1 lds
    s_add_u32 m0, s57, 116736
    s_nop 0
    buffer_load_dwordx4 v64, s[36:39], s50 offen offset:0 sc1 lds
    s_lshl_b32 s48, s62, 10
    s_add_u32 m0, s48, 32768
    s_nop 0
    buffer_load_dwordx4 v70, s[36:39], 0 offen sc1 lds
    s_lshl_b32 s48, s62, 10
    s_add_u32 m0, s48, 34816
    s_nop 0
    buffer_load_dwordx4 v71, s[36:39], 0 offen sc1 lds
    s_lshl_b32 s48, s62, 10
    s_add_u32 m0, s48, 36864
    s_nop 0
    buffer_load_dwordx4 v72, s[36:39], 0 offen sc1 lds
    s_lshl_b32 s48, s62, 10
    s_add_u32 m0, s48, 38912
    s_nop 0
    buffer_load_dwordx4 v73, s[36:39], 0 offen sc1 lds
    s_mul_i32 s48, s62, 40960
    s_add_u32 m0, s48, 40960
    s_nop 0
    buffer_load_dwordx4 v74, s[36:39], 0 offen sc1 lds
    s_waitcnt vmcnt(14)
    s_barrier
    s_waitcnt vmcnt(5)
    s_barrier
    s_waitcnt vmcnt(0)
    s_barrier
    s_branch L_m_100
L_m_50:
    v_lshlrev_b32 v29, 1, v2
    v_xor_b32 v29, v29, v1
    v_xor_b32 v30, 8, v29
    v_mul_u32_u24 v28, 4096, v2
    v_lshl_add_u32 v56, v29, 4, v28
    v_lshl_add_u32 v57, v30, 4, v28
    v_add_u32 v58, 30720, v56
    v_add_u32 v59, 46080, v57
    v_add_u32 v57, 15360, v57
    v_add_u32 v60, 65536, v56
    v_add_u32 v61, 65536, v57
    v_add_u32 v62, 65536, v58
    v_add_u32 v63, 65536, v59
    s_mul_i32 s49, s53, 4718592
    s_lshl_b32 s48, s62, 17
    s_add_u32 s49, s49, s48
    s_lshl_b32 s48, s54, 8
    s_add_u32 s49, s49, s48
    s_mul_i32 s58, s64, 262144
    s_add_u32 s58, s58, s49
    s_add_u32 s59, s49, 4718592
    s_cmp_ge_u32 s5, 27
    s_cbranch_scc1 L_m_101
    v_lshlrev_b32 v29, 1, v2
    v_xor_b32 v29, v29, v1
    v_xor_b32 v30, 8, v29
    v_mul_u32_u24 v28, 2359296, v2
    v_lshl_add_u32 v12, v29, 4, v28
    v_lshl_add_u32 v13, v30, 4, v28
    v_add_u32 v14, 16384, v12
    v_add_u32 v15, 24576, v13
    v_add_u32 v13, 8192, v13
    v_add_u32 v16, 9437184, v12
    v_add_u32 v17, 9437184, v13
    v_add_u32 v18, 9437184, v14
    v_add_u32 v19, 9437184, v15
    s_mul_i32 s49, s62, 36864
    s_lshl_b32 s48, s51, 8
    s_add_u32 s49, s49, s48
    s_mul_i32 s60, s63, 73728
    s_add_u32 s60, s60, s49
    s_add_u32 s61, s49, 2359296
    s_branch L_stub_14
L_back_w1:
    s_add_u32 s50, s60, 0
    s_cmp_ge_u32 s50, s61
    s_cselect_b32 s48, 2359296, 0
    s_sub_u32 s50, s50, s48
    s_add_u32 m0, s68, 0
    s_nop 0
    buffer_load_dwordx4 v12, s[40:43], s50 offen offset:0  lds
    buffer_load_dwordx4 v13, s[40:43], s50 offen offset:1024  lds
    buffer_load_dwordx4 v14, s[40:43], s50 offen offset:2048  lds
    buffer_load_dwordx4 v15, s[40:43], s50 offen offset:3072  lds
    s_add_u32 m0, s68, 4096
    s_nop 0
    buffer_load_dwordx4 v16, s[40:43], s50 offen offset:0  lds
    buffer_load_dwordx4 v17, s[40:43], s50 offen offset:1024  lds
    buffer_load_dwordx4 v18, s[40:43], s50 offen offset:2048  lds
    buffer_load_dwordx4 v19, s[40:43], s50 offen offset:3072  lds
    s_add_u32 s50, s60, 73728
    s_cmp_ge_u32 s50, s61
    s_cselect_b32 s48, 2359296, 0
    s_sub_u32 s50, s50, s48
    s_add_u32 m0, s68, 16384
    s_nop 0
    buffer_load_dwordx4 v12, s[40:43], s50 offen offset:0  lds
    buffer_load_dwordx4 v13, s[40:43], s50 offen offset:1024  lds
    buffer_load_dwordx4 v14, s[40:43], s50 offen offset:2048  lds
    buffer_load_dwordx4 v15, s[40:43], s50 offen offset:3072  lds
    s_add_u32 m0, s68, 20480
    s_nop 0
    buffer_load_dwordx4 v16, s[40:43], s50 offen offset:0  lds
    buffer_load_dwordx4 v17, s[40:43], s50 offen offset:1024  lds
    buffer_load_dwordx4 v18, s[40:43], s50 offen offset:2048  lds
    buffer_load_dwordx4 v19, s[40:43], s50 offen offset:3072  lds
    s_barrier
    s_add_u32 s50, s60, 147456
    s_cmp_ge_u32 s50, s61
    s_cselect_b32 s48, 2359296, 0
    s_sub_u32 s50, s50, s48
    s_add_u32 m0, s68, 32768
    s_nop 0
    buffer_load_dwordx4 v12, s[40:43], s50 offen offset:0  lds
    buffer_load_dwordx4 v13, s[40:43], s50 offen offset:1024  lds
    buffer_load_dwordx4 v14, s[40:43], s50 offen offset:2048  lds
    buffer_load_dwordx4 v15, s[40:43], s50 offen offset:3072  lds
    s_add_u32 m0, s68, 36864
    s_nop 0
    buffer_load_dwordx4 v16, s[40:43], s50 offen offset:0  lds
    buffer_load_dwordx4 v17, s[40:43], s50 offen offset:1024  lds
    buffer_load_dwordx4 v18, s[40:43], s50 offen offset:2048  lds
    buffer_load_dwordx4 v19, s[40:43], s50 offen offset:3072  lds
    s_add_u32 s50, s60, 221184
    s_cmp_ge_u32 s50, s61
    s_cselect_b32 s48, 2359296, 0
    s_sub_u32 s50, s50, s48
    s_add_u32 m0, s68, 49152
    s_nop 0
    buffer_load_dwordx4 v12, s[40:43], s50 offen offset:0  lds
    buffer_load_dwordx4 v13, s[40:43], s50 offen offset:1024  lds
    buffer_load_dwordx4 v14, s[40:43], s50 offen offset:2048  lds
    buffer_load_dwordx4 v15, s[40:43], s50 offen offset:3072  lds
    s_add_u32 m0, s68, 53248
    s_nop 0
    buffer_load_dwordx4 v16, s[40:43], s50 offen offset:0  lds
    buffer_load_dwordx4 v17, s[40:43], s50 offen offset:1024  lds
    buffer_load_dwordx4 v18, s[40:43], s50 offen offset:2048  lds
    buffer_load_dwordx4 v19, s[40:43], s50 offen offset:3072  lds
    s_barrier
    s_add_u32 s50, s60, 294912
    s_cmp_ge_u32 s50, s61
    s_cselect_b32 s48, 2359296, 0
    s_sub_u32 s50, s50, s48
    s_add_u32 m0, s68, 65536
    s_nop 0
    buffer_load_dwordx4 v12, s[40:43], s50 offen offset:0  lds
    buffer_load_dwordx4 v13, s[40:43], s50 offen offset:1024  lds
    buffer_load_dwordx4 v14, s[40:43], s50 offen offset:2048  lds
    buffer_load_dwordx4 v15, s[40:43], s50 offen offset:3072  lds
    s_add_u32 m0, s68, 69632
    s_nop 0
    buffer_load_dwordx4 v16, s[40:43], s50 offen offset:0  lds
    buffer_load_dwordx4 v17, s[40:43], s50 offen offset:1024  lds
    buffer_load_dwordx4 v18, s[40:43], s50 offen offset:2048  lds
    buffer_load_dwordx4 v19, s[40:43], s50 offen offset:3072  lds
    s_add_u32 s50, s60, 368640
    s_cmp_ge_u32 s50, s61
    s_cselect_b32 s48, 2359296, 0
    s_sub_u32 s50, s50, s48
    s_add_u32 m0, s68, 81920
    s_nop 0
    buffer_load_dwordx4 v12, s[40:43], s50 offen offset:0  lds
    buffer_load_dwordx4 v13, s[40:43], s50 offen offset:1024  lds
    buffer_load_dwordx4 v14, s[40:43], s50 offen offset:2048  lds
    buffer_load_dwordx4 v15, s[40:43], s50 offen offset:3072  lds
    s_add_u32 m0, s68, 86016
    s_nop 0
    buffer_load_dwordx4 v16, s[40:43], s50 offen offset:0  lds
    buffer_load_dwordx4 v17, s[40:43], s50 offen offset:1024  lds
    buffer_load_dwordx4 v18, s[40:43], s50 offen offset:2048  lds
    buffer_load_dwordx4 v19, s[40:43], s50 offen offset:3072  lds
    s_barrier
    s_waitcnt vmcnt(0)
    s_barrier
    s_barrier
    s_add_u32 s50, s60, 442368
    s_cmp_ge_u32 s50, s61
    s_cselect_b32 s48, 2359296, 0
    s_sub_u32 s50, s50, s48
    s_add_u32 m0, s68, 0
    s_nop 0
    buffer_load_dwordx4 v12, s[40:43], s50 offen offset:0  lds
    buffer_load_dwordx4 v13, s[40:43], s50 offen offset:1024  lds
    buffer_load_dwordx4 v14, s[40:43], s50 offen offset:2048  lds
    s_branch L_skip_14
L_stub_14:
    s_branch L_stub_15
L_skip_14:
    buffer_load_dwordx4 v15, s[40:43], s50 offen offset:3072  lds
    s_add_u32 m0, s68, 4096
    s_nop 0
    buffer_load_dwordx4 v16, s[40:43], s50 offen offset:0  lds
    buffer_load_dwordx4 v17, s[40:43], s50 offen offset:1024  lds
    buffer_load_dwordx4 v18, s[40:43], s50 offen offset:2048  lds
    buffer_load_dwordx4 v19, s[40:43], s50 offen offset:3072  lds
    s_add_u32 s50, s60, 516096
    s_cmp_ge_u32 s50, s61
    s_cselect_b32 s48, 2359296, 0
    s_sub_u32 s50, s50, s48
    s_add_u32 m0, s68, 16384
    s_nop 0
    buffer_load_dwordx4 v12, s[40:43], s50 offen offset:0  lds
    buffer_load_dwordx4 v13, s[40:43], s50 offen offset:1024  lds
    buffer_load_dwordx4 v14, s[40:43], s50 offen offset:2048  lds
    buffer_load_dwordx4 v15, s[40:43], s50 offen offset:3072  lds
    s_add_u32 m0, s68, 20480
    s_nop 0
    buffer_load_dwordx4 v16, s[40:43], s50 offen offset:0  lds
    buffer_load_dwordx4 v17, s[40:43], s50 offen offset:1024  lds
    buffer_load_dwordx4 v18, s[40:43], s50 offen offset:2048  lds
    buffer_load_dwordx4 v19, s[40:43], s50 offen offset:3072  lds
    s_add_u32 s50, s60, 589824
    s_cmp_ge_u32 s50, s61
    s_cselect_b32 s48, 2359296, 0
    s_sub_u32 s50, s50, s48
    s_add_u32 m0, s68, 32768
    s_nop 0
    buffer_load_dwordx4 v12, s[40:43], s50 offen offset:0  lds
    buffer_load_dwordx4 v13, s[40:43], s50 offen offset:1024  lds
    buffer_load_dwordx4 v14, s[40:43], s50 offen offset:2048  lds
    buffer_load_dwordx4 v15, s[40:43], s50 offen offset:3072  lds
    s_add_u32 m0, s68, 36864
    s_nop 0
    buffer_load_dwordx4 v16, s[40:43], s50 offen offset:0  lds
    buffer_load_dwordx4 v17, s[40:43], s50 offen offset:1024  lds
    buffer_load_dwordx4 v18, s[40:43], s50 offen offset:2048  lds
    buffer_load_dwordx4 v19, s[40:43], s50 offen offset:3072  lds
    s_add_u32 s50, s60, 663552
    s_cmp_ge_u32 s50, s61
    s_cselect_b32 s48, 2359296, 0
    s_sub_u32 s50, s50, s48
    s_add_u32 m0, s68, 49152
    s_nop 0
    buffer_load_dwordx4 v12, s[40:43], s50 offen offset:0  lds
    buffer_load_dwordx4 v13, s[40:43], s50 offen offset:1024  lds
    buffer_load_dwordx4 v14, s[40:43], s50 offen offset:2048  lds
    buffer_load_dwordx4 v15, s[40:43], s50 offen offset:3072  lds
    s_add_u32 m0, s68, 53248
    s_nop 0
    buffer_load_dwordx4 v16, s[40:43], s50 offen offset:0  lds
    buffer_load_dwordx4 v17, s[40:43], s50 offen offset:1024  lds
    buffer_load_dwordx4 v18, s[40:43], s50 offen offset:2048  lds
    buffer_load_dwordx4 v19, s[40:43], s50 offen offset:3072  lds
    s_add_u32 s50, s60, 737280
    s_cmp_ge_u32 s50, s61
    s_cselect_b32 s48, 2359296, 0
    s_sub_u32 s50, s50, s48
    s_add_u32 m0, s68, 65536
    s_nop 0
    buffer_load_dwordx4 v12, s[40:43], s50 offen offset:0  lds
    buffer_load_dwordx4 v13, s[40:43], s50 offen offset:1024  lds
    buffer_load_dwordx4 v14, s[40:43], s50 offen offset:2048  lds
    buffer_load_dwordx4 v15, s[40:43], s50 offen offset:3072  lds
    s_add_u32 m0, s68, 69632
    s_nop 0
    buffer_load_dwordx4 v16, s[40:43], s50 offen offset:0  lds
    buffer_load_dwordx4 v17, s[40:43], s50 offen offset:1024  lds
    buffer_load_dwordx4 v18, s[40:43], s50 offen offset:2048  lds
    buffer_load_dwordx4 v19, s[40:43], s50 offen offset:3072  lds
    s_add_u32 s50, s60, 811008
    s_cmp_ge_u32 s50, s61
    s_cselect_b32 s48, 2359296, 0
    s_sub_u32 s50, s50, s48
    s_add_u32 m0, s68, 81920
    s_nop 0
    buffer_load_dwordx4 v12, s[40:43], s50 offen offset:0  lds
    buffer_load_dwordx4 v13, s[40:43], s50 offen offset:1024  lds
    buffer_load_dwordx4 v14, s[40:43], s50 offen offset:2048  lds
    buffer_load_dwordx4 v15, s[40:43], s50 offen offset:3072  lds
    s_add_u32 m0, s68, 86016
    s_nop 0
    buffer_load_dwordx4 v16, s[40:43], s50 offen offset:0  lds
    buffer_load_dwordx4 v17, s[40:43], s50 offen offset:1024  lds
    buffer_load_dwordx4 v18, s[40:43], s50 offen offset:2048  lds
    buffer_load_dwordx4 v19, s[40:43], s50 offen offset:3072  lds
    s_waitcnt vmcnt(40)
    s_barrier
    s_waitcnt vmcnt(32)
    s_barrier
    s_add_u32 s50, s60, 884736
    s_cmp_ge_u32 s50, s61
    s_cselect_b32 s48, 2359296, 0
    s_sub_u32 s50, s50, s48
    s_add_u32 m0, s68, 0
    s_nop 0
    buffer_load_dwordx4 v12, s[40:43], s50 offen offset:0  lds
    buffer_load_dwordx4 v13, s[40:43], s50 offen offset:1024  lds
    buffer_load_dwordx4 v14, s[40:43], s50 offen offset:2048  lds
    buffer_load_dwordx4 v15, s[40:43], s50 offen offset:3072  lds
    s_add_u32 m0, s68, 4096
    s_nop 0
    buffer_load_dwordx4 v16, s[40:43], s50 offen offset:0  lds
    buffer_load_dwordx4 v17, s[40:43], s50 offen offset:1024  lds
    s_waitcnt vmcnt(30)
    s_barrier
    buffer_load_dwordx4 v18, s[40:43], s50 offen offset:2048  lds
    buffer_load_dwordx4 v19, s[40:43], s50 offen offset:3072  lds
    s_add_u32 s50, s60, 958464
    s_cmp_ge_u32 s50, s61
    s_cselect_b32 s48, 2359296, 0
    s_sub_u32 s50, s50, s48
    s_add_u32 m0, s68, 16384
    s_nop 0
    buffer_load_dwordx4 v12, s[40:43], s50 offen offset:0  lds
    buffer_load_dwordx4 v13, s[40:43], s50 offen offset:1024  lds
    buffer_load_dwordx4 v14, s[40:43], s50 offen offset:2048  lds
    s_waitcnt vmcnt(27)
    s_barrier
    buffer_load_dwordx4 v15, s[40:43], s50 offen offset:3072  lds
    s_add_u32 m0, s68, 20480
    s_nop 0
    buffer_load_dwordx4 v16, s[40:43], s50 offen offset:0  lds
    buffer_load_dwordx4 v17, s[40:43], s50 offen offset:1024  lds
    buffer_load_dwordx4 v18, s[40:43], s50 offen offset:2048  lds
    buffer_load_dwordx4 v19, s[40:43], s50 offen offset:3072  lds
    s_add_u32 s50, s60, 1032192
    s_cmp_ge_u32 s50, s61
    s_cselect_b32 s48, 2359296, 0
    s_sub_u32 s50, s50, s48
    s_add_u32 m0, s68, 32768
    s_nop 0
    buffer_load_dwordx4 v12, s[40:43], s50 offen offset:0  lds
    s_waitcnt vmcnt(25)
    s_barrier
    buffer_load_dwordx4 v13, s[40:43], s50 offen offset:1024  lds
    buffer_load_dwordx4 v14, s[40:43], s50 offen offset:2048  lds
    buffer_load_dwordx4 v15, s[40:43], s50 offen offset:3072  lds
    s_add_u32 m0, s68, 36864
    s_nop 0
    buffer_load_dwordx4 v16, s[40:43], s50 offen offset:0  lds
    buffer_load_dwordx4 v17, s[40:43], s50 offen offset:1024  lds
    buffer_load_dwordx4 v18, s[40:43], s50 offen offset:2048  lds
    s_waitcnt vmcnt(23)
    s_barrier
    buffer_load_dwordx4 v19, s[40:43], s50 offen offset:3072  lds
    s_add_u32 s50, s60, 1105920
    s_cmp_ge_u32 s50, s61
    s_cselect_b32 s48, 2359296, 0
    s_sub_u32 s50, s50, s48
    s_add_u32 m0, s68, 49152
    s_nop 0
    buffer_load_dwordx4 v12, s[40:43], s50 offen offset:0  lds
    buffer_load_dwordx4 v13, s[40:43], s50 offen offset:1024  lds
    buffer_load_dwordx4 v14, s[40:43], s50 offen offset:2048  lds
    buffer_load_dwordx4 v15, s[40:43], s50 offen offset:3072  lds
    s_add_u32 m0, s68, 53248
    s_nop 0
    buffer_load_dwordx4 v16, s[40:43], s50 offen offset:0  lds
    s_barrier
    buffer_load_dwordx4 v17, s[40:43], s50 offen offset:1024  lds
    buffer_load_dwordx4 v18, s[40:43], s50 offen offset:2048  lds
    buffer_load_dwordx4 v19, s[40:43], s50 offen offset:3072  lds
    s_add_u32 s50, s60, 1179648
    s_cmp_ge_u32 s50, s61
    s_cselect_b32 s48, 2359296, 0
    s_sub_u32 s50, s50, s48
    s_add_u32 m0, s68, 65536
    s_nop 0
    buffer_load_dwordx4 v12, s[40:43], s50 offen offset:0  lds
    buffer_load_dwordx4 v13, s[40:43], s50 offen offset:1024  lds
    s_waitcnt vmcnt(26)
    s_barrier
    buffer_load_dwordx4 v14, s[40:43], s50 offen offset:2048  lds
    buffer_load_dwordx4 v15, s[40:43], s50 offen offset:3072  lds
    s_add_u32 m0, s68, 69632
    s_nop 0
    buffer_load_dwordx4 v16, s[40:43], s50 offen offset:0  lds
    buffer_load_dwordx4 v17, s[40:43], s50 offen offset:1024  lds
    buffer_load_dwordx4 v18, s[40:43], s50 offen offset:2048  lds
    buffer_load_dwordx4 v19, s[40:43], s50 offen offset:3072  lds
    s_waitcnt vmcnt(24)
    s_barrier
    s_add_u32 s50, s60, 1253376
    s_cmp_ge_u32 s50, s61
    s_cselect_b32 s48, 2359296, 0
    s_sub_u32 s50, s50, s48
    s_add_u32 m0, s68, 81920
    s_nop 0
    buffer_load_dwordx4 v12, s[40:43], s50 offen offset:0  lds
    buffer_load_dwordx4 v13, s[40:43], s50 offen offset:1024  lds
    buffer_load_dwordx4 v14, s[40:43], s50 offen offset:2048  lds
    buffer_load_dwordx4 v15, s[40:43], s50 offen offset:3072  lds
    s_add_u32 m0, s68, 86016
    s_nop 0
    buffer_load_dwordx4 v16, s[40:43], s50 offen offset:0  lds
    buffer_load_dwordx4 v17, s[40:43], s50 offen offset:1024  lds
    s_waitcnt vmcnt(22)
    s_barrier
    buffer_load_dwordx4 v18, s[40:43], s50 offen offset:2048  lds
    buffer_load_dwordx4 v19, s[40:43], s50 offen offset:3072  lds
    s_add_u32 s50, s60, 1327104
    s_cmp_ge_u32 s50, s61
    s_cselect_b32 s48, 2359296, 0
    s_sub_u32 s50, s50, s48
    s_add_u32 m0, s68, 0
    s_nop 0
    buffer_load_dwordx4 v12, s[40:43], s50 offen offset:0  lds
    buffer_load_dwordx4 v13, s[40:43], s50 offen offset:1024  lds
    buffer_load_dwordx4 v14, s[40:43], s50 offen offset:2048  lds
    s_barrier
    buffer_load_dwordx4 v15, s[40:43], s50 offen offset:3072  lds
    s_add_u32 m0, s68, 4096
    s_nop 0
    buffer_load_dwordx4 v16, s[40:43], s50 offen offset:0  lds
    buffer_load_dwordx4 v17, s[40:43], s50 offen offset:1024  lds
    buffer_load_dwordx4 v18, s[40:43], s50 offen offset:2048  lds
    buffer_load_dwordx4 v19, s[40:43], s50 offen offset:3072  lds
    s_add_u32 s50, s60, 1400832
    s_cmp_ge_u32 s50, s61
    s_cselect_b32 s48, 2359296, 0
    s_sub_u32 s50, s50, s48
    s_add_u32 m0, s68, 16384
    s_nop 0
    buffer_load_dwordx4 v12, s[40:43], s50 offen offset:0  lds
    s_waitcnt vmcnt(25)
    s_barrier
    buffer_load_dwordx4 v13, s[40:43], s50 offen offset:1024  lds
    buffer_load_dwordx4 v14, s[40:43], s50 offen offset:2048  lds
    buffer_load_dwordx4 v15, s[40:43], s50 offen offset:3072  lds
    s_add_u32 m0, s68, 20480
    s_nop 0
    buffer_load_dwordx4 v16, s[40:43], s50 offen offset:0  lds
    buffer_load_dwordx4 v17, s[40:43], s50 offen offset:1024  lds
    buffer_load_dwordx4 v18, s[40:43], s50 offen offset:2048  lds
    s_waitcnt vmcnt(23)
    s_barrier
    buffer_load_dwordx4 v19, s[40:43], s50 offen offset:3072  lds
    s_add_u32 s50, s60, 1474560
    s_cmp_ge_u32 s50, s61
    s_cselect_b32 s48, 2359296, 0
    s_sub_u32 s50, s50, s48
    s_add_u32 m0, s68, 32768
    s_nop 0
    buffer_load_dwordx4 v12, s[40:43], s50 offen offset:0  lds
    buffer_load_dwordx4 v13, s[40:43], s50 offen offset:1024  lds
    buffer_load_dwordx4 v14, s[40:43], s50 offen offset:2048  lds
    buffer_load_dwordx4 v15, s[40:43], s50 offen offset:3072  lds
    s_add_u32 m0, s68, 36864
    s_nop 0
    buffer_load_dwordx4 v16, s[40:43], s50 offen offset:0  lds
    s_waitcnt vmcnt(21)
    s_barrier
    buffer_load_dwordx4 v17, s[40:43], s50 offen offset:1024  lds
    buffer_load_dwordx4 v18, s[40:43], s50 offen offset:2048  lds
    buffer_load_dwordx4 v19, s[40:43], s50 offen offset:3072  lds
    s_add_u32 s50, s60, 1548288
    s_cmp_ge_u32 s50, s61
    s_cselect_b32 s48, 2359296, 0
    s_sub_u32 s50, s50, s48
    s_add_u32 m0, s68, 49152
    s_nop 0
    buffer_load_dwordx4 v12, s[40:43], s50 offen offset:0  lds
    buffer_load_dwordx4 v13, s[40:43], s50 offen offset:1024  lds
    s_barrier
    buffer_load_dwordx4 v14, s[40:43], s50 offen offset:2048  lds
    buffer_load_dwordx4 v15, s[40:43], s50 offen offset:3072  lds
    s_add_u32 m0, s68, 53248
    s_nop 0
    buffer_load_dwordx4 v16, s[40:43], s50 offen offset:0  lds
    buffer_load_dwordx4 v17, s[40:43], s50 offen offset:1024  lds
    buffer_load_dwordx4 v18, s[40:43], s50 offen offset:2048  lds
    buffer_load_dwordx4 v19, s[40:43], s50 offen offset:3072  lds
    s_waitcnt vmcnt(24)
    s_barrier
    s_add_u32 s50, s60, 1622016
    s_cmp_ge_u32 s50, s61
    s_cselect_b32 s48, 2359296, 0
    s_sub_u32 s50, s50, s48
    s_add_u32 m0, s68, 65536
    s_nop 0
    buffer_load_dwordx4 v12, s[40:43], s50 offen offset:0  lds
    buffer_load_dwordx4 v13, s[40:43], s50 offen offset:1024  lds
    buffer_load_dwordx4 v14, s[40:43], s50 offen offset:2048  lds
    buffer_load_dwordx4 v15, s[40:43], s50 offen offset:3072  lds
    s_add_u32 m0, s68, 69632
    s_nop 0
    buffer_load_dwordx4 v16, s[40:43], s50 offen offset:0  lds
    buffer_load_dwordx4 v17, s[40:43], s50 offen offset:1024  lds
    s_waitcnt vmcnt(22)
    s_barrier
    buffer_load_dwordx4 v18, s[40:43], s50 offen offset:2048  lds
    buffer_load_dwordx4 v19, s[40:43], s50 offen offset:3072  lds
    s_add_u32 s50, s60, 1695744
    s_cmp_ge_u32 s50, s61
    s_cselect_b32 s48, 2359296, 0
    s_sub_u32 s50, s50, s48
    s_add_u32 m0, s68, 81920
    s_nop 0
    buffer_load_dwordx4 v12, s[40:43], s50 offen offset:0  lds
    buffer_load_dwordx4 v13, s[40:43], s50 offen offset:1024  lds
    buffer_load_dwordx4 v14, s[40:43], s50 offen offset:2048  lds
    s_waitcnt vmcnt(19)
    s_barrier
    buffer_load_dwordx4 v15, s[40:43], s50 offen offset:3072  lds
    s_add_u32 m0, s68, 86016
    s_nop 0
    buffer_load_dwordx4 v16, s[40:43], s50 offen offset:0  lds
    buffer_load_dwordx4 v17, s[40:43], s50 offen offset:1024  lds
    buffer_load_dwordx4 v18, s[40:43], s50 offen offset:2048  lds
    buffer_load_dwordx4 v19, s[40:43], s50 offen offset:3072  lds
    s_add_u32 s50, s60, 1769472
    s_cmp_ge_u32 s50, s61
    s_cselect_b32 s48, 2359296, 0
    s_sub_u32 s50, s50, s48
    s_add_u32 m0, s68, 0
    s_nop 0
    buffer_load_dwordx4 v12, s[40:43], s50 offen offset:0  lds
    s_barrier
    buffer_load_dwordx4 v13, s[40:43], s50 offen offset:1024  lds
    buffer_load_dwordx4 v14, s[40:43], s50 offen offset:2048  lds
    buffer_load_dwordx4 v15, s[40:43], s50 offen offset:3072  lds
    s_add_u32 m0, s68, 4096
    s_nop 0
    buffer_load_dwordx4 v16, s[40:43], s50 offen offset:0  lds
    buffer_load_dwordx4 v17, s[40:43], s50 offen offset:1024  lds
    buffer_load_dwordx4 v18, s[40:43], s50 offen offset:2048  lds
    s_waitcnt vmcnt(23)
    s_barrier
    buffer_load_dwordx4 v19, s[40:43], s50 offen offset:3072  lds
    s_add_u32 s50, s60, 1843200
    s_cmp_ge_u32 s50, s61
    s_cselect_b32 s48, 2359296, 0
    s_sub_u32 s50, s50, s48
    s_add_u32 m0, s68, 16384
    s_nop 0
    buffer_load_dwordx4 v12, s[40:43], s50 offen offset:0  lds
    buffer_load_dwordx4 v13, s[40:43], s50 offen offset:1024  lds
    buffer_load_dwordx4 v14, s[40:43], s50 offen offset:2048  lds
    buffer_load_dwordx4 v15, s[40:43], s50 offen offset:3072  lds
    s_add_u32 m0, s68, 20480
    s_nop 0
    buffer_load_dwordx4 v16, s[40:43], s50 offen offset:0  lds
    s_waitcnt vmcnt(21)
    s_barrier
    buffer_load_dwordx4 v17, s[40:43], s50 offen offset:1024  lds
    buffer_load_dwordx4 v18, s[40:43], s50 offen offset:2048  lds
    buffer_load_dwordx4 v19, s[40:43], s50 offen offset:3072  lds
    s_add_u32 s50, s60, 1916928
    s_cmp_ge_u32 s50, s61
    s_cselect_b32 s48, 2359296, 0
    s_sub_u32 s50, s50, s48
    s_add_u32 m0, s68, 32768
    s_nop 0
    buffer_load_dwordx4 v12, s[40:43], s50 offen offset:0  lds
    buffer_load_dwordx4 v13, s[40:43], s50 offen offset:1024  lds
    s_waitcnt vmcnt(18)
    s_barrier
    buffer_load_dwordx4 v14, s[40:43], s50 offen offset:2048  lds
    buffer_load_dwordx4 v15, s[40:43], s50 offen offset:3072  lds
    s_add_u32 m0, s68, 36864
    s_nop 0
    buffer_load_dwordx4 v16, s[40:43], s50 offen offset:0  lds
    buffer_load_dwordx4 v17, s[40:43], s50 offen offset:1024  lds
    buffer_load_dwordx4 v18, s[40:43], s50 offen offset:2048  lds
    buffer_load_dwordx4 v19, s[40:43], s50 offen offset:3072  lds
    s_barrier
    s_add_u32 s50, s60, 1990656
    s_cmp_ge_u32 s50, s61
    s_cselect_b32 s48, 2359296, 0
    s_sub_u32 s50, s50, s48
    s_add_u32 m0, s68, 49152
    s_nop 0
    buffer_load_dwordx4 v12, s[40:43], s50 offen offset:0  lds
    buffer_load_dwordx4 v13, s[40:43], s50 offen offset:1024  lds
    buffer_load_dwordx4 v14, s[40:43], s50 offen offset:2048  lds
    buffer_load_dwordx4 v15, s[40:43], s50 offen offset:3072  lds
    s_add_u32 m0, s68, 53248
    s_nop 0
    buffer_load_dwordx4 v16, s[40:43], s50 offen offset:0  lds
    buffer_load_dwordx4 v17, s[40:43], s50 offen offset:1024  lds
    s_waitcnt vmcnt(22)
    s_barrier
    buffer_load_dwordx4 v18, s[40:43], s50 offen offset:2048  lds
    buffer_load_dwordx4 v19, s[40:43], s50 offen offset:3072  lds
    s_add_u32 s50, s60, 2064384
    s_cmp_ge_u32 s50, s61
    s_cselect_b32 s48, 2359296, 0
    s_sub_u32 s50, s50, s48
    s_add_u32 m0, s68, 65536
    s_nop 0
    buffer_load_dwordx4 v12, s[40:43], s50 offen offset:0  lds
    buffer_load_dwordx4 v13, s[40:43], s50 offen offset:1024  lds
    buffer_load_dwordx4 v14, s[40:43], s50 offen offset:2048  lds
    s_waitcnt vmcnt(19)
    s_barrier
    buffer_load_dwordx4 v15, s[40:43], s50 offen offset:3072  lds
    s_add_u32 m0, s68, 69632
    s_nop 0
    buffer_load_dwordx4 v16, s[40:43], s50 offen offset:0  lds
    buffer_load_dwordx4 v17, s[40:43], s50 offen offset:1024  lds
    buffer_load_dwordx4 v18, s[40:43], s50 offen offset:2048  lds
    buffer_load_dwordx4 v19, s[40:43], s50 offen offset:3072  lds
    s_add_u32 s50, s60, 2138112
    s_cmp_ge_u32 s50, s61
    s_cselect_b32 s48, 2359296, 0
    s_sub_u32 s50, s50, s48
    s_add_u32 m0, s68, 81920
    s_nop 0
    buffer_load_dwordx4 v12, s[40:43], s50 offen offset:0  lds
    s_waitcnt vmcnt(17)
    s_barrier
    buffer_load_dwordx4 v13, s[40:43], s50 offen offset:1024  lds
    buffer_load_dwordx4 v14, s[40:43], s50 offen offset:2048  lds
    buffer_load_dwordx4 v15, s[40:43], s50 offen offset:3072  lds
    s_add_u32 m0, s68, 86016
    s_nop 0
    buffer_load_dwordx4 v16, s[40:43], s50 offen offset:0  lds
    buffer_load_dwordx4 v17, s[40:43], s50 offen offset:1024  lds
    buffer_load_dwordx4 v18, s[40:43], s50 offen offset:2048  lds
    s_barrier
    buffer_load_dwordx4 v19, s[40:43], s50 offen offset:3072  lds
    s_add_u32 s50, s60, 2211840
    s_cmp_ge_u32 s50, s61
    s_cselect_b32 s48, 2359296, 0
    s_sub_u32 s50, s50, s48
    s_add_u32 m0, s68, 0
    s_nop 0
    buffer_load_dwordx4 v12, s[40:43], s50 offen offset:0  lds
    buffer_load_dwordx4 v13, s[40:43], s50 offen offset:1024  lds
    buffer_load_dwordx4 v14, s[40:43], s50 offen offset:2048  lds
    buffer_load_dwordx4 v15, s[40:43], s50 offen offset:3072  lds
    s_add_u32 m0, s68, 4096
    s_nop 0
    buffer_load_dwordx4 v16, s[40:43], s50 offen offset:0  lds
    s_waitcnt vmcnt(21)
    s_barrier
    buffer_load_dwordx4 v17, s[40:43], s50 offen offset:1024  lds
    buffer_load_dwordx4 v18, s[40:43], s50 offen offset:2048  lds
    buffer_load_dwordx4 v19, s[40:43], s50 offen offset:3072  lds
    s_add_u32 s50, s60, 2285568
    s_cmp_ge_u32 s50, s61
    s_cselect_b32 s48, 2359296, 0
    s_sub_u32 s50, s50, s48
    s_add_u32 m0, s68, 16384
    s_nop 0
    buffer_load_dwordx4 v12, s[40:43], s50 offen offset:0  lds
    buffer_load_dwordx4 v13, s[40:43], s50 offen offset:1024  lds
    s_waitcnt vmcnt(18)
    s_barrier
    buffer_load_dwordx4 v14, s[40:43], s50 offen offset:2048  lds
    buffer_load_dwordx4 v15, s[40:43], s50 offen offset:3072  lds
    s_add_u32 m0, s68, 20480
    s_nop 0
    buffer_load_dwordx4 v16, s[40:43], s50 offen offset:0  lds
    buffer_load_dwordx4 v17, s[40:43], s50 offen offset:1024  lds
    buffer_load_dwordx4 v18, s[40:43], s50 offen offset:2048  lds
    buffer_load_dwordx4 v19, s[40:43], s50 offen offset:3072  lds
    s_waitcnt vmcnt(16)
    s_barrier
    s_add_u32 s50, s58, 0
    s_cmp_ge_u32 s50, s59
    s_cselect_b32 s48, 4718592, 0
    s_sub_u32 s50, s50, s48
    s_add_u32 m0, s68, 32768
    s_nop 0
    buffer_load_dwordx4 v56, s[44:47], s50 offen offset:0  lds
    buffer_load_dwordx4 v57, s[44:47], s50 offen offset:1024  lds
    buffer_load_dwordx4 v58, s[44:47], s50 offen offset:2048  lds
    buffer_load_dwordx4 v59, s[44:47], s50 offen offset:3072  lds
    s_add_u32 m0, s68, 36864
    s_nop 0
    buffer_load_dwordx4 v60, s[44:47], s50 offen offset:0  lds
    buffer_load_dwordx4 v61, s[44:47], s50 offen offset:1024  lds
    buffer_load_dwordx4 v62, s[44:47], s50 offen offset:2048  lds
    buffer_load_dwordx4 v63, s[44:47], s50 offen offset:3072  lds
    s_add_u32 s50, s58, 262144
    s_cmp_ge_u32 s50, s59
    s_cselect_b32 s48, 4718592, 0
    s_sub_u32 s50, s50, s48
    s_add_u32 m0, s68, 49152
    s_nop 0
    buffer_load_dwordx4 v56, s[44:47], s50 offen offset:0  lds
    buffer_load_dwordx4 v57, s[44:47], s50 offen offset:1024  lds
    s_waitcnt vmcnt(18)
    s_barrier
    buffer_load_dwordx4 v58, s[44:47], s50 offen offset:2048  lds
    buffer_load_dwordx4 v59, s[44:47], s50 offen offset:3072  lds
    s_add_u32 m0, s68, 53248
    s_nop 0
    buffer_load_dwordx4 v60, s[44:47], s50 offen offset:0  lds
    buffer_load_dwordx4 v61, s[44:47], s50 offen offset:1024  lds
    buffer_load_dwordx4 v62, s[44:47], s50 offen offset:2048  lds
    buffer_load_dwordx4 v63, s[44:47], s50 offen offset:3072  lds
    s_add_u32 s50, s58, 524288
    s_cmp_ge_u32 s50, s59
    s_cselect_b32 s48, 4718592, 0
    s_sub_u32 s50, s50, s48
    s_add_u32 m0, s68, 65536
    s_nop 0
    buffer_load_dwordx4 v56, s[44:47], s50 offen offset:0  lds
    buffer_load_dwordx4 v57, s[44:47], s50 offen offset:1024  lds
    buffer_load_dwordx4 v58, s[44:47], s50 offen offset:2048  lds
    buffer_load_dwordx4 v59, s[44:47], s50 offen offset:3072  lds
    s_add_u32 m0, s68, 69632
    s_nop 0
    buffer_load_dwordx4 v60, s[44:47], s50 offen offset:0  lds
    buffer_load_dwordx4 v61, s[44:47], s50 offen offset:1024  lds
    s_waitcnt vmcnt(22)
    s_barrier
    buffer_load_dwordx4 v62, s[44:47], s50 offen offset:2048  lds
    buffer_load_dwordx4 v63, s[44:47], s50 offen offset:3072  lds
    s_add_u32 s50, s58, 786432
    s_cmp_ge_u32 s50, s59
    s_cselect_b32 s48, 4718592, 0
    s_sub_u32 s50, s50, s48
    s_add_u32 m0, s68, 81920
    s_nop 0
    buffer_load_dwordx4 v56, s[44:47], s50 offen offset:0  lds
    buffer_load_dwordx4 v57, s[44:47], s50 offen offset:1024  lds
    buffer_load_dwordx4 v58, s[44:47], s50 offen offset:2048  lds
    buffer_load_dwordx4 v59, s[44:47], s50 offen offset:3072  lds
    s_add_u32 m0, s68, 86016
    s_nop 0
    buffer_load_dwordx4 v60, s[44:47], s50 offen offset:0  lds
    buffer_load_dwordx4 v61, s[44:47], s50 offen offset:1024  lds
    buffer_load_dwordx4 v62, s[44:47], s50 offen offset:2048  lds
    buffer_load_dwordx4 v63, s[44:47], s50 offen offset:3072  lds
    s_barrier
    s_branch L_m_102
L_m_101:
    s_sub_u32 s56, s5, 27
    s_lshl_b32 s56, s56, 1
    s_add_u32 s56, s56, s62
    s_add_u32 s56, s56, 96
    s_barrier
L_m_103:
    s_cmp_ge_u32 s56, 116
    s_cbranch_scc1 L_m_104
    s_mul_i32 s48, s56, 820
    s_lshr_b32 s48, s48, 13
    s_mul_i32 s49, s48, 10
    s_sub_u32 s49, s56, s49
    s_lshl_b32 s49, s49, 6
    v_add_u32 v22, s49, v0
    s_and_b32 s49, s4, 7
    s_mul_i32 s49, s49, 4
    s_add_u32 s48, s48, s49
    s_add_u32 s48, s48, 26
    s_and_b32 s48, s48, 31
    s_mul_i32 s48, s48, 73728
    s_mul_i32 s49, s4, 1152
    s_and_b32 s49, s49, -256
    s_add_u32 s48, s48, s49
    v_mul_u32_u24 v23, 820, v22
    v_lshrrev_b32 v23, 13, v23
    v_mul_u32_u24 v24, 10, v23
    v_sub_u32 v24, v22, v24
    v_and_b32 v22, 7, v23
    v_lshrrev_b32 v23, 3, v23
    v_lshl_add_u32 v22, v22, 8, v23
    v_mul_u32_u24 v22, 9216, v22
    v_lshl_add_u32 v22, v24, 7, v22
    buffer_load_dword v25, v22, s[40:43], s48 offen
    s_add_u32 s56, s56, 10
    s_branch L_m_103
L_m_104:
    s_barrier
    s_barrier
    s_barrier
    s_barrier
    s_barrier
    s_add_u32 s50, s58, 0
    s_cmp_ge_u32 s50, s59
    s_cselect_b32 s48, 4718592, 0
    s_sub_u32 s50, s50, s48
    s_add_u32 m0, s68, 32768
    s_nop 0
    buffer_load_dwordx4 v56, s[44:47], s50 offen offset:0  lds
    buffer_load_dwordx4 v57, s[44:47], s50 offen offset:1024  lds
    buffer_load_dwordx4 v58, s[44:47], s50 offen offset:2048  lds
    buffer_load_dwordx4 v59, s[44:47], s50 offen offset:3072  lds
    s_add_u32 m0, s68, 36864
    s_nop 0
    buffer_load_dwordx4 v60, s[44:47], s50 offen offset:0  lds
    buffer_load_dwordx4 v61, s[44:47], s50 offen offset:1024  lds
    buffer_load_dwordx4 v62, s[44:47], s50 offen offset:2048  lds
    buffer_load_dwordx4 v63, s[44:47], s50 offen offset:3072  lds
    s_add_u32 s50, s58, 262144
    s_cmp_ge_u32 s50, s59
    s_cselect_b32 s48, 4718592, 0
    s_sub_u32 s50, s50, s48
    s_add_u32 m0, s68, 49152
    s_nop 0
    buffer_load_dwordx4 v56, s[44:47], s50 offen offset:0  lds
    buffer_load_dwordx4 v57, s[44:47], s50 offen offset:1024  lds
    buffer_load_dwordx4 v58, s[44:47], s50 offen offset:2048  lds
    buffer_load_dwordx4 v59, s[44:47], s50 offen offset:3072  lds
    s_add_u32 m0, s68, 53248
    s_nop 0
    buffer_load_dwordx4 v60, s[44:47], s50 offen offset:0  lds
    buffer_load_dwordx4 v61, s[44:47], s50 offen offset:1024  lds
    buffer_load_dwordx4 v62, s[44:47], s50 offen offset:2048  lds
    buffer_load_dwordx4 v63, s[44:47], s50 offen offset:3072  lds
    s_add_u32 s50, s58, 524288
    s_cmp_ge_u32 s50, s59
    s_cselect_b32 s48, 4718592, 0
    s_sub_u32 s50, s50, s48
    s_add_u32 m0, s68, 65536
    s_nop 0
    buffer_load_dwordx4 v56, s[44:47], s50 offen offset:0  lds
    buffer_load_dwordx4 v57, s[44:47], s50 offen offset:1024  lds
    buffer_load_dwordx4 v58, s[44:47], s50 offen offset:2048  lds
    buffer_load_dwordx4 v59, s[44:47], s50 offen offset:3072  lds
    s_add_u32 m0, s68, 69632
    s_nop 0
    buffer_load_dwordx4 v60, s[44:47], s50 offen offset:0  lds
    buffer_load_dwordx4 v61, s[44:47], s50 offen offset:1024  lds
    buffer_load_dwordx4 v62, s[44:47], s50 offen offset:2048  lds
    buffer_load_dwordx4 v63, s[44:47], s50 offen offset:3072  lds
    s_add_u32 s50, s58, 786432
    s_cmp_ge_u32 s50, s59
    s_cselect_b32 s48, 4718592, 0
    s_sub_u32 s50, s50, s48
    s_add_u32 m0, s68, 81920
    s_nop 0
    s_branch L_skip_15
L_stub_15:
    s_branch L_back_w1
L_skip_15:
    buffer_load_dwordx4 v56, s[44:47], s50 offen offset:0  lds
    buffer_load_dwordx4 v57, s[44:47], s50 offen offset:1024  lds
    buffer_load_dwordx4 v58, s[44:47], s50 offen offset:2048  lds
    buffer_load_dwordx4 v59, s[44:47], s50 offen offset:3072  lds
    s_add_u32 m0, s68, 86016
    s_nop 0
    buffer_load_dwordx4 v60, s[44:47], s50 offen offset:0  lds
    buffer_load_dwordx4 v61, s[44:47], s50 offen offset:1024  lds
    buffer_load_dwordx4 v62, s[44:47], s50 offen offset:2048  lds
    buffer_load_dwordx4 v63, s[44:47], s50 offen offset:3072  lds
L_m_102:
    s_add_u32 s50, s58, 1048576
    s_cmp_ge_u32 s50, s59
    s_cselect_b32 s48, 4718592, 0
    s_sub_u32 s50, s50, s48
    s_add_u32 m0, s68, 0
    s_nop 0
    buffer_load_dwordx4 v56, s[44:47], s50 offen offset:0  lds
    buffer_load_dwordx4 v57, s[44:47], s50 offen offset:1024  lds
    buffer_load_dwordx4 v58, s[44:47], s50 offen offset:2048  lds
    buffer_load_dwordx4 v59, s[44:47], s50 offen offset:3072  lds
    s_add_u32 m0, s68, 4096
    s_nop 0
    buffer_load_dwordx4 v60, s[44:47], s50 offen offset:0  lds
    buffer_load_dwordx4 v61, s[44:47], s50 offen offset:1024  lds
    buffer_load_dwordx4 v62, s[44:47], s50 offen offset:2048  lds
    buffer_load_dwordx4 v63, s[44:47], s50 offen offset:3072  lds
    s_add_u32 s50, s58, 1310720
    s_cmp_ge_u32 s50, s59
    s_cselect_b32 s48, 4718592, 0
    s_sub_u32 s50, s50, s48
    s_add_u32 m0, s68, 16384
    s_nop 0
    buffer_load_dwordx4 v56, s[44:47], s50 offen offset:0  lds
    buffer_load_dwordx4 v57, s[44:47], s50 offen offset:1024  lds
    buffer_load_dwordx4 v58, s[44:47], s50 offen offset:2048  lds
    buffer_load_dwordx4 v59, s[44:47], s50 offen offset:3072  lds
    s_add_u32 m0, s68, 20480
    s_nop 0
    buffer_load_dwordx4 v60, s[44:47], s50 offen offset:0  lds
    buffer_load_dwordx4 v61, s[44:47], s50 offen offset:1024  lds
    buffer_load_dwordx4 v62, s[44:47], s50 offen offset:2048  lds
    buffer_load_dwordx4 v63, s[44:47], s50 offen offset:3072  lds
    s_nop 0
L_back_w2:
    s_waitcnt vmcnt(0)
    s_barrier
    s_barrier
    s_add_u32 s50, s58, 1572864
    s_cmp_ge_u32 s50, s59
    s_cselect_b32 s48, 4718592, 0
    s_sub_u32 s50, s50, s48
    s_add_u32 m0, s68, 0
    s_nop 0
    buffer_load_dwordx4 v56, s[44:47], s50 offen offset:0  lds
    buffer_load_dwordx4 v57, s[44:47], s50 offen offset:1024  lds
    buffer_load_dwordx4 v58, s[44:47], s50 offen offset:2048  lds
    buffer_load_dwordx4 v59, s[44:47], s50 offen offset:3072  lds
    s_add_u32 m0, s68, 4096
    s_nop 0
    buffer_load_dwordx4 v60, s[44:47], s50 offen offset:0  lds
    buffer_load_dwordx4 v61, s[44:47], s50 offen offset:1024  lds
    buffer_load_dwordx4 v62, s[44:47], s50 offen offset:2048  lds
    buffer_load_dwordx4 v63, s[44:47], s50 offen offset:3072  lds
    s_barrier
    s_add_u32 s50, s58, 1835008
    s_cmp_ge_u32 s50, s59
    s_cselect_b32 s48, 4718592, 0
    s_sub_u32 s50, s50, s48
    s_add_u32 m0, s68, 16384
    s_nop 0
    buffer_load_dwordx4 v56, s[44:47], s50 offen offset:0  lds
    buffer_load_dwordx4 v57, s[44:47], s50 offen offset:1024  lds
    buffer_load_dwordx4 v58, s[44:47], s50 offen offset:2048  lds
    buffer_load_dwordx4 v59, s[44:47], s50 offen offset:3072  lds
    s_add_u32 m0, s68, 20480
    s_nop 0
    buffer_load_dwordx4 v60, s[44:47], s50 offen offset:0  lds
    buffer_load_dwordx4 v61, s[44:47], s50 offen offset:1024  lds
    buffer_load_dwordx4 v62, s[44:47], s50 offen offset:2048  lds
    buffer_load_dwordx4 v63, s[44:47], s50 offen offset:3072  lds
    s_add_u32 s50, s58, 2097152
    s_cmp_ge_u32 s50, s59
    s_cselect_b32 s48, 4718592, 0
    s_sub_u32 s50, s50, s48
    s_add_u32 m0, s68, 32768
    s_nop 0
    buffer_load_dwordx4 v56, s[44:47], s50 offen offset:0  lds
    buffer_load_dwordx4 v57, s[44:47], s50 offen offset:1024  lds
    buffer_load_dwordx4 v58, s[44:47], s50 offen offset:2048  lds
    buffer_load_dwordx4 v59, s[44:47], s50 offen offset:3072  lds
    s_add_u32 m0, s68, 36864
    s_nop 0
    buffer_load_dwordx4 v60, s[44:47], s50 offen offset:0  lds
    buffer_load_dwordx4 v61, s[44:47], s50 offen offset:1024  lds
    buffer_load_dwordx4 v62, s[44:47], s50 offen offset:2048  lds
    buffer_load_dwordx4 v63, s[44:47], s50 offen offset:3072  lds
    s_add_u32 s50, s58, 2359296
    s_cmp_ge_u32 s50, s59
    s_cselect_b32 s48, 4718592, 0
    s_sub_u32 s50, s50, s48
    s_add_u32 m0, s68, 49152
    s_nop 0
    buffer_load_dwordx4 v56, s[44:47], s50 offen offset:0  lds
    buffer_load_dwordx4 v57, s[44:47], s50 offen offset:1024  lds
    buffer_load_dwordx4 v58, s[44:47], s50 offen offset:2048  lds
    buffer_load_dwordx4 v59, s[44:47], s50 offen offset:3072  lds
    s_add_u32 m0, s68, 53248
    s_nop 0
    buffer_load_dwordx4 v60, s[44:47], s50 offen offset:0  lds
    buffer_load_dwordx4 v61, s[44:47], s50 offen offset:1024  lds
    buffer_load_dwordx4 v62, s[44:47], s50 offen offset:2048  lds
    buffer_load_dwordx4 v63, s[44:47], s50 offen offset:3072  lds
    v_mov_b64 v[100:101], -1
    v_mov_b64 v[102:103], -1
    v_mov_b32 v104, v3
    v_mov_b32 v105, v3
    v_mov_b32 v106, v3
    v_mov_b32 v107, v3
    v_lshlrev_b32 v110, 4, v0
    s_lshl_b32 s48, s2, 7
    s_add_u32 s48, s48, 38797312
    v_add_u32 v108, s48, v110
    s_cmp_eq_u32 s62, 0
    s_cselect_b32 s48, 8, 0
    v_cmp_gt_u32 vcc, s48, v0
    v_mov_b32 v109, 2146435072
    s_nop 0
    v_cndmask_b32 v108, v109, v108, vcc
    v_min_u32 v109, 2, v0
    v_add_u32 v109, 1, v109
    v_lshlrev_b32 v109, 1, v109
    v_xor_b32 v109, s2, v109
    v_lshlrev_b32 v109, 7, v109
    v_add_u32 v109, 38797312, v109
    v_lshlrev_b32 v111, 4, v0
    s_mul_i32 s56, s2, 27648
    s_lshl_b32 s48, s62, 10
    s_add_u32 s56, s56, s48
    s_add_u32 s56, s56, 27262976
    s_waitcnt vmcnt(24)
    s_barrier
    s_add_u32 s50, s58, 2621440
    s_cmp_ge_u32 s50, s59
    s_cselect_b32 s48, 4718592, 0
    s_sub_u32 s50, s50, s48
    s_add_u32 m0, s68, 65536
    s_nop 0
    buffer_load_dwordx4 v56, s[44:47], s50 offen offset:0  lds
    buffer_load_dwordx4 v57, s[44:47], s50 offen offset:1024  lds
    buffer_load_dwordx4 v58, s[44:47], s50 offen offset:2048  lds
    buffer_load_dwordx4 v59, s[44:47], s50 offen offset:3072  lds
    s_waitcnt vmcnt(20)
    s_barrier
    s_add_u32 m0, s68, 69632
    s_nop 0
    buffer_load_dwordx4 v60, s[44:47], s50 offen offset:0  lds
    buffer_load_dwordx4 v61, s[44:47], s50 offen offset:1024  lds
    buffer_load_dwordx4 v62, s[44:47], s50 offen offset:2048  lds
    buffer_load_dwordx4 v63, s[44:47], s50 offen offset:3072  lds
    s_waitcnt vmcnt(16)
    s_barrier
    s_add_u32 s57, s56, 0
    buffer_store_dwordx4 v[100:103], v111, s[36:39], s57 offen sc1
    s_add_u32 s50, s58, 2883584
    s_cmp_ge_u32 s50, s59
    s_cselect_b32 s48, 4718592, 0
    s_sub_u32 s50, s50, s48
    s_add_u32 m0, s68, 0
    s_nop 0
    buffer_load_dwordx4 v56, s[44:47], s50 offen offset:0  lds
    buffer_load_dwordx4 v57, s[44:47], s50 offen offset:1024  lds
    buffer_load_dwordx4 v58, s[44:47], s50 offen offset:2048  lds
    buffer_load_dwordx4 v59, s[44:47], s50 offen offset:3072  lds
    s_waitcnt vmcnt(13)
    s_barrier
    s_add_u32 s57, s56, 2048
    buffer_store_dwordx4 v[100:103], v111, s[36:39], s57 offen sc1
    s_add_u32 s57, s56, 4096
    buffer_store_dwordx4 v[100:103], v111, s[36:39], s57 offen sc1
    s_add_u32 m0, s68, 4096
    s_nop 0
    buffer_load_dwordx4 v60, s[44:47], s50 offen offset:0  lds
    buffer_load_dwordx4 v61, s[44:47], s50 offen offset:1024  lds
    buffer_load_dwordx4 v62, s[44:47], s50 offen offset:2048  lds
    buffer_load_dwordx4 v63, s[44:47], s50 offen offset:3072  lds
    s_barrier
    s_add_u32 s57, s56, 6144
    buffer_store_dwordx4 v[100:103], v111, s[36:39], s57 offen sc1
    s_add_u32 s57, s56, 8192
    buffer_store_dwordx4 v[100:103], v111, s[36:39], s57 offen sc1
    s_add_u32 s50, s58, 3145728
    s_cmp_ge_u32 s50, s59
    s_cselect_b32 s48, 4718592, 0
    s_sub_u32 s50, s50, s48
    s_add_u32 m0, s68, 16384
    s_nop 0
    buffer_load_dwordx4 v56, s[44:47], s50 offen offset:0  lds
    buffer_load_dwordx4 v57, s[44:47], s50 offen offset:1024  lds
    buffer_load_dwordx4 v58, s[44:47], s50 offen offset:2048  lds
    buffer_load_dwordx4 v59, s[44:47], s50 offen offset:3072  lds
    s_waitcnt vmcnt(17)
    s_barrier
    s_add_u32 s57, s56, 10240
    buffer_store_dwordx4 v[100:103], v111, s[36:39], s57 offen sc1
    s_add_u32 s57, s56, 12288
    buffer_store_dwordx4 v[100:103], v111, s[36:39], s57 offen sc1
    s_add_u32 m0, s68, 20480
    s_nop 0
    buffer_load_dwordx4 v60, s[44:47], s50 offen offset:0  lds
    buffer_load_dwordx4 v61, s[44:47], s50 offen offset:1024  lds
    buffer_load_dwordx4 v62, s[44:47], s50 offen offset:2048  lds
    buffer_load_dwordx4 v63, s[44:47], s50 offen offset:3072  lds
    s_barrier
    s_add_u32 s57, s56, 14336
    buffer_store_dwordx4 v[100:103], v111, s[36:39], s57 offen sc1
    s_add_u32 s50, s58, 3407872
    s_cmp_ge_u32 s50, s59
    s_cselect_b32 s48, 4718592, 0
    s_sub_u32 s50, s50, s48
    s_add_u32 m0, s68, 32768
    s_nop 0
    buffer_load_dwordx4 v56, s[44:47], s50 offen offset:0  lds
    buffer_load_dwordx4 v57, s[44:47], s50 offen offset:1024  lds
    buffer_load_dwordx4 v58, s[44:47], s50 offen offset:2048  lds
    buffer_load_dwordx4 v59, s[44:47], s50 offen offset:3072  lds
    s_waitcnt vmcnt(17)
    s_barrier
    s_add_u32 s57, s56, 16384
    buffer_store_dwordx4 v[100:103], v111, s[36:39], s57 offen sc1
    s_add_u32 s57, s56, 18432
    buffer_store_dwordx4 v[100:103], v111, s[36:39], s57 offen sc1
    s_add_u32 m0, s68, 36864
    s_nop 0
    buffer_load_dwordx4 v60, s[44:47], s50 offen offset:0  lds
    buffer_load_dwordx4 v61, s[44:47], s50 offen offset:1024  lds
    buffer_load_dwordx4 v62, s[44:47], s50 offen offset:2048  lds
    buffer_load_dwordx4 v63, s[44:47], s50 offen offset:3072  lds
    s_barrier
    s_add_u32 s57, s56, 20480
    buffer_store_dwordx4 v[100:103], v111, s[36:39], s57 offen sc1
    s_add_u32 s57, s56, 22528
    buffer_store_dwordx4 v[100:103], v111, s[36:39], s57 offen sc1
    s_add_u32 s50, s58, 3670016
    s_cmp_ge_u32 s50, s59
    s_cselect_b32 s48, 4718592, 0
    s_sub_u32 s50, s50, s48
    s_add_u32 m0, s68, 49152
    s_nop 0
    buffer_load_dwordx4 v56, s[44:47], s50 offen offset:0  lds
    buffer_load_dwordx4 v57, s[44:47], s50 offen offset:1024  lds
    buffer_load_dwordx4 v58, s[44:47], s50 offen offset:2048  lds
    buffer_load_dwordx4 v59, s[44:47], s50 offen offset:3072  lds
    s_waitcnt vmcnt(17)
    s_barrier
    s_add_u32 s57, s56, 24576
    buffer_store_dwordx4 v[100:103], v111, s[36:39], s57 offen sc1
    s_mul_i32 s57, s62, -2048
    s_add_u32 s57, s57, 26624
    s_add_u32 s57, s57, s56
    buffer_store_dwordx4 v[100:103], v111, s[36:39], s57 offen sc1
    s_add_u32 m0, s68, 53248
    s_nop 0
    buffer_load_dwordx4 v60, s[44:47], s50 offen offset:0  lds
    buffer_load_dwordx4 v61, s[44:47], s50 offen offset:1024  lds
    buffer_load_dwordx4 v62, s[44:47], s50 offen offset:2048  lds
    buffer_load_dwordx4 v63, s[44:47], s50 offen offset:3072  lds
    s_barrier
    s_add_u32 s50, s58, 3932160
    s_cmp_ge_u32 s50, s59
    s_cselect_b32 s48, 4718592, 0
    s_sub_u32 s50, s50, s48
    s_add_u32 m0, s68, 65536
    s_nop 0
    buffer_load_dwordx4 v56, s[44:47], s50 offen offset:0  lds
    buffer_load_dwordx4 v57, s[44:47], s50 offen offset:1024  lds
    buffer_load_dwordx4 v58, s[44:47], s50 offen offset:2048  lds
    buffer_load_dwordx4 v59, s[44:47], s50 offen offset:3072  lds
    s_barrier
    s_add_u32 m0, s68, 69632
    s_nop 0
    buffer_load_dwordx4 v60, s[44:47], s50 offen offset:0  lds
    buffer_load_dwordx4 v61, s[44:47], s50 offen offset:1024  lds
    buffer_load_dwordx4 v62, s[44:47], s50 offen offset:2048  lds
    buffer_load_dwordx4 v63, s[44:47], s50 offen offset:3072  lds
    s_waitcnt vmcnt(12)
    s_barrier
    buffer_store_dwordx4 v[104:107], v108, s[36:39], 0 offen sc1
    s_add_u32 s50, s58, 4194304
    s_cmp_ge_u32 s50, s59
    s_cselect_b32 s48, 4718592, 0
    s_sub_u32 s50, s50, s48
    s_add_u32 m0, s68, 0
    s_nop 0
    buffer_load_dwordx4 v56, s[44:47], s50 offen offset:0  lds
    buffer_load_dwordx4 v57, s[44:47], s50 offen offset:1024  lds
    buffer_load_dwordx4 v58, s[44:47], s50 offen offset:2048  lds
    buffer_load_dwordx4 v59, s[44:47], s50 offen offset:3072  lds
    s_waitcnt vmcnt(25)
    s_barrier
    s_add_u32 m0, s68, 4096
    s_nop 0
    buffer_load_dwordx4 v60, s[44:47], s50 offen offset:0  lds
    buffer_load_dwordx4 v61, s[44:47], s50 offen offset:1024  lds
    buffer_load_dwordx4 v62, s[44:47], s50 offen offset:2048  lds
    buffer_load_dwordx4 v63, s[44:47], s50 offen offset:3072  lds
    s_waitcnt vmcnt(17)
    s_barrier
    s_add_u32 s50, s58, 4456448
    s_cmp_ge_u32 s50, s59
    s_cselect_b32 s48, 4718592, 0
    s_sub_u32 s50, s50, s48
    s_add_u32 m0, s68, 16384
    s_nop 0
    buffer_load_dwordx4 v56, s[44:47], s50 offen offset:0  lds
    buffer_load_dwordx4 v57, s[44:47], s50 offen offset:1024  lds
    buffer_load_dwordx4 v58, s[44:47], s50 offen offset:2048  lds
    buffer_load_dwordx4 v59, s[44:47], s50 offen offset:3072  lds
    s_waitcnt vmcnt(13)
    s_barrier
    buffer_load_dword v110, v109, s[36:39], 0 offen sc1
    s_add_u32 m0, s68, 20480
    s_nop 0
    buffer_load_dwordx4 v60, s[44:47], s50 offen offset:0  lds
    buffer_load_dwordx4 v61, s[44:47], s50 offen offset:1024  lds
    buffer_load_dwordx4 v62, s[44:47], s50 offen offset:2048  lds
    buffer_load_dwordx4 v63, s[44:47], s50 offen offset:3072  lds
    s_waitcnt vmcnt(9)
    s_barrier
    s_waitcnt vmcnt(0)
    s_waitcnt vmcnt(4)
    v_cmp_ne_u32 vcc, v3, v110
    s_nop 0
    s_cbranch_vccz L_m_105
Lp_m_106:
    buffer_load_dword v110, v109, s[36:39], 0 offen sc1
    s_waitcnt vmcnt(0)
    v_cmp_ne_u32 vcc, v3, v110
    s_nop 0
    s_cbranch_vccz Le_m_107
    s_sub_u32 s7, s7, 1
    s_cbranch_scc1 Le_m_107
    s_mov_b64 exec, vcc
    s_sleep 1
    s_branch Lp_m_106
Le_m_107:
    s_mov_b64 exec, -1
    s_max_i32 s7, s7, 0
L_m_105:
    s_barrier
    s_barrier
L_m_100:
    v_lshlrev_b32 v100, 4, v0
    v_lshlrev_b32 v101, 2, v0
    s_mul_i32 s48, s3, 2304
    s_mul_i32 s60, s2, 27648
    s_add_u32 s60, s60, s48
    s_add_u32 s60, s60, 27272192
    s_add_u32 s61, s60, 9216
    s_mul_i32 s63, s3, 4608
    s_add_u32 s63, s63, 49152
    v_add_u32 v102, s63, v100
    v_add_u32 v103, s63, v101
Lp_m_108:
    s_add_u32 m0, s63, 2304
    s_nop 0
    buffer_load_dwordx4 v100, s[36:39], s61 offen sc1 lds
    buffer_load_dwordx4 v100, s[36:39], s61 offen offset:1024 sc1 lds
    buffer_load_dword v101, s[36:39], s61 offen offset:2048 sc1 lds
    s_add_u32 m0, s63, 0
    s_nop 0
    buffer_load_dwordx4 v100, s[36:39], s60 offen sc1 lds
    buffer_load_dwordx4 v100, s[36:39], s60 offen offset:1024 sc1 lds
    buffer_load_dword v101, s[36:39], s60 offen offset:2048 sc1 lds
    s_waitcnt vmcnt(0)
    ds_read_b32 v104, v102 offset:0
    ds_read_b32 v105, v102 offset:1024
    ds_read_b32 v106, v103 offset:2048
    ds_read_b32 v107, v102 offset:2304
    ds_read_b32 v108, v102 offset:3328
    ds_read_b32 v109, v103 offset:4352
    s_waitcnt lgkmcnt(3)
    v_max3_u32 v110, v104, v105, v106
    s_waitcnt lgkmcnt(2)
    v_max_u32 v110, v110, v107
    s_waitcnt lgkmcnt(1)
    v_max_u32 v110, v110, v108
    s_waitcnt lgkmcnt(0)
    v_max_u32 v110, v110, v109
    v_cmp_eq_u32 vcc, -1, v110
    s_nop 0
    s_cbranch_vccz Le_m_109
    s_sub_u32 s7, s7, 1
    s_cbranch_scc1 Le_m_109
    s_sleep 1
    s_branch Lp_m_108
Le_m_109:
    s_max_i32 s7, s7, 0
    s_barrier
L_end:
L_exit:
    s_endpgm
L_code_end:
.section .rodata,"a"
.p2align 6
.amdhsa_kernel adaLN_cond__spectral_gfnet__mixer_token_mlp__prompt_kernel
  .amdhsa_next_free_vgpr 256
  .amdhsa_next_free_sgpr 70
  .amdhsa_accum_offset 256
  .amdhsa_group_segment_fixed_size 0
  .amdhsa_kernarg_size 104
  .amdhsa_user_sgpr_count 2
  .amdhsa_user_sgpr_kernarg_segment_ptr 1
  .amdhsa_system_sgpr_workgroup_id_x 1
.end_amdhsa_kernel
```

```asm
; @launch grid=(256,1,1) block=(512,1,1) lds=163840
.amdgcn_target "amdgcn-amd-amdhsa--gfx950"
.text
.globl adaLN_cond__spectral_gfnet__mixer_token_mlp__prompt_kernel
.p2align 8
.type adaLN_cond__spectral_gfnet__mixer_token_mlp__prompt_kernel,@function
adaLN_cond__spectral_gfnet__mixer_token_mlp__prompt_kernel:
    s_cmp_ge_u32 s2, 256
    s_cbranch_scc1 L_exit
    s_load_dwordx16 s[8:23], s[0:1], 0
    s_load_dwordx8 s[24:31], s[0:1], 64
    s_load_dwordx2 s[32:33], s[0:1], 96
    v_readfirstlane_b32 s4, v0
    s_lshr_b32 s5, s2, 3
    s_lshr_b32 s4, s4, 6
    s_cmp_lg_u32 s4, s5
    s_cbranch_scc1 L_nopf
    s_getpc_b64 s[52:53]
L_pc:
    s_sub_u32 s52, s52, L_pc-adaLN_cond__spectral_gfnet__mixer_token_mlp__prompt_kernel
    s_subb_u32 s53, s53, 0
    s_mov_b32 s54, L_code_end-adaLN_cond__spectral_gfnet__mixer_token_mlp__prompt_kernel
    s_mov_b32 s55, 0x20000
    v_lshlrev_b32 v1, 7, v0
    buffer_load_dword v255, v1, s[52:55], 0 offen
    v_add_u32 v1, 65536, v1
    buffer_load_dword v255, v1, s[52:55], 0 offen
L_nopf:
    v_lshrrev_b32 v1, 6, v0
    v_and_b32 v0, 63, v0
    v_readfirstlane_b32 s34, v1
    v_and_b32 v1, 15, v0
    v_lshrrev_b32 v2, 4, v0
    s_and_b32 s4, s2, 7
    s_lshr_b32 s5, s2, 3
    s_lshl_b32 s6, s4, 5
    s_add_u32 s6, s6, s5
    s_mov_b32 s7, 100000
    s_and_b32 s3, s34, 3
    s_cmp_ge_u32 s34, 4
    s_cbranch_scc0 L_C
L_H:
    v_lshlrev_b32 v16, 4, v0
    v_mov_b32 v30, 2146435072
    v_mov_b32 v12, 2146435072
    v_mov_b32 v18, 2146435072
    s_sub_u32 s63, 255, s2
    s_mul_i32 s62, s63, 171
    s_lshr_b32 s62, s62, 9
    s_mul_i32 s48, s62, 3
    s_sub_u32 s61, s63, s48
    s_cmp_ge_u32 s63, 54
    s_cbranch_scc1 L_m_30
    v_lshrrev_b32 v4, 3, v0
    v_and_b32 v5, 7, v0
    v_and_b32 v6, 6, v4
    v_xor_b32 v5, v5, v6
    v_mul_u32_u24 v4, 6912, v4
    v_lshl_add_u32 v12, v5, 4, v4
    s_lshl_b32 s48, s61, 2
    s_add_u32 s48, s48, s3
    s_mul_i32 s48, s48, 331776
    s_lshl_b32 s49, s62, 7
    s_add_u32 s47, s48, s49
    s_lshl_b32 s50, s3, 8
    v_lshl_add_u32 v27, v0, 2, s50
    s_mul_i32 s49, s61, 384
    v_add_u32 v9, s49, v27
    v_add_u32 v12, s47, v12
    s_waitcnt lgkmcnt(0)
    s_mov_b32 s40, s26
    s_mov_b32 s41, s27
    s_mov_b32 s42, 3981312
    s_mov_b32 s43, 0x20000
    s_mul_i32 m0, s3, 6144
    s_mov_b32 s59, 0
    buffer_load_dwordx4 v12, s[40:43], s59 offen lds
    s_add_u32 m0, m0, 1024
    s_add_u32 s59, s59, 55296
    buffer_load_dwordx4 v12, s[40:43], s59 offen lds
    s_add_u32 m0, m0, 1024
    s_add_u32 s59, s59, 55296
    buffer_load_dwordx4 v12, s[40:43], s59 offen lds
    s_add_u32 m0, m0, 1024
    s_add_u32 s59, s59, 55296
    buffer_load_dwordx4 v12, s[40:43], s59 offen lds
    s_add_u32 m0, m0, 1024
    s_add_u32 s59, s59, 55296
    buffer_load_dwordx4 v12, s[40:43], s59 offen lds
    s_add_u32 m0, m0, 1024
    s_add_u32 s59, s59, 55296
    buffer_load_dwordx4 v12, s[40:43], s59 offen lds
    s_mov_b32 s44, s24
    s_mov_b32 s45, s25
    s_mov_b32 s46, 1152
    s_mov_b32 s47, 0x20000
    buffer_load_dword v26, v9, s[44:47], 0 offen
    s_mov_b32 s36, s32
    s_mov_b32 s37, s33
    s_mov_b32 s38, 50331648
    s_mov_b32 s39, 0x20000
    v_mov_b32 v7, 32768
    buffer_load_dword v3, v7, s[36:39], 0 offen sc1
    v_lshrrev_b32 v4, 2, v0
    v_bfe_u32 v5, v4, 1, 2
    v_xor_b32 v5, s3, v5
    v_lshlrev_b32 v5, 5, v5
    v_lshlrev_b32 v4, 7, v4
    v_and_b32 v6, 3, v0
    v_lshlrev_b32 v6, 3, v6
    v_add3_u32 v28, v4, v5, v6
    v_lshlrev_b32 v29, 3, v2
    v_add_u32 v29, 90112, v29
    s_mul_i32 s48, s3, 3456
    s_mul_i32 s49, s61, 1152
    s_add_u32 s48, s48, s49
    s_lshl_b32 s49, s62, 6
    s_add_u32 s48, s48, s49
    s_add_u32 s48, s48, 15204352
    v_mul_u32_u24 v4, 13824, v2
    v_lshl_add_u32 v4, v1, 2, v4
    v_add_u32 v30, s48, v4
    v_add_u32 v31, 55296, v30
    v_mov_b32 v5, 0
    s_mov_b32 s48, 0
    buffer_store_dword v5, v30, s[36:39], s48 offen sc1
    buffer_store_dword v5, v31, s[36:39], s48 offen sc1
    s_lshr_b32 s51, s5, 2
    s_lshl_b32 s51, s51, 3
    s_add_u32 s51, s51, s4
    s_and_b32 s60, s5, 3
    s_lshl_b32 s35, s51, 2
    s_add_u32 s35, s35, s60
    s_lshl_b32 s35, s35, 14
    s_bfe_u32 s48, s6, 0x20002
    s_lshl_b32 s48, s48, 6
    s_lshr_b32 s49, s6, 4
    s_lshl_b32 s49, s49, 2
    s_add_u32 s48, s48, s49
    s_and_b32 s49, s6, 3
    s_add_u32 s48, s48, s49
    s_lshl_b32 s48, s48, 4
    s_lshl_b32 s49, s3, 16
    s_add_u32 s48, s48, s49
    s_add_u32 s48, s48, 15728640
    v_mov_b32 v17, 2146435072
    v_writelane_b32 v17, s48, 0
    s_add_u32 s48, s48, 16384
    s_add_u32 s48, s2, 160
    s_lshl_b32 s48, s48, 7
    s_add_u32 s48, s48, 557056
    s_lshl_b32 s49, s3, 8
    s_add_u32 s49, s49, s5
    s_cmp_lt_u32 s49, 12
    s_cselect_b32 s48, s48, 2146435072
    v_mov_b32 v19, 2146435072
    v_writelane_b32 v19, s48, 0
    s_or_b32 s48, s2, s3
    s_cmp_eq_u32 s48, 0
    s_cselect_b32 s48, 0, 2146435072
    s_add_u32 s48, s48, 32768
    v_writelane_b32 v19, s48, 1
    buffer_load_dword v220, v17, s[36:39], 0 offen
    s_waitcnt vmcnt(3)
    s_setprio 2
    v_lshlrev_b32 v4, 16, v26
    v_and_b32 v5, 0xffff0000, v26
    v_mul_f32 v6, 0xbfb8aa3b, v4
    v_mul_f32 v7, 0xbfb8aa3b, v5
    v_exp_f32 v6, v6
    v_exp_f32 v7, v7
    v_add_f32 v6, 1.0, v6
    v_add_f32 v7, 1.0, v7
    v_rcp_f32 v6, v6
    v_rcp_f32 v7, v7
    v_mul_f32 v4, v4, v6
    v_mul_f32 v5, v5, v7
    v_cvt_pk_bf16_f32 v26, v4, v5
    v_add_u32 v27, 90112, v27
    ds_write_b32 v27, v26
    s_mov_b32 s48, 0x9e3779b1
    v_mul_lo_u32 v3, v3, s48
    v_add_u32 v3, 0x7f4a7c15, v3
    v_or_b32 v3, 0x01010101, v3
    s_waitcnt lgkmcnt(0)
    s_barrier
    ds_read_b64_tr_b16 v[132:133], v28 offset:0
    ds_read_b64_tr_b16 v[134:135], v28 offset:2048
    ds_read2_b64 v[136:139], v29 offset0:0 offset1:4
    ds_read_b64_tr_b16 v[140:141], v28 offset:4096
    ds_read_b64_tr_b16 v[142:143], v28 offset:6144
    ds_read2_b64 v[144:147], v29 offset0:8 offset1:12
    ds_read_b64_tr_b16 v[148:149], v28 offset:8192
    ds_read_b64_tr_b16 v[150:151], v28 offset:10240
    ds_read2_b64 v[152:155], v29 offset0:16 offset1:20
    ds_read_b64_tr_b16 v[156:157], v28 offset:12288
    ds_read_b64_tr_b16 v[158:159], v28 offset:14336
    ds_read2_b64 v[160:163], v29 offset0:24 offset1:28
    ds_read_b64_tr_b16 v[164:165], v28 offset:16384
    ds_read_b64_tr_b16 v[166:167], v28 offset:18432
    ds_read2_b64 v[168:171], v29 offset0:32 offset1:36
    ds_read_b64_tr_b16 v[172:173], v28 offset:20480
    ds_read_b64_tr_b16 v[174:175], v28 offset:22528
    ds_read2_b64 v[176:179], v29 offset0:40 offset1:44
    v_and_b32 v4, 3, v1
    v_or_b32 v4, 0x07060500, v4
    s_waitcnt lgkmcnt(14)
    v_mfma_f32_16x16x32_bf16 v[36:39], v[136:139], v[132:135], 0
    s_waitcnt lgkmcnt(12)
    v_mfma_f32_16x16x32_bf16 v[36:39], v[144:147], v[140:143], v[36:39]
    s_waitcnt lgkmcnt(9)
    v_mfma_f32_16x16x32_bf16 v[36:39], v[152:155], v[148:151], v[36:39]
    s_waitcnt lgkmcnt(6)
    v_mfma_f32_16x16x32_bf16 v[36:39], v[160:163], v[156:159], v[36:39]
    s_waitcnt lgkmcnt(3)
    v_mfma_f32_16x16x32_bf16 v[36:39], v[168:171], v[164:167], v[36:39]
    s_waitcnt lgkmcnt(0)
    v_mfma_f32_16x16x32_bf16 v[36:39], v[176:179], v[172:175], v[36:39]
    s_nop 7
    v_add_u32 v40, 0x80, v36
    v_perm_b32 v40, v40, v3, v4
    s_waitcnt vmcnt(1)
    s_mov_b32 s48, 0
    buffer_store_dword v40, v30, s[36:39], s48 offen sc1
    buffer_store_dword v40, v31, s[36:39], s48 offen sc1
    s_setprio 0
    s_mov_b32 s63, 999
    s_branch L_m_34
L_C:
    v_lshrrev_b32 v18, 5, v0
    v_and_b32 v19, 31, v0
    v_mul_u32_u24 v20, 294912, v18
    v_lshl_add_u32 v20, v19, 2, v20
    s_mul_i32 s62, s3, 589824
    s_mul_i32 s48, s6, 1152
    s_add_u32 s62, s62, s48
    s_waitcnt lgkmcnt(0)
    s_mov_b32 s40, s8
    s_mov_b32 s41, s9
    s_mov_b32 s42, 2359296
    s_mov_b32 s43, 0x20000
    buffer_load_dword v9, v20, s[40:43], s62 offen offset:0
    buffer_load_dword v10, v20, s[40:43], s62 offen offset:128
    buffer_load_dword v11, v20, s[40:43], s62 offen offset:256
    buffer_load_dword v12, v20, s[40:43], s62 offen offset:384
    buffer_load_dword v13, v20, s[40:43], s62 offen offset:512
    buffer_load_dword v14, v20, s[40:43], s62 offen offset:640
    buffer_load_dword v15, v20, s[40:43], s62 offen offset:768
    buffer_load_dword v16, v20, s[40:43], s62 offen offset:896
    buffer_load_dword v17, v20, s[40:43], s62 offen offset:1024
    s_mov_b32 s36, s32
    s_mov_b32 s37, s33
    s_mov_b32 s38, 50331648
    s_mov_b32 s39, 0x20000
    v_mov_b32 v21, 32768
    buffer_load_dword v3, v21, s[36:39], 0 offen sc1
    s_mul_i32 s52, s4, 27
    s_add_u32 s52, s52, s5
    s_mul_i32 s51, s52, 171
    s_lshr_b32 s51, s51, 10
    s_mul_i32 s48, s51, 6
    s_sub_u32 s52, s52, s48
    s_lshr_b32 s53, s4, 1
    s_and_b32 s54, s4, 1
    s_lshl_b32 s54, s54, 3
    s_lshr_b32 s48, s5, 2
    s_add_u32 s54, s54, s48
    s_and_b32 s55, s5, 3
    s_mov_b32 s44, s18
    s_mov_b32 s45, s19
    s_mov_b32 s46, 9216
    s_mov_b32 s47, 0x20000
    s_mov_b32 s64, s22
    s_mov_b32 s65, s23
    s_mov_b32 s66, 4096
    s_mov_b32 s67, 0x20000
    s_lshl_b32 s48, s51, 8
    s_lshl_b32 s49, s3, 6
    s_add_u32 s48, s48, s49
    v_lshl_add_u32 v22, v2, 3, s48
    buffer_load_dwordx2 v[4:5], v22, s[44:47], 0 offen
    buffer_load_dwordx2 v[6:7], v22, s[44:47], 0 offen offset:32
    s_lshl_b32 s48, s54, 8
    s_add_u32 s48, s48, s49
    s_lshr_b32 s49, s53, 1
    s_lshl_b32 s49, s49, 5
    s_add_u32 s48, s48, s49
    v_lshl_add_u32 v23, v1, 1, s48
    buffer_load_ushort v8, v23, s[64:67], 0 offen
    s_bfe_u32 s56, s6, 0x10002
    s_lshl_b32 s56, s56, 7
    s_lshr_b32 s57, s6, 3
    s_lshl_b32 s57, s57, 2
    s_add_u32 s56, s56, s57
    s_and_b32 s57, s6, 3
    s_add_u32 s56, s56, s57
    s_lshl_b32 s48, s56, 4
    s_lshl_b32 s49, s3, 16
    s_add_u32 s48, s48, s49
    s_add_u32 s48, s48, 16252928
    v_mov_b32 v24, 2146435072
    v_writelane_b32 v24, s48, 0
    s_add_u32 s48, s48, 16384
    s_lshl_b32 s56, s52, 6
    s_add_u32 s56, s56, s51
    s_lshl_b32 s48, s56, 4
    s_lshl_b32 s49, s3, 16
    s_add_u32 s48, s48, s49
    s_add_u32 s48, s48, 16515072
    v_mov_b32 v25, 2146435072
    v_writelane_b32 v25, s48, 0
    s_add_u32 s48, s48, 16384
    s_add_u32 s48, s2, 216
    s_lshl_b32 s48, s48, 7
    s_add_u32 s48, s48, 622592
    s_lshl_b32 s49, s3, 8
    s_add_u32 s49, s49, s5
    s_cmp_lt_u32 s49, 5
    s_cselect_b32 s48, s48, 2146435072
    v_writelane_b32 v25, s48, 8
    buffer_load_dword v90, v24, s[36:39], 0 offen
    buffer_load_dword v91, v25, s[36:39], 0 offen
    s_branch L_aligned
.p2align 12
L_aligned:
    v_lshlrev_b32 v36, 4, v0
    v_mul_u32_u24 v148, 1184, v18
    v_lshl_add_u32 v148, v19, 2, v148
    s_mul_i32 s48, s3, 2368
    s_add_u32 s48, s48, 100352
    v_add_u32 v148, s48, v148
    v_lshrrev_b32 v220, 1, v1
    v_and_b32 v221, 1, v1
    v_and_b32 v222, 1, v220
    v_cvt_f32_u32 v220, v220
    v_cvt_f32_u32 v221, v221
    v_mul_f32 v220, 0x3e000000, v220
    v_mul_f32 v221, 0x3e800000, v221
    v_mul_u32_u24 v222, 0x8000, v222
    v_lshl_or_b32 v222, v222, 16, v222
    s_lshl_b32 s48, s3, 10
    s_add_u32 s48, s48, 109952
    v_add_u32 v223, s48, v36
    s_mov_b32 s63, 0x3de38e39
    s_add_u32 s48, s3, 0
    s_mul_i32 s49, s48, 43
    s_lshr_b32 s49, s49, 7
    s_mul_i32 s50, s49, 3
    s_sub_u32 s50, s48, s50
    s_lshl_b32 s50, s50, 2
    v_add_u32 v224, s50, v2
    v_cmp_gt_u32 vcc, 9, v224
    v_mul_u32_u24 v224, s49, v224
    v_cvt_f32_u32 v224, v224
    v_fma_f32 v224, v224, s63, v221
    v_add_f32 v225, v224, v220
    v_fma_f32 v226, v220, 2.0, v224
    v_add_f32 v227, v226, v220
    v_cos_f32 v224, v224
    v_cos_f32 v225, v225
    v_cos_f32 v226, v226
    v_cos_f32 v227, v227
    v_cvt_pk_bf16_f32 v232, v224, v225
    v_cvt_pk_bf16_f32 v233, v226, v227
    v_cndmask_b32 v232, 0, v232, vcc
    v_cndmask_b32 v233, 0, v233, vcc
    v_xor_b32 v234, v222, v232
    v_xor_b32 v235, v222, v233
    ds_write_b128 v223, v[232:235] offset:0
    s_add_u32 s48, s3, 4
    s_mul_i32 s49, s48, 43
    s_lshr_b32 s49, s49, 7
    s_mul_i32 s50, s49, 3
    s_sub_u32 s50, s48, s50
    s_lshl_b32 s50, s50, 2
    v_add_u32 v224, s50, v2
    v_cmp_gt_u32 vcc, 9, v224
    v_mul_u32_u24 v224, s49, v224
    v_cvt_f32_u32 v224, v224
    v_fma_f32 v224, v224, s63, v221
    v_add_f32 v225, v224, v220
    v_fma_f32 v226, v220, 2.0, v224
    v_add_f32 v227, v226, v220
    v_cos_f32 v224, v224
    v_cos_f32 v225, v225
    v_cos_f32 v226, v226
    v_cos_f32 v227, v227
    v_cvt_pk_bf16_f32 v236, v224, v225
    v_cvt_pk_bf16_f32 v237, v226, v227
    v_cndmask_b32 v236, 0, v236, vcc
    v_cndmask_b32 v237, 0, v237, vcc
    v_xor_b32 v238, v222, v236
    v_xor_b32 v239, v222, v237
    ds_write_b128 v223, v[236:239] offset:4096
    s_add_u32 s48, s3, 8
    s_mul_i32 s49, s48, 43
    s_lshr_b32 s49, s49, 7
    s_mul_i32 s50, s49, 3
    s_sub_u32 s50, s48, s50
    s_lshl_b32 s50, s50, 2
    v_add_u32 v224, s50, v2
    v_cmp_gt_u32 vcc, 9, v224
    v_mul_u32_u24 v224, s49, v224
    v_cvt_f32_u32 v224, v224
    v_fma_f32 v224, v224, s63, v221
    v_add_f32 v225, v224, v220
    v_fma_f32 v226, v220, 2.0, v224
    v_add_f32 v227, v226, v220
    v_cos_f32 v224, v224
    v_cos_f32 v225, v225
    v_cos_f32 v226, v226
    v_cos_f32 v227, v227
    v_cvt_pk_bf16_f32 v232, v224, v225
    v_cvt_pk_bf16_f32 v233, v226, v227
    v_cndmask_b32 v232, 0, v232, vcc
    v_cndmask_b32 v233, 0, v233, vcc
    v_xor_b32 v234, v222, v232
    v_xor_b32 v235, v222, v233
    ds_write_b128 v223, v[232:235] offset:8192
    s_add_u32 s48, s3, 12
    s_mul_i32 s49, s48, 43
    s_lshr_b32 s49, s49, 7
    s_mul_i32 s50, s49, 3
    s_sub_u32 s50, s48, s50
    s_lshl_b32 s50, s50, 2
    v_add_u32 v224, s50, v2
    v_cmp_gt_u32 vcc, 9, v224
    v_mul_u32_u24 v224, s49, v224
    v_cvt_f32_u32 v224, v224
    v_fma_f32 v224, v224, s63, v221
    v_add_f32 v225, v224, v220
    v_fma_f32 v226, v220, 2.0, v224
    v_add_f32 v227, v226, v220
    v_cos_f32 v224, v224
    v_cos_f32 v225, v225
    v_cos_f32 v226, v226
    v_cos_f32 v227, v227
    v_cvt_pk_bf16_f32 v236, v224, v225
    v_cvt_pk_bf16_f32 v237, v226, v227
    v_cndmask_b32 v236, 0, v236, vcc
    v_cndmask_b32 v237, 0, v237, vcc
    v_xor_b32 v238, v222, v236
    v_xor_b32 v239, v222, v237
    ds_write_b128 v223, v[236:239] offset:12288
    v_lshrrev_b32 v22, 5, v0
    v_lshlrev_b32 v22, 2, v22
    s_lshl_b32 s48, s3, 3
    s_add_u32 s48, s48, 109824
    v_add_u32 v22, s48, v22
    v_bfe_u32 v18, v0, 2, 2
    v_mul_u32_u24 v18, 1184, v18
    v_and_b32 v19, 3, v0
    v_lshl_add_u32 v18, v19, 3, v18
    s_lshl_b32 s48, s3, 5
    s_add_u32 s48, s48, 100352
    v_add_u32 v19, s48, v18
    v_lshl_add_u32 v18, v2, 7, v19
    v_mov_b32 v20, 109824
    v_add_u32 v21, 109952, v36
    s_waitcnt vmcnt(14)
    ds_write_b32 v148, v9 offset:0
    v_lshlrev_b32 v106, 16, v9
    v_and_b32 v107, 0xffff0000, v9
    s_waitcnt vmcnt(13)
    ds_write_b32 v148, v10 offset:128
    v_lshlrev_b32 v108, 16, v10
    v_and_b32 v109, 0xffff0000, v10
    s_waitcnt vmcnt(12)
    ds_write_b32 v148, v11 offset:256
    v_lshlrev_b32 v110, 16, v11
    v_and_b32 v111, 0xffff0000, v11
    s_waitcnt vmcnt(11)
    ds_write_b32 v148, v12 offset:384
    v_lshlrev_b32 v112, 16, v12
    v_and_b32 v113, 0xffff0000, v12
    s_waitcnt vmcnt(10)
    ds_write_b32 v148, v13 offset:512
    v_lshlrev_b32 v114, 16, v13
    v_and_b32 v115, 0xffff0000, v13
    s_waitcnt vmcnt(9)
    ds_write_b32 v148, v14 offset:640
    v_lshlrev_b32 v116, 16, v14
    v_and_b32 v117, 0xffff0000, v14
    s_waitcnt vmcnt(8)
    ds_write_b32 v148, v15 offset:768
    v_lshlrev_b32 v118, 16, v15
    v_and_b32 v119, 0xffff0000, v15
    s_waitcnt vmcnt(7)
    ds_write_b32 v148, v16 offset:896
    v_lshlrev_b32 v120, 16, v16
    v_and_b32 v121, 0xffff0000, v16
    s_waitcnt vmcnt(6)
    ds_write_b32 v148, v17 offset:1024
    v_lshlrev_b32 v122, 16, v17
    v_and_b32 v123, 0xffff0000, v17
    v_pk_add_f32 v[24:25], v[106:107], v[108:109]
    v_pk_mul_f32 v[26:27], v[106:107], v[106:107]
    v_pk_fma_f32 v[26:27], v[108:109], v[108:109], v[26:27]
    v_pk_add_f32 v[24:25], v[24:25], v[110:111]
    v_pk_fma_f32 v[26:27], v[110:111], v[110:111], v[26:27]
    v_pk_add_f32 v[24:25], v[24:25], v[112:113]
    v_pk_fma_f32 v[26:27], v[112:113], v[112:113], v[26:27]
    v_pk_add_f32 v[24:25], v[24:25], v[114:115]
    v_pk_fma_f32 v[26:27], v[114:115], v[114:115], v[26:27]
    v_pk_add_f32 v[24:25], v[24:25], v[116:117]
    v_pk_fma_f32 v[26:27], v[116:117], v[116:117], v[26:27]
    v_pk_add_f32 v[24:25], v[24:25], v[118:119]
    v_pk_fma_f32 v[26:27], v[118:119], v[118:119], v[26:27]
    v_pk_add_f32 v[24:25], v[24:25], v[120:121]
    v_pk_fma_f32 v[26:27], v[120:121], v[120:121], v[26:27]
    v_pk_add_f32 v[24:25], v[24:25], v[122:123]
    v_pk_fma_f32 v[26:27], v[122:123], v[122:123], v[26:27]
    v_add_f32 v24, v24, v25
    v_add_f32 v25, v26, v27
    s_nop 0
    v_add_f32_dpp v24, v24, v24 quad_perm:[1,0,3,2] row_mask:0xf bank_mask:0xf
    v_add_f32_dpp v25, v25, v25 quad_perm:[1,0,3,2] row_mask:0xf bank_mask:0xf
    s_nop 0
    v_add_f32_dpp v24, v24, v24 quad_perm:[2,3,0,1] row_mask:0xf bank_mask:0xf
    v_add_f32_dpp v25, v25, v25 quad_perm:[2,3,0,1] row_mask:0xf bank_mask:0xf
    s_nop 0
    v_add_f32_dpp v24, v24, v24 row_half_mirror row_mask:0xf bank_mask:0xf
    v_add_f32_dpp v25, v25, v25 row_half_mirror row_mask:0xf bank_mask:0xf
    s_nop 0
    v_add_f32_dpp v24, v24, v24 row_mirror row_mask:0xf bank_mask:0xf
    v_add_f32_dpp v25, v25, v25 row_mirror row_mask:0xf bank_mask:0xf
    v_mov_b32 v26, v24
    v_mov_b32 v27, v25
    s_nop 0
    v_permlane16_swap_b32 v24, v26
    v_permlane16_swap_b32 v25, v27
    v_add_f32 v24, v24, v26
    v_add_f32 v25, v25, v27
    v_mul_f32 v24, 0xbae38e39, v24
    v_mul_f32 v25, 0x3ae38e39, v25
    v_fma_f32 v25, -v24, v24, v25
    v_max_f32 v25, 0, v25
    v_add_f32 v25, 0x3727c5ac, v25
    v_rsq_f32 v26, v25
    s_nop 0
    v_mul_f32 v24, v24, v26
    ds_write_b32 v22, v26
    ds_write_b32 v22, v24 offset:32
    s_waitcnt lgkmcnt(0)
    s_barrier
    ds_read_b128 v[132:135], v20 offset:0
    ds_read_b128 v[136:139], v20 offset:16
    ds_read_b128 v[140:143], v20 offset:32
    ds_read_b128 v[144:147], v20 offset:48
    ds_read_b64_tr_b16 v[148:149], v18 offset:0
    ds_read_b64_tr_b16 v[150:151], v18 offset:4736
    ds_read_b64_tr_b16 v[152:153], v18 offset:512
    ds_read_b64_tr_b16 v[154:155], v18 offset:5248
    ds_read_b64_tr_b16 v[156:157], v19 offset:1024
    ds_read_b64_tr_b16 v[158:159], v19 offset:5760
    ds_read_b128 v[160:163], v21 offset:0
    ds_read_b128 v[164:167], v21 offset:1024
    ds_read_b128 v[168:171], v21 offset:2048
    ds_read_b128 v[172:175], v21 offset:3072
    ds_read_b128 v[176:179], v21 offset:4096
    ds_read_b128 v[180:183], v21 offset:5120
    ds_read_b128 v[184:187], v21 offset:6144
    ds_read_b128 v[188:191], v21 offset:7168
    ds_read_b128 v[192:195], v21 offset:8192
    ds_read_b128 v[196:199], v21 offset:9216
    ds_read_b128 v[200:203], v21 offset:10240
    ds_read_b128 v[204:207], v21 offset:11264
    ds_read_b128 v[208:211], v21 offset:12288
    ds_read_b128 v[212:215], v21 offset:13312
    ds_read_b128 v[216:219], v21 offset:14336
    s_lshl_b32 s48, s3, 4
    v_add_u32 v24, s48, v1
    v_cvt_f32_u32 v24, v24
    v_mul_f32 v24, 0x3c800000, v24
    v_cvt_f32_u32 v26, v2
    v_mul_f32 v26, 4.0, v26
    v_mul_f32 v25, v26, v24
    v_cos_f32 v19, v25
    v_sin_f32 v20, v25
    s_nop 0
    v_cvt_pk_bf16_f32 v40, v19, v20
    v_cvt_pk_bf16_f32 v44, -v20, v19
    v_fma_f32 v21, v24, 1.0, v25
    v_cos_f32 v22, v21
    v_sin_f32 v23, v21
    s_nop 0
    v_cvt_pk_bf16_f32 v41, v22, v23
    v_cvt_pk_bf16_f32 v45, -v23, v22
    v_fma_f32 v18, v24, 2.0, v25
    v_cos_f32 v19, v18
    v_sin_f32 v20, v18
    s_nop 0
    v_cvt_pk_bf16_f32 v42, v19, v20
    v_cvt_pk_bf16_f32 v46, -v20, v19
    v_add_f32 v21, v18, v24
    v_cos_f32 v22, v21
    v_sin_f32 v23, v21
    s_nop 0
    v_cvt_pk_bf16_f32 v43, v22, v23
    v_cvt_pk_bf16_f32 v47, -v23, v22
    v_add_f32 v26, 0x41800000, v26
    v_mul_f32 v25, v26, v24
    v_cos_f32 v19, v25
    v_sin_f32 v20, v25
    s_nop 0
    v_cvt_pk_bf16_f32 v48, v19, v20
    v_cvt_pk_bf16_f32 v52, -v20, v19
    v_fma_f32 v21, v24, 1.0, v25
    v_cos_f32 v22, v21
    v_sin_f32 v23, v21
    s_nop 0
    v_cvt_pk_bf16_f32 v49, v22, v23
    v_cvt_pk_bf16_f32 v53, -v23, v22
    v_fma_f32 v18, v24, 2.0, v25
    v_cos_f32 v19, v18
    v_sin_f32 v20, v18
    s_nop 0
    v_cvt_pk_bf16_f32 v50, v19, v20
    v_cvt_pk_bf16_f32 v54, -v20, v19
    v_add_f32 v21, v18, v24
    v_cos_f32 v22, v21
    v_sin_f32 v23, v21
    s_nop 0
    v_cvt_pk_bf16_f32 v51, v22, v23
    v_cvt_pk_bf16_f32 v55, -v23, v22
    v_add_f32 v26, 0x41800000, v26
    v_mul_f32 v25, v26, v24
    v_cos_f32 v19, v25
    v_sin_f32 v20, v25
    s_nop 0
    v_cvt_pk_bf16_f32 v56, v19, v20
    v_cvt_pk_bf16_f32 v60, -v20, v19
    v_fma_f32 v21, v24, 1.0, v25
    v_cos_f32 v22, v21
    v_sin_f32 v23, v21
    s_nop 0
    v_cvt_pk_bf16_f32 v57, v22, v23
    v_cvt_pk_bf16_f32 v61, -v23, v22
    v_fma_f32 v18, v24, 2.0, v25
    v_cos_f32 v19, v18
    v_sin_f32 v20, v18
    s_nop 0
    v_cvt_pk_bf16_f32 v58, v19, v20
    v_cvt_pk_bf16_f32 v62, -v20, v19
    v_add_f32 v21, v18, v24
    v_cos_f32 v22, v21
    v_sin_f32 v23, v21
    s_nop 0
    v_cvt_pk_bf16_f32 v59, v22, v23
    v_cvt_pk_bf16_f32 v63, -v23, v22
    v_add_f32 v26, 0x41800000, v26
    v_mul_f32 v25, v26, v24
    v_cos_f32 v19, v25
    v_sin_f32 v20, v25
    s_nop 0
    v_cvt_pk_bf16_f32 v64, v19, v20
    v_cvt_pk_bf16_f32 v68, -v20, v19
    v_fma_f32 v21, v24, 1.0, v25
    v_cos_f32 v22, v21
    v_sin_f32 v23, v21
    s_nop 0
    v_cvt_pk_bf16_f32 v65, v22, v23
    v_cvt_pk_bf16_f32 v69, -v23, v22
    v_fma_f32 v18, v24, 2.0, v25
    v_cos_f32 v19, v18
    v_sin_f32 v20, v18
    s_nop 0
    v_cvt_pk_bf16_f32 v66, v19, v20
    v_cvt_pk_bf16_f32 v70, -v20, v19
    v_add_f32 v21, v18, v24
    v_cos_f32 v22, v21
    v_sin_f32 v23, v21
    s_nop 0
    v_cvt_pk_bf16_f32 v67, v22, v23
    v_cvt_pk_bf16_f32 v71, -v23, v22
    v_mul_f32 v37, 0x3de38e39, v24
    v_mul_f32 v22, 0x3f800000, v37
    v_cos_f32 v98, v22
    v_sin_f32 v99, v22
    v_mul_f32 v22, 0x40000000, v37
    v_cos_f32 v100, v22
    v_sin_f32 v101, v22
    v_mul_f32 v22, 0x40400000, v37
    v_cos_f32 v102, v22
    v_sin_f32 v103, v22
    v_mul_f32 v22, 0x40800000, v37
    v_cos_f32 v104, v22
    v_sin_f32 v105, v22
L_m_1:
    s_waitcnt lgkmcnt(14)
    v_lshlrev_b32 v106, 16, v148
    v_and_b32 v107, 0xffff0000, v148
    v_pk_fma_f32 v[106:107], v[106:107], v[132:133], v[140:141]
    v_lshlrev_b32 v108, 16, v149
    v_and_b32 v109, 0xffff0000, v149
    v_pk_fma_f32 v[108:109], v[108:109], v[134:135], v[142:143]
    v_lshlrev_b32 v110, 16, v150
    v_and_b32 v111, 0xffff0000, v150
    v_pk_fma_f32 v[110:111], v[110:111], v[136:137], v[144:145]
    v_lshlrev_b32 v112, 16, v151
    v_and_b32 v113, 0xffff0000, v151
    v_pk_fma_f32 v[112:113], v[112:113], v[138:139], v[146:147]
    v_lshlrev_b32 v114, 16, v152
    v_and_b32 v115, 0xffff0000, v152
    v_pk_fma_f32 v[114:115], v[114:115], v[132:133], v[140:141]
    v_lshlrev_b32 v116, 16, v153
    v_and_b32 v117, 0xffff0000, v153
    v_pk_fma_f32 v[116:117], v[116:117], v[134:135], v[142:143]
    v_lshlrev_b32 v118, 16, v154
    v_and_b32 v119, 0xffff0000, v154
    v_pk_fma_f32 v[118:119], v[118:119], v[136:137], v[144:145]
    v_lshlrev_b32 v120, 16, v155
    v_and_b32 v121, 0xffff0000, v155
    v_pk_fma_f32 v[120:121], v[120:121], v[138:139], v[146:147]
    v_lshlrev_b32 v122, 16, v156
    v_and_b32 v123, 0xffff0000, v156
    v_pk_fma_f32 v[122:123], v[122:123], v[132:133], v[140:141]
    v_lshlrev_b32 v124, 16, v157
    v_and_b32 v125, 0xffff0000, v157
    v_pk_fma_f32 v[124:125], v[124:125], v[134:135], v[142:143]
    v_lshlrev_b32 v126, 16, v158
    v_and_b32 v127, 0xffff0000, v158
    v_pk_fma_f32 v[126:127], v[126:127], v[136:137], v[144:145]
    v_lshlrev_b32 v128, 16, v159
    v_and_b32 v129, 0xffff0000, v159
    v_pk_fma_f32 v[128:129], v[128:129], v[138:139], v[146:147]
    s_waitcnt lgkmcnt(0)
    s_cmp_ge_u32 s2, 202
    s_cbranch_scc1 L_m_2
    v_and_b32 v220, 7, v1
    v_cvt_f32_u32 v220, v220
    v_mul_f32 v220, 0x3e000000, v220
    v_and_b32 v221, 1, v2
    v_cvt_f32_u32 v221, v221
    v_mul_f32 v221, 4.0, v221
    v_mul_f32 v221, v221, v220
    v_lshrrev_b32 v222, 3, v1
    v_lshrrev_b32 v223, 1, v2
    s_lshl_b32 s48, s3, 10
    s_add_u32 s48, s48, 147456
    v_add_u32 v224, s48, v36
    s_add_u32 s48, s3, 0
    s_mul_i32 s49, s48, 43
    s_lshr_b32 s49, s49, 7
    s_mul_i32 s50, s49, 3
    s_sub_u32 s50, s48, s50
    s_lshl_b32 s50, s50, 1
    s_lshl_b32 s49, s49, 1
    v_add_u32 v225, s49, v222
    v_add_u32 v226, s50, v223
    v_cmp_gt_u32 vcc, 9, v225
    v_cmp_gt_u32 s[48:49], 5, v226
    v_mul_u32_u24 v225, v225, v226
    v_cvt_f32_u32 v225, v225
    s_and_b64 vcc, vcc, s[48:49]
    v_fma_f32 v225, v225, s63, v221
    v_cos_f32 v226, v225
    v_sin_f32 v227, v225
    s_nop 0
    v_cvt_pk_bf16_f32 v232, v226, -v227
    v_add_f32 v225, v225, v220
    v_cos_f32 v228, v225
    v_sin_f32 v229, v225
    s_nop 0
    v_cvt_pk_bf16_f32 v233, v228, -v229
    v_add_f32 v225, v225, v220
    v_cos_f32 v226, v225
    v_sin_f32 v227, v225
    s_nop 0
    v_cvt_pk_bf16_f32 v234, v226, -v227
    v_add_f32 v225, v225, v220
    v_cos_f32 v228, v225
    v_sin_f32 v229, v225
    s_nop 0
    v_cvt_pk_bf16_f32 v235, v228, -v229
    v_cndmask_b32 v232, 0, v232, vcc
    v_cndmask_b32 v233, 0, v233, vcc
    v_cndmask_b32 v234, 0, v234, vcc
    v_cndmask_b32 v235, 0, v235, vcc
    ds_write_b128 v224, v[232:235] offset:0
    s_add_u32 s48, s3, 4
    s_mul_i32 s49, s48, 43
    s_lshr_b32 s49, s49, 7
    s_mul_i32 s50, s49, 3
    s_sub_u32 s50, s48, s50
    s_lshl_b32 s50, s50, 1
    s_lshl_b32 s49, s49, 1
    v_add_u32 v225, s49, v222
    v_add_u32 v226, s50, v223
    v_cmp_gt_u32 vcc, 9, v225
    v_cmp_gt_u32 s[48:49], 5, v226
    v_mul_u32_u24 v225, v225, v226
    v_cvt_f32_u32 v225, v225
    s_and_b64 vcc, vcc, s[48:49]
    v_fma_f32 v225, v225, s63, v221
    v_cos_f32 v226, v225
    v_sin_f32 v227, v225
    s_nop 0
    v_cvt_pk_bf16_f32 v236, v226, -v227
    v_add_f32 v225, v225, v220
    v_cos_f32 v228, v225
    v_sin_f32 v229, v225
    s_nop 0
    v_cvt_pk_bf16_f32 v237, v228, -v229
    v_add_f32 v225, v225, v220
    v_cos_f32 v226, v225
    v_sin_f32 v227, v225
    s_nop 0
    v_cvt_pk_bf16_f32 v238, v226, -v227
    v_add_f32 v225, v225, v220
    v_cos_f32 v228, v225
    v_sin_f32 v229, v225
    s_nop 0
    v_cvt_pk_bf16_f32 v239, v228, -v229
    v_cndmask_b32 v236, 0, v236, vcc
    v_cndmask_b32 v237, 0, v237, vcc
    v_cndmask_b32 v238, 0, v238, vcc
    v_cndmask_b32 v239, 0, v239, vcc
    ds_write_b128 v224, v[236:239] offset:4096
    s_add_u32 s48, s3, 8
    s_mul_i32 s49, s48, 43
    s_lshr_b32 s49, s49, 7
    s_mul_i32 s50, s49, 3
    s_sub_u32 s50, s48, s50
    s_lshl_b32 s50, s50, 1
    s_lshl_b32 s49, s49, 1
    v_add_u32 v225, s49, v222
    v_add_u32 v226, s50, v223
    v_cmp_gt_u32 vcc, 9, v225
    v_cmp_gt_u32 s[48:49], 5, v226
    v_mul_u32_u24 v225, v225, v226
    v_cvt_f32_u32 v225, v225
    s_and_b64 vcc, vcc, s[48:49]
    v_fma_f32 v225, v225, s63, v221
    v_cos_f32 v226, v225
    v_sin_f32 v227, v225
    s_nop 0
    v_cvt_pk_bf16_f32 v232, v226, -v227
    v_add_f32 v225, v225, v220
    v_cos_f32 v228, v225
    v_sin_f32 v229, v225
    s_nop 0
    v_cvt_pk_bf16_f32 v233, v228, -v229
    v_add_f32 v225, v225, v220
    v_cos_f32 v226, v225
    v_sin_f32 v227, v225
    s_nop 0
    v_cvt_pk_bf16_f32 v234, v226, -v227
    v_add_f32 v225, v225, v220
    v_cos_f32 v228, v225
    v_sin_f32 v229, v225
    s_nop 0
    v_cvt_pk_bf16_f32 v235, v228, -v229
    v_cndmask_b32 v232, 0, v232, vcc
    v_cndmask_b32 v233, 0, v233, vcc
    v_cndmask_b32 v234, 0, v234, vcc
    v_cndmask_b32 v235, 0, v235, vcc
    ds_write_b128 v224, v[232:235] offset:8192
    s_add_u32 s48, s3, 12
    s_mul_i32 s49, s48, 43
    s_lshr_b32 s49, s49, 7
    s_mul_i32 s50, s49, 3
    s_sub_u32 s50, s48, s50
    s_lshl_b32 s50, s50, 1
    s_lshl_b32 s49, s49, 1
    v_add_u32 v225, s49, v222
    v_add_u32 v226, s50, v223
    v_cmp_gt_u32 vcc, 9, v225
    v_cmp_gt_u32 s[48:49], 5, v226
    v_mul_u32_u24 v225, v225, v226
    v_cvt_f32_u32 v225, v225
    s_and_b64 vcc, vcc, s[48:49]
    v_fma_f32 v225, v225, s63, v221
    v_cos_f32 v226, v225
    v_sin_f32 v227, v225
    s_nop 0
    v_cvt_pk_bf16_f32 v236, v226, -v227
    v_add_f32 v225, v225, v220
    v_cos_f32 v228, v225
    v_sin_f32 v229, v225
    s_nop 0
    v_cvt_pk_bf16_f32 v237, v228, -v229
    v_add_f32 v225, v225, v220
    v_cos_f32 v226, v225
    v_sin_f32 v227, v225
    s_nop 0
    v_cvt_pk_bf16_f32 v238, v226, -v227
    v_add_f32 v225, v225, v220
    v_cos_f32 v228, v225
    v_sin_f32 v229, v225
    s_nop 0
    v_cvt_pk_bf16_f32 v239, v228, -v229
    v_cndmask_b32 v236, 0, v236, vcc
    v_cndmask_b32 v237, 0, v237, vcc
    v_cndmask_b32 v238, 0, v238, vcc
    v_cndmask_b32 v239, 0, v239, vcc
    ds_write_b128 v224, v[236:239] offset:12288
L_m_2:
    v_lshrrev_b32 v22, 1, v2
    v_cvt_f32_u32 v22, v22
    v_add_f32 v23, 1.0, v22
    v_mul_f32 v23, 0x35638e39, v23
    v_mul_f32 v24, v22, v37
    v_cos_f32 v25, v24
    v_sin_f32 v26, v24
    v_mul_f32 v30, v23, v25
    v_mul_f32 v31, v23, v26
    v_add_f32 v22, 2.0, v22
    v_mul_f32 v24, v22, v37
    v_cos_f32 v25, v24
    v_sin_f32 v26, v24
    v_mul_f32 v32, 0x35e38e39, v25
    v_mul_f32 v33, 0x35e38e39, v26
    v_add_f32 v22, 2.0, v22
    v_mul_f32 v24, v22, v37
    v_cos_f32 v25, v24
    v_sin_f32 v26, v24
    v_mul_f32 v34, 0x35e38e39, v25
    v_mul_f32 v35, 0x35e38e39, v26
    s_mov_b32 s48, 0x9e3779b1
    s_waitcnt vmcnt(5)
    v_mul_lo_u32 v3, v3, s48
    v_add_u32 v3, 0x7f4a7c15, v3
    v_or_b32 v3, 0x01010101, v3
    s_lshl_b32 s48, s3, 6
    s_add_u32 s48, s48, 126336
    v_mul_u32_u24 v18, 576, v2
    v_lshl_add_u32 v18, v1, 2, v18
    v_add_u32 v18, s48, v18
    v_mul_u32_u24 v19, 288, v1
    v_lshl_add_u32 v19, v2, 4, v19
    v_add_u32 v19, 126336, v19
    v_bfe_u32 v27, v1, 1, 2
    v_xor_b32 v27, v27, v2
    v_lshl_add_u32 v27, v1, 2, v27
    s_mul_i32 s48, s3, 3072
    s_add_u32 s48, s48, 77824
    v_lshl_add_u32 v27, v27, 4, s48
    v_add_u32 v28, s48, v36
    v_lshrrev_b32 v20, 3, v0
    v_xor_b32 v20, v20, v0
    v_and_b32 v20, 3, v20
    v_lshlrev_b32 v20, 4, v20
    v_lshrrev_b32 v21, 2, v0
    v_lshl_add_u32 v20, v21, 16, v20
    s_lshl_b32 s48, s3, 14
    s_lshl_b32 s49, s6, 6
    s_add_u32 s48, s48, s49
    s_add_u32 s48, s48, 4194304
    v_add_u32 v20, s48, v20
    v_add_u32 v21, 1048576, v20
    v_add_u32 v22, 2097152, v20
    v_cmp_gt_u32 vcc, 32, v0
    v_mov_b32 v23, 2146435072
    s_nop 0
    v_cndmask_b32 v22, v23, v22, vcc
    s_lshl_b32 s58, s3, 12
    s_add_u32 s58, s58, 61440
    v_lshl_add_u32 v93, v1, 2, s58
    s_waitcnt vmcnt(1)
    v_lshl_add_u32 v90, v2, 6, v93
    v_add_u32 v93, 512, v93
    s_waitcnt vmcnt(0)
    v_add_u32 v91, 1152, v90
    v_add_u32 v92, 2304, v90
    v_add_u32 v94, 1152, v93
    v_add_u32 v95, 2304, v93
    v_cmp_gt_u32 vcc, 24, v0
    s_nop 1
    v_cndmask_b32 v96, v23, v36, vcc
    s_mul_i32 s59, s4, 13824
    s_mul_i32 s48, s3, 3456
    s_add_u32 s59, s59, s48
    s_add_u32 s59, s59, 15204352
    v_min_u32 v97, 496, v36
    s_mul_i32 s48, s3, 2560
    s_mul_i32 s60, s6, 10240
    s_add_u32 s60, s60, s48
    s_add_u32 s60, s60, 8388608
    v_mov_b64 v[144:145], -1
    v_mov_b64 v[146:147], -1
    v_and_b32 v24, 3, v1
    v_lshlrev_b32 v24, 3, v24
    v_bfe_u32 v24, v3, v24, 8
    s_mov_b32 m0, s58
    s_branch L_stub_1
L_back_c1:
    s_waitcnt vmcnt(0) lgkmcnt(0)
Lp_m_3:
    buffer_load_dwordx4 v36, s[36:39], s59 offen offset:0 sc1 lds
    buffer_load_dwordx4 v36, s[36:39], s59 offen offset:1024 sc1 lds
    buffer_load_dwordx4 v36, s[36:39], s59 offen offset:2048 sc1 lds
    buffer_load_dwordx4 v96, s[36:39], s59 offen offset:3072 sc1 lds
    s_waitcnt vmcnt(0)
    ds_read2_b32 v[72:73], v90 offset0:0 offset1:144
    ds_read2_b32 v[74:75], v90 offset0:64 offset1:208
    ds_read2_b32 v[76:77], v93 offset0:0 offset1:144
    ds_read2_b32 v[78:79], v91 offset0:0 offset1:144
    ds_read2_b32 v[80:81], v91 offset0:64 offset1:208
    ds_read2_b32 v[82:83], v94 offset0:0 offset1:144
    ds_read2_b32 v[84:85], v92 offset0:0 offset1:144
    ds_read2_b32 v[86:87], v92 offset0:64 offset1:208
    ds_read2_b32 v[88:89], v95 offset0:0 offset1:144
    s_waitcnt lgkmcnt(8)
    v_xor_b32 v72, v72, v24
    v_xor_b32 v73, v73, v24
    v_or_b32 v26, v72, v73
    s_waitcnt lgkmcnt(7)
    v_xor_b32 v74, v74, v24
    v_xor_b32 v75, v75, v24
    v_or3_b32 v26, v74, v75, v26
    s_waitcnt lgkmcnt(6)
    v_xor_b32 v76, v76, v24
    v_xor_b32 v77, v77, v24
    v_or3_b32 v26, v76, v77, v26
    s_waitcnt lgkmcnt(5)
    v_xor_b32 v78, v78, v24
    v_xor_b32 v79, v79, v24
    v_or3_b32 v26, v78, v79, v26
    s_waitcnt lgkmcnt(4)
    v_xor_b32 v80, v80, v24
    v_xor_b32 v81, v81, v24
    v_or3_b32 v26, v80, v81, v26
    s_waitcnt lgkmcnt(3)
    v_xor_b32 v82, v82, v24
    v_xor_b32 v83, v83, v24
    v_or3_b32 v26, v82, v83, v26
    s_waitcnt lgkmcnt(2)
    v_xor_b32 v84, v84, v24
    v_xor_b32 v85, v85, v24
    v_or3_b32 v26, v84, v85, v26
    s_waitcnt lgkmcnt(1)
    v_xor_b32 v86, v86, v24
    v_xor_b32 v87, v87, v24
    v_or3_b32 v26, v86, v87, v26
    s_waitcnt lgkmcnt(0)
    v_xor_b32 v88, v88, v24
    v_xor_b32 v89, v89, v24
    v_or3_b32 v26, v88, v89, v26
    v_and_b32 v26, 0xff, v26
    v_cmp_ne_u32 vcc, 0, v26
    s_nop 0
    s_cbranch_vccz Le_m_4
    s_sub_u32 s7, s7, 1
    s_cbranch_scc1 Le_m_4
    s_sleep 1
    s_branch Lp_m_3
Le_m_4:
    s_max_i32 s7, s7, 0
    buffer_store_dwordx4 v[144:147], v36, s[36:39], s60 offen offset:0 sc1
    buffer_store_dwordx4 v[144:147], v36, s[36:39], s60 offen offset:1024 sc1
    buffer_store_dwordx4 v[144:147], v97, s[36:39], s60 offen offset:2048 sc1
    v_pk_add_f32 v[72:73], v[72:73], v[78:79]
    v_pk_add_f32 v[74:75], v[74:75], v[80:81]
    v_pk_add_f32 v[76:77], v[76:77], v[82:83]
    v_pk_add_f32 v[72:73], v[72:73], v[84:85]
    v_pk_add_f32 v[74:75], v[74:75], v[86:87]
    v_pk_add_f32 v[76:77], v[76:77], v[88:89]
    v_cvt_pk_bf16_f32 v78, v72, v73
    v_and_b32 v73, 0xffff0000, v78
    v_add_f32 v73, 1.0, v73
    v_lshlrev_b32 v72, 16, v78
    v_cvt_pk_bf16_f32 v73, 0, v73
    v_pk_fma_f32 v[106:107], v[106:107], v[72:73], v[72:73] op_sel:[0,1,0] op_sel_hi:[1,1,0]
    s_branch L_skip_1
L_stub_1:
    s_branch L_stub_2
L_skip_1:
    v_pk_fma_f32 v[108:109], v[108:109], v[72:73], v[72:73] op_sel:[0,1,0] op_sel_hi:[1,1,0]
    v_pk_fma_f32 v[110:111], v[110:111], v[72:73], v[72:73] op_sel:[0,1,0] op_sel_hi:[1,1,0]
    v_pk_fma_f32 v[112:113], v[112:113], v[72:73], v[72:73] op_sel:[0,1,0] op_sel_hi:[1,1,0]
    v_cvt_pk_bf16_f32 v148, v106, v107
    v_cvt_pk_bf16_f32 v149, v108, v109
    v_cvt_pk_bf16_f32 v150, v110, v111
    v_cvt_pk_bf16_f32 v151, v112, v113
    v_cvt_pk_bf16_f32 v80, v74, v75
    v_and_b32 v75, 0xffff0000, v80
    v_add_f32 v75, 1.0, v75
    v_lshlrev_b32 v74, 16, v80
    v_cvt_pk_bf16_f32 v75, 0, v75
    v_pk_fma_f32 v[114:115], v[114:115], v[74:75], v[74:75] op_sel:[0,1,0] op_sel_hi:[1,1,0]
    v_pk_fma_f32 v[116:117], v[116:117], v[74:75], v[74:75] op_sel:[0,1,0] op_sel_hi:[1,1,0]
    v_pk_fma_f32 v[118:119], v[118:119], v[74:75], v[74:75] op_sel:[0,1,0] op_sel_hi:[1,1,0]
    v_pk_fma_f32 v[120:121], v[120:121], v[74:75], v[74:75] op_sel:[0,1,0] op_sel_hi:[1,1,0]
    v_cvt_pk_bf16_f32 v152, v114, v115
    v_cvt_pk_bf16_f32 v153, v116, v117
    v_cvt_pk_bf16_f32 v154, v118, v119
    v_cvt_pk_bf16_f32 v155, v120, v121
    v_cvt_pk_bf16_f32 v82, v76, v77
    v_and_b32 v77, 0xffff0000, v82
    v_add_f32 v77, 1.0, v77
    v_lshlrev_b32 v76, 16, v82
    v_cvt_pk_bf16_f32 v77, 0, v77
    v_pk_fma_f32 v[122:123], v[122:123], v[76:77], v[76:77] op_sel:[0,1,0] op_sel_hi:[1,1,0]
    v_pk_fma_f32 v[124:125], v[124:125], v[76:77], v[76:77] op_sel:[0,1,0] op_sel_hi:[1,1,0]
    v_pk_fma_f32 v[126:127], v[126:127], v[76:77], v[76:77] op_sel:[0,1,0] op_sel_hi:[1,1,0]
    v_pk_fma_f32 v[128:129], v[128:129], v[76:77], v[76:77] op_sel:[0,1,0] op_sel_hi:[1,1,0]
    v_cvt_pk_bf16_f32 v156, v122, v123
    v_cvt_pk_bf16_f32 v157, v124, v125
    v_cvt_pk_bf16_f32 v158, v126, v127
    v_cvt_pk_bf16_f32 v159, v128, v129
    v_mfma_f32_16x16x32_bf16 v[224:227], v[172:175], v[148:151], 0
    v_mfma_f32_16x16x32_bf16 v[224:227], v[176:179], v[152:155], v[224:227]
    v_mfma_f32_16x16x32_bf16 v[224:227], v[180:183], v[156:159], v[224:227]
    v_mfma_f32_16x16x32_bf16 v[228:231], v[184:187], v[148:151], 0
    v_mfma_f32_16x16x32_bf16 v[228:231], v[188:191], v[152:155], v[228:231]
    v_mfma_f32_16x16x32_bf16 v[228:231], v[192:195], v[156:159], v[228:231]
    v_mfma_f32_16x16x32_bf16 v[232:235], v[196:199], v[148:151], 0
    s_nop 3
    v_mul_f32 v114, v224, v98
    v_mul_f32 v115, v225, v98
    v_mfma_f32_16x16x32_bf16 v[232:235], v[200:203], v[152:155], v[232:235]
    v_fmac_f32 v114, v225, v99
    v_fma_f32 v115, -v224, v99, v115
    v_mfma_f32_16x16x32_bf16 v[232:235], v[204:207], v[156:159], v[232:235]
    v_cvt_pk_bf16_f32 v116, v114, v115
    ds_write_b32 v18, v116 offset:2304
    v_mfma_f32_16x16x32_bf16 v[236:239], v[208:211], v[148:151], 0
    v_mul_f32 v118, v226, v98
    v_mul_f32 v119, v227, v98
    v_mfma_f32_16x16x32_bf16 v[236:239], v[212:215], v[152:155], v[236:239]
    v_fmac_f32 v118, v227, v99
    v_fma_f32 v119, -v226, v99, v119
    v_mfma_f32_16x16x32_bf16 v[236:239], v[216:219], v[156:159], v[236:239]
    v_cvt_pk_bf16_f32 v120, v118, v119
    ds_write_b32 v18, v120 offset:2592
    v_mfma_f32_16x16x32_bf16 v[220:223], v[160:163], v[148:151], 0
    v_mul_f32 v106, v228, v100
    v_mul_f32 v107, v229, v100
    v_mfma_f32_16x16x32_bf16 v[220:223], v[164:167], v[152:155], v[220:223]
    v_fmac_f32 v106, v229, v101
    v_fma_f32 v107, -v228, v101, v107
    v_mfma_f32_16x16x32_bf16 v[220:223], v[168:171], v[156:159], v[220:223]
    v_cvt_pk_bf16_f32 v108, v106, v107
    ds_write_b32 v18, v108 offset:4608
    v_mul_f32 v110, v230, v100
    v_mul_f32 v111, v231, v100
    v_fmac_f32 v110, v231, v101
    v_fma_f32 v111, -v230, v101, v111
    v_cvt_pk_bf16_f32 v112, v110, v111
    ds_write_b32 v18, v112 offset:4896
    v_mul_f32 v114, v232, v102
    v_mul_f32 v115, v233, v102
    v_fmac_f32 v114, v233, v103
    v_fma_f32 v115, -v232, v103, v115
    v_cvt_pk_bf16_f32 v116, v114, v115
    ds_write_b32 v18, v116 offset:6912
    v_mul_f32 v118, v234, v102
    v_mul_f32 v119, v235, v102
    v_fmac_f32 v118, v235, v103
    v_fma_f32 v119, -v234, v103, v119
    v_cvt_pk_bf16_f32 v120, v118, v119
    ds_write_b32 v18, v120 offset:7200
    v_mul_f32 v106, v236, v104
    v_mul_f32 v107, v237, v104
    v_fmac_f32 v106, v237, v105
    v_fma_f32 v107, -v236, v105, v107
    v_cvt_pk_bf16_f32 v108, v106, v107
    ds_write_b32 v18, v108 offset:9216
    v_mul_f32 v110, v238, v104
    v_mul_f32 v111, v239, v104
    v_fmac_f32 v110, v239, v105
    v_fma_f32 v111, -v238, v105, v111
    v_cvt_pk_bf16_f32 v112, v110, v111
    ds_write_b32 v18, v112 offset:9504
    v_cvt_pk_bf16_f32 v108, v220, v221
    ds_write_b32 v18, v108 offset:0
    v_cvt_pk_bf16_f32 v112, v222, v223
    ds_write_b32 v18, v112 offset:288
    s_waitcnt lgkmcnt(0)
    s_barrier
    ds_read_b128 v[160:163], v19 offset:0
    ds_read_b128 v[164:167], v19 offset:64
    ds_read_b128 v[168:171], v19 offset:128
    ds_read_b128 v[172:175], v19 offset:192
    ds_read_b128 v[176:179], v19 offset:4608
    ds_read_b128 v[180:183], v19 offset:4672
    ds_read_b128 v[184:187], v19 offset:4736
    ds_read_b128 v[188:191], v19 offset:4800
    ds_read_b128 v[192:195], v19 offset:9216
    ds_read_b128 v[196:199], v19 offset:9280
    ds_read_b128 v[200:203], v19 offset:9344
    ds_read_b128 v[204:207], v19 offset:9408
    s_waitcnt lgkmcnt(11)
    v_mfma_f32_16x16x32_bf16 v[220:223], v[40:43], v[160:163], 0
    v_mfma_f32_16x16x32_bf16 v[224:227], v[44:47], v[160:163], 0
    s_waitcnt lgkmcnt(10)
    v_mfma_f32_16x16x32_bf16 v[220:223], v[48:51], v[164:167], v[220:223]
    v_mfma_f32_16x16x32_bf16 v[224:227], v[52:55], v[164:167], v[224:227]
    s_waitcnt lgkmcnt(9)
    v_mfma_f32_16x16x32_bf16 v[220:223], v[56:59], v[168:171], v[220:223]
    v_mfma_f32_16x16x32_bf16 v[224:227], v[60:63], v[168:171], v[224:227]
    s_waitcnt lgkmcnt(8)
    v_mfma_f32_16x16x32_bf16 v[220:223], v[64:67], v[172:175], v[220:223]
    v_mfma_f32_16x16x32_bf16 v[224:227], v[68:71], v[172:175], v[224:227]
    s_waitcnt lgkmcnt(7)
    v_mfma_f32_16x16x32_bf16 v[228:231], v[40:43], v[176:179], 0
    v_mfma_f32_16x16x32_bf16 v[232:235], v[44:47], v[176:179], 0
    s_waitcnt lgkmcnt(6)
    v_mfma_f32_16x16x32_bf16 v[228:231], v[48:51], v[180:183], v[228:231]
    v_mfma_f32_16x16x32_bf16 v[232:235], v[52:55], v[180:183], v[232:235]
    s_waitcnt lgkmcnt(5)
    v_mfma_f32_16x16x32_bf16 v[228:231], v[56:59], v[184:187], v[228:231]
    v_cvt_pk_bf16_f32 v148, v220, v224
    v_mfma_f32_16x16x32_bf16 v[232:235], v[60:63], v[184:187], v[232:235]
    v_cvt_pk_bf16_f32 v149, v221, v225
    s_waitcnt lgkmcnt(4)
    v_mfma_f32_16x16x32_bf16 v[228:231], v[64:67], v[188:191], v[228:231]
    v_cvt_pk_bf16_f32 v150, v222, v226
    v_mfma_f32_16x16x32_bf16 v[232:235], v[68:71], v[188:191], v[232:235]
    v_cvt_pk_bf16_f32 v151, v223, v227
    ds_write_b128 v27, v[148:151] offset:0
    ds_read_b128 v[132:135], v28 offset:0
    s_waitcnt lgkmcnt(5)
    v_mfma_f32_16x16x32_bf16 v[236:239], v[40:43], v[192:195], 0
    v_mfma_f32_16x16x32_bf16 v[240:243], v[44:47], v[192:195], 0
    s_waitcnt lgkmcnt(4)
    v_mfma_f32_16x16x32_bf16 v[236:239], v[48:51], v[196:199], v[236:239]
    v_mfma_f32_16x16x32_bf16 v[240:243], v[52:55], v[196:199], v[240:243]
    s_waitcnt lgkmcnt(3)
    v_mfma_f32_16x16x32_bf16 v[236:239], v[56:59], v[200:203], v[236:239]
    v_cvt_pk_bf16_f32 v152, v228, v232
    v_mfma_f32_16x16x32_bf16 v[240:243], v[60:63], v[200:203], v[240:243]
    v_cvt_pk_bf16_f32 v153, v229, v233
    s_waitcnt lgkmcnt(2)
    v_mfma_f32_16x16x32_bf16 v[236:239], v[64:67], v[204:207], v[236:239]
    v_cvt_pk_bf16_f32 v154, v230, v234
    v_mfma_f32_16x16x32_bf16 v[240:243], v[68:71], v[204:207], v[240:243]
    v_cvt_pk_bf16_f32 v155, v231, v235
    ds_write_b128 v27, v[152:155] offset:1024
    ds_read_b128 v[136:139], v28 offset:1024
    s_waitcnt lgkmcnt(2)
    buffer_store_dwordx4 v[132:135], v20, s[36:39], 0 offen sc1
    s_nop 2
    v_cvt_pk_bf16_f32 v156, v236, v240
    v_cvt_pk_bf16_f32 v157, v237, v241
    v_cvt_pk_bf16_f32 v158, v238, v242
    v_cvt_pk_bf16_f32 v159, v239, v243
    ds_write_b128 v27, v[156:159] offset:2048
    ds_read_b128 v[140:143], v28 offset:2048
    s_waitcnt lgkmcnt(2)
    buffer_store_dwordx4 v[136:139], v21, s[36:39], 0 offen sc1
    s_waitcnt lgkmcnt(0)
    buffer_store_dwordx4 v[140:143], v22, s[36:39], 0 offen sc1
    v_lshrrev_b32 v18, 2, v1
    v_and_b32 v18, 2, v18
    v_xor_b32 v18, v18, v2
    v_lshlrev_b32 v18, 4, v18
    v_lshl_add_u32 v18, v1, 8, v18
    v_add_u32 v18, 98304, v18
    v_and_b32 v19, 7, v1
    v_lshlrev_b32 v19, 8, v19
    v_lshl_add_u32 v19, v2, 4, v19
    v_add_u32 v19, 98304, v19
    v_and_b32 v23, 3, v1
    v_xor_b32 v24, 0, v23
    v_lshl_add_u32 v72, v24, 6, v18
    v_lshl_add_u32 v76, v24, 6, v19
    v_xor_b32 v24, 1, v23
    v_lshl_add_u32 v73, v24, 6, v18
    v_lshl_add_u32 v77, v24, 6, v19
    v_xor_b32 v24, 2, v23
    v_lshl_add_u32 v74, v24, 6, v18
    v_lshl_add_u32 v78, v24, 6, v19
    v_xor_b32 v24, 3, v23
    v_lshl_add_u32 v75, v24, 6, v18
    v_lshl_add_u32 v79, v24, 6, v19
    v_and_b32 v18, 7, v1
    v_mul_u32_u24 v18, 2320, v18
    v_lshl_add_u32 v18, v2, 4, v18
    s_lshl_b32 s48, s3, 6
    s_add_u32 s48, s48, 116736
    v_add_u32 v18, s48, v18
    v_lshrrev_b32 v19, 3, v1
    v_lshl_add_u32 v225, v19, 8, v18
    v_cmp_gt_u32 vcc, 8, v1
    v_mov_b32 v23, 133248
    s_nop 0
    v_cndmask_b32 v224, v23, v18, vcc
    v_lshrrev_b32 v23, 5, v0
    s_lshl_b32 s48, s3, 1
    v_add_u32 v23, s48, v23
    v_and_b32 v24, 31, v0
    v_mul_u32_u24 v18, 2320, v23
    v_lshl_add_u32 v18, v24, 3, v18
    v_add_u32 v226, 116736, v18
    v_mul_u32_u24 v18, 1184, v23
    v_lshl_add_u32 v18, v24, 2, v18
    v_add_u32 v227, 135808, v18
    v_mul_u32_u24 v18, 1152, v23
    v_lshl_add_u32 v18, v24, 2, v18
    v_add_u32 v231, 98304, v18
    v_lshlrev_b32 v18, 3, v24
    v_add_u32 v228, 108544, v18
    v_add_u32 v37, 108800, v18
    v_bfe_u32 v18, v0, 2, 2
    v_mul_u32_u24 v18, 1184, v18
    v_and_b32 v19, 3, v0
    v_lshl_add_u32 v18, v19, 3, v18
    v_lshl_add_u32 v18, v2, 5, v18
    s_lshl_b32 s48, s3, 7
    s_add_u32 s48, s48, 135808
    v_add_u32 v229, s48, v18
    v_add_u32 v230, 147456, v36
    v_min_u32 v232, 496, v36
    s_mul_i32 s48, s3, 2560
    s_mul_i32 s66, s6, 10240
    s_add_u32 s66, s66, s48
    s_add_u32 s66, s66, 8388608
    s_add_u32 s48, s48, 98304
    v_add_u32 v233, s48, v36
    v_add_u32 v234, s48, v232
    s_lshr_b32 s48, s4, 1
    s_lshl_b32 s48, s48, 12
    s_mul_i32 s49, s3, 640
    s_add_u32 s48, s48, s49
    s_add_u32 s48, s48, 294912
    v_min_u32 v235, 624, v36
    v_add_u32 v235, s48, v235
    s_waitcnt vmcnt(0)
    s_waitcnt vmcnt(0)
    s_barrier
    s_cmp_lt_u32 s2, 202
    s_cbranch_scc1 L_m_5
    v_and_b32 v188, 7, v1
    v_cvt_f32_u32 v188, v188
    v_mul_f32 v188, 0x3e000000, v188
    v_and_b32 v189, 1, v2
    v_cvt_f32_u32 v189, v189
    v_mul_f32 v189, 4.0, v189
    v_mul_f32 v189, v189, v188
    v_lshrrev_b32 v190, 3, v1
    v_lshrrev_b32 v191, 1, v2
    s_lshl_b32 s48, s3, 10
    s_add_u32 s48, s48, 147456
    v_add_u32 v192, s48, v36
    s_add_u32 s48, s3, 0
    s_mul_i32 s49, s48, 43
    s_lshr_b32 s49, s49, 7
    s_mul_i32 s50, s49, 3
    s_sub_u32 s50, s48, s50
    s_lshl_b32 s50, s50, 1
    s_lshl_b32 s49, s49, 1
    v_add_u32 v193, s49, v190
    v_add_u32 v194, s50, v191
    v_cmp_gt_u32 vcc, 9, v193
    v_cmp_gt_u32 s[48:49], 5, v194
    v_mul_u32_u24 v193, v193, v194
    v_cvt_f32_u32 v193, v193
    s_and_b64 vcc, vcc, s[48:49]
    v_fma_f32 v193, v193, s63, v189
    v_cos_f32 v194, v193
    v_sin_f32 v195, v193
    s_nop 0
    v_cvt_pk_bf16_f32 v200, v194, -v195
    v_add_f32 v193, v193, v188
    v_cos_f32 v196, v193
    v_sin_f32 v197, v193
    s_nop 0
    v_cvt_pk_bf16_f32 v201, v196, -v197
    v_add_f32 v193, v193, v188
    v_cos_f32 v194, v193
    v_sin_f32 v195, v193
    s_nop 0
    v_cvt_pk_bf16_f32 v202, v194, -v195
    v_add_f32 v193, v193, v188
    v_cos_f32 v196, v193
    v_sin_f32 v197, v193
    s_nop 0
    v_cvt_pk_bf16_f32 v203, v196, -v197
    v_cndmask_b32 v200, 0, v200, vcc
    v_cndmask_b32 v201, 0, v201, vcc
    v_cndmask_b32 v202, 0, v202, vcc
    v_cndmask_b32 v203, 0, v203, vcc
    ds_write_b128 v192, v[200:203] offset:0
    s_add_u32 s48, s3, 4
    s_mul_i32 s49, s48, 43
    s_lshr_b32 s49, s49, 7
    s_mul_i32 s50, s49, 3
    s_sub_u32 s50, s48, s50
    s_lshl_b32 s50, s50, 1
    s_lshl_b32 s49, s49, 1
    v_add_u32 v193, s49, v190
    v_add_u32 v194, s50, v191
    v_cmp_gt_u32 vcc, 9, v193
    v_cmp_gt_u32 s[48:49], 5, v194
    v_mul_u32_u24 v193, v193, v194
    v_cvt_f32_u32 v193, v193
    s_and_b64 vcc, vcc, s[48:49]
    v_fma_f32 v193, v193, s63, v189
    v_cos_f32 v194, v193
    v_sin_f32 v195, v193
    s_nop 0
    v_cvt_pk_bf16_f32 v204, v194, -v195
    v_add_f32 v193, v193, v188
    v_cos_f32 v196, v193
    v_sin_f32 v197, v193
    s_nop 0
    v_cvt_pk_bf16_f32 v205, v196, -v197
    v_add_f32 v193, v193, v188
    v_cos_f32 v194, v193
    v_sin_f32 v195, v193
    s_nop 0
    v_cvt_pk_bf16_f32 v206, v194, -v195
    v_add_f32 v193, v193, v188
    v_cos_f32 v196, v193
    v_sin_f32 v197, v193
    s_nop 0
    v_cvt_pk_bf16_f32 v207, v196, -v197
    v_cndmask_b32 v204, 0, v204, vcc
    v_cndmask_b32 v205, 0, v205, vcc
    v_cndmask_b32 v206, 0, v206, vcc
    v_cndmask_b32 v207, 0, v207, vcc
    ds_write_b128 v192, v[204:207] offset:4096
    s_add_u32 s48, s3, 8
    s_mul_i32 s49, s48, 43
    s_lshr_b32 s49, s49, 7
    s_mul_i32 s50, s49, 3
    s_sub_u32 s50, s48, s50
    s_lshl_b32 s50, s50, 1
    s_lshl_b32 s49, s49, 1
    v_add_u32 v193, s49, v190
    v_add_u32 v194, s50, v191
    v_cmp_gt_u32 vcc, 9, v193
    v_cmp_gt_u32 s[48:49], 5, v194
    v_mul_u32_u24 v193, v193, v194
    v_cvt_f32_u32 v193, v193
    s_and_b64 vcc, vcc, s[48:49]
    v_fma_f32 v193, v193, s63, v189
    v_cos_f32 v194, v193
    v_sin_f32 v195, v193
    s_nop 0
    v_cvt_pk_bf16_f32 v200, v194, -v195
    v_add_f32 v193, v193, v188
    v_cos_f32 v196, v193
    v_sin_f32 v197, v193
    s_nop 0
    v_cvt_pk_bf16_f32 v201, v196, -v197
    v_add_f32 v193, v193, v188
    v_cos_f32 v194, v193
    v_sin_f32 v195, v193
    s_nop 0
    v_cvt_pk_bf16_f32 v202, v194, -v195
    v_add_f32 v193, v193, v188
    v_cos_f32 v196, v193
    v_sin_f32 v197, v193
    s_nop 0
    v_cvt_pk_bf16_f32 v203, v196, -v197
    v_cndmask_b32 v200, 0, v200, vcc
    v_cndmask_b32 v201, 0, v201, vcc
    v_cndmask_b32 v202, 0, v202, vcc
    v_cndmask_b32 v203, 0, v203, vcc
    ds_write_b128 v192, v[200:203] offset:8192
    s_add_u32 s48, s3, 12
    s_mul_i32 s49, s48, 43
    s_lshr_b32 s49, s49, 7
    s_mul_i32 s50, s49, 3
    s_sub_u32 s50, s48, s50
    s_lshl_b32 s50, s50, 1
    s_lshl_b32 s49, s49, 1
    v_add_u32 v193, s49, v190
    v_add_u32 v194, s50, v191
    v_cmp_gt_u32 vcc, 9, v193
    v_cmp_gt_u32 s[48:49], 5, v194
    v_mul_u32_u24 v193, v193, v194
    v_cvt_f32_u32 v193, v193
    s_and_b64 vcc, vcc, s[48:49]
    v_fma_f32 v193, v193, s63, v189
    v_cos_f32 v194, v193
    v_sin_f32 v195, v193
    s_nop 0
    v_cvt_pk_bf16_f32 v204, v194, -v195
    v_add_f32 v193, v193, v188
    v_cos_f32 v196, v193
    v_sin_f32 v197, v193
    s_nop 0
    v_cvt_pk_bf16_f32 v205, v196, -v197
    v_add_f32 v193, v193, v188
    v_cos_f32 v194, v193
    v_sin_f32 v195, v193
    s_nop 0
    v_cvt_pk_bf16_f32 v206, v194, -v195
    v_add_f32 v193, v193, v188
    v_cos_f32 v196, v193
    v_sin_f32 v197, v193
    s_nop 0
    v_cvt_pk_bf16_f32 v207, v196, -v197
    v_cndmask_b32 v204, 0, v204, vcc
    v_cndmask_b32 v205, 0, v205, vcc
    v_cndmask_b32 v206, 0, v206, vcc
    v_cndmask_b32 v207, 0, v207, vcc
    ds_write_b128 v192, v[204:207] offset:12288
L_m_5:
    s_lshl_b32 s58, s3, 10
    v_add_u32 v18, s58, v36
    v_add_u32 v19, 4096, v18
    v_min_u32 v19, 6896, v19
    v_min_u32 v20, 2288, v18
    v_add_u32 v20, 6912, v20
    s_mov_b32 s56, 0x0c0c0400
    s_mov_b32 s57, 0x04000c0c
    s_mov_b32 s58, 196608
    s_mov_b32 s59, 205824
    s_mov_b32 s60, 215040
    s_waitcnt lgkmcnt(0)
    s_cmp_ge_u32 s5, 20
    s_cbranch_scc1 L_m_6
    s_barrier
L_m_6:
    buffer_load_dwordx4 v[80:83], v18, s[36:39], s58 offen sc1
    buffer_load_dwordx4 v[84:87], v18, s[36:39], s59 offen sc1
    buffer_load_dwordx4 v[92:95], v19, s[36:39], s58 offen sc1
    buffer_load_dwordx4 v[96:99], v19, s[36:39], s59 offen sc1
    s_cmp_ge_u32 s5, 20
    s_cbranch_scc1 L_m_7
    s_barrier
L_m_7:
    s_waitcnt vmcnt(0)
    v_perm_b32 v22, v81, v80, s56
    v_perm_b32 v23, v83, v82, s57
    v_or_b32 v22, v22, v23
    v_cmp_ne_u32 vcc, v3, v22
    v_perm_b32 v22, v85, v84, s56
    v_perm_b32 v23, v87, v86, s57
    v_or_b32 v22, v22, v23
    v_cmp_ne_u32 s[48:49], v3, v22
    s_nop 0
    s_or_b64 vcc, vcc, s[48:49]
    v_perm_b32 v22, v93, v92, s56
    v_perm_b32 v23, v95, v94, s57
    v_or_b32 v22, v22, v23
    v_cmp_ne_u32 s[48:49], v3, v22
    s_nop 0
    s_or_b64 vcc, vcc, s[48:49]
    v_perm_b32 v22, v97, v96, s56
    v_perm_b32 v23, v99, v98, s57
    v_or_b32 v22, v22, v23
    v_cmp_ne_u32 s[48:49], v3, v22
    s_nop 0
    s_or_b64 vcc, vcc, s[48:49]
    s_cbranch_vccz L_m_8
Lp_m_9:
    buffer_load_dwordx4 v[80:83], v18, s[36:39], s58 offen sc1
    buffer_load_dwordx4 v[84:87], v18, s[36:39], s59 offen sc1
    buffer_load_dwordx4 v[92:95], v19, s[36:39], s58 offen sc1
    buffer_load_dwordx4 v[96:99], v19, s[36:39], s59 offen sc1
    s_waitcnt vmcnt(0)
    v_perm_b32 v22, v81, v80, s56
    v_perm_b32 v23, v83, v82, s57
    v_or_b32 v22, v22, v23
    v_cmp_ne_u32 vcc, v3, v22
    v_perm_b32 v22, v85, v84, s56
    v_perm_b32 v23, v87, v86, s57
    v_or_b32 v22, v22, v23
    v_cmp_ne_u32 s[48:49], v3, v22
    s_nop 0
    s_or_b64 vcc, vcc, s[48:49]
    v_perm_b32 v22, v93, v92, s56
    v_perm_b32 v23, v95, v94, s57
    v_or_b32 v22, v22, v23
    v_cmp_ne_u32 s[48:49], v3, v22
    s_nop 0
    s_or_b64 vcc, vcc, s[48:49]
    v_perm_b32 v22, v97, v96, s56
    v_perm_b32 v23, v99, v98, s57
    v_or_b32 v22, v22, v23
    v_cmp_ne_u32 s[48:49], v3, v22
    s_nop 0
    s_or_b64 vcc, vcc, s[48:49]
    s_cbranch_vccz Le_m_10
    s_sub_u32 s7, s7, 1
    s_cbranch_scc1 Le_m_10
    s_sleep 1
    s_branch Lp_m_9
Le_m_10:
    s_max_i32 s7, s7, 0
L_m_8:
    v_cmp_le_u32 vcc, 4608, v19
    s_nop 1
    v_cndmask_b32 v22, 0, 1.0, vcc
    v_and_b32 v80, 0xffffff00, v80
    v_and_b32 v81, 0xffffff00, v81
    v_and_b32 v82, 0xffffff00, v82
    v_and_b32 v83, 0xffffff00, v83
    v_and_b32 v84, 0xffffff00, v84
    v_and_b32 v85, 0xffffff00, v85
    v_and_b32 v86, 0xffffff00, v86
    v_and_b32 v87, 0xffffff00, v87
    v_pk_add_f32 v[80:81], v[80:81], v[84:85]
    v_pk_add_f32 v[82:83], v[82:83], v[86:87]
    v_cvt_pk_bf16_f32 v80, 0, v80
    v_cvt_pk_bf16_f32 v81, 0, v81
    v_cvt_pk_bf16_f32 v82, 0, v82
    v_cvt_pk_bf16_f32 v83, 0, v83
    v_and_b32 v92, 0xffffff00, v92
    v_and_b32 v93, 0xffffff00, v93
    v_and_b32 v94, 0xffffff00, v94
    v_and_b32 v95, 0xffffff00, v95
    v_and_b32 v96, 0xffffff00, v96
    v_and_b32 v97, 0xffffff00, v97
    v_and_b32 v98, 0xffffff00, v98
    v_and_b32 v99, 0xffffff00, v99
    v_pk_add_f32 v[92:93], v[92:93], v[96:97]
    v_pk_add_f32 v[94:95], v[94:95], v[98:99]
    v_cvt_pk_bf16_f32 v92, 0, v92
    v_cvt_pk_bf16_f32 v93, 0, v93
    v_cvt_pk_bf16_f32 v94, 0, v94
    v_cvt_pk_bf16_f32 v95, 0, v95
    v_add_f32 v92, v92, v22
    v_add_f32 v93, v93, v22
    v_add_f32 v94, v94, v22
    v_add_f32 v95, v95, v22
    v_cvt_pk_bf16_f32 v92, 0, v92
    v_cvt_pk_bf16_f32 v93, 0, v93
    v_cvt_pk_bf16_f32 v94, 0, v94
    v_cvt_pk_bf16_f32 v95, 0, v95
    v_add_u32 v22, 108544, v18
    v_add_u32 v23, 108544, v19
    ds_write_b128 v22, v[80:83]
    ds_write_b128 v23, v[92:95]
    s_cmp_lg_u32 s2, 255
    s_cbranch_scc1 L_m_11
    s_mov_b32 s50, 4608
    buffer_store_dwordx4 v[80:83], v18, s[36:39], s50 offen sc1
    buffer_store_dwordx4 v[92:95], v19, s[36:39], s50 offen sc1
Lp_m_12:
    buffer_load_dwordx4 v[104:107], v20, s[36:39], s58 offen sc1
    buffer_load_dwordx4 v[108:111], v20, s[36:39], s59 offen sc1
    s_waitcnt vmcnt(0)
    v_perm_b32 v22, v105, v104, s56
    v_perm_b32 v23, v107, v106, s57
    v_or_b32 v22, v22, v23
    v_cmp_ne_u32 vcc, v3, v22
    v_perm_b32 v22, v109, v108, s56
    v_perm_b32 v23, v111, v110, s57
    v_or_b32 v22, v22, v23
    v_cmp_ne_u32 s[48:49], v3, v22
    s_nop 0
    s_or_b64 vcc, vcc, s[48:49]
    s_cbranch_vccz Le_m_13
    s_sub_u32 s7, s7, 1
    s_cbranch_scc1 Le_m_13
    s_sleep 1
    s_branch Lp_m_12
Le_m_13:
    s_max_i32 s7, s7, 0
    v_and_b32 v104, 0xffffff00, v104
    v_and_b32 v105, 0xffffff00, v105
    v_and_b32 v106, 0xffffff00, v106
    v_and_b32 v107, 0xffffff00, v107
    v_and_b32 v108, 0xffffff00, v108
    v_and_b32 v109, 0xffffff00, v109
    v_and_b32 v110, 0xffffff00, v110
    v_and_b32 v111, 0xffffff00, v111
    v_pk_add_f32 v[104:105], v[104:105], v[108:109]
    v_pk_add_f32 v[106:107], v[106:107], v[110:111]
    v_cvt_pk_bf16_f32 v104, 0, v104
    v_cvt_pk_bf16_f32 v105, 0, v105
    v_cvt_pk_bf16_f32 v106, 0, v106
    v_cvt_pk_bf16_f32 v107, 0, v107
    buffer_store_dwordx4 v[104:107], v20, s[36:39], s50 offen sc1
L_m_11:
    v_lshlrev_b32 v236, 16, v9
    v_and_b32 v237, 0xffff0000, v9
    v_lshlrev_b32 v238, 16, v10
    v_and_b32 v239, 0xffff0000, v10
    v_lshlrev_b32 v240, 16, v11
    v_and_b32 v241, 0xffff0000, v11
    v_lshlrev_b32 v242, 16, v12
    v_and_b32 v243, 0xffff0000, v12
    v_lshlrev_b32 v244, 16, v13
    v_and_b32 v245, 0xffff0000, v13
    v_lshlrev_b32 v246, 16, v14
    v_and_b32 v247, 0xffff0000, v14
    v_lshlrev_b32 v248, 16, v15
    v_and_b32 v249, 0xffff0000, v15
    v_lshlrev_b32 v250, 16, v16
    v_and_b32 v251, 0xffff0000, v16
    v_lshlrev_b32 v252, 16, v17
    v_and_b32 v253, 0xffff0000, v17
    s_cmp_ge_u32 s5, 20
    s_cbranch_scc1 L_m_14
    ds_read_b128 v[128:131], v230 offset:0
    ds_read_b128 v[132:135], v230 offset:1024
    ds_read_b128 v[136:139], v230 offset:2048
    ds_read_b128 v[140:143], v230 offset:3072
    ds_read_b128 v[144:147], v230 offset:4096
    ds_read_b128 v[148:151], v230 offset:5120
    ds_read_b128 v[152:155], v230 offset:6144
    ds_read_b128 v[156:159], v230 offset:7168
    ds_read_b128 v[160:163], v230 offset:8192
    ds_read_b128 v[164:167], v230 offset:9216
    ds_read_b128 v[168:171], v230 offset:10240
    ds_read_b128 v[172:175], v230 offset:11264
    ds_read_b128 v[176:179], v230 offset:12288
    ds_read_b128 v[180:183], v230 offset:13312
    ds_read_b128 v[184:187], v230 offset:14336
    s_waitcnt lgkmcnt(0)
    s_barrier
    s_branch L_m_15
L_m_14:
    s_waitcnt lgkmcnt(0)
    s_barrier
    ds_read_b128 v[128:131], v230 offset:0
    ds_read_b128 v[132:135], v230 offset:1024
    ds_read_b128 v[136:139], v230 offset:2048
    ds_read_b128 v[140:143], v230 offset:3072
    ds_read_b128 v[144:147], v230 offset:4096
    ds_read_b128 v[148:151], v230 offset:5120
    ds_read_b128 v[152:155], v230 offset:6144
    ds_read_b128 v[156:159], v230 offset:7168
    ds_read_b128 v[160:163], v230 offset:8192
    ds_read_b128 v[164:167], v230 offset:9216
    ds_read_b128 v[168:171], v230 offset:10240
    ds_read_b128 v[172:175], v230 offset:11264
    ds_read_b128 v[176:179], v230 offset:12288
    ds_read_b128 v[180:183], v230 offset:13312
    ds_read_b128 v[184:187], v230 offset:14336
    s_lshl_b32 s50, s2, 7
    s_add_u32 s50, s50, 557056
    v_mov_b32 v18, 0
Lp_m_16:
    buffer_load_dword v19, v18, s[36:39], s50 offen sc1
    s_waitcnt vmcnt(0)
    v_cmp_ne_u32 vcc, v3, v19
    s_nop 0
    s_cbranch_vccz Le_m_17
    s_sub_u32 s7, s7, 1
    s_cbranch_scc1 Le_m_17
    s_sleep 4
    s_branch Lp_m_16
Le_m_17:
    s_max_i32 s7, s7, 0
    s_waitcnt lgkmcnt(0)
L_m_15:
Lp_m_18:
    buffer_load_dwordx4 v[212:215], v36, s[36:39], s66 offen offset:0 sc1
    buffer_load_dwordx4 v[216:219], v36, s[36:39], s66 offen offset:1024 sc1
    buffer_load_dwordx4 v[220:223], v232, s[36:39], s66 offen offset:2048 sc1
    s_waitcnt vmcnt(0)
    v_max3_u32 v18, v212, v216, v220
    v_cmp_eq_u32 vcc, -1, v18
    s_nop 0
    s_cbranch_vccz Le_m_19
    s_sub_u32 s7, s7, 1
    s_cbranch_scc1 Le_m_19
    s_mov_b64 exec, vcc
    s_sleep 1
    s_branch Lp_m_18
Le_m_19:
    s_mov_b64 exec, -1
    s_max_i32 s7, s7, 0
    ds_write_b128 v233, v[212:215] offset:0
    s_branch L_skip_2
    s_nop 0
L_stub_2:
    s_branch L_back_c1
L_skip_2:
    ds_write_b128 v233, v[216:219] offset:1024
    ds_write_b128 v234, v[220:223] offset:2048
    s_waitcnt lgkmcnt(0)
    s_barrier
    ds_read_b128 v[80:83], v72 offset:0
    ds_read_b128 v[84:87], v73 offset:0
    ds_read_b128 v[88:91], v74 offset:0
    ds_read_b128 v[92:95], v75 offset:0
    ds_read_b128 v[96:99], v72 offset:4096
    ds_read_b128 v[100:103], v73 offset:4096
    ds_read_b128 v[104:107], v74 offset:4096
    ds_read_b128 v[108:111], v75 offset:4096
    ds_read_b128 v[112:115], v76 offset:8192
    ds_read_b128 v[116:119], v77 offset:8192
    ds_read_b128 v[120:123], v78 offset:8192
    ds_read_b128 v[124:127], v79 offset:8192
    s_waitcnt lgkmcnt(11)
    v_mfma_f32_16x16x32_bf16 v[188:191], v[80:83], v[44:47], 0
    v_mfma_f32_16x16x32_bf16 v[192:195], v[80:83], v[40:43], 0
    s_waitcnt lgkmcnt(10)
    v_mfma_f32_16x16x32_bf16 v[188:191], v[84:87], v[52:55], v[188:191]
    v_mfma_f32_16x16x32_bf16 v[192:195], v[84:87], v[48:51], v[192:195]
    s_waitcnt lgkmcnt(9)
    v_mfma_f32_16x16x32_bf16 v[188:191], v[88:91], v[60:63], v[188:191]
    v_mfma_f32_16x16x32_bf16 v[192:195], v[88:91], v[56:59], v[192:195]
    s_waitcnt lgkmcnt(8)
    v_mfma_f32_16x16x32_bf16 v[188:191], v[92:95], v[68:71], v[188:191]
    v_mfma_f32_16x16x32_bf16 v[192:195], v[92:95], v[64:67], v[192:195]
    s_waitcnt lgkmcnt(7)
    v_mfma_f32_16x16x32_bf16 v[196:199], v[96:99], v[44:47], 0
    v_mfma_f32_16x16x32_bf16 v[200:203], v[96:99], v[40:43], 0
    s_waitcnt lgkmcnt(6)
    v_mfma_f32_16x16x32_bf16 v[196:199], v[100:103], v[52:55], v[196:199]
    v_mfma_f32_16x16x32_bf16 v[200:203], v[100:103], v[48:51], v[200:203]
    s_waitcnt lgkmcnt(5)
    v_mfma_f32_16x16x32_bf16 v[196:199], v[104:107], v[60:63], v[196:199]
    v_mul_f32 v18, v188, v30
    v_mul_f32 v19, v192, v30
    v_mfma_f32_16x16x32_bf16 v[200:203], v[104:107], v[56:59], v[200:203]
    v_fma_f32 v18, -v192, v31, v18
    v_fmac_f32 v19, v188, v31
    s_waitcnt lgkmcnt(4)
    v_mfma_f32_16x16x32_bf16 v[196:199], v[108:111], v[68:71], v[196:199]
    v_cvt_pk_bf16_f32 v212, v18, v19
    v_mul_f32 v20, v189, v30
    v_mfma_f32_16x16x32_bf16 v[200:203], v[108:111], v[64:67], v[200:203]
    v_mul_f32 v21, v193, v30
    v_fma_f32 v20, -v193, v31, v20
    s_waitcnt lgkmcnt(3)
    v_mfma_f32_16x16x32_bf16 v[204:207], v[112:115], v[44:47], 0
    v_fmac_f32 v21, v189, v31
    v_cvt_pk_bf16_f32 v213, v20, v21
    v_mfma_f32_16x16x32_bf16 v[208:211], v[112:115], v[40:43], 0
    v_mul_f32 v22, v190, v30
    v_mul_f32 v23, v194, v30
    s_waitcnt lgkmcnt(2)
    v_mfma_f32_16x16x32_bf16 v[204:207], v[116:119], v[52:55], v[204:207]
    v_fma_f32 v22, -v194, v31, v22
    v_fmac_f32 v23, v190, v31
    v_mfma_f32_16x16x32_bf16 v[208:211], v[116:119], v[48:51], v[208:211]
    v_cvt_pk_bf16_f32 v214, v22, v23
    v_mul_f32 v24, v191, v30
    s_waitcnt lgkmcnt(1)
    v_mfma_f32_16x16x32_bf16 v[204:207], v[120:123], v[60:63], v[204:207]
    v_mul_f32 v25, v195, v30
    v_fma_f32 v24, -v195, v31, v24
    v_mfma_f32_16x16x32_bf16 v[208:211], v[120:123], v[56:59], v[208:211]
    v_fmac_f32 v25, v191, v31
    v_cvt_pk_bf16_f32 v215, v24, v25
    s_waitcnt lgkmcnt(0)
    v_mfma_f32_16x16x32_bf16 v[204:207], v[124:127], v[68:71], v[204:207]
    v_mul_f32 v18, v196, v32
    v_mul_f32 v19, v200, v32
    v_mfma_f32_16x16x32_bf16 v[208:211], v[124:127], v[64:67], v[208:211]
    v_fma_f32 v18, -v200, v33, v18
    v_fmac_f32 v19, v196, v33
    v_mfma_f32_16x16x32_bf16 v[80:83], v[212:215], v[128:131], 0
    v_cvt_pk_bf16_f32 v216, v18, v19
    v_mul_f32 v20, v197, v32
    v_mfma_f32_16x16x32_bf16 v[84:87], v[212:215], v[140:143], 0
    v_mul_f32 v21, v201, v32
    v_fma_f32 v20, -v201, v33, v20
    v_mfma_f32_16x16x32_bf16 v[88:91], v[212:215], v[152:155], 0
    v_fmac_f32 v21, v197, v33
    v_cvt_pk_bf16_f32 v217, v20, v21
    v_mfma_f32_16x16x32_bf16 v[92:95], v[212:215], v[164:167], 0
    v_mul_f32 v22, v198, v32
    v_mul_f32 v23, v202, v32
    v_mfma_f32_16x16x32_bf16 v[96:99], v[212:215], v[176:179], 0
    v_fma_f32 v22, -v202, v33, v22
    v_fmac_f32 v23, v198, v33
    v_cvt_pk_bf16_f32 v218, v22, v23
    v_mul_f32 v24, v199, v32
    v_mul_f32 v25, v203, v32
    v_fma_f32 v24, -v203, v33, v24
    v_fmac_f32 v25, v199, v33
    v_cvt_pk_bf16_f32 v219, v24, v25
    s_nop 1
    v_mfma_f32_16x16x32_bf16 v[80:83], v[216:219], v[132:135], v[80:83]
    v_mul_f32 v18, v204, v34
    v_mul_f32 v19, v208, v34
    v_mfma_f32_16x16x32_bf16 v[84:87], v[216:219], v[144:147], v[84:87]
    v_fma_f32 v18, -v208, v35, v18
    v_fmac_f32 v19, v204, v35
    v_mfma_f32_16x16x32_bf16 v[88:91], v[216:219], v[156:159], v[88:91]
    v_cvt_pk_bf16_f32 v220, v18, v19
    v_mul_f32 v20, v205, v34
    v_mfma_f32_16x16x32_bf16 v[92:95], v[216:219], v[168:171], v[92:95]
    v_mul_f32 v21, v209, v34
    v_fma_f32 v20, -v209, v35, v20
    v_mfma_f32_16x16x32_bf16 v[96:99], v[216:219], v[180:183], v[96:99]
    v_fmac_f32 v21, v205, v35
    v_cvt_pk_bf16_f32 v221, v20, v21
    v_mul_f32 v22, v206, v34
    v_mul_f32 v23, v210, v34
    v_fma_f32 v22, -v210, v35, v22
    v_fmac_f32 v23, v206, v35
    v_cvt_pk_bf16_f32 v222, v22, v23
    v_mul_f32 v24, v207, v34
    v_mul_f32 v25, v211, v34
    v_fma_f32 v24, -v211, v35, v24
    v_fmac_f32 v25, v207, v35
    v_cvt_pk_bf16_f32 v223, v24, v25
    s_nop 1
    v_mfma_f32_16x16x32_bf16 v[80:83], v[220:223], v[136:139], v[80:83]
    v_mfma_f32_16x16x32_bf16 v[84:87], v[220:223], v[148:151], v[84:87]
    v_mfma_f32_16x16x32_bf16 v[88:91], v[220:223], v[160:163], v[88:91]
    v_mfma_f32_16x16x32_bf16 v[92:95], v[220:223], v[172:175], v[92:95]
    v_mfma_f32_16x16x32_bf16 v[96:99], v[220:223], v[184:187], v[96:99]
    ds_read2st64_b64 v[40:43], v228 offset0:0 offset1:1
    ds_read2st64_b64 v[44:47], v37 offset0:0 offset1:1
    ds_read2st64_b64 v[48:51], v228 offset0:2 offset1:3
    ds_read2st64_b64 v[52:55], v37 offset0:2 offset1:3
    ds_read_b64 v[56:57], v228 offset:2048
    ds_write_b128 v225, v[80:83] offset:0
    ds_write_b128 v225, v[84:87] offset:512
    ds_write_b128 v225, v[88:91] offset:1024
    ds_write_b128 v225, v[92:95] offset:1536
    ds_write_b128 v224, v[96:99] offset:2048
    ds_read2st64_b64 v[188:191], v228 offset0:9 offset1:10
    ds_read2st64_b64 v[192:195], v37 offset0:9 offset1:10
    ds_read2st64_b64 v[196:199], v228 offset0:11 offset1:12
    ds_read2st64_b64 v[200:203], v37 offset0:11 offset1:12
    ds_read_b64 v[204:205], v228 offset:6656
    ds_read2st64_b64 v[128:131], v37 offset0:4 offset1:5
    ds_read2st64_b64 v[132:135], v228 offset0:5 offset1:6
    ds_read2st64_b64 v[136:139], v37 offset0:6 offset1:7
    ds_read2st64_b64 v[140:143], v228 offset0:7 offset1:8
    ds_read_b64 v[144:145], v228 offset:4352
    s_waitcnt lgkmcnt(10)
    s_barrier
    ds_read_b64 v[100:101], v226 offset:0
    ds_read_b64 v[102:103], v226 offset:256
    ds_read_b64 v[104:105], v226 offset:512
    ds_read_b64 v[106:107], v226 offset:768
    ds_read_b64 v[108:109], v226 offset:1024
    ds_read_b64 v[110:111], v226 offset:1280
    ds_read_b64 v[112:113], v226 offset:1536
    ds_read_b64 v[114:115], v226 offset:1792
    ds_read_b64 v[116:117], v226 offset:2048
    s_mul_i32 s48, s6, 9216
    s_lshl_b32 s49, s3, 10
    s_add_u32 s48, s48, s49
    s_add_u32 s48, s48, 16777216
    s_add_u32 s49, s48, 4096
    s_add_u32 s50, s48, 8192
    s_waitcnt lgkmcnt(8)
    v_pk_fma_f32 v[236:237], v[100:101], v[40:41], v[236:237]
    s_waitcnt lgkmcnt(7)
    v_pk_fma_f32 v[238:239], v[102:103], v[44:45], v[238:239]
    s_waitcnt lgkmcnt(6)
    v_pk_fma_f32 v[240:241], v[104:105], v[42:43], v[240:241]
    s_waitcnt lgkmcnt(5)
    v_pk_fma_f32 v[242:243], v[106:107], v[46:47], v[242:243]
    s_waitcnt lgkmcnt(4)
    v_pk_fma_f32 v[244:245], v[108:109], v[48:49], v[244:245]
    s_waitcnt lgkmcnt(3)
    v_pk_fma_f32 v[246:247], v[110:111], v[52:53], v[246:247]
    s_waitcnt lgkmcnt(2)
    v_pk_fma_f32 v[248:249], v[112:113], v[50:51], v[248:249]
    s_waitcnt lgkmcnt(1)
    v_pk_fma_f32 v[250:251], v[114:115], v[54:55], v[250:251]
    s_waitcnt lgkmcnt(0)
    v_pk_fma_f32 v[252:253], v[116:117], v[56:57], v[252:253]
    v_pk_add_f32 v[24:25], v[236:237], v[238:239]
    v_pk_mul_f32 v[26:27], v[236:237], v[236:237]
    v_pk_fma_f32 v[26:27], v[238:239], v[238:239], v[26:27]
    v_pk_add_f32 v[24:25], v[24:25], v[240:241]
    v_pk_fma_f32 v[26:27], v[240:241], v[240:241], v[26:27]
    v_pk_add_f32 v[24:25], v[24:25], v[242:243]
    v_pk_fma_f32 v[26:27], v[242:243], v[242:243], v[26:27]
    v_pk_add_f32 v[24:25], v[24:25], v[244:245]
    v_pk_fma_f32 v[26:27], v[244:245], v[244:245], v[26:27]
    v_pk_add_f32 v[24:25], v[24:25], v[246:247]
    v_pk_fma_f32 v[26:27], v[246:247], v[246:247], v[26:27]
    v_pk_add_f32 v[24:25], v[24:25], v[248:249]
    v_pk_fma_f32 v[26:27], v[248:249], v[248:249], v[26:27]
    v_pk_add_f32 v[24:25], v[24:25], v[250:251]
    v_pk_fma_f32 v[26:27], v[250:251], v[250:251], v[26:27]
    v_pk_add_f32 v[24:25], v[24:25], v[252:253]
    v_pk_fma_f32 v[26:27], v[252:253], v[252:253], v[26:27]
    v_add_f32 v24, v24, v25
    v_add_f32 v25, v26, v27
    s_nop 0
    v_add_f32_dpp v24, v24, v24 quad_perm:[1,0,3,2] row_mask:0xf bank_mask:0xf
    v_add_f32_dpp v25, v25, v25 quad_perm:[1,0,3,2] row_mask:0xf bank_mask:0xf
    s_nop 0
    v_add_f32_dpp v24, v24, v24 quad_perm:[2,3,0,1] row_mask:0xf bank_mask:0xf
    v_add_f32_dpp v25, v25, v25 quad_perm:[2,3,0,1] row_mask:0xf bank_mask:0xf
    s_nop 0
    v_add_f32_dpp v24, v24, v24 row_half_mirror row_mask:0xf bank_mask:0xf
    v_add_f32_dpp v25, v25, v25 row_half_mirror row_mask:0xf bank_mask:0xf
    s_nop 0
    v_add_f32_dpp v24, v24, v24 row_mirror row_mask:0xf bank_mask:0xf
    v_add_f32_dpp v25, v25, v25 row_mirror row_mask:0xf bank_mask:0xf
    v_mov_b32 v26, v24
    v_mov_b32 v27, v25
    s_nop 0
    v_permlane16_swap_b32 v24, v26
    v_permlane16_swap_b32 v25, v27
    v_add_f32 v24, v24, v26
    v_add_f32 v25, v25, v27
    v_mul_f32 v24, 0xbae38e39, v24
    v_mul_f32 v25, 0x3ae38e39, v25
    v_fma_f32 v25, -v24, v24, v25
    v_max_f32 v25, 0, v25
    v_add_f32 v25, 0x3727c5ac, v25
    v_rsq_f32 v26, v25
    s_nop 0
    v_mul_f32 v24, v24, v26
    v_pk_fma_f32 v[100:101], v[236:237], v[26:27], v[24:25] op_sel_hi:[1,0,0]
    v_pk_fma_f32 v[102:103], v[238:239], v[26:27], v[24:25] op_sel_hi:[1,0,0]
    v_pk_fma_f32 v[104:105], v[240:241], v[26:27], v[24:25] op_sel_hi:[1,0,0]
    v_pk_fma_f32 v[106:107], v[242:243], v[26:27], v[24:25] op_sel_hi:[1,0,0]
    v_pk_fma_f32 v[108:109], v[244:245], v[26:27], v[24:25] op_sel_hi:[1,0,0]
    v_pk_fma_f32 v[110:111], v[246:247], v[26:27], v[24:25] op_sel_hi:[1,0,0]
    v_pk_fma_f32 v[112:113], v[248:249], v[26:27], v[24:25] op_sel_hi:[1,0,0]
    v_pk_fma_f32 v[114:115], v[250:251], v[26:27], v[24:25] op_sel_hi:[1,0,0]
    v_pk_fma_f32 v[116:117], v[252:253], v[26:27], v[24:25] op_sel_hi:[1,0,0]
    v_pk_fma_f32 v[100:101], v[100:101], v[188:189], v[128:129]
    v_pk_fma_f32 v[102:103], v[102:103], v[192:193], v[132:133]
    v_pk_fma_f32 v[104:105], v[104:105], v[190:191], v[130:131]
    v_pk_fma_f32 v[106:107], v[106:107], v[194:195], v[134:135]
    v_pk_fma_f32 v[108:109], v[108:109], v[196:197], v[136:137]
    v_pk_fma_f32 v[110:111], v[110:111], v[200:201], v[140:141]
    v_pk_fma_f32 v[112:113], v[112:113], v[198:199], v[138:139]
    v_pk_fma_f32 v[114:115], v[114:115], v[202:203], v[142:143]
    v_pk_fma_f32 v[116:117], v[116:117], v[204:205], v[144:145]
    v_pk_add_f32 v[24:25], v[100:101], v[102:103]
    v_pk_mul_f32 v[26:27], v[100:101], v[100:101]
    v_pk_fma_f32 v[26:27], v[102:103], v[102:103], v[26:27]
    v_pk_add_f32 v[24:25], v[24:25], v[104:105]
    v_pk_fma_f32 v[26:27], v[104:105], v[104:105], v[26:27]
    v_pk_add_f32 v[24:25], v[24:25], v[106:107]
    v_pk_fma_f32 v[26:27], v[106:107], v[106:107], v[26:27]
    v_pk_add_f32 v[24:25], v[24:25], v[108:109]
    v_pk_fma_f32 v[26:27], v[108:109], v[108:109], v[26:27]
    v_pk_add_f32 v[24:25], v[24:25], v[110:111]
    v_pk_fma_f32 v[26:27], v[110:111], v[110:111], v[26:27]
    v_pk_add_f32 v[24:25], v[24:25], v[112:113]
    v_pk_fma_f32 v[26:27], v[112:113], v[112:113], v[26:27]
    v_pk_add_f32 v[24:25], v[24:25], v[114:115]
    v_pk_fma_f32 v[26:27], v[114:115], v[114:115], v[26:27]
    v_pk_add_f32 v[24:25], v[24:25], v[116:117]
    v_pk_fma_f32 v[26:27], v[116:117], v[116:117], v[26:27]
    v_add_f32 v24, v24, v25
    v_add_f32 v25, v26, v27
    s_nop 0
    v_add_f32_dpp v24, v24, v24 quad_perm:[1,0,3,2] row_mask:0xf bank_mask:0xf
    v_add_f32_dpp v25, v25, v25 quad_perm:[1,0,3,2] row_mask:0xf bank_mask:0xf
    s_nop 0
    v_add_f32_dpp v24, v24, v24 quad_perm:[2,3,0,1] row_mask:0xf bank_mask:0xf
    v_add_f32_dpp v25, v25, v25 quad_perm:[2,3,0,1] row_mask:0xf bank_mask:0xf
    s_nop 0
    v_add_f32_dpp v24, v24, v24 row_half_mirror row_mask:0xf bank_mask:0xf
    v_add_f32_dpp v25, v25, v25 row_half_mirror row_mask:0xf bank_mask:0xf
    s_nop 0
    v_add_f32_dpp v24, v24, v24 row_mirror row_mask:0xf bank_mask:0xf
    v_add_f32_dpp v25, v25, v25 row_mirror row_mask:0xf bank_mask:0xf
    v_mov_b32 v26, v24
    v_mov_b32 v27, v25
    s_nop 0
    v_permlane16_swap_b32 v24, v26
    v_permlane16_swap_b32 v25, v27
    v_add_f32 v24, v24, v26
    v_add_f32 v25, v25, v27
    v_mul_f32 v24, 0xbae38e39, v24
    v_mul_f32 v25, 0x3ae38e39, v25
    v_fma_f32 v25, -v24, v24, v25
    v_max_f32 v25, 0, v25
    v_add_f32 v25, 0x3727c5ac, v25
    v_rsq_f32 v26, v25
    s_nop 0
    v_mul_f32 v24, v24, v26
    v_pk_fma_f32 v[100:101], v[100:101], v[26:27], v[24:25] op_sel_hi:[1,0,0]
    v_cvt_pk_bf16_f32 v9, v100, v101
    v_pk_fma_f32 v[102:103], v[102:103], v[26:27], v[24:25] op_sel_hi:[1,0,0]
    v_cvt_pk_bf16_f32 v10, v102, v103
    ds_write2_b32 v227, v9, v10 offset0:0 offset1:32
    v_pk_fma_f32 v[104:105], v[104:105], v[26:27], v[24:25] op_sel_hi:[1,0,0]
    v_cvt_pk_bf16_f32 v11, v104, v105
    v_pk_fma_f32 v[106:107], v[106:107], v[26:27], v[24:25] op_sel_hi:[1,0,0]
    v_cvt_pk_bf16_f32 v12, v106, v107
    ds_write2_b32 v227, v11, v12 offset0:64 offset1:96
    v_pk_fma_f32 v[108:109], v[108:109], v[26:27], v[24:25] op_sel_hi:[1,0,0]
    v_cvt_pk_bf16_f32 v13, v108, v109
    v_pk_fma_f32 v[110:111], v[110:111], v[26:27], v[24:25] op_sel_hi:[1,0,0]
    v_cvt_pk_bf16_f32 v14, v110, v111
    ds_write2_b32 v227, v13, v14 offset0:128 offset1:160
    v_pk_fma_f32 v[112:113], v[112:113], v[26:27], v[24:25] op_sel_hi:[1,0,0]
    v_cvt_pk_bf16_f32 v15, v112, v113
    v_pk_fma_f32 v[114:115], v[114:115], v[26:27], v[24:25] op_sel_hi:[1,0,0]
    v_cvt_pk_bf16_f32 v16, v114, v115
    ds_write2_b32 v227, v15, v16 offset0:192 offset1:224
    v_pk_fma_f32 v[116:117], v[116:117], v[26:27], v[24:25] op_sel_hi:[1,0,0]
    v_cvt_pk_bf16_f32 v17, v116, v117
    ds_write_b32 v227, v17 offset:1024
    s_waitcnt lgkmcnt(0)
    s_barrier
    ds_read_b64_tr_b16 v[188:189], v229 offset:0
    ds_read_b64_tr_b16 v[190:191], v229 offset:4736
    ds_read_b64_tr_b16 v[192:193], v229 offset:512
    ds_read_b64_tr_b16 v[194:195], v229 offset:5248
    ds_read_b64_tr_b16 v[196:197], v229 offset:1024
    ds_read_b64_tr_b16 v[198:199], v229 offset:5760
    s_waitcnt lgkmcnt(4)
    buffer_store_dwordx4 v[188:191], v36, s[36:39], s48 offen sc1
    s_waitcnt lgkmcnt(2)
    buffer_store_dwordx4 v[192:195], v36, s[36:39], s49 offen sc1
    s_waitcnt lgkmcnt(0)
    s_cmp_lg_u32 s3, 0
    s_cbranch_scc1 L_m_20
    buffer_store_dwordx4 v[196:199], v36, s[36:39], s50 offen sc1
L_m_20:
    v_cvt_pk_bf16_f32 v9, v236, v237
    v_cvt_pk_bf16_f32 v10, v238, v239
    v_cvt_pk_bf16_f32 v11, v240, v241
    v_cvt_pk_bf16_f32 v12, v242, v243
    v_cvt_pk_bf16_f32 v13, v244, v245
    v_cvt_pk_bf16_f32 v14, v246, v247
    v_cvt_pk_bf16_f32 v15, v248, v249
    v_cvt_pk_bf16_f32 v16, v250, v251
    v_cvt_pk_bf16_f32 v17, v252, v253
    ds_write2_b32 v231, v9, v10 offset0:0 offset1:32
    ds_write2_b32 v231, v11, v12 offset0:64 offset1:96
    ds_write2_b32 v231, v13, v14 offset0:128 offset1:160
    ds_write2_b32 v231, v15, v16 offset0:192 offset1:224
    ds_write_b32 v231, v17 offset:1024
    s_waitcnt lgkmcnt(0)
    s_barrier
    s_cmp_ge_u32 s5, 27
    s_cbranch_scc1 L_m_21
    v_lshrrev_b32 v10, 2, v0
    v_and_b32 v11, 7, v10
    s_lshl_b32 s59, s3, 1
    s_add_u32 s59, s59, 0
    v_xor_b32 v11, s59, v11
    v_xor_b32 v12, 1, v11
    v_and_b32 v13, 3, v0
    v_lshlrev_b32 v13, 3, v13
    v_lshl_add_u32 v10, v10, 8, v13
    v_lshl_add_u32 v20, v11, 5, v10
    v_lshl_add_u32 v21, v12, 5, v10
    v_add_u32 v24, 0, v20
    v_add_u32 v25, 0, v21
    ds_read_b64_tr_b16 v[92:93], v24 offset:0
    ds_read_b64_tr_b16 v[94:95], v24 offset:4096
    ds_read_b64_tr_b16 v[96:97], v25 offset:0
    ds_read_b64_tr_b16 v[98:99], v25 offset:4096
    ds_read_b64_tr_b16 v[100:101], v24 offset:8192
    ds_read_b64_tr_b16 v[102:103], v24 offset:12288
    ds_read_b64_tr_b16 v[104:105], v25 offset:8192
    ds_read_b64_tr_b16 v[106:107], v25 offset:12288
    ds_read_b64_tr_b16 v[108:109], v24 offset:16384
    ds_read_b64_tr_b16 v[110:111], v24 offset:20480
    ds_read_b64_tr_b16 v[112:113], v25 offset:16384
    ds_read_b64_tr_b16 v[114:115], v25 offset:20480
    ds_read_b64_tr_b16 v[116:117], v24 offset:24576
    ds_read_b64_tr_b16 v[118:119], v24 offset:28672
    ds_read_b64_tr_b16 v[120:121], v25 offset:24576
    ds_read_b64_tr_b16 v[122:123], v25 offset:28672
    ds_read_b64_tr_b16 v[124:125], v24 offset:32768
    ds_read_b64_tr_b16 v[126:127], v24 offset:36864
    ds_read_b64_tr_b16 v[128:129], v25 offset:32768
    ds_read_b64_tr_b16 v[130:131], v25 offset:36864
    ds_read_b64_tr_b16 v[132:133], v24 offset:40960
    ds_read_b64_tr_b16 v[134:135], v24 offset:45056
    ds_read_b64_tr_b16 v[136:137], v25 offset:40960
    ds_read_b64_tr_b16 v[138:139], v25 offset:45056
    v_add_u32 v24, 49152, v20
    v_add_u32 v25, 49152, v21
    ds_read_b64_tr_b16 v[140:141], v24 offset:0
    ds_read_b64_tr_b16 v[142:143], v24 offset:4096
    ds_read_b64_tr_b16 v[144:145], v25 offset:0
    ds_read_b64_tr_b16 v[146:147], v25 offset:4096
    ds_read_b64_tr_b16 v[148:149], v24 offset:8192
    ds_read_b64_tr_b16 v[150:151], v24 offset:12288
    ds_read_b64_tr_b16 v[152:153], v25 offset:8192
    ds_read_b64_tr_b16 v[154:155], v25 offset:12288
    ds_read_b64_tr_b16 v[156:157], v24 offset:16384
    ds_read_b64_tr_b16 v[158:159], v24 offset:20480
    ds_read_b64_tr_b16 v[160:161], v25 offset:16384
    ds_read_b64_tr_b16 v[162:163], v25 offset:20480
    ds_read_b64_tr_b16 v[164:165], v24 offset:24576
    ds_read_b64_tr_b16 v[166:167], v24 offset:28672
    ds_read_b64_tr_b16 v[168:169], v25 offset:24576
    ds_read_b64_tr_b16 v[170:171], v25 offset:28672
    ds_read_b64_tr_b16 v[172:173], v24 offset:32768
    ds_read_b64_tr_b16 v[174:175], v24 offset:36864
    ds_read_b64_tr_b16 v[176:177], v25 offset:32768
    ds_read_b64_tr_b16 v[178:179], v25 offset:36864
    ds_read_b64_tr_b16 v[180:181], v24 offset:40960
    ds_read_b64_tr_b16 v[182:183], v24 offset:45056
    ds_read_b64_tr_b16 v[184:185], v25 offset:40960
    ds_read_b64_tr_b16 v[186:187], v25 offset:45056
    s_waitcnt vmcnt(0) lgkmcnt(0)
    s_barrier
    v_mul_u32_u24 v18, 1536, v2
    v_lshl_add_u32 v18, v1, 4, v18
    v_add_u32 v18, 98304, v18
    v_lshlrev_b32 v204, 16, v4
    v_and_b32 v205, 0xffff0000, v4
    v_lshlrev_b32 v206, 16, v5
    v_and_b32 v207, 0xffff0000, v5
    v_lshlrev_b32 v208, 16, v6
    v_and_b32 v209, 0xffff0000, v6
    v_lshlrev_b32 v210, 16, v7
    v_and_b32 v211, 0xffff0000, v7
    v_mov_b64 v[212:213], v[204:205]
    v_mov_b64 v[214:215], v[206:207]
    v_mov_b64 v[216:217], v[208:209]
    v_mov_b64 v[218:219], v[210:211]
    v_mov_b64 v[220:221], v[204:205]
    v_mov_b64 v[222:223], v[206:207]
    v_mov_b64 v[224:225], v[208:209]
    v_mov_b64 v[226:227], v[210:211]
    v_mov_b64 v[228:229], v[204:205]
    v_mov_b64 v[230:231], v[206:207]
    v_mov_b64 v[232:233], v[208:209]
    v_mov_b64 v[234:235], v[210:211]
    v_mov_b64 v[236:237], v[204:205]
    v_mov_b64 v[238:239], v[206:207]
    v_mov_b64 v[240:241], v[208:209]
    v_mov_b64 v[242:243], v[210:211]
    v_mov_b64 v[244:245], v[204:205]
    v_mov_b64 v[246:247], v[206:207]
    v_mov_b64 v[248:249], v[208:209]
    v_mov_b64 v[250:251], v[210:211]
    s_barrier
    v_add_u32 v24, 0, v20
    v_add_u32 v25, 0, v21
    ds_read_b64_tr_b16 v[188:189], v24 offset:0
    ds_read_b64_tr_b16 v[190:191], v24 offset:4096
    ds_read_b64_tr_b16 v[192:193], v25 offset:0
    ds_read_b64_tr_b16 v[194:195], v25 offset:4096
    ds_read_b64_tr_b16 v[196:197], v24 offset:8192
    ds_read_b64_tr_b16 v[198:199], v24 offset:12288
    ds_read_b64_tr_b16 v[200:201], v25 offset:8192
    ds_read_b64_tr_b16 v[202:203], v25 offset:12288
    ds_read_b64_tr_b16 v[52:53], v24 offset:16384
    ds_read_b64_tr_b16 v[54:55], v24 offset:20480
    ds_read_b64_tr_b16 v[56:57], v25 offset:16384
    ds_read_b64_tr_b16 v[58:59], v25 offset:20480
    ds_read_b64_tr_b16 v[60:61], v24 offset:24576
    ds_read_b64_tr_b16 v[62:63], v24 offset:28672
    ds_read_b64_tr_b16 v[64:65], v25 offset:24576
    ds_read_b64_tr_b16 v[66:67], v25 offset:28672
    s_waitcnt lgkmcnt(0)
    s_barrier
    s_branch L_stub_3
L_back_c2:
    v_add_u32 v24, 49152, v20
    v_add_u32 v25, 49152, v21
    s_barrier
    ds_read_b64_tr_b16 v[76:77], v20 offset:32768
    ds_read_b128 v[28:31], v18 offset:0
    ds_read_b64_tr_b16 v[78:79], v20 offset:36864
    ds_read_b128 v[32:35], v18 offset:256
    ds_read_b64_tr_b16 v[80:81], v21 offset:32768
    ds_read_b128 v[36:39], v18 offset:512
    ds_read_b64_tr_b16 v[82:83], v21 offset:36864
    ds_read_b128 v[40:43], v18 offset:768
    ds_read_b128 v[44:47], v18 offset:1024
    ds_read_b128 v[48:51], v18 offset:1280
    s_waitcnt lgkmcnt(7)
    v_mfma_f32_16x16x32_bf16 v[204:207], v[76:79], v[28:31], v[204:207]
    ds_read_b64_tr_b16 v[84:85], v20 offset:40960
    s_waitcnt lgkmcnt(4)
    v_mfma_f32_16x16x32_bf16 v[208:211], v[80:83], v[28:31], v[208:211]
    ds_read_b128 v[28:31], v18 offset:6144
    v_mfma_f32_16x16x32_bf16 v[212:215], v[76:79], v[32:35], v[212:215]
    ds_read_b64_tr_b16 v[86:87], v20 offset:45056
    v_mfma_f32_16x16x32_bf16 v[216:219], v[80:83], v[32:35], v[216:219]
    ds_read_b128 v[32:35], v18 offset:6400
    v_mfma_f32_16x16x32_bf16 v[220:223], v[76:79], v[36:39], v[220:223]
    ds_read_b64_tr_b16 v[88:89], v21 offset:40960
    v_mfma_f32_16x16x32_bf16 v[224:227], v[80:83], v[36:39], v[224:227]
    ds_read_b128 v[36:39], v18 offset:6656
    s_waitcnt lgkmcnt(8)
    v_mfma_f32_16x16x32_bf16 v[228:231], v[76:79], v[40:43], v[228:231]
    ds_read_b64_tr_b16 v[90:91], v21 offset:45056
    v_mfma_f32_16x16x32_bf16 v[232:235], v[80:83], v[40:43], v[232:235]
    ds_read_b128 v[40:43], v18 offset:6912
    s_waitcnt lgkmcnt(9)
    v_mfma_f32_16x16x32_bf16 v[236:239], v[76:79], v[44:47], v[236:239]
    v_mfma_f32_16x16x32_bf16 v[240:243], v[80:83], v[44:47], v[240:243]
    ds_read_b128 v[44:47], v18 offset:7168
    s_waitcnt lgkmcnt(9)
    v_mfma_f32_16x16x32_bf16 v[244:247], v[76:79], v[48:51], v[244:247]
    v_mfma_f32_16x16x32_bf16 v[248:251], v[80:83], v[48:51], v[248:251]
    ds_read_b128 v[48:51], v18 offset:7424
    s_waitcnt lgkmcnt(3)
    v_mfma_f32_16x16x32_bf16 v[204:207], v[84:87], v[28:31], v[204:207]
    s_barrier
    ds_read_b64_tr_b16 v[76:77], v24 offset:0
    v_mfma_f32_16x16x32_bf16 v[208:211], v[88:91], v[28:31], v[208:211]
    ds_read_b128 v[28:31], v18 offset:12288
    v_mfma_f32_16x16x32_bf16 v[212:215], v[84:87], v[32:35], v[212:215]
    ds_read_b64_tr_b16 v[78:79], v24 offset:4096
    v_mfma_f32_16x16x32_bf16 v[216:219], v[88:91], v[32:35], v[216:219]
    ds_read_b128 v[32:35], v18 offset:12544
    v_mfma_f32_16x16x32_bf16 v[220:223], v[84:87], v[36:39], v[220:223]
    ds_read_b64_tr_b16 v[80:81], v25 offset:0
    v_mfma_f32_16x16x32_bf16 v[224:227], v[88:91], v[36:39], v[224:227]
    ds_read_b128 v[36:39], v18 offset:12800
    s_waitcnt lgkmcnt(8)
    v_mfma_f32_16x16x32_bf16 v[228:231], v[84:87], v[40:43], v[228:231]
    ds_read_b64_tr_b16 v[82:83], v25 offset:4096
    v_mfma_f32_16x16x32_bf16 v[232:235], v[88:91], v[40:43], v[232:235]
    ds_read_b128 v[40:43], v18 offset:13056
    s_waitcnt lgkmcnt(9)
    v_mfma_f32_16x16x32_bf16 v[236:239], v[84:87], v[44:47], v[236:239]
    v_mfma_f32_16x16x32_bf16 v[240:243], v[88:91], v[44:47], v[240:243]
    ds_read_b128 v[44:47], v18 offset:13312
    s_waitcnt lgkmcnt(9)
    v_mfma_f32_16x16x32_bf16 v[244:247], v[84:87], v[48:51], v[244:247]
    v_mfma_f32_16x16x32_bf16 v[248:251], v[88:91], v[48:51], v[248:251]
    ds_read_b128 v[48:51], v18 offset:13568
    s_waitcnt lgkmcnt(3)
    v_mfma_f32_16x16x32_bf16 v[204:207], v[76:79], v[28:31], v[204:207]
    ds_read_b64_tr_b16 v[84:85], v24 offset:8192
    v_mfma_f32_16x16x32_bf16 v[208:211], v[80:83], v[28:31], v[208:211]
    ds_read_b128 v[28:31], v18 offset:18432
    v_mfma_f32_16x16x32_bf16 v[212:215], v[76:79], v[32:35], v[212:215]
    ds_read_b64_tr_b16 v[86:87], v24 offset:12288
    v_mfma_f32_16x16x32_bf16 v[216:219], v[80:83], v[32:35], v[216:219]
    ds_read_b128 v[32:35], v18 offset:18688
    v_mfma_f32_16x16x32_bf16 v[220:223], v[76:79], v[36:39], v[220:223]
    ds_read_b64_tr_b16 v[88:89], v25 offset:8192
    v_mfma_f32_16x16x32_bf16 v[224:227], v[80:83], v[36:39], v[224:227]
    ds_read_b128 v[36:39], v18 offset:18944
    s_waitcnt lgkmcnt(8)
    v_mfma_f32_16x16x32_bf16 v[228:231], v[76:79], v[40:43], v[228:231]
    ds_read_b64_tr_b16 v[90:91], v25 offset:12288
    v_mfma_f32_16x16x32_bf16 v[232:235], v[80:83], v[40:43], v[232:235]
    ds_read_b128 v[40:43], v18 offset:19200
    s_waitcnt lgkmcnt(9)
    v_mfma_f32_16x16x32_bf16 v[236:239], v[76:79], v[44:47], v[236:239]
    v_mfma_f32_16x16x32_bf16 v[240:243], v[80:83], v[44:47], v[240:243]
    ds_read_b128 v[44:47], v18 offset:19456
    s_waitcnt lgkmcnt(9)
    v_mfma_f32_16x16x32_bf16 v[244:247], v[76:79], v[48:51], v[244:247]
    v_mfma_f32_16x16x32_bf16 v[248:251], v[80:83], v[48:51], v[248:251]
    ds_read_b128 v[48:51], v18 offset:19712
    s_waitcnt lgkmcnt(3)
    v_mfma_f32_16x16x32_bf16 v[204:207], v[84:87], v[28:31], v[204:207]
    s_barrier
    ds_read_b64_tr_b16 v[76:77], v24 offset:16384
    v_mfma_f32_16x16x32_bf16 v[208:211], v[88:91], v[28:31], v[208:211]
    ds_read_b128 v[28:31], v18 offset:24576
    v_mfma_f32_16x16x32_bf16 v[212:215], v[84:87], v[32:35], v[212:215]
    ds_read_b64_tr_b16 v[78:79], v24 offset:20480
    v_mfma_f32_16x16x32_bf16 v[216:219], v[88:91], v[32:35], v[216:219]
    ds_read_b128 v[32:35], v18 offset:24832
    v_mfma_f32_16x16x32_bf16 v[220:223], v[84:87], v[36:39], v[220:223]
    ds_read_b64_tr_b16 v[80:81], v25 offset:16384
    v_mfma_f32_16x16x32_bf16 v[224:227], v[88:91], v[36:39], v[224:227]
    ds_read_b128 v[36:39], v18 offset:25088
    s_waitcnt lgkmcnt(8)
    v_mfma_f32_16x16x32_bf16 v[228:231], v[84:87], v[40:43], v[228:231]
    ds_read_b64_tr_b16 v[82:83], v25 offset:20480
    v_mfma_f32_16x16x32_bf16 v[232:235], v[88:91], v[40:43], v[232:235]
    ds_read_b128 v[40:43], v18 offset:25344
    s_waitcnt lgkmcnt(9)
    v_mfma_f32_16x16x32_bf16 v[236:239], v[84:87], v[44:47], v[236:239]
    v_mfma_f32_16x16x32_bf16 v[240:243], v[88:91], v[44:47], v[240:243]
    ds_read_b128 v[44:47], v18 offset:25600
    s_waitcnt lgkmcnt(9)
    v_mfma_f32_16x16x32_bf16 v[244:247], v[84:87], v[48:51], v[244:247]
    v_mfma_f32_16x16x32_bf16 v[248:251], v[88:91], v[48:51], v[248:251]
    ds_read_b128 v[48:51], v18 offset:25856
    s_waitcnt lgkmcnt(3)
    v_mfma_f32_16x16x32_bf16 v[204:207], v[76:79], v[28:31], v[204:207]
    ds_read_b64_tr_b16 v[84:85], v24 offset:24576
    v_mfma_f32_16x16x32_bf16 v[208:211], v[80:83], v[28:31], v[208:211]
    ds_read_b128 v[28:31], v18 offset:30720
    v_mfma_f32_16x16x32_bf16 v[212:215], v[76:79], v[32:35], v[212:215]
    ds_read_b64_tr_b16 v[86:87], v24 offset:28672
    v_mfma_f32_16x16x32_bf16 v[216:219], v[80:83], v[32:35], v[216:219]
    s_branch L_skip_3
    s_nop 0
L_stub_3:
    s_branch L_stub_4
L_skip_3:
    ds_read_b128 v[32:35], v18 offset:30976
    v_mfma_f32_16x16x32_bf16 v[220:223], v[76:79], v[36:39], v[220:223]
    ds_read_b64_tr_b16 v[88:89], v25 offset:24576
    v_mfma_f32_16x16x32_bf16 v[224:227], v[80:83], v[36:39], v[224:227]
    ds_read_b128 v[36:39], v18 offset:31232
    s_waitcnt lgkmcnt(8)
    v_mfma_f32_16x16x32_bf16 v[228:231], v[76:79], v[40:43], v[228:231]
    ds_read_b64_tr_b16 v[90:91], v25 offset:28672
    v_mfma_f32_16x16x32_bf16 v[232:235], v[80:83], v[40:43], v[232:235]
    ds_read_b128 v[40:43], v18 offset:31488
    s_waitcnt lgkmcnt(9)
    v_mfma_f32_16x16x32_bf16 v[236:239], v[76:79], v[44:47], v[236:239]
    v_mfma_f32_16x16x32_bf16 v[240:243], v[80:83], v[44:47], v[240:243]
    ds_read_b128 v[44:47], v18 offset:31744
    s_waitcnt lgkmcnt(9)
    v_mfma_f32_16x16x32_bf16 v[244:247], v[76:79], v[48:51], v[244:247]
    v_mfma_f32_16x16x32_bf16 v[248:251], v[80:83], v[48:51], v[248:251]
    ds_read_b128 v[48:51], v18 offset:32000
    s_waitcnt lgkmcnt(3)
    v_mfma_f32_16x16x32_bf16 v[204:207], v[84:87], v[28:31], v[204:207]
    s_barrier
    ds_read_b64_tr_b16 v[76:77], v24 offset:32768
    v_mfma_f32_16x16x32_bf16 v[208:211], v[88:91], v[28:31], v[208:211]
    ds_read_b128 v[28:31], v18 offset:36864
    v_mfma_f32_16x16x32_bf16 v[212:215], v[84:87], v[32:35], v[212:215]
    ds_read_b64_tr_b16 v[78:79], v24 offset:36864
    v_mfma_f32_16x16x32_bf16 v[216:219], v[88:91], v[32:35], v[216:219]
    ds_read_b128 v[32:35], v18 offset:37120
    v_mfma_f32_16x16x32_bf16 v[220:223], v[84:87], v[36:39], v[220:223]
    ds_read_b64_tr_b16 v[80:81], v25 offset:32768
    v_mfma_f32_16x16x32_bf16 v[224:227], v[88:91], v[36:39], v[224:227]
    ds_read_b128 v[36:39], v18 offset:37376
    s_waitcnt lgkmcnt(8)
    v_mfma_f32_16x16x32_bf16 v[228:231], v[84:87], v[40:43], v[228:231]
    ds_read_b64_tr_b16 v[82:83], v25 offset:36864
    v_mfma_f32_16x16x32_bf16 v[232:235], v[88:91], v[40:43], v[232:235]
    ds_read_b128 v[40:43], v18 offset:37632
    s_waitcnt lgkmcnt(9)
    v_mfma_f32_16x16x32_bf16 v[236:239], v[84:87], v[44:47], v[236:239]
    v_mfma_f32_16x16x32_bf16 v[240:243], v[88:91], v[44:47], v[240:243]
    ds_read_b128 v[44:47], v18 offset:37888
    s_waitcnt lgkmcnt(9)
    v_mfma_f32_16x16x32_bf16 v[244:247], v[84:87], v[48:51], v[244:247]
    v_mfma_f32_16x16x32_bf16 v[248:251], v[88:91], v[48:51], v[248:251]
    ds_read_b128 v[48:51], v18 offset:38144
    s_waitcnt lgkmcnt(3)
    v_mfma_f32_16x16x32_bf16 v[204:207], v[76:79], v[28:31], v[204:207]
    ds_read_b64_tr_b16 v[84:85], v24 offset:40960
    v_mfma_f32_16x16x32_bf16 v[208:211], v[80:83], v[28:31], v[208:211]
    ds_read_b128 v[28:31], v18 offset:43008
    v_mfma_f32_16x16x32_bf16 v[212:215], v[76:79], v[32:35], v[212:215]
    ds_read_b64_tr_b16 v[86:87], v24 offset:45056
    v_mfma_f32_16x16x32_bf16 v[216:219], v[80:83], v[32:35], v[216:219]
    ds_read_b128 v[32:35], v18 offset:43264
    v_mfma_f32_16x16x32_bf16 v[220:223], v[76:79], v[36:39], v[220:223]
    ds_read_b64_tr_b16 v[88:89], v25 offset:40960
    v_mfma_f32_16x16x32_bf16 v[224:227], v[80:83], v[36:39], v[224:227]
    ds_read_b128 v[36:39], v18 offset:43520
    s_waitcnt lgkmcnt(8)
    v_mfma_f32_16x16x32_bf16 v[228:231], v[76:79], v[40:43], v[228:231]
    ds_read_b64_tr_b16 v[90:91], v25 offset:45056
    v_mfma_f32_16x16x32_bf16 v[232:235], v[80:83], v[40:43], v[232:235]
    ds_read_b128 v[40:43], v18 offset:43776
    s_waitcnt lgkmcnt(9)
    v_mfma_f32_16x16x32_bf16 v[236:239], v[76:79], v[44:47], v[236:239]
    v_mfma_f32_16x16x32_bf16 v[240:243], v[80:83], v[44:47], v[240:243]
    ds_read_b128 v[44:47], v18 offset:44032
    s_waitcnt lgkmcnt(9)
    v_mfma_f32_16x16x32_bf16 v[244:247], v[76:79], v[48:51], v[244:247]
    v_mfma_f32_16x16x32_bf16 v[248:251], v[80:83], v[48:51], v[248:251]
    ds_read_b128 v[48:51], v18 offset:44288
    s_waitcnt lgkmcnt(3)
    v_mfma_f32_16x16x32_bf16 v[204:207], v[84:87], v[28:31], v[204:207]
    s_barrier
    ds_read_b64_tr_b16 v[76:77], v20 offset:0
    v_mfma_f32_16x16x32_bf16 v[208:211], v[88:91], v[28:31], v[208:211]
    ds_read_b128 v[28:31], v18 offset:49152
    v_mfma_f32_16x16x32_bf16 v[212:215], v[84:87], v[32:35], v[212:215]
    ds_read_b64_tr_b16 v[78:79], v20 offset:4096
    v_mfma_f32_16x16x32_bf16 v[216:219], v[88:91], v[32:35], v[216:219]
    ds_read_b128 v[32:35], v18 offset:49408
    v_mfma_f32_16x16x32_bf16 v[220:223], v[84:87], v[36:39], v[220:223]
    ds_read_b64_tr_b16 v[80:81], v21 offset:0
    v_mfma_f32_16x16x32_bf16 v[224:227], v[88:91], v[36:39], v[224:227]
    ds_read_b128 v[36:39], v18 offset:49664
    s_waitcnt lgkmcnt(8)
    v_mfma_f32_16x16x32_bf16 v[228:231], v[84:87], v[40:43], v[228:231]
    ds_read_b64_tr_b16 v[82:83], v21 offset:4096
    v_mfma_f32_16x16x32_bf16 v[232:235], v[88:91], v[40:43], v[232:235]
    ds_read_b128 v[40:43], v18 offset:49920
    s_waitcnt lgkmcnt(9)
    v_mfma_f32_16x16x32_bf16 v[236:239], v[84:87], v[44:47], v[236:239]
    v_mfma_f32_16x16x32_bf16 v[240:243], v[88:91], v[44:47], v[240:243]
    ds_read_b128 v[44:47], v18 offset:50176
    s_waitcnt lgkmcnt(9)
    v_mfma_f32_16x16x32_bf16 v[244:247], v[84:87], v[48:51], v[244:247]
    v_mfma_f32_16x16x32_bf16 v[248:251], v[88:91], v[48:51], v[248:251]
    ds_read_b128 v[48:51], v18 offset:50432
    s_waitcnt lgkmcnt(3)
    v_mfma_f32_16x16x32_bf16 v[204:207], v[76:79], v[28:31], v[204:207]
    ds_read_b64_tr_b16 v[84:85], v20 offset:8192
    v_mfma_f32_16x16x32_bf16 v[208:211], v[80:83], v[28:31], v[208:211]
    ds_read_b128 v[28:31], v18 offset:55296
    v_mfma_f32_16x16x32_bf16 v[212:215], v[76:79], v[32:35], v[212:215]
    ds_read_b64_tr_b16 v[86:87], v20 offset:12288
    v_mfma_f32_16x16x32_bf16 v[216:219], v[80:83], v[32:35], v[216:219]
    ds_read_b128 v[32:35], v18 offset:55552
    v_mfma_f32_16x16x32_bf16 v[220:223], v[76:79], v[36:39], v[220:223]
    ds_read_b64_tr_b16 v[88:89], v21 offset:8192
    v_mfma_f32_16x16x32_bf16 v[224:227], v[80:83], v[36:39], v[224:227]
    ds_read_b128 v[36:39], v18 offset:55808
    s_waitcnt lgkmcnt(8)
    v_mfma_f32_16x16x32_bf16 v[228:231], v[76:79], v[40:43], v[228:231]
    ds_read_b64_tr_b16 v[90:91], v21 offset:12288
    v_mfma_f32_16x16x32_bf16 v[232:235], v[80:83], v[40:43], v[232:235]
    ds_read_b128 v[40:43], v18 offset:56064
    s_waitcnt lgkmcnt(9)
    v_mfma_f32_16x16x32_bf16 v[236:239], v[76:79], v[44:47], v[236:239]
    v_mfma_f32_16x16x32_bf16 v[240:243], v[80:83], v[44:47], v[240:243]
    ds_read_b128 v[44:47], v18 offset:56320
    s_waitcnt lgkmcnt(9)
    v_mfma_f32_16x16x32_bf16 v[244:247], v[76:79], v[48:51], v[244:247]
    v_mfma_f32_16x16x32_bf16 v[248:251], v[80:83], v[48:51], v[248:251]
    ds_read_b128 v[48:51], v18 offset:56576
    s_waitcnt lgkmcnt(3)
    v_mfma_f32_16x16x32_bf16 v[204:207], v[84:87], v[28:31], v[204:207]
    s_barrier
    ds_read_b64_tr_b16 v[76:77], v20 offset:16384
    v_mfma_f32_16x16x32_bf16 v[208:211], v[88:91], v[28:31], v[208:211]
    ds_read_b128 v[28:31], v18 offset:0
    v_mfma_f32_16x16x32_bf16 v[212:215], v[84:87], v[32:35], v[212:215]
    ds_read_b64_tr_b16 v[78:79], v20 offset:20480
    v_mfma_f32_16x16x32_bf16 v[216:219], v[88:91], v[32:35], v[216:219]
    ds_read_b128 v[32:35], v18 offset:256
    v_mfma_f32_16x16x32_bf16 v[220:223], v[84:87], v[36:39], v[220:223]
    ds_read_b64_tr_b16 v[80:81], v21 offset:16384
    v_mfma_f32_16x16x32_bf16 v[224:227], v[88:91], v[36:39], v[224:227]
    ds_read_b128 v[36:39], v18 offset:512
    s_waitcnt lgkmcnt(8)
    v_mfma_f32_16x16x32_bf16 v[228:231], v[84:87], v[40:43], v[228:231]
    ds_read_b64_tr_b16 v[82:83], v21 offset:20480
    v_mfma_f32_16x16x32_bf16 v[232:235], v[88:91], v[40:43], v[232:235]
    ds_read_b128 v[40:43], v18 offset:768
    s_waitcnt lgkmcnt(9)
    v_mfma_f32_16x16x32_bf16 v[236:239], v[84:87], v[44:47], v[236:239]
    v_mfma_f32_16x16x32_bf16 v[240:243], v[88:91], v[44:47], v[240:243]
    ds_read_b128 v[44:47], v18 offset:1024
    s_waitcnt lgkmcnt(9)
    v_mfma_f32_16x16x32_bf16 v[244:247], v[84:87], v[48:51], v[244:247]
    v_mfma_f32_16x16x32_bf16 v[248:251], v[88:91], v[48:51], v[248:251]
    ds_read_b128 v[48:51], v18 offset:1280
    s_waitcnt lgkmcnt(3)
    v_mfma_f32_16x16x32_bf16 v[204:207], v[76:79], v[28:31], v[204:207]
    ds_read_b64_tr_b16 v[84:85], v20 offset:24576
    v_mfma_f32_16x16x32_bf16 v[208:211], v[80:83], v[28:31], v[208:211]
    ds_read_b128 v[28:31], v18 offset:6144
    v_mfma_f32_16x16x32_bf16 v[212:215], v[76:79], v[32:35], v[212:215]
    ds_read_b64_tr_b16 v[86:87], v20 offset:28672
    v_mfma_f32_16x16x32_bf16 v[216:219], v[80:83], v[32:35], v[216:219]
    ds_read_b128 v[32:35], v18 offset:6400
    v_mfma_f32_16x16x32_bf16 v[220:223], v[76:79], v[36:39], v[220:223]
    ds_read_b64_tr_b16 v[88:89], v21 offset:24576
    v_mfma_f32_16x16x32_bf16 v[224:227], v[80:83], v[36:39], v[224:227]
    ds_read_b128 v[36:39], v18 offset:6656
    s_waitcnt lgkmcnt(8)
    v_mfma_f32_16x16x32_bf16 v[228:231], v[76:79], v[40:43], v[228:231]
    ds_read_b64_tr_b16 v[90:91], v21 offset:28672
    v_mfma_f32_16x16x32_bf16 v[232:235], v[80:83], v[40:43], v[232:235]
    ds_read_b128 v[40:43], v18 offset:6912
    s_waitcnt lgkmcnt(9)
    v_mfma_f32_16x16x32_bf16 v[236:239], v[76:79], v[44:47], v[236:239]
    v_mfma_f32_16x16x32_bf16 v[240:243], v[80:83], v[44:47], v[240:243]
    ds_read_b128 v[44:47], v18 offset:7168
    s_waitcnt lgkmcnt(9)
    v_mfma_f32_16x16x32_bf16 v[244:247], v[76:79], v[48:51], v[244:247]
    v_mfma_f32_16x16x32_bf16 v[248:251], v[80:83], v[48:51], v[248:251]
    ds_read_b128 v[48:51], v18 offset:7424
    s_waitcnt lgkmcnt(3)
    v_mfma_f32_16x16x32_bf16 v[204:207], v[84:87], v[28:31], v[204:207]
    s_barrier
    v_mfma_f32_16x16x32_bf16 v[208:211], v[88:91], v[28:31], v[208:211]
    ds_read_b128 v[28:31], v18 offset:12288
    v_mfma_f32_16x16x32_bf16 v[212:215], v[84:87], v[32:35], v[212:215]
    v_mfma_f32_16x16x32_bf16 v[216:219], v[88:91], v[32:35], v[216:219]
    ds_read_b128 v[32:35], v18 offset:12544
    v_mfma_f32_16x16x32_bf16 v[220:223], v[84:87], v[36:39], v[220:223]
    v_mfma_f32_16x16x32_bf16 v[224:227], v[88:91], v[36:39], v[224:227]
    ds_read_b128 v[36:39], v18 offset:12800
    s_waitcnt lgkmcnt(5)
    v_mfma_f32_16x16x32_bf16 v[228:231], v[84:87], v[40:43], v[228:231]
    v_mfma_f32_16x16x32_bf16 v[232:235], v[88:91], v[40:43], v[232:235]
    ds_read_b128 v[40:43], v18 offset:13056
    s_waitcnt lgkmcnt(5)
    v_mfma_f32_16x16x32_bf16 v[236:239], v[84:87], v[44:47], v[236:239]
    v_mfma_f32_16x16x32_bf16 v[240:243], v[88:91], v[44:47], v[240:243]
    ds_read_b128 v[44:47], v18 offset:13312
    s_waitcnt lgkmcnt(5)
    v_mfma_f32_16x16x32_bf16 v[244:247], v[84:87], v[48:51], v[244:247]
    v_mfma_f32_16x16x32_bf16 v[248:251], v[88:91], v[48:51], v[248:251]
    ds_read_b128 v[48:51], v18 offset:13568
    s_waitcnt lgkmcnt(3)
    v_mfma_f32_16x16x32_bf16 v[204:207], v[92:95], v[28:31], v[204:207]
    v_mfma_f32_16x16x32_bf16 v[208:211], v[96:99], v[28:31], v[208:211]
    ds_read_b128 v[28:31], v18 offset:18432
    v_mfma_f32_16x16x32_bf16 v[212:215], v[92:95], v[32:35], v[212:215]
    v_mfma_f32_16x16x32_bf16 v[216:219], v[96:99], v[32:35], v[216:219]
    ds_read_b128 v[32:35], v18 offset:18688
    v_mfma_f32_16x16x32_bf16 v[220:223], v[92:95], v[36:39], v[220:223]
    v_mfma_f32_16x16x32_bf16 v[224:227], v[96:99], v[36:39], v[224:227]
    ds_read_b128 v[36:39], v18 offset:18944
    s_waitcnt lgkmcnt(5)
    v_mfma_f32_16x16x32_bf16 v[228:231], v[92:95], v[40:43], v[228:231]
    v_mfma_f32_16x16x32_bf16 v[232:235], v[96:99], v[40:43], v[232:235]
    ds_read_b128 v[40:43], v18 offset:19200
    s_waitcnt lgkmcnt(5)
    v_mfma_f32_16x16x32_bf16 v[236:239], v[92:95], v[44:47], v[236:239]
    v_mfma_f32_16x16x32_bf16 v[240:243], v[96:99], v[44:47], v[240:243]
    ds_read_b128 v[44:47], v18 offset:19456
    s_waitcnt lgkmcnt(5)
    v_mfma_f32_16x16x32_bf16 v[244:247], v[92:95], v[48:51], v[244:247]
    v_mfma_f32_16x16x32_bf16 v[248:251], v[96:99], v[48:51], v[248:251]
    ds_read_b128 v[48:51], v18 offset:19712
    s_waitcnt lgkmcnt(3)
    v_mfma_f32_16x16x32_bf16 v[204:207], v[100:103], v[28:31], v[204:207]
    s_barrier
    ds_read_b64_tr_b16 v[76:77], v20 offset:32768
    v_mfma_f32_16x16x32_bf16 v[208:211], v[104:107], v[28:31], v[208:211]
    ds_read_b128 v[28:31], v18 offset:24576
    v_mfma_f32_16x16x32_bf16 v[212:215], v[100:103], v[32:35], v[212:215]
    ds_read_b64_tr_b16 v[78:79], v20 offset:36864
    v_mfma_f32_16x16x32_bf16 v[216:219], v[104:107], v[32:35], v[216:219]
    ds_read_b128 v[32:35], v18 offset:24832
    v_mfma_f32_16x16x32_bf16 v[220:223], v[100:103], v[36:39], v[220:223]
    ds_read_b64_tr_b16 v[80:81], v21 offset:32768
    v_mfma_f32_16x16x32_bf16 v[224:227], v[104:107], v[36:39], v[224:227]
    ds_read_b128 v[36:39], v18 offset:25088
    s_waitcnt lgkmcnt(8)
    v_mfma_f32_16x16x32_bf16 v[228:231], v[100:103], v[40:43], v[228:231]
    ds_read_b64_tr_b16 v[82:83], v21 offset:36864
    v_mfma_f32_16x16x32_bf16 v[232:235], v[104:107], v[40:43], v[232:235]
    ds_read_b128 v[40:43], v18 offset:25344
    s_waitcnt lgkmcnt(9)
    v_mfma_f32_16x16x32_bf16 v[236:239], v[100:103], v[44:47], v[236:239]
    v_mfma_f32_16x16x32_bf16 v[240:243], v[104:107], v[44:47], v[240:243]
    ds_read_b128 v[44:47], v18 offset:25600
    s_waitcnt lgkmcnt(9)
    v_mfma_f32_16x16x32_bf16 v[244:247], v[100:103], v[48:51], v[244:247]
    v_mfma_f32_16x16x32_bf16 v[248:251], v[104:107], v[48:51], v[248:251]
    ds_read_b128 v[48:51], v18 offset:25856
    s_waitcnt lgkmcnt(3)
    v_mfma_f32_16x16x32_bf16 v[204:207], v[76:79], v[28:31], v[204:207]
    ds_read_b64_tr_b16 v[84:85], v20 offset:40960
    v_mfma_f32_16x16x32_bf16 v[208:211], v[80:83], v[28:31], v[208:211]
    ds_read_b128 v[28:31], v18 offset:30720
    v_mfma_f32_16x16x32_bf16 v[212:215], v[76:79], v[32:35], v[212:215]
    ds_read_b64_tr_b16 v[86:87], v20 offset:45056
    v_mfma_f32_16x16x32_bf16 v[216:219], v[80:83], v[32:35], v[216:219]
    ds_read_b128 v[32:35], v18 offset:30976
    v_mfma_f32_16x16x32_bf16 v[220:223], v[76:79], v[36:39], v[220:223]
    ds_read_b64_tr_b16 v[88:89], v21 offset:40960
    v_mfma_f32_16x16x32_bf16 v[224:227], v[80:83], v[36:39], v[224:227]
    ds_read_b128 v[36:39], v18 offset:31232
    s_waitcnt lgkmcnt(8)
    v_mfma_f32_16x16x32_bf16 v[228:231], v[76:79], v[40:43], v[228:231]
    ds_read_b64_tr_b16 v[90:91], v21 offset:45056
    v_mfma_f32_16x16x32_bf16 v[232:235], v[80:83], v[40:43], v[232:235]
    ds_read_b128 v[40:43], v18 offset:31488
    s_waitcnt lgkmcnt(9)
    v_mfma_f32_16x16x32_bf16 v[236:239], v[76:79], v[44:47], v[236:239]
    v_mfma_f32_16x16x32_bf16 v[240:243], v[80:83], v[44:47], v[240:243]
    ds_read_b128 v[44:47], v18 offset:31744
    s_waitcnt lgkmcnt(9)
    v_mfma_f32_16x16x32_bf16 v[244:247], v[76:79], v[48:51], v[244:247]
    v_mfma_f32_16x16x32_bf16 v[248:251], v[80:83], v[48:51], v[248:251]
    ds_read_b128 v[48:51], v18 offset:32000
    s_waitcnt lgkmcnt(3)
    v_mfma_f32_16x16x32_bf16 v[204:207], v[84:87], v[28:31], v[204:207]
    s_barrier
    ds_read_b64_tr_b16 v[76:77], v24 offset:0
    v_mfma_f32_16x16x32_bf16 v[208:211], v[88:91], v[28:31], v[208:211]
    ds_read_b128 v[28:31], v18 offset:36864
    v_mfma_f32_16x16x32_bf16 v[212:215], v[84:87], v[32:35], v[212:215]
    ds_read_b64_tr_b16 v[78:79], v24 offset:4096
    v_mfma_f32_16x16x32_bf16 v[216:219], v[88:91], v[32:35], v[216:219]
    ds_read_b128 v[32:35], v18 offset:37120
    v_mfma_f32_16x16x32_bf16 v[220:223], v[84:87], v[36:39], v[220:223]
    ds_read_b64_tr_b16 v[80:81], v25 offset:0
    v_mfma_f32_16x16x32_bf16 v[224:227], v[88:91], v[36:39], v[224:227]
    ds_read_b128 v[36:39], v18 offset:37376
    s_waitcnt lgkmcnt(8)
    v_mfma_f32_16x16x32_bf16 v[228:231], v[84:87], v[40:43], v[228:231]
    ds_read_b64_tr_b16 v[82:83], v25 offset:4096
    v_mfma_f32_16x16x32_bf16 v[232:235], v[88:91], v[40:43], v[232:235]
    ds_read_b128 v[40:43], v18 offset:37632
    s_waitcnt lgkmcnt(9)
    v_mfma_f32_16x16x32_bf16 v[236:239], v[84:87], v[44:47], v[236:239]
    v_mfma_f32_16x16x32_bf16 v[240:243], v[88:91], v[44:47], v[240:243]
    ds_read_b128 v[44:47], v18 offset:37888
    s_waitcnt lgkmcnt(9)
    v_mfma_f32_16x16x32_bf16 v[244:247], v[84:87], v[48:51], v[244:247]
    v_mfma_f32_16x16x32_bf16 v[248:251], v[88:91], v[48:51], v[248:251]
    ds_read_b128 v[48:51], v18 offset:38144
    s_waitcnt lgkmcnt(3)
    v_mfma_f32_16x16x32_bf16 v[204:207], v[76:79], v[28:31], v[204:207]
    ds_read_b64_tr_b16 v[84:85], v24 offset:8192
    v_mfma_f32_16x16x32_bf16 v[208:211], v[80:83], v[28:31], v[208:211]
    ds_read_b128 v[28:31], v18 offset:43008
    v_mfma_f32_16x16x32_bf16 v[212:215], v[76:79], v[32:35], v[212:215]
    ds_read_b64_tr_b16 v[86:87], v24 offset:12288
    v_mfma_f32_16x16x32_bf16 v[216:219], v[80:83], v[32:35], v[216:219]
    ds_read_b128 v[32:35], v18 offset:43264
    v_mfma_f32_16x16x32_bf16 v[220:223], v[76:79], v[36:39], v[220:223]
    ds_read_b64_tr_b16 v[88:89], v25 offset:8192
    v_mfma_f32_16x16x32_bf16 v[224:227], v[80:83], v[36:39], v[224:227]
    ds_read_b128 v[36:39], v18 offset:43520
    s_waitcnt lgkmcnt(8)
    v_mfma_f32_16x16x32_bf16 v[228:231], v[76:79], v[40:43], v[228:231]
    ds_read_b64_tr_b16 v[90:91], v25 offset:12288
    v_mfma_f32_16x16x32_bf16 v[232:235], v[80:83], v[40:43], v[232:235]
    ds_read_b128 v[40:43], v18 offset:43776
    s_waitcnt lgkmcnt(9)
    v_mfma_f32_16x16x32_bf16 v[236:239], v[76:79], v[44:47], v[236:239]
    v_mfma_f32_16x16x32_bf16 v[240:243], v[80:83], v[44:47], v[240:243]
    ds_read_b128 v[44:47], v18 offset:44032
    s_waitcnt lgkmcnt(9)
    v_mfma_f32_16x16x32_bf16 v[244:247], v[76:79], v[48:51], v[244:247]
    v_mfma_f32_16x16x32_bf16 v[248:251], v[80:83], v[48:51], v[248:251]
    ds_read_b128 v[48:51], v18 offset:44288
    s_waitcnt lgkmcnt(3)
    v_mfma_f32_16x16x32_bf16 v[204:207], v[84:87], v[28:31], v[204:207]
    s_barrier
    v_mfma_f32_16x16x32_bf16 v[208:211], v[88:91], v[28:31], v[208:211]
    ds_read_b128 v[28:31], v18 offset:49152
    v_mfma_f32_16x16x32_bf16 v[212:215], v[84:87], v[32:35], v[212:215]
    v_mfma_f32_16x16x32_bf16 v[216:219], v[88:91], v[32:35], v[216:219]
    ds_read_b128 v[32:35], v18 offset:49408
    v_mfma_f32_16x16x32_bf16 v[220:223], v[84:87], v[36:39], v[220:223]
    v_mfma_f32_16x16x32_bf16 v[224:227], v[88:91], v[36:39], v[224:227]
    ds_read_b128 v[36:39], v18 offset:49664
    s_waitcnt lgkmcnt(5)
    v_mfma_f32_16x16x32_bf16 v[228:231], v[84:87], v[40:43], v[228:231]
    v_mfma_f32_16x16x32_bf16 v[232:235], v[88:91], v[40:43], v[232:235]
    ds_read_b128 v[40:43], v18 offset:49920
    s_waitcnt lgkmcnt(5)
    v_mfma_f32_16x16x32_bf16 v[236:239], v[84:87], v[44:47], v[236:239]
    v_mfma_f32_16x16x32_bf16 v[240:243], v[88:91], v[44:47], v[240:243]
    ds_read_b128 v[44:47], v18 offset:50176
    s_waitcnt lgkmcnt(5)
    v_mfma_f32_16x16x32_bf16 v[244:247], v[84:87], v[48:51], v[244:247]
    v_mfma_f32_16x16x32_bf16 v[248:251], v[88:91], v[48:51], v[248:251]
    ds_read_b128 v[48:51], v18 offset:50432
    s_waitcnt lgkmcnt(3)
    v_mfma_f32_16x16x32_bf16 v[204:207], v[108:111], v[28:31], v[204:207]
    v_mfma_f32_16x16x32_bf16 v[208:211], v[112:115], v[28:31], v[208:211]
    ds_read_b128 v[28:31], v18 offset:55296
    v_mfma_f32_16x16x32_bf16 v[212:215], v[108:111], v[32:35], v[212:215]
    v_mfma_f32_16x16x32_bf16 v[216:219], v[112:115], v[32:35], v[216:219]
    ds_read_b128 v[32:35], v18 offset:55552
    v_mfma_f32_16x16x32_bf16 v[220:223], v[108:111], v[36:39], v[220:223]
    v_mfma_f32_16x16x32_bf16 v[224:227], v[112:115], v[36:39], v[224:227]
    ds_read_b128 v[36:39], v18 offset:55808
    s_waitcnt lgkmcnt(5)
    v_mfma_f32_16x16x32_bf16 v[228:231], v[108:111], v[40:43], v[228:231]
    v_mfma_f32_16x16x32_bf16 v[232:235], v[112:115], v[40:43], v[232:235]
    ds_read_b128 v[40:43], v18 offset:56064
    s_waitcnt lgkmcnt(5)
    v_mfma_f32_16x16x32_bf16 v[236:239], v[108:111], v[44:47], v[236:239]
    v_mfma_f32_16x16x32_bf16 v[240:243], v[112:115], v[44:47], v[240:243]
    ds_read_b128 v[44:47], v18 offset:56320
    s_waitcnt lgkmcnt(5)
    v_mfma_f32_16x16x32_bf16 v[244:247], v[108:111], v[48:51], v[244:247]
    v_mfma_f32_16x16x32_bf16 v[248:251], v[112:115], v[48:51], v[248:251]
    ds_read_b128 v[48:51], v18 offset:56576
    s_waitcnt lgkmcnt(3)
    v_mfma_f32_16x16x32_bf16 v[204:207], v[116:119], v[28:31], v[204:207]
    s_barrier
    ds_read_b64_tr_b16 v[76:77], v24 offset:16384
    v_mfma_f32_16x16x32_bf16 v[208:211], v[120:123], v[28:31], v[208:211]
    ds_read_b128 v[28:31], v18 offset:0
    v_mfma_f32_16x16x32_bf16 v[212:215], v[116:119], v[32:35], v[212:215]
    ds_read_b64_tr_b16 v[78:79], v24 offset:20480
    v_mfma_f32_16x16x32_bf16 v[216:219], v[120:123], v[32:35], v[216:219]
    ds_read_b128 v[32:35], v18 offset:256
    v_mfma_f32_16x16x32_bf16 v[220:223], v[116:119], v[36:39], v[220:223]
    ds_read_b64_tr_b16 v[80:81], v25 offset:16384
    v_mfma_f32_16x16x32_bf16 v[224:227], v[120:123], v[36:39], v[224:227]
    ds_read_b128 v[36:39], v18 offset:512
    s_waitcnt lgkmcnt(8)
    v_mfma_f32_16x16x32_bf16 v[228:231], v[116:119], v[40:43], v[228:231]
    ds_read_b64_tr_b16 v[82:83], v25 offset:20480
    v_mfma_f32_16x16x32_bf16 v[232:235], v[120:123], v[40:43], v[232:235]
    ds_read_b128 v[40:43], v18 offset:768
    s_waitcnt lgkmcnt(9)
    v_mfma_f32_16x16x32_bf16 v[236:239], v[116:119], v[44:47], v[236:239]
    v_mfma_f32_16x16x32_bf16 v[240:243], v[120:123], v[44:47], v[240:243]
    ds_read_b128 v[44:47], v18 offset:1024
    s_waitcnt lgkmcnt(9)
    v_mfma_f32_16x16x32_bf16 v[244:247], v[116:119], v[48:51], v[244:247]
    v_mfma_f32_16x16x32_bf16 v[248:251], v[120:123], v[48:51], v[248:251]
    ds_read_b128 v[48:51], v18 offset:1280
    s_waitcnt lgkmcnt(3)
    v_mfma_f32_16x16x32_bf16 v[204:207], v[76:79], v[28:31], v[204:207]
    ds_read_b64_tr_b16 v[84:85], v24 offset:24576
    v_mfma_f32_16x16x32_bf16 v[208:211], v[80:83], v[28:31], v[208:211]
    ds_read_b128 v[28:31], v18 offset:6144
    v_mfma_f32_16x16x32_bf16 v[212:215], v[76:79], v[32:35], v[212:215]
    ds_read_b64_tr_b16 v[86:87], v24 offset:28672
    v_mfma_f32_16x16x32_bf16 v[216:219], v[80:83], v[32:35], v[216:219]
    ds_read_b128 v[32:35], v18 offset:6400
    v_mfma_f32_16x16x32_bf16 v[220:223], v[76:79], v[36:39], v[220:223]
    ds_read_b64_tr_b16 v[88:89], v25 offset:24576
    v_mfma_f32_16x16x32_bf16 v[224:227], v[80:83], v[36:39], v[224:227]
    ds_read_b128 v[36:39], v18 offset:6656
    s_waitcnt lgkmcnt(8)
    v_mfma_f32_16x16x32_bf16 v[228:231], v[76:79], v[40:43], v[228:231]
    ds_read_b64_tr_b16 v[90:91], v25 offset:28672
    v_mfma_f32_16x16x32_bf16 v[232:235], v[80:83], v[40:43], v[232:235]
    ds_read_b128 v[40:43], v18 offset:6912
    s_waitcnt lgkmcnt(9)
    v_mfma_f32_16x16x32_bf16 v[236:239], v[76:79], v[44:47], v[236:239]
    v_mfma_f32_16x16x32_bf16 v[240:243], v[80:83], v[44:47], v[240:243]
    ds_read_b128 v[44:47], v18 offset:7168
    s_waitcnt lgkmcnt(9)
    v_mfma_f32_16x16x32_bf16 v[244:247], v[76:79], v[48:51], v[244:247]
    v_mfma_f32_16x16x32_bf16 v[248:251], v[80:83], v[48:51], v[248:251]
    ds_read_b128 v[48:51], v18 offset:7424
    s_waitcnt lgkmcnt(3)
    v_mfma_f32_16x16x32_bf16 v[204:207], v[84:87], v[28:31], v[204:207]
    s_barrier
    ds_read_b64_tr_b16 v[76:77], v24 offset:32768
    v_mfma_f32_16x16x32_bf16 v[208:211], v[88:91], v[28:31], v[208:211]
    ds_read_b128 v[28:31], v18 offset:12288
    v_mfma_f32_16x16x32_bf16 v[212:215], v[84:87], v[32:35], v[212:215]
    ds_read_b64_tr_b16 v[78:79], v24 offset:36864
    v_mfma_f32_16x16x32_bf16 v[216:219], v[88:91], v[32:35], v[216:219]
    ds_read_b128 v[32:35], v18 offset:12544
    v_mfma_f32_16x16x32_bf16 v[220:223], v[84:87], v[36:39], v[220:223]
    ds_read_b64_tr_b16 v[80:81], v25 offset:32768
    v_mfma_f32_16x16x32_bf16 v[224:227], v[88:91], v[36:39], v[224:227]
    ds_read_b128 v[36:39], v18 offset:12800
    s_waitcnt lgkmcnt(8)
    v_mfma_f32_16x16x32_bf16 v[228:231], v[84:87], v[40:43], v[228:231]
    ds_read_b64_tr_b16 v[82:83], v25 offset:36864
    v_mfma_f32_16x16x32_bf16 v[232:235], v[88:91], v[40:43], v[232:235]
    ds_read_b128 v[40:43], v18 offset:13056
    s_waitcnt lgkmcnt(9)
    v_mfma_f32_16x16x32_bf16 v[236:239], v[84:87], v[44:47], v[236:239]
    v_mfma_f32_16x16x32_bf16 v[240:243], v[88:91], v[44:47], v[240:243]
    ds_read_b128 v[44:47], v18 offset:13312
    s_waitcnt lgkmcnt(9)
    v_mfma_f32_16x16x32_bf16 v[244:247], v[84:87], v[48:51], v[244:247]
    v_mfma_f32_16x16x32_bf16 v[248:251], v[88:91], v[48:51], v[248:251]
    ds_read_b128 v[48:51], v18 offset:13568
    s_waitcnt lgkmcnt(3)
    v_mfma_f32_16x16x32_bf16 v[204:207], v[76:79], v[28:31], v[204:207]
    ds_read_b64_tr_b16 v[84:85], v24 offset:40960
    v_mfma_f32_16x16x32_bf16 v[208:211], v[80:83], v[28:31], v[208:211]
    ds_read_b128 v[28:31], v18 offset:18432
    v_mfma_f32_16x16x32_bf16 v[212:215], v[76:79], v[32:35], v[212:215]
    ds_read_b64_tr_b16 v[86:87], v24 offset:45056
    v_mfma_f32_16x16x32_bf16 v[216:219], v[80:83], v[32:35], v[216:219]
    ds_read_b128 v[32:35], v18 offset:18688
    v_mfma_f32_16x16x32_bf16 v[220:223], v[76:79], v[36:39], v[220:223]
    ds_read_b64_tr_b16 v[88:89], v25 offset:40960
    v_mfma_f32_16x16x32_bf16 v[224:227], v[80:83], v[36:39], v[224:227]
    ds_read_b128 v[36:39], v18 offset:18944
    s_waitcnt lgkmcnt(8)
    v_mfma_f32_16x16x32_bf16 v[228:231], v[76:79], v[40:43], v[228:231]
    ds_read_b64_tr_b16 v[90:91], v25 offset:45056
    v_mfma_f32_16x16x32_bf16 v[232:235], v[80:83], v[40:43], v[232:235]
    ds_read_b128 v[40:43], v18 offset:19200
    s_waitcnt lgkmcnt(9)
    v_mfma_f32_16x16x32_bf16 v[236:239], v[76:79], v[44:47], v[236:239]
    v_mfma_f32_16x16x32_bf16 v[240:243], v[80:83], v[44:47], v[240:243]
    ds_read_b128 v[44:47], v18 offset:19456
    s_waitcnt lgkmcnt(9)
    v_mfma_f32_16x16x32_bf16 v[244:247], v[76:79], v[48:51], v[244:247]
    v_mfma_f32_16x16x32_bf16 v[248:251], v[80:83], v[48:51], v[248:251]
    ds_read_b128 v[48:51], v18 offset:19712
    s_waitcnt lgkmcnt(3)
    v_mfma_f32_16x16x32_bf16 v[204:207], v[84:87], v[28:31], v[204:207]
    s_barrier
    v_mfma_f32_16x16x32_bf16 v[208:211], v[88:91], v[28:31], v[208:211]
    ds_read_b128 v[28:31], v18 offset:24576
    v_mfma_f32_16x16x32_bf16 v[212:215], v[84:87], v[32:35], v[212:215]
    v_mfma_f32_16x16x32_bf16 v[216:219], v[88:91], v[32:35], v[216:219]
    ds_read_b128 v[32:35], v18 offset:24832
    v_mfma_f32_16x16x32_bf16 v[220:223], v[84:87], v[36:39], v[220:223]
    v_mfma_f32_16x16x32_bf16 v[224:227], v[88:91], v[36:39], v[224:227]
    ds_read_b128 v[36:39], v18 offset:25088
    s_waitcnt lgkmcnt(5)
    v_mfma_f32_16x16x32_bf16 v[228:231], v[84:87], v[40:43], v[228:231]
    v_mfma_f32_16x16x32_bf16 v[232:235], v[88:91], v[40:43], v[232:235]
    ds_read_b128 v[40:43], v18 offset:25344
    s_waitcnt lgkmcnt(5)
    v_mfma_f32_16x16x32_bf16 v[236:239], v[84:87], v[44:47], v[236:239]
    v_mfma_f32_16x16x32_bf16 v[240:243], v[88:91], v[44:47], v[240:243]
    ds_read_b128 v[44:47], v18 offset:25600
    s_waitcnt lgkmcnt(5)
    v_mfma_f32_16x16x32_bf16 v[244:247], v[84:87], v[48:51], v[244:247]
    v_mfma_f32_16x16x32_bf16 v[248:251], v[88:91], v[48:51], v[248:251]
    ds_read_b128 v[48:51], v18 offset:25856
    s_waitcnt lgkmcnt(3)
    v_mfma_f32_16x16x32_bf16 v[204:207], v[124:127], v[28:31], v[204:207]
    v_mfma_f32_16x16x32_bf16 v[208:211], v[128:131], v[28:31], v[208:211]
    ds_read_b128 v[28:31], v18 offset:30720
    v_mfma_f32_16x16x32_bf16 v[212:215], v[124:127], v[32:35], v[212:215]
    v_mfma_f32_16x16x32_bf16 v[216:219], v[128:131], v[32:35], v[216:219]
    ds_read_b128 v[32:35], v18 offset:30976
    v_mfma_f32_16x16x32_bf16 v[220:223], v[124:127], v[36:39], v[220:223]
    v_mfma_f32_16x16x32_bf16 v[224:227], v[128:131], v[36:39], v[224:227]
    ds_read_b128 v[36:39], v18 offset:31232
    s_waitcnt lgkmcnt(5)
    v_mfma_f32_16x16x32_bf16 v[228:231], v[124:127], v[40:43], v[228:231]
    v_mfma_f32_16x16x32_bf16 v[232:235], v[128:131], v[40:43], v[232:235]
    ds_read_b128 v[40:43], v18 offset:31488
    s_waitcnt lgkmcnt(5)
    v_mfma_f32_16x16x32_bf16 v[236:239], v[124:127], v[44:47], v[236:239]
    v_mfma_f32_16x16x32_bf16 v[240:243], v[128:131], v[44:47], v[240:243]
    ds_read_b128 v[44:47], v18 offset:31744
    s_waitcnt lgkmcnt(5)
    v_mfma_f32_16x16x32_bf16 v[244:247], v[124:127], v[48:51], v[244:247]
    v_mfma_f32_16x16x32_bf16 v[248:251], v[128:131], v[48:51], v[248:251]
    ds_read_b128 v[48:51], v18 offset:32000
    s_waitcnt lgkmcnt(3)
    v_mfma_f32_16x16x32_bf16 v[204:207], v[132:135], v[28:31], v[204:207]
    s_barrier
    ds_read_b64_tr_b16 v[76:77], v20 offset:0
    v_mfma_f32_16x16x32_bf16 v[208:211], v[136:139], v[28:31], v[208:211]
    ds_read_b128 v[28:31], v18 offset:36864
    v_mfma_f32_16x16x32_bf16 v[212:215], v[132:135], v[32:35], v[212:215]
    ds_read_b64_tr_b16 v[78:79], v20 offset:4096
    v_mfma_f32_16x16x32_bf16 v[216:219], v[136:139], v[32:35], v[216:219]
    ds_read_b128 v[32:35], v18 offset:37120
    v_mfma_f32_16x16x32_bf16 v[220:223], v[132:135], v[36:39], v[220:223]
    ds_read_b64_tr_b16 v[80:81], v21 offset:0
    v_mfma_f32_16x16x32_bf16 v[224:227], v[136:139], v[36:39], v[224:227]
    ds_read_b128 v[36:39], v18 offset:37376
    s_waitcnt lgkmcnt(8)
    v_mfma_f32_16x16x32_bf16 v[228:231], v[132:135], v[40:43], v[228:231]
    ds_read_b64_tr_b16 v[82:83], v21 offset:4096
    v_mfma_f32_16x16x32_bf16 v[232:235], v[136:139], v[40:43], v[232:235]
    ds_read_b128 v[40:43], v18 offset:37632
    s_waitcnt lgkmcnt(9)
    v_mfma_f32_16x16x32_bf16 v[236:239], v[132:135], v[44:47], v[236:239]
    v_mfma_f32_16x16x32_bf16 v[240:243], v[136:139], v[44:47], v[240:243]
    ds_read_b128 v[44:47], v18 offset:37888
    s_waitcnt lgkmcnt(9)
    v_mfma_f32_16x16x32_bf16 v[244:247], v[132:135], v[48:51], v[244:247]
    v_mfma_f32_16x16x32_bf16 v[248:251], v[136:139], v[48:51], v[248:251]
    ds_read_b128 v[48:51], v18 offset:38144
    s_waitcnt lgkmcnt(3)
    v_mfma_f32_16x16x32_bf16 v[204:207], v[76:79], v[28:31], v[204:207]
    ds_read_b64_tr_b16 v[84:85], v20 offset:8192
    v_mfma_f32_16x16x32_bf16 v[208:211], v[80:83], v[28:31], v[208:211]
    ds_read_b128 v[28:31], v18 offset:43008
    v_mfma_f32_16x16x32_bf16 v[212:215], v[76:79], v[32:35], v[212:215]
    ds_read_b64_tr_b16 v[86:87], v20 offset:12288
    v_mfma_f32_16x16x32_bf16 v[216:219], v[80:83], v[32:35], v[216:219]
    ds_read_b128 v[32:35], v18 offset:43264
    s_branch L_skip_4
    s_nop 0
L_stub_4:
    s_branch L_stub_5
L_skip_4:
    v_mfma_f32_16x16x32_bf16 v[220:223], v[76:79], v[36:39], v[220:223]
    ds_read_b64_tr_b16 v[88:89], v21 offset:8192
    v_mfma_f32_16x16x32_bf16 v[224:227], v[80:83], v[36:39], v[224:227]
    ds_read_b128 v[36:39], v18 offset:43520
    s_waitcnt lgkmcnt(8)
    v_mfma_f32_16x16x32_bf16 v[228:231], v[76:79], v[40:43], v[228:231]
    ds_read_b64_tr_b16 v[90:91], v21 offset:12288
    v_mfma_f32_16x16x32_bf16 v[232:235], v[80:83], v[40:43], v[232:235]
    ds_read_b128 v[40:43], v18 offset:43776
    s_waitcnt lgkmcnt(9)
    v_mfma_f32_16x16x32_bf16 v[236:239], v[76:79], v[44:47], v[236:239]
    v_mfma_f32_16x16x32_bf16 v[240:243], v[80:83], v[44:47], v[240:243]
    ds_read_b128 v[44:47], v18 offset:44032
    s_waitcnt lgkmcnt(9)
    v_mfma_f32_16x16x32_bf16 v[244:247], v[76:79], v[48:51], v[244:247]
    v_mfma_f32_16x16x32_bf16 v[248:251], v[80:83], v[48:51], v[248:251]
    ds_read_b128 v[48:51], v18 offset:44288
    s_waitcnt lgkmcnt(3)
    v_mfma_f32_16x16x32_bf16 v[204:207], v[84:87], v[28:31], v[204:207]
    s_barrier
    ds_read_b64_tr_b16 v[76:77], v20 offset:16384
    v_mfma_f32_16x16x32_bf16 v[208:211], v[88:91], v[28:31], v[208:211]
    ds_read_b128 v[28:31], v18 offset:49152
    v_mfma_f32_16x16x32_bf16 v[212:215], v[84:87], v[32:35], v[212:215]
    ds_read_b64_tr_b16 v[78:79], v20 offset:20480
    v_mfma_f32_16x16x32_bf16 v[216:219], v[88:91], v[32:35], v[216:219]
    ds_read_b128 v[32:35], v18 offset:49408
    v_mfma_f32_16x16x32_bf16 v[220:223], v[84:87], v[36:39], v[220:223]
    ds_read_b64_tr_b16 v[80:81], v21 offset:16384
    v_mfma_f32_16x16x32_bf16 v[224:227], v[88:91], v[36:39], v[224:227]
    ds_read_b128 v[36:39], v18 offset:49664
    s_waitcnt lgkmcnt(8)
    v_mfma_f32_16x16x32_bf16 v[228:231], v[84:87], v[40:43], v[228:231]
    ds_read_b64_tr_b16 v[82:83], v21 offset:20480
    v_mfma_f32_16x16x32_bf16 v[232:235], v[88:91], v[40:43], v[232:235]
    ds_read_b128 v[40:43], v18 offset:49920
    s_waitcnt lgkmcnt(9)
    v_mfma_f32_16x16x32_bf16 v[236:239], v[84:87], v[44:47], v[236:239]
    v_mfma_f32_16x16x32_bf16 v[240:243], v[88:91], v[44:47], v[240:243]
    ds_read_b128 v[44:47], v18 offset:50176
    s_waitcnt lgkmcnt(9)
    v_mfma_f32_16x16x32_bf16 v[244:247], v[84:87], v[48:51], v[244:247]
    v_mfma_f32_16x16x32_bf16 v[248:251], v[88:91], v[48:51], v[248:251]
    ds_read_b128 v[48:51], v18 offset:50432
    s_waitcnt lgkmcnt(3)
    v_mfma_f32_16x16x32_bf16 v[204:207], v[76:79], v[28:31], v[204:207]
    ds_read_b64_tr_b16 v[84:85], v20 offset:24576
    v_mfma_f32_16x16x32_bf16 v[208:211], v[80:83], v[28:31], v[208:211]
    ds_read_b128 v[28:31], v18 offset:55296
    v_mfma_f32_16x16x32_bf16 v[212:215], v[76:79], v[32:35], v[212:215]
    ds_read_b64_tr_b16 v[86:87], v20 offset:28672
    v_mfma_f32_16x16x32_bf16 v[216:219], v[80:83], v[32:35], v[216:219]
    ds_read_b128 v[32:35], v18 offset:55552
    v_mfma_f32_16x16x32_bf16 v[220:223], v[76:79], v[36:39], v[220:223]
    ds_read_b64_tr_b16 v[88:89], v21 offset:24576
    v_mfma_f32_16x16x32_bf16 v[224:227], v[80:83], v[36:39], v[224:227]
    ds_read_b128 v[36:39], v18 offset:55808
    s_waitcnt lgkmcnt(8)
    v_mfma_f32_16x16x32_bf16 v[228:231], v[76:79], v[40:43], v[228:231]
    ds_read_b64_tr_b16 v[90:91], v21 offset:28672
    v_mfma_f32_16x16x32_bf16 v[232:235], v[80:83], v[40:43], v[232:235]
    ds_read_b128 v[40:43], v18 offset:56064
    s_waitcnt lgkmcnt(9)
    v_mfma_f32_16x16x32_bf16 v[236:239], v[76:79], v[44:47], v[236:239]
    v_mfma_f32_16x16x32_bf16 v[240:243], v[80:83], v[44:47], v[240:243]
    ds_read_b128 v[44:47], v18 offset:56320
    s_waitcnt lgkmcnt(9)
    v_mfma_f32_16x16x32_bf16 v[244:247], v[76:79], v[48:51], v[244:247]
    v_mfma_f32_16x16x32_bf16 v[248:251], v[80:83], v[48:51], v[248:251]
    ds_read_b128 v[48:51], v18 offset:56576
    s_waitcnt lgkmcnt(3)
    v_mfma_f32_16x16x32_bf16 v[204:207], v[84:87], v[28:31], v[204:207]
    s_barrier
    v_mfma_f32_16x16x32_bf16 v[208:211], v[88:91], v[28:31], v[208:211]
    ds_read_b128 v[28:31], v18 offset:0
    v_mfma_f32_16x16x32_bf16 v[212:215], v[84:87], v[32:35], v[212:215]
    v_mfma_f32_16x16x32_bf16 v[216:219], v[88:91], v[32:35], v[216:219]
    ds_read_b128 v[32:35], v18 offset:256
    v_mfma_f32_16x16x32_bf16 v[220:223], v[84:87], v[36:39], v[220:223]
    v_mfma_f32_16x16x32_bf16 v[224:227], v[88:91], v[36:39], v[224:227]
    ds_read_b128 v[36:39], v18 offset:512
    s_waitcnt lgkmcnt(5)
    v_mfma_f32_16x16x32_bf16 v[228:231], v[84:87], v[40:43], v[228:231]
    v_mfma_f32_16x16x32_bf16 v[232:235], v[88:91], v[40:43], v[232:235]
    ds_read_b128 v[40:43], v18 offset:768
    s_waitcnt lgkmcnt(5)
    v_mfma_f32_16x16x32_bf16 v[236:239], v[84:87], v[44:47], v[236:239]
    v_mfma_f32_16x16x32_bf16 v[240:243], v[88:91], v[44:47], v[240:243]
    ds_read_b128 v[44:47], v18 offset:1024
    s_waitcnt lgkmcnt(5)
    v_mfma_f32_16x16x32_bf16 v[244:247], v[84:87], v[48:51], v[244:247]
    v_mfma_f32_16x16x32_bf16 v[248:251], v[88:91], v[48:51], v[248:251]
    ds_read_b128 v[48:51], v18 offset:1280
    s_waitcnt lgkmcnt(3)
    v_mfma_f32_16x16x32_bf16 v[204:207], v[140:143], v[28:31], v[204:207]
    v_mfma_f32_16x16x32_bf16 v[208:211], v[144:147], v[28:31], v[208:211]
    ds_read_b128 v[28:31], v18 offset:6144
    v_mfma_f32_16x16x32_bf16 v[212:215], v[140:143], v[32:35], v[212:215]
    v_mfma_f32_16x16x32_bf16 v[216:219], v[144:147], v[32:35], v[216:219]
    ds_read_b128 v[32:35], v18 offset:6400
    v_mfma_f32_16x16x32_bf16 v[220:223], v[140:143], v[36:39], v[220:223]
    v_mfma_f32_16x16x32_bf16 v[224:227], v[144:147], v[36:39], v[224:227]
    ds_read_b128 v[36:39], v18 offset:6656
    s_waitcnt lgkmcnt(5)
    v_mfma_f32_16x16x32_bf16 v[228:231], v[140:143], v[40:43], v[228:231]
    v_mfma_f32_16x16x32_bf16 v[232:235], v[144:147], v[40:43], v[232:235]
    ds_read_b128 v[40:43], v18 offset:6912
    s_waitcnt lgkmcnt(5)
    v_mfma_f32_16x16x32_bf16 v[236:239], v[140:143], v[44:47], v[236:239]
    v_mfma_f32_16x16x32_bf16 v[240:243], v[144:147], v[44:47], v[240:243]
    ds_read_b128 v[44:47], v18 offset:7168
    s_waitcnt lgkmcnt(5)
    v_mfma_f32_16x16x32_bf16 v[244:247], v[140:143], v[48:51], v[244:247]
    v_mfma_f32_16x16x32_bf16 v[248:251], v[144:147], v[48:51], v[248:251]
    ds_read_b128 v[48:51], v18 offset:7424
    s_waitcnt lgkmcnt(3)
    v_mfma_f32_16x16x32_bf16 v[204:207], v[148:151], v[28:31], v[204:207]
    s_barrier
    ds_read_b64_tr_b16 v[76:77], v20 offset:32768
    v_mfma_f32_16x16x32_bf16 v[208:211], v[152:155], v[28:31], v[208:211]
    ds_read_b128 v[28:31], v18 offset:12288
    v_mfma_f32_16x16x32_bf16 v[212:215], v[148:151], v[32:35], v[212:215]
    ds_read_b64_tr_b16 v[78:79], v20 offset:36864
    v_mfma_f32_16x16x32_bf16 v[216:219], v[152:155], v[32:35], v[216:219]
    ds_read_b128 v[32:35], v18 offset:12544
    v_mfma_f32_16x16x32_bf16 v[220:223], v[148:151], v[36:39], v[220:223]
    ds_read_b64_tr_b16 v[80:81], v21 offset:32768
    v_mfma_f32_16x16x32_bf16 v[224:227], v[152:155], v[36:39], v[224:227]
    ds_read_b128 v[36:39], v18 offset:12800
    s_waitcnt lgkmcnt(8)
    v_mfma_f32_16x16x32_bf16 v[228:231], v[148:151], v[40:43], v[228:231]
    ds_read_b64_tr_b16 v[82:83], v21 offset:36864
    v_mfma_f32_16x16x32_bf16 v[232:235], v[152:155], v[40:43], v[232:235]
    ds_read_b128 v[40:43], v18 offset:13056
    s_waitcnt lgkmcnt(9)
    v_mfma_f32_16x16x32_bf16 v[236:239], v[148:151], v[44:47], v[236:239]
    v_mfma_f32_16x16x32_bf16 v[240:243], v[152:155], v[44:47], v[240:243]
    ds_read_b128 v[44:47], v18 offset:13312
    s_waitcnt lgkmcnt(9)
    v_mfma_f32_16x16x32_bf16 v[244:247], v[148:151], v[48:51], v[244:247]
    v_mfma_f32_16x16x32_bf16 v[248:251], v[152:155], v[48:51], v[248:251]
    ds_read_b128 v[48:51], v18 offset:13568
    s_waitcnt lgkmcnt(3)
    v_mfma_f32_16x16x32_bf16 v[204:207], v[76:79], v[28:31], v[204:207]
    ds_read_b64_tr_b16 v[84:85], v20 offset:40960
    v_mfma_f32_16x16x32_bf16 v[208:211], v[80:83], v[28:31], v[208:211]
    ds_read_b128 v[28:31], v18 offset:18432
    v_mfma_f32_16x16x32_bf16 v[212:215], v[76:79], v[32:35], v[212:215]
    ds_read_b64_tr_b16 v[86:87], v20 offset:45056
    v_mfma_f32_16x16x32_bf16 v[216:219], v[80:83], v[32:35], v[216:219]
    ds_read_b128 v[32:35], v18 offset:18688
    v_mfma_f32_16x16x32_bf16 v[220:223], v[76:79], v[36:39], v[220:223]
    ds_read_b64_tr_b16 v[88:89], v21 offset:40960
    v_mfma_f32_16x16x32_bf16 v[224:227], v[80:83], v[36:39], v[224:227]
    ds_read_b128 v[36:39], v18 offset:18944
    s_waitcnt lgkmcnt(8)
    v_mfma_f32_16x16x32_bf16 v[228:231], v[76:79], v[40:43], v[228:231]
    ds_read_b64_tr_b16 v[90:91], v21 offset:45056
    v_mfma_f32_16x16x32_bf16 v[232:235], v[80:83], v[40:43], v[232:235]
    ds_read_b128 v[40:43], v18 offset:19200
    s_waitcnt lgkmcnt(9)
    v_mfma_f32_16x16x32_bf16 v[236:239], v[76:79], v[44:47], v[236:239]
    v_mfma_f32_16x16x32_bf16 v[240:243], v[80:83], v[44:47], v[240:243]
    ds_read_b128 v[44:47], v18 offset:19456
    s_waitcnt lgkmcnt(9)
    v_mfma_f32_16x16x32_bf16 v[244:247], v[76:79], v[48:51], v[244:247]
    v_mfma_f32_16x16x32_bf16 v[248:251], v[80:83], v[48:51], v[248:251]
    ds_read_b128 v[48:51], v18 offset:19712
    s_waitcnt lgkmcnt(3)
    v_mfma_f32_16x16x32_bf16 v[204:207], v[84:87], v[28:31], v[204:207]
    s_barrier
    ds_read_b64_tr_b16 v[76:77], v24 offset:0
    v_mfma_f32_16x16x32_bf16 v[208:211], v[88:91], v[28:31], v[208:211]
    ds_read_b128 v[28:31], v18 offset:24576
    v_mfma_f32_16x16x32_bf16 v[212:215], v[84:87], v[32:35], v[212:215]
    ds_read_b64_tr_b16 v[78:79], v24 offset:4096
    v_mfma_f32_16x16x32_bf16 v[216:219], v[88:91], v[32:35], v[216:219]
    ds_read_b128 v[32:35], v18 offset:24832
    v_mfma_f32_16x16x32_bf16 v[220:223], v[84:87], v[36:39], v[220:223]
    ds_read_b64_tr_b16 v[80:81], v25 offset:0
    v_mfma_f32_16x16x32_bf16 v[224:227], v[88:91], v[36:39], v[224:227]
    ds_read_b128 v[36:39], v18 offset:25088
    s_waitcnt lgkmcnt(8)
    v_mfma_f32_16x16x32_bf16 v[228:231], v[84:87], v[40:43], v[228:231]
    ds_read_b64_tr_b16 v[82:83], v25 offset:4096
    v_mfma_f32_16x16x32_bf16 v[232:235], v[88:91], v[40:43], v[232:235]
    ds_read_b128 v[40:43], v18 offset:25344
    s_waitcnt lgkmcnt(9)
    v_mfma_f32_16x16x32_bf16 v[236:239], v[84:87], v[44:47], v[236:239]
    v_mfma_f32_16x16x32_bf16 v[240:243], v[88:91], v[44:47], v[240:243]
    ds_read_b128 v[44:47], v18 offset:25600
    s_waitcnt lgkmcnt(9)
    v_mfma_f32_16x16x32_bf16 v[244:247], v[84:87], v[48:51], v[244:247]
    v_mfma_f32_16x16x32_bf16 v[248:251], v[88:91], v[48:51], v[248:251]
    ds_read_b128 v[48:51], v18 offset:25856
    s_waitcnt lgkmcnt(3)
    v_mfma_f32_16x16x32_bf16 v[204:207], v[76:79], v[28:31], v[204:207]
    ds_read_b64_tr_b16 v[84:85], v24 offset:8192
    v_mfma_f32_16x16x32_bf16 v[208:211], v[80:83], v[28:31], v[208:211]
    ds_read_b128 v[28:31], v18 offset:30720
    v_mfma_f32_16x16x32_bf16 v[212:215], v[76:79], v[32:35], v[212:215]
    ds_read_b64_tr_b16 v[86:87], v24 offset:12288
    v_mfma_f32_16x16x32_bf16 v[216:219], v[80:83], v[32:35], v[216:219]
    ds_read_b128 v[32:35], v18 offset:30976
    v_mfma_f32_16x16x32_bf16 v[220:223], v[76:79], v[36:39], v[220:223]
    ds_read_b64_tr_b16 v[88:89], v25 offset:8192
    v_mfma_f32_16x16x32_bf16 v[224:227], v[80:83], v[36:39], v[224:227]
    ds_read_b128 v[36:39], v18 offset:31232
    s_waitcnt lgkmcnt(8)
    v_mfma_f32_16x16x32_bf16 v[228:231], v[76:79], v[40:43], v[228:231]
    ds_read_b64_tr_b16 v[90:91], v25 offset:12288
    v_mfma_f32_16x16x32_bf16 v[232:235], v[80:83], v[40:43], v[232:235]
    ds_read_b128 v[40:43], v18 offset:31488
    s_waitcnt lgkmcnt(9)
    v_mfma_f32_16x16x32_bf16 v[236:239], v[76:79], v[44:47], v[236:239]
    v_mfma_f32_16x16x32_bf16 v[240:243], v[80:83], v[44:47], v[240:243]
    ds_read_b128 v[44:47], v18 offset:31744
    s_waitcnt lgkmcnt(9)
    v_mfma_f32_16x16x32_bf16 v[244:247], v[76:79], v[48:51], v[244:247]
    v_mfma_f32_16x16x32_bf16 v[248:251], v[80:83], v[48:51], v[248:251]
    ds_read_b128 v[48:51], v18 offset:32000
    s_waitcnt lgkmcnt(3)
    v_mfma_f32_16x16x32_bf16 v[204:207], v[84:87], v[28:31], v[204:207]
    s_barrier
    v_mfma_f32_16x16x32_bf16 v[208:211], v[88:91], v[28:31], v[208:211]
    ds_read_b128 v[28:31], v18 offset:36864
    v_mfma_f32_16x16x32_bf16 v[212:215], v[84:87], v[32:35], v[212:215]
    v_mfma_f32_16x16x32_bf16 v[216:219], v[88:91], v[32:35], v[216:219]
    ds_read_b128 v[32:35], v18 offset:37120
    v_mfma_f32_16x16x32_bf16 v[220:223], v[84:87], v[36:39], v[220:223]
    v_mfma_f32_16x16x32_bf16 v[224:227], v[88:91], v[36:39], v[224:227]
    ds_read_b128 v[36:39], v18 offset:37376
    s_waitcnt lgkmcnt(5)
    v_mfma_f32_16x16x32_bf16 v[228:231], v[84:87], v[40:43], v[228:231]
    v_mfma_f32_16x16x32_bf16 v[232:235], v[88:91], v[40:43], v[232:235]
    ds_read_b128 v[40:43], v18 offset:37632
    s_waitcnt lgkmcnt(5)
    v_mfma_f32_16x16x32_bf16 v[236:239], v[84:87], v[44:47], v[236:239]
    v_mfma_f32_16x16x32_bf16 v[240:243], v[88:91], v[44:47], v[240:243]
    ds_read_b128 v[44:47], v18 offset:37888
    s_waitcnt lgkmcnt(5)
    v_mfma_f32_16x16x32_bf16 v[244:247], v[84:87], v[48:51], v[244:247]
    v_mfma_f32_16x16x32_bf16 v[248:251], v[88:91], v[48:51], v[248:251]
    ds_read_b128 v[48:51], v18 offset:38144
    s_waitcnt lgkmcnt(3)
    v_mfma_f32_16x16x32_bf16 v[204:207], v[156:159], v[28:31], v[204:207]
    v_mfma_f32_16x16x32_bf16 v[208:211], v[160:163], v[28:31], v[208:211]
    ds_read_b128 v[28:31], v18 offset:43008
    v_mfma_f32_16x16x32_bf16 v[212:215], v[156:159], v[32:35], v[212:215]
    v_mfma_f32_16x16x32_bf16 v[216:219], v[160:163], v[32:35], v[216:219]
    ds_read_b128 v[32:35], v18 offset:43264
    v_mfma_f32_16x16x32_bf16 v[220:223], v[156:159], v[36:39], v[220:223]
    v_mfma_f32_16x16x32_bf16 v[224:227], v[160:163], v[36:39], v[224:227]
    ds_read_b128 v[36:39], v18 offset:43520
    s_waitcnt lgkmcnt(5)
    v_mfma_f32_16x16x32_bf16 v[228:231], v[156:159], v[40:43], v[228:231]
    v_mfma_f32_16x16x32_bf16 v[232:235], v[160:163], v[40:43], v[232:235]
    ds_read_b128 v[40:43], v18 offset:43776
    s_waitcnt lgkmcnt(5)
    v_mfma_f32_16x16x32_bf16 v[236:239], v[156:159], v[44:47], v[236:239]
    v_mfma_f32_16x16x32_bf16 v[240:243], v[160:163], v[44:47], v[240:243]
    ds_read_b128 v[44:47], v18 offset:44032
    s_waitcnt lgkmcnt(5)
    v_mfma_f32_16x16x32_bf16 v[244:247], v[156:159], v[48:51], v[244:247]
    v_mfma_f32_16x16x32_bf16 v[248:251], v[160:163], v[48:51], v[248:251]
    ds_read_b128 v[48:51], v18 offset:44288
    s_waitcnt lgkmcnt(3)
    v_mfma_f32_16x16x32_bf16 v[204:207], v[164:167], v[28:31], v[204:207]
    s_barrier
    ds_read_b64_tr_b16 v[76:77], v24 offset:16384
    v_mfma_f32_16x16x32_bf16 v[208:211], v[168:171], v[28:31], v[208:211]
    ds_read_b128 v[28:31], v18 offset:49152
    v_mfma_f32_16x16x32_bf16 v[212:215], v[164:167], v[32:35], v[212:215]
    ds_read_b64_tr_b16 v[78:79], v24 offset:20480
    v_mfma_f32_16x16x32_bf16 v[216:219], v[168:171], v[32:35], v[216:219]
    ds_read_b128 v[32:35], v18 offset:49408
    v_mfma_f32_16x16x32_bf16 v[220:223], v[164:167], v[36:39], v[220:223]
    ds_read_b64_tr_b16 v[80:81], v25 offset:16384
    v_mfma_f32_16x16x32_bf16 v[224:227], v[168:171], v[36:39], v[224:227]
    ds_read_b128 v[36:39], v18 offset:49664
    s_waitcnt lgkmcnt(8)
    v_mfma_f32_16x16x32_bf16 v[228:231], v[164:167], v[40:43], v[228:231]
    ds_read_b64_tr_b16 v[82:83], v25 offset:20480
    v_mfma_f32_16x16x32_bf16 v[232:235], v[168:171], v[40:43], v[232:235]
    ds_read_b128 v[40:43], v18 offset:49920
    s_waitcnt lgkmcnt(9)
    v_mfma_f32_16x16x32_bf16 v[236:239], v[164:167], v[44:47], v[236:239]
    v_mfma_f32_16x16x32_bf16 v[240:243], v[168:171], v[44:47], v[240:243]
    ds_read_b128 v[44:47], v18 offset:50176
    s_waitcnt lgkmcnt(9)
    v_mfma_f32_16x16x32_bf16 v[244:247], v[164:167], v[48:51], v[244:247]
    v_mfma_f32_16x16x32_bf16 v[248:251], v[168:171], v[48:51], v[248:251]
    ds_read_b128 v[48:51], v18 offset:50432
    s_waitcnt lgkmcnt(3)
    v_mfma_f32_16x16x32_bf16 v[204:207], v[76:79], v[28:31], v[204:207]
    ds_read_b64_tr_b16 v[84:85], v24 offset:24576
    v_mfma_f32_16x16x32_bf16 v[208:211], v[80:83], v[28:31], v[208:211]
    ds_read_b128 v[28:31], v18 offset:55296
    v_mfma_f32_16x16x32_bf16 v[212:215], v[76:79], v[32:35], v[212:215]
    ds_read_b64_tr_b16 v[86:87], v24 offset:28672
    v_mfma_f32_16x16x32_bf16 v[216:219], v[80:83], v[32:35], v[216:219]
    ds_read_b128 v[32:35], v18 offset:55552
    v_mfma_f32_16x16x32_bf16 v[220:223], v[76:79], v[36:39], v[220:223]
    ds_read_b64_tr_b16 v[88:89], v25 offset:24576
    v_mfma_f32_16x16x32_bf16 v[224:227], v[80:83], v[36:39], v[224:227]
    ds_read_b128 v[36:39], v18 offset:55808
    s_waitcnt lgkmcnt(8)
    v_mfma_f32_16x16x32_bf16 v[228:231], v[76:79], v[40:43], v[228:231]
    ds_read_b64_tr_b16 v[90:91], v25 offset:28672
    v_mfma_f32_16x16x32_bf16 v[232:235], v[80:83], v[40:43], v[232:235]
    ds_read_b128 v[40:43], v18 offset:56064
    s_waitcnt lgkmcnt(9)
    v_mfma_f32_16x16x32_bf16 v[236:239], v[76:79], v[44:47], v[236:239]
    v_mfma_f32_16x16x32_bf16 v[240:243], v[80:83], v[44:47], v[240:243]
    ds_read_b128 v[44:47], v18 offset:56320
    s_waitcnt lgkmcnt(9)
    v_mfma_f32_16x16x32_bf16 v[244:247], v[76:79], v[48:51], v[244:247]
    v_mfma_f32_16x16x32_bf16 v[248:251], v[80:83], v[48:51], v[248:251]
    ds_read_b128 v[48:51], v18 offset:56576
    s_waitcnt lgkmcnt(3)
    v_mfma_f32_16x16x32_bf16 v[204:207], v[84:87], v[28:31], v[204:207]
    s_barrier
    ds_read_b64_tr_b16 v[76:77], v24 offset:32768
    v_mfma_f32_16x16x32_bf16 v[208:211], v[88:91], v[28:31], v[208:211]
    ds_read_b128 v[28:31], v18 offset:0
    v_mfma_f32_16x16x32_bf16 v[212:215], v[84:87], v[32:35], v[212:215]
    ds_read_b64_tr_b16 v[78:79], v24 offset:36864
    v_mfma_f32_16x16x32_bf16 v[216:219], v[88:91], v[32:35], v[216:219]
    ds_read_b128 v[32:35], v18 offset:256
    v_mfma_f32_16x16x32_bf16 v[220:223], v[84:87], v[36:39], v[220:223]
    ds_read_b64_tr_b16 v[80:81], v25 offset:32768
    v_mfma_f32_16x16x32_bf16 v[224:227], v[88:91], v[36:39], v[224:227]
    ds_read_b128 v[36:39], v18 offset:512
    s_waitcnt lgkmcnt(8)
    v_mfma_f32_16x16x32_bf16 v[228:231], v[84:87], v[40:43], v[228:231]
    ds_read_b64_tr_b16 v[82:83], v25 offset:36864
    v_mfma_f32_16x16x32_bf16 v[232:235], v[88:91], v[40:43], v[232:235]
    ds_read_b128 v[40:43], v18 offset:768
    s_waitcnt lgkmcnt(9)
    v_mfma_f32_16x16x32_bf16 v[236:239], v[84:87], v[44:47], v[236:239]
    v_mfma_f32_16x16x32_bf16 v[240:243], v[88:91], v[44:47], v[240:243]
    ds_read_b128 v[44:47], v18 offset:1024
    s_waitcnt lgkmcnt(9)
    v_mfma_f32_16x16x32_bf16 v[244:247], v[84:87], v[48:51], v[244:247]
    v_mfma_f32_16x16x32_bf16 v[248:251], v[88:91], v[48:51], v[248:251]
    ds_read_b128 v[48:51], v18 offset:1280
    s_waitcnt lgkmcnt(3)
    v_mfma_f32_16x16x32_bf16 v[204:207], v[76:79], v[28:31], v[204:207]
    ds_read_b64_tr_b16 v[84:85], v24 offset:40960
    v_mfma_f32_16x16x32_bf16 v[208:211], v[80:83], v[28:31], v[208:211]
    ds_read_b128 v[28:31], v18 offset:6144
    v_mfma_f32_16x16x32_bf16 v[212:215], v[76:79], v[32:35], v[212:215]
    ds_read_b64_tr_b16 v[86:87], v24 offset:45056
    v_mfma_f32_16x16x32_bf16 v[216:219], v[80:83], v[32:35], v[216:219]
    ds_read_b128 v[32:35], v18 offset:6400
    v_mfma_f32_16x16x32_bf16 v[220:223], v[76:79], v[36:39], v[220:223]
    ds_read_b64_tr_b16 v[88:89], v25 offset:40960
    v_mfma_f32_16x16x32_bf16 v[224:227], v[80:83], v[36:39], v[224:227]
    ds_read_b128 v[36:39], v18 offset:6656
    s_waitcnt lgkmcnt(8)
    v_mfma_f32_16x16x32_bf16 v[228:231], v[76:79], v[40:43], v[228:231]
    ds_read_b64_tr_b16 v[90:91], v25 offset:45056
    v_mfma_f32_16x16x32_bf16 v[232:235], v[80:83], v[40:43], v[232:235]
    ds_read_b128 v[40:43], v18 offset:6912
    s_waitcnt lgkmcnt(9)
    v_mfma_f32_16x16x32_bf16 v[236:239], v[76:79], v[44:47], v[236:239]
    v_mfma_f32_16x16x32_bf16 v[240:243], v[80:83], v[44:47], v[240:243]
    ds_read_b128 v[44:47], v18 offset:7168
    s_waitcnt lgkmcnt(9)
    v_mfma_f32_16x16x32_bf16 v[244:247], v[76:79], v[48:51], v[244:247]
    v_mfma_f32_16x16x32_bf16 v[248:251], v[80:83], v[48:51], v[248:251]
    ds_read_b128 v[48:51], v18 offset:7424
    s_waitcnt lgkmcnt(3)
    v_mfma_f32_16x16x32_bf16 v[204:207], v[84:87], v[28:31], v[204:207]
    s_barrier
    v_mfma_f32_16x16x32_bf16 v[208:211], v[88:91], v[28:31], v[208:211]
    ds_read_b128 v[28:31], v18 offset:12288
    v_mfma_f32_16x16x32_bf16 v[212:215], v[84:87], v[32:35], v[212:215]
    v_mfma_f32_16x16x32_bf16 v[216:219], v[88:91], v[32:35], v[216:219]
    ds_read_b128 v[32:35], v18 offset:12544
    v_mfma_f32_16x16x32_bf16 v[220:223], v[84:87], v[36:39], v[220:223]
    v_mfma_f32_16x16x32_bf16 v[224:227], v[88:91], v[36:39], v[224:227]
    ds_read_b128 v[36:39], v18 offset:12800
    s_waitcnt lgkmcnt(5)
    v_mfma_f32_16x16x32_bf16 v[228:231], v[84:87], v[40:43], v[228:231]
    v_mfma_f32_16x16x32_bf16 v[232:235], v[88:91], v[40:43], v[232:235]
    ds_read_b128 v[40:43], v18 offset:13056
    s_waitcnt lgkmcnt(5)
    v_mfma_f32_16x16x32_bf16 v[236:239], v[84:87], v[44:47], v[236:239]
    v_mfma_f32_16x16x32_bf16 v[240:243], v[88:91], v[44:47], v[240:243]
    ds_read_b128 v[44:47], v18 offset:13312
    s_waitcnt lgkmcnt(5)
    v_mfma_f32_16x16x32_bf16 v[244:247], v[84:87], v[48:51], v[244:247]
    v_mfma_f32_16x16x32_bf16 v[248:251], v[88:91], v[48:51], v[248:251]
    ds_read_b128 v[48:51], v18 offset:13568
    s_waitcnt lgkmcnt(3)
    v_mfma_f32_16x16x32_bf16 v[204:207], v[172:175], v[28:31], v[204:207]
    v_mfma_f32_16x16x32_bf16 v[208:211], v[176:179], v[28:31], v[208:211]
    ds_read_b128 v[28:31], v18 offset:18432
    v_mfma_f32_16x16x32_bf16 v[212:215], v[172:175], v[32:35], v[212:215]
    v_mfma_f32_16x16x32_bf16 v[216:219], v[176:179], v[32:35], v[216:219]
    ds_read_b128 v[32:35], v18 offset:18688
    v_mfma_f32_16x16x32_bf16 v[220:223], v[172:175], v[36:39], v[220:223]
    v_mfma_f32_16x16x32_bf16 v[224:227], v[176:179], v[36:39], v[224:227]
    ds_read_b128 v[36:39], v18 offset:18944
    s_waitcnt lgkmcnt(5)
    v_mfma_f32_16x16x32_bf16 v[228:231], v[172:175], v[40:43], v[228:231]
    v_mfma_f32_16x16x32_bf16 v[232:235], v[176:179], v[40:43], v[232:235]
    ds_read_b128 v[40:43], v18 offset:19200
    s_waitcnt lgkmcnt(5)
    v_mfma_f32_16x16x32_bf16 v[236:239], v[172:175], v[44:47], v[236:239]
    v_mfma_f32_16x16x32_bf16 v[240:243], v[176:179], v[44:47], v[240:243]
    ds_read_b128 v[44:47], v18 offset:19456
    s_waitcnt lgkmcnt(5)
    v_mfma_f32_16x16x32_bf16 v[244:247], v[172:175], v[48:51], v[244:247]
    v_mfma_f32_16x16x32_bf16 v[248:251], v[176:179], v[48:51], v[248:251]
    ds_read_b128 v[48:51], v18 offset:19712
    s_waitcnt lgkmcnt(3)
    v_mfma_f32_16x16x32_bf16 v[204:207], v[180:183], v[28:31], v[204:207]
    s_barrier
    ds_read_b64_tr_b16 v[76:77], v20 offset:0
    v_mfma_f32_16x16x32_bf16 v[208:211], v[184:187], v[28:31], v[208:211]
    ds_read_b128 v[28:31], v18 offset:24576
    v_mfma_f32_16x16x32_bf16 v[212:215], v[180:183], v[32:35], v[212:215]
    ds_read_b64_tr_b16 v[78:79], v20 offset:4096
    v_mfma_f32_16x16x32_bf16 v[216:219], v[184:187], v[32:35], v[216:219]
    ds_read_b128 v[32:35], v18 offset:24832
    v_mfma_f32_16x16x32_bf16 v[220:223], v[180:183], v[36:39], v[220:223]
    ds_read_b64_tr_b16 v[80:81], v21 offset:0
    v_mfma_f32_16x16x32_bf16 v[224:227], v[184:187], v[36:39], v[224:227]
    ds_read_b128 v[36:39], v18 offset:25088
    s_waitcnt lgkmcnt(8)
    v_mfma_f32_16x16x32_bf16 v[228:231], v[180:183], v[40:43], v[228:231]
    ds_read_b64_tr_b16 v[82:83], v21 offset:4096
    v_mfma_f32_16x16x32_bf16 v[232:235], v[184:187], v[40:43], v[232:235]
    ds_read_b128 v[40:43], v18 offset:25344
    s_waitcnt lgkmcnt(9)
    v_mfma_f32_16x16x32_bf16 v[236:239], v[180:183], v[44:47], v[236:239]
    v_mfma_f32_16x16x32_bf16 v[240:243], v[184:187], v[44:47], v[240:243]
    ds_read_b128 v[44:47], v18 offset:25600
    s_waitcnt lgkmcnt(9)
    v_mfma_f32_16x16x32_bf16 v[244:247], v[180:183], v[48:51], v[244:247]
    v_mfma_f32_16x16x32_bf16 v[248:251], v[184:187], v[48:51], v[248:251]
    ds_read_b128 v[48:51], v18 offset:25856
    s_waitcnt lgkmcnt(3)
    v_mfma_f32_16x16x32_bf16 v[204:207], v[76:79], v[28:31], v[204:207]
    ds_read_b64_tr_b16 v[84:85], v20 offset:8192
    v_mfma_f32_16x16x32_bf16 v[208:211], v[80:83], v[28:31], v[208:211]
    ds_read_b128 v[28:31], v18 offset:30720
    v_mfma_f32_16x16x32_bf16 v[212:215], v[76:79], v[32:35], v[212:215]
    ds_read_b64_tr_b16 v[86:87], v20 offset:12288
    v_mfma_f32_16x16x32_bf16 v[216:219], v[80:83], v[32:35], v[216:219]
    ds_read_b128 v[32:35], v18 offset:30976
    v_mfma_f32_16x16x32_bf16 v[220:223], v[76:79], v[36:39], v[220:223]
    ds_read_b64_tr_b16 v[88:89], v21 offset:8192
    v_mfma_f32_16x16x32_bf16 v[224:227], v[80:83], v[36:39], v[224:227]
    ds_read_b128 v[36:39], v18 offset:31232
    s_waitcnt lgkmcnt(8)
    v_mfma_f32_16x16x32_bf16 v[228:231], v[76:79], v[40:43], v[228:231]
    ds_read_b64_tr_b16 v[90:91], v21 offset:12288
    v_mfma_f32_16x16x32_bf16 v[232:235], v[80:83], v[40:43], v[232:235]
    ds_read_b128 v[40:43], v18 offset:31488
    s_waitcnt lgkmcnt(9)
    v_mfma_f32_16x16x32_bf16 v[236:239], v[76:79], v[44:47], v[236:239]
    v_mfma_f32_16x16x32_bf16 v[240:243], v[80:83], v[44:47], v[240:243]
    ds_read_b128 v[44:47], v18 offset:31744
    s_waitcnt lgkmcnt(9)
    v_mfma_f32_16x16x32_bf16 v[244:247], v[76:79], v[48:51], v[244:247]
    v_mfma_f32_16x16x32_bf16 v[248:251], v[80:83], v[48:51], v[248:251]
    ds_read_b128 v[48:51], v18 offset:32000
    s_waitcnt lgkmcnt(3)
    v_mfma_f32_16x16x32_bf16 v[204:207], v[84:87], v[28:31], v[204:207]
    s_barrier
    ds_read_b64_tr_b16 v[76:77], v20 offset:16384
    v_mfma_f32_16x16x32_bf16 v[208:211], v[88:91], v[28:31], v[208:211]
    ds_read_b128 v[28:31], v18 offset:36864
    v_mfma_f32_16x16x32_bf16 v[212:215], v[84:87], v[32:35], v[212:215]
    ds_read_b64_tr_b16 v[78:79], v20 offset:20480
    v_mfma_f32_16x16x32_bf16 v[216:219], v[88:91], v[32:35], v[216:219]
    ds_read_b128 v[32:35], v18 offset:37120
    v_mfma_f32_16x16x32_bf16 v[220:223], v[84:87], v[36:39], v[220:223]
    ds_read_b64_tr_b16 v[80:81], v21 offset:16384
    v_mfma_f32_16x16x32_bf16 v[224:227], v[88:91], v[36:39], v[224:227]
    ds_read_b128 v[36:39], v18 offset:37376
    s_waitcnt lgkmcnt(8)
    v_mfma_f32_16x16x32_bf16 v[228:231], v[84:87], v[40:43], v[228:231]
    ds_read_b64_tr_b16 v[82:83], v21 offset:20480
    v_mfma_f32_16x16x32_bf16 v[232:235], v[88:91], v[40:43], v[232:235]
    ds_read_b128 v[40:43], v18 offset:37632
    s_waitcnt lgkmcnt(9)
    v_mfma_f32_16x16x32_bf16 v[236:239], v[84:87], v[44:47], v[236:239]
    v_mfma_f32_16x16x32_bf16 v[240:243], v[88:91], v[44:47], v[240:243]
    ds_read_b128 v[44:47], v18 offset:37888
    s_waitcnt lgkmcnt(9)
    v_mfma_f32_16x16x32_bf16 v[244:247], v[84:87], v[48:51], v[244:247]
    v_mfma_f32_16x16x32_bf16 v[248:251], v[88:91], v[48:51], v[248:251]
    ds_read_b128 v[48:51], v18 offset:38144
    s_waitcnt lgkmcnt(3)
    v_mfma_f32_16x16x32_bf16 v[204:207], v[76:79], v[28:31], v[204:207]
    ds_read_b64_tr_b16 v[84:85], v20 offset:24576
    v_mfma_f32_16x16x32_bf16 v[208:211], v[80:83], v[28:31], v[208:211]
    ds_read_b128 v[28:31], v18 offset:43008
    v_mfma_f32_16x16x32_bf16 v[212:215], v[76:79], v[32:35], v[212:215]
    ds_read_b64_tr_b16 v[86:87], v20 offset:28672
    v_mfma_f32_16x16x32_bf16 v[216:219], v[80:83], v[32:35], v[216:219]
    ds_read_b128 v[32:35], v18 offset:43264
    v_mfma_f32_16x16x32_bf16 v[220:223], v[76:79], v[36:39], v[220:223]
    ds_read_b64_tr_b16 v[88:89], v21 offset:24576
    v_mfma_f32_16x16x32_bf16 v[224:227], v[80:83], v[36:39], v[224:227]
    ds_read_b128 v[36:39], v18 offset:43520
    s_waitcnt lgkmcnt(8)
    v_mfma_f32_16x16x32_bf16 v[228:231], v[76:79], v[40:43], v[228:231]
    ds_read_b64_tr_b16 v[90:91], v21 offset:28672
    v_mfma_f32_16x16x32_bf16 v[232:235], v[80:83], v[40:43], v[232:235]
    ds_read_b128 v[40:43], v18 offset:43776
    s_waitcnt lgkmcnt(9)
    v_mfma_f32_16x16x32_bf16 v[236:239], v[76:79], v[44:47], v[236:239]
    v_mfma_f32_16x16x32_bf16 v[240:243], v[80:83], v[44:47], v[240:243]
    ds_read_b128 v[44:47], v18 offset:44032
    s_waitcnt lgkmcnt(9)
    v_mfma_f32_16x16x32_bf16 v[244:247], v[76:79], v[48:51], v[244:247]
    v_mfma_f32_16x16x32_bf16 v[248:251], v[80:83], v[48:51], v[248:251]
    ds_read_b128 v[48:51], v18 offset:44288
    s_waitcnt lgkmcnt(3)
    v_mfma_f32_16x16x32_bf16 v[204:207], v[84:87], v[28:31], v[204:207]
    s_barrier
    v_mfma_f32_16x16x32_bf16 v[208:211], v[88:91], v[28:31], v[208:211]
    ds_read_b128 v[28:31], v18 offset:49152
    v_mfma_f32_16x16x32_bf16 v[212:215], v[84:87], v[32:35], v[212:215]
    v_mfma_f32_16x16x32_bf16 v[216:219], v[88:91], v[32:35], v[216:219]
    ds_read_b128 v[32:35], v18 offset:49408
    v_mfma_f32_16x16x32_bf16 v[220:223], v[84:87], v[36:39], v[220:223]
    v_mfma_f32_16x16x32_bf16 v[224:227], v[88:91], v[36:39], v[224:227]
    ds_read_b128 v[36:39], v18 offset:49664
    s_waitcnt lgkmcnt(5)
    v_mfma_f32_16x16x32_bf16 v[228:231], v[84:87], v[40:43], v[228:231]
    v_mfma_f32_16x16x32_bf16 v[232:235], v[88:91], v[40:43], v[232:235]
    ds_read_b128 v[40:43], v18 offset:49920
    s_waitcnt lgkmcnt(5)
    v_mfma_f32_16x16x32_bf16 v[236:239], v[84:87], v[44:47], v[236:239]
    v_mfma_f32_16x16x32_bf16 v[240:243], v[88:91], v[44:47], v[240:243]
    ds_read_b128 v[44:47], v18 offset:50176
    s_waitcnt lgkmcnt(5)
    v_mfma_f32_16x16x32_bf16 v[244:247], v[84:87], v[48:51], v[244:247]
    v_mfma_f32_16x16x32_bf16 v[248:251], v[88:91], v[48:51], v[248:251]
    ds_read_b128 v[48:51], v18 offset:50432
    s_waitcnt lgkmcnt(3)
    v_mfma_f32_16x16x32_bf16 v[204:207], v[188:191], v[28:31], v[204:207]
    v_mfma_f32_16x16x32_bf16 v[208:211], v[192:195], v[28:31], v[208:211]
    ds_read_b128 v[28:31], v18 offset:55296
    v_mfma_f32_16x16x32_bf16 v[212:215], v[188:191], v[32:35], v[212:215]
    v_mfma_f32_16x16x32_bf16 v[216:219], v[192:195], v[32:35], v[216:219]
    ds_read_b128 v[32:35], v18 offset:55552
    v_mfma_f32_16x16x32_bf16 v[220:223], v[188:191], v[36:39], v[220:223]
    v_mfma_f32_16x16x32_bf16 v[224:227], v[192:195], v[36:39], v[224:227]
    ds_read_b128 v[36:39], v18 offset:55808
    s_waitcnt lgkmcnt(5)
    v_mfma_f32_16x16x32_bf16 v[228:231], v[188:191], v[40:43], v[228:231]
    v_mfma_f32_16x16x32_bf16 v[232:235], v[192:195], v[40:43], v[232:235]
    ds_read_b128 v[40:43], v18 offset:56064
    s_waitcnt lgkmcnt(5)
    s_branch L_skip_5
    s_nop 0
L_stub_5:
    s_branch L_stub_6
L_skip_5:
    v_mfma_f32_16x16x32_bf16 v[236:239], v[188:191], v[44:47], v[236:239]
    v_mfma_f32_16x16x32_bf16 v[240:243], v[192:195], v[44:47], v[240:243]
    ds_read_b128 v[44:47], v18 offset:56320
    s_waitcnt lgkmcnt(5)
    v_mfma_f32_16x16x32_bf16 v[244:247], v[188:191], v[48:51], v[244:247]
    v_mfma_f32_16x16x32_bf16 v[248:251], v[192:195], v[48:51], v[248:251]
    ds_read_b128 v[48:51], v18 offset:56576
    s_waitcnt lgkmcnt(3)
    v_mfma_f32_16x16x32_bf16 v[204:207], v[196:199], v[28:31], v[204:207]
    s_barrier
    ds_read_b64_tr_b16 v[76:77], v20 offset:32768
    v_mfma_f32_16x16x32_bf16 v[208:211], v[200:203], v[28:31], v[208:211]
    ds_read_b128 v[28:31], v18 offset:0
    v_mfma_f32_16x16x32_bf16 v[212:215], v[196:199], v[32:35], v[212:215]
    ds_read_b64_tr_b16 v[78:79], v20 offset:36864
    v_mfma_f32_16x16x32_bf16 v[216:219], v[200:203], v[32:35], v[216:219]
    ds_read_b128 v[32:35], v18 offset:256
    v_mfma_f32_16x16x32_bf16 v[220:223], v[196:199], v[36:39], v[220:223]
    ds_read_b64_tr_b16 v[80:81], v21 offset:32768
    v_mfma_f32_16x16x32_bf16 v[224:227], v[200:203], v[36:39], v[224:227]
    ds_read_b128 v[36:39], v18 offset:512
    s_waitcnt lgkmcnt(8)
    v_mfma_f32_16x16x32_bf16 v[228:231], v[196:199], v[40:43], v[228:231]
    ds_read_b64_tr_b16 v[82:83], v21 offset:36864
    v_mfma_f32_16x16x32_bf16 v[232:235], v[200:203], v[40:43], v[232:235]
    ds_read_b128 v[40:43], v18 offset:768
    s_waitcnt lgkmcnt(9)
    v_mfma_f32_16x16x32_bf16 v[236:239], v[196:199], v[44:47], v[236:239]
    v_mfma_f32_16x16x32_bf16 v[240:243], v[200:203], v[44:47], v[240:243]
    ds_read_b128 v[44:47], v18 offset:1024
    s_waitcnt lgkmcnt(9)
    v_mfma_f32_16x16x32_bf16 v[244:247], v[196:199], v[48:51], v[244:247]
    v_mfma_f32_16x16x32_bf16 v[248:251], v[200:203], v[48:51], v[248:251]
    ds_read_b128 v[48:51], v18 offset:1280
    s_waitcnt lgkmcnt(3)
    v_mfma_f32_16x16x32_bf16 v[204:207], v[76:79], v[28:31], v[204:207]
    ds_read_b64_tr_b16 v[84:85], v20 offset:40960
    v_mfma_f32_16x16x32_bf16 v[208:211], v[80:83], v[28:31], v[208:211]
    ds_read_b128 v[28:31], v18 offset:6144
    v_mfma_f32_16x16x32_bf16 v[212:215], v[76:79], v[32:35], v[212:215]
    ds_read_b64_tr_b16 v[86:87], v20 offset:45056
    v_mfma_f32_16x16x32_bf16 v[216:219], v[80:83], v[32:35], v[216:219]
    ds_read_b128 v[32:35], v18 offset:6400
    v_mfma_f32_16x16x32_bf16 v[220:223], v[76:79], v[36:39], v[220:223]
    ds_read_b64_tr_b16 v[88:89], v21 offset:40960
    v_mfma_f32_16x16x32_bf16 v[224:227], v[80:83], v[36:39], v[224:227]
    ds_read_b128 v[36:39], v18 offset:6656
    s_waitcnt lgkmcnt(8)
    v_mfma_f32_16x16x32_bf16 v[228:231], v[76:79], v[40:43], v[228:231]
    ds_read_b64_tr_b16 v[90:91], v21 offset:45056
    v_mfma_f32_16x16x32_bf16 v[232:235], v[80:83], v[40:43], v[232:235]
    ds_read_b128 v[40:43], v18 offset:6912
    s_waitcnt lgkmcnt(9)
    v_mfma_f32_16x16x32_bf16 v[236:239], v[76:79], v[44:47], v[236:239]
    v_mfma_f32_16x16x32_bf16 v[240:243], v[80:83], v[44:47], v[240:243]
    ds_read_b128 v[44:47], v18 offset:7168
    s_waitcnt lgkmcnt(9)
    v_mfma_f32_16x16x32_bf16 v[244:247], v[76:79], v[48:51], v[244:247]
    v_mfma_f32_16x16x32_bf16 v[248:251], v[80:83], v[48:51], v[248:251]
    ds_read_b128 v[48:51], v18 offset:7424
    s_waitcnt lgkmcnt(3)
    v_mfma_f32_16x16x32_bf16 v[204:207], v[84:87], v[28:31], v[204:207]
    s_barrier
    ds_read_b64_tr_b16 v[76:77], v24 offset:0
    v_mfma_f32_16x16x32_bf16 v[208:211], v[88:91], v[28:31], v[208:211]
    ds_read_b128 v[28:31], v18 offset:12288
    v_mfma_f32_16x16x32_bf16 v[212:215], v[84:87], v[32:35], v[212:215]
    ds_read_b64_tr_b16 v[78:79], v24 offset:4096
    v_mfma_f32_16x16x32_bf16 v[216:219], v[88:91], v[32:35], v[216:219]
    ds_read_b128 v[32:35], v18 offset:12544
    v_mfma_f32_16x16x32_bf16 v[220:223], v[84:87], v[36:39], v[220:223]
    ds_read_b64_tr_b16 v[80:81], v25 offset:0
    v_mfma_f32_16x16x32_bf16 v[224:227], v[88:91], v[36:39], v[224:227]
    ds_read_b128 v[36:39], v18 offset:12800
    s_waitcnt lgkmcnt(8)
    v_mfma_f32_16x16x32_bf16 v[228:231], v[84:87], v[40:43], v[228:231]
    ds_read_b64_tr_b16 v[82:83], v25 offset:4096
    v_mfma_f32_16x16x32_bf16 v[232:235], v[88:91], v[40:43], v[232:235]
    ds_read_b128 v[40:43], v18 offset:13056
    s_waitcnt lgkmcnt(9)
    v_mfma_f32_16x16x32_bf16 v[236:239], v[84:87], v[44:47], v[236:239]
    v_mfma_f32_16x16x32_bf16 v[240:243], v[88:91], v[44:47], v[240:243]
    ds_read_b128 v[44:47], v18 offset:13312
    s_waitcnt lgkmcnt(9)
    v_mfma_f32_16x16x32_bf16 v[244:247], v[84:87], v[48:51], v[244:247]
    v_mfma_f32_16x16x32_bf16 v[248:251], v[88:91], v[48:51], v[248:251]
    ds_read_b128 v[48:51], v18 offset:13568
    s_waitcnt lgkmcnt(3)
    v_mfma_f32_16x16x32_bf16 v[204:207], v[76:79], v[28:31], v[204:207]
    ds_read_b64_tr_b16 v[84:85], v24 offset:8192
    v_mfma_f32_16x16x32_bf16 v[208:211], v[80:83], v[28:31], v[208:211]
    ds_read_b128 v[28:31], v18 offset:18432
    v_mfma_f32_16x16x32_bf16 v[212:215], v[76:79], v[32:35], v[212:215]
    ds_read_b64_tr_b16 v[86:87], v24 offset:12288
    v_mfma_f32_16x16x32_bf16 v[216:219], v[80:83], v[32:35], v[216:219]
    ds_read_b128 v[32:35], v18 offset:18688
    v_mfma_f32_16x16x32_bf16 v[220:223], v[76:79], v[36:39], v[220:223]
    ds_read_b64_tr_b16 v[88:89], v25 offset:8192
    v_mfma_f32_16x16x32_bf16 v[224:227], v[80:83], v[36:39], v[224:227]
    ds_read_b128 v[36:39], v18 offset:18944
    s_waitcnt lgkmcnt(8)
    v_mfma_f32_16x16x32_bf16 v[228:231], v[76:79], v[40:43], v[228:231]
    ds_read_b64_tr_b16 v[90:91], v25 offset:12288
    v_mfma_f32_16x16x32_bf16 v[232:235], v[80:83], v[40:43], v[232:235]
    ds_read_b128 v[40:43], v18 offset:19200
    s_waitcnt lgkmcnt(9)
    v_mfma_f32_16x16x32_bf16 v[236:239], v[76:79], v[44:47], v[236:239]
    v_mfma_f32_16x16x32_bf16 v[240:243], v[80:83], v[44:47], v[240:243]
    ds_read_b128 v[44:47], v18 offset:19456
    s_waitcnt lgkmcnt(9)
    v_mfma_f32_16x16x32_bf16 v[244:247], v[76:79], v[48:51], v[244:247]
    v_mfma_f32_16x16x32_bf16 v[248:251], v[80:83], v[48:51], v[248:251]
    ds_read_b128 v[48:51], v18 offset:19712
    s_waitcnt lgkmcnt(3)
    v_mfma_f32_16x16x32_bf16 v[204:207], v[84:87], v[28:31], v[204:207]
    s_barrier
    v_mfma_f32_16x16x32_bf16 v[208:211], v[88:91], v[28:31], v[208:211]
    ds_read_b128 v[28:31], v18 offset:24576
    v_mfma_f32_16x16x32_bf16 v[212:215], v[84:87], v[32:35], v[212:215]
    v_mfma_f32_16x16x32_bf16 v[216:219], v[88:91], v[32:35], v[216:219]
    ds_read_b128 v[32:35], v18 offset:24832
    v_mfma_f32_16x16x32_bf16 v[220:223], v[84:87], v[36:39], v[220:223]
    v_mfma_f32_16x16x32_bf16 v[224:227], v[88:91], v[36:39], v[224:227]
    ds_read_b128 v[36:39], v18 offset:25088
    s_waitcnt lgkmcnt(5)
    v_mfma_f32_16x16x32_bf16 v[228:231], v[84:87], v[40:43], v[228:231]
    v_mfma_f32_16x16x32_bf16 v[232:235], v[88:91], v[40:43], v[232:235]
    ds_read_b128 v[40:43], v18 offset:25344
    s_waitcnt lgkmcnt(5)
    v_mfma_f32_16x16x32_bf16 v[236:239], v[84:87], v[44:47], v[236:239]
    v_mfma_f32_16x16x32_bf16 v[240:243], v[88:91], v[44:47], v[240:243]
    ds_read_b128 v[44:47], v18 offset:25600
    s_waitcnt lgkmcnt(5)
    v_mfma_f32_16x16x32_bf16 v[244:247], v[84:87], v[48:51], v[244:247]
    v_mfma_f32_16x16x32_bf16 v[248:251], v[88:91], v[48:51], v[248:251]
    ds_read_b128 v[48:51], v18 offset:25856
    s_waitcnt lgkmcnt(3)
    v_mfma_f32_16x16x32_bf16 v[204:207], v[52:55], v[28:31], v[204:207]
    v_mfma_f32_16x16x32_bf16 v[208:211], v[56:59], v[28:31], v[208:211]
    ds_read_b128 v[28:31], v18 offset:30720
    v_mfma_f32_16x16x32_bf16 v[212:215], v[52:55], v[32:35], v[212:215]
    v_mfma_f32_16x16x32_bf16 v[216:219], v[56:59], v[32:35], v[216:219]
    ds_read_b128 v[32:35], v18 offset:30976
    v_mfma_f32_16x16x32_bf16 v[220:223], v[52:55], v[36:39], v[220:223]
    v_mfma_f32_16x16x32_bf16 v[224:227], v[56:59], v[36:39], v[224:227]
    ds_read_b128 v[36:39], v18 offset:31232
    s_waitcnt lgkmcnt(5)
    v_mfma_f32_16x16x32_bf16 v[228:231], v[52:55], v[40:43], v[228:231]
    v_mfma_f32_16x16x32_bf16 v[232:235], v[56:59], v[40:43], v[232:235]
    ds_read_b128 v[40:43], v18 offset:31488
    s_waitcnt lgkmcnt(5)
    v_mfma_f32_16x16x32_bf16 v[236:239], v[52:55], v[44:47], v[236:239]
    v_mfma_f32_16x16x32_bf16 v[240:243], v[56:59], v[44:47], v[240:243]
    ds_read_b128 v[44:47], v18 offset:31744
    s_waitcnt lgkmcnt(5)
    v_mfma_f32_16x16x32_bf16 v[244:247], v[52:55], v[48:51], v[244:247]
    v_mfma_f32_16x16x32_bf16 v[248:251], v[56:59], v[48:51], v[248:251]
    ds_read_b128 v[48:51], v18 offset:32000
    s_waitcnt lgkmcnt(3)
    v_mfma_f32_16x16x32_bf16 v[204:207], v[60:63], v[28:31], v[204:207]
    s_barrier
    ds_read_b64_tr_b16 v[76:77], v24 offset:16384
    v_mfma_f32_16x16x32_bf16 v[208:211], v[64:67], v[28:31], v[208:211]
    ds_read_b128 v[28:31], v18 offset:36864
    v_mfma_f32_16x16x32_bf16 v[212:215], v[60:63], v[32:35], v[212:215]
    ds_read_b64_tr_b16 v[78:79], v24 offset:20480
    v_mfma_f32_16x16x32_bf16 v[216:219], v[64:67], v[32:35], v[216:219]
    ds_read_b128 v[32:35], v18 offset:37120
    v_mfma_f32_16x16x32_bf16 v[220:223], v[60:63], v[36:39], v[220:223]
    ds_read_b64_tr_b16 v[80:81], v25 offset:16384
    v_mfma_f32_16x16x32_bf16 v[224:227], v[64:67], v[36:39], v[224:227]
    ds_read_b128 v[36:39], v18 offset:37376
    s_waitcnt lgkmcnt(8)
    v_mfma_f32_16x16x32_bf16 v[228:231], v[60:63], v[40:43], v[228:231]
    ds_read_b64_tr_b16 v[82:83], v25 offset:20480
    v_mfma_f32_16x16x32_bf16 v[232:235], v[64:67], v[40:43], v[232:235]
    ds_read_b128 v[40:43], v18 offset:37632
    s_waitcnt lgkmcnt(9)
    v_mfma_f32_16x16x32_bf16 v[236:239], v[60:63], v[44:47], v[236:239]
    v_mfma_f32_16x16x32_bf16 v[240:243], v[64:67], v[44:47], v[240:243]
    ds_read_b128 v[44:47], v18 offset:37888
    s_waitcnt lgkmcnt(9)
    v_mfma_f32_16x16x32_bf16 v[244:247], v[60:63], v[48:51], v[244:247]
    v_mfma_f32_16x16x32_bf16 v[248:251], v[64:67], v[48:51], v[248:251]
    ds_read_b128 v[48:51], v18 offset:38144
    s_waitcnt lgkmcnt(3)
    v_mfma_f32_16x16x32_bf16 v[204:207], v[76:79], v[28:31], v[204:207]
    ds_read_b64_tr_b16 v[84:85], v24 offset:24576
    v_mfma_f32_16x16x32_bf16 v[208:211], v[80:83], v[28:31], v[208:211]
    ds_read_b128 v[28:31], v18 offset:43008
    v_mfma_f32_16x16x32_bf16 v[212:215], v[76:79], v[32:35], v[212:215]
    ds_read_b64_tr_b16 v[86:87], v24 offset:28672
    v_mfma_f32_16x16x32_bf16 v[216:219], v[80:83], v[32:35], v[216:219]
    ds_read_b128 v[32:35], v18 offset:43264
    v_mfma_f32_16x16x32_bf16 v[220:223], v[76:79], v[36:39], v[220:223]
    ds_read_b64_tr_b16 v[88:89], v25 offset:24576
    v_mfma_f32_16x16x32_bf16 v[224:227], v[80:83], v[36:39], v[224:227]
    ds_read_b128 v[36:39], v18 offset:43520
    s_waitcnt lgkmcnt(8)
    v_mfma_f32_16x16x32_bf16 v[228:231], v[76:79], v[40:43], v[228:231]
    ds_read_b64_tr_b16 v[90:91], v25 offset:28672
    v_mfma_f32_16x16x32_bf16 v[232:235], v[80:83], v[40:43], v[232:235]
    ds_read_b128 v[40:43], v18 offset:43776
    s_waitcnt lgkmcnt(9)
    v_mfma_f32_16x16x32_bf16 v[236:239], v[76:79], v[44:47], v[236:239]
    v_mfma_f32_16x16x32_bf16 v[240:243], v[80:83], v[44:47], v[240:243]
    ds_read_b128 v[44:47], v18 offset:44032
    s_waitcnt lgkmcnt(9)
    v_mfma_f32_16x16x32_bf16 v[244:247], v[76:79], v[48:51], v[244:247]
    v_mfma_f32_16x16x32_bf16 v[248:251], v[80:83], v[48:51], v[248:251]
    ds_read_b128 v[48:51], v18 offset:44288
    s_waitcnt lgkmcnt(3)
    v_mfma_f32_16x16x32_bf16 v[204:207], v[84:87], v[28:31], v[204:207]
    s_barrier
    ds_read_b64_tr_b16 v[76:77], v24 offset:32768
    v_mfma_f32_16x16x32_bf16 v[208:211], v[88:91], v[28:31], v[208:211]
    ds_read_b128 v[28:31], v18 offset:49152
    v_mfma_f32_16x16x32_bf16 v[212:215], v[84:87], v[32:35], v[212:215]
    ds_read_b64_tr_b16 v[78:79], v24 offset:36864
    v_mfma_f32_16x16x32_bf16 v[216:219], v[88:91], v[32:35], v[216:219]
    ds_read_b128 v[32:35], v18 offset:49408
    v_mfma_f32_16x16x32_bf16 v[220:223], v[84:87], v[36:39], v[220:223]
    ds_read_b64_tr_b16 v[80:81], v25 offset:32768
    v_mfma_f32_16x16x32_bf16 v[224:227], v[88:91], v[36:39], v[224:227]
    ds_read_b128 v[36:39], v18 offset:49664
    s_waitcnt lgkmcnt(8)
    v_mfma_f32_16x16x32_bf16 v[228:231], v[84:87], v[40:43], v[228:231]
    ds_read_b64_tr_b16 v[82:83], v25 offset:36864
    v_mfma_f32_16x16x32_bf16 v[232:235], v[88:91], v[40:43], v[232:235]
    ds_read_b128 v[40:43], v18 offset:49920
    s_waitcnt lgkmcnt(9)
    v_mfma_f32_16x16x32_bf16 v[236:239], v[84:87], v[44:47], v[236:239]
    v_mfma_f32_16x16x32_bf16 v[240:243], v[88:91], v[44:47], v[240:243]
    ds_read_b128 v[44:47], v18 offset:50176
    s_waitcnt lgkmcnt(9)
    v_mfma_f32_16x16x32_bf16 v[244:247], v[84:87], v[48:51], v[244:247]
    v_mfma_f32_16x16x32_bf16 v[248:251], v[88:91], v[48:51], v[248:251]
    ds_read_b128 v[48:51], v18 offset:50432
    s_waitcnt lgkmcnt(3)
    v_mfma_f32_16x16x32_bf16 v[204:207], v[76:79], v[28:31], v[204:207]
    ds_read_b64_tr_b16 v[84:85], v24 offset:40960
    v_mfma_f32_16x16x32_bf16 v[208:211], v[80:83], v[28:31], v[208:211]
    ds_read_b128 v[28:31], v18 offset:55296
    v_mfma_f32_16x16x32_bf16 v[212:215], v[76:79], v[32:35], v[212:215]
    ds_read_b64_tr_b16 v[86:87], v24 offset:45056
    v_mfma_f32_16x16x32_bf16 v[216:219], v[80:83], v[32:35], v[216:219]
    ds_read_b128 v[32:35], v18 offset:55552
    v_mfma_f32_16x16x32_bf16 v[220:223], v[76:79], v[36:39], v[220:223]
    ds_read_b64_tr_b16 v[88:89], v25 offset:40960
    v_mfma_f32_16x16x32_bf16 v[224:227], v[80:83], v[36:39], v[224:227]
    ds_read_b128 v[36:39], v18 offset:55808
    s_waitcnt lgkmcnt(8)
    v_mfma_f32_16x16x32_bf16 v[228:231], v[76:79], v[40:43], v[228:231]
    ds_read_b64_tr_b16 v[90:91], v25 offset:45056
    v_mfma_f32_16x16x32_bf16 v[232:235], v[80:83], v[40:43], v[232:235]
    ds_read_b128 v[40:43], v18 offset:56064
    s_waitcnt lgkmcnt(9)
    v_mfma_f32_16x16x32_bf16 v[236:239], v[76:79], v[44:47], v[236:239]
    v_mfma_f32_16x16x32_bf16 v[240:243], v[80:83], v[44:47], v[240:243]
    ds_read_b128 v[44:47], v18 offset:56320
    s_waitcnt lgkmcnt(9)
    v_mfma_f32_16x16x32_bf16 v[244:247], v[76:79], v[48:51], v[244:247]
    v_mfma_f32_16x16x32_bf16 v[248:251], v[80:83], v[48:51], v[248:251]
    ds_read_b128 v[48:51], v18 offset:56576
    s_waitcnt lgkmcnt(3)
    v_mfma_f32_16x16x32_bf16 v[204:207], v[84:87], v[28:31], v[204:207]
    s_barrier
    ds_read_b64_tr_b16 v[76:77], v20 offset:0
    v_mfma_f32_16x16x32_bf16 v[208:211], v[88:91], v[28:31], v[208:211]
    ds_read_b128 v[28:31], v18 offset:0
    v_mfma_f32_16x16x32_bf16 v[212:215], v[84:87], v[32:35], v[212:215]
    ds_read_b64_tr_b16 v[78:79], v20 offset:4096
    v_mfma_f32_16x16x32_bf16 v[216:219], v[88:91], v[32:35], v[216:219]
    ds_read_b128 v[32:35], v18 offset:256
    v_mfma_f32_16x16x32_bf16 v[220:223], v[84:87], v[36:39], v[220:223]
    ds_read_b64_tr_b16 v[80:81], v21 offset:0
    v_mfma_f32_16x16x32_bf16 v[224:227], v[88:91], v[36:39], v[224:227]
    ds_read_b128 v[36:39], v18 offset:512
    s_waitcnt lgkmcnt(8)
    v_mfma_f32_16x16x32_bf16 v[228:231], v[84:87], v[40:43], v[228:231]
    ds_read_b64_tr_b16 v[82:83], v21 offset:4096
    v_mfma_f32_16x16x32_bf16 v[232:235], v[88:91], v[40:43], v[232:235]
    ds_read_b128 v[40:43], v18 offset:768
    s_waitcnt lgkmcnt(9)
    v_mfma_f32_16x16x32_bf16 v[236:239], v[84:87], v[44:47], v[236:239]
    v_mfma_f32_16x16x32_bf16 v[240:243], v[88:91], v[44:47], v[240:243]
    ds_read_b128 v[44:47], v18 offset:1024
    s_waitcnt lgkmcnt(9)
    v_mfma_f32_16x16x32_bf16 v[244:247], v[84:87], v[48:51], v[244:247]
    v_mfma_f32_16x16x32_bf16 v[248:251], v[88:91], v[48:51], v[248:251]
    ds_read_b128 v[48:51], v18 offset:1280
    s_waitcnt lgkmcnt(3)
    v_mfma_f32_16x16x32_bf16 v[204:207], v[76:79], v[28:31], v[204:207]
    ds_read_b64_tr_b16 v[84:85], v20 offset:8192
    v_mfma_f32_16x16x32_bf16 v[208:211], v[80:83], v[28:31], v[208:211]
    ds_read_b128 v[28:31], v18 offset:6144
    v_mfma_f32_16x16x32_bf16 v[212:215], v[76:79], v[32:35], v[212:215]
    ds_read_b64_tr_b16 v[86:87], v20 offset:12288
    v_mfma_f32_16x16x32_bf16 v[216:219], v[80:83], v[32:35], v[216:219]
    ds_read_b128 v[32:35], v18 offset:6400
    v_mfma_f32_16x16x32_bf16 v[220:223], v[76:79], v[36:39], v[220:223]
    ds_read_b64_tr_b16 v[88:89], v21 offset:8192
    v_mfma_f32_16x16x32_bf16 v[224:227], v[80:83], v[36:39], v[224:227]
    ds_read_b128 v[36:39], v18 offset:6656
    s_waitcnt lgkmcnt(8)
    v_mfma_f32_16x16x32_bf16 v[228:231], v[76:79], v[40:43], v[228:231]
    ds_read_b64_tr_b16 v[90:91], v21 offset:12288
    v_mfma_f32_16x16x32_bf16 v[232:235], v[80:83], v[40:43], v[232:235]
    ds_read_b128 v[40:43], v18 offset:6912
    s_waitcnt lgkmcnt(9)
    v_mfma_f32_16x16x32_bf16 v[236:239], v[76:79], v[44:47], v[236:239]
    v_mfma_f32_16x16x32_bf16 v[240:243], v[80:83], v[44:47], v[240:243]
    ds_read_b128 v[44:47], v18 offset:7168
    s_waitcnt lgkmcnt(9)
    v_mfma_f32_16x16x32_bf16 v[244:247], v[76:79], v[48:51], v[244:247]
    v_mfma_f32_16x16x32_bf16 v[248:251], v[80:83], v[48:51], v[248:251]
    ds_read_b128 v[48:51], v18 offset:7424
    s_waitcnt lgkmcnt(3)
    v_mfma_f32_16x16x32_bf16 v[204:207], v[84:87], v[28:31], v[204:207]
    s_barrier
    ds_read_b64_tr_b16 v[76:77], v20 offset:16384
    v_mfma_f32_16x16x32_bf16 v[208:211], v[88:91], v[28:31], v[208:211]
    ds_read_b128 v[28:31], v18 offset:12288
    v_mfma_f32_16x16x32_bf16 v[212:215], v[84:87], v[32:35], v[212:215]
    ds_read_b64_tr_b16 v[78:79], v20 offset:20480
    v_mfma_f32_16x16x32_bf16 v[216:219], v[88:91], v[32:35], v[216:219]
    ds_read_b128 v[32:35], v18 offset:12544
    v_mfma_f32_16x16x32_bf16 v[220:223], v[84:87], v[36:39], v[220:223]
    ds_read_b64_tr_b16 v[80:81], v21 offset:16384
    v_mfma_f32_16x16x32_bf16 v[224:227], v[88:91], v[36:39], v[224:227]
    ds_read_b128 v[36:39], v18 offset:12800
    s_waitcnt lgkmcnt(8)
    v_mfma_f32_16x16x32_bf16 v[228:231], v[84:87], v[40:43], v[228:231]
    ds_read_b64_tr_b16 v[82:83], v21 offset:20480
    v_mfma_f32_16x16x32_bf16 v[232:235], v[88:91], v[40:43], v[232:235]
    ds_read_b128 v[40:43], v18 offset:13056
    s_waitcnt lgkmcnt(9)
    v_mfma_f32_16x16x32_bf16 v[236:239], v[84:87], v[44:47], v[236:239]
    v_mfma_f32_16x16x32_bf16 v[240:243], v[88:91], v[44:47], v[240:243]
    ds_read_b128 v[44:47], v18 offset:13312
    s_waitcnt lgkmcnt(9)
    v_mfma_f32_16x16x32_bf16 v[244:247], v[84:87], v[48:51], v[244:247]
    v_mfma_f32_16x16x32_bf16 v[248:251], v[88:91], v[48:51], v[248:251]
    ds_read_b128 v[48:51], v18 offset:13568
    s_waitcnt lgkmcnt(3)
    v_mfma_f32_16x16x32_bf16 v[204:207], v[76:79], v[28:31], v[204:207]
    ds_read_b64_tr_b16 v[84:85], v20 offset:24576
    v_mfma_f32_16x16x32_bf16 v[208:211], v[80:83], v[28:31], v[208:211]
    ds_read_b128 v[28:31], v18 offset:18432
    v_mfma_f32_16x16x32_bf16 v[212:215], v[76:79], v[32:35], v[212:215]
    ds_read_b64_tr_b16 v[86:87], v20 offset:28672
    v_mfma_f32_16x16x32_bf16 v[216:219], v[80:83], v[32:35], v[216:219]
    ds_read_b128 v[32:35], v18 offset:18688
    v_mfma_f32_16x16x32_bf16 v[220:223], v[76:79], v[36:39], v[220:223]
    ds_read_b64_tr_b16 v[88:89], v21 offset:24576
    v_mfma_f32_16x16x32_bf16 v[224:227], v[80:83], v[36:39], v[224:227]
    ds_read_b128 v[36:39], v18 offset:18944
    s_waitcnt lgkmcnt(8)
    v_mfma_f32_16x16x32_bf16 v[228:231], v[76:79], v[40:43], v[228:231]
    ds_read_b64_tr_b16 v[90:91], v21 offset:28672
    v_mfma_f32_16x16x32_bf16 v[232:235], v[80:83], v[40:43], v[232:235]
    ds_read_b128 v[40:43], v18 offset:19200
    s_waitcnt lgkmcnt(9)
    v_mfma_f32_16x16x32_bf16 v[236:239], v[76:79], v[44:47], v[236:239]
    v_mfma_f32_16x16x32_bf16 v[240:243], v[80:83], v[44:47], v[240:243]
    ds_read_b128 v[44:47], v18 offset:19456
    s_waitcnt lgkmcnt(9)
    v_mfma_f32_16x16x32_bf16 v[244:247], v[76:79], v[48:51], v[244:247]
    v_mfma_f32_16x16x32_bf16 v[248:251], v[80:83], v[48:51], v[248:251]
    ds_read_b128 v[48:51], v18 offset:19712
    s_waitcnt lgkmcnt(0)
    s_barrier
    v_mfma_f32_16x16x32_bf16 v[204:207], v[84:87], v[28:31], v[204:207]
    v_mfma_f32_16x16x32_bf16 v[208:211], v[88:91], v[28:31], v[208:211]
    v_mfma_f32_16x16x32_bf16 v[212:215], v[84:87], v[32:35], v[212:215]
    v_mfma_f32_16x16x32_bf16 v[216:219], v[88:91], v[32:35], v[216:219]
    v_mfma_f32_16x16x32_bf16 v[220:223], v[84:87], v[36:39], v[220:223]
    v_mfma_f32_16x16x32_bf16 v[224:227], v[88:91], v[36:39], v[224:227]
    v_mfma_f32_16x16x32_bf16 v[228:231], v[84:87], v[40:43], v[228:231]
    v_mfma_f32_16x16x32_bf16 v[232:235], v[88:91], v[40:43], v[232:235]
    v_mfma_f32_16x16x32_bf16 v[236:239], v[84:87], v[44:47], v[236:239]
    v_mfma_f32_16x16x32_bf16 v[240:243], v[88:91], v[44:47], v[240:243]
    v_mfma_f32_16x16x32_bf16 v[244:247], v[84:87], v[48:51], v[244:247]
    v_mfma_f32_16x16x32_bf16 v[248:251], v[88:91], v[48:51], v[248:251]
    s_lshl_b32 s48, s51, 2
    s_add_u32 s48, s48, s3
    s_mul_i32 s48, s48, 36864
    s_mul_i32 s49, s52, 1536
    s_add_u32 s48, s48, s49
    s_add_u32 s48, s48, 20971520
    v_mul_u32_u24 v22, 9216, v2
    v_lshl_add_u32 v22, v1, 4, v22
    s_mov_b32 s60, 0xbdd2d3e8
    v_mov_b32 v4, 0xc0135761
    v_pk_mul_f32 v[28:29], v[204:205], v[204:205]
    v_pk_mul_f32 v[30:31], v[206:207], v[206:207]
    v_pk_mul_f32 v[32:33], v[208:209], v[208:209]
    v_pk_mul_f32 v[34:35], v[210:211], v[210:211]
    v_pk_fma_f32 v[28:29], v[28:29], s[60:61], v[4:5] op_sel_hi:[1,0,0]
    v_pk_fma_f32 v[30:31], v[30:31], s[60:61], v[4:5] op_sel_hi:[1,0,0]
    v_pk_fma_f32 v[32:33], v[32:33], s[60:61], v[4:5] op_sel_hi:[1,0,0]
    v_pk_fma_f32 v[34:35], v[34:35], s[60:61], v[4:5] op_sel_hi:[1,0,0]
    v_pk_mul_f32 v[28:29], v[28:29], v[204:205]
    v_pk_mul_f32 v[30:31], v[30:31], v[206:207]
    v_pk_mul_f32 v[32:33], v[32:33], v[208:209]
    v_pk_mul_f32 v[34:35], v[34:35], v[210:211]
    v_exp_f32 v28, v28
    v_exp_f32 v29, v29
    v_exp_f32 v30, v30
    v_exp_f32 v31, v31
    v_exp_f32 v32, v32
    v_exp_f32 v33, v33
    v_exp_f32 v34, v34
    v_exp_f32 v35, v35
    v_pk_add_f32 v[28:29], v[28:29], 1.0 op_sel_hi:[1,0]
    v_pk_add_f32 v[30:31], v[30:31], 1.0 op_sel_hi:[1,0]
    v_pk_add_f32 v[32:33], v[32:33], 1.0 op_sel_hi:[1,0]
    v_pk_add_f32 v[34:35], v[34:35], 1.0 op_sel_hi:[1,0]
    v_rcp_f32 v28, v28
    v_rcp_f32 v29, v29
    v_rcp_f32 v30, v30
    v_rcp_f32 v31, v31
    v_rcp_f32 v32, v32
    v_rcp_f32 v33, v33
    v_rcp_f32 v34, v34
    v_rcp_f32 v35, v35
    v_pk_mul_f32 v[28:29], v[28:29], v[204:205]
    v_pk_mul_f32 v[30:31], v[30:31], v[206:207]
    v_pk_mul_f32 v[32:33], v[32:33], v[208:209]
    v_pk_mul_f32 v[34:35], v[34:35], v[210:211]
    v_cvt_pk_bf16_f32 v76, v28, v29
    v_cvt_pk_bf16_f32 v77, v30, v31
    v_cvt_pk_bf16_f32 v78, v32, v33
    v_cvt_pk_bf16_f32 v79, v34, v35
    buffer_store_dwordx4 v[76:79], v22, s[36:39], s48 offen offset:0 sc1
    v_pk_mul_f32 v[36:37], v[212:213], v[212:213]
    v_pk_mul_f32 v[38:39], v[214:215], v[214:215]
    v_pk_mul_f32 v[40:41], v[216:217], v[216:217]
    v_pk_mul_f32 v[42:43], v[218:219], v[218:219]
    v_pk_fma_f32 v[36:37], v[36:37], s[60:61], v[4:5] op_sel_hi:[1,0,0]
    v_pk_fma_f32 v[38:39], v[38:39], s[60:61], v[4:5] op_sel_hi:[1,0,0]
    v_pk_fma_f32 v[40:41], v[40:41], s[60:61], v[4:5] op_sel_hi:[1,0,0]
    v_pk_fma_f32 v[42:43], v[42:43], s[60:61], v[4:5] op_sel_hi:[1,0,0]
    v_pk_mul_f32 v[36:37], v[36:37], v[212:213]
    v_pk_mul_f32 v[38:39], v[38:39], v[214:215]
    v_pk_mul_f32 v[40:41], v[40:41], v[216:217]
    v_pk_mul_f32 v[42:43], v[42:43], v[218:219]
    v_exp_f32 v36, v36
    v_exp_f32 v37, v37
    v_exp_f32 v38, v38
    v_exp_f32 v39, v39
    v_exp_f32 v40, v40
    v_exp_f32 v41, v41
    v_exp_f32 v42, v42
    v_exp_f32 v43, v43
    v_pk_add_f32 v[36:37], v[36:37], 1.0 op_sel_hi:[1,0]
    v_pk_add_f32 v[38:39], v[38:39], 1.0 op_sel_hi:[1,0]
    v_pk_add_f32 v[40:41], v[40:41], 1.0 op_sel_hi:[1,0]
    v_pk_add_f32 v[42:43], v[42:43], 1.0 op_sel_hi:[1,0]
    v_rcp_f32 v36, v36
    v_rcp_f32 v37, v37
    v_rcp_f32 v38, v38
    v_rcp_f32 v39, v39
    v_rcp_f32 v40, v40
    v_rcp_f32 v41, v41
    v_rcp_f32 v42, v42
    v_rcp_f32 v43, v43
    v_pk_mul_f32 v[36:37], v[36:37], v[212:213]
    v_pk_mul_f32 v[38:39], v[38:39], v[214:215]
    v_pk_mul_f32 v[40:41], v[40:41], v[216:217]
    v_pk_mul_f32 v[42:43], v[42:43], v[218:219]
    v_cvt_pk_bf16_f32 v80, v36, v37
    v_cvt_pk_bf16_f32 v81, v38, v39
    v_cvt_pk_bf16_f32 v82, v40, v41
    v_cvt_pk_bf16_f32 v83, v42, v43
    buffer_store_dwordx4 v[80:83], v22, s[36:39], s48 offen offset:256 sc1
    v_pk_mul_f32 v[28:29], v[220:221], v[220:221]
    v_pk_mul_f32 v[30:31], v[222:223], v[222:223]
    v_pk_mul_f32 v[32:33], v[224:225], v[224:225]
    v_pk_mul_f32 v[34:35], v[226:227], v[226:227]
    v_pk_fma_f32 v[28:29], v[28:29], s[60:61], v[4:5] op_sel_hi:[1,0,0]
    v_pk_fma_f32 v[30:31], v[30:31], s[60:61], v[4:5] op_sel_hi:[1,0,0]
    v_pk_fma_f32 v[32:33], v[32:33], s[60:61], v[4:5] op_sel_hi:[1,0,0]
    v_pk_fma_f32 v[34:35], v[34:35], s[60:61], v[4:5] op_sel_hi:[1,0,0]
    v_pk_mul_f32 v[28:29], v[28:29], v[220:221]
    v_pk_mul_f32 v[30:31], v[30:31], v[222:223]
    v_pk_mul_f32 v[32:33], v[32:33], v[224:225]
    v_pk_mul_f32 v[34:35], v[34:35], v[226:227]
    v_exp_f32 v28, v28
    v_exp_f32 v29, v29
    v_exp_f32 v30, v30
    v_exp_f32 v31, v31
    v_exp_f32 v32, v32
    v_exp_f32 v33, v33
    v_exp_f32 v34, v34
    v_exp_f32 v35, v35
    v_pk_add_f32 v[28:29], v[28:29], 1.0 op_sel_hi:[1,0]
    v_pk_add_f32 v[30:31], v[30:31], 1.0 op_sel_hi:[1,0]
    v_pk_add_f32 v[32:33], v[32:33], 1.0 op_sel_hi:[1,0]
    v_pk_add_f32 v[34:35], v[34:35], 1.0 op_sel_hi:[1,0]
    v_rcp_f32 v28, v28
    v_rcp_f32 v29, v29
    v_rcp_f32 v30, v30
    v_rcp_f32 v31, v31
    v_rcp_f32 v32, v32
    v_rcp_f32 v33, v33
    v_rcp_f32 v34, v34
    v_rcp_f32 v35, v35
    v_pk_mul_f32 v[28:29], v[28:29], v[220:221]
    v_pk_mul_f32 v[30:31], v[30:31], v[222:223]
    v_pk_mul_f32 v[32:33], v[32:33], v[224:225]
    v_pk_mul_f32 v[34:35], v[34:35], v[226:227]
    v_cvt_pk_bf16_f32 v76, v28, v29
    v_cvt_pk_bf16_f32 v77, v30, v31
    v_cvt_pk_bf16_f32 v78, v32, v33
    v_cvt_pk_bf16_f32 v79, v34, v35
    buffer_store_dwordx4 v[76:79], v22, s[36:39], s48 offen offset:512 sc1
    v_pk_mul_f32 v[36:37], v[228:229], v[228:229]
    v_pk_mul_f32 v[38:39], v[230:231], v[230:231]
    v_pk_mul_f32 v[40:41], v[232:233], v[232:233]
    v_pk_mul_f32 v[42:43], v[234:235], v[234:235]
    v_pk_fma_f32 v[36:37], v[36:37], s[60:61], v[4:5] op_sel_hi:[1,0,0]
    v_pk_fma_f32 v[38:39], v[38:39], s[60:61], v[4:5] op_sel_hi:[1,0,0]
    v_pk_fma_f32 v[40:41], v[40:41], s[60:61], v[4:5] op_sel_hi:[1,0,0]
    v_pk_fma_f32 v[42:43], v[42:43], s[60:61], v[4:5] op_sel_hi:[1,0,0]
    v_pk_mul_f32 v[36:37], v[36:37], v[228:229]
    v_pk_mul_f32 v[38:39], v[38:39], v[230:231]
    v_pk_mul_f32 v[40:41], v[40:41], v[232:233]
    v_pk_mul_f32 v[42:43], v[42:43], v[234:235]
    v_exp_f32 v36, v36
    v_exp_f32 v37, v37
    v_exp_f32 v38, v38
    v_exp_f32 v39, v39
    v_exp_f32 v40, v40
    v_exp_f32 v41, v41
    v_exp_f32 v42, v42
    v_exp_f32 v43, v43
    v_pk_add_f32 v[36:37], v[36:37], 1.0 op_sel_hi:[1,0]
    v_pk_add_f32 v[38:39], v[38:39], 1.0 op_sel_hi:[1,0]
    v_pk_add_f32 v[40:41], v[40:41], 1.0 op_sel_hi:[1,0]
    v_pk_add_f32 v[42:43], v[42:43], 1.0 op_sel_hi:[1,0]
    v_rcp_f32 v36, v36
    v_rcp_f32 v37, v37
    v_rcp_f32 v38, v38
    v_rcp_f32 v39, v39
    v_rcp_f32 v40, v40
    v_rcp_f32 v41, v41
    v_rcp_f32 v42, v42
    v_rcp_f32 v43, v43
    v_pk_mul_f32 v[36:37], v[36:37], v[228:229]
    v_pk_mul_f32 v[38:39], v[38:39], v[230:231]
    v_pk_mul_f32 v[40:41], v[40:41], v[232:233]
    v_pk_mul_f32 v[42:43], v[42:43], v[234:235]
    v_cvt_pk_bf16_f32 v80, v36, v37
    v_cvt_pk_bf16_f32 v81, v38, v39
    v_cvt_pk_bf16_f32 v82, v40, v41
    v_cvt_pk_bf16_f32 v83, v42, v43
    buffer_store_dwordx4 v[80:83], v22, s[36:39], s48 offen offset:768 sc1
    v_pk_mul_f32 v[28:29], v[236:237], v[236:237]
    v_pk_mul_f32 v[30:31], v[238:239], v[238:239]
    v_pk_mul_f32 v[32:33], v[240:241], v[240:241]
    v_pk_mul_f32 v[34:35], v[242:243], v[242:243]
    v_pk_fma_f32 v[28:29], v[28:29], s[60:61], v[4:5] op_sel_hi:[1,0,0]
    v_pk_fma_f32 v[30:31], v[30:31], s[60:61], v[4:5] op_sel_hi:[1,0,0]
    v_pk_fma_f32 v[32:33], v[32:33], s[60:61], v[4:5] op_sel_hi:[1,0,0]
    v_pk_fma_f32 v[34:35], v[34:35], s[60:61], v[4:5] op_sel_hi:[1,0,0]
    v_pk_mul_f32 v[28:29], v[28:29], v[236:237]
    v_pk_mul_f32 v[30:31], v[30:31], v[238:239]
    v_pk_mul_f32 v[32:33], v[32:33], v[240:241]
    v_pk_mul_f32 v[34:35], v[34:35], v[242:243]
    v_exp_f32 v28, v28
    v_exp_f32 v29, v29
    v_exp_f32 v30, v30
    v_exp_f32 v31, v31
    v_exp_f32 v32, v32
    v_exp_f32 v33, v33
    v_exp_f32 v34, v34
    v_exp_f32 v35, v35
    v_pk_add_f32 v[28:29], v[28:29], 1.0 op_sel_hi:[1,0]
    v_pk_add_f32 v[30:31], v[30:31], 1.0 op_sel_hi:[1,0]
    v_pk_add_f32 v[32:33], v[32:33], 1.0 op_sel_hi:[1,0]
    s_branch L_skip_6
    s_nop 0
L_stub_6:
    s_branch L_stub_7
L_skip_6:
    v_pk_add_f32 v[34:35], v[34:35], 1.0 op_sel_hi:[1,0]
    v_rcp_f32 v28, v28
    v_rcp_f32 v29, v29
    v_rcp_f32 v30, v30
    v_rcp_f32 v31, v31
    v_rcp_f32 v32, v32
    v_rcp_f32 v33, v33
    v_rcp_f32 v34, v34
    v_rcp_f32 v35, v35
    v_pk_mul_f32 v[28:29], v[28:29], v[236:237]
    v_pk_mul_f32 v[30:31], v[30:31], v[238:239]
    v_pk_mul_f32 v[32:33], v[32:33], v[240:241]
    v_pk_mul_f32 v[34:35], v[34:35], v[242:243]
    v_cvt_pk_bf16_f32 v76, v28, v29
    v_cvt_pk_bf16_f32 v77, v30, v31
    v_cvt_pk_bf16_f32 v78, v32, v33
    v_cvt_pk_bf16_f32 v79, v34, v35
    buffer_store_dwordx4 v[76:79], v22, s[36:39], s48 offen offset:1024 sc1
    v_pk_mul_f32 v[36:37], v[244:245], v[244:245]
    v_pk_mul_f32 v[38:39], v[246:247], v[246:247]
    v_pk_mul_f32 v[40:41], v[248:249], v[248:249]
    v_pk_mul_f32 v[42:43], v[250:251], v[250:251]
    v_pk_fma_f32 v[36:37], v[36:37], s[60:61], v[4:5] op_sel_hi:[1,0,0]
    v_pk_fma_f32 v[38:39], v[38:39], s[60:61], v[4:5] op_sel_hi:[1,0,0]
    v_pk_fma_f32 v[40:41], v[40:41], s[60:61], v[4:5] op_sel_hi:[1,0,0]
    v_pk_fma_f32 v[42:43], v[42:43], s[60:61], v[4:5] op_sel_hi:[1,0,0]
    v_pk_mul_f32 v[36:37], v[36:37], v[244:245]
    v_pk_mul_f32 v[38:39], v[38:39], v[246:247]
    v_pk_mul_f32 v[40:41], v[40:41], v[248:249]
    v_pk_mul_f32 v[42:43], v[42:43], v[250:251]
    v_exp_f32 v36, v36
    v_exp_f32 v37, v37
    v_exp_f32 v38, v38
    v_exp_f32 v39, v39
    v_exp_f32 v40, v40
    v_exp_f32 v41, v41
    v_exp_f32 v42, v42
    v_exp_f32 v43, v43
    v_pk_add_f32 v[36:37], v[36:37], 1.0 op_sel_hi:[1,0]
    v_pk_add_f32 v[38:39], v[38:39], 1.0 op_sel_hi:[1,0]
    v_pk_add_f32 v[40:41], v[40:41], 1.0 op_sel_hi:[1,0]
    v_pk_add_f32 v[42:43], v[42:43], 1.0 op_sel_hi:[1,0]
    v_rcp_f32 v36, v36
    v_rcp_f32 v37, v37
    v_rcp_f32 v38, v38
    v_rcp_f32 v39, v39
    v_rcp_f32 v40, v40
    v_rcp_f32 v41, v41
    v_rcp_f32 v42, v42
    v_rcp_f32 v43, v43
    v_pk_mul_f32 v[36:37], v[36:37], v[244:245]
    v_pk_mul_f32 v[38:39], v[38:39], v[246:247]
    v_pk_mul_f32 v[40:41], v[40:41], v[248:249]
    v_pk_mul_f32 v[42:43], v[42:43], v[250:251]
    v_cvt_pk_bf16_f32 v80, v36, v37
    v_cvt_pk_bf16_f32 v81, v38, v39
    v_cvt_pk_bf16_f32 v82, v40, v41
    v_cvt_pk_bf16_f32 v83, v42, v43
    buffer_store_dwordx4 v[80:83], v22, s[36:39], s48 offen offset:1280 sc1
    s_branch L_m_22
L_m_21:
    s_waitcnt vmcnt(0)
    s_barrier
    s_mov_b32 s40, s16
    s_mov_b32 s41, s17
    s_mov_b32 s42, 18874368
    s_mov_b32 s43, 0x20000
    s_mov_b32 s44, s20
    s_mov_b32 s45, s21
    s_mov_b32 s46, 18874368
    s_mov_b32 s47, 0x20000
    s_mul_i32 s56, s3, 5
    s_add_u32 s56, s56, s5
    s_sub_u32 s56, s56, 27
    s_add_u32 s57, s56, 116
    s_add_u32 s56, s56, 0
L_m_23:
    s_cmp_ge_u32 s57, 320
    s_cbranch_scc1 L_m_24
    s_mul_i32 s48, s57, 820
    s_lshr_b32 s48, s48, 13
    s_mul_i32 s49, s48, 10
    s_sub_u32 s49, s57, s49
    s_lshl_b32 s49, s49, 6
    v_add_u32 v10, s49, v0
    s_and_b32 s49, s4, 7
    s_mul_i32 s49, s49, 4
    s_add_u32 s48, s48, s49
    s_add_u32 s48, s48, 26
    s_and_b32 s48, s48, 31
    s_mul_i32 s48, s48, 73728
    s_mul_i32 s49, s4, 1152
    s_and_b32 s49, s49, -256
    s_add_u32 s48, s48, s49
    v_mul_u32_u24 v11, 820, v10
    v_lshrrev_b32 v11, 13, v11
    v_mul_u32_u24 v12, 10, v11
    v_sub_u32 v12, v10, v12
    v_and_b32 v10, 7, v11
    v_lshrrev_b32 v11, 3, v11
    v_lshl_add_u32 v10, v10, 8, v11
    v_mul_u32_u24 v10, 9216, v10
    v_lshl_add_u32 v10, v12, 7, v10
    buffer_load_dword v13, v10, s[40:43], s48 offen
    s_add_u32 s57, s57, 20
    s_branch L_m_23
L_m_24:
    v_lshrrev_b32 v14, 4, v0
    v_and_b32 v15, 15, v0
    v_lshlrev_b32 v14, 12, v14
    v_lshl_add_u32 v14, v15, 7, v14
    s_lshr_b32 s48, s4, 1
    s_mul_i32 s48, s48, 4718592
    s_and_b32 s49, s4, 1
    s_lshl_b32 s49, s49, 11
    s_add_u32 s48, s48, s49
    v_add_u32 v14, s48, v14
    s_mov_b32 s50, 0
L_m_25:
    s_cmp_ge_u32 s56, 52
    s_cbranch_scc1 L_m_26
    s_add_u32 s48, s56, s50
    s_cmp_ge_u32 s48, 288
    s_cselect_b32 s49, 288, 0
    s_sub_u32 s48, s48, s49
    s_lshl_b32 s48, s48, 14
    buffer_load_dword v17, v14, s[44:47], s48 offen
    s_add_u32 s56, s56, 20
    s_branch L_m_25
L_m_26:
    s_waitcnt vmcnt(0)
    s_waitcnt vmcnt(0)
    s_barrier
    s_branch L_skip_7
L_stub_7:
    s_branch L_back_c2
L_skip_7:
L_m_22:
    s_lshr_b32 s58, s53, 1
    v_lshrrev_b32 v10, 2, v0
    v_and_b32 v11, 7, v10
    s_lshl_b32 s59, s3, 1
    s_add_u32 s59, s59, s58
    v_xor_b32 v11, s59, v11
    v_xor_b32 v12, 1, v11
    v_and_b32 v13, 3, v0
    v_lshlrev_b32 v13, 3, v13
    v_lshl_add_u32 v10, v10, 8, v13
    v_lshl_add_u32 v20, v11, 5, v10
    v_lshl_add_u32 v21, v12, 5, v10
    s_barrier
    v_add_u32 v24, 0, v20
    v_add_u32 v25, 0, v21
    ds_read_b64_tr_b16 v[92:93], v24 offset:32768
    ds_read_b64_tr_b16 v[94:95], v24 offset:36864
    ds_read_b64_tr_b16 v[96:97], v25 offset:32768
    ds_read_b64_tr_b16 v[98:99], v25 offset:36864
    ds_read_b64_tr_b16 v[100:101], v24 offset:40960
    ds_read_b64_tr_b16 v[102:103], v24 offset:45056
    ds_read_b64_tr_b16 v[104:105], v25 offset:40960
    ds_read_b64_tr_b16 v[106:107], v25 offset:45056
    ds_read_b64_tr_b16 v[156:157], v24 offset:0
    ds_read_b64_tr_b16 v[158:159], v24 offset:4096
    ds_read_b64_tr_b16 v[160:161], v25 offset:0
    ds_read_b64_tr_b16 v[162:163], v25 offset:4096
    ds_read_b64_tr_b16 v[164:165], v24 offset:8192
    ds_read_b64_tr_b16 v[166:167], v24 offset:12288
    ds_read_b64_tr_b16 v[168:169], v25 offset:8192
    ds_read_b64_tr_b16 v[170:171], v25 offset:12288
    ds_read_b64_tr_b16 v[172:173], v24 offset:16384
    ds_read_b64_tr_b16 v[174:175], v24 offset:20480
    ds_read_b64_tr_b16 v[176:177], v25 offset:16384
    ds_read_b64_tr_b16 v[178:179], v25 offset:20480
    ds_read_b64_tr_b16 v[180:181], v24 offset:24576
    ds_read_b64_tr_b16 v[182:183], v24 offset:28672
    ds_read_b64_tr_b16 v[184:185], v25 offset:24576
    ds_read_b64_tr_b16 v[186:187], v25 offset:28672
    v_add_u32 v24, 49152, v20
    v_add_u32 v25, 49152, v21
    ds_read_b64_tr_b16 v[108:109], v24 offset:0
    ds_read_b64_tr_b16 v[110:111], v24 offset:4096
    ds_read_b64_tr_b16 v[112:113], v25 offset:0
    ds_read_b64_tr_b16 v[114:115], v25 offset:4096
    ds_read_b64_tr_b16 v[116:117], v24 offset:8192
    ds_read_b64_tr_b16 v[118:119], v24 offset:12288
    ds_read_b64_tr_b16 v[120:121], v25 offset:8192
    ds_read_b64_tr_b16 v[122:123], v25 offset:12288
    ds_read_b64_tr_b16 v[124:125], v24 offset:16384
    ds_read_b64_tr_b16 v[126:127], v24 offset:20480
    ds_read_b64_tr_b16 v[128:129], v25 offset:16384
    ds_read_b64_tr_b16 v[130:131], v25 offset:20480
    ds_read_b64_tr_b16 v[132:133], v24 offset:24576
    ds_read_b64_tr_b16 v[134:135], v24 offset:28672
    ds_read_b64_tr_b16 v[136:137], v25 offset:24576
    ds_read_b64_tr_b16 v[138:139], v25 offset:28672
    ds_read_b64_tr_b16 v[140:141], v24 offset:32768
    ds_read_b64_tr_b16 v[142:143], v24 offset:36864
    ds_read_b64_tr_b16 v[144:145], v25 offset:32768
    ds_read_b64_tr_b16 v[146:147], v25 offset:36864
    ds_read_b64_tr_b16 v[148:149], v24 offset:40960
    ds_read_b64_tr_b16 v[150:151], v24 offset:45056
    ds_read_b64_tr_b16 v[152:153], v25 offset:40960
    ds_read_b64_tr_b16 v[154:155], v25 offset:45056
    s_waitcnt lgkmcnt(0)
    s_barrier
    s_waitcnt vmcnt(0)
    s_barrier
    s_and_b32 s58, s53, 1
    s_mul_i32 s48, s58, 1280
    s_sub_u32 s49, 1280, s48
    v_mul_u32_u24 v10, 2304, v2
    v_add_u32 v10, 90112, v10
    v_lshl_add_u32 v12, v1, 4, v10
    v_add_u32 v18, s48, v12
    v_add_u32 v22, s49, v12
    s_lshl_b32 s48, s58, 3
    v_xor_b32 v11, s48, v1
    v_lshl_add_u32 v19, v11, 4, v10
    v_add_u32 v19, 1024, v19
    v_lshlrev_b32 v9, 4, v0
    v_lshlrev_b32 v8, 16, v8
    v_cmp_gt_u32 vcc, 32, v0
    s_nop 1
    v_cndmask_b32 v10, 0, v8, vcc
    v_mov_b32 v188, v8
    v_mov_b32 v189, v8
    v_mov_b32 v190, v8
    v_mov_b32 v191, v8
    v_mov_b64 v[192:193], 0
    v_mov_b64 v[194:195], 0
    v_mov_b32 v196, v8
    v_mov_b32 v197, v8
    v_mov_b32 v198, v8
    v_mov_b32 v199, v8
    v_mov_b64 v[200:201], 0
    v_mov_b64 v[202:203], 0
    v_mov_b32 v204, v8
    v_mov_b32 v205, v8
    v_mov_b32 v206, v8
    v_mov_b32 v207, v8
    v_mov_b64 v[208:209], 0
    v_mov_b64 v[210:211], 0
    v_mov_b32 v212, v8
    v_mov_b32 v213, v8
    v_mov_b32 v214, v8
    v_mov_b32 v215, v8
    v_mov_b64 v[216:217], 0
    v_mov_b64 v[218:219], 0
    v_mov_b32 v220, v10
    v_mov_b32 v221, v10
    v_mov_b32 v222, v10
    v_mov_b32 v223, v10
    v_mov_b64 v[224:225], 0
    v_mov_b64 v[226:227], 0
    v_mov_b64 v[228:229], 0
    v_mov_b64 v[230:231], 0
    v_mov_b64 v[232:233], 0
    v_mov_b64 v[234:235], 0
    v_mov_b64 v[236:237], 0
    v_mov_b64 v[238:239], 0
    v_mov_b64 v[240:241], 0
    v_mov_b64 v[242:243], 0
    v_mov_b64 v[244:245], 0
    v_mov_b64 v[246:247], 0
    v_mov_b64 v[248:249], 0
    v_mov_b64 v[250:251], 0
    v_mov_b64 v[252:253], 0
    v_mov_b64 v[254:255], 0
    v_mov_b64 v[64:65], 0
    v_mov_b64 v[66:67], 0
    s_mov_b32 s44, s28
    s_mov_b32 s45, s29
    s_mov_b32 s46, 2359296
    s_mov_b32 s47, 0x20000
    s_mul_i32 s48, s3, 2304
    s_add_u32 s48, s48, 32768
    v_mul_u32_u24 v10, 144, v1
    v_lshl_add_u32 v10, v2, 3, v10
    v_add_u32 v10, s48, v10
    v_add_u32 v7, s48, v9
    s_lshl_b32 s49, s58, 4
    v_add_u32 v4, s49, v10
    s_lshl_b32 s49, s58, 7
    s_sub_u32 s49, 128, s49
    v_add_u32 v10, s49, v10
    v_cmp_gt_u32 vcc, 32, v0
    v_mov_b32 v11, 82432
    s_nop 0
    v_cndmask_b32 v5, v11, v10, vcc
    v_lshlrev_b32 v10, 4, v2
    v_add_u32 v10, 81920, v10
    s_lshl_b32 s49, s58, 5
    v_add_u32 v6, s49, v10
    s_lshl_b32 s49, s58, 8
    s_sub_u32 s49, 256, s49
    v_add_u32 v23, s49, v10
    s_lshl_b32 s48, s59, 4
    s_lshl_b32 s49, s54, 7
    s_add_u32 s48, s48, s49
    s_mul_i32 s48, s48, 1152
    s_mul_i32 s49, s55, 288
    s_add_u32 s62, s48, s49
    s_mul_i32 s49, s58, 144
    s_add_u32 s62, s62, s49
    v_add_u32 v10, 0, v0
    v_mul_u32_u24 v11, 911, v10
    v_lshrrev_b32 v11, 13, v11
    v_mul_u32_u24 v11, 1008, v11
    v_lshl_add_u32 v68, v10, 4, v11
    v_add_u32 v10, 64, v0
    v_mul_u32_u24 v11, 911, v10
    v_lshrrev_b32 v11, 13, v11
    v_mul_u32_u24 v11, 1008, v11
    v_lshl_add_u32 v69, v10, 4, v11
    v_add_u32 v10, 128, v0
    v_mul_u32_u24 v11, 911, v10
    v_lshrrev_b32 v11, 13, v11
    v_mul_u32_u24 v11, 1008, v11
    v_lshl_add_u32 v70, v10, 4, v11
    v_cmp_gt_u32 vcc, 16, v0
    v_mov_b32 v11, 2146435072
    s_nop 0
    v_cndmask_b32 v70, v11, v70, vcc
    s_mul_i32 s48, s3, 2304
    s_add_u32 s48, s48, 27262976
    s_mul_i32 s64, s2, 27648
    s_add_u32 s64, s64, s48
    v_and_b32 v10, 3, v0
    v_cmp_eq_u32 vcc, 0, v10
    v_lshlrev_b32 v27, 2, v0
    s_nop 0
    v_cndmask_b32 v26, v11, v27, vcc
    s_mul_i32 s49, s3, 4608
    s_add_u32 s49, s49, 49152
    v_add_u32 v71, s49, v9
    v_add_u32 v72, 73728, v18
    v_add_u32 v75, 73728, v19
    v_add_u32 v74, 73728, v22
    s_xor_b32 s65, s2, 2
    s_mul_i32 s65, s65, 27648
    s_add_u32 s65, s65, s48
    s_add_u32 s65, s65, 0
    s_xor_b32 s66, s2, 4
    s_mul_i32 s66, s66, 27648
    s_add_u32 s66, s66, s48
    s_add_u32 s66, s66, 9216
    s_xor_b32 s67, s2, 6
    s_mul_i32 s67, s67, 27648
    s_add_u32 s67, s67, s48
    s_add_u32 s67, s67, 18432
    s_branch L_stub_8
L_back_c3:
    v_add_u32 v24, 49152, v20
    v_add_u32 v25, 49152, v21
    s_barrier
    ds_read_b64_tr_b16 v[80:81], v21 offset:0
    ds_read_b64_tr_b16 v[82:83], v21 offset:4096
    ds_read_b64_tr_b16 v[76:77], v20 offset:0
    ds_read_b64_tr_b16 v[78:79], v20 offset:4096
    ds_read_b128 v[28:31], v18 offset:0
    ds_read_b128 v[32:35], v18 offset:256
    ds_read_b128 v[36:39], v18 offset:512
    ds_read_b128 v[40:43], v18 offset:768
    ds_read_b128 v[44:47], v19 offset:0
    ds_read_b128 v[48:51], v22 offset:0
    ds_read_b128 v[52:55], v22 offset:256
    ds_read_b128 v[56:59], v22 offset:512
    ds_read_b128 v[60:63], v22 offset:768
    s_waitcnt lgkmcnt(6)
    v_mfma_f32_16x16x32_bf16 v[192:195], v[28:31], v[80:83], v[192:195]
    ds_read_b64_tr_b16 v[88:89], v21 offset:8192
    v_mfma_f32_16x16x32_bf16 v[188:191], v[28:31], v[76:79], v[188:191]
    ds_read_b128 v[28:31], v18 offset:9216
    v_mfma_f32_16x16x32_bf16 v[200:203], v[32:35], v[80:83], v[200:203]
    ds_read_b64_tr_b16 v[90:91], v21 offset:12288
    v_mfma_f32_16x16x32_bf16 v[196:199], v[32:35], v[76:79], v[196:199]
    ds_read_b128 v[32:35], v18 offset:9472
    v_mfma_f32_16x16x32_bf16 v[208:211], v[36:39], v[80:83], v[208:211]
    ds_read_b64_tr_b16 v[84:85], v20 offset:8192
    v_mfma_f32_16x16x32_bf16 v[204:207], v[36:39], v[76:79], v[204:207]
    ds_read_b128 v[36:39], v18 offset:9728
    s_waitcnt lgkmcnt(9)
    v_mfma_f32_16x16x32_bf16 v[216:219], v[40:43], v[80:83], v[216:219]
    ds_read_b64_tr_b16 v[86:87], v20 offset:12288
    v_mfma_f32_16x16x32_bf16 v[212:215], v[40:43], v[76:79], v[212:215]
    ds_read_b128 v[40:43], v18 offset:9984
    v_mfma_f32_16x16x32_bf16 v[224:227], v[44:47], v[80:83], v[224:227]
    v_mfma_f32_16x16x32_bf16 v[220:223], v[44:47], v[76:79], v[220:223]
    ds_read_b128 v[44:47], v19 offset:9216
    v_mfma_f32_16x16x32_bf16 v[232:235], v[48:51], v[80:83], v[232:235]
    v_mfma_f32_16x16x32_bf16 v[228:231], v[48:51], v[76:79], v[228:231]
    ds_read_b128 v[48:51], v22 offset:9216
    s_waitcnt lgkmcnt(10)
    v_mfma_f32_16x16x32_bf16 v[240:243], v[52:55], v[80:83], v[240:243]
    v_mfma_f32_16x16x32_bf16 v[236:239], v[52:55], v[76:79], v[236:239]
    ds_read_b128 v[52:55], v22 offset:9472
    v_mfma_f32_16x16x32_bf16 v[248:251], v[56:59], v[80:83], v[248:251]
    v_mfma_f32_16x16x32_bf16 v[244:247], v[56:59], v[76:79], v[244:247]
    ds_read_b128 v[56:59], v22 offset:9728
    v_mfma_f32_16x16x32_bf16 v[64:67], v[60:63], v[80:83], v[64:67]
    v_mfma_f32_16x16x32_bf16 v[252:255], v[60:63], v[76:79], v[252:255]
    ds_read_b128 v[60:63], v22 offset:9984
    s_waitcnt lgkmcnt(6)
    v_mfma_f32_16x16x32_bf16 v[192:195], v[28:31], v[88:91], v[192:195]
    s_barrier
    ds_read_b64_tr_b16 v[80:81], v21 offset:16384
    v_mfma_f32_16x16x32_bf16 v[188:191], v[28:31], v[84:87], v[188:191]
    ds_read_b128 v[28:31], v18 offset:18432
    v_mfma_f32_16x16x32_bf16 v[200:203], v[32:35], v[88:91], v[200:203]
    ds_read_b64_tr_b16 v[82:83], v21 offset:20480
    v_mfma_f32_16x16x32_bf16 v[196:199], v[32:35], v[84:87], v[196:199]
    ds_read_b128 v[32:35], v18 offset:18688
    v_mfma_f32_16x16x32_bf16 v[208:211], v[36:39], v[88:91], v[208:211]
    ds_read_b64_tr_b16 v[76:77], v20 offset:16384
    v_mfma_f32_16x16x32_bf16 v[204:207], v[36:39], v[84:87], v[204:207]
    ds_read_b128 v[36:39], v18 offset:18944
    s_waitcnt lgkmcnt(9)
    v_mfma_f32_16x16x32_bf16 v[216:219], v[40:43], v[88:91], v[216:219]
    ds_read_b64_tr_b16 v[78:79], v20 offset:20480
    v_mfma_f32_16x16x32_bf16 v[212:215], v[40:43], v[84:87], v[212:215]
    ds_read_b128 v[40:43], v18 offset:19200
    v_mfma_f32_16x16x32_bf16 v[224:227], v[44:47], v[88:91], v[224:227]
    v_mfma_f32_16x16x32_bf16 v[220:223], v[44:47], v[84:87], v[220:223]
    ds_read_b128 v[44:47], v19 offset:18432
    v_mfma_f32_16x16x32_bf16 v[232:235], v[48:51], v[88:91], v[232:235]
    v_mfma_f32_16x16x32_bf16 v[228:231], v[48:51], v[84:87], v[228:231]
    ds_read_b128 v[48:51], v22 offset:18432
    s_waitcnt lgkmcnt(10)
    v_mfma_f32_16x16x32_bf16 v[240:243], v[52:55], v[88:91], v[240:243]
    v_mfma_f32_16x16x32_bf16 v[236:239], v[52:55], v[84:87], v[236:239]
    ds_read_b128 v[52:55], v22 offset:18688
    v_mfma_f32_16x16x32_bf16 v[248:251], v[56:59], v[88:91], v[248:251]
    v_mfma_f32_16x16x32_bf16 v[244:247], v[56:59], v[84:87], v[244:247]
    ds_read_b128 v[56:59], v22 offset:18944
    v_mfma_f32_16x16x32_bf16 v[64:67], v[60:63], v[88:91], v[64:67]
    v_mfma_f32_16x16x32_bf16 v[252:255], v[60:63], v[84:87], v[252:255]
    ds_read_b128 v[60:63], v22 offset:19200
    s_waitcnt lgkmcnt(6)
    v_mfma_f32_16x16x32_bf16 v[192:195], v[28:31], v[80:83], v[192:195]
    ds_read_b64_tr_b16 v[88:89], v21 offset:24576
    v_mfma_f32_16x16x32_bf16 v[188:191], v[28:31], v[76:79], v[188:191]
    ds_read_b128 v[28:31], v18 offset:27648
    v_mfma_f32_16x16x32_bf16 v[200:203], v[32:35], v[80:83], v[200:203]
    ds_read_b64_tr_b16 v[90:91], v21 offset:28672
    v_mfma_f32_16x16x32_bf16 v[196:199], v[32:35], v[76:79], v[196:199]
    ds_read_b128 v[32:35], v18 offset:27904
    v_mfma_f32_16x16x32_bf16 v[208:211], v[36:39], v[80:83], v[208:211]
    ds_read_b64_tr_b16 v[84:85], v20 offset:24576
    v_mfma_f32_16x16x32_bf16 v[204:207], v[36:39], v[76:79], v[204:207]
    ds_read_b128 v[36:39], v18 offset:28160
    s_waitcnt lgkmcnt(9)
    v_mfma_f32_16x16x32_bf16 v[216:219], v[40:43], v[80:83], v[216:219]
    ds_read_b64_tr_b16 v[86:87], v20 offset:28672
    v_mfma_f32_16x16x32_bf16 v[212:215], v[40:43], v[76:79], v[212:215]
    ds_read_b128 v[40:43], v18 offset:28416
    v_mfma_f32_16x16x32_bf16 v[224:227], v[44:47], v[80:83], v[224:227]
    v_mfma_f32_16x16x32_bf16 v[220:223], v[44:47], v[76:79], v[220:223]
    ds_read_b128 v[44:47], v19 offset:27648
    v_mfma_f32_16x16x32_bf16 v[232:235], v[48:51], v[80:83], v[232:235]
    v_mfma_f32_16x16x32_bf16 v[228:231], v[48:51], v[76:79], v[228:231]
    ds_read_b128 v[48:51], v22 offset:27648
    s_waitcnt lgkmcnt(10)
    v_mfma_f32_16x16x32_bf16 v[240:243], v[52:55], v[80:83], v[240:243]
    v_mfma_f32_16x16x32_bf16 v[236:239], v[52:55], v[76:79], v[236:239]
    ds_read_b128 v[52:55], v22 offset:27904
    v_mfma_f32_16x16x32_bf16 v[248:251], v[56:59], v[80:83], v[248:251]
    v_mfma_f32_16x16x32_bf16 v[244:247], v[56:59], v[76:79], v[244:247]
    ds_read_b128 v[56:59], v22 offset:28160
    v_mfma_f32_16x16x32_bf16 v[64:67], v[60:63], v[80:83], v[64:67]
    v_mfma_f32_16x16x32_bf16 v[252:255], v[60:63], v[76:79], v[252:255]
    ds_read_b128 v[60:63], v22 offset:28416
    s_waitcnt lgkmcnt(6)
    v_mfma_f32_16x16x32_bf16 v[192:195], v[28:31], v[88:91], v[192:195]
    s_barrier
    ds_read_b64_tr_b16 v[80:81], v21 offset:32768
    v_mfma_f32_16x16x32_bf16 v[188:191], v[28:31], v[84:87], v[188:191]
    ds_read_b128 v[28:31], v18 offset:36864
    v_mfma_f32_16x16x32_bf16 v[200:203], v[32:35], v[88:91], v[200:203]
    ds_read_b64_tr_b16 v[82:83], v21 offset:36864
    v_mfma_f32_16x16x32_bf16 v[196:199], v[32:35], v[84:87], v[196:199]
    ds_read_b128 v[32:35], v18 offset:37120
    v_mfma_f32_16x16x32_bf16 v[208:211], v[36:39], v[88:91], v[208:211]
    ds_read_b64_tr_b16 v[76:77], v20 offset:32768
    v_mfma_f32_16x16x32_bf16 v[204:207], v[36:39], v[84:87], v[204:207]
    ds_read_b128 v[36:39], v18 offset:37376
    s_waitcnt lgkmcnt(9)
    v_mfma_f32_16x16x32_bf16 v[216:219], v[40:43], v[88:91], v[216:219]
    ds_read_b64_tr_b16 v[78:79], v20 offset:36864
    v_mfma_f32_16x16x32_bf16 v[212:215], v[40:43], v[84:87], v[212:215]
    ds_read_b128 v[40:43], v18 offset:37632
    v_mfma_f32_16x16x32_bf16 v[224:227], v[44:47], v[88:91], v[224:227]
    v_mfma_f32_16x16x32_bf16 v[220:223], v[44:47], v[84:87], v[220:223]
    ds_read_b128 v[44:47], v19 offset:36864
    v_mfma_f32_16x16x32_bf16 v[232:235], v[48:51], v[88:91], v[232:235]
    v_mfma_f32_16x16x32_bf16 v[228:231], v[48:51], v[84:87], v[228:231]
    ds_read_b128 v[48:51], v22 offset:36864
    s_waitcnt lgkmcnt(10)
    v_mfma_f32_16x16x32_bf16 v[240:243], v[52:55], v[88:91], v[240:243]
    v_mfma_f32_16x16x32_bf16 v[236:239], v[52:55], v[84:87], v[236:239]
    ds_read_b128 v[52:55], v22 offset:37120
    v_mfma_f32_16x16x32_bf16 v[248:251], v[56:59], v[88:91], v[248:251]
    v_mfma_f32_16x16x32_bf16 v[244:247], v[56:59], v[84:87], v[244:247]
    ds_read_b128 v[56:59], v22 offset:37376
    v_mfma_f32_16x16x32_bf16 v[64:67], v[60:63], v[88:91], v[64:67]
    v_mfma_f32_16x16x32_bf16 v[252:255], v[60:63], v[84:87], v[252:255]
    ds_read_b128 v[60:63], v22 offset:37632
    s_waitcnt lgkmcnt(6)
    v_mfma_f32_16x16x32_bf16 v[192:195], v[28:31], v[80:83], v[192:195]
    ds_read_b64_tr_b16 v[88:89], v21 offset:40960
    v_mfma_f32_16x16x32_bf16 v[188:191], v[28:31], v[76:79], v[188:191]
    ds_read_b128 v[28:31], v18 offset:46080
    v_mfma_f32_16x16x32_bf16 v[200:203], v[32:35], v[80:83], v[200:203]
    ds_read_b64_tr_b16 v[90:91], v21 offset:45056
    v_mfma_f32_16x16x32_bf16 v[196:199], v[32:35], v[76:79], v[196:199]
    ds_read_b128 v[32:35], v18 offset:46336
    v_mfma_f32_16x16x32_bf16 v[208:211], v[36:39], v[80:83], v[208:211]
    ds_read_b64_tr_b16 v[84:85], v20 offset:40960
    v_mfma_f32_16x16x32_bf16 v[204:207], v[36:39], v[76:79], v[204:207]
    ds_read_b128 v[36:39], v18 offset:46592
    s_waitcnt lgkmcnt(9)
    v_mfma_f32_16x16x32_bf16 v[216:219], v[40:43], v[80:83], v[216:219]
    ds_read_b64_tr_b16 v[86:87], v20 offset:45056
    v_mfma_f32_16x16x32_bf16 v[212:215], v[40:43], v[76:79], v[212:215]
    ds_read_b128 v[40:43], v18 offset:46848
    v_mfma_f32_16x16x32_bf16 v[224:227], v[44:47], v[80:83], v[224:227]
    v_mfma_f32_16x16x32_bf16 v[220:223], v[44:47], v[76:79], v[220:223]
    ds_read_b128 v[44:47], v19 offset:46080
    v_mfma_f32_16x16x32_bf16 v[232:235], v[48:51], v[80:83], v[232:235]
    v_mfma_f32_16x16x32_bf16 v[228:231], v[48:51], v[76:79], v[228:231]
    ds_read_b128 v[48:51], v22 offset:46080
    s_waitcnt lgkmcnt(10)
    v_mfma_f32_16x16x32_bf16 v[240:243], v[52:55], v[80:83], v[240:243]
    v_mfma_f32_16x16x32_bf16 v[236:239], v[52:55], v[76:79], v[236:239]
    ds_read_b128 v[52:55], v22 offset:46336
    v_mfma_f32_16x16x32_bf16 v[248:251], v[56:59], v[80:83], v[248:251]
    v_mfma_f32_16x16x32_bf16 v[244:247], v[56:59], v[76:79], v[244:247]
    ds_read_b128 v[56:59], v22 offset:46592
    v_mfma_f32_16x16x32_bf16 v[64:67], v[60:63], v[80:83], v[64:67]
    v_mfma_f32_16x16x32_bf16 v[252:255], v[60:63], v[76:79], v[252:255]
    ds_read_b128 v[60:63], v22 offset:46848
    s_waitcnt lgkmcnt(6)
    v_mfma_f32_16x16x32_bf16 v[192:195], v[28:31], v[88:91], v[192:195]
    s_barrier
    ds_read_b64_tr_b16 v[80:81], v25 offset:0
    v_mfma_f32_16x16x32_bf16 v[188:191], v[28:31], v[84:87], v[188:191]
    ds_read_b128 v[28:31], v18 offset:55296
    v_mfma_f32_16x16x32_bf16 v[200:203], v[32:35], v[88:91], v[200:203]
    ds_read_b64_tr_b16 v[82:83], v25 offset:4096
    v_mfma_f32_16x16x32_bf16 v[196:199], v[32:35], v[84:87], v[196:199]
    ds_read_b128 v[32:35], v18 offset:55552
    v_mfma_f32_16x16x32_bf16 v[208:211], v[36:39], v[88:91], v[208:211]
    ds_read_b64_tr_b16 v[76:77], v24 offset:0
    v_mfma_f32_16x16x32_bf16 v[204:207], v[36:39], v[84:87], v[204:207]
    ds_read_b128 v[36:39], v18 offset:55808
    s_waitcnt lgkmcnt(9)
    v_mfma_f32_16x16x32_bf16 v[216:219], v[40:43], v[88:91], v[216:219]
    ds_read_b64_tr_b16 v[78:79], v24 offset:4096
    v_mfma_f32_16x16x32_bf16 v[212:215], v[40:43], v[84:87], v[212:215]
    ds_read_b128 v[40:43], v18 offset:56064
    v_mfma_f32_16x16x32_bf16 v[224:227], v[44:47], v[88:91], v[224:227]
    v_mfma_f32_16x16x32_bf16 v[220:223], v[44:47], v[84:87], v[220:223]
    ds_read_b128 v[44:47], v19 offset:55296
    v_mfma_f32_16x16x32_bf16 v[232:235], v[48:51], v[88:91], v[232:235]
    v_mfma_f32_16x16x32_bf16 v[228:231], v[48:51], v[84:87], v[228:231]
    ds_read_b128 v[48:51], v22 offset:55296
    s_waitcnt lgkmcnt(10)
    v_mfma_f32_16x16x32_bf16 v[240:243], v[52:55], v[88:91], v[240:243]
    v_mfma_f32_16x16x32_bf16 v[236:239], v[52:55], v[84:87], v[236:239]
    ds_read_b128 v[52:55], v22 offset:55552
    v_mfma_f32_16x16x32_bf16 v[248:251], v[56:59], v[88:91], v[248:251]
    v_mfma_f32_16x16x32_bf16 v[244:247], v[56:59], v[84:87], v[244:247]
    ds_read_b128 v[56:59], v22 offset:55808
    v_mfma_f32_16x16x32_bf16 v[64:67], v[60:63], v[88:91], v[64:67]
    v_mfma_f32_16x16x32_bf16 v[252:255], v[60:63], v[84:87], v[252:255]
    ds_read_b128 v[60:63], v22 offset:56064
    s_waitcnt lgkmcnt(6)
    v_mfma_f32_16x16x32_bf16 v[192:195], v[28:31], v[80:83], v[192:195]
    ds_read_b64_tr_b16 v[88:89], v25 offset:8192
    v_mfma_f32_16x16x32_bf16 v[188:191], v[28:31], v[76:79], v[188:191]
    ds_read_b128 v[28:31], v18 offset:64512
    v_mfma_f32_16x16x32_bf16 v[200:203], v[32:35], v[80:83], v[200:203]
    ds_read_b64_tr_b16 v[90:91], v25 offset:12288
    v_mfma_f32_16x16x32_bf16 v[196:199], v[32:35], v[76:79], v[196:199]
    ds_read_b128 v[32:35], v18 offset:64768
    v_mfma_f32_16x16x32_bf16 v[208:211], v[36:39], v[80:83], v[208:211]
    ds_read_b64_tr_b16 v[84:85], v24 offset:8192
    v_mfma_f32_16x16x32_bf16 v[204:207], v[36:39], v[76:79], v[204:207]
    ds_read_b128 v[36:39], v18 offset:65024
    s_waitcnt lgkmcnt(9)
    v_mfma_f32_16x16x32_bf16 v[216:219], v[40:43], v[80:83], v[216:219]
    ds_read_b64_tr_b16 v[86:87], v24 offset:12288
    v_mfma_f32_16x16x32_bf16 v[212:215], v[40:43], v[76:79], v[212:215]
    ds_read_b128 v[40:43], v18 offset:65280
    v_mfma_f32_16x16x32_bf16 v[224:227], v[44:47], v[80:83], v[224:227]
    v_mfma_f32_16x16x32_bf16 v[220:223], v[44:47], v[76:79], v[220:223]
    ds_read_b128 v[44:47], v19 offset:64512
    v_mfma_f32_16x16x32_bf16 v[232:235], v[48:51], v[80:83], v[232:235]
    v_mfma_f32_16x16x32_bf16 v[228:231], v[48:51], v[76:79], v[228:231]
    ds_read_b128 v[48:51], v22 offset:64512
    s_waitcnt lgkmcnt(10)
    v_mfma_f32_16x16x32_bf16 v[240:243], v[52:55], v[80:83], v[240:243]
    v_mfma_f32_16x16x32_bf16 v[236:239], v[52:55], v[76:79], v[236:239]
    ds_read_b128 v[52:55], v22 offset:64768
    v_mfma_f32_16x16x32_bf16 v[248:251], v[56:59], v[80:83], v[248:251]
    v_mfma_f32_16x16x32_bf16 v[244:247], v[56:59], v[76:79], v[244:247]
    ds_read_b128 v[56:59], v22 offset:65024
    v_mfma_f32_16x16x32_bf16 v[64:67], v[60:63], v[80:83], v[64:67]
    v_mfma_f32_16x16x32_bf16 v[252:255], v[60:63], v[76:79], v[252:255]
    ds_read_b128 v[60:63], v22 offset:65280
    s_waitcnt lgkmcnt(6)
    v_mfma_f32_16x16x32_bf16 v[192:195], v[28:31], v[88:91], v[192:195]
    s_barrier
    v_mfma_f32_16x16x32_bf16 v[188:191], v[28:31], v[84:87], v[188:191]
    ds_read_b128 v[28:31], v18 offset:0
    v_mfma_f32_16x16x32_bf16 v[200:203], v[32:35], v[88:91], v[200:203]
    v_mfma_f32_16x16x32_bf16 v[196:199], v[32:35], v[84:87], v[196:199]
    ds_read_b128 v[32:35], v18 offset:256
    v_mfma_f32_16x16x32_bf16 v[208:211], v[36:39], v[88:91], v[208:211]
    v_mfma_f32_16x16x32_bf16 v[204:207], v[36:39], v[84:87], v[204:207]
    ds_read_b128 v[36:39], v18 offset:512
    s_waitcnt lgkmcnt(6)
    v_mfma_f32_16x16x32_bf16 v[216:219], v[40:43], v[88:91], v[216:219]
    v_mfma_f32_16x16x32_bf16 v[212:215], v[40:43], v[84:87], v[212:215]
    ds_read_b128 v[40:43], v18 offset:768
    v_mfma_f32_16x16x32_bf16 v[224:227], v[44:47], v[88:91], v[224:227]
    v_mfma_f32_16x16x32_bf16 v[220:223], v[44:47], v[84:87], v[220:223]
    ds_read_b128 v[44:47], v19 offset:0
    v_mfma_f32_16x16x32_bf16 v[232:235], v[48:51], v[88:91], v[232:235]
    v_mfma_f32_16x16x32_bf16 v[228:231], v[48:51], v[84:87], v[228:231]
    s_branch L_skip_8
    s_nop 0
L_stub_8:
    s_branch L_stub_9
L_skip_8:
    ds_read_b128 v[48:51], v22 offset:0
    s_waitcnt lgkmcnt(6)
    v_mfma_f32_16x16x32_bf16 v[240:243], v[52:55], v[88:91], v[240:243]
    v_mfma_f32_16x16x32_bf16 v[236:239], v[52:55], v[84:87], v[236:239]
    ds_read_b128 v[52:55], v22 offset:256
    v_mfma_f32_16x16x32_bf16 v[248:251], v[56:59], v[88:91], v[248:251]
    v_mfma_f32_16x16x32_bf16 v[244:247], v[56:59], v[84:87], v[244:247]
    ds_read_b128 v[56:59], v22 offset:512
    v_mfma_f32_16x16x32_bf16 v[64:67], v[60:63], v[88:91], v[64:67]
    v_mfma_f32_16x16x32_bf16 v[252:255], v[60:63], v[84:87], v[252:255]
    ds_read_b128 v[60:63], v22 offset:768
    s_waitcnt lgkmcnt(6)
    v_mfma_f32_16x16x32_bf16 v[192:195], v[28:31], v[96:99], v[192:195]
    v_mfma_f32_16x16x32_bf16 v[188:191], v[28:31], v[92:95], v[188:191]
    ds_read_b128 v[28:31], v18 offset:9216
    v_mfma_f32_16x16x32_bf16 v[200:203], v[32:35], v[96:99], v[200:203]
    v_mfma_f32_16x16x32_bf16 v[196:199], v[32:35], v[92:95], v[196:199]
    ds_read_b128 v[32:35], v18 offset:9472
    v_mfma_f32_16x16x32_bf16 v[208:211], v[36:39], v[96:99], v[208:211]
    v_mfma_f32_16x16x32_bf16 v[204:207], v[36:39], v[92:95], v[204:207]
    ds_read_b128 v[36:39], v18 offset:9728
    s_waitcnt lgkmcnt(6)
    v_mfma_f32_16x16x32_bf16 v[216:219], v[40:43], v[96:99], v[216:219]
    v_mfma_f32_16x16x32_bf16 v[212:215], v[40:43], v[92:95], v[212:215]
    ds_read_b128 v[40:43], v18 offset:9984
    v_mfma_f32_16x16x32_bf16 v[224:227], v[44:47], v[96:99], v[224:227]
    v_mfma_f32_16x16x32_bf16 v[220:223], v[44:47], v[92:95], v[220:223]
    ds_read_b128 v[44:47], v19 offset:9216
    v_mfma_f32_16x16x32_bf16 v[232:235], v[48:51], v[96:99], v[232:235]
    v_mfma_f32_16x16x32_bf16 v[228:231], v[48:51], v[92:95], v[228:231]
    ds_read_b128 v[48:51], v22 offset:9216
    s_waitcnt lgkmcnt(6)
    v_mfma_f32_16x16x32_bf16 v[240:243], v[52:55], v[96:99], v[240:243]
    v_mfma_f32_16x16x32_bf16 v[236:239], v[52:55], v[92:95], v[236:239]
    ds_read_b128 v[52:55], v22 offset:9472
    v_mfma_f32_16x16x32_bf16 v[248:251], v[56:59], v[96:99], v[248:251]
    v_mfma_f32_16x16x32_bf16 v[244:247], v[56:59], v[92:95], v[244:247]
    ds_read_b128 v[56:59], v22 offset:9728
    v_mfma_f32_16x16x32_bf16 v[64:67], v[60:63], v[96:99], v[64:67]
    v_mfma_f32_16x16x32_bf16 v[252:255], v[60:63], v[92:95], v[252:255]
    ds_read_b128 v[60:63], v22 offset:9984
    s_waitcnt lgkmcnt(6)
    v_mfma_f32_16x16x32_bf16 v[192:195], v[28:31], v[104:107], v[192:195]
    s_barrier
    ds_read_b64_tr_b16 v[80:81], v25 offset:16384
    v_mfma_f32_16x16x32_bf16 v[188:191], v[28:31], v[100:103], v[188:191]
    ds_read_b128 v[28:31], v18 offset:18432
    v_mfma_f32_16x16x32_bf16 v[200:203], v[32:35], v[104:107], v[200:203]
    ds_read_b64_tr_b16 v[82:83], v25 offset:20480
    v_mfma_f32_16x16x32_bf16 v[196:199], v[32:35], v[100:103], v[196:199]
    ds_read_b128 v[32:35], v18 offset:18688
    v_mfma_f32_16x16x32_bf16 v[208:211], v[36:39], v[104:107], v[208:211]
    ds_read_b64_tr_b16 v[76:77], v24 offset:16384
    v_mfma_f32_16x16x32_bf16 v[204:207], v[36:39], v[100:103], v[204:207]
    ds_read_b128 v[36:39], v18 offset:18944
    s_waitcnt lgkmcnt(9)
    v_mfma_f32_16x16x32_bf16 v[216:219], v[40:43], v[104:107], v[216:219]
    ds_read_b64_tr_b16 v[78:79], v24 offset:20480
    v_mfma_f32_16x16x32_bf16 v[212:215], v[40:43], v[100:103], v[212:215]
    ds_read_b128 v[40:43], v18 offset:19200
    v_mfma_f32_16x16x32_bf16 v[224:227], v[44:47], v[104:107], v[224:227]
    v_mfma_f32_16x16x32_bf16 v[220:223], v[44:47], v[100:103], v[220:223]
    ds_read_b128 v[44:47], v19 offset:18432
    v_mfma_f32_16x16x32_bf16 v[232:235], v[48:51], v[104:107], v[232:235]
    v_mfma_f32_16x16x32_bf16 v[228:231], v[48:51], v[100:103], v[228:231]
    ds_read_b128 v[48:51], v22 offset:18432
    s_waitcnt lgkmcnt(10)
    v_mfma_f32_16x16x32_bf16 v[240:243], v[52:55], v[104:107], v[240:243]
    v_mfma_f32_16x16x32_bf16 v[236:239], v[52:55], v[100:103], v[236:239]
    ds_read_b128 v[52:55], v22 offset:18688
    v_mfma_f32_16x16x32_bf16 v[248:251], v[56:59], v[104:107], v[248:251]
    v_mfma_f32_16x16x32_bf16 v[244:247], v[56:59], v[100:103], v[244:247]
    ds_read_b128 v[56:59], v22 offset:18944
    v_mfma_f32_16x16x32_bf16 v[64:67], v[60:63], v[104:107], v[64:67]
    v_mfma_f32_16x16x32_bf16 v[252:255], v[60:63], v[100:103], v[252:255]
    ds_read_b128 v[60:63], v22 offset:19200
    s_waitcnt lgkmcnt(6)
    v_mfma_f32_16x16x32_bf16 v[192:195], v[28:31], v[80:83], v[192:195]
    ds_read_b64_tr_b16 v[88:89], v25 offset:24576
    v_mfma_f32_16x16x32_bf16 v[188:191], v[28:31], v[76:79], v[188:191]
    ds_read_b128 v[28:31], v18 offset:27648
    v_mfma_f32_16x16x32_bf16 v[200:203], v[32:35], v[80:83], v[200:203]
    ds_read_b64_tr_b16 v[90:91], v25 offset:28672
    v_mfma_f32_16x16x32_bf16 v[196:199], v[32:35], v[76:79], v[196:199]
    ds_read_b128 v[32:35], v18 offset:27904
    v_mfma_f32_16x16x32_bf16 v[208:211], v[36:39], v[80:83], v[208:211]
    ds_read_b64_tr_b16 v[84:85], v24 offset:24576
    v_mfma_f32_16x16x32_bf16 v[204:207], v[36:39], v[76:79], v[204:207]
    ds_read_b128 v[36:39], v18 offset:28160
    s_waitcnt lgkmcnt(9)
    v_mfma_f32_16x16x32_bf16 v[216:219], v[40:43], v[80:83], v[216:219]
    ds_read_b64_tr_b16 v[86:87], v24 offset:28672
    v_mfma_f32_16x16x32_bf16 v[212:215], v[40:43], v[76:79], v[212:215]
    ds_read_b128 v[40:43], v18 offset:28416
    v_mfma_f32_16x16x32_bf16 v[224:227], v[44:47], v[80:83], v[224:227]
    v_mfma_f32_16x16x32_bf16 v[220:223], v[44:47], v[76:79], v[220:223]
    ds_read_b128 v[44:47], v19 offset:27648
    v_mfma_f32_16x16x32_bf16 v[232:235], v[48:51], v[80:83], v[232:235]
    v_mfma_f32_16x16x32_bf16 v[228:231], v[48:51], v[76:79], v[228:231]
    ds_read_b128 v[48:51], v22 offset:27648
    s_waitcnt lgkmcnt(10)
    v_mfma_f32_16x16x32_bf16 v[240:243], v[52:55], v[80:83], v[240:243]
    v_mfma_f32_16x16x32_bf16 v[236:239], v[52:55], v[76:79], v[236:239]
    ds_read_b128 v[52:55], v22 offset:27904
    v_mfma_f32_16x16x32_bf16 v[248:251], v[56:59], v[80:83], v[248:251]
    v_mfma_f32_16x16x32_bf16 v[244:247], v[56:59], v[76:79], v[244:247]
    ds_read_b128 v[56:59], v22 offset:28160
    v_mfma_f32_16x16x32_bf16 v[64:67], v[60:63], v[80:83], v[64:67]
    v_mfma_f32_16x16x32_bf16 v[252:255], v[60:63], v[76:79], v[252:255]
    ds_read_b128 v[60:63], v22 offset:28416
    s_waitcnt lgkmcnt(6)
    v_mfma_f32_16x16x32_bf16 v[192:195], v[28:31], v[88:91], v[192:195]
    s_barrier
    v_mfma_f32_16x16x32_bf16 v[188:191], v[28:31], v[84:87], v[188:191]
    ds_read_b128 v[28:31], v18 offset:36864
    v_mfma_f32_16x16x32_bf16 v[200:203], v[32:35], v[88:91], v[200:203]
    v_mfma_f32_16x16x32_bf16 v[196:199], v[32:35], v[84:87], v[196:199]
    ds_read_b128 v[32:35], v18 offset:37120
    v_mfma_f32_16x16x32_bf16 v[208:211], v[36:39], v[88:91], v[208:211]
    v_mfma_f32_16x16x32_bf16 v[204:207], v[36:39], v[84:87], v[204:207]
    ds_read_b128 v[36:39], v18 offset:37376
    s_waitcnt lgkmcnt(6)
    v_mfma_f32_16x16x32_bf16 v[216:219], v[40:43], v[88:91], v[216:219]
    v_mfma_f32_16x16x32_bf16 v[212:215], v[40:43], v[84:87], v[212:215]
    ds_read_b128 v[40:43], v18 offset:37632
    v_mfma_f32_16x16x32_bf16 v[224:227], v[44:47], v[88:91], v[224:227]
    v_mfma_f32_16x16x32_bf16 v[220:223], v[44:47], v[84:87], v[220:223]
    ds_read_b128 v[44:47], v19 offset:36864
    v_mfma_f32_16x16x32_bf16 v[232:235], v[48:51], v[88:91], v[232:235]
    v_mfma_f32_16x16x32_bf16 v[228:231], v[48:51], v[84:87], v[228:231]
    ds_read_b128 v[48:51], v22 offset:36864
    s_waitcnt lgkmcnt(6)
    v_mfma_f32_16x16x32_bf16 v[240:243], v[52:55], v[88:91], v[240:243]
    v_mfma_f32_16x16x32_bf16 v[236:239], v[52:55], v[84:87], v[236:239]
    ds_read_b128 v[52:55], v22 offset:37120
    v_mfma_f32_16x16x32_bf16 v[248:251], v[56:59], v[88:91], v[248:251]
    v_mfma_f32_16x16x32_bf16 v[244:247], v[56:59], v[84:87], v[244:247]
    ds_read_b128 v[56:59], v22 offset:37376
    v_mfma_f32_16x16x32_bf16 v[64:67], v[60:63], v[88:91], v[64:67]
    v_mfma_f32_16x16x32_bf16 v[252:255], v[60:63], v[84:87], v[252:255]
    ds_read_b128 v[60:63], v22 offset:37632
    s_waitcnt lgkmcnt(6)
    v_mfma_f32_16x16x32_bf16 v[192:195], v[28:31], v[112:115], v[192:195]
    v_mfma_f32_16x16x32_bf16 v[188:191], v[28:31], v[108:111], v[188:191]
    ds_read_b128 v[28:31], v18 offset:46080
    v_mfma_f32_16x16x32_bf16 v[200:203], v[32:35], v[112:115], v[200:203]
    v_mfma_f32_16x16x32_bf16 v[196:199], v[32:35], v[108:111], v[196:199]
    ds_read_b128 v[32:35], v18 offset:46336
    v_mfma_f32_16x16x32_bf16 v[208:211], v[36:39], v[112:115], v[208:211]
    v_mfma_f32_16x16x32_bf16 v[204:207], v[36:39], v[108:111], v[204:207]
    ds_read_b128 v[36:39], v18 offset:46592
    s_waitcnt lgkmcnt(6)
    v_mfma_f32_16x16x32_bf16 v[216:219], v[40:43], v[112:115], v[216:219]
    v_mfma_f32_16x16x32_bf16 v[212:215], v[40:43], v[108:111], v[212:215]
    ds_read_b128 v[40:43], v18 offset:46848
    v_mfma_f32_16x16x32_bf16 v[224:227], v[44:47], v[112:115], v[224:227]
    v_mfma_f32_16x16x32_bf16 v[220:223], v[44:47], v[108:111], v[220:223]
    ds_read_b128 v[44:47], v19 offset:46080
    v_mfma_f32_16x16x32_bf16 v[232:235], v[48:51], v[112:115], v[232:235]
    v_mfma_f32_16x16x32_bf16 v[228:231], v[48:51], v[108:111], v[228:231]
    ds_read_b128 v[48:51], v22 offset:46080
    s_waitcnt lgkmcnt(6)
    v_mfma_f32_16x16x32_bf16 v[240:243], v[52:55], v[112:115], v[240:243]
    v_mfma_f32_16x16x32_bf16 v[236:239], v[52:55], v[108:111], v[236:239]
    ds_read_b128 v[52:55], v22 offset:46336
    v_mfma_f32_16x16x32_bf16 v[248:251], v[56:59], v[112:115], v[248:251]
    v_mfma_f32_16x16x32_bf16 v[244:247], v[56:59], v[108:111], v[244:247]
    ds_read_b128 v[56:59], v22 offset:46592
    v_mfma_f32_16x16x32_bf16 v[64:67], v[60:63], v[112:115], v[64:67]
    v_mfma_f32_16x16x32_bf16 v[252:255], v[60:63], v[108:111], v[252:255]
    ds_read_b128 v[60:63], v22 offset:46848
    s_waitcnt lgkmcnt(6)
    v_mfma_f32_16x16x32_bf16 v[192:195], v[28:31], v[120:123], v[192:195]
    s_barrier
    ds_read_b64_tr_b16 v[80:81], v21 offset:0
    v_mfma_f32_16x16x32_bf16 v[188:191], v[28:31], v[116:119], v[188:191]
    ds_read_b128 v[28:31], v18 offset:55296
    v_mfma_f32_16x16x32_bf16 v[200:203], v[32:35], v[120:123], v[200:203]
    ds_read_b64_tr_b16 v[82:83], v21 offset:4096
    v_mfma_f32_16x16x32_bf16 v[196:199], v[32:35], v[116:119], v[196:199]
    ds_read_b128 v[32:35], v18 offset:55552
    v_mfma_f32_16x16x32_bf16 v[208:211], v[36:39], v[120:123], v[208:211]
    ds_read_b64_tr_b16 v[76:77], v20 offset:0
    v_mfma_f32_16x16x32_bf16 v[204:207], v[36:39], v[116:119], v[204:207]
    ds_read_b128 v[36:39], v18 offset:55808
    s_waitcnt lgkmcnt(9)
    v_mfma_f32_16x16x32_bf16 v[216:219], v[40:43], v[120:123], v[216:219]
    ds_read_b64_tr_b16 v[78:79], v20 offset:4096
    v_mfma_f32_16x16x32_bf16 v[212:215], v[40:43], v[116:119], v[212:215]
    ds_read_b128 v[40:43], v18 offset:56064
    v_mfma_f32_16x16x32_bf16 v[224:227], v[44:47], v[120:123], v[224:227]
    v_mfma_f32_16x16x32_bf16 v[220:223], v[44:47], v[116:119], v[220:223]
    ds_read_b128 v[44:47], v19 offset:55296
    v_mfma_f32_16x16x32_bf16 v[232:235], v[48:51], v[120:123], v[232:235]
    v_mfma_f32_16x16x32_bf16 v[228:231], v[48:51], v[116:119], v[228:231]
    ds_read_b128 v[48:51], v22 offset:55296
    s_waitcnt lgkmcnt(10)
    v_mfma_f32_16x16x32_bf16 v[240:243], v[52:55], v[120:123], v[240:243]
    v_mfma_f32_16x16x32_bf16 v[236:239], v[52:55], v[116:119], v[236:239]
    ds_read_b128 v[52:55], v22 offset:55552
    v_mfma_f32_16x16x32_bf16 v[248:251], v[56:59], v[120:123], v[248:251]
    v_mfma_f32_16x16x32_bf16 v[244:247], v[56:59], v[116:119], v[244:247]
    ds_read_b128 v[56:59], v22 offset:55808
    v_mfma_f32_16x16x32_bf16 v[64:67], v[60:63], v[120:123], v[64:67]
    v_mfma_f32_16x16x32_bf16 v[252:255], v[60:63], v[116:119], v[252:255]
    ds_read_b128 v[60:63], v22 offset:56064
    s_waitcnt lgkmcnt(6)
    v_mfma_f32_16x16x32_bf16 v[192:195], v[28:31], v[80:83], v[192:195]
    ds_read_b64_tr_b16 v[88:89], v21 offset:8192
    v_mfma_f32_16x16x32_bf16 v[188:191], v[28:31], v[76:79], v[188:191]
    ds_read_b128 v[28:31], v18 offset:64512
    v_mfma_f32_16x16x32_bf16 v[200:203], v[32:35], v[80:83], v[200:203]
    ds_read_b64_tr_b16 v[90:91], v21 offset:12288
    v_mfma_f32_16x16x32_bf16 v[196:199], v[32:35], v[76:79], v[196:199]
    ds_read_b128 v[32:35], v18 offset:64768
    v_mfma_f32_16x16x32_bf16 v[208:211], v[36:39], v[80:83], v[208:211]
    ds_read_b64_tr_b16 v[84:85], v20 offset:8192
    v_mfma_f32_16x16x32_bf16 v[204:207], v[36:39], v[76:79], v[204:207]
    ds_read_b128 v[36:39], v18 offset:65024
    s_waitcnt lgkmcnt(9)
    v_mfma_f32_16x16x32_bf16 v[216:219], v[40:43], v[80:83], v[216:219]
    ds_read_b64_tr_b16 v[86:87], v20 offset:12288
    v_mfma_f32_16x16x32_bf16 v[212:215], v[40:43], v[76:79], v[212:215]
    ds_read_b128 v[40:43], v18 offset:65280
    v_mfma_f32_16x16x32_bf16 v[224:227], v[44:47], v[80:83], v[224:227]
    v_mfma_f32_16x16x32_bf16 v[220:223], v[44:47], v[76:79], v[220:223]
    ds_read_b128 v[44:47], v19 offset:64512
    v_mfma_f32_16x16x32_bf16 v[232:235], v[48:51], v[80:83], v[232:235]
    v_mfma_f32_16x16x32_bf16 v[228:231], v[48:51], v[76:79], v[228:231]
    ds_read_b128 v[48:51], v22 offset:64512
    s_waitcnt lgkmcnt(10)
    v_mfma_f32_16x16x32_bf16 v[240:243], v[52:55], v[80:83], v[240:243]
    v_mfma_f32_16x16x32_bf16 v[236:239], v[52:55], v[76:79], v[236:239]
    ds_read_b128 v[52:55], v22 offset:64768
    v_mfma_f32_16x16x32_bf16 v[248:251], v[56:59], v[80:83], v[248:251]
    v_mfma_f32_16x16x32_bf16 v[244:247], v[56:59], v[76:79], v[244:247]
    ds_read_b128 v[56:59], v22 offset:65024
    v_mfma_f32_16x16x32_bf16 v[64:67], v[60:63], v[80:83], v[64:67]
    v_mfma_f32_16x16x32_bf16 v[252:255], v[60:63], v[76:79], v[252:255]
    ds_read_b128 v[60:63], v22 offset:65280
    s_waitcnt lgkmcnt(6)
    v_mfma_f32_16x16x32_bf16 v[192:195], v[28:31], v[88:91], v[192:195]
    s_barrier
    v_mfma_f32_16x16x32_bf16 v[188:191], v[28:31], v[84:87], v[188:191]
    ds_read_b128 v[28:31], v18 offset:0
    v_mfma_f32_16x16x32_bf16 v[200:203], v[32:35], v[88:91], v[200:203]
    v_mfma_f32_16x16x32_bf16 v[196:199], v[32:35], v[84:87], v[196:199]
    ds_read_b128 v[32:35], v18 offset:256
    v_mfma_f32_16x16x32_bf16 v[208:211], v[36:39], v[88:91], v[208:211]
    v_mfma_f32_16x16x32_bf16 v[204:207], v[36:39], v[84:87], v[204:207]
    ds_read_b128 v[36:39], v18 offset:512
    s_waitcnt lgkmcnt(6)
    v_mfma_f32_16x16x32_bf16 v[216:219], v[40:43], v[88:91], v[216:219]
    v_mfma_f32_16x16x32_bf16 v[212:215], v[40:43], v[84:87], v[212:215]
    ds_read_b128 v[40:43], v18 offset:768
    v_mfma_f32_16x16x32_bf16 v[224:227], v[44:47], v[88:91], v[224:227]
    v_mfma_f32_16x16x32_bf16 v[220:223], v[44:47], v[84:87], v[220:223]
    ds_read_b128 v[44:47], v19 offset:0
    v_mfma_f32_16x16x32_bf16 v[232:235], v[48:51], v[88:91], v[232:235]
    v_mfma_f32_16x16x32_bf16 v[228:231], v[48:51], v[84:87], v[228:231]
    ds_read_b128 v[48:51], v22 offset:0
    s_waitcnt lgkmcnt(6)
    v_mfma_f32_16x16x32_bf16 v[240:243], v[52:55], v[88:91], v[240:243]
    v_mfma_f32_16x16x32_bf16 v[236:239], v[52:55], v[84:87], v[236:239]
    ds_read_b128 v[52:55], v22 offset:256
    v_mfma_f32_16x16x32_bf16 v[248:251], v[56:59], v[88:91], v[248:251]
    v_mfma_f32_16x16x32_bf16 v[244:247], v[56:59], v[84:87], v[244:247]
    ds_read_b128 v[56:59], v22 offset:512
    v_mfma_f32_16x16x32_bf16 v[64:67], v[60:63], v[88:91], v[64:67]
    v_mfma_f32_16x16x32_bf16 v[252:255], v[60:63], v[84:87], v[252:255]
    ds_read_b128 v[60:63], v22 offset:768
    s_waitcnt lgkmcnt(6)
    v_mfma_f32_16x16x32_bf16 v[192:195], v[28:31], v[128:131], v[192:195]
    v_mfma_f32_16x16x32_bf16 v[188:191], v[28:31], v[124:127], v[188:191]
    ds_read_b128 v[28:31], v18 offset:9216
    v_mfma_f32_16x16x32_bf16 v[200:203], v[32:35], v[128:131], v[200:203]
    v_mfma_f32_16x16x32_bf16 v[196:199], v[32:35], v[124:127], v[196:199]
    ds_read_b128 v[32:35], v18 offset:9472
    v_mfma_f32_16x16x32_bf16 v[208:211], v[36:39], v[128:131], v[208:211]
    v_mfma_f32_16x16x32_bf16 v[204:207], v[36:39], v[124:127], v[204:207]
    ds_read_b128 v[36:39], v18 offset:9728
    s_waitcnt lgkmcnt(6)
    v_mfma_f32_16x16x32_bf16 v[216:219], v[40:43], v[128:131], v[216:219]
    v_mfma_f32_16x16x32_bf16 v[212:215], v[40:43], v[124:127], v[212:215]
    ds_read_b128 v[40:43], v18 offset:9984
    v_mfma_f32_16x16x32_bf16 v[224:227], v[44:47], v[128:131], v[224:227]
    v_mfma_f32_16x16x32_bf16 v[220:223], v[44:47], v[124:127], v[220:223]
    ds_read_b128 v[44:47], v19 offset:9216
    v_mfma_f32_16x16x32_bf16 v[232:235], v[48:51], v[128:131], v[232:235]
    v_mfma_f32_16x16x32_bf16 v[228:231], v[48:51], v[124:127], v[228:231]
    ds_read_b128 v[48:51], v22 offset:9216
    s_waitcnt lgkmcnt(6)
    v_mfma_f32_16x16x32_bf16 v[240:243], v[52:55], v[128:131], v[240:243]
    v_mfma_f32_16x16x32_bf16 v[236:239], v[52:55], v[124:127], v[236:239]
    ds_read_b128 v[52:55], v22 offset:9472
    v_mfma_f32_16x16x32_bf16 v[248:251], v[56:59], v[128:131], v[248:251]
    v_mfma_f32_16x16x32_bf16 v[244:247], v[56:59], v[124:127], v[244:247]
    ds_read_b128 v[56:59], v22 offset:9728
    v_mfma_f32_16x16x32_bf16 v[64:67], v[60:63], v[128:131], v[64:67]
    v_mfma_f32_16x16x32_bf16 v[252:255], v[60:63], v[124:127], v[252:255]
    ds_read_b128 v[60:63], v22 offset:9984
    s_waitcnt lgkmcnt(6)
    v_mfma_f32_16x16x32_bf16 v[192:195], v[28:31], v[136:139], v[192:195]
    s_barrier
    ds_read_b64_tr_b16 v[80:81], v21 offset:16384
    v_mfma_f32_16x16x32_bf16 v[188:191], v[28:31], v[132:135], v[188:191]
    ds_read_b128 v[28:31], v18 offset:18432
    v_mfma_f32_16x16x32_bf16 v[200:203], v[32:35], v[136:139], v[200:203]
    ds_read_b64_tr_b16 v[82:83], v21 offset:20480
    v_mfma_f32_16x16x32_bf16 v[196:199], v[32:35], v[132:135], v[196:199]
    ds_read_b128 v[32:35], v18 offset:18688
    v_mfma_f32_16x16x32_bf16 v[208:211], v[36:39], v[136:139], v[208:211]
    ds_read_b64_tr_b16 v[76:77], v20 offset:16384
    v_mfma_f32_16x16x32_bf16 v[204:207], v[36:39], v[132:135], v[204:207]
    ds_read_b128 v[36:39], v18 offset:18944
    s_waitcnt lgkmcnt(9)
    v_mfma_f32_16x16x32_bf16 v[216:219], v[40:43], v[136:139], v[216:219]
    ds_read_b64_tr_b16 v[78:79], v20 offset:20480
    v_mfma_f32_16x16x32_bf16 v[212:215], v[40:43], v[132:135], v[212:215]
    ds_read_b128 v[40:43], v18 offset:19200
    v_mfma_f32_16x16x32_bf16 v[224:227], v[44:47], v[136:139], v[224:227]
    v_mfma_f32_16x16x32_bf16 v[220:223], v[44:47], v[132:135], v[220:223]
    ds_read_b128 v[44:47], v19 offset:18432
    v_mfma_f32_16x16x32_bf16 v[232:235], v[48:51], v[136:139], v[232:235]
    v_mfma_f32_16x16x32_bf16 v[228:231], v[48:51], v[132:135], v[228:231]
    ds_read_b128 v[48:51], v22 offset:18432
    s_waitcnt lgkmcnt(10)
    v_mfma_f32_16x16x32_bf16 v[240:243], v[52:55], v[136:139], v[240:243]
    v_mfma_f32_16x16x32_bf16 v[236:239], v[52:55], v[132:135], v[236:239]
    ds_read_b128 v[52:55], v22 offset:18688
    v_mfma_f32_16x16x32_bf16 v[248:251], v[56:59], v[136:139], v[248:251]
    v_mfma_f32_16x16x32_bf16 v[244:247], v[56:59], v[132:135], v[244:247]
    ds_read_b128 v[56:59], v22 offset:18944
    v_mfma_f32_16x16x32_bf16 v[64:67], v[60:63], v[136:139], v[64:67]
    v_mfma_f32_16x16x32_bf16 v[252:255], v[60:63], v[132:135], v[252:255]
    ds_read_b128 v[60:63], v22 offset:19200
    s_waitcnt lgkmcnt(6)
    v_mfma_f32_16x16x32_bf16 v[192:195], v[28:31], v[80:83], v[192:195]
    ds_read_b64_tr_b16 v[88:89], v21 offset:24576
    v_mfma_f32_16x16x32_bf16 v[188:191], v[28:31], v[76:79], v[188:191]
    ds_read_b128 v[28:31], v18 offset:27648
    v_mfma_f32_16x16x32_bf16 v[200:203], v[32:35], v[80:83], v[200:203]
    ds_read_b64_tr_b16 v[90:91], v21 offset:28672
    v_mfma_f32_16x16x32_bf16 v[196:199], v[32:35], v[76:79], v[196:199]
    ds_read_b128 v[32:35], v18 offset:27904
    v_mfma_f32_16x16x32_bf16 v[208:211], v[36:39], v[80:83], v[208:211]
    ds_read_b64_tr_b16 v[84:85], v20 offset:24576
    v_mfma_f32_16x16x32_bf16 v[204:207], v[36:39], v[76:79], v[204:207]
    ds_read_b128 v[36:39], v18 offset:28160
    s_waitcnt lgkmcnt(9)
    v_mfma_f32_16x16x32_bf16 v[216:219], v[40:43], v[80:83], v[216:219]
    ds_read_b64_tr_b16 v[86:87], v20 offset:28672
    v_mfma_f32_16x16x32_bf16 v[212:215], v[40:43], v[76:79], v[212:215]
    ds_read_b128 v[40:43], v18 offset:28416
    v_mfma_f32_16x16x32_bf16 v[224:227], v[44:47], v[80:83], v[224:227]
    v_mfma_f32_16x16x32_bf16 v[220:223], v[44:47], v[76:79], v[220:223]
    ds_read_b128 v[44:47], v19 offset:27648
    v_mfma_f32_16x16x32_bf16 v[232:235], v[48:51], v[80:83], v[232:235]
    v_mfma_f32_16x16x32_bf16 v[228:231], v[48:51], v[76:79], v[228:231]
    ds_read_b128 v[48:51], v22 offset:27648
    s_waitcnt lgkmcnt(10)
    v_mfma_f32_16x16x32_bf16 v[240:243], v[52:55], v[80:83], v[240:243]
    v_mfma_f32_16x16x32_bf16 v[236:239], v[52:55], v[76:79], v[236:239]
    ds_read_b128 v[52:55], v22 offset:27904
    v_mfma_f32_16x16x32_bf16 v[248:251], v[56:59], v[80:83], v[248:251]
    v_mfma_f32_16x16x32_bf16 v[244:247], v[56:59], v[76:79], v[244:247]
    ds_read_b128 v[56:59], v22 offset:28160
    v_mfma_f32_16x16x32_bf16 v[64:67], v[60:63], v[80:83], v[64:67]
    v_mfma_f32_16x16x32_bf16 v[252:255], v[60:63], v[76:79], v[252:255]
    ds_read_b128 v[60:63], v22 offset:28416
    s_waitcnt lgkmcnt(6)
    v_mfma_f32_16x16x32_bf16 v[192:195], v[28:31], v[88:91], v[192:195]
    s_barrier
    v_mfma_f32_16x16x32_bf16 v[188:191], v[28:31], v[84:87], v[188:191]
    ds_read_b128 v[28:31], v18 offset:36864
    v_mfma_f32_16x16x32_bf16 v[200:203], v[32:35], v[88:91], v[200:203]
    v_mfma_f32_16x16x32_bf16 v[196:199], v[32:35], v[84:87], v[196:199]
    ds_read_b128 v[32:35], v18 offset:37120
    v_mfma_f32_16x16x32_bf16 v[208:211], v[36:39], v[88:91], v[208:211]
    v_mfma_f32_16x16x32_bf16 v[204:207], v[36:39], v[84:87], v[204:207]
    ds_read_b128 v[36:39], v18 offset:37376
    s_waitcnt lgkmcnt(6)
    v_mfma_f32_16x16x32_bf16 v[216:219], v[40:43], v[88:91], v[216:219]
    v_mfma_f32_16x16x32_bf16 v[212:215], v[40:43], v[84:87], v[212:215]
    ds_read_b128 v[40:43], v18 offset:37632
    v_mfma_f32_16x16x32_bf16 v[224:227], v[44:47], v[88:91], v[224:227]
    v_mfma_f32_16x16x32_bf16 v[220:223], v[44:47], v[84:87], v[220:223]
    ds_read_b128 v[44:47], v19 offset:36864
    v_mfma_f32_16x16x32_bf16 v[232:235], v[48:51], v[88:91], v[232:235]
    v_mfma_f32_16x16x32_bf16 v[228:231], v[48:51], v[84:87], v[228:231]
    ds_read_b128 v[48:51], v22 offset:36864
    s_waitcnt lgkmcnt(6)
    v_mfma_f32_16x16x32_bf16 v[240:243], v[52:55], v[88:91], v[240:243]
    v_mfma_f32_16x16x32_bf16 v[236:239], v[52:55], v[84:87], v[236:239]
    ds_read_b128 v[52:55], v22 offset:37120
    v_mfma_f32_16x16x32_bf16 v[248:251], v[56:59], v[88:91], v[248:251]
    v_mfma_f32_16x16x32_bf16 v[244:247], v[56:59], v[84:87], v[244:247]
    ds_read_b128 v[56:59], v22 offset:37376
    v_mfma_f32_16x16x32_bf16 v[64:67], v[60:63], v[88:91], v[64:67]
    v_mfma_f32_16x16x32_bf16 v[252:255], v[60:63], v[84:87], v[252:255]
    ds_read_b128 v[60:63], v22 offset:37632
    s_waitcnt lgkmcnt(6)
    v_mfma_f32_16x16x32_bf16 v[192:195], v[28:31], v[144:147], v[192:195]
    v_mfma_f32_16x16x32_bf16 v[188:191], v[28:31], v[140:143], v[188:191]
    ds_read_b128 v[28:31], v18 offset:46080
    v_mfma_f32_16x16x32_bf16 v[200:203], v[32:35], v[144:147], v[200:203]
    v_mfma_f32_16x16x32_bf16 v[196:199], v[32:35], v[140:143], v[196:199]
    ds_read_b128 v[32:35], v18 offset:46336
    v_mfma_f32_16x16x32_bf16 v[208:211], v[36:39], v[144:147], v[208:211]
    v_mfma_f32_16x16x32_bf16 v[204:207], v[36:39], v[140:143], v[204:207]
    ds_read_b128 v[36:39], v18 offset:46592
    s_waitcnt lgkmcnt(6)
    v_mfma_f32_16x16x32_bf16 v[216:219], v[40:43], v[144:147], v[216:219]
    v_mfma_f32_16x16x32_bf16 v[212:215], v[40:43], v[140:143], v[212:215]
    ds_read_b128 v[40:43], v18 offset:46848
    v_mfma_f32_16x16x32_bf16 v[224:227], v[44:47], v[144:147], v[224:227]
    v_mfma_f32_16x16x32_bf16 v[220:223], v[44:47], v[140:143], v[220:223]
    ds_read_b128 v[44:47], v19 offset:46080
    v_mfma_f32_16x16x32_bf16 v[232:235], v[48:51], v[144:147], v[232:235]
    v_mfma_f32_16x16x32_bf16 v[228:231], v[48:51], v[140:143], v[228:231]
    ds_read_b128 v[48:51], v22 offset:46080
    s_waitcnt lgkmcnt(6)
    v_mfma_f32_16x16x32_bf16 v[240:243], v[52:55], v[144:147], v[240:243]
    v_mfma_f32_16x16x32_bf16 v[236:239], v[52:55], v[140:143], v[236:239]
    ds_read_b128 v[52:55], v22 offset:46336
    v_mfma_f32_16x16x32_bf16 v[248:251], v[56:59], v[144:147], v[248:251]
    v_mfma_f32_16x16x32_bf16 v[244:247], v[56:59], v[140:143], v[244:247]
    ds_read_b128 v[56:59], v22 offset:46592
    v_mfma_f32_16x16x32_bf16 v[64:67], v[60:63], v[144:147], v[64:67]
    v_mfma_f32_16x16x32_bf16 v[252:255], v[60:63], v[140:143], v[252:255]
    ds_read_b128 v[60:63], v22 offset:46848
    s_waitcnt lgkmcnt(6)
    v_mfma_f32_16x16x32_bf16 v[192:195], v[28:31], v[152:155], v[192:195]
    s_barrier
    v_mfma_f32_16x16x32_bf16 v[188:191], v[28:31], v[148:151], v[188:191]
    ds_read_b128 v[28:31], v18 offset:55296
    v_mfma_f32_16x16x32_bf16 v[200:203], v[32:35], v[152:155], v[200:203]
    v_mfma_f32_16x16x32_bf16 v[196:199], v[32:35], v[148:151], v[196:199]
    ds_read_b128 v[32:35], v18 offset:55552
    v_mfma_f32_16x16x32_bf16 v[208:211], v[36:39], v[152:155], v[208:211]
    v_mfma_f32_16x16x32_bf16 v[204:207], v[36:39], v[148:151], v[204:207]
    ds_read_b128 v[36:39], v18 offset:55808
    s_waitcnt lgkmcnt(6)
    v_mfma_f32_16x16x32_bf16 v[216:219], v[40:43], v[152:155], v[216:219]
    v_mfma_f32_16x16x32_bf16 v[212:215], v[40:43], v[148:151], v[212:215]
    ds_read_b128 v[40:43], v18 offset:56064
    v_mfma_f32_16x16x32_bf16 v[224:227], v[44:47], v[152:155], v[224:227]
    v_mfma_f32_16x16x32_bf16 v[220:223], v[44:47], v[148:151], v[220:223]
    ds_read_b128 v[44:47], v19 offset:55296
    v_mfma_f32_16x16x32_bf16 v[232:235], v[48:51], v[152:155], v[232:235]
    v_mfma_f32_16x16x32_bf16 v[228:231], v[48:51], v[148:151], v[228:231]
    ds_read_b128 v[48:51], v22 offset:55296
    s_waitcnt lgkmcnt(6)
    v_mfma_f32_16x16x32_bf16 v[240:243], v[52:55], v[152:155], v[240:243]
    v_mfma_f32_16x16x32_bf16 v[236:239], v[52:55], v[148:151], v[236:239]
    ds_read_b128 v[52:55], v22 offset:55552
    v_mfma_f32_16x16x32_bf16 v[248:251], v[56:59], v[152:155], v[248:251]
    v_mfma_f32_16x16x32_bf16 v[244:247], v[56:59], v[148:151], v[244:247]
    ds_read_b128 v[56:59], v22 offset:55808
    v_mfma_f32_16x16x32_bf16 v[64:67], v[60:63], v[152:155], v[64:67]
    v_mfma_f32_16x16x32_bf16 v[252:255], v[60:63], v[148:151], v[252:255]
    ds_read_b128 v[60:63], v22 offset:56064
    s_waitcnt lgkmcnt(6)
    v_mfma_f32_16x16x32_bf16 v[192:195], v[28:31], v[160:163], v[192:195]
    v_mfma_f32_16x16x32_bf16 v[188:191], v[28:31], v[156:159], v[188:191]
    ds_read_b128 v[28:31], v18 offset:64512
    v_mfma_f32_16x16x32_bf16 v[200:203], v[32:35], v[160:163], v[200:203]
    v_mfma_f32_16x16x32_bf16 v[196:199], v[32:35], v[156:159], v[196:199]
    ds_read_b128 v[32:35], v18 offset:64768
    v_mfma_f32_16x16x32_bf16 v[208:211], v[36:39], v[160:163], v[208:211]
    v_mfma_f32_16x16x32_bf16 v[204:207], v[36:39], v[156:159], v[204:207]
    ds_read_b128 v[36:39], v18 offset:65024
    s_waitcnt lgkmcnt(6)
    v_mfma_f32_16x16x32_bf16 v[216:219], v[40:43], v[160:163], v[216:219]
    v_mfma_f32_16x16x32_bf16 v[212:215], v[40:43], v[156:159], v[212:215]
    ds_read_b128 v[40:43], v18 offset:65280
    v_mfma_f32_16x16x32_bf16 v[224:227], v[44:47], v[160:163], v[224:227]
    v_mfma_f32_16x16x32_bf16 v[220:223], v[44:47], v[156:159], v[220:223]
    ds_read_b128 v[44:47], v19 offset:64512
    v_mfma_f32_16x16x32_bf16 v[232:235], v[48:51], v[160:163], v[232:235]
    v_mfma_f32_16x16x32_bf16 v[228:231], v[48:51], v[156:159], v[228:231]
    ds_read_b128 v[48:51], v22 offset:64512
    s_waitcnt lgkmcnt(6)
    v_mfma_f32_16x16x32_bf16 v[240:243], v[52:55], v[160:163], v[240:243]
    v_mfma_f32_16x16x32_bf16 v[236:239], v[52:55], v[156:159], v[236:239]
    ds_read_b128 v[52:55], v22 offset:64768
    v_mfma_f32_16x16x32_bf16 v[248:251], v[56:59], v[160:163], v[248:251]
    v_mfma_f32_16x16x32_bf16 v[244:247], v[56:59], v[156:159], v[244:247]
    ds_read_b128 v[56:59], v22 offset:65024
    v_mfma_f32_16x16x32_bf16 v[64:67], v[60:63], v[160:163], v[64:67]
    v_mfma_f32_16x16x32_bf16 v[252:255], v[60:63], v[156:159], v[252:255]
    ds_read_b128 v[60:63], v22 offset:65280
    s_waitcnt lgkmcnt(6)
    v_mfma_f32_16x16x32_bf16 v[192:195], v[28:31], v[168:171], v[192:195]
    s_barrier
    v_mfma_f32_16x16x32_bf16 v[188:191], v[28:31], v[164:167], v[188:191]
    ds_read_b128 v[28:31], v18 offset:0
    v_mfma_f32_16x16x32_bf16 v[200:203], v[32:35], v[168:171], v[200:203]
    v_mfma_f32_16x16x32_bf16 v[196:199], v[32:35], v[164:167], v[196:199]
    ds_read_b128 v[32:35], v18 offset:256
    v_mfma_f32_16x16x32_bf16 v[208:211], v[36:39], v[168:171], v[208:211]
    v_mfma_f32_16x16x32_bf16 v[204:207], v[36:39], v[164:167], v[204:207]
    ds_read_b128 v[36:39], v18 offset:512
    s_waitcnt lgkmcnt(6)
    v_mfma_f32_16x16x32_bf16 v[216:219], v[40:43], v[168:171], v[216:219]
    v_mfma_f32_16x16x32_bf16 v[212:215], v[40:43], v[164:167], v[212:215]
    ds_read_b128 v[40:43], v18 offset:768
    v_mfma_f32_16x16x32_bf16 v[224:227], v[44:47], v[168:171], v[224:227]
    v_mfma_f32_16x16x32_bf16 v[220:223], v[44:47], v[164:167], v[220:223]
    ds_read_b128 v[44:47], v19 offset:0
    v_mfma_f32_16x16x32_bf16 v[232:235], v[48:51], v[168:171], v[232:235]
    v_mfma_f32_16x16x32_bf16 v[228:231], v[48:51], v[164:167], v[228:231]
    ds_read_b128 v[48:51], v22 offset:0
    s_waitcnt lgkmcnt(6)
    v_mfma_f32_16x16x32_bf16 v[240:243], v[52:55], v[168:171], v[240:243]
    v_mfma_f32_16x16x32_bf16 v[236:239], v[52:55], v[164:167], v[236:239]
    ds_read_b128 v[52:55], v22 offset:256
    v_mfma_f32_16x16x32_bf16 v[248:251], v[56:59], v[168:171], v[248:251]
    v_mfma_f32_16x16x32_bf16 v[244:247], v[56:59], v[164:167], v[244:247]
    ds_read_b128 v[56:59], v22 offset:512
    v_mfma_f32_16x16x32_bf16 v[64:67], v[60:63], v[168:171], v[64:67]
    v_mfma_f32_16x16x32_bf16 v[252:255], v[60:63], v[164:167], v[252:255]
    ds_read_b128 v[60:63], v22 offset:768
    s_waitcnt lgkmcnt(6)
    v_mfma_f32_16x16x32_bf16 v[192:195], v[28:31], v[176:179], v[192:195]
    v_mfma_f32_16x16x32_bf16 v[188:191], v[28:31], v[172:175], v[188:191]
    ds_read_b128 v[28:31], v18 offset:9216
    v_mfma_f32_16x16x32_bf16 v[200:203], v[32:35], v[176:179], v[200:203]
    v_mfma_f32_16x16x32_bf16 v[196:199], v[32:35], v[172:175], v[196:199]
    ds_read_b128 v[32:35], v18 offset:9472
    v_mfma_f32_16x16x32_bf16 v[208:211], v[36:39], v[176:179], v[208:211]
    v_mfma_f32_16x16x32_bf16 v[204:207], v[36:39], v[172:175], v[204:207]
    ds_read_b128 v[36:39], v18 offset:9728
    s_waitcnt lgkmcnt(6)
    v_mfma_f32_16x16x32_bf16 v[216:219], v[40:43], v[176:179], v[216:219]
    v_mfma_f32_16x16x32_bf16 v[212:215], v[40:43], v[172:175], v[212:215]
    ds_read_b128 v[40:43], v18 offset:9984
    v_mfma_f32_16x16x32_bf16 v[224:227], v[44:47], v[176:179], v[224:227]
    v_mfma_f32_16x16x32_bf16 v[220:223], v[44:47], v[172:175], v[220:223]
    ds_read_b128 v[44:47], v19 offset:9216
    s_branch L_skip_9
    s_nop 0
L_stub_9:
    s_branch L_stub_10
L_skip_9:
    v_mfma_f32_16x16x32_bf16 v[232:235], v[48:51], v[176:179], v[232:235]
    v_mfma_f32_16x16x32_bf16 v[228:231], v[48:51], v[172:175], v[228:231]
    ds_read_b128 v[48:51], v22 offset:9216
    s_waitcnt lgkmcnt(6)
    v_mfma_f32_16x16x32_bf16 v[240:243], v[52:55], v[176:179], v[240:243]
    v_mfma_f32_16x16x32_bf16 v[236:239], v[52:55], v[172:175], v[236:239]
    ds_read_b128 v[52:55], v22 offset:9472
    v_mfma_f32_16x16x32_bf16 v[248:251], v[56:59], v[176:179], v[248:251]
    v_mfma_f32_16x16x32_bf16 v[244:247], v[56:59], v[172:175], v[244:247]
    ds_read_b128 v[56:59], v22 offset:9728
    v_mfma_f32_16x16x32_bf16 v[64:67], v[60:63], v[176:179], v[64:67]
    v_mfma_f32_16x16x32_bf16 v[252:255], v[60:63], v[172:175], v[252:255]
    ds_read_b128 v[60:63], v22 offset:9984
    s_waitcnt lgkmcnt(6)
    v_mfma_f32_16x16x32_bf16 v[192:195], v[28:31], v[184:187], v[192:195]
    s_barrier
    ds_read_b64_tr_b16 v[80:81], v21 offset:32768
    v_mfma_f32_16x16x32_bf16 v[188:191], v[28:31], v[180:183], v[188:191]
    ds_read_b128 v[28:31], v18 offset:18432
    v_mfma_f32_16x16x32_bf16 v[200:203], v[32:35], v[184:187], v[200:203]
    ds_read_b64_tr_b16 v[82:83], v21 offset:36864
    v_mfma_f32_16x16x32_bf16 v[196:199], v[32:35], v[180:183], v[196:199]
    ds_read_b128 v[32:35], v18 offset:18688
    v_mfma_f32_16x16x32_bf16 v[208:211], v[36:39], v[184:187], v[208:211]
    ds_read_b64_tr_b16 v[76:77], v20 offset:32768
    v_mfma_f32_16x16x32_bf16 v[204:207], v[36:39], v[180:183], v[204:207]
    ds_read_b128 v[36:39], v18 offset:18944
    s_waitcnt lgkmcnt(9)
    v_mfma_f32_16x16x32_bf16 v[216:219], v[40:43], v[184:187], v[216:219]
    ds_read_b64_tr_b16 v[78:79], v20 offset:36864
    v_mfma_f32_16x16x32_bf16 v[212:215], v[40:43], v[180:183], v[212:215]
    ds_read_b128 v[40:43], v18 offset:19200
    v_mfma_f32_16x16x32_bf16 v[224:227], v[44:47], v[184:187], v[224:227]
    v_mfma_f32_16x16x32_bf16 v[220:223], v[44:47], v[180:183], v[220:223]
    ds_read_b128 v[44:47], v19 offset:18432
    v_mfma_f32_16x16x32_bf16 v[232:235], v[48:51], v[184:187], v[232:235]
    v_mfma_f32_16x16x32_bf16 v[228:231], v[48:51], v[180:183], v[228:231]
    ds_read_b128 v[48:51], v22 offset:18432
    s_waitcnt lgkmcnt(10)
    v_mfma_f32_16x16x32_bf16 v[240:243], v[52:55], v[184:187], v[240:243]
    v_mfma_f32_16x16x32_bf16 v[236:239], v[52:55], v[180:183], v[236:239]
    ds_read_b128 v[52:55], v22 offset:18688
    v_mfma_f32_16x16x32_bf16 v[248:251], v[56:59], v[184:187], v[248:251]
    v_mfma_f32_16x16x32_bf16 v[244:247], v[56:59], v[180:183], v[244:247]
    ds_read_b128 v[56:59], v22 offset:18944
    v_mfma_f32_16x16x32_bf16 v[64:67], v[60:63], v[184:187], v[64:67]
    v_mfma_f32_16x16x32_bf16 v[252:255], v[60:63], v[180:183], v[252:255]
    ds_read_b128 v[60:63], v22 offset:19200
    s_waitcnt lgkmcnt(6)
    v_mfma_f32_16x16x32_bf16 v[192:195], v[28:31], v[80:83], v[192:195]
    ds_read_b64_tr_b16 v[88:89], v21 offset:40960
    v_mfma_f32_16x16x32_bf16 v[188:191], v[28:31], v[76:79], v[188:191]
    ds_read_b128 v[28:31], v18 offset:27648
    v_mfma_f32_16x16x32_bf16 v[200:203], v[32:35], v[80:83], v[200:203]
    ds_read_b64_tr_b16 v[90:91], v21 offset:45056
    v_mfma_f32_16x16x32_bf16 v[196:199], v[32:35], v[76:79], v[196:199]
    ds_read_b128 v[32:35], v18 offset:27904
    v_mfma_f32_16x16x32_bf16 v[208:211], v[36:39], v[80:83], v[208:211]
    ds_read_b64_tr_b16 v[84:85], v20 offset:40960
    v_mfma_f32_16x16x32_bf16 v[204:207], v[36:39], v[76:79], v[204:207]
    ds_read_b128 v[36:39], v18 offset:28160
    s_waitcnt lgkmcnt(9)
    v_mfma_f32_16x16x32_bf16 v[216:219], v[40:43], v[80:83], v[216:219]
    ds_read_b64_tr_b16 v[86:87], v20 offset:45056
    v_mfma_f32_16x16x32_bf16 v[212:215], v[40:43], v[76:79], v[212:215]
    ds_read_b128 v[40:43], v18 offset:28416
    v_mfma_f32_16x16x32_bf16 v[224:227], v[44:47], v[80:83], v[224:227]
    v_mfma_f32_16x16x32_bf16 v[220:223], v[44:47], v[76:79], v[220:223]
    ds_read_b128 v[44:47], v19 offset:27648
    v_mfma_f32_16x16x32_bf16 v[232:235], v[48:51], v[80:83], v[232:235]
    v_mfma_f32_16x16x32_bf16 v[228:231], v[48:51], v[76:79], v[228:231]
    ds_read_b128 v[48:51], v22 offset:27648
    s_waitcnt lgkmcnt(10)
    v_mfma_f32_16x16x32_bf16 v[240:243], v[52:55], v[80:83], v[240:243]
    v_mfma_f32_16x16x32_bf16 v[236:239], v[52:55], v[76:79], v[236:239]
    ds_read_b128 v[52:55], v22 offset:27904
    v_mfma_f32_16x16x32_bf16 v[248:251], v[56:59], v[80:83], v[248:251]
    v_mfma_f32_16x16x32_bf16 v[244:247], v[56:59], v[76:79], v[244:247]
    ds_read_b128 v[56:59], v22 offset:28160
    v_mfma_f32_16x16x32_bf16 v[64:67], v[60:63], v[80:83], v[64:67]
    v_mfma_f32_16x16x32_bf16 v[252:255], v[60:63], v[76:79], v[252:255]
    ds_read_b128 v[60:63], v22 offset:28416
    s_waitcnt lgkmcnt(6)
    v_mfma_f32_16x16x32_bf16 v[192:195], v[28:31], v[88:91], v[192:195]
    s_barrier
    ds_read_b64_tr_b16 v[80:81], v25 offset:0
    v_mfma_f32_16x16x32_bf16 v[188:191], v[28:31], v[84:87], v[188:191]
    ds_read_b128 v[28:31], v18 offset:36864
    v_mfma_f32_16x16x32_bf16 v[200:203], v[32:35], v[88:91], v[200:203]
    ds_read_b64_tr_b16 v[82:83], v25 offset:4096
    v_mfma_f32_16x16x32_bf16 v[196:199], v[32:35], v[84:87], v[196:199]
    ds_read_b128 v[32:35], v18 offset:37120
    v_mfma_f32_16x16x32_bf16 v[208:211], v[36:39], v[88:91], v[208:211]
    ds_read_b64_tr_b16 v[92:93], v24 offset:0
    v_mfma_f32_16x16x32_bf16 v[204:207], v[36:39], v[84:87], v[204:207]
    ds_read_b128 v[36:39], v18 offset:37376
    s_waitcnt lgkmcnt(9)
    v_mfma_f32_16x16x32_bf16 v[216:219], v[40:43], v[88:91], v[216:219]
    ds_read_b64_tr_b16 v[94:95], v24 offset:4096
    v_mfma_f32_16x16x32_bf16 v[212:215], v[40:43], v[84:87], v[212:215]
    ds_read_b128 v[40:43], v18 offset:37632
    v_mfma_f32_16x16x32_bf16 v[224:227], v[44:47], v[88:91], v[224:227]
    v_mfma_f32_16x16x32_bf16 v[220:223], v[44:47], v[84:87], v[220:223]
    ds_read_b128 v[44:47], v19 offset:36864
    v_mfma_f32_16x16x32_bf16 v[232:235], v[48:51], v[88:91], v[232:235]
    v_mfma_f32_16x16x32_bf16 v[228:231], v[48:51], v[84:87], v[228:231]
    ds_read_b128 v[48:51], v22 offset:36864
    s_waitcnt lgkmcnt(10)
    v_mfma_f32_16x16x32_bf16 v[240:243], v[52:55], v[88:91], v[240:243]
    v_mfma_f32_16x16x32_bf16 v[236:239], v[52:55], v[84:87], v[236:239]
    ds_read_b128 v[52:55], v22 offset:37120
    v_mfma_f32_16x16x32_bf16 v[248:251], v[56:59], v[88:91], v[248:251]
    v_mfma_f32_16x16x32_bf16 v[244:247], v[56:59], v[84:87], v[244:247]
    ds_read_b128 v[56:59], v22 offset:37376
    v_mfma_f32_16x16x32_bf16 v[64:67], v[60:63], v[88:91], v[64:67]
    v_mfma_f32_16x16x32_bf16 v[252:255], v[60:63], v[84:87], v[252:255]
    ds_read_b128 v[60:63], v22 offset:37632
    s_waitcnt lgkmcnt(7)
    v_mfma_f32_16x16x32_bf16 v[192:195], v[28:31], v[80:83], v[192:195]
    ds_read_b128 v[28:31], v18 offset:46080
    ds_read_b64_tr_b16 v[88:89], v25 offset:8192
    v_mfma_f32_16x16x32_bf16 v[200:203], v[32:35], v[80:83], v[200:203]
    ds_read_b128 v[32:35], v18 offset:46336
    ds_read_b64_tr_b16 v[90:91], v25 offset:12288
    v_mfma_f32_16x16x32_bf16 v[208:211], v[36:39], v[80:83], v[208:211]
    ds_read_b128 v[36:39], v18 offset:46592
    s_waitcnt lgkmcnt(8)
    v_mfma_f32_16x16x32_bf16 v[216:219], v[40:43], v[80:83], v[216:219]
    ds_read_b128 v[40:43], v18 offset:46848
    v_mfma_f32_16x16x32_bf16 v[224:227], v[44:47], v[80:83], v[224:227]
    ds_read_b128 v[44:47], v19 offset:46080
    v_mfma_f32_16x16x32_bf16 v[232:235], v[48:51], v[80:83], v[232:235]
    ds_read_b128 v[48:51], v22 offset:46080
    ds_read_b64_tr_b16 v[96:97], v24 offset:8192
    s_waitcnt lgkmcnt(9)
    v_mfma_f32_16x16x32_bf16 v[240:243], v[52:55], v[80:83], v[240:243]
    ds_read_b128 v[52:55], v22 offset:46336
    ds_read_b64_tr_b16 v[98:99], v24 offset:12288
    v_mfma_f32_16x16x32_bf16 v[248:251], v[56:59], v[80:83], v[248:251]
    ds_read_b128 v[56:59], v22 offset:46592
    v_mfma_f32_16x16x32_bf16 v[64:67], v[60:63], v[80:83], v[64:67]
    ds_read_b128 v[60:63], v22 offset:46848
    s_waitcnt lgkmcnt(8)
    v_mfma_f32_16x16x32_bf16 v[192:195], v[28:31], v[88:91], v[192:195]
    s_barrier
    ds_read_b128 v[28:31], v18 offset:55296
    ds_read_b64_tr_b16 v[80:81], v25 offset:16384
    v_mfma_f32_16x16x32_bf16 v[200:203], v[32:35], v[88:91], v[200:203]
    ds_read_b128 v[32:35], v18 offset:55552
    ds_read_b64_tr_b16 v[82:83], v25 offset:20480
    v_mfma_f32_16x16x32_bf16 v[208:211], v[36:39], v[88:91], v[208:211]
    ds_read_b128 v[36:39], v18 offset:55808
    s_waitcnt lgkmcnt(10)
    v_mfma_f32_16x16x32_bf16 v[216:219], v[40:43], v[88:91], v[216:219]
    ds_read_b128 v[40:43], v18 offset:56064
    v_mfma_f32_16x16x32_bf16 v[224:227], v[44:47], v[88:91], v[224:227]
    ds_read_b128 v[44:47], v19 offset:55296
    v_mfma_f32_16x16x32_bf16 v[232:235], v[48:51], v[88:91], v[232:235]
    ds_read_b128 v[48:51], v22 offset:55296
    ds_read_b64_tr_b16 v[100:101], v24 offset:16384
    s_waitcnt lgkmcnt(9)
    v_mfma_f32_16x16x32_bf16 v[240:243], v[52:55], v[88:91], v[240:243]
    ds_read_b128 v[52:55], v22 offset:55552
    ds_read_b64_tr_b16 v[102:103], v24 offset:20480
    v_mfma_f32_16x16x32_bf16 v[248:251], v[56:59], v[88:91], v[248:251]
    ds_read_b128 v[56:59], v22 offset:55808
    v_mfma_f32_16x16x32_bf16 v[64:67], v[60:63], v[88:91], v[64:67]
    ds_read_b128 v[60:63], v22 offset:56064
    s_waitcnt lgkmcnt(8)
    v_mfma_f32_16x16x32_bf16 v[192:195], v[28:31], v[80:83], v[192:195]
    ds_read_b128 v[28:31], v18 offset:64512
    ds_read_b64_tr_b16 v[88:89], v25 offset:24576
    v_mfma_f32_16x16x32_bf16 v[200:203], v[32:35], v[80:83], v[200:203]
    ds_read_b128 v[32:35], v18 offset:64768
    ds_read_b64_tr_b16 v[90:91], v25 offset:28672
    v_mfma_f32_16x16x32_bf16 v[208:211], v[36:39], v[80:83], v[208:211]
    ds_read_b128 v[36:39], v18 offset:65024
    s_waitcnt lgkmcnt(10)
    v_mfma_f32_16x16x32_bf16 v[216:219], v[40:43], v[80:83], v[216:219]
    ds_read_b128 v[40:43], v18 offset:65280
    v_mfma_f32_16x16x32_bf16 v[224:227], v[44:47], v[80:83], v[224:227]
    ds_read_b128 v[44:47], v19 offset:64512
    v_mfma_f32_16x16x32_bf16 v[232:235], v[48:51], v[80:83], v[232:235]
    ds_read_b128 v[48:51], v22 offset:64512
    ds_read_b64_tr_b16 v[104:105], v24 offset:24576
    s_waitcnt lgkmcnt(9)
    v_mfma_f32_16x16x32_bf16 v[240:243], v[52:55], v[80:83], v[240:243]
    ds_read_b128 v[52:55], v22 offset:64768
    ds_read_b64_tr_b16 v[106:107], v24 offset:28672
    v_mfma_f32_16x16x32_bf16 v[248:251], v[56:59], v[80:83], v[248:251]
    ds_read_b128 v[56:59], v22 offset:65024
    v_mfma_f32_16x16x32_bf16 v[64:67], v[60:63], v[80:83], v[64:67]
    ds_read_b128 v[60:63], v22 offset:65280
    s_waitcnt lgkmcnt(8)
    v_mfma_f32_16x16x32_bf16 v[192:195], v[28:31], v[88:91], v[192:195]
    s_barrier
    ds_read_b128 v[28:31], v18 offset:0
    ds_read_b64_tr_b16 v[80:81], v21 offset:0
    v_mfma_f32_16x16x32_bf16 v[200:203], v[32:35], v[88:91], v[200:203]
    ds_read_b128 v[32:35], v18 offset:256
    ds_read_b64_tr_b16 v[82:83], v21 offset:4096
    v_mfma_f32_16x16x32_bf16 v[208:211], v[36:39], v[88:91], v[208:211]
    ds_read_b128 v[36:39], v18 offset:512
    s_waitcnt lgkmcnt(10)
    v_mfma_f32_16x16x32_bf16 v[216:219], v[40:43], v[88:91], v[216:219]
    ds_read_b128 v[40:43], v18 offset:768
    v_mfma_f32_16x16x32_bf16 v[224:227], v[44:47], v[88:91], v[224:227]
    ds_read_b128 v[44:47], v19 offset:0
    v_mfma_f32_16x16x32_bf16 v[232:235], v[48:51], v[88:91], v[232:235]
    ds_read_b128 v[48:51], v22 offset:0
    ds_read_b64_tr_b16 v[108:109], v20 offset:0
    s_waitcnt lgkmcnt(9)
    v_mfma_f32_16x16x32_bf16 v[240:243], v[52:55], v[88:91], v[240:243]
    ds_read_b128 v[52:55], v22 offset:256
    ds_read_b64_tr_b16 v[110:111], v20 offset:4096
    v_mfma_f32_16x16x32_bf16 v[248:251], v[56:59], v[88:91], v[248:251]
    ds_read_b128 v[56:59], v22 offset:512
    v_mfma_f32_16x16x32_bf16 v[64:67], v[60:63], v[88:91], v[64:67]
    ds_read_b128 v[60:63], v22 offset:768
    s_waitcnt lgkmcnt(8)
    v_mfma_f32_16x16x32_bf16 v[192:195], v[28:31], v[80:83], v[192:195]
    ds_read_b128 v[28:31], v18 offset:9216
    ds_read_b64_tr_b16 v[88:89], v21 offset:8192
    v_mfma_f32_16x16x32_bf16 v[200:203], v[32:35], v[80:83], v[200:203]
    ds_read_b128 v[32:35], v18 offset:9472
    ds_read_b64_tr_b16 v[90:91], v21 offset:12288
    v_mfma_f32_16x16x32_bf16 v[208:211], v[36:39], v[80:83], v[208:211]
    ds_read_b128 v[36:39], v18 offset:9728
    s_waitcnt lgkmcnt(10)
    v_mfma_f32_16x16x32_bf16 v[216:219], v[40:43], v[80:83], v[216:219]
    ds_read_b128 v[40:43], v18 offset:9984
    v_mfma_f32_16x16x32_bf16 v[224:227], v[44:47], v[80:83], v[224:227]
    ds_read_b128 v[44:47], v19 offset:9216
    v_mfma_f32_16x16x32_bf16 v[232:235], v[48:51], v[80:83], v[232:235]
    ds_read_b128 v[48:51], v22 offset:9216
    ds_read_b64_tr_b16 v[112:113], v20 offset:8192
    s_waitcnt lgkmcnt(9)
    v_mfma_f32_16x16x32_bf16 v[240:243], v[52:55], v[80:83], v[240:243]
    ds_read_b128 v[52:55], v22 offset:9472
    ds_read_b64_tr_b16 v[114:115], v20 offset:12288
    v_mfma_f32_16x16x32_bf16 v[248:251], v[56:59], v[80:83], v[248:251]
    ds_read_b128 v[56:59], v22 offset:9728
    v_mfma_f32_16x16x32_bf16 v[64:67], v[60:63], v[80:83], v[64:67]
    ds_read_b128 v[60:63], v22 offset:9984
    s_waitcnt lgkmcnt(8)
    v_mfma_f32_16x16x32_bf16 v[192:195], v[28:31], v[88:91], v[192:195]
    s_barrier
    ds_read_b128 v[28:31], v18 offset:18432
    ds_read_b64_tr_b16 v[80:81], v21 offset:16384
    v_mfma_f32_16x16x32_bf16 v[200:203], v[32:35], v[88:91], v[200:203]
    ds_read_b128 v[32:35], v18 offset:18688
    ds_read_b64_tr_b16 v[82:83], v21 offset:20480
    v_mfma_f32_16x16x32_bf16 v[208:211], v[36:39], v[88:91], v[208:211]
    ds_read_b128 v[36:39], v18 offset:18944
    s_waitcnt lgkmcnt(10)
    v_mfma_f32_16x16x32_bf16 v[216:219], v[40:43], v[88:91], v[216:219]
    ds_read_b128 v[40:43], v18 offset:19200
    v_mfma_f32_16x16x32_bf16 v[224:227], v[44:47], v[88:91], v[224:227]
    ds_read_b128 v[44:47], v19 offset:18432
    v_mfma_f32_16x16x32_bf16 v[232:235], v[48:51], v[88:91], v[232:235]
    ds_read_b128 v[48:51], v22 offset:18432
    ds_read_b64_tr_b16 v[116:117], v20 offset:16384
    s_waitcnt lgkmcnt(9)
    v_mfma_f32_16x16x32_bf16 v[240:243], v[52:55], v[88:91], v[240:243]
    ds_read_b128 v[52:55], v22 offset:18688
    ds_read_b64_tr_b16 v[118:119], v20 offset:20480
    v_mfma_f32_16x16x32_bf16 v[248:251], v[56:59], v[88:91], v[248:251]
    ds_read_b128 v[56:59], v22 offset:18944
    v_mfma_f32_16x16x32_bf16 v[64:67], v[60:63], v[88:91], v[64:67]
    ds_read_b128 v[60:63], v22 offset:19200
    s_waitcnt lgkmcnt(8)
    v_mfma_f32_16x16x32_bf16 v[192:195], v[28:31], v[80:83], v[192:195]
    ds_read_b128 v[28:31], v18 offset:27648
    ds_read_b64_tr_b16 v[88:89], v21 offset:24576
    v_mfma_f32_16x16x32_bf16 v[200:203], v[32:35], v[80:83], v[200:203]
    ds_read_b128 v[32:35], v18 offset:27904
    ds_read_b64_tr_b16 v[90:91], v21 offset:28672
    v_mfma_f32_16x16x32_bf16 v[208:211], v[36:39], v[80:83], v[208:211]
    ds_read_b128 v[36:39], v18 offset:28160
    s_waitcnt lgkmcnt(10)
    v_mfma_f32_16x16x32_bf16 v[216:219], v[40:43], v[80:83], v[216:219]
    ds_read_b128 v[40:43], v18 offset:28416
    v_mfma_f32_16x16x32_bf16 v[224:227], v[44:47], v[80:83], v[224:227]
    ds_read_b128 v[44:47], v19 offset:27648
    v_mfma_f32_16x16x32_bf16 v[232:235], v[48:51], v[80:83], v[232:235]
    ds_read_b128 v[48:51], v22 offset:27648
    ds_read_b64_tr_b16 v[120:121], v20 offset:24576
    s_waitcnt lgkmcnt(9)
    v_mfma_f32_16x16x32_bf16 v[240:243], v[52:55], v[80:83], v[240:243]
    ds_read_b128 v[52:55], v22 offset:27904
    ds_read_b64_tr_b16 v[122:123], v20 offset:28672
    v_mfma_f32_16x16x32_bf16 v[248:251], v[56:59], v[80:83], v[248:251]
    ds_read_b128 v[56:59], v22 offset:28160
    v_mfma_f32_16x16x32_bf16 v[64:67], v[60:63], v[80:83], v[64:67]
    ds_read_b128 v[60:63], v22 offset:28416
    s_waitcnt lgkmcnt(8)
    v_mfma_f32_16x16x32_bf16 v[192:195], v[28:31], v[88:91], v[192:195]
    v_mfma_f32_16x16x32_bf16 v[200:203], v[32:35], v[88:91], v[200:203]
    v_mfma_f32_16x16x32_bf16 v[208:211], v[36:39], v[88:91], v[208:211]
    s_waitcnt lgkmcnt(5)
    v_mfma_f32_16x16x32_bf16 v[216:219], v[40:43], v[88:91], v[216:219]
    v_mfma_f32_16x16x32_bf16 v[224:227], v[44:47], v[88:91], v[224:227]
    v_mfma_f32_16x16x32_bf16 v[232:235], v[48:51], v[88:91], v[232:235]
    s_waitcnt lgkmcnt(0)
    v_mfma_f32_16x16x32_bf16 v[240:243], v[52:55], v[88:91], v[240:243]
    v_mfma_f32_16x16x32_bf16 v[248:251], v[56:59], v[88:91], v[248:251]
    v_mfma_f32_16x16x32_bf16 v[64:67], v[60:63], v[88:91], v[64:67]
    v_mfma_f32_16x16x32_bf16 v[220:223], v[44:47], v[120:123], v[220:223]
    ds_read_b128 v[44:47], v19 offset:36864
    v_mfma_f32_16x16x32_bf16 v[228:231], v[48:51], v[120:123], v[228:231]
    ds_read_b128 v[48:51], v22 offset:36864
    v_mfma_f32_16x16x32_bf16 v[236:239], v[52:55], v[120:123], v[236:239]
    ds_read_b128 v[52:55], v22 offset:37120
    v_mfma_f32_16x16x32_bf16 v[244:247], v[56:59], v[120:123], v[244:247]
    ds_read_b128 v[56:59], v22 offset:37376
    v_mfma_f32_16x16x32_bf16 v[252:255], v[60:63], v[120:123], v[252:255]
    ds_read_b128 v[60:63], v22 offset:37632
    v_mfma_f32_16x16x32_bf16 v[188:191], v[28:31], v[120:123], v[188:191]
    ds_read_b128 v[28:31], v18 offset:36864
    v_mfma_f32_16x16x32_bf16 v[196:199], v[32:35], v[120:123], v[196:199]
    ds_read_b128 v[32:35], v18 offset:37120
    v_mfma_f32_16x16x32_bf16 v[204:207], v[36:39], v[120:123], v[204:207]
    ds_read_b128 v[36:39], v18 offset:37376
    v_mfma_f32_16x16x32_bf16 v[212:215], v[40:43], v[120:123], v[212:215]
    ds_read_b128 v[40:43], v18 offset:37632
    s_waitcnt lgkmcnt(4)
    v_mfma_f32_16x16x32_bf16 v[220:223], v[44:47], v[92:95], v[220:223]
    ds_read_b128 v[44:47], v19 offset:46080
    v_cvt_pk_bf16_f32 v144, v224, v225
    v_cvt_pk_bf16_f32 v156, v226, v227
    v_mfma_f32_16x16x32_bf16 v[228:231], v[48:51], v[92:95], v[228:231]
    ds_read_b128 v[48:51], v22 offset:46080
    v_permlane32_swap_b32 v144, v156
    s_nop 1
    v_mov_b32_dpp v157, v156 quad_perm:[1,1,1,1] row_mask:0xf bank_mask:0xf
    v_mfma_f32_16x16x32_bf16 v[236:239], v[52:55], v[92:95], v[236:239]
    ds_read_b128 v[52:55], v22 offset:46336
    v_mov_b32_dpp v158, v156 quad_perm:[2,2,2,2] row_mask:0xf bank_mask:0xf
    v_mov_b32_dpp v159, v156 quad_perm:[3,3,3,3] row_mask:0xf bank_mask:0xf
    v_mfma_f32_16x16x32_bf16 v[244:247], v[56:59], v[92:95], v[244:247]
    ds_read_b128 v[56:59], v22 offset:46592
    v_cvt_pk_bf16_f32 v148, v232, v233
    v_cvt_pk_bf16_f32 v149, v234, v235
    v_mfma_f32_16x16x32_bf16 v[252:255], v[60:63], v[92:95], v[252:255]
    ds_read_b128 v[60:63], v22 offset:46848
    v_cvt_pk_bf16_f32 v150, v240, v241
    v_cvt_pk_bf16_f32 v151, v242, v243
    s_waitcnt lgkmcnt(0)
    v_mfma_f32_16x16x32_bf16 v[220:223], v[44:47], v[96:99], v[220:223]
    ds_read_b128 v[44:47], v19 offset:55296
    buffer_store_dwordx4 v[148:151], v9, s[36:39], s67 offen offset:0 sc1
    v_cvt_pk_bf16_f32 v152, v248, v249
    v_mfma_f32_16x16x32_bf16 v[228:231], v[48:51], v[96:99], v[228:231]
    ds_read_b128 v[48:51], v22 offset:55296
    v_cvt_pk_bf16_f32 v153, v250, v251
    v_cvt_pk_bf16_f32 v154, v64, v65
    v_mfma_f32_16x16x32_bf16 v[236:239], v[52:55], v[96:99], v[236:239]
    ds_read_b128 v[52:55], v22 offset:55552
    v_cvt_pk_bf16_f32 v155, v66, v67
    buffer_store_dwordx4 v[152:155], v9, s[36:39], s67 offen offset:1024 sc1
    v_mfma_f32_16x16x32_bf16 v[244:247], v[56:59], v[96:99], v[244:247]
    ds_read_b128 v[56:59], v22 offset:55808
    buffer_store_dwordx4 v[156:159], v26, s[36:39], s67 offen offset:2048 sc1
    v_mov_b32_dpp v145, v144 quad_perm:[1,1,1,1] row_mask:0xf bank_mask:0xf
    v_mfma_f32_16x16x32_bf16 v[252:255], v[60:63], v[96:99], v[252:255]
    ds_read_b128 v[60:63], v22 offset:56064
    v_mov_b32_dpp v146, v144 quad_perm:[2,2,2,2] row_mask:0xf bank_mask:0xf
    v_mov_b32_dpp v147, v144 quad_perm:[3,3,3,3] row_mask:0xf bank_mask:0xf
    s_waitcnt lgkmcnt(0)
    v_mfma_f32_16x16x32_bf16 v[220:223], v[44:47], v[100:103], v[220:223]
    ds_read_b128 v[44:47], v19 offset:64512
    v_cvt_pk_bf16_f32 v136, v192, v193
    v_cvt_pk_bf16_f32 v137, v194, v195
    v_mfma_f32_16x16x32_bf16 v[228:231], v[48:51], v[100:103], v[228:231]
    ds_read_b128 v[48:51], v22 offset:64512
    v_cvt_pk_bf16_f32 v138, v200, v201
    v_cvt_pk_bf16_f32 v139, v202, v203
    v_mfma_f32_16x16x32_bf16 v[236:239], v[52:55], v[100:103], v[236:239]
    ds_read_b128 v[52:55], v22 offset:64768
    buffer_store_dwordx4 v[136:139], v9, s[36:39], s66 offen offset:0 sc1
    v_cvt_pk_bf16_f32 v140, v208, v209
    v_mfma_f32_16x16x32_bf16 v[244:247], v[56:59], v[100:103], v[244:247]
    ds_read_b128 v[56:59], v22 offset:65024
    v_cvt_pk_bf16_f32 v141, v210, v211
    v_cvt_pk_bf16_f32 v142, v216, v217
    v_mfma_f32_16x16x32_bf16 v[252:255], v[60:63], v[100:103], v[252:255]
    ds_read_b128 v[60:63], v22 offset:65280
    v_cvt_pk_bf16_f32 v143, v218, v219
    buffer_store_dwordx4 v[140:143], v9, s[36:39], s66 offen offset:1024 sc1
    s_waitcnt lgkmcnt(0)
    v_mfma_f32_16x16x32_bf16 v[220:223], v[44:47], v[104:107], v[220:223]
    ds_read_b128 v[44:47], v19 offset:0
    buffer_store_dwordx4 v[144:147], v26, s[36:39], s66 offen offset:2048 sc1
    v_mfma_f32_16x16x32_bf16 v[228:231], v[48:51], v[104:107], v[228:231]
    ds_read_b128 v[48:51], v22 offset:0
    v_mfma_f32_16x16x32_bf16 v[236:239], v[52:55], v[104:107], v[236:239]
    ds_read_b128 v[52:55], v22 offset:256
    v_mfma_f32_16x16x32_bf16 v[244:247], v[56:59], v[104:107], v[244:247]
    ds_read_b128 v[56:59], v22 offset:512
    v_mfma_f32_16x16x32_bf16 v[252:255], v[60:63], v[104:107], v[252:255]
    ds_read_b128 v[60:63], v22 offset:768
    s_waitcnt lgkmcnt(0)
    v_mfma_f32_16x16x32_bf16 v[220:223], v[44:47], v[108:111], v[220:223]
    ds_read_b128 v[44:47], v19 offset:9216
    v_mfma_f32_16x16x32_bf16 v[228:231], v[48:51], v[108:111], v[228:231]
    ds_read_b128 v[48:51], v22 offset:9216
    v_mfma_f32_16x16x32_bf16 v[236:239], v[52:55], v[108:111], v[236:239]
    ds_read_b128 v[52:55], v22 offset:9472
    v_mfma_f32_16x16x32_bf16 v[244:247], v[56:59], v[108:111], v[244:247]
    ds_read_b128 v[56:59], v22 offset:9728
    v_mfma_f32_16x16x32_bf16 v[252:255], v[60:63], v[108:111], v[252:255]
    ds_read_b128 v[60:63], v22 offset:9984
    s_waitcnt lgkmcnt(0)
    v_mfma_f32_16x16x32_bf16 v[220:223], v[44:47], v[112:115], v[220:223]
    ds_read_b128 v[44:47], v19 offset:18432
    v_mfma_f32_16x16x32_bf16 v[228:231], v[48:51], v[112:115], v[228:231]
    ds_read_b128 v[48:51], v22 offset:18432
    v_mfma_f32_16x16x32_bf16 v[236:239], v[52:55], v[112:115], v[236:239]
    ds_read_b128 v[52:55], v22 offset:18688
    v_mfma_f32_16x16x32_bf16 v[244:247], v[56:59], v[112:115], v[244:247]
    ds_read_b128 v[56:59], v22 offset:18944
    v_mfma_f32_16x16x32_bf16 v[252:255], v[60:63], v[112:115], v[252:255]
    ds_read_b128 v[60:63], v22 offset:19200
    s_waitcnt lgkmcnt(0)
    v_mfma_f32_16x16x32_bf16 v[220:223], v[44:47], v[116:119], v[220:223]
    v_mfma_f32_16x16x32_bf16 v[228:231], v[48:51], v[116:119], v[228:231]
    v_mfma_f32_16x16x32_bf16 v[236:239], v[52:55], v[116:119], v[236:239]
    v_mfma_f32_16x16x32_bf16 v[244:247], v[56:59], v[116:119], v[244:247]
    v_mfma_f32_16x16x32_bf16 v[252:255], v[60:63], v[116:119], v[252:255]
    v_mfma_f32_16x16x32_bf16 v[188:191], v[28:31], v[92:95], v[188:191]
    ds_read_b128 v[28:31], v18 offset:46080
    v_mfma_f32_16x16x32_bf16 v[196:199], v[32:35], v[92:95], v[196:199]
    ds_read_b128 v[32:35], v18 offset:46336
    v_mfma_f32_16x16x32_bf16 v[204:207], v[36:39], v[92:95], v[204:207]
    ds_read_b128 v[36:39], v18 offset:46592
    v_mfma_f32_16x16x32_bf16 v[212:215], v[40:43], v[92:95], v[212:215]
    ds_read_b128 v[40:43], v18 offset:46848
    s_waitcnt lgkmcnt(0)
    v_mfma_f32_16x16x32_bf16 v[188:191], v[28:31], v[96:99], v[188:191]
    ds_read_b128 v[28:31], v18 offset:55296
    v_cvt_pk_bf16_f32 v13, v220, v221
    v_cvt_pk_bf16_f32 v132, v222, v223
    v_mfma_f32_16x16x32_bf16 v[196:199], v[32:35], v[96:99], v[196:199]
    ds_read_b128 v[32:35], v18 offset:55552
    v_permlane32_swap_b32 v13, v132
    s_nop 1
    v_mov_b32_dpp v133, v132 quad_perm:[1,1,1,1] row_mask:0xf bank_mask:0xf
    v_mfma_f32_16x16x32_bf16 v[204:207], v[36:39], v[96:99], v[204:207]
    ds_read_b128 v[36:39], v18 offset:55808
    v_mov_b32_dpp v134, v132 quad_perm:[2,2,2,2] row_mask:0xf bank_mask:0xf
    v_mov_b32_dpp v135, v132 quad_perm:[3,3,3,3] row_mask:0xf bank_mask:0xf
    v_mfma_f32_16x16x32_bf16 v[212:215], v[40:43], v[96:99], v[212:215]
    ds_read_b128 v[40:43], v18 offset:56064
    v_cvt_pk_bf16_f32 v124, v228, v229
    v_cvt_pk_bf16_f32 v125, v230, v231
    s_waitcnt lgkmcnt(0)
    v_mfma_f32_16x16x32_bf16 v[188:191], v[28:31], v[100:103], v[188:191]
    ds_read_b128 v[28:31], v18 offset:64512
    v_cvt_pk_bf16_f32 v126, v236, v237
    v_cvt_pk_bf16_f32 v127, v238, v239
    v_mfma_f32_16x16x32_bf16 v[196:199], v[32:35], v[100:103], v[196:199]
    ds_read_b128 v[32:35], v18 offset:64768
    buffer_store_dwordx4 v[124:127], v9, s[36:39], s65 offen offset:0 sc1
    v_cvt_pk_bf16_f32 v128, v244, v245
    v_mfma_f32_16x16x32_bf16 v[204:207], v[36:39], v[100:103], v[204:207]
    ds_read_b128 v[36:39], v18 offset:65024
    v_cvt_pk_bf16_f32 v129, v246, v247
    v_cvt_pk_bf16_f32 v130, v252, v253
    v_mfma_f32_16x16x32_bf16 v[212:215], v[40:43], v[100:103], v[212:215]
    ds_read_b128 v[40:43], v18 offset:65280
    v_cvt_pk_bf16_f32 v131, v254, v255
    buffer_store_dwordx4 v[128:131], v9, s[36:39], s65 offen offset:1024 sc1
    s_waitcnt lgkmcnt(0)
    v_mfma_f32_16x16x32_bf16 v[188:191], v[28:31], v[104:107], v[188:191]
    ds_read_b128 v[28:31], v18 offset:0
    buffer_store_dwordx4 v[132:135], v26, s[36:39], s65 offen offset:2048 sc1
    v_lshrrev_b32 v10, 2, v1
    v_mfma_f32_16x16x32_bf16 v[196:199], v[32:35], v[104:107], v[196:199]
    ds_read_b128 v[32:35], v18 offset:256
    v_and_b32 v11, 1, v1
    v_lshlrev_b32 v11, 4, v11
    v_mfma_f32_16x16x32_bf16 v[204:207], v[36:39], v[104:107], v[204:207]
    ds_read_b128 v[36:39], v18 offset:512
    v_mov_b32 v12, 0x3f80
    v_lshlrev_b32 v11, v11, v12
    v_mfma_f32_16x16x32_bf16 v[212:215], v[40:43], v[104:107], v[212:215]
    ds_read_b128 v[40:43], v18 offset:768
    v_and_b32 v12, 2, v1
    v_add_u32 v13, v10, v12
    s_waitcnt lgkmcnt(0)
    v_mfma_f32_16x16x32_bf16 v[188:191], v[28:31], v[108:111], v[188:191]
    ds_read_b128 v[28:31], v18 offset:9216
    v_cmp_eq_u32 vcc, v10, v2
    s_nop 1
    v_cndmask_b32 v80, 0, v11, vcc
    v_mfma_f32_16x16x32_bf16 v[196:199], v[32:35], v[108:111], v[196:199]
    ds_read_b128 v[32:35], v18 offset:9472
    v_cmp_eq_u32 vcc, v13, v2
    s_nop 1
    v_cndmask_b32 v76, 0, v11, vcc
    v_mfma_f32_16x16x32_bf16 v[204:207], v[36:39], v[108:111], v[204:207]
    ds_read_b128 v[36:39], v18 offset:9728
    v_cmp_gt_u32 vcc, 8, v1
    s_nop 1
    v_cndmask_b32 v76, 0, v76, vcc
    v_mfma_f32_16x16x32_bf16 v[212:215], v[40:43], v[108:111], v[212:215]
    ds_read_b128 v[40:43], v18 offset:9984
    v_cmp_eq_u32 vcc, 0, v12
    s_nop 1
    v_cndmask_b32 v81, v80, 0, vcc
    s_waitcnt lgkmcnt(0)
    v_mfma_f32_16x16x32_bf16 v[188:191], v[28:31], v[112:115], v[188:191]
    ds_read_b128 v[28:31], v18 offset:18432
    v_cndmask_b32 v80, 0, v80, vcc
    v_mov_b32 v77, v76
    v_mfma_f32_16x16x32_bf16 v[196:199], v[32:35], v[112:115], v[196:199]
    ds_read_b128 v[32:35], v18 offset:18688
    v_mov_b64 v[78:79], 0
    v_mov_b64 v[82:83], 0
    s_nop 0
    v_mfma_f32_16x16x32_bf16 v[204:207], v[36:39], v[112:115], v[204:207]
    ds_read_b128 v[36:39], v18 offset:18944
    v_mfma_f32_16x16x32_bf16 v[212:215], v[40:43], v[112:115], v[212:215]
    ds_read_b128 v[40:43], v18 offset:19200
    s_waitcnt lgkmcnt(0)
    v_mfma_f32_16x16x32_bf16 v[188:191], v[28:31], v[116:119], v[188:191]
    v_mfma_f32_16x16x32_bf16 v[196:199], v[32:35], v[116:119], v[196:199]
    v_mfma_f32_16x16x32_bf16 v[204:207], v[36:39], v[116:119], v[204:207]
    v_mfma_f32_16x16x32_bf16 v[212:215], v[40:43], v[116:119], v[212:215]
    s_barrier
    ds_read_b64 v[28:29], v4 offset:0
    ds_read_b128 v[160:163], v6 offset:0
    ds_read_b64 v[30:31], v4 offset:32
    ds_read_b128 v[164:167], v6 offset:64
    ds_read_b64 v[32:33], v4 offset:64
    ds_read_b128 v[168:171], v6 offset:128
    ds_read_b64 v[34:35], v4 offset:96
    ds_read_b128 v[172:175], v6 offset:192
    ds_read_b64 v[36:37], v5
    ds_read_b128 v[176:179], v23
    s_mul_i32 s49, s3, 4608
    s_add_u32 s49, s49, 49152
    v_add_u32 v73, s49, v27
    s_waitcnt lgkmcnt(9)
    v_lshlrev_b32 v44, 16, v28
    v_and_b32 v45, 0xffff0000, v28
    v_lshlrev_b32 v46, 16, v29
    v_and_b32 v47, 0xffff0000, v29
    s_waitcnt lgkmcnt(7)
    v_lshlrev_b32 v48, 16, v30
    v_and_b32 v49, 0xffff0000, v30
    v_lshlrev_b32 v50, 16, v31
    v_and_b32 v51, 0xffff0000, v31
    s_waitcnt lgkmcnt(5)
    v_lshlrev_b32 v52, 16, v32
    s_branch L_skip_10
L_stub_10:
    s_branch L_back_c3
L_skip_10:
    v_and_b32 v53, 0xffff0000, v32
    v_lshlrev_b32 v54, 16, v33
    v_and_b32 v55, 0xffff0000, v33
    s_waitcnt lgkmcnt(3)
    v_lshlrev_b32 v56, 16, v34
    v_and_b32 v57, 0xffff0000, v34
    v_lshlrev_b32 v58, 16, v35
    v_and_b32 v59, 0xffff0000, v35
    s_waitcnt lgkmcnt(1)
    v_lshlrev_b32 v60, 16, v36
    v_and_b32 v61, 0xffff0000, v36
    v_lshlrev_b32 v62, 16, v37
    v_and_b32 v63, 0xffff0000, v37
    s_waitcnt vmcnt(0)
    v_mov_b32 v133, 0
    v_mov_b64 v[134:135], 0
    v_mov_b64 v[146:147], 0
    buffer_load_dwordx4 v[124:127], v9, s[36:39], s64 offen offset:0 sc1
    buffer_load_dwordx4 v[128:131], v9, s[36:39], s64 offen offset:1024 sc1
    buffer_load_dword v132, v27, s[36:39], s64 offen offset:2048 sc1
    s_barrier
    ds_read_b128 v[136:139], v71 offset:0
    ds_read_b128 v[140:143], v71 offset:1024
    ds_read_b128 v[148:151], v71 offset:2304
    ds_read_b128 v[152:155], v71 offset:3328
    ds_read_b32 v144, v73 offset:2048
    ds_read_b32 v145, v73 offset:4352
    s_waitcnt lgkmcnt(5)
    v_mfma_f32_16x16x32_bf16 v[188:191], v[80:83], v[136:139], v[188:191]
    v_mfma_f32_16x16x32_bf16 v[196:199], v[78:81], v[136:139], v[196:199]
    s_waitcnt lgkmcnt(4)
    v_mfma_f32_16x16x32_bf16 v[204:207], v[80:83], v[140:143], v[204:207]
    v_mfma_f32_16x16x32_bf16 v[212:215], v[78:81], v[140:143], v[212:215]
    s_waitcnt lgkmcnt(3)
    v_mfma_f32_16x16x32_bf16 v[188:191], v[80:83], v[148:151], v[188:191]
    v_mfma_f32_16x16x32_bf16 v[196:199], v[78:81], v[148:151], v[196:199]
    s_waitcnt lgkmcnt(2)
    v_mfma_f32_16x16x32_bf16 v[204:207], v[80:83], v[152:155], v[204:207]
    v_mfma_f32_16x16x32_bf16 v[212:215], v[78:81], v[152:155], v[212:215]
    s_waitcnt lgkmcnt(0)
    v_mfma_f32_16x16x32_bf16 v[220:223], v[76:79], v[144:147], v[220:223]
    s_waitcnt vmcnt(0)
    v_max3_u32 v10, v124, v128, v132
    v_cmp_eq_u32 vcc, -1, v10
    s_nop 0
    s_cbranch_vccz L_m_27
Lp_m_28:
    buffer_load_dwordx4 v[124:127], v9, s[36:39], s64 offen offset:0 sc1
    buffer_load_dwordx4 v[128:131], v9, s[36:39], s64 offen offset:1024 sc1
    buffer_load_dword v132, v27, s[36:39], s64 offen offset:2048 sc1
    s_waitcnt vmcnt(0)
    v_max3_u32 v10, v124, v128, v132
    v_cmp_eq_u32 vcc, -1, v10
    s_nop 0
    s_cbranch_vccz Le_m_29
    s_sub_u32 s7, s7, 1
    s_cbranch_scc1 Le_m_29
    s_mov_b64 exec, vcc
    s_sleep 1
    s_branch Lp_m_28
Le_m_29:
    s_mov_b64 exec, -1
    s_max_i32 s7, s7, 0
L_m_27:
    v_mfma_f32_16x16x32_bf16 v[188:191], v[80:83], v[124:127], v[188:191]
    v_mfma_f32_16x16x32_bf16 v[196:199], v[78:81], v[124:127], v[196:199]
    v_mfma_f32_16x16x32_bf16 v[204:207], v[80:83], v[128:131], v[204:207]
    v_mfma_f32_16x16x32_bf16 v[212:215], v[78:81], v[128:131], v[212:215]
    v_mfma_f32_16x16x32_bf16 v[220:223], v[76:79], v[132:135], v[220:223]
    s_nop 3
    v_pk_fma_f32 v[44:45], v[188:189], v[160:161], v[44:45]
    v_pk_fma_f32 v[46:47], v[190:191], v[162:163], v[46:47]
    v_cvt_pk_bf16_f32 v28, v44, v45
    v_cvt_pk_bf16_f32 v29, v46, v47
    ds_write_b64 v4, v[28:29] offset:0
    v_pk_fma_f32 v[48:49], v[196:197], v[164:165], v[48:49]
    v_pk_fma_f32 v[50:51], v[198:199], v[166:167], v[50:51]
    v_cvt_pk_bf16_f32 v30, v48, v49
    v_cvt_pk_bf16_f32 v31, v50, v51
    ds_write_b64 v4, v[30:31] offset:32
    v_pk_fma_f32 v[52:53], v[204:205], v[168:169], v[52:53]
    v_pk_fma_f32 v[54:55], v[206:207], v[170:171], v[54:55]
    v_cvt_pk_bf16_f32 v32, v52, v53
    v_cvt_pk_bf16_f32 v33, v54, v55
    ds_write_b64 v4, v[32:33] offset:64
    v_pk_fma_f32 v[56:57], v[212:213], v[172:173], v[56:57]
    v_pk_fma_f32 v[58:59], v[214:215], v[174:175], v[58:59]
    v_cvt_pk_bf16_f32 v34, v56, v57
    v_cvt_pk_bf16_f32 v35, v58, v59
    ds_write_b64 v4, v[34:35] offset:96
    v_pk_fma_f32 v[60:61], v[220:221], v[176:177], v[60:61]
    v_pk_fma_f32 v[62:63], v[222:223], v[178:179], v[62:63]
    v_cvt_pk_bf16_f32 v36, v60, v61
    v_cvt_pk_bf16_f32 v37, v62, v63
    ds_write_b64 v5, v[36:37]
    ds_read_b128 v[160:163], v7 offset:0
    ds_read_b128 v[164:167], v7 offset:1024
    ds_read_b128 v[168:171], v7 offset:2048
    s_waitcnt lgkmcnt(2)
    buffer_store_dwordx4 v[160:163], v68, s[44:47], s62 offen sc1
    s_waitcnt lgkmcnt(1)
    buffer_store_dwordx4 v[164:167], v69, s[44:47], s62 offen sc1
    s_waitcnt lgkmcnt(0)
    buffer_store_dwordx4 v[168:171], v70, s[44:47], s62 offen sc1
    s_branch L_end
L_m_30:
    s_sub_u32 s61, s63, 54
    s_lshr_b32 s62, s61, 1
    s_add_u32 s62, s62, 18
    s_and_b32 s61, s61, 1
    s_cmp_ge_u32 s5, 16
    s_cbranch_scc1 L_m_35
    s_lshl_b32 s67, s4, 4
    s_add_u32 s67, s67, s5
    s_and_b32 s67, s67, 127
    s_lshl_b32 s48, s3, 9
    s_add_u32 s48, s48, s67
    s_mul_i32 s69, s3, 6144
    s_add_u32 s69, s69, 36864
    s_cmp_eq_u32 s67, 0
    s_cselect_b32 s68, 38, 0
    s_add_u32 s68, s68, 152
    v_mov_b32 v8, 2146435072
    v_add_u32 v4, 0, v0
    v_mul_u32_u24 v5, 1725, v4
    v_lshrrev_b32 v5, 16, v5
    v_mul_u32_u24 v6, 38, v5
    v_sub_u32 v6, v4, v6
    v_cmp_gt_u32 vcc, s68, v4
    v_lshl_add_u32 v5, v5, 7, s48
    v_and_b32 v5, 2047, v5
    v_mul_u32_u24 v5, 578, v5
    v_and_b32 v5, 0xfffffff0, v5
    v_lshl_add_u32 v5, v6, 4, v5
    v_cndmask_b32 v20, v8, v5, vcc
    v_add_u32 v4, 64, v0
    v_mul_u32_u24 v5, 1725, v4
    v_lshrrev_b32 v5, 16, v5
    v_mul_u32_u24 v6, 38, v5
    v_sub_u32 v6, v4, v6
    v_cmp_gt_u32 vcc, s68, v4
    v_lshl_add_u32 v5, v5, 7, s48
    v_and_b32 v5, 2047, v5
    v_mul_u32_u24 v5, 578, v5
    v_and_b32 v5, 0xfffffff0, v5
    v_lshl_add_u32 v5, v6, 4, v5
    v_cndmask_b32 v21, v8, v5, vcc
    v_add_u32 v4, 128, v0
    v_mul_u32_u24 v5, 1725, v4
    v_lshrrev_b32 v5, 16, v5
    v_mul_u32_u24 v6, 38, v5
    v_sub_u32 v6, v4, v6
    v_cmp_gt_u32 vcc, s68, v4
    v_lshl_add_u32 v5, v5, 7, s48
    v_and_b32 v5, 2047, v5
    v_mul_u32_u24 v5, 578, v5
    v_and_b32 v5, 0xfffffff0, v5
    v_lshl_add_u32 v5, v6, 4, v5
    v_cndmask_b32 v22, v8, v5, vcc
    s_waitcnt lgkmcnt(0)
    s_mov_b32 s36, s32
    s_mov_b32 s37, s33
    s_mov_b32 s38, 50331648
    s_mov_b32 s39, 0x20000
    s_mov_b32 s40, s26
    s_mov_b32 s41, s27
    s_mov_b32 s42, 3981312
    s_mov_b32 s43, 0x20000
    v_mov_b32 v4, 32768
    buffer_load_dword v3, v4, s[36:39], 0 offen sc1
    s_lshr_b32 s51, s5, 2
    s_lshl_b32 s51, s51, 3
    s_add_u32 s51, s51, s4
    s_and_b32 s60, s5, 3
    s_lshl_b32 s35, s51, 2
    s_add_u32 s35, s35, s60
    s_lshl_b32 s35, s35, 14
    s_bfe_u32 s48, s6, 0x20002
    s_lshl_b32 s48, s48, 6
    s_lshr_b32 s49, s6, 4
    s_lshl_b32 s49, s49, 2
    s_add_u32 s48, s48, s49
    s_and_b32 s49, s6, 3
    s_add_u32 s48, s48, s49
    s_lshl_b32 s48, s48, 4
    s_lshl_b32 s49, s3, 16
    s_add_u32 s48, s48, s49
    s_add_u32 s48, s48, 15728640
    v_mov_b32 v17, 2146435072
    v_writelane_b32 v17, s48, 0
    s_add_u32 s48, s48, 16384
    s_add_u32 s48, s2, 160
    s_lshl_b32 s48, s48, 7
    s_add_u32 s48, s48, 557056
    s_lshl_b32 s49, s3, 8
    s_add_u32 s49, s49, s5
    s_cmp_lt_u32 s49, 12
    s_cselect_b32 s48, s48, 2146435072
    v_mov_b32 v19, 2146435072
    v_writelane_b32 v19, s48, 0
    s_or_b32 s48, s2, s3
    s_cmp_eq_u32 s48, 0
    s_cselect_b32 s48, 0, 2146435072
    s_add_u32 s48, s48, 32768
    v_writelane_b32 v19, s48, 1
    buffer_load_dword v220, v17, s[36:39], 0 offen
    buffer_load_dword v221, v19, s[36:39], 0 offen
    v_cvt_f32_u32 v218, v2
    v_mul_f32 v218, 4.0, v218
    v_cvt_f32_u32 v219, v1
    v_cvt_f32_u32 v13, s4
    v_mul_f32 v10, 0x3d800000, v219
    v_fmac_f32 v10, 0x3c000000, v13
    v_mul_f32 v11, v218, v10
    v_cos_f32 v5, v11
    v_sin_f32 v6, v11
    s_nop 0
    v_cvt_pk_bf16_f32 v52, v5, v6
    v_cvt_pk_bf16_f32 v56, -v6, v5
    v_fma_f32 v7, v10, 1.0, v11
    v_cos_f32 v8, v7
    v_sin_f32 v9, v7
    s_nop 0
    v_cvt_pk_bf16_f32 v53, v8, v9
    v_cvt_pk_bf16_f32 v57, -v9, v8
    v_fma_f32 v4, v10, 2.0, v11
    v_cos_f32 v5, v4
    v_sin_f32 v6, v4
    s_nop 0
    v_cvt_pk_bf16_f32 v54, v5, v6
    v_cvt_pk_bf16_f32 v58, -v6, v5
    v_add_f32 v7, v4, v10
    v_cos_f32 v8, v7
    v_sin_f32 v9, v7
    s_nop 0
    v_cvt_pk_bf16_f32 v55, v8, v9
    v_cvt_pk_bf16_f32 v59, -v9, v8
    s_lshl_b32 s48, s3, 5
    s_add_u32 s48, s48, s4
    v_cvt_f32_u32 v14, s48
    v_mul_f32 v14, 0x3a000000, v14
    v_mul_f32 v10, 0x3d800000, v219
    v_add_f32 v10, v10, v14
    v_mul_f32 v11, v218, v10
    v_cos_f32 v5, v11
    v_sin_f32 v6, v11
    s_nop 0
    v_cvt_pk_bf16_f32 v68, v5, v6
    v_cvt_pk_bf16_f32 v72, -v6, v5
    v_fma_f32 v7, v10, 1.0, v11
    v_cos_f32 v8, v7
    v_sin_f32 v9, v7
    s_nop 0
    v_cvt_pk_bf16_f32 v69, v8, v9
    v_cvt_pk_bf16_f32 v73, -v9, v8
    v_fma_f32 v4, v10, 2.0, v11
    v_cos_f32 v5, v4
    v_sin_f32 v6, v4
    s_nop 0
    v_cvt_pk_bf16_f32 v70, v5, v6
    v_cvt_pk_bf16_f32 v74, -v6, v5
    v_add_f32 v7, v4, v10
    v_cos_f32 v8, v7
    v_sin_f32 v9, v7
    s_nop 0
    v_cvt_pk_bf16_f32 v71, v8, v9
    v_cvt_pk_bf16_f32 v75, -v9, v8
    v_add_f32 v10, 0x3b800000, v10
    v_mul_f32 v11, v218, v10
    v_cos_f32 v5, v11
    v_sin_f32 v6, v11
    s_nop 0
    v_cvt_pk_bf16_f32 v76, v5, v6
    v_cvt_pk_bf16_f32 v80, -v6, v5
    v_fma_f32 v7, v10, 1.0, v11
    v_cos_f32 v8, v7
    v_sin_f32 v9, v7
    s_nop 0
    v_cvt_pk_bf16_f32 v77, v8, v9
    v_cvt_pk_bf16_f32 v81, -v9, v8
    v_fma_f32 v4, v10, 2.0, v11
    v_cos_f32 v5, v4
    v_sin_f32 v6, v4
    s_nop 0
    v_cvt_pk_bf16_f32 v78, v5, v6
    v_cvt_pk_bf16_f32 v82, -v6, v5
    v_add_f32 v7, v4, v10
    v_cos_f32 v8, v7
    v_sin_f32 v9, v7
    s_nop 0
    v_cvt_pk_bf16_f32 v79, v8, v9
    v_cvt_pk_bf16_f32 v83, -v9, v8
    v_add_f32 v10, 0x3b800000, v10
    v_mul_f32 v11, v218, v10
    v_cos_f32 v5, v11
    v_sin_f32 v6, v11
    s_nop 0
    v_cvt_pk_bf16_f32 v84, v5, v6
    v_cvt_pk_bf16_f32 v88, -v6, v5
    v_fma_f32 v7, v10, 1.0, v11
    v_cos_f32 v8, v7
    v_sin_f32 v9, v7
    s_nop 0
    v_cvt_pk_bf16_f32 v85, v8, v9
    v_cvt_pk_bf16_f32 v89, -v9, v8
    v_fma_f32 v4, v10, 2.0, v11
    v_cos_f32 v5, v4
    v_sin_f32 v6, v4
    s_nop 0
    v_cvt_pk_bf16_f32 v86, v5, v6
    v_cvt_pk_bf16_f32 v90, -v6, v5
    v_add_f32 v7, v4, v10
    v_cos_f32 v8, v7
    v_sin_f32 v9, v7
    s_nop 0
    v_cvt_pk_bf16_f32 v87, v8, v9
    v_cvt_pk_bf16_f32 v91, -v9, v8
    v_add_f32 v10, 0x3b800000, v10
    v_mul_f32 v11, v218, v10
    v_cos_f32 v5, v11
    v_sin_f32 v6, v11
    s_nop 0
    v_cvt_pk_bf16_f32 v92, v5, v6
    v_cvt_pk_bf16_f32 v96, -v6, v5
    v_fma_f32 v7, v10, 1.0, v11
    v_cos_f32 v8, v7
    v_sin_f32 v9, v7
    s_nop 0
    v_cvt_pk_bf16_f32 v93, v8, v9
    v_cvt_pk_bf16_f32 v97, -v9, v8
    v_fma_f32 v4, v10, 2.0, v11
    v_cos_f32 v5, v4
    v_sin_f32 v6, v4
    s_nop 0
    v_cvt_pk_bf16_f32 v94, v5, v6
    v_cvt_pk_bf16_f32 v98, -v6, v5
    v_add_f32 v7, v4, v10
    v_cos_f32 v8, v7
    v_sin_f32 v9, v7
    s_nop 0
    v_cvt_pk_bf16_f32 v95, v8, v9
    v_cvt_pk_bf16_f32 v99, -v9, v8
    s_barrier
    s_mov_b32 s52, s10
    s_mov_b32 s53, s11
    s_mov_b32 s54, 1183744
    s_mov_b32 s55, 0x20000
    s_mov_b32 s56, s12
    s_mov_b32 s57, s13
    s_mov_b32 s58, 1183744
    s_mov_b32 s59, 0x20000
    s_add_u32 m0, s69, 0
    s_nop 0
    buffer_load_dwordx4 v20, s[52:55], 0 offen lds
    s_add_u32 m0, s69, 1024
    s_nop 0
    buffer_load_dwordx4 v21, s[52:55], 0 offen lds
    s_add_u32 m0, s69, 2048
    s_nop 0
    buffer_load_dwordx4 v22, s[52:55], 0 offen lds
    s_add_u32 m0, s69, 3072
    s_nop 0
    buffer_load_dwordx4 v20, s[56:59], 0 offen lds
    s_add_u32 m0, s69, 4096
    s_nop 0
    buffer_load_dwordx4 v21, s[56:59], 0 offen lds
    s_add_u32 m0, s69, 5120
    s_nop 0
    buffer_load_dwordx4 v22, s[56:59], 0 offen lds
    s_lshl_b32 s48, s67, 1
    s_and_b32 s48, s48, 15
    s_add_u32 s48, s48, s69
    v_and_b32 v4, 1, v2
    v_lshrrev_b32 v5, 1, v2
    v_mul_u32_u24 v6, 144, v4
    v_mad_u32_u24 v6, v1, 9, v6
    v_add_lshl_u32 v6, v6, v5, 1
    v_add_u32 v20, s48, v6
    s_cmp_eq_u32 s67, 0
    s_cselect_b32 s49, 608, 0
    s_add_u32 s48, s48, s49
    s_add_u32 s48, s48, 568
    v_sub_u32 v21, s48, v6
    v_lshl_add_u32 v4, v5, 5, v4
    v_lshlrev_b32 v4, 14, v4
    v_lshl_add_u32 v23, v1, 4, v4
    v_add_u32 v24, 1048576, v23
    v_add_u32 v25, 2097152, v23
    v_cmp_gt_u32 vcc, 32, v0
    v_mov_b32 v8, 2146435072
    s_nop 0
    v_cndmask_b32 v25, v8, v25, vcc
    s_lshl_b32 s48, s67, 2
    s_add_u32 s48, s48, s3
    s_lshl_b32 s48, s48, 4
    s_add_u32 s48, s48, 262144
    v_writelane_b32 v18, s48, 0
    buffer_load_dword v222, v18, s[36:39], 0 offen
    s_mov_b32 s48, s67
    s_mov_b32 s49, s3
    s_and_b32 s50, s48, 7
    s_lshr_b32 s48, s48, 3
    s_lshl_b32 s58, s50, 16
    s_lshl_b32 s59, s48, 10
    s_add_u32 s58, s58, s59
    s_lshl_b32 s59, s49, 8
    s_add_u32 s58, s58, s59
    s_add_u32 s56, s58, 1048576
    s_sub_u32 s48, 128, s67
    s_and_b32 s48, s48, 127
    s_sub_u32 s49, 3, s3
    s_and_b32 s50, s48, 7
    s_lshr_b32 s48, s48, 3
    s_lshl_b32 s58, s50, 16
    s_lshl_b32 s59, s48, 10
    s_add_u32 s58, s58, s59
    s_lshl_b32 s59, s49, 8
    s_add_u32 s58, s58, s59
    s_add_u32 s57, s58, 1081344
    s_waitcnt vmcnt(0)
    s_mov_b32 s48, 0x9e3779b1
    v_mul_lo_u32 v3, v3, s48
    v_add_u32 v3, 0x7f4a7c15, v3
    v_or_b32 v3, 0x01010101, v3
    ds_read_u16 v132, v20 offset:0
    ds_read_u16 v136, v20 offset:3072
    ds_read_u16 v133, v20 offset:608
    ds_read_u16 v137, v20 offset:3680
    ds_read_u16 v134, v20 offset:1216
    ds_read_u16 v138, v20 offset:4288
    ds_read_u16 v135, v20 offset:1824
    ds_read_u16 v139, v20 offset:4896
    ds_read_u16 v140, v20 offset:4
    ds_read_u16 v144, v20 offset:3076
    ds_read_u16 v141, v20 offset:612
    ds_read_u16 v145, v20 offset:3684
    ds_read_u16 v142, v20 offset:1220
    ds_read_u16 v146, v20 offset:4292
    ds_read_u16 v143, v20 offset:1828
    ds_read_u16 v147, v20 offset:4900
    ds_read_u16 v148, v20 offset:8
    ds_read_u16 v152, v20 offset:3080
    ds_read_u16 v149, v20 offset:616
    ds_read_u16 v153, v20 offset:3688
    ds_read_u16 v150, v20 offset:1224
    ds_read_u16 v154, v20 offset:4296
    ds_read_u16 v151, v20 offset:1832
    ds_read_u16 v155, v20 offset:4904
    ds_read_u16 v156, v21 offset:1832
    ds_read_u16 v160, v21 offset:4904
    ds_read_u16 v157, v21 offset:1224
    ds_read_u16 v161, v21 offset:4296
    ds_read_u16 v158, v21 offset:616
    ds_read_u16 v162, v21 offset:3688
    ds_read_u16 v159, v21 offset:8
    ds_read_u16 v163, v21 offset:3080
    ds_read_u16 v164, v21 offset:1828
    ds_read_u16 v168, v21 offset:4900
    ds_read_u16 v165, v21 offset:1220
    ds_read_u16 v169, v21 offset:4292
    ds_read_u16 v166, v21 offset:612
    ds_read_u16 v170, v21 offset:3684
    ds_read_u16 v167, v21 offset:4
    ds_read_u16 v171, v21 offset:3076
    ds_read_u16 v172, v21 offset:1824
    ds_read_u16 v176, v21 offset:4896
    ds_read_u16 v173, v21 offset:1216
    ds_read_u16 v177, v21 offset:4288
    ds_read_u16 v174, v21 offset:608
    ds_read_u16 v178, v21 offset:3680
    ds_read_u16 v175, v21 offset:0
    ds_read_u16 v179, v21 offset:3072
    s_waitcnt lgkmcnt(14)
    v_lshl_or_b32 v132, v136, 16, v132
    v_lshl_or_b32 v133, v137, 16, v133
    v_lshl_or_b32 v134, v138, 16, v134
    v_lshl_or_b32 v135, v139, 16, v135
    buffer_store_dwordx4 v[132:135], v23, s[36:39], s56 offen sc1
    v_lshl_or_b32 v140, v144, 16, v140
    v_lshl_or_b32 v141, v145, 16, v141
    v_lshl_or_b32 v142, v146, 16, v142
    v_lshl_or_b32 v143, v147, 16, v143
    buffer_store_dwordx4 v[140:143], v24, s[36:39], s56 offen sc1
    v_lshl_or_b32 v148, v152, 16, v148
    v_lshl_or_b32 v149, v153, 16, v149
    v_lshl_or_b32 v150, v154, 16, v150
    v_lshl_or_b32 v151, v155, 16, v151
    buffer_store_dwordx4 v[148:151], v25, s[36:39], s56 offen sc1
    v_lshl_or_b32 v156, v160, 16, v156
    v_lshl_or_b32 v157, v161, 16, v157
    v_lshl_or_b32 v158, v162, 16, v158
    v_lshl_or_b32 v159, v163, 16, v159
    v_xor_b32 v156, 0x80000000, v156
    v_xor_b32 v157, 0x80000000, v157
    v_xor_b32 v158, 0x80000000, v158
    v_xor_b32 v159, 0x80000000, v159
    buffer_store_dwordx4 v[156:159], v23, s[36:39], s57 offen sc1
    v_lshl_or_b32 v164, v168, 16, v164
    s_waitcnt lgkmcnt(12)
    v_lshl_or_b32 v165, v169, 16, v165
    s_waitcnt lgkmcnt(10)
    v_lshl_or_b32 v166, v170, 16, v166
    s_waitcnt lgkmcnt(8)
    v_lshl_or_b32 v167, v171, 16, v167
    v_xor_b32 v164, 0x80000000, v164
    v_xor_b32 v165, 0x80000000, v165
    v_xor_b32 v166, 0x80000000, v166
    v_xor_b32 v167, 0x80000000, v167
    buffer_store_dwordx4 v[164:167], v24, s[36:39], s57 offen sc1
    s_waitcnt lgkmcnt(6)
    v_lshl_or_b32 v172, v176, 16, v172
    s_waitcnt lgkmcnt(4)
    v_lshl_or_b32 v173, v177, 16, v173
    s_waitcnt lgkmcnt(2)
    v_lshl_or_b32 v174, v178, 16, v174
    s_waitcnt lgkmcnt(0)
    v_lshl_or_b32 v175, v179, 16, v175
    v_xor_b32 v172, 0x80000000, v172
    v_xor_b32 v173, 0x80000000, v173
    v_xor_b32 v174, 0x80000000, v174
    v_xor_b32 v175, 0x80000000, v175
    buffer_store_dwordx4 v[172:175], v25, s[36:39], s57 offen sc1
    s_branch L_m_34
L_m_35:
    v_lshrrev_b32 v4, 3, v0
    v_and_b32 v5, 7, v0
    v_and_b32 v6, 6, v4
    v_xor_b32 v5, v5, v6
    v_mul_u32_u24 v4, 6912, v4
    v_lshl_add_u32 v12, v5, 4, v4
    s_lshl_b32 s48, s61, 2
    s_add_u32 s48, s48, s3
    s_mul_i32 s48, s48, 497664
    s_lshl_b32 s49, s62, 7
    s_add_u32 s47, s48, s49
    s_lshl_b32 s50, s3, 8
    v_lshl_add_u32 v27, v0, 2, s50
    s_mul_i32 s49, s61, 576
    v_add_u32 v9, s49, v27
    v_add_u32 v12, s47, v12
    v_lshrrev_b32 v4, 2, v0
    v_bfe_u32 v5, v4, 1, 2
    v_xor_b32 v5, s3, v5
    v_lshlrev_b32 v5, 5, v5
    v_lshlrev_b32 v4, 7, v4
    v_and_b32 v6, 3, v0
    v_lshlrev_b32 v6, 3, v6
    v_add3_u32 v28, v4, v5, v6
    v_lshlrev_b32 v29, 3, v2
    v_add_u32 v29, 90112, v29
    s_mul_i32 s49, s61, 9216
    s_lshl_b32 s50, s62, 8
    s_add_u32 s49, s49, s50
    s_lshl_b32 s50, s3, 6
    s_add_u32 s49, s49, s50
    s_add_u32 s49, s49, 192000
    v_lshl_add_u32 v4, v1, 2, s49
    v_cmp_gt_u32 vcc, 16, v0
    v_mov_b32 v5, 2146435072
    s_nop 0
    v_cndmask_b32 v30, v5, v4, vcc
    s_waitcnt lgkmcnt(0)
    s_mov_b32 s36, s32
    s_mov_b32 s37, s33
    s_mov_b32 s38, 50331648
    s_mov_b32 s39, 0x20000
    s_mov_b32 s40, s26
    s_mov_b32 s41, s27
    s_mov_b32 s42, 3981312
    s_mov_b32 s43, 0x20000
    v_mov_b32 v4, 32768
    buffer_load_dword v3, v4, s[36:39], 0 offen sc1
    s_mov_b32 s44, s24
    s_mov_b32 s45, s25
    s_mov_b32 s46, 1152
    s_mov_b32 s47, 0x20000
    buffer_load_dword v26, v9, s[44:47], 0 offen
    s_lshr_b32 s51, s5, 2
    s_lshl_b32 s51, s51, 3
    s_add_u32 s51, s51, s4
    s_and_b32 s60, s5, 3
    s_lshl_b32 s35, s51, 2
    s_add_u32 s35, s35, s60
    s_lshl_b32 s35, s35, 14
    s_bfe_u32 s48, s6, 0x20002
    s_lshl_b32 s48, s48, 6
    s_lshr_b32 s49, s6, 4
    s_lshl_b32 s49, s49, 2
    s_add_u32 s48, s48, s49
    s_and_b32 s49, s6, 3
    s_add_u32 s48, s48, s49
    s_lshl_b32 s48, s48, 4
    s_lshl_b32 s49, s3, 16
    s_add_u32 s48, s48, s49
    s_add_u32 s48, s48, 15728640
    v_mov_b32 v17, 2146435072
    v_writelane_b32 v17, s48, 0
    s_add_u32 s48, s48, 16384
    s_add_u32 s48, s2, 160
    s_lshl_b32 s48, s48, 7
    s_add_u32 s48, s48, 557056
    s_lshl_b32 s49, s3, 8
    s_add_u32 s49, s49, s5
    s_cmp_lt_u32 s49, 12
    s_cselect_b32 s48, s48, 2146435072
    v_mov_b32 v19, 2146435072
    v_writelane_b32 v19, s48, 0
    s_or_b32 s48, s2, s3
    s_cmp_eq_u32 s48, 0
    s_cselect_b32 s48, 0, 2146435072
    s_add_u32 s48, s48, 32768
    v_writelane_b32 v19, s48, 1
    buffer_load_dword v220, v17, s[36:39], 0 offen
    buffer_load_dword v221, v19, s[36:39], 0 offen
    buffer_load_dword v222, v30, s[36:39], 0 offen
    s_cmp_ge_u32 s63, 126
    s_cbranch_scc1 L_m_37
    s_mul_i32 m0, s3, 9216
    s_mov_b32 s59, 0
    buffer_load_dwordx4 v12, s[40:43], s59 offen lds
    s_add_u32 m0, m0, 1024
    s_add_u32 s59, s59, 55296
    buffer_load_dwordx4 v12, s[40:43], s59 offen lds
    s_add_u32 m0, m0, 1024
    s_add_u32 s59, s59, 55296
L_m_37:
    s_barrier
    s_waitcnt vmcnt(0)
    s_cmp_ge_u32 s63, 126
    s_cbranch_scc1 L_m_38
    buffer_load_dwordx4 v12, s[40:43], s59 offen lds
    s_add_u32 m0, m0, 1024
    s_add_u32 s59, s59, 55296
    buffer_load_dwordx4 v12, s[40:43], s59 offen lds
    s_add_u32 m0, m0, 1024
    s_add_u32 s59, s59, 55296
    buffer_load_dwordx4 v12, s[40:43], s59 offen lds
    s_add_u32 m0, m0, 1024
    s_add_u32 s59, s59, 55296
    buffer_load_dwordx4 v12, s[40:43], s59 offen lds
    s_add_u32 m0, m0, 1024
    s_add_u32 s59, s59, 55296
    buffer_load_dwordx4 v12, s[40:43], s59 offen lds
    s_add_u32 m0, m0, 1024
    s_add_u32 s59, s59, 55296
    buffer_load_dwordx4 v12, s[40:43], s59 offen lds
    s_add_u32 m0, m0, 1024
    s_add_u32 s59, s59, 55296
    buffer_load_dwordx4 v12, s[40:43], s59 offen lds
L_m_38:
    s_mov_b32 s48, 0x9e3779b1
    v_mul_lo_u32 v3, v3, s48
    v_add_u32 v3, 0x7f4a7c15, v3
    v_or_b32 v3, 0x01010101, v3
    v_lshlrev_b32 v4, 16, v26
    v_and_b32 v5, 0xffff0000, v26
    v_mul_f32 v6, 0xbfb8aa3b, v4
    v_mul_f32 v7, 0xbfb8aa3b, v5
    v_exp_f32 v6, v6
    v_exp_f32 v7, v7
    v_add_f32 v6, 1.0, v6
    v_add_f32 v7, 1.0, v7
    v_rcp_f32 v6, v6
    v_rcp_f32 v7, v7
    v_mul_f32 v4, v4, v6
    v_mul_f32 v5, v5, v7
    v_cvt_pk_bf16_f32 v26, v4, v5
    v_add_u32 v27, 90112, v27
    ds_write_b32 v27, v26
    s_cmp_ge_u32 s5, 20
    s_cbranch_scc1 L_m_39
    v_cvt_f32_u32 v218, v2
    v_mul_f32 v218, 4.0, v218
    v_cvt_f32_u32 v219, v1
    v_cvt_f32_u32 v13, s4
    v_mul_f32 v10, 0x3d800000, v219
    v_fmac_f32 v10, 0x3c000000, v13
    v_mul_f32 v11, v218, v10
    v_cos_f32 v5, v11
    v_sin_f32 v6, v11
    s_nop 0
    v_cvt_pk_bf16_f32 v52, v5, v6
    v_cvt_pk_bf16_f32 v56, -v6, v5
    v_fma_f32 v7, v10, 1.0, v11
    v_cos_f32 v8, v7
    v_sin_f32 v9, v7
    s_nop 0
    v_cvt_pk_bf16_f32 v53, v8, v9
    v_cvt_pk_bf16_f32 v57, -v9, v8
    v_fma_f32 v4, v10, 2.0, v11
    v_cos_f32 v5, v4
    v_sin_f32 v6, v4
    s_nop 0
    v_cvt_pk_bf16_f32 v54, v5, v6
    v_cvt_pk_bf16_f32 v58, -v6, v5
    v_add_f32 v7, v4, v10
    v_cos_f32 v8, v7
    v_sin_f32 v9, v7
    s_nop 0
    v_cvt_pk_bf16_f32 v55, v8, v9
    v_cvt_pk_bf16_f32 v59, -v9, v8
    s_lshl_b32 s48, s3, 5
    s_add_u32 s48, s48, s4
    v_cvt_f32_u32 v14, s48
    v_mul_f32 v14, 0x3a000000, v14
    v_mul_f32 v10, 0x3d800000, v219
    v_add_f32 v10, v10, v14
    v_mul_f32 v11, v218, v10
    v_cos_f32 v5, v11
    v_sin_f32 v6, v11
    s_nop 0
    v_cvt_pk_bf16_f32 v68, v5, v6
    v_cvt_pk_bf16_f32 v72, -v6, v5
    v_fma_f32 v7, v10, 1.0, v11
    v_cos_f32 v8, v7
    v_sin_f32 v9, v7
    s_nop 0
    v_cvt_pk_bf16_f32 v69, v8, v9
    v_cvt_pk_bf16_f32 v73, -v9, v8
    v_fma_f32 v4, v10, 2.0, v11
    v_cos_f32 v5, v4
    v_sin_f32 v6, v4
    s_nop 0
    v_cvt_pk_bf16_f32 v70, v5, v6
    v_cvt_pk_bf16_f32 v74, -v6, v5
    v_add_f32 v7, v4, v10
    v_cos_f32 v8, v7
    v_sin_f32 v9, v7
    s_nop 0
    v_cvt_pk_bf16_f32 v71, v8, v9
    v_cvt_pk_bf16_f32 v75, -v9, v8
    v_add_f32 v10, 0x3b800000, v10
    v_mul_f32 v11, v218, v10
    v_cos_f32 v5, v11
    v_sin_f32 v6, v11
    s_nop 0
    v_cvt_pk_bf16_f32 v76, v5, v6
    v_cvt_pk_bf16_f32 v80, -v6, v5
    v_fma_f32 v7, v10, 1.0, v11
    v_cos_f32 v8, v7
    v_sin_f32 v9, v7
    s_nop 0
    v_cvt_pk_bf16_f32 v77, v8, v9
    v_cvt_pk_bf16_f32 v81, -v9, v8
    v_fma_f32 v4, v10, 2.0, v11
    v_cos_f32 v5, v4
    v_sin_f32 v6, v4
    s_nop 0
    v_cvt_pk_bf16_f32 v78, v5, v6
    v_cvt_pk_bf16_f32 v82, -v6, v5
    v_add_f32 v7, v4, v10
    v_cos_f32 v8, v7
    v_sin_f32 v9, v7
    s_nop 0
    v_cvt_pk_bf16_f32 v79, v8, v9
    v_cvt_pk_bf16_f32 v83, -v9, v8
    v_add_f32 v10, 0x3b800000, v10
    v_mul_f32 v11, v218, v10
    v_cos_f32 v5, v11
    v_sin_f32 v6, v11
    s_nop 0
    v_cvt_pk_bf16_f32 v84, v5, v6
    v_cvt_pk_bf16_f32 v88, -v6, v5
    v_fma_f32 v7, v10, 1.0, v11
    v_cos_f32 v8, v7
    v_sin_f32 v9, v7
    s_nop 0
    v_cvt_pk_bf16_f32 v85, v8, v9
    v_cvt_pk_bf16_f32 v89, -v9, v8
    v_fma_f32 v4, v10, 2.0, v11
    v_cos_f32 v5, v4
    v_sin_f32 v6, v4
    s_nop 0
    v_cvt_pk_bf16_f32 v86, v5, v6
    v_cvt_pk_bf16_f32 v90, -v6, v5
    v_add_f32 v7, v4, v10
    v_cos_f32 v8, v7
    v_sin_f32 v9, v7
    s_nop 0
    v_cvt_pk_bf16_f32 v87, v8, v9
    v_cvt_pk_bf16_f32 v91, -v9, v8
    v_add_f32 v10, 0x3b800000, v10
    v_mul_f32 v11, v218, v10
    v_cos_f32 v5, v11
    v_sin_f32 v6, v11
    s_nop 0
    v_cvt_pk_bf16_f32 v92, v5, v6
    v_cvt_pk_bf16_f32 v96, -v6, v5
    v_fma_f32 v7, v10, 1.0, v11
    v_cos_f32 v8, v7
    v_sin_f32 v9, v7
    s_nop 0
    v_cvt_pk_bf16_f32 v93, v8, v9
    v_cvt_pk_bf16_f32 v97, -v9, v8
    v_fma_f32 v4, v10, 2.0, v11
    v_cos_f32 v5, v4
    v_sin_f32 v6, v4
    s_nop 0
    v_cvt_pk_bf16_f32 v94, v5, v6
    v_cvt_pk_bf16_f32 v98, -v6, v5
    v_add_f32 v7, v4, v10
    v_cos_f32 v8, v7
    v_sin_f32 v9, v7
    s_nop 0
    v_cvt_pk_bf16_f32 v95, v8, v9
    v_cvt_pk_bf16_f32 v99, -v9, v8
L_m_39:
L_m_34:
    s_waitcnt lgkmcnt(0)
    s_barrier
    s_cmp_ge_u32 s5, 20
    s_cbranch_scc1 L_m_40
    s_waitcnt vmcnt(0)
    buffer_store_dword v3, v18, s[36:39], 0 offen sc1
    v_mul_f32 v10, 0x3d800000, v219
    v_fmac_f32 v14, 0x3d800000, v218
    v_mul_f32 v11, v219, v14
    v_cos_f32 v5, v11
    v_sin_f32 v6, v11
    s_nop 0
    v_cvt_pk_bf16_f32 v100, v5, -v6
    v_cvt_pk_bf16_f32 v104, v6, v5
    v_fma_f32 v7, v10, 1.0, v11
    v_cos_f32 v8, v7
    v_sin_f32 v9, v7
    s_nop 0
    v_cvt_pk_bf16_f32 v101, v8, -v9
    v_cvt_pk_bf16_f32 v105, v9, v8
    v_fma_f32 v4, v10, 2.0, v11
    v_cos_f32 v5, v4
    v_sin_f32 v6, v4
    s_nop 0
    v_cvt_pk_bf16_f32 v102, v5, -v6
    v_cvt_pk_bf16_f32 v106, v6, v5
    v_add_f32 v7, v4, v10
    v_cos_f32 v8, v7
    v_sin_f32 v9, v7
    s_nop 0
    v_cvt_pk_bf16_f32 v103, v8, -v9
    v_cvt_pk_bf16_f32 v107, v9, v8
    v_add_f32 v14, 0x3b800000, v14
    v_mul_f32 v11, v219, v14
    v_cos_f32 v5, v11
    v_sin_f32 v6, v11
    s_nop 0
    v_cvt_pk_bf16_f32 v108, v5, -v6
    v_cvt_pk_bf16_f32 v112, v6, v5
    v_fma_f32 v7, v10, 1.0, v11
    v_cos_f32 v8, v7
    v_sin_f32 v9, v7
    s_nop 0
    v_cvt_pk_bf16_f32 v109, v8, -v9
    v_cvt_pk_bf16_f32 v113, v9, v8
    v_fma_f32 v4, v10, 2.0, v11
    v_cos_f32 v5, v4
    v_sin_f32 v6, v4
    s_nop 0
    v_cvt_pk_bf16_f32 v110, v5, -v6
    v_cvt_pk_bf16_f32 v114, v6, v5
    v_add_f32 v7, v4, v10
    v_cos_f32 v8, v7
    v_sin_f32 v9, v7
    s_nop 0
    v_cvt_pk_bf16_f32 v111, v8, -v9
    v_cvt_pk_bf16_f32 v115, v9, v8
    v_add_f32 v14, 0x3b800000, v14
    v_mul_f32 v11, v219, v14
    v_cos_f32 v5, v11
    v_sin_f32 v6, v11
    s_nop 0
    v_cvt_pk_bf16_f32 v116, v5, -v6
    v_cvt_pk_bf16_f32 v120, v6, v5
    v_fma_f32 v7, v10, 1.0, v11
    v_cos_f32 v8, v7
    v_sin_f32 v9, v7
    s_nop 0
    v_cvt_pk_bf16_f32 v117, v8, -v9
    v_cvt_pk_bf16_f32 v121, v9, v8
    v_fma_f32 v4, v10, 2.0, v11
    v_cos_f32 v5, v4
    v_sin_f32 v6, v4
    s_nop 0
    v_cvt_pk_bf16_f32 v118, v5, -v6
    v_cvt_pk_bf16_f32 v122, v6, v5
    v_add_f32 v7, v4, v10
    v_cos_f32 v8, v7
    v_sin_f32 v9, v7
    s_nop 0
    v_cvt_pk_bf16_f32 v119, v8, -v9
    v_cvt_pk_bf16_f32 v123, v9, v8
    v_add_f32 v14, 0x3b800000, v14
    v_mul_f32 v11, v219, v14
    v_cos_f32 v5, v11
    v_sin_f32 v6, v11
    s_nop 0
    v_cvt_pk_bf16_f32 v124, v5, -v6
    v_cvt_pk_bf16_f32 v128, v6, v5
    v_fma_f32 v7, v10, 1.0, v11
    v_cos_f32 v8, v7
    v_sin_f32 v9, v7
    s_nop 0
    v_cvt_pk_bf16_f32 v125, v8, -v9
    v_cvt_pk_bf16_f32 v129, v9, v8
    v_fma_f32 v4, v10, 2.0, v11
    v_cos_f32 v5, v4
    v_sin_f32 v6, v4
    s_nop 0
    v_cvt_pk_bf16_f32 v126, v5, -v6
    v_cvt_pk_bf16_f32 v130, v6, v5
    v_add_f32 v7, v4, v10
    v_cos_f32 v8, v7
    v_sin_f32 v9, v7
    s_nop 0
    v_cvt_pk_bf16_f32 v127, v8, -v9
    v_cvt_pk_bf16_f32 v131, v9, v8
    v_mul_f32 v13, 0x3c000000, v13
    v_fmac_f32 v13, 0x3d800000, v218
    v_mul_f32 v11, v219, v13
    v_cos_f32 v5, v11
    v_sin_f32 v6, v11
    s_nop 0
    v_cvt_pk_bf16_f32 v60, v5, -v6
    v_cvt_pk_bf16_f32 v64, v6, v5
    v_fma_f32 v7, v10, 1.0, v11
    v_cos_f32 v8, v7
    v_sin_f32 v9, v7
    s_nop 0
    v_cvt_pk_bf16_f32 v61, v8, -v9
    v_cvt_pk_bf16_f32 v65, v9, v8
    v_fma_f32 v4, v10, 2.0, v11
    v_cos_f32 v5, v4
    v_sin_f32 v6, v4
    s_nop 0
    v_cvt_pk_bf16_f32 v62, v5, -v6
    v_cvt_pk_bf16_f32 v66, v6, v5
    v_add_f32 v7, v4, v10
    v_cos_f32 v8, v7
    v_sin_f32 v9, v7
    s_nop 0
    v_cvt_pk_bf16_f32 v63, v8, -v9
    v_cvt_pk_bf16_f32 v67, v9, v8
L_m_40:
    s_branch L_stub_11
L_back_h1:
    s_waitcnt vmcnt(0)
    s_lshl_b32 s48, s3, 5
    s_add_u32 s48, s48, s4
    v_lshrrev_b32 v8, 2, v1
    v_lshl_add_u32 v8, v8, 3, s48
    s_cmp_lt_u32 s60, 2
    s_cselect_b32 s48, 1, -1
    v_mul_i32_i24 v8, s48, v8
    v_and_b32 v8, 127, v8
    v_and_b32 v7, 3, v1
    v_lshl_add_u32 v8, v8, 2, v7
    v_lshlrev_b32 v15, 4, v8
    s_mov_b32 s64, 262144
    s_cmp_ge_u32 s5, 20
    s_cbranch_scc1 L_m_41
    buffer_load_dword v18, v15, s[36:39], s64 offen sc1
L_m_41:
    s_barrier
    buffer_store_dword v3, v17, s[36:39], 0 offen sc1
    s_cmp_ge_u32 s63, 126
    s_cbranch_scc1 L_m_42
    ds_read_b64_tr_b16 v[132:133], v28 offset:0
    ds_read_b64_tr_b16 v[134:135], v28 offset:2048
    ds_read2_b64 v[136:139], v29 offset0:0 offset1:4
    ds_read_b64_tr_b16 v[140:141], v28 offset:4096
    ds_read_b64_tr_b16 v[142:143], v28 offset:6144
    ds_read2_b64 v[144:147], v29 offset0:8 offset1:12
    ds_read_b64_tr_b16 v[148:149], v28 offset:8192
    ds_read_b64_tr_b16 v[150:151], v28 offset:10240
    ds_read2_b64 v[152:155], v29 offset0:16 offset1:20
    ds_read_b64_tr_b16 v[156:157], v28 offset:12288
    ds_read_b64_tr_b16 v[158:159], v28 offset:14336
    ds_read2_b64 v[160:163], v29 offset0:24 offset1:28
    ds_read_b64_tr_b16 v[164:165], v28 offset:16384
    ds_read_b64_tr_b16 v[166:167], v28 offset:18432
    ds_read2_b64 v[168:171], v29 offset0:32 offset1:36
    ds_read_b64_tr_b16 v[172:173], v28 offset:20480
    ds_read_b64_tr_b16 v[174:175], v28 offset:22528
    ds_read2_b64 v[176:179], v29 offset0:40 offset1:44
    ds_read_b64_tr_b16 v[180:181], v28 offset:24576
    ds_read_b64_tr_b16 v[182:183], v28 offset:26624
    ds_read2_b64 v[184:187], v29 offset0:48 offset1:52
    ds_read_b64_tr_b16 v[188:189], v28 offset:28672
    ds_read_b64_tr_b16 v[190:191], v28 offset:30720
    ds_read2_b64 v[192:195], v29 offset0:56 offset1:60
    ds_read_b64_tr_b16 v[196:197], v28 offset:32768
    ds_read_b64_tr_b16 v[198:199], v28 offset:34816
    ds_read2_b64 v[200:203], v29 offset0:64 offset1:68
    v_and_b32 v4, 3, v1
    v_or_b32 v4, 0x07060500, v4
    s_waitcnt lgkmcnt(14)
    v_mfma_f32_16x16x32_bf16 v[36:39], v[136:139], v[132:135], 0
    v_mfma_f32_16x16x32_bf16 v[36:39], v[144:147], v[140:143], v[36:39]
    v_mfma_f32_16x16x32_bf16 v[36:39], v[152:155], v[148:151], v[36:39]
    v_mfma_f32_16x16x32_bf16 v[36:39], v[160:163], v[156:159], v[36:39]
    s_waitcnt lgkmcnt(12)
    v_mfma_f32_16x16x32_bf16 v[36:39], v[168:171], v[164:167], v[36:39]
    s_waitcnt lgkmcnt(9)
    v_mfma_f32_16x16x32_bf16 v[36:39], v[176:179], v[172:175], v[36:39]
    s_waitcnt lgkmcnt(6)
    v_mfma_f32_16x16x32_bf16 v[36:39], v[184:187], v[180:183], v[36:39]
    s_waitcnt lgkmcnt(3)
    v_mfma_f32_16x16x32_bf16 v[36:39], v[192:195], v[188:191], v[36:39]
    s_waitcnt lgkmcnt(0)
    v_mfma_f32_16x16x32_bf16 v[36:39], v[200:203], v[196:199], v[36:39]
    s_nop 7
    v_add_u32 v40, 0x80, v36
    v_perm_b32 v40, v40, v3, v4
    s_mov_b32 s48, 0
    buffer_store_dword v40, v30, s[36:39], s48 offen sc1
L_m_42:
    s_cmp_lt_u32 s5, 20
    s_cbranch_scc1 L_m_32
    s_mov_b32 s52, s16
    s_mov_b32 s53, s17
    s_mov_b32 s54, 18874368
    s_mov_b32 s55, 0x20000
    s_mul_i32 s58, s3, 12
    s_add_u32 s58, s58, s5
    s_add_u32 s58, s58, -20
L_m_43:
    s_cmp_ge_u32 s58, 96
    s_cbranch_scc1 L_m_44
    s_mul_i32 s48, s58, 820
    s_lshr_b32 s48, s48, 13
    s_mul_i32 s49, s48, 10
    s_sub_u32 s49, s58, s49
    s_lshl_b32 s49, s49, 6
    v_add_u32 v220, s49, v0
    s_and_b32 s49, s4, 7
    s_mul_i32 s49, s49, 4
    s_add_u32 s48, s48, s49
    s_add_u32 s48, s48, 26
    s_and_b32 s48, s48, 31
    s_mul_i32 s48, s48, 73728
    s_mul_i32 s49, s4, 1152
    s_and_b32 s49, s49, -256
    s_add_u32 s48, s48, s49
    v_mul_u32_u24 v221, 820, v220
    v_lshrrev_b32 v221, 13, v221
    v_mul_u32_u24 v222, 10, v221
    v_sub_u32 v222, v220, v222
    v_and_b32 v220, 7, v221
    v_lshrrev_b32 v221, 3, v221
    v_lshl_add_u32 v220, v220, 8, v221
    v_mul_u32_u24 v220, 9216, v220
    v_lshl_add_u32 v220, v222, 7, v220
    buffer_load_dword v223, v220, s[52:55], s48 offen
    s_add_u32 s58, s58, 48
    s_branch L_m_43
L_m_44:
    s_waitcnt vmcnt(0)
    s_barrier
    s_branch L_m_33
    s_branch L_skip_11
L_stub_11:
    s_branch L_stub_12
L_skip_11:
L_m_32:
    s_setprio 1
    s_lshl_b32 s54, s3, 8
    s_add_u32 s52, s35, s54
    s_add_u32 s52, s52, 4194304
    s_lshl_b32 s53, s3, 12
    s_add_u32 s53, s53, s35
    s_add_u32 s53, s53, 1048576
    v_and_b32 v4, 3, v1
    v_lshrrev_b32 v5, 2, v1
    v_lshlrev_b32 v6, 6, v4
    v_lshl_add_u32 v6, v5, 4, v6
    v_lshl_add_u32 v217, v2, 12, v6
    v_mul_u32_u24 v212, 1040, v1
    v_lshl_add_u32 v212, v2, 6, v212
    v_add_u32 v212, s54, v212
    s_mul_i32 s48, s3, 4160
    v_add_u32 v214, s48, v16
    v_lshl_add_u32 v6, v2, 2, v4
    v_mul_u32_u24 v215, 1056, v6
    v_lshl_add_u32 v215, v5, 4, v215
    v_add_u32 v215, s54, v215
    s_mul_i32 s48, s3, 4224
    v_add_u32 v213, s48, v16
    s_and_b32 s66, s51, 3
    s_xor_b32 s66, s66, s60
    s_lshl_b32 s66, s66, 6
    s_lshl_b32 s48, s51, 8
    s_add_u32 s66, s66, s48
    s_mul_i32 s48, s3, 40960
    s_add_u32 s66, s66, s48
    s_add_u32 s66, s66, 8388608
    s_add_u32 s67, s66, 163840
    s_add_u32 s68, s66, 327680
    s_add_u32 s69, s66, 491520
    s_lshr_b32 s48, s51, 2
    s_and_b32 s48, s48, 2
    v_xor_b32 v4, s48, v4
    v_lshl_add_u32 v5, v2, 6, v5
    v_mul_u32_u24 v216, 10240, v5
    v_lshl_add_u32 v216, v4, 4, v216
    s_lshr_b32 s65, s4, 1
    s_lshl_b32 s65, s65, 16
    s_add_u32 s65, s65, 15728640
    s_lshl_b32 s48, s3, 10
    s_add_u32 s65, s65, s48
    v_lshlrev_b32 v218, 4, v0
    s_waitcnt vmcnt(1)
    v_cmp_ne_u32 vcc, v3, v18
    s_nop 0
    s_cbranch_vccz L_m_45
Lp_m_46:
    buffer_load_dword v18, v15, s[36:39], s64 offen sc1
    s_waitcnt vmcnt(0)
    v_cmp_ne_u32 vcc, v3, v18
    s_nop 0
    s_cbranch_vccz Le_m_47
    s_sub_u32 s7, s7, 1
    s_cbranch_scc1 Le_m_47
    s_sleep 1
    s_branch Lp_m_46
Le_m_47:
    s_max_i32 s7, s7, 0
L_m_45:
    buffer_load_dwordx4 v[224:227], v16, s[36:39], s53 offen offset:0 sc1
    buffer_load_dwordx4 v[228:231], v16, s[36:39], s53 offen offset:1024 sc1
    buffer_load_dwordx4 v[232:235], v16, s[36:39], s53 offen offset:2048 sc1
    buffer_load_dwordx4 v[236:239], v16, s[36:39], s53 offen offset:3072 sc1
    s_waitcnt vmcnt(0)
Lp_m_48:
    buffer_load_dword v4, v218, s[36:39], s65 offen sc1
    s_waitcnt vmcnt(0)
    v_cmp_ne_u32 vcc, v3, v4
    s_nop 0
    s_cbranch_vccz Le_m_49
    s_sub_u32 s7, s7, 1
    s_cbranch_scc1 Le_m_49
    s_mov_b64 exec, vcc
    s_sleep 1
    s_branch Lp_m_48
Le_m_49:
    s_mov_b64 exec, -1
    s_max_i32 s7, s7, 0
    buffer_load_dwordx4 v[36:39], v217, s[36:39], s52 offen offset:0 sc1
    buffer_load_dwordx4 v[40:43], v217, s[36:39], s52 offen offset:1024 sc1
    buffer_load_dwordx4 v[44:47], v217, s[36:39], s52 offen offset:2048 sc1
    buffer_load_dwordx4 v[48:51], v217, s[36:39], s52 offen offset:3072 sc1
    v_lshlrev_b32 v132, 16, v224
    v_and_b32 v136, 0xffff0000, v224
    v_lshlrev_b32 v133, 16, v225
    v_and_b32 v137, 0xffff0000, v225
    v_lshlrev_b32 v134, 16, v226
    v_and_b32 v138, 0xffff0000, v226
    v_lshlrev_b32 v135, 16, v227
    v_and_b32 v139, 0xffff0000, v227
    v_lshlrev_b32 v140, 16, v228
    v_and_b32 v144, 0xffff0000, v228
    v_lshlrev_b32 v141, 16, v229
    v_and_b32 v145, 0xffff0000, v229
    v_lshlrev_b32 v142, 16, v230
    v_and_b32 v146, 0xffff0000, v230
    v_lshlrev_b32 v143, 16, v231
    v_and_b32 v147, 0xffff0000, v231
    v_lshlrev_b32 v148, 16, v232
    v_and_b32 v152, 0xffff0000, v232
    v_lshlrev_b32 v149, 16, v233
    v_and_b32 v153, 0xffff0000, v233
    v_lshlrev_b32 v150, 16, v234
    v_and_b32 v154, 0xffff0000, v234
    v_lshlrev_b32 v151, 16, v235
    v_and_b32 v155, 0xffff0000, v235
    v_lshlrev_b32 v156, 16, v236
    v_and_b32 v160, 0xffff0000, v236
    v_lshlrev_b32 v157, 16, v237
    v_and_b32 v161, 0xffff0000, v237
    v_lshlrev_b32 v158, 16, v238
    v_and_b32 v162, 0xffff0000, v238
    v_lshlrev_b32 v159, 16, v239
    v_and_b32 v163, 0xffff0000, v239
    s_waitcnt vmcnt(2)
    v_swap_b32 v37, v40
    s_waitcnt vmcnt(1)
    v_swap_b32 v38, v44
    s_waitcnt vmcnt(0)
    v_swap_b32 v39, v48
    s_nop 1
    v_mfma_f32_16x16x32_bf16 v[164:167], v[36:39], v[52:55], 0
    v_mfma_f32_16x16x32_bf16 v[168:171], v[36:39], v[56:59], 0
    v_swap_b32 v42, v45
    v_swap_b32 v43, v49
    s_nop 1
    v_mfma_f32_16x16x32_bf16 v[172:175], v[40:43], v[52:55], 0
    v_mfma_f32_16x16x32_bf16 v[176:179], v[40:43], v[56:59], 0
    v_swap_b32 v47, v50
    s_nop 1
    v_mfma_f32_16x16x32_bf16 v[180:183], v[44:47], v[52:55], 0
    v_mfma_f32_16x16x32_bf16 v[184:187], v[44:47], v[56:59], 0
    v_mfma_f32_16x16x32_bf16 v[188:191], v[48:51], v[52:55], 0
    v_mfma_f32_16x16x32_bf16 v[192:195], v[48:51], v[56:59], 0
    v_cvt_pk_bf16_f32 v196, v164, v168
    v_cvt_pk_bf16_f32 v197, v165, v169
    v_cvt_pk_bf16_f32 v198, v166, v170
    v_cvt_pk_bf16_f32 v199, v167, v171
    ds_write_b128 v212, v[196:199] offset:36864
    v_cvt_pk_bf16_f32 v200, v172, v176
    v_cvt_pk_bf16_f32 v201, v173, v177
    v_cvt_pk_bf16_f32 v202, v174, v178
    v_cvt_pk_bf16_f32 v203, v175, v179
    ds_write_b128 v212, v[200:203] offset:36880
    v_cvt_pk_bf16_f32 v204, v180, v184
    v_cvt_pk_bf16_f32 v205, v181, v185
    v_cvt_pk_bf16_f32 v206, v182, v186
    v_cvt_pk_bf16_f32 v207, v183, v187
    ds_write_b128 v212, v[204:207] offset:36896
    v_cvt_pk_bf16_f32 v208, v188, v192
    v_cvt_pk_bf16_f32 v209, v189, v193
    v_cvt_pk_bf16_f32 v210, v190, v194
    v_cvt_pk_bf16_f32 v211, v191, v195
    ds_write_b128 v212, v[208:211] offset:36912
    s_waitcnt lgkmcnt(0)
    s_barrier
    ds_read_b128 v[36:39], v214 offset:36864
    ds_read_b128 v[40:43], v214 offset:37904
    ds_read_b128 v[44:47], v214 offset:38944
    ds_read_b128 v[48:51], v214 offset:39984
    s_waitcnt lgkmcnt(3)
    v_mfma_f32_16x16x32_bf16 v[164:167], v[68:71], v[36:39], 0
    v_mfma_f32_16x16x32_bf16 v[168:171], v[72:75], v[36:39], 0
    s_waitcnt lgkmcnt(2)
    v_mfma_f32_16x16x32_bf16 v[172:175], v[76:79], v[40:43], 0
    v_mfma_f32_16x16x32_bf16 v[176:179], v[80:83], v[40:43], 0
    s_waitcnt lgkmcnt(1)
    v_mfma_f32_16x16x32_bf16 v[180:183], v[84:87], v[44:47], 0
    v_mfma_f32_16x16x32_bf16 v[184:187], v[88:91], v[44:47], 0
    s_waitcnt lgkmcnt(0)
    v_mfma_f32_16x16x32_bf16 v[188:191], v[92:95], v[48:51], 0
    v_mfma_f32_16x16x32_bf16 v[192:195], v[96:99], v[48:51], 0
    v_pk_mul_f32 v[4:5], v[164:165], v[132:133]
    v_pk_mul_f32 v[6:7], v[168:169], v[132:133]
    v_pk_fma_f32 v[4:5], v[168:169], v[136:137], v[4:5] neg_lo:[1,0,0] neg_hi:[1,0,0]
    v_pk_fma_f32 v[6:7], v[164:165], v[136:137], v[6:7]
    v_cvt_pk_bf16_f32 v196, v4, v6
    v_cvt_pk_bf16_f32 v197, v5, v7
    v_pk_mul_f32 v[8:9], v[166:167], v[134:135]
    v_pk_mul_f32 v[10:11], v[170:171], v[134:135]
    v_pk_fma_f32 v[8:9], v[170:171], v[138:139], v[8:9] neg_lo:[1,0,0] neg_hi:[1,0,0]
    v_pk_fma_f32 v[10:11], v[166:167], v[138:139], v[10:11]
    v_cvt_pk_bf16_f32 v198, v8, v10
    v_cvt_pk_bf16_f32 v199, v9, v11
    v_pk_mul_f32 v[4:5], v[172:173], v[140:141]
    v_pk_mul_f32 v[6:7], v[176:177], v[140:141]
    v_pk_fma_f32 v[4:5], v[176:177], v[144:145], v[4:5] neg_lo:[1,0,0] neg_hi:[1,0,0]
    v_pk_fma_f32 v[6:7], v[172:173], v[144:145], v[6:7]
    v_cvt_pk_bf16_f32 v200, v4, v6
    v_cvt_pk_bf16_f32 v201, v5, v7
    v_mfma_f32_16x16x32_bf16 v[164:167], v[100:103], v[196:199], 0
    v_pk_mul_f32 v[8:9], v[174:175], v[142:143]
    v_pk_mul_f32 v[10:11], v[178:179], v[142:143]
    v_pk_fma_f32 v[8:9], v[178:179], v[146:147], v[8:9] neg_lo:[1,0,0] neg_hi:[1,0,0]
    v_pk_fma_f32 v[10:11], v[174:175], v[146:147], v[10:11]
    v_cvt_pk_bf16_f32 v202, v8, v10
    v_cvt_pk_bf16_f32 v203, v9, v11
    v_mfma_f32_16x16x32_bf16 v[168:171], v[104:107], v[196:199], 0
    v_pk_mul_f32 v[4:5], v[180:181], v[148:149]
    v_pk_mul_f32 v[6:7], v[184:185], v[148:149]
    v_pk_fma_f32 v[4:5], v[184:185], v[152:153], v[4:5] neg_lo:[1,0,0] neg_hi:[1,0,0]
    v_pk_fma_f32 v[6:7], v[180:181], v[152:153], v[6:7]
    v_cvt_pk_bf16_f32 v204, v4, v6
    v_cvt_pk_bf16_f32 v205, v5, v7
    v_mfma_f32_16x16x32_bf16 v[172:175], v[108:111], v[200:203], 0
    v_pk_mul_f32 v[8:9], v[182:183], v[150:151]
    v_pk_mul_f32 v[10:11], v[186:187], v[150:151]
    v_pk_fma_f32 v[8:9], v[186:187], v[154:155], v[8:9] neg_lo:[1,0,0] neg_hi:[1,0,0]
    v_pk_fma_f32 v[10:11], v[182:183], v[154:155], v[10:11]
    v_cvt_pk_bf16_f32 v206, v8, v10
    v_cvt_pk_bf16_f32 v207, v9, v11
    v_mfma_f32_16x16x32_bf16 v[176:179], v[112:115], v[200:203], 0
    v_pk_mul_f32 v[4:5], v[188:189], v[156:157]
    v_pk_mul_f32 v[6:7], v[192:193], v[156:157]
    v_pk_fma_f32 v[4:5], v[192:193], v[160:161], v[4:5] neg_lo:[1,0,0] neg_hi:[1,0,0]
    v_pk_fma_f32 v[6:7], v[188:189], v[160:161], v[6:7]
    v_cvt_pk_bf16_f32 v208, v4, v6
    v_cvt_pk_bf16_f32 v209, v5, v7
    v_mfma_f32_16x16x32_bf16 v[180:183], v[116:119], v[204:207], 0
    v_pk_mul_f32 v[8:9], v[190:191], v[158:159]
    v_pk_mul_f32 v[10:11], v[194:195], v[158:159]
    v_pk_fma_f32 v[8:9], v[194:195], v[162:163], v[8:9] neg_lo:[1,0,0] neg_hi:[1,0,0]
    v_pk_fma_f32 v[10:11], v[190:191], v[162:163], v[10:11]
    v_cvt_pk_bf16_f32 v210, v8, v10
    v_cvt_pk_bf16_f32 v211, v9, v11
    v_mfma_f32_16x16x32_bf16 v[184:187], v[120:123], v[204:207], 0
    v_cvt_pk_bf16_f32 v36, v164, v168
    v_cvt_pk_bf16_f32 v40, v165, v169
    v_cvt_pk_bf16_f32 v44, v166, v170
    v_cvt_pk_bf16_f32 v48, v167, v171
    v_mfma_f32_16x16x32_bf16 v[188:191], v[124:127], v[208:211], 0
    v_mfma_f32_16x16x32_bf16 v[192:195], v[128:131], v[208:211], 0
    v_cvt_pk_bf16_f32 v37, v172, v176
    v_cvt_pk_bf16_f32 v41, v173, v177
    v_cvt_pk_bf16_f32 v45, v174, v178
    v_cvt_pk_bf16_f32 v49, v175, v179
    v_cvt_pk_bf16_f32 v38, v180, v184
    v_cvt_pk_bf16_f32 v42, v181, v185
    v_cvt_pk_bf16_f32 v46, v182, v186
    v_cvt_pk_bf16_f32 v50, v183, v187
    v_cvt_pk_bf16_f32 v39, v188, v192
    ds_write_b128 v215, v[36:39] offset:53504
    v_cvt_pk_bf16_f32 v43, v189, v193
    ds_write_b128 v215, v[40:43] offset:53568
    v_cvt_pk_bf16_f32 v47, v190, v194
    ds_write_b128 v215, v[44:47] offset:53632
    v_cvt_pk_bf16_f32 v51, v191, v195
    ds_write_b128 v215, v[48:51] offset:53696
    s_waitcnt lgkmcnt(0)
    s_barrier
    ds_read_b128 v[196:199], v213 offset:53504
    ds_read_b128 v[200:203], v213 offset:54560
    ds_read_b128 v[204:207], v213 offset:55616
    ds_read_b128 v[208:211], v213 offset:56672
    s_waitcnt lgkmcnt(3)
    v_mfma_f32_16x16x32_bf16 v[164:167], v[60:63], v[196:199], 0
    v_mfma_f32_16x16x32_bf16 v[168:171], v[64:67], v[196:199], 0
    s_waitcnt lgkmcnt(2)
    v_mfma_f32_16x16x32_bf16 v[172:175], v[60:63], v[200:203], 0
    v_mfma_f32_16x16x32_bf16 v[176:179], v[64:67], v[200:203], 0
    s_waitcnt lgkmcnt(1)
    v_mfma_f32_16x16x32_bf16 v[180:183], v[60:63], v[204:207], 0
    v_mfma_f32_16x16x32_bf16 v[184:187], v[64:67], v[204:207], 0
    s_waitcnt lgkmcnt(0)
    v_mfma_f32_16x16x32_bf16 v[188:191], v[60:63], v[208:211], 0
    v_mfma_f32_16x16x32_bf16 v[192:195], v[64:67], v[208:211], 0
    v_cvt_pk_bf16_f32 v36, v168, v164
    v_cvt_pk_bf16_f32 v40, v169, v165
    v_cvt_pk_bf16_f32 v44, v170, v166
    v_cvt_pk_bf16_f32 v48, v171, v167
    v_cvt_pk_bf16_f32 v37, v176, v172
    v_cvt_pk_bf16_f32 v41, v177, v173
    v_cvt_pk_bf16_f32 v45, v178, v174
    v_cvt_pk_bf16_f32 v49, v179, v175
    v_cvt_pk_bf16_f32 v38, v184, v180
    v_cvt_pk_bf16_f32 v42, v185, v181
    v_cvt_pk_bf16_f32 v46, v186, v182
    s_branch L_skip_12
L_stub_12:
    s_branch L_back_h1
L_skip_12:
    v_cvt_pk_bf16_f32 v50, v187, v183
    v_cvt_pk_bf16_f32 v39, v192, v188
    buffer_store_dwordx4 v[36:39], v216, s[36:39], s66 offen sc1
    v_cvt_pk_bf16_f32 v43, v193, v189
    buffer_store_dwordx4 v[40:43], v216, s[36:39], s67 offen sc1
    v_cvt_pk_bf16_f32 v47, v194, v190
    buffer_store_dwordx4 v[44:47], v216, s[36:39], s68 offen sc1
    v_cvt_pk_bf16_f32 v51, v195, v191
    buffer_store_dwordx4 v[48:51], v216, s[36:39], s69 offen sc1
    buffer_store_dword v3, v19, s[36:39], 0 offen sc1
    s_setprio 0
    s_waitcnt vmcnt(0)
    s_barrier
L_m_33:
    v_lshlrev_b32 v8, 4, v0
    s_mul_i32 s52, s4, 27
    s_add_u32 s52, s52, s5
    s_mul_i32 s51, s52, 171
    s_lshr_b32 s51, s51, 10
    s_mul_i32 s48, s51, 6
    s_sub_u32 s52, s52, s48
    s_lshr_b32 s53, s4, 1
    s_and_b32 s54, s4, 1
    s_lshl_b32 s54, s54, 3
    s_lshr_b32 s48, s5, 2
    s_add_u32 s54, s54, s48
    s_and_b32 s55, s5, 3
    s_mov_b32 s40, s16
    s_mov_b32 s41, s17
    s_mov_b32 s42, 18874368
    s_mov_b32 s43, 0x20000
    s_mov_b32 s44, s20
    s_mov_b32 s45, s21
    s_mov_b32 s46, 18874368
    s_mov_b32 s47, 0x20000
    s_and_b32 s62, s3, 1
    s_and_b32 s63, s4, 7
    s_mul_i32 s63, s63, 4
    s_add_u32 s63, s63, 26
    s_mul_i32 s48, s51, 0
    s_add_u32 s63, s63, s48
    s_and_b32 s63, s63, 31
    s_mov_b32 s64, 0
    s_lshl_b32 s68, s62, 13
    s_cmp_ge_u32 s3, 2
    s_cbranch_scc1 L_m_50
    s_branch L_stub_13
L_back_a1:
    s_mul_i32 s56, s62, 27
    s_add_u32 s56, s56, s5
    s_add_u32 s56, s56, 116
    s_cmp_lt_u32 s5, 27
    s_cselect_b32 s56, s56, 999
    s_barrier
    v_mov_b64 v[28:29], -1
    v_mov_b64 v[30:31], -1
    s_lshl_b32 s56, s2, 1
    s_add_u32 s56, s56, s62
    s_add_u32 s48, s56, 0
    s_cmp_ge_u32 s48, 1152
    s_cbranch_scc1 L_m_51
    s_mov_b32 s49, s48
    s_cmp_ge_u32 s49, 288
    s_cselect_b32 s50, 1008, 0
    s_add_u32 s48, s48, s50
    s_cmp_ge_u32 s49, 576
    s_cselect_b32 s50, 1008, 0
    s_add_u32 s48, s48, s50
    s_cmp_ge_u32 s49, 864
    s_cselect_b32 s50, 1008, 0
    s_add_u32 s48, s48, s50
    s_lshl_b32 s48, s48, 10
    s_add_u32 s48, s48, 21413888
    buffer_store_dwordx4 v[28:31], v8, s[36:39], s48 offen sc1
L_m_51:
    s_add_u32 s48, s56, 512
    s_cmp_ge_u32 s48, 1152
    s_cbranch_scc1 L_m_52
    s_mov_b32 s49, s48
    s_cmp_ge_u32 s49, 288
    s_cselect_b32 s50, 1008, 0
    s_add_u32 s48, s48, s50
    s_cmp_ge_u32 s49, 576
    s_cselect_b32 s50, 1008, 0
    s_add_u32 s48, s48, s50
    s_cmp_ge_u32 s49, 864
    s_cselect_b32 s50, 1008, 0
    s_add_u32 s48, s48, s50
    s_lshl_b32 s48, s48, 10
    s_add_u32 s48, s48, 21413888
    buffer_store_dwordx4 v[28:31], v8, s[36:39], s48 offen sc1
L_m_52:
    s_add_u32 s48, s56, 1024
    s_cmp_ge_u32 s48, 1152
    s_cbranch_scc1 L_m_53
    s_mov_b32 s49, s48
    s_cmp_ge_u32 s49, 288
    s_cselect_b32 s50, 1008, 0
    s_add_u32 s48, s48, s50
    s_cmp_ge_u32 s49, 576
    s_cselect_b32 s50, 1008, 0
    s_add_u32 s48, s48, s50
    s_cmp_ge_u32 s49, 864
    s_cselect_b32 s50, 1008, 0
    s_add_u32 s48, s48, s50
    s_lshl_b32 s48, s48, 10
    s_add_u32 s48, s48, 21413888
    buffer_store_dwordx4 v[28:31], v8, s[36:39], s48 offen sc1
L_m_53:
    s_bfe_u32 s56, s6, 0x10002
    s_lshl_b32 s56, s56, 7
    s_lshr_b32 s57, s6, 3
    s_lshl_b32 s57, s57, 2
    s_add_u32 s56, s56, s57
    s_and_b32 s57, s6, 3
    s_add_u32 s56, s56, s57
    s_lshl_b32 s48, s56, 4
    s_lshl_b32 s49, s3, 16
    s_add_u32 s48, s48, s49
    s_add_u32 s48, s48, 16252928
    v_mov_b32 v10, 2146435072
    v_writelane_b32 v10, s48, 0
    s_add_u32 s48, s48, 16384
    s_lshl_b32 s56, s52, 6
    s_add_u32 s56, s56, s51
    s_lshl_b32 s48, s56, 4
    s_lshl_b32 s49, s3, 16
    s_add_u32 s48, s48, s49
    s_add_u32 s48, s48, 16515072
    v_mov_b32 v11, 2146435072
    v_writelane_b32 v11, s48, 0
    s_add_u32 s48, s48, 16384
    s_add_u32 s48, s2, 216
    s_lshl_b32 s48, s48, 7
    s_add_u32 s48, s48, 622592
    s_lshl_b32 s49, s3, 8
    s_add_u32 s49, s49, s5
    s_cmp_lt_u32 s49, 5
    s_cselect_b32 s48, s48, 2146435072
    v_writelane_b32 v11, s48, 8
    s_lshr_b32 s65, s4, 2
    s_lshl_b32 s65, s65, 16
    s_add_u32 s66, s65, 16515072
    s_lshl_b32 s48, s62, 11
    s_add_u32 s65, s65, s48
    s_add_u32 s65, s65, 16252928
    s_add_u32 s69, s65, 1024
    v_lshlrev_b32 v27, 4, v0
    s_mul_i32 s67, s52, 1536
    s_mul_i32 s48, s62, 36864
    s_add_u32 s67, s67, s48
    s_add_u32 s67, s67, 16777216
    v_add_u32 v14, 7680, v8
    v_cmp_gt_u32 vcc, 32, v0
    s_nop 1
    v_cndmask_b32 v13, v14, v8, vcc
    v_add_u32 v15, 18432, v8
    v_add_u32 v16, 18432, v13
    v_add_u32 v17, 18432, v14
    s_mul_i32 s68, s62, 6144
    s_mul_i32 s58, s63, 73728
    s_add_u32 s58, s58, s67
    s_add_u32 s59, s67, 2359296
    s_barrier
    s_mul_i32 s56, s62, 288
    s_mul_i32 s57, s6, 1152
    s_add_u32 s57, s57, 12582912
    v_add_u32 v4, 0, v0
    v_min_u32 v4, 287, v4
    v_add_u32 v4, s56, v4
    v_mul_u32_u24 v5, 911, v4
    v_lshrrev_b32 v5, 16, v5
    v_mul_u32_u24 v5, 293760, v5
    v_lshl_add_u32 v22, v4, 4, v5
    v_lshlrev_b32 v4, 4, v4
    v_add_u32 v6, 98304, v4
    v_add_u32 v4, 64, v0
    v_min_u32 v4, 287, v4
    v_add_u32 v4, s56, v4
    v_mul_u32_u24 v5, 911, v4
    v_lshrrev_b32 v5, 16, v5
    v_mul_u32_u24 v5, 293760, v5
    v_lshl_add_u32 v23, v4, 4, v5
    v_add_u32 v4, 128, v0
    v_min_u32 v4, 287, v4
    v_add_u32 v4, s56, v4
    v_mul_u32_u24 v5, 911, v4
    v_lshrrev_b32 v5, 16, v5
    v_mul_u32_u24 v5, 293760, v5
    v_lshl_add_u32 v24, v4, 4, v5
    v_add_u32 v4, 192, v0
    v_min_u32 v4, 287, v4
    v_add_u32 v4, s56, v4
    v_mul_u32_u24 v5, 911, v4
    v_lshrrev_b32 v5, 16, v5
    v_mul_u32_u24 v5, 293760, v5
    v_lshl_add_u32 v25, v4, 4, v5
    v_add_u32 v4, 256, v0
    v_min_u32 v4, 287, v4
    v_add_u32 v4, s56, v4
    v_mul_u32_u24 v5, 911, v4
    v_lshrrev_b32 v5, 16, v5
    v_mul_u32_u24 v5, 293760, v5
    v_lshl_add_u32 v26, v4, 4, v5
    v_lshlrev_b32 v4, 4, v4
    v_add_u32 v7, 98304, v4
    s_barrier
    s_barrier
    ds_read_b128 v[28:31], v6 offset:0
    ds_read_b128 v[32:35], v6 offset:1024
    ds_read_b128 v[36:39], v6 offset:2048
    ds_read_b128 v[40:43], v6 offset:3072
    ds_read_b128 v[44:47], v7 offset:0
    s_lshl_b32 s48, s62, 8
    s_add_u32 s48, s48, s6
    s_lshl_b32 s48, s48, 7
    s_add_u32 s48, s48, 15990784
    v_add_u32 v54, s48, v8
    v_cmp_gt_u32 vcc, 8, v0
    v_mov_b32 v4, 2146435072
    s_nop 0
    v_cndmask_b32 v54, v4, v54, vcc
    s_waitcnt vmcnt(0)
    v_mov_b32 v48, v3
    v_mov_b32 v49, v3
    v_mov_b32 v50, v3
    v_mov_b32 v51, v3
    s_cmp_ge_u32 s5, 27
    s_cbranch_scc1 L_m_54
    v_lshrrev_b32 v52, 4, v0
    v_and_b32 v53, 15, v0
    v_lshlrev_b32 v52, 12, v52
    v_lshl_add_u32 v52, v53, 7, v52
    s_lshr_b32 s48, s4, 1
    s_mul_i32 s48, s48, 4718592
    s_and_b32 s49, s4, 1
    s_lshl_b32 s49, s49, 11
    s_add_u32 s48, s48, s49
    v_add_u32 v52, s48, v52
    s_mov_b32 s35, 0
    s_mov_b32 s49, s35
    s_mul_i32 s48, s62, 1
    s_add_u32 s49, s49, s48
    s_bfm_b32 s48, s5, 0
    s_and_b32 s48, s48, 0
    s_bcnt1_i32_b32 s48, s48
    s_sub_u32 s12, s5, s48
    s_mul_i32 s35, s12, 4
    s_add_u32 s35, s35, 52
    s_add_u32 s35, s35, s49
    s_min_u32 s35, s35, 159
    s_lshl_b32 s8, s35, 14
    s_mul_i32 s35, s12, 4
    s_add_u32 s35, s35, 54
    s_add_u32 s35, s35, s49
    s_min_u32 s35, s35, 159
    s_lshl_b32 s9, s35, 14
    s_mul_i32 s35, s12, 132
    s_lshr_b32 s35, s35, 8
    s_add_u32 s35, s35, 0
    s_mov_b32 s48, 0
    s_bitcmp1_b32 s48, s5
    s_cselect_b32 s35, 999, s35
    s_add_u32 s50, s58, 589824
    s_cmp_ge_u32 s50, s59
    s_cselect_b32 s48, 2359296, 0
    s_sub_u32 s50, s50, s48
    s_waitcnt lgkmcnt(0)
    s_barrier
    buffer_store_dword v3, v10, s[36:39], 0 offen sc1
    v_add_u32 v76, 0, v0
    v_mul_u32_u24 v77, 1821, v76
    v_lshrrev_b32 v77, 18, v77
    v_mul_u32_u24 v77, 6912, v77
    v_lshl_add_u32 v77, v76, 4, v77
    v_subrev_u32 v56, 0, v77
    v_add_u32 v76, 64, v0
    v_mul_u32_u24 v77, 1821, v76
    v_lshrrev_b32 v77, 18, v77
    v_mul_u32_u24 v77, 6912, v77
    v_lshl_add_u32 v77, v76, 4, v77
    v_subrev_u32 v57, 1024, v77
    v_add_u32 v76, 128, v0
    v_mul_u32_u24 v77, 1821, v76
    v_lshrrev_b32 v77, 18, v77
    v_mul_u32_u24 v77, 6912, v77
    v_lshl_add_u32 v77, v76, 4, v77
    v_subrev_u32 v58, 2048, v77
    v_add_u32 v76, 192, v0
    v_mul_u32_u24 v77, 1821, v76
    v_lshrrev_b32 v77, 18, v77
    v_mul_u32_u24 v77, 6912, v77
    v_lshl_add_u32 v77, v76, 4, v77
    v_subrev_u32 v59, 3072, v77
    v_add_u32 v76, 256, v0
    v_mul_u32_u24 v77, 1821, v76
    v_lshrrev_b32 v77, 18, v77
    v_mul_u32_u24 v77, 6912, v77
    v_lshl_add_u32 v77, v76, 4, v77
    v_subrev_u32 v60, 0, v77
    v_add_u32 v76, 320, v0
    v_mul_u32_u24 v77, 1821, v76
    v_lshrrev_b32 v77, 18, v77
    v_mul_u32_u24 v77, 6912, v77
    v_lshl_add_u32 v77, v76, 4, v77
    v_subrev_u32 v61, 1024, v77
    v_add_u32 v76, 384, v0
    v_mul_u32_u24 v77, 1821, v76
    v_lshrrev_b32 v77, 18, v77
    v_mul_u32_u24 v77, 6912, v77
    v_lshl_add_u32 v77, v76, 4, v77
    v_subrev_u32 v62, 2048, v77
    v_add_u32 v76, 448, v0
    v_mul_u32_u24 v77, 1821, v76
    v_lshrrev_b32 v77, 18, v77
    v_mul_u32_u24 v77, 6912, v77
    v_lshl_add_u32 v77, v76, 4, v77
    v_subrev_u32 v63, 3072, v77
    v_add_u32 v76, 512, v0
    v_mul_u32_u24 v77, 1821, v76
    v_lshrrev_b32 v77, 18, v77
    v_mul_u32_u24 v77, 6912, v77
    v_lshl_add_u32 v77, v76, 4, v77
    v_subrev_u32 v64, 0, v77
    s_mul_i32 s48, s55, 3
    s_add_u32 s49, s48, 2
    s_lshr_b32 s48, s48, 1
    s_lshr_b32 s49, s49, 1
    v_mov_b32 v76, s48
    v_mov_b32 v77, s49
    v_cmp_gt_u32 vcc, 32, v0
    s_nop 1
    v_cndmask_b32 v76, v77, v76, vcc
    v_and_b32 v77, 31, v0
    v_min_u32 v77, 8, v77
    v_lshl_add_u32 v76, v76, 6, v77
    s_mul_i32 s48, s53, 9
    v_add_u32 v76, s48, v76
    v_lshlrev_b32 v66, 4, v76
    s_lshr_b32 s48, s54, 3
    s_lshl_b32 s48, s48, 2
    s_and_b32 s49, s54, 1
    s_lshl_b32 s49, s49, 1
    s_add_u32 s48, s48, s49
    s_add_u32 s48, s48, s62
    s_lshl_b32 s48, s48, 13
    s_add_u32 s48, s48, 15990784
    v_lshl_add_u32 v67, v0, 7, s48
    v_mov_b32 v68, 0
    s_lshl_b32 s48, s54, 7
    s_lshr_b32 s49, s53, 1
    s_lshl_b32 s49, s49, 4
    s_add_u32 s48, s48, s49
    s_mul_i32 s48, s48, 1152
    s_mul_i32 s49, s55, 288
    s_add_u32 s48, s48, s49
    s_and_b32 s49, s53, 1
    s_mul_i32 s49, s49, 144
    s_add_u32 s48, s48, s49
    s_add_u32 s12, s48, 12582912
    s_lshl_b32 s13, s62, 6
    v_add_u32 v76, s13, v0
    v_mul_u32_u24 v77, 911, v76
    v_lshrrev_b32 v77, 13, v77
    v_mul_u32_u24 v78, 9, v77
    v_sub_u32 v78, v76, v78
    v_and_b32 v76, 48, v77
    v_add_u32 v77, v77, v76
    v_mul_u32_u24 v77, 1152, v77
    v_lshl_add_u32 v77, v78, 4, v77
    v_add_u32 v70, s12, v77
    s_add_u32 s13, s13, 128
    v_add_u32 v76, s13, v0
    v_mul_u32_u24 v77, 911, v76
    v_lshrrev_b32 v77, 13, v77
    v_mul_u32_u24 v78, 9, v77
    v_sub_u32 v78, v76, v78
    v_and_b32 v76, 48, v77
    v_add_u32 v77, v77, v76
    v_mul_u32_u24 v77, 1152, v77
    v_lshl_add_u32 v77, v78, 4, v77
    v_add_u32 v71, s12, v77
    s_add_u32 s13, s13, 128
    v_add_u32 v76, s13, v0
    v_mul_u32_u24 v77, 911, v76
    v_lshrrev_b32 v77, 13, v77
    v_mul_u32_u24 v78, 9, v77
    v_sub_u32 v78, v76, v78
    v_and_b32 v76, 48, v77
    v_add_u32 v77, v77, v76
    v_mul_u32_u24 v77, 1152, v77
    v_lshl_add_u32 v77, v78, 4, v77
    v_add_u32 v72, s12, v77
    s_add_u32 s13, s13, 128
    v_add_u32 v76, s13, v0
    v_mul_u32_u24 v77, 911, v76
    v_lshrrev_b32 v77, 13, v77
    v_mul_u32_u24 v78, 9, v77
    v_sub_u32 v78, v76, v78
    v_and_b32 v76, 48, v77
    v_add_u32 v77, v77, v76
    v_mul_u32_u24 v77, 1152, v77
    v_lshl_add_u32 v77, v78, 4, v77
    v_add_u32 v73, s12, v77
    s_add_u32 s13, s13, 128
    v_add_u32 v76, s13, v0
    v_mul_u32_u24 v77, 911, v76
    v_lshrrev_b32 v77, 13, v77
    v_mul_u32_u24 v78, 9, v77
    v_sub_u32 v78, v76, v78
    v_and_b32 v76, 48, v77
    v_add_u32 v77, v77, v76
    v_mul_u32_u24 v77, 1152, v77
    v_lshl_add_u32 v77, v78, 4, v77
    v_add_u32 v74, s12, v77
    s_add_u32 s13, s13, 128
    s_mul_i32 s48, s55, 576
    s_and_b32 s49, s53, 1
    s_mul_i32 s49, s49, 288
    s_add_u32 s48, s48, s49
    s_add_u32 s48, s48, 11520
    v_min_u32 v76, 272, v8
    v_add_u32 v76, s48, v76
    s_cmp_eq_u32 s62, 1
    s_cselect_b64 vcc, -1, 0
    v_cndmask_b32 v74, v74, v76, vcc
    s_waitcnt vmcnt(0)
    s_barrier
    buffer_store_dwordx4 v[28:31], v22, s[36:39], s57 offen sc1
    buffer_store_dwordx4 v[32:35], v23, s[36:39], s57 offen sc1
    buffer_store_dwordx4 v[36:39], v24, s[36:39], s57 offen sc1
    buffer_store_dwordx4 v[40:43], v25, s[36:39], s57 offen sc1
    buffer_store_dwordx4 v[44:47], v26, s[36:39], s57 offen sc1
    s_barrier
    s_waitcnt vmcnt(0)
    buffer_store_dwordx4 v[48:51], v54, s[36:39], 0 offen sc1
Lp_m_56:
    buffer_load_dword v4, v27, s[36:39], s65 offen sc1
    buffer_load_dword v5, v27, s[36:39], s69 offen sc1
    s_waitcnt vmcnt(0)
    v_cmp_ne_u32 vcc, v3, v4
    v_cmp_ne_u32 s[48:49], v3, v5
    s_nop 0
    s_or_b64 vcc, vcc, s[48:49]
    s_cbranch_vccz Le_m_57
    s_sub_u32 s7, s7, 1
    s_cbranch_scc1 Le_m_57
    s_mov_b64 exec, vcc
    s_sleep 1
    s_branch Lp_m_56
Le_m_57:
    s_mov_b64 exec, -1
    s_max_i32 s7, s7, 0
    s_add_u32 m0, s68, 98304
    s_nop 0
    buffer_load_dwordx4 v8, s[36:39], s50 offen offset:0 sc1 lds
    buffer_load_dwordx4 v13, s[36:39], s50 offen offset:1024 sc1 lds
    buffer_load_dwordx4 v14, s[36:39], s50 offen offset:2048 sc1 lds
    s_add_u32 m0, s68, 101376
    s_nop 0
    buffer_load_dwordx4 v15, s[36:39], s50 offen offset:0 sc1 lds
    buffer_load_dwordx4 v16, s[36:39], s50 offen offset:1024 sc1 lds
    buffer_load_dwordx4 v17, s[36:39], s50 offen offset:2048 sc1 lds
    s_add_u32 s50, s58, 663552
    s_cmp_ge_u32 s50, s59
    s_cselect_b32 s48, 2359296, 0
    s_sub_u32 s50, s50, s48
    s_add_u32 m0, s68, 110592
    s_nop 0
    buffer_load_dwordx4 v8, s[36:39], s50 offen offset:0 sc1 lds
    buffer_load_dwordx4 v13, s[36:39], s50 offen offset:1024 sc1 lds
    buffer_load_dwordx4 v14, s[36:39], s50 offen offset:2048 sc1 lds
    s_add_u32 m0, s68, 113664
    s_nop 0
    buffer_load_dwordx4 v15, s[36:39], s50 offen offset:0 sc1 lds
    buffer_load_dwordx4 v16, s[36:39], s50 offen offset:1024 sc1 lds
    buffer_load_dwordx4 v17, s[36:39], s50 offen offset:2048 sc1 lds
    s_add_u32 s50, s58, 737280
    s_cmp_ge_u32 s50, s59
    s_cselect_b32 s48, 2359296, 0
    s_sub_u32 s50, s50, s48
    s_waitcnt vmcnt(6)
    s_barrier
    s_add_u32 m0, s68, 122880
    s_nop 0
    buffer_load_dwordx4 v8, s[36:39], s50 offen offset:0 sc1 lds
    buffer_load_dwordx4 v13, s[36:39], s50 offen offset:1024 sc1 lds
    buffer_load_dwordx4 v14, s[36:39], s50 offen offset:2048 sc1 lds
    s_add_u32 m0, s68, 125952
    s_nop 0
    buffer_load_dwordx4 v15, s[36:39], s50 offen offset:0 sc1 lds
    buffer_load_dwordx4 v16, s[36:39], s50 offen offset:1024 sc1 lds
    buffer_load_dwordx4 v17, s[36:39], s50 offen offset:2048 sc1 lds
    s_add_u32 s50, s58, 811008
    s_cmp_ge_u32 s50, s59
    s_cselect_b32 s48, 2359296, 0
    s_sub_u32 s50, s50, s48
    s_add_u32 m0, s68, 135168
    s_nop 0
    buffer_load_dwordx4 v8, s[36:39], s50 offen offset:0 sc1 lds
    buffer_load_dwordx4 v13, s[36:39], s50 offen offset:1024 sc1 lds
    buffer_load_dwordx4 v14, s[36:39], s50 offen offset:2048 sc1 lds
    s_add_u32 m0, s68, 138240
    s_nop 0
    buffer_load_dwordx4 v15, s[36:39], s50 offen offset:0 sc1 lds
    buffer_load_dwordx4 v16, s[36:39], s50 offen offset:1024 sc1 lds
    buffer_load_dwordx4 v17, s[36:39], s50 offen offset:2048 sc1 lds
    s_add_u32 s50, s58, 884736
    s_cmp_ge_u32 s50, s59
    s_cselect_b32 s48, 2359296, 0
    s_sub_u32 s50, s50, s48
    s_cmp_lg_u32 s35, 0
    s_cbranch_scc1 L_m_58
    buffer_load_dword v53, v52, s[44:47], s8 offen
    buffer_load_dword v53, v52, s[44:47], s9 offen
L_m_58:
    s_waitcnt vmcnt(12)
    s_barrier
    s_add_u32 m0, s68, 147456
    s_nop 0
    buffer_load_dwordx4 v8, s[36:39], s50 offen offset:0 sc1 lds
    buffer_load_dwordx4 v13, s[36:39], s50 offen offset:1024 sc1 lds
    buffer_load_dwordx4 v14, s[36:39], s50 offen offset:2048 sc1 lds
    s_add_u32 m0, s68, 150528
    s_nop 0
    buffer_load_dwordx4 v15, s[36:39], s50 offen offset:0 sc1 lds
    buffer_load_dwordx4 v16, s[36:39], s50 offen offset:1024 sc1 lds
    buffer_load_dwordx4 v17, s[36:39], s50 offen offset:2048 sc1 lds
    s_add_u32 s50, s58, 958464
    s_cmp_ge_u32 s50, s59
    s_cselect_b32 s48, 2359296, 0
    s_sub_u32 s50, s50, s48
    s_cmp_lg_u32 s35, 1
    s_cbranch_scc1 L_m_59
    buffer_load_dword v53, v52, s[44:47], s8 offen
    buffer_load_dword v53, v52, s[44:47], s9 offen
L_m_59:
    s_waitcnt vmcnt(12)
    s_barrier
    s_add_u32 m0, s68, 98304
    s_nop 0
    buffer_load_dwordx4 v8, s[36:39], s50 offen offset:0 sc1 lds
    buffer_load_dwordx4 v13, s[36:39], s50 offen offset:1024 sc1 lds
    buffer_load_dwordx4 v14, s[36:39], s50 offen offset:2048 sc1 lds
    s_add_u32 m0, s68, 101376
    s_nop 0
    buffer_load_dwordx4 v15, s[36:39], s50 offen offset:0 sc1 lds
    buffer_load_dwordx4 v16, s[36:39], s50 offen offset:1024 sc1 lds
    buffer_load_dwordx4 v17, s[36:39], s50 offen offset:2048 sc1 lds
    s_add_u32 s50, s58, 0
    s_cmp_ge_u32 s50, s59
    s_cselect_b32 s48, 2359296, 0
    s_sub_u32 s50, s50, s48
    s_cmp_lg_u32 s35, 2
    s_cbranch_scc1 L_m_60
    buffer_load_dword v53, v52, s[44:47], s8 offen
    buffer_load_dword v53, v52, s[44:47], s9 offen
L_m_60:
    s_waitcnt vmcnt(12)
    s_barrier
    s_add_u32 m0, s68, 110592
    s_nop 0
    buffer_load_dwordx4 v8, s[36:39], s50 offen offset:0 sc1 lds
    buffer_load_dwordx4 v13, s[36:39], s50 offen offset:1024 sc1 lds
    buffer_load_dwordx4 v14, s[36:39], s50 offen offset:2048 sc1 lds
    s_add_u32 m0, s68, 113664
    s_nop 0
    buffer_load_dwordx4 v15, s[36:39], s50 offen offset:0 sc1 lds
    buffer_load_dwordx4 v16, s[36:39], s50 offen offset:1024 sc1 lds
    buffer_load_dwordx4 v17, s[36:39], s50 offen offset:2048 sc1 lds
    s_add_u32 s50, s58, 1032192
    s_cmp_ge_u32 s50, s59
    s_cselect_b32 s48, 2359296, 0
    s_sub_u32 s50, s50, s48
    s_cmp_lg_u32 s35, 3
    s_cbranch_scc1 L_m_61
    buffer_load_dword v53, v52, s[44:47], s8 offen
    buffer_load_dword v53, v52, s[44:47], s9 offen
L_m_61:
    s_waitcnt vmcnt(12)
    s_barrier
    s_add_u32 m0, s68, 122880
    s_nop 0
    buffer_load_dwordx4 v8, s[36:39], s50 offen offset:0 sc1 lds
    buffer_load_dwordx4 v13, s[36:39], s50 offen offset:1024 sc1 lds
    buffer_load_dwordx4 v14, s[36:39], s50 offen offset:2048 sc1 lds
    s_add_u32 m0, s68, 125952
    s_nop 0
    buffer_load_dwordx4 v15, s[36:39], s50 offen offset:0 sc1 lds
    buffer_load_dwordx4 v16, s[36:39], s50 offen offset:1024 sc1 lds
    buffer_load_dwordx4 v17, s[36:39], s50 offen offset:2048 sc1 lds
    s_add_u32 s50, s58, 1105920
    s_cmp_ge_u32 s50, s59
    s_cselect_b32 s48, 2359296, 0
    s_sub_u32 s50, s50, s48
    s_cmp_lg_u32 s35, 4
    s_cbranch_scc1 L_m_62
    buffer_load_dword v53, v52, s[44:47], s8 offen
    buffer_load_dword v53, v52, s[44:47], s9 offen
L_m_62:
    s_waitcnt vmcnt(12)
    s_barrier
    s_add_u32 m0, s68, 135168
    s_nop 0
    buffer_load_dwordx4 v8, s[36:39], s50 offen offset:0 sc1 lds
    buffer_load_dwordx4 v13, s[36:39], s50 offen offset:1024 sc1 lds
    buffer_load_dwordx4 v14, s[36:39], s50 offen offset:2048 sc1 lds
    s_add_u32 m0, s68, 138240
    s_nop 0
    buffer_load_dwordx4 v15, s[36:39], s50 offen offset:0 sc1 lds
    buffer_load_dwordx4 v16, s[36:39], s50 offen offset:1024 sc1 lds
    buffer_load_dwordx4 v17, s[36:39], s50 offen offset:2048 sc1 lds
    s_add_u32 s50, s58, 73728
    s_cmp_ge_u32 s50, s59
    s_cselect_b32 s48, 2359296, 0
    s_sub_u32 s50, s50, s48
    s_cmp_lg_u32 s35, 5
    s_cbranch_scc1 L_m_63
    buffer_load_dword v53, v52, s[44:47], s8 offen
    buffer_load_dword v53, v52, s[44:47], s9 offen
L_m_63:
    s_waitcnt vmcnt(12)
    s_barrier
    s_add_u32 m0, s68, 147456
    s_nop 0
    buffer_load_dwordx4 v8, s[36:39], s50 offen offset:0 sc1 lds
    buffer_load_dwordx4 v13, s[36:39], s50 offen offset:1024 sc1 lds
    buffer_load_dwordx4 v14, s[36:39], s50 offen offset:2048 sc1 lds
    s_add_u32 m0, s68, 150528
    s_nop 0
    buffer_load_dwordx4 v15, s[36:39], s50 offen offset:0 sc1 lds
    buffer_load_dwordx4 v16, s[36:39], s50 offen offset:1024 sc1 lds
    buffer_load_dwordx4 v17, s[36:39], s50 offen offset:2048 sc1 lds
    s_add_u32 s50, s58, 1179648
    s_cmp_ge_u32 s50, s59
    s_cselect_b32 s48, 2359296, 0
    s_sub_u32 s50, s50, s48
    s_cmp_lg_u32 s35, 6
    s_cbranch_scc1 L_m_64
    buffer_load_dword v53, v52, s[44:47], s8 offen
    buffer_load_dword v53, v52, s[44:47], s9 offen
L_m_64:
    s_waitcnt vmcnt(12)
    s_barrier
    s_add_u32 m0, s68, 98304
    s_nop 0
    buffer_load_dwordx4 v8, s[36:39], s50 offen offset:0 sc1 lds
    buffer_load_dwordx4 v13, s[36:39], s50 offen offset:1024 sc1 lds
    buffer_load_dwordx4 v14, s[36:39], s50 offen offset:2048 sc1 lds
    s_add_u32 m0, s68, 101376
    s_nop 0
    buffer_load_dwordx4 v15, s[36:39], s50 offen offset:0 sc1 lds
    buffer_load_dwordx4 v16, s[36:39], s50 offen offset:1024 sc1 lds
    buffer_load_dwordx4 v17, s[36:39], s50 offen offset:2048 sc1 lds
    s_add_u32 s50, s58, 1253376
    s_cmp_ge_u32 s50, s59
    s_cselect_b32 s48, 2359296, 0
    s_sub_u32 s50, s50, s48
    s_cmp_lg_u32 s35, 7
    s_cbranch_scc1 L_m_65
    buffer_load_dword v53, v52, s[44:47], s8 offen
    buffer_load_dword v53, v52, s[44:47], s9 offen
L_m_65:
    s_waitcnt vmcnt(12)
    s_barrier
    s_add_u32 m0, s68, 110592
    s_nop 0
    buffer_load_dwordx4 v8, s[36:39], s50 offen offset:0 sc1 lds
    buffer_load_dwordx4 v13, s[36:39], s50 offen offset:1024 sc1 lds
    buffer_load_dwordx4 v14, s[36:39], s50 offen offset:2048 sc1 lds
    s_add_u32 m0, s68, 113664
    s_nop 0
    buffer_load_dwordx4 v15, s[36:39], s50 offen offset:0 sc1 lds
    buffer_load_dwordx4 v16, s[36:39], s50 offen offset:1024 sc1 lds
    buffer_load_dwordx4 v17, s[36:39], s50 offen offset:2048 sc1 lds
    s_add_u32 s50, s58, 147456
    s_cmp_ge_u32 s50, s59
    s_cselect_b32 s48, 2359296, 0
    s_sub_u32 s50, s50, s48
    s_cmp_lg_u32 s35, 8
    s_cbranch_scc1 L_m_66
    buffer_load_dword v53, v52, s[44:47], s8 offen
    buffer_load_dword v53, v52, s[44:47], s9 offen
L_m_66:
    s_waitcnt vmcnt(12)
    s_barrier
    s_add_u32 m0, s68, 122880
    s_nop 0
    buffer_load_dwordx4 v8, s[36:39], s50 offen offset:0 sc1 lds
    buffer_load_dwordx4 v13, s[36:39], s50 offen offset:1024 sc1 lds
    buffer_load_dwordx4 v14, s[36:39], s50 offen offset:2048 sc1 lds
    s_add_u32 m0, s68, 125952
    s_nop 0
    buffer_load_dwordx4 v15, s[36:39], s50 offen offset:0 sc1 lds
    buffer_load_dwordx4 v16, s[36:39], s50 offen offset:1024 sc1 lds
    buffer_load_dwordx4 v17, s[36:39], s50 offen offset:2048 sc1 lds
    s_branch L_skip_13
    s_nop 0
L_stub_13:
    s_branch L_back_a1
L_skip_13:
    s_add_u32 s50, s58, 1327104
    s_cmp_ge_u32 s50, s59
    s_cselect_b32 s48, 2359296, 0
    s_sub_u32 s50, s50, s48
    s_cmp_lg_u32 s35, 9
    s_cbranch_scc1 L_m_67
    buffer_load_dword v53, v52, s[44:47], s8 offen
    buffer_load_dword v53, v52, s[44:47], s9 offen
L_m_67:
    s_waitcnt vmcnt(12)
    s_barrier
    s_add_u32 m0, s68, 135168
    s_nop 0
    buffer_load_dwordx4 v8, s[36:39], s50 offen offset:0 sc1 lds
    buffer_load_dwordx4 v13, s[36:39], s50 offen offset:1024 sc1 lds
    buffer_load_dwordx4 v14, s[36:39], s50 offen offset:2048 sc1 lds
    s_add_u32 m0, s68, 138240
    s_nop 0
    buffer_load_dwordx4 v15, s[36:39], s50 offen offset:0 sc1 lds
    buffer_load_dwordx4 v16, s[36:39], s50 offen offset:1024 sc1 lds
    buffer_load_dwordx4 v17, s[36:39], s50 offen offset:2048 sc1 lds
    s_add_u32 s50, s58, 1400832
    s_cmp_ge_u32 s50, s59
    s_cselect_b32 s48, 2359296, 0
    s_sub_u32 s50, s50, s48
    s_cmp_lg_u32 s35, 10
    s_cbranch_scc1 L_m_68
    buffer_load_dword v53, v52, s[44:47], s8 offen
    buffer_load_dword v53, v52, s[44:47], s9 offen
L_m_68:
    s_waitcnt vmcnt(12)
    s_barrier
    s_add_u32 m0, s68, 147456
    s_nop 0
    buffer_load_dwordx4 v8, s[36:39], s50 offen offset:0 sc1 lds
    buffer_load_dwordx4 v13, s[36:39], s50 offen offset:1024 sc1 lds
    buffer_load_dwordx4 v14, s[36:39], s50 offen offset:2048 sc1 lds
    s_add_u32 m0, s68, 150528
    s_nop 0
    buffer_load_dwordx4 v15, s[36:39], s50 offen offset:0 sc1 lds
    buffer_load_dwordx4 v16, s[36:39], s50 offen offset:1024 sc1 lds
    buffer_load_dwordx4 v17, s[36:39], s50 offen offset:2048 sc1 lds
    s_add_u32 s50, s58, 221184
    s_cmp_ge_u32 s50, s59
    s_cselect_b32 s48, 2359296, 0
    s_sub_u32 s50, s50, s48
    s_cmp_lg_u32 s35, 11
    s_cbranch_scc1 L_m_69
    buffer_load_dword v53, v52, s[44:47], s8 offen
    buffer_load_dword v53, v52, s[44:47], s9 offen
L_m_69:
    s_waitcnt vmcnt(12)
    s_barrier
    s_add_u32 m0, s68, 98304
    s_nop 0
    buffer_load_dwordx4 v8, s[36:39], s50 offen offset:0 sc1 lds
    buffer_load_dwordx4 v13, s[36:39], s50 offen offset:1024 sc1 lds
    buffer_load_dwordx4 v14, s[36:39], s50 offen offset:2048 sc1 lds
    s_add_u32 m0, s68, 101376
    s_nop 0
    buffer_load_dwordx4 v15, s[36:39], s50 offen offset:0 sc1 lds
    buffer_load_dwordx4 v16, s[36:39], s50 offen offset:1024 sc1 lds
    buffer_load_dwordx4 v17, s[36:39], s50 offen offset:2048 sc1 lds
    s_add_u32 s50, s58, 1474560
    s_cmp_ge_u32 s50, s59
    s_cselect_b32 s48, 2359296, 0
    s_sub_u32 s50, s50, s48
    s_cmp_lg_u32 s35, 12
    s_cbranch_scc1 L_m_70
    buffer_load_dword v53, v52, s[44:47], s8 offen
    buffer_load_dword v53, v52, s[44:47], s9 offen
L_m_70:
    s_waitcnt vmcnt(12)
    s_barrier
    s_add_u32 m0, s68, 110592
    s_nop 0
    buffer_load_dwordx4 v8, s[36:39], s50 offen offset:0 sc1 lds
    buffer_load_dwordx4 v13, s[36:39], s50 offen offset:1024 sc1 lds
    buffer_load_dwordx4 v14, s[36:39], s50 offen offset:2048 sc1 lds
    s_add_u32 m0, s68, 113664
    s_nop 0
    buffer_load_dwordx4 v15, s[36:39], s50 offen offset:0 sc1 lds
    buffer_load_dwordx4 v16, s[36:39], s50 offen offset:1024 sc1 lds
    buffer_load_dwordx4 v17, s[36:39], s50 offen offset:2048 sc1 lds
    s_add_u32 s50, s58, 1548288
    s_cmp_ge_u32 s50, s59
    s_cselect_b32 s48, 2359296, 0
    s_sub_u32 s50, s50, s48
    s_cmp_lg_u32 s35, 13
    s_cbranch_scc1 L_m_71
    buffer_load_dword v53, v52, s[44:47], s8 offen
    buffer_load_dword v53, v52, s[44:47], s9 offen
L_m_71:
    s_waitcnt vmcnt(12)
    s_barrier
    s_add_u32 m0, s68, 122880
    s_nop 0
    buffer_load_dwordx4 v8, s[36:39], s50 offen offset:0 sc1 lds
    buffer_load_dwordx4 v13, s[36:39], s50 offen offset:1024 sc1 lds
    buffer_load_dwordx4 v14, s[36:39], s50 offen offset:2048 sc1 lds
    s_add_u32 m0, s68, 125952
    s_nop 0
    buffer_load_dwordx4 v15, s[36:39], s50 offen offset:0 sc1 lds
    buffer_load_dwordx4 v16, s[36:39], s50 offen offset:1024 sc1 lds
    buffer_load_dwordx4 v17, s[36:39], s50 offen offset:2048 sc1 lds
    s_add_u32 s50, s58, 294912
    s_cmp_ge_u32 s50, s59
    s_cselect_b32 s48, 2359296, 0
    s_sub_u32 s50, s50, s48
    s_waitcnt vmcnt(12)
    s_barrier
    s_add_u32 m0, s68, 135168
    s_nop 0
    buffer_load_dwordx4 v8, s[36:39], s50 offen offset:0 sc1 lds
    buffer_load_dwordx4 v13, s[36:39], s50 offen offset:1024 sc1 lds
    buffer_load_dwordx4 v14, s[36:39], s50 offen offset:2048 sc1 lds
    s_add_u32 m0, s68, 138240
    s_nop 0
    buffer_load_dwordx4 v15, s[36:39], s50 offen offset:0 sc1 lds
    buffer_load_dwordx4 v16, s[36:39], s50 offen offset:1024 sc1 lds
    buffer_load_dwordx4 v17, s[36:39], s50 offen offset:2048 sc1 lds
    s_add_u32 s50, s58, 1622016
    s_cmp_ge_u32 s50, s59
    s_cselect_b32 s48, 2359296, 0
    s_sub_u32 s50, s50, s48
    s_waitcnt vmcnt(12)
    s_barrier
    s_add_u32 m0, s68, 147456
    s_nop 0
    buffer_load_dwordx4 v8, s[36:39], s50 offen offset:0 sc1 lds
    buffer_load_dwordx4 v13, s[36:39], s50 offen offset:1024 sc1 lds
    buffer_load_dwordx4 v14, s[36:39], s50 offen offset:2048 sc1 lds
    s_add_u32 m0, s68, 150528
    s_nop 0
    buffer_load_dwordx4 v15, s[36:39], s50 offen offset:0 sc1 lds
    buffer_load_dwordx4 v16, s[36:39], s50 offen offset:1024 sc1 lds
    buffer_load_dwordx4 v17, s[36:39], s50 offen offset:2048 sc1 lds
    s_add_u32 s50, s58, 1695744
    s_cmp_ge_u32 s50, s59
    s_cselect_b32 s48, 2359296, 0
    s_sub_u32 s50, s50, s48
    s_waitcnt vmcnt(12)
    s_barrier
    s_add_u32 m0, s68, 98304
    s_nop 0
    buffer_load_dwordx4 v8, s[36:39], s50 offen offset:0 sc1 lds
    buffer_load_dwordx4 v13, s[36:39], s50 offen offset:1024 sc1 lds
    buffer_load_dwordx4 v14, s[36:39], s50 offen offset:2048 sc1 lds
    s_add_u32 m0, s68, 101376
    s_nop 0
    buffer_load_dwordx4 v15, s[36:39], s50 offen offset:0 sc1 lds
    buffer_load_dwordx4 v16, s[36:39], s50 offen offset:1024 sc1 lds
    buffer_load_dwordx4 v17, s[36:39], s50 offen offset:2048 sc1 lds
    s_add_u32 s50, s58, 368640
    s_cmp_ge_u32 s50, s59
    s_cselect_b32 s48, 2359296, 0
    s_sub_u32 s50, s50, s48
    s_waitcnt vmcnt(12)
    s_barrier
    s_add_u32 m0, s68, 110592
    s_nop 0
    buffer_load_dwordx4 v8, s[36:39], s50 offen offset:0 sc1 lds
    buffer_load_dwordx4 v13, s[36:39], s50 offen offset:1024 sc1 lds
    buffer_load_dwordx4 v14, s[36:39], s50 offen offset:2048 sc1 lds
    s_add_u32 m0, s68, 113664
    s_nop 0
    buffer_load_dwordx4 v15, s[36:39], s50 offen offset:0 sc1 lds
    buffer_load_dwordx4 v16, s[36:39], s50 offen offset:1024 sc1 lds
    buffer_load_dwordx4 v17, s[36:39], s50 offen offset:2048 sc1 lds
    s_add_u32 s50, s58, 1769472
    s_cmp_ge_u32 s50, s59
    s_cselect_b32 s48, 2359296, 0
    s_sub_u32 s50, s50, s48
    s_waitcnt vmcnt(12)
    s_barrier
    s_add_u32 m0, s68, 122880
    s_nop 0
    buffer_load_dwordx4 v8, s[36:39], s50 offen offset:0 sc1 lds
    buffer_load_dwordx4 v13, s[36:39], s50 offen offset:1024 sc1 lds
    buffer_load_dwordx4 v14, s[36:39], s50 offen offset:2048 sc1 lds
    s_add_u32 m0, s68, 125952
    s_nop 0
    buffer_load_dwordx4 v15, s[36:39], s50 offen offset:0 sc1 lds
    buffer_load_dwordx4 v16, s[36:39], s50 offen offset:1024 sc1 lds
    buffer_load_dwordx4 v17, s[36:39], s50 offen offset:2048 sc1 lds
    s_add_u32 s50, s58, 1843200
    s_cmp_ge_u32 s50, s59
    s_cselect_b32 s48, 2359296, 0
    s_sub_u32 s50, s50, s48
    s_waitcnt vmcnt(12)
    s_barrier
    s_add_u32 m0, s68, 135168
    s_nop 0
    buffer_load_dwordx4 v8, s[36:39], s50 offen offset:0 sc1 lds
    buffer_load_dwordx4 v13, s[36:39], s50 offen offset:1024 sc1 lds
    buffer_load_dwordx4 v14, s[36:39], s50 offen offset:2048 sc1 lds
    s_add_u32 m0, s68, 138240
    s_nop 0
    buffer_load_dwordx4 v15, s[36:39], s50 offen offset:0 sc1 lds
    buffer_load_dwordx4 v16, s[36:39], s50 offen offset:1024 sc1 lds
    buffer_load_dwordx4 v17, s[36:39], s50 offen offset:2048 sc1 lds
    s_add_u32 s50, s58, 442368
    s_cmp_ge_u32 s50, s59
    s_cselect_b32 s48, 2359296, 0
    s_sub_u32 s50, s50, s48
    s_waitcnt vmcnt(12)
    s_barrier
    s_add_u32 m0, s68, 147456
    s_nop 0
    buffer_load_dwordx4 v8, s[36:39], s50 offen offset:0 sc1 lds
    buffer_load_dwordx4 v13, s[36:39], s50 offen offset:1024 sc1 lds
    buffer_load_dwordx4 v14, s[36:39], s50 offen offset:2048 sc1 lds
    s_add_u32 m0, s68, 150528
    s_nop 0
    buffer_load_dwordx4 v15, s[36:39], s50 offen offset:0 sc1 lds
    buffer_load_dwordx4 v16, s[36:39], s50 offen offset:1024 sc1 lds
    buffer_load_dwordx4 v17, s[36:39], s50 offen offset:2048 sc1 lds
    s_add_u32 s50, s58, 1916928
    s_cmp_ge_u32 s50, s59
    s_cselect_b32 s48, 2359296, 0
    s_sub_u32 s50, s50, s48
    s_waitcnt vmcnt(12)
    s_barrier
    s_add_u32 m0, s68, 98304
    s_nop 0
    buffer_load_dwordx4 v8, s[36:39], s50 offen offset:0 sc1 lds
    buffer_load_dwordx4 v13, s[36:39], s50 offen offset:1024 sc1 lds
    buffer_load_dwordx4 v14, s[36:39], s50 offen offset:2048 sc1 lds
    s_add_u32 m0, s68, 101376
    s_nop 0
    buffer_load_dwordx4 v15, s[36:39], s50 offen offset:0 sc1 lds
    buffer_load_dwordx4 v16, s[36:39], s50 offen offset:1024 sc1 lds
    buffer_load_dwordx4 v17, s[36:39], s50 offen offset:2048 sc1 lds
    s_add_u32 s50, s58, 1990656
    s_cmp_ge_u32 s50, s59
    s_cselect_b32 s48, 2359296, 0
    s_sub_u32 s50, s50, s48
    s_waitcnt vmcnt(12)
    s_barrier
    s_add_u32 m0, s68, 110592
    s_nop 0
    buffer_load_dwordx4 v8, s[36:39], s50 offen offset:0 sc1 lds
    buffer_load_dwordx4 v13, s[36:39], s50 offen offset:1024 sc1 lds
    buffer_load_dwordx4 v14, s[36:39], s50 offen offset:2048 sc1 lds
    s_add_u32 m0, s68, 113664
    s_nop 0
    buffer_load_dwordx4 v15, s[36:39], s50 offen offset:0 sc1 lds
    buffer_load_dwordx4 v16, s[36:39], s50 offen offset:1024 sc1 lds
    buffer_load_dwordx4 v17, s[36:39], s50 offen offset:2048 sc1 lds
    s_add_u32 s50, s58, 516096
    s_cmp_ge_u32 s50, s59
    s_cselect_b32 s48, 2359296, 0
    s_sub_u32 s50, s50, s48
    s_waitcnt vmcnt(12)
    s_barrier
    s_add_u32 m0, s68, 122880
    s_nop 0
    buffer_load_dwordx4 v8, s[36:39], s50 offen offset:0 sc1 lds
    buffer_load_dwordx4 v13, s[36:39], s50 offen offset:1024 sc1 lds
    buffer_load_dwordx4 v14, s[36:39], s50 offen offset:2048 sc1 lds
    s_add_u32 m0, s68, 125952
    s_nop 0
    buffer_load_dwordx4 v15, s[36:39], s50 offen offset:0 sc1 lds
    buffer_load_dwordx4 v16, s[36:39], s50 offen offset:1024 sc1 lds
    buffer_load_dwordx4 v17, s[36:39], s50 offen offset:2048 sc1 lds
    s_add_u32 s50, s58, 2064384
    s_cmp_ge_u32 s50, s59
    s_cselect_b32 s48, 2359296, 0
    s_sub_u32 s50, s50, s48
    s_waitcnt vmcnt(12)
    s_barrier
    s_add_u32 m0, s68, 135168
    s_nop 0
    buffer_load_dwordx4 v8, s[36:39], s50 offen offset:0 sc1 lds
    buffer_load_dwordx4 v13, s[36:39], s50 offen offset:1024 sc1 lds
    buffer_load_dwordx4 v14, s[36:39], s50 offen offset:2048 sc1 lds
    s_add_u32 m0, s68, 138240
    s_nop 0
    buffer_load_dwordx4 v15, s[36:39], s50 offen offset:0 sc1 lds
    buffer_load_dwordx4 v16, s[36:39], s50 offen offset:1024 sc1 lds
    buffer_load_dwordx4 v17, s[36:39], s50 offen offset:2048 sc1 lds
    s_add_u32 s50, s58, 2138112
    s_cmp_ge_u32 s50, s59
    s_cselect_b32 s48, 2359296, 0
    s_sub_u32 s50, s50, s48
    s_waitcnt vmcnt(12)
    s_barrier
    s_add_u32 m0, s68, 147456
    s_nop 0
    buffer_load_dwordx4 v8, s[36:39], s50 offen offset:0 sc1 lds
    buffer_load_dwordx4 v13, s[36:39], s50 offen offset:1024 sc1 lds
    buffer_load_dwordx4 v14, s[36:39], s50 offen offset:2048 sc1 lds
    s_add_u32 m0, s68, 150528
    s_nop 0
    buffer_load_dwordx4 v15, s[36:39], s50 offen offset:0 sc1 lds
    buffer_load_dwordx4 v16, s[36:39], s50 offen offset:1024 sc1 lds
    buffer_load_dwordx4 v17, s[36:39], s50 offen offset:2048 sc1 lds
    s_add_u32 s50, s58, 2211840
    s_cmp_ge_u32 s50, s59
    s_cselect_b32 s48, 2359296, 0
    s_sub_u32 s50, s50, s48
    s_waitcnt vmcnt(12)
    s_barrier
    s_add_u32 m0, s68, 98304
    s_nop 0
    buffer_load_dwordx4 v8, s[36:39], s50 offen offset:0 sc1 lds
    buffer_load_dwordx4 v13, s[36:39], s50 offen offset:1024 sc1 lds
    buffer_load_dwordx4 v14, s[36:39], s50 offen offset:2048 sc1 lds
    s_add_u32 m0, s68, 101376
    s_nop 0
    buffer_load_dwordx4 v15, s[36:39], s50 offen offset:0 sc1 lds
    buffer_load_dwordx4 v16, s[36:39], s50 offen offset:1024 sc1 lds
    buffer_load_dwordx4 v17, s[36:39], s50 offen offset:2048 sc1 lds
    s_add_u32 s50, s58, 2285568
    s_cmp_ge_u32 s50, s59
    s_cselect_b32 s48, 2359296, 0
    s_sub_u32 s50, s50, s48
    s_waitcnt vmcnt(12)
    s_barrier
    s_add_u32 m0, s68, 110592
    s_nop 0
    buffer_load_dwordx4 v8, s[36:39], s50 offen offset:0 sc1 lds
    buffer_load_dwordx4 v13, s[36:39], s50 offen offset:1024 sc1 lds
    buffer_load_dwordx4 v14, s[36:39], s50 offen offset:2048 sc1 lds
    s_add_u32 m0, s68, 113664
    s_nop 0
    buffer_load_dwordx4 v15, s[36:39], s50 offen offset:0 sc1 lds
    buffer_load_dwordx4 v16, s[36:39], s50 offen offset:1024 sc1 lds
    buffer_load_dwordx4 v17, s[36:39], s50 offen offset:2048 sc1 lds
    buffer_load_dword v68, v67, s[36:39], 0 offen sc1
    s_waitcnt vmcnt(12)
    s_barrier
    s_waitcnt vmcnt(6)
    s_barrier
    s_waitcnt vmcnt(0)
    s_barrier
    s_branch L_m_55
L_m_54:
    s_waitcnt lgkmcnt(0)
    buffer_store_dwordx4 v[28:31], v22, s[36:39], s57 offen sc1
    buffer_store_dwordx4 v[32:35], v23, s[36:39], s57 offen sc1
    buffer_store_dwordx4 v[36:39], v24, s[36:39], s57 offen sc1
    buffer_store_dwordx4 v[40:43], v25, s[36:39], s57 offen sc1
    buffer_store_dwordx4 v[44:47], v26, s[36:39], s57 offen sc1
    s_waitcnt vmcnt(0)
    s_barrier
    buffer_store_dword v3, v10, s[36:39], 0 offen sc1
    buffer_store_dwordx4 v[48:51], v54, s[36:39], 0 offen sc1
    v_add_u32 v76, 0, v0
    v_mul_u32_u24 v77, 1821, v76
    v_lshrrev_b32 v77, 18, v77
    v_mul_u32_u24 v77, 6912, v77
    v_lshl_add_u32 v77, v76, 4, v77
    v_subrev_u32 v56, 0, v77
    v_add_u32 v76, 64, v0
    v_mul_u32_u24 v77, 1821, v76
    v_lshrrev_b32 v77, 18, v77
    v_mul_u32_u24 v77, 6912, v77
    v_lshl_add_u32 v77, v76, 4, v77
    v_subrev_u32 v57, 1024, v77
    v_add_u32 v76, 128, v0
    v_mul_u32_u24 v77, 1821, v76
    v_lshrrev_b32 v77, 18, v77
    v_mul_u32_u24 v77, 6912, v77
    v_lshl_add_u32 v77, v76, 4, v77
    v_subrev_u32 v58, 2048, v77
    v_add_u32 v76, 192, v0
    v_mul_u32_u24 v77, 1821, v76
    v_lshrrev_b32 v77, 18, v77
    v_mul_u32_u24 v77, 6912, v77
    v_lshl_add_u32 v77, v76, 4, v77
    v_subrev_u32 v59, 3072, v77
    v_add_u32 v76, 256, v0
    v_mul_u32_u24 v77, 1821, v76
    v_lshrrev_b32 v77, 18, v77
    v_mul_u32_u24 v77, 6912, v77
    v_lshl_add_u32 v77, v76, 4, v77
    v_subrev_u32 v60, 0, v77
    v_add_u32 v76, 320, v0
    v_mul_u32_u24 v77, 1821, v76
    v_lshrrev_b32 v77, 18, v77
    v_mul_u32_u24 v77, 6912, v77
    v_lshl_add_u32 v77, v76, 4, v77
    v_subrev_u32 v61, 1024, v77
    v_add_u32 v76, 384, v0
    v_mul_u32_u24 v77, 1821, v76
    v_lshrrev_b32 v77, 18, v77
    v_mul_u32_u24 v77, 6912, v77
    v_lshl_add_u32 v77, v76, 4, v77
    v_subrev_u32 v62, 2048, v77
    v_add_u32 v76, 448, v0
    v_mul_u32_u24 v77, 1821, v76
    v_lshrrev_b32 v77, 18, v77
    v_mul_u32_u24 v77, 6912, v77
    v_lshl_add_u32 v77, v76, 4, v77
    v_subrev_u32 v63, 3072, v77
    v_add_u32 v76, 512, v0
    v_mul_u32_u24 v77, 1821, v76
    v_lshrrev_b32 v77, 18, v77
    v_mul_u32_u24 v77, 6912, v77
    v_lshl_add_u32 v77, v76, 4, v77
    v_subrev_u32 v64, 0, v77
    s_mul_i32 s48, s55, 3
    s_add_u32 s49, s48, 2
    s_lshr_b32 s48, s48, 1
    s_lshr_b32 s49, s49, 1
    v_mov_b32 v76, s48
    v_mov_b32 v77, s49
    v_cmp_gt_u32 vcc, 32, v0
    s_nop 1
    v_cndmask_b32 v76, v77, v76, vcc
    v_and_b32 v77, 31, v0
    v_min_u32 v77, 8, v77
    v_lshl_add_u32 v76, v76, 6, v77
    s_mul_i32 s48, s53, 9
    v_add_u32 v76, s48, v76
    v_lshlrev_b32 v66, 4, v76
    s_lshr_b32 s48, s54, 3
    s_lshl_b32 s48, s48, 2
    s_and_b32 s49, s54, 1
    s_lshl_b32 s49, s49, 1
    s_add_u32 s48, s48, s49
    s_add_u32 s48, s48, s62
    s_lshl_b32 s48, s48, 13
    s_add_u32 s48, s48, 15990784
    v_lshl_add_u32 v67, v0, 7, s48
    v_mov_b32 v68, 0
    s_lshl_b32 s48, s54, 7
    s_lshr_b32 s49, s53, 1
    s_lshl_b32 s49, s49, 4
    s_add_u32 s48, s48, s49
    s_mul_i32 s48, s48, 1152
    s_mul_i32 s49, s55, 288
    s_add_u32 s48, s48, s49
    s_and_b32 s49, s53, 1
    s_mul_i32 s49, s49, 144
    s_add_u32 s48, s48, s49
    s_add_u32 s12, s48, 12582912
    s_lshl_b32 s13, s62, 6
    v_add_u32 v76, s13, v0
    v_mul_u32_u24 v77, 911, v76
    v_lshrrev_b32 v77, 13, v77
    v_mul_u32_u24 v78, 9, v77
    v_sub_u32 v78, v76, v78
    v_and_b32 v76, 48, v77
    v_add_u32 v77, v77, v76
    v_mul_u32_u24 v77, 1152, v77
    v_lshl_add_u32 v77, v78, 4, v77
    v_add_u32 v70, s12, v77
    s_add_u32 s13, s13, 128
    v_add_u32 v76, s13, v0
    v_mul_u32_u24 v77, 911, v76
    v_lshrrev_b32 v77, 13, v77
    v_mul_u32_u24 v78, 9, v77
    v_sub_u32 v78, v76, v78
    v_and_b32 v76, 48, v77
    v_add_u32 v77, v77, v76
    v_mul_u32_u24 v77, 1152, v77
    v_lshl_add_u32 v77, v78, 4, v77
    v_add_u32 v71, s12, v77
    s_add_u32 s13, s13, 128
    v_add_u32 v76, s13, v0
    v_mul_u32_u24 v77, 911, v76
    v_lshrrev_b32 v77, 13, v77
    v_mul_u32_u24 v78, 9, v77
    v_sub_u32 v78, v76, v78
    v_and_b32 v76, 48, v77
    v_add_u32 v77, v77, v76
    v_mul_u32_u24 v77, 1152, v77
    v_lshl_add_u32 v77, v78, 4, v77
    v_add_u32 v72, s12, v77
    s_add_u32 s13, s13, 128
    v_add_u32 v76, s13, v0
    v_mul_u32_u24 v77, 911, v76
    v_lshrrev_b32 v77, 13, v77
    v_mul_u32_u24 v78, 9, v77
    v_sub_u32 v78, v76, v78
    v_and_b32 v76, 48, v77
    v_add_u32 v77, v77, v76
    v_mul_u32_u24 v77, 1152, v77
    v_lshl_add_u32 v77, v78, 4, v77
    v_add_u32 v73, s12, v77
    s_add_u32 s13, s13, 128
    v_add_u32 v76, s13, v0
    v_mul_u32_u24 v77, 911, v76
    v_lshrrev_b32 v77, 13, v77
    v_mul_u32_u24 v78, 9, v77
    v_sub_u32 v78, v76, v78
    v_and_b32 v76, 48, v77
    v_add_u32 v77, v77, v76
    v_mul_u32_u24 v77, 1152, v77
    v_lshl_add_u32 v77, v78, 4, v77
    v_add_u32 v74, s12, v77
    s_add_u32 s13, s13, 128
    s_mul_i32 s48, s55, 576
    s_and_b32 s49, s53, 1
    s_mul_i32 s49, s49, 288
    s_add_u32 s48, s48, s49
    s_add_u32 s48, s48, 11520
    v_min_u32 v76, 272, v8
    v_add_u32 v76, s48, v76
    s_cmp_eq_u32 s62, 1
    s_cselect_b64 vcc, -1, 0
    v_cndmask_b32 v74, v74, v76, vcc
    s_waitcnt vmcnt(0)
Lp_m_72:
    buffer_load_dword v4, v27, s[36:39], s65 offen sc1
    buffer_load_dword v5, v27, s[36:39], s69 offen sc1
    s_waitcnt vmcnt(0)
    v_cmp_ne_u32 vcc, v3, v4
    v_cmp_ne_u32 s[48:49], v3, v5
    s_nop 0
    s_or_b64 vcc, vcc, s[48:49]
    s_cbranch_vccz Le_m_73
    s_sub_u32 s7, s7, 1
    s_cbranch_scc1 Le_m_73
    s_mov_b64 exec, vcc
    s_sleep 1
    s_branch Lp_m_72
Le_m_73:
    s_mov_b64 exec, -1
    s_max_i32 s7, s7, 0
L_m_55:
    s_mul_i32 s67, s55, 2304
    s_mul_i32 s48, s53, 1327104
    s_add_u32 s67, s67, s48
    s_mul_i32 s48, s62, 36864
    s_add_u32 s67, s67, s48
    s_add_u32 s67, s67, 20971520
    s_mul_i32 s57, s62, 9216
    s_add_u32 s48, s57, 90112
    v_add_u32 v85, s48, v8
    v_add_u32 v90, 73728, v85
    s_mul_i32 s58, s64, 73728
    s_add_u32 s58, s58, s67
    s_add_u32 s59, s67, 1327104
    s_waitcnt vmcnt(0)
    v_cmp_ne_u32 vcc, v3, v68
    s_nop 0
    s_cbranch_vccz L_m_74
Lp_m_75:
    buffer_load_dword v68, v67, s[36:39], 0 offen sc1
    s_waitcnt vmcnt(0)
    v_cmp_ne_u32 vcc, v3, v68
    s_nop 0
    s_cbranch_vccz Le_m_76
    s_sub_u32 s7, s7, 1
    s_cbranch_scc1 Le_m_76
    s_mov_b64 exec, vcc
    s_sleep 1
    s_branch Lp_m_75
Le_m_76:
    s_mov_b64 exec, -1
    s_max_i32 s7, s7, 0
L_m_74:
    v_lshrrev_b32 v52, 4, v0
    v_and_b32 v53, 15, v0
    v_lshlrev_b32 v52, 12, v52
    v_lshl_add_u32 v52, v53, 7, v52
    s_lshr_b32 s48, s4, 1
    s_mul_i32 s48, s48, 4718592
    s_and_b32 s49, s4, 1
    s_lshl_b32 s49, s49, 11
    s_add_u32 s48, s48, s49
    v_add_u32 v52, s48, v52
    s_mov_b32 s35, 0
    s_mov_b32 s49, s35
    s_mul_i32 s48, s62, 1
    s_add_u32 s49, s49, s48
    s_bfm_b32 s48, s5, 0
    s_and_b32 s48, s48, 0
    s_bcnt1_i32_b32 s48, s48
    s_sub_u32 s12, s5, s48
    s_mul_i32 s35, s12, 4
    s_add_u32 s35, s35, 160
    s_add_u32 s35, s35, s49
    s_min_u32 s35, s35, 287
    s_lshl_b32 s8, s35, 14
    s_mul_i32 s35, s12, 4
    s_add_u32 s35, s35, 162
    s_add_u32 s35, s35, s49
    s_min_u32 s35, s35, 287
    s_lshl_b32 s9, s35, 14
    s_mul_i32 s35, s12, 64
    s_lshr_b32 s35, s35, 8
    s_add_u32 s35, s35, 0
    s_mov_b32 s48, 0
    s_bitcmp1_b32 s48, s5
    s_cselect_b32 s35, 999, s35
    s_barrier
    s_branch L_stub_14
L_back_a2:
    s_barrier
    s_barrier
    s_barrier
    s_cmp_ge_u32 s5, 27
    s_cbranch_scc1 L_m_77
    buffer_store_dword v3, v11, s[36:39], 0 offen sc1
    s_branch L_m_78
L_m_77:
    s_lshl_b32 s50, s2, 7
    s_add_u32 s50, s50, 622592
    v_mov_b32 v28, 0
Lp_m_79:
    buffer_load_dword v29, v28, s[36:39], s50 offen sc1
    s_waitcnt vmcnt(0)
    v_cmp_ne_u32 vcc, v3, v29
    s_nop 0
    s_cbranch_vccz Le_m_80
    s_sub_u32 s7, s7, 1
    s_cbranch_scc1 Le_m_80
    s_sleep 4
    s_branch Lp_m_79
Le_m_80:
    s_max_i32 s7, s7, 0
L_m_78:
    s_add_u32 s50, s58, 442368
    s_cmp_ge_u32 s50, s59
    s_cselect_b32 s48, 1327104, 0
    s_sub_u32 s50, s50, s48
    s_add_u32 m0, s57, 90112
    s_nop 0
    buffer_load_dwordx4 v56, s[36:39], s50 offen offset:0 sc1 lds
    buffer_load_dwordx4 v57, s[36:39], s50 offen offset:1024 sc1 lds
    buffer_load_dwordx4 v58, s[36:39], s50 offen offset:2048 sc1 lds
    buffer_load_dwordx4 v59, s[36:39], s50 offen offset:3072 sc1 lds
    s_add_u32 m0, s57, 94208
    s_nop 0
    buffer_load_dwordx4 v60, s[36:39], s50 offen offset:0 sc1 lds
    buffer_load_dwordx4 v61, s[36:39], s50 offen offset:1024 sc1 lds
    buffer_load_dwordx4 v62, s[36:39], s50 offen offset:2048 sc1 lds
    buffer_load_dwordx4 v63, s[36:39], s50 offen offset:3072 sc1 lds
    s_add_u32 m0, s57, 98304
    s_nop 0
    buffer_load_dwordx4 v64, s[36:39], s50 offen offset:0 sc1 lds
    s_add_u32 s50, s58, 516096
    s_cmp_ge_u32 s50, s59
    s_cselect_b32 s48, 1327104, 0
    s_sub_u32 s50, s50, s48
    s_add_u32 m0, s57, 108544
    s_nop 0
    buffer_load_dwordx4 v56, s[36:39], s50 offen offset:0 sc1 lds
    buffer_load_dwordx4 v57, s[36:39], s50 offen offset:1024 sc1 lds
    buffer_load_dwordx4 v58, s[36:39], s50 offen offset:2048 sc1 lds
    buffer_load_dwordx4 v59, s[36:39], s50 offen offset:3072 sc1 lds
    s_add_u32 m0, s57, 112640
    s_nop 0
    buffer_load_dwordx4 v60, s[36:39], s50 offen offset:0 sc1 lds
    buffer_load_dwordx4 v61, s[36:39], s50 offen offset:1024 sc1 lds
    buffer_load_dwordx4 v62, s[36:39], s50 offen offset:2048 sc1 lds
    buffer_load_dwordx4 v63, s[36:39], s50 offen offset:3072 sc1 lds
    s_add_u32 m0, s57, 116736
    s_nop 0
    buffer_load_dwordx4 v64, s[36:39], s50 offen offset:0 sc1 lds
    s_add_u32 s50, s58, 589824
    s_cmp_ge_u32 s50, s59
    s_cselect_b32 s48, 1327104, 0
    s_sub_u32 s50, s50, s48
    s_add_u32 m0, s57, 126976
    s_nop 0
    buffer_load_dwordx4 v56, s[36:39], s50 offen offset:0 sc1 lds
    buffer_load_dwordx4 v57, s[36:39], s50 offen offset:1024 sc1 lds
    buffer_load_dwordx4 v58, s[36:39], s50 offen offset:2048 sc1 lds
    buffer_load_dwordx4 v59, s[36:39], s50 offen offset:3072 sc1 lds
    s_add_u32 m0, s57, 131072
    s_nop 0
    buffer_load_dwordx4 v60, s[36:39], s50 offen offset:0 sc1 lds
    buffer_load_dwordx4 v61, s[36:39], s50 offen offset:1024 sc1 lds
    buffer_load_dwordx4 v62, s[36:39], s50 offen offset:2048 sc1 lds
    buffer_load_dwordx4 v63, s[36:39], s50 offen offset:3072 sc1 lds
    s_add_u32 m0, s57, 135168
    s_nop 0
    buffer_load_dwordx4 v64, s[36:39], s50 offen offset:0 sc1 lds
    s_add_u32 s50, s58, 663552
    s_cmp_ge_u32 s50, s59
    s_cselect_b32 s48, 1327104, 0
    s_sub_u32 s50, s50, s48
    s_waitcnt vmcnt(18)
L_m_81:
    ds_read_b32 v76, v85 offset:0
    ds_read_b32 v77, v85 offset:1024
    ds_read_b32 v78, v85 offset:2048
    ds_read_b32 v79, v85 offset:3072
    ds_read_b32 v80, v85 offset:4096
    ds_read_b32 v81, v85 offset:5120
    ds_read_b32 v82, v85 offset:6144
    s_branch L_skip_14
    s_nop 0
L_stub_14:
    s_branch L_back_a2
L_skip_14:
    ds_read_b32 v83, v85 offset:7168
    ds_read_b32 v84, v85 offset:8192
    s_waitcnt lgkmcnt(6)
    v_max3_u32 v76, v76, v77, v78
    s_waitcnt lgkmcnt(4)
    v_max3_u32 v76, v76, v79, v80
    s_waitcnt lgkmcnt(2)
    v_max3_u32 v76, v76, v81, v82
    s_waitcnt lgkmcnt(0)
    v_max3_u32 v76, v76, v83, v84
    v_cmp_eq_u32 vcc, -1, v76
    s_nop 0
    s_cbranch_vccz L_m_82
    s_sub_u32 s7, s7, 1
    s_cbranch_scc1 L_m_82
    s_mov_b32 s14, m0
    s_sleep 2
    s_add_u32 s15, s58, 442368
    s_cmp_ge_u32 s15, s59
    s_cselect_b32 s48, 1327104, 0
    s_sub_u32 s15, s15, s48
    s_add_u32 m0, s57, 90112
    s_nop 0
    buffer_load_dwordx4 v56, s[36:39], s15 offen offset:0 sc1 lds
    buffer_load_dwordx4 v57, s[36:39], s15 offen offset:1024 sc1 lds
    buffer_load_dwordx4 v58, s[36:39], s15 offen offset:2048 sc1 lds
    buffer_load_dwordx4 v59, s[36:39], s15 offen offset:3072 sc1 lds
    s_add_u32 m0, s57, 94208
    s_nop 0
    buffer_load_dwordx4 v60, s[36:39], s15 offen offset:0 sc1 lds
    buffer_load_dwordx4 v61, s[36:39], s15 offen offset:1024 sc1 lds
    buffer_load_dwordx4 v62, s[36:39], s15 offen offset:2048 sc1 lds
    buffer_load_dwordx4 v63, s[36:39], s15 offen offset:3072 sc1 lds
    s_add_u32 m0, s57, 98304
    s_nop 0
    buffer_load_dwordx4 v64, s[36:39], s15 offen offset:0 sc1 lds
    s_mov_b32 m0, s14
    s_waitcnt vmcnt(0)
    s_branch L_m_81
L_m_82:
    s_max_i32 s7, s7, 0
    s_barrier
    s_add_u32 m0, s57, 145408
    s_nop 0
    buffer_load_dwordx4 v56, s[36:39], s50 offen offset:0 sc1 lds
    buffer_load_dwordx4 v57, s[36:39], s50 offen offset:1024 sc1 lds
    buffer_load_dwordx4 v58, s[36:39], s50 offen offset:2048 sc1 lds
    buffer_load_dwordx4 v59, s[36:39], s50 offen offset:3072 sc1 lds
    s_add_u32 m0, s57, 149504
    s_nop 0
    buffer_load_dwordx4 v60, s[36:39], s50 offen offset:0 sc1 lds
    buffer_load_dwordx4 v61, s[36:39], s50 offen offset:1024 sc1 lds
    buffer_load_dwordx4 v62, s[36:39], s50 offen offset:2048 sc1 lds
    buffer_load_dwordx4 v63, s[36:39], s50 offen offset:3072 sc1 lds
    s_add_u32 m0, s57, 153600
    s_nop 0
    buffer_load_dwordx4 v64, s[36:39], s50 offen offset:0 sc1 lds
    s_add_u32 s50, s58, 0
    s_cmp_ge_u32 s50, s59
    s_cselect_b32 s48, 1327104, 0
    s_sub_u32 s50, s50, s48
    s_cmp_lg_u32 s35, 0
    s_cbranch_scc1 L_m_83
    buffer_load_dword v53, v52, s[44:47], s8 offen
    buffer_load_dword v53, v52, s[44:47], s9 offen
L_m_83:
    s_waitcnt vmcnt(18)
L_m_84:
    ds_read_b32 v76, v85 offset:18432
    ds_read_b32 v77, v85 offset:19456
    ds_read_b32 v78, v85 offset:20480
    ds_read_b32 v79, v85 offset:21504
    ds_read_b32 v80, v85 offset:22528
    ds_read_b32 v81, v85 offset:23552
    ds_read_b32 v82, v85 offset:24576
    ds_read_b32 v83, v85 offset:25600
    ds_read_b32 v84, v85 offset:26624
    s_waitcnt lgkmcnt(6)
    v_max3_u32 v76, v76, v77, v78
    s_waitcnt lgkmcnt(4)
    v_max3_u32 v76, v76, v79, v80
    s_waitcnt lgkmcnt(2)
    v_max3_u32 v76, v76, v81, v82
    s_waitcnt lgkmcnt(0)
    v_max3_u32 v76, v76, v83, v84
    v_cmp_eq_u32 vcc, -1, v76
    s_nop 0
    s_cbranch_vccz L_m_85
    s_sub_u32 s7, s7, 1
    s_cbranch_scc1 L_m_85
    s_mov_b32 s14, m0
    s_sleep 2
    s_add_u32 s15, s58, 516096
    s_cmp_ge_u32 s15, s59
    s_cselect_b32 s48, 1327104, 0
    s_sub_u32 s15, s15, s48
    s_add_u32 m0, s57, 108544
    s_nop 0
    buffer_load_dwordx4 v56, s[36:39], s15 offen offset:0 sc1 lds
    buffer_load_dwordx4 v57, s[36:39], s15 offen offset:1024 sc1 lds
    buffer_load_dwordx4 v58, s[36:39], s15 offen offset:2048 sc1 lds
    buffer_load_dwordx4 v59, s[36:39], s15 offen offset:3072 sc1 lds
    s_add_u32 m0, s57, 112640
    s_nop 0
    buffer_load_dwordx4 v60, s[36:39], s15 offen offset:0 sc1 lds
    buffer_load_dwordx4 v61, s[36:39], s15 offen offset:1024 sc1 lds
    buffer_load_dwordx4 v62, s[36:39], s15 offen offset:2048 sc1 lds
    buffer_load_dwordx4 v63, s[36:39], s15 offen offset:3072 sc1 lds
    s_add_u32 m0, s57, 116736
    s_nop 0
    buffer_load_dwordx4 v64, s[36:39], s15 offen offset:0 sc1 lds
    s_mov_b32 m0, s14
    s_waitcnt vmcnt(0)
    s_branch L_m_84
L_m_85:
    s_max_i32 s7, s7, 0
    s_barrier
    buffer_load_dword v28, v66, s[36:39], s66 offen sc1
    s_cmp_lg_u32 s35, 1
    s_cbranch_scc1 L_m_86
    buffer_load_dword v53, v52, s[44:47], s8 offen
    buffer_load_dword v53, v52, s[44:47], s9 offen
L_m_86:
    s_waitcnt vmcnt(10)
L_m_87:
    ds_read_b32 v76, v85 offset:36864
    ds_read_b32 v77, v85 offset:37888
    ds_read_b32 v78, v85 offset:38912
    ds_read_b32 v79, v85 offset:39936
    ds_read_b32 v80, v85 offset:40960
    ds_read_b32 v81, v85 offset:41984
    ds_read_b32 v82, v85 offset:43008
    ds_read_b32 v83, v85 offset:44032
    ds_read_b32 v84, v85 offset:45056
    s_waitcnt lgkmcnt(6)
    v_max3_u32 v76, v76, v77, v78
    s_waitcnt lgkmcnt(4)
    v_max3_u32 v76, v76, v79, v80
    s_waitcnt lgkmcnt(2)
    v_max3_u32 v76, v76, v81, v82
    s_waitcnt lgkmcnt(0)
    v_max3_u32 v76, v76, v83, v84
    v_cmp_eq_u32 vcc, -1, v76
    s_nop 0
    s_cbranch_vccz L_m_88
    s_sub_u32 s7, s7, 1
    s_cbranch_scc1 L_m_88
    s_mov_b32 s14, m0
    s_sleep 2
    s_add_u32 s15, s58, 589824
    s_cmp_ge_u32 s15, s59
    s_cselect_b32 s48, 1327104, 0
    s_sub_u32 s15, s15, s48
    s_add_u32 m0, s57, 126976
    s_nop 0
    buffer_load_dwordx4 v56, s[36:39], s15 offen offset:0 sc1 lds
    buffer_load_dwordx4 v57, s[36:39], s15 offen offset:1024 sc1 lds
    buffer_load_dwordx4 v58, s[36:39], s15 offen offset:2048 sc1 lds
    buffer_load_dwordx4 v59, s[36:39], s15 offen offset:3072 sc1 lds
    s_add_u32 m0, s57, 131072
    s_nop 0
    buffer_load_dwordx4 v60, s[36:39], s15 offen offset:0 sc1 lds
    buffer_load_dwordx4 v61, s[36:39], s15 offen offset:1024 sc1 lds
    buffer_load_dwordx4 v62, s[36:39], s15 offen offset:2048 sc1 lds
    buffer_load_dwordx4 v63, s[36:39], s15 offen offset:3072 sc1 lds
    s_add_u32 m0, s57, 135168
    s_nop 0
    buffer_load_dwordx4 v64, s[36:39], s15 offen offset:0 sc1 lds
    s_mov_b32 m0, s14
    s_waitcnt vmcnt(0)
    s_branch L_m_87
L_m_88:
    s_max_i32 s7, s7, 0
    s_barrier
    s_waitcnt vmcnt(0)
    v_cmp_ne_u32 vcc, v3, v28
    s_nop 0
    s_cbranch_vccz L_m_89
Lp_m_90:
    buffer_load_dword v28, v66, s[36:39], s66 offen sc1
    s_waitcnt vmcnt(0)
    v_cmp_ne_u32 vcc, v3, v28
    s_nop 0
    s_cbranch_vccz Le_m_91
    s_sub_u32 s7, s7, 1
    s_cbranch_scc1 Le_m_91
    s_mov_b64 exec, vcc
    s_sleep 1
    s_branch Lp_m_90
Le_m_91:
    s_mov_b64 exec, -1
    s_max_i32 s7, s7, 0
L_m_89:
    s_add_u32 m0, s57, 90112
    s_nop 0
    buffer_load_dwordx4 v56, s[36:39], s50 offen offset:0 sc1 lds
    buffer_load_dwordx4 v57, s[36:39], s50 offen offset:1024 sc1 lds
    buffer_load_dwordx4 v58, s[36:39], s50 offen offset:2048 sc1 lds
    buffer_load_dwordx4 v59, s[36:39], s50 offen offset:3072 sc1 lds
    s_add_u32 m0, s57, 94208
    s_nop 0
    buffer_load_dwordx4 v60, s[36:39], s50 offen offset:0 sc1 lds
    buffer_load_dwordx4 v61, s[36:39], s50 offen offset:1024 sc1 lds
    buffer_load_dwordx4 v62, s[36:39], s50 offen offset:2048 sc1 lds
    buffer_load_dwordx4 v63, s[36:39], s50 offen offset:3072 sc1 lds
    s_add_u32 m0, s57, 98304
    s_nop 0
    buffer_load_dwordx4 v64, s[36:39], s50 offen offset:0 sc1 lds
    s_add_u32 s50, s58, 737280
    s_cmp_ge_u32 s50, s59
    s_cselect_b32 s48, 1327104, 0
    s_sub_u32 s50, s50, s48
    s_cmp_lg_u32 s35, 2
    s_cbranch_scc1 L_m_92
    buffer_load_dword v53, v52, s[44:47], s8 offen
    buffer_load_dword v53, v52, s[44:47], s9 offen
L_m_92:
    s_waitcnt vmcnt(10)
L_m_93:
    ds_read_b32 v76, v85 offset:55296
    ds_read_b32 v77, v85 offset:56320
    ds_read_b32 v78, v85 offset:57344
    ds_read_b32 v79, v85 offset:58368
    ds_read_b32 v80, v85 offset:59392
    ds_read_b32 v81, v85 offset:60416
    ds_read_b32 v82, v85 offset:61440
    ds_read_b32 v83, v85 offset:62464
    ds_read_b32 v84, v85 offset:63488
    s_waitcnt lgkmcnt(6)
    v_max3_u32 v76, v76, v77, v78
    s_waitcnt lgkmcnt(4)
    v_max3_u32 v76, v76, v79, v80
    s_waitcnt lgkmcnt(2)
    v_max3_u32 v76, v76, v81, v82
    s_waitcnt lgkmcnt(0)
    v_max3_u32 v76, v76, v83, v84
    v_cmp_eq_u32 vcc, -1, v76
    s_nop 0
    s_cbranch_vccz L_m_94
    s_sub_u32 s7, s7, 1
    s_cbranch_scc1 L_m_94
    s_mov_b32 s14, m0
    s_sleep 2
    s_add_u32 s15, s58, 663552
    s_cmp_ge_u32 s15, s59
    s_cselect_b32 s48, 1327104, 0
    s_sub_u32 s15, s15, s48
    s_add_u32 m0, s57, 145408
    s_nop 0
    buffer_load_dwordx4 v56, s[36:39], s15 offen offset:0 sc1 lds
    buffer_load_dwordx4 v57, s[36:39], s15 offen offset:1024 sc1 lds
    buffer_load_dwordx4 v58, s[36:39], s15 offen offset:2048 sc1 lds
    buffer_load_dwordx4 v59, s[36:39], s15 offen offset:3072 sc1 lds
    s_add_u32 m0, s57, 149504
    s_nop 0
    buffer_load_dwordx4 v60, s[36:39], s15 offen offset:0 sc1 lds
    buffer_load_dwordx4 v61, s[36:39], s15 offen offset:1024 sc1 lds
    buffer_load_dwordx4 v62, s[36:39], s15 offen offset:2048 sc1 lds
    buffer_load_dwordx4 v63, s[36:39], s15 offen offset:3072 sc1 lds
    s_add_u32 m0, s57, 153600
    s_nop 0
    buffer_load_dwordx4 v64, s[36:39], s15 offen offset:0 sc1 lds
    s_mov_b32 m0, s14
    s_waitcnt vmcnt(0)
    s_branch L_m_93
L_m_94:
    s_max_i32 s7, s7, 0
    s_barrier
    s_add_u32 m0, s57, 108544
    s_nop 0
    buffer_load_dwordx4 v56, s[36:39], s50 offen offset:0 sc1 lds
    buffer_load_dwordx4 v57, s[36:39], s50 offen offset:1024 sc1 lds
    buffer_load_dwordx4 v58, s[36:39], s50 offen offset:2048 sc1 lds
    buffer_load_dwordx4 v59, s[36:39], s50 offen offset:3072 sc1 lds
    s_add_u32 m0, s57, 112640
    s_nop 0
    buffer_load_dwordx4 v60, s[36:39], s50 offen offset:0 sc1 lds
    buffer_load_dwordx4 v61, s[36:39], s50 offen offset:1024 sc1 lds
    buffer_load_dwordx4 v62, s[36:39], s50 offen offset:2048 sc1 lds
    buffer_load_dwordx4 v63, s[36:39], s50 offen offset:3072 sc1 lds
    s_add_u32 m0, s57, 116736
    s_nop 0
    buffer_load_dwordx4 v64, s[36:39], s50 offen offset:0 sc1 lds
    s_add_u32 s50, s58, 73728
    s_cmp_ge_u32 s50, s59
    s_cselect_b32 s48, 1327104, 0
    s_sub_u32 s50, s50, s48
    s_cmp_lg_u32 s35, 3
    s_cbranch_scc1 L_m_95
    buffer_load_dword v53, v52, s[44:47], s8 offen
    buffer_load_dword v53, v52, s[44:47], s9 offen
L_m_95:
    s_waitcnt vmcnt(9)
    s_barrier
    s_add_u32 m0, s57, 126976
    s_nop 0
    buffer_load_dwordx4 v56, s[36:39], s50 offen offset:0 sc1 lds
    buffer_load_dwordx4 v57, s[36:39], s50 offen offset:1024 sc1 lds
    buffer_load_dwordx4 v58, s[36:39], s50 offen offset:2048 sc1 lds
    buffer_load_dwordx4 v59, s[36:39], s50 offen offset:3072 sc1 lds
    s_add_u32 m0, s57, 131072
    s_nop 0
    buffer_load_dwordx4 v60, s[36:39], s50 offen offset:0 sc1 lds
    buffer_load_dwordx4 v61, s[36:39], s50 offen offset:1024 sc1 lds
    buffer_load_dwordx4 v62, s[36:39], s50 offen offset:2048 sc1 lds
    buffer_load_dwordx4 v63, s[36:39], s50 offen offset:3072 sc1 lds
    s_add_u32 m0, s57, 135168
    s_nop 0
    buffer_load_dwordx4 v64, s[36:39], s50 offen offset:0 sc1 lds
    s_add_u32 s50, s58, 811008
    s_cmp_ge_u32 s50, s59
    s_cselect_b32 s48, 1327104, 0
    s_sub_u32 s50, s50, s48
    s_cmp_lg_u32 s35, 4
    s_cbranch_scc1 L_m_96
    buffer_load_dword v53, v52, s[44:47], s8 offen
    buffer_load_dword v53, v52, s[44:47], s9 offen
L_m_96:
    s_waitcnt vmcnt(9)
    s_barrier
    s_add_u32 m0, s57, 145408
    s_nop 0
    buffer_load_dwordx4 v56, s[36:39], s50 offen offset:0 sc1 lds
    buffer_load_dwordx4 v57, s[36:39], s50 offen offset:1024 sc1 lds
    buffer_load_dwordx4 v58, s[36:39], s50 offen offset:2048 sc1 lds
    buffer_load_dwordx4 v59, s[36:39], s50 offen offset:3072 sc1 lds
    s_add_u32 m0, s57, 149504
    s_nop 0
    buffer_load_dwordx4 v60, s[36:39], s50 offen offset:0 sc1 lds
    buffer_load_dwordx4 v61, s[36:39], s50 offen offset:1024 sc1 lds
    buffer_load_dwordx4 v62, s[36:39], s50 offen offset:2048 sc1 lds
    buffer_load_dwordx4 v63, s[36:39], s50 offen offset:3072 sc1 lds
    s_add_u32 m0, s57, 153600
    s_nop 0
    buffer_load_dwordx4 v64, s[36:39], s50 offen offset:0 sc1 lds
    s_add_u32 s50, s58, 147456
    s_cmp_ge_u32 s50, s59
    s_cselect_b32 s48, 1327104, 0
    s_sub_u32 s50, s50, s48
    s_cmp_lg_u32 s35, 5
    s_cbranch_scc1 L_m_97
    buffer_load_dword v53, v52, s[44:47], s8 offen
    buffer_load_dword v53, v52, s[44:47], s9 offen
L_m_97:
    s_waitcnt vmcnt(9)
    s_barrier
    s_add_u32 m0, s57, 90112
    s_nop 0
    buffer_load_dwordx4 v56, s[36:39], s50 offen offset:0 sc1 lds
    buffer_load_dwordx4 v57, s[36:39], s50 offen offset:1024 sc1 lds
    buffer_load_dwordx4 v58, s[36:39], s50 offen offset:2048 sc1 lds
    buffer_load_dwordx4 v59, s[36:39], s50 offen offset:3072 sc1 lds
    s_add_u32 m0, s57, 94208
    s_nop 0
    buffer_load_dwordx4 v60, s[36:39], s50 offen offset:0 sc1 lds
    buffer_load_dwordx4 v61, s[36:39], s50 offen offset:1024 sc1 lds
    buffer_load_dwordx4 v62, s[36:39], s50 offen offset:2048 sc1 lds
    buffer_load_dwordx4 v63, s[36:39], s50 offen offset:3072 sc1 lds
    s_add_u32 m0, s57, 98304
    s_nop 0
    buffer_load_dwordx4 v64, s[36:39], s50 offen offset:0 sc1 lds
    s_add_u32 s50, s58, 884736
    s_cmp_ge_u32 s50, s59
    s_cselect_b32 s48, 1327104, 0
    s_sub_u32 s50, s50, s48
    s_cmp_lg_u32 s35, 6
    s_cbranch_scc1 L_m_98
    buffer_load_dword v53, v52, s[44:47], s8 offen
    buffer_load_dword v53, v52, s[44:47], s9 offen
L_m_98:
    s_waitcnt vmcnt(9)
    s_barrier
    s_add_u32 m0, s57, 108544
    s_nop 0
    buffer_load_dwordx4 v56, s[36:39], s50 offen offset:0 sc1 lds
    buffer_load_dwordx4 v57, s[36:39], s50 offen offset:1024 sc1 lds
    buffer_load_dwordx4 v58, s[36:39], s50 offen offset:2048 sc1 lds
    buffer_load_dwordx4 v59, s[36:39], s50 offen offset:3072 sc1 lds
    s_add_u32 m0, s57, 112640
    s_nop 0
    buffer_load_dwordx4 v60, s[36:39], s50 offen offset:0 sc1 lds
    buffer_load_dwordx4 v61, s[36:39], s50 offen offset:1024 sc1 lds
    buffer_load_dwordx4 v62, s[36:39], s50 offen offset:2048 sc1 lds
    buffer_load_dwordx4 v63, s[36:39], s50 offen offset:3072 sc1 lds
    s_add_u32 m0, s57, 116736
    s_nop 0
    buffer_load_dwordx4 v64, s[36:39], s50 offen offset:0 sc1 lds
    s_add_u32 s50, s58, 221184
    s_cmp_ge_u32 s50, s59
    s_cselect_b32 s48, 1327104, 0
    s_sub_u32 s50, s50, s48
    s_cmp_lg_u32 s35, 7
    s_cbranch_scc1 L_m_99
    buffer_load_dword v53, v52, s[44:47], s8 offen
    buffer_load_dword v53, v52, s[44:47], s9 offen
L_m_99:
    s_waitcnt vmcnt(9)
    s_barrier
    s_add_u32 m0, s57, 126976
    s_nop 0
    buffer_load_dwordx4 v56, s[36:39], s50 offen offset:0 sc1 lds
    buffer_load_dwordx4 v57, s[36:39], s50 offen offset:1024 sc1 lds
    buffer_load_dwordx4 v58, s[36:39], s50 offen offset:2048 sc1 lds
    buffer_load_dwordx4 v59, s[36:39], s50 offen offset:3072 sc1 lds
    s_add_u32 m0, s57, 131072
    s_nop 0
    buffer_load_dwordx4 v60, s[36:39], s50 offen offset:0 sc1 lds
    buffer_load_dwordx4 v61, s[36:39], s50 offen offset:1024 sc1 lds
    buffer_load_dwordx4 v62, s[36:39], s50 offen offset:2048 sc1 lds
    buffer_load_dwordx4 v63, s[36:39], s50 offen offset:3072 sc1 lds
    s_add_u32 m0, s57, 135168
    s_nop 0
    buffer_load_dwordx4 v64, s[36:39], s50 offen offset:0 sc1 lds
    s_add_u32 s50, s58, 294912
    s_cmp_ge_u32 s50, s59
    s_cselect_b32 s48, 1327104, 0
    s_sub_u32 s50, s50, s48
    s_waitcnt vmcnt(9)
    s_barrier
    s_add_u32 m0, s57, 145408
    s_nop 0
    buffer_load_dwordx4 v56, s[36:39], s50 offen offset:0 sc1 lds
    buffer_load_dwordx4 v57, s[36:39], s50 offen offset:1024 sc1 lds
    buffer_load_dwordx4 v58, s[36:39], s50 offen offset:2048 sc1 lds
    buffer_load_dwordx4 v59, s[36:39], s50 offen offset:3072 sc1 lds
    s_add_u32 m0, s57, 149504
    s_nop 0
    buffer_load_dwordx4 v60, s[36:39], s50 offen offset:0 sc1 lds
    buffer_load_dwordx4 v61, s[36:39], s50 offen offset:1024 sc1 lds
    buffer_load_dwordx4 v62, s[36:39], s50 offen offset:2048 sc1 lds
    buffer_load_dwordx4 v63, s[36:39], s50 offen offset:3072 sc1 lds
    s_add_u32 m0, s57, 153600
    s_nop 0
    buffer_load_dwordx4 v64, s[36:39], s50 offen offset:0 sc1 lds
    s_add_u32 s50, s58, 368640
    s_cmp_ge_u32 s50, s59
    s_cselect_b32 s48, 1327104, 0
    s_sub_u32 s50, s50, s48
    s_waitcnt vmcnt(9)
    s_barrier
    s_add_u32 m0, s57, 90112
    s_nop 0
    buffer_load_dwordx4 v56, s[36:39], s50 offen offset:0 sc1 lds
    buffer_load_dwordx4 v57, s[36:39], s50 offen offset:1024 sc1 lds
    buffer_load_dwordx4 v58, s[36:39], s50 offen offset:2048 sc1 lds
    buffer_load_dwordx4 v59, s[36:39], s50 offen offset:3072 sc1 lds
    s_add_u32 m0, s57, 94208
    s_nop 0
    buffer_load_dwordx4 v60, s[36:39], s50 offen offset:0 sc1 lds
    buffer_load_dwordx4 v61, s[36:39], s50 offen offset:1024 sc1 lds
    buffer_load_dwordx4 v62, s[36:39], s50 offen offset:2048 sc1 lds
    buffer_load_dwordx4 v63, s[36:39], s50 offen offset:3072 sc1 lds
    s_add_u32 m0, s57, 98304
    s_nop 0
    buffer_load_dwordx4 v64, s[36:39], s50 offen offset:0 sc1 lds
    s_add_u32 s50, s58, 958464
    s_cmp_ge_u32 s50, s59
    s_cselect_b32 s48, 1327104, 0
    s_sub_u32 s50, s50, s48
    s_waitcnt vmcnt(9)
    s_barrier
    s_add_u32 m0, s57, 108544
    s_nop 0
    buffer_load_dwordx4 v56, s[36:39], s50 offen offset:0 sc1 lds
    buffer_load_dwordx4 v57, s[36:39], s50 offen offset:1024 sc1 lds
    buffer_load_dwordx4 v58, s[36:39], s50 offen offset:2048 sc1 lds
    buffer_load_dwordx4 v59, s[36:39], s50 offen offset:3072 sc1 lds
    s_add_u32 m0, s57, 112640
    s_nop 0
    buffer_load_dwordx4 v60, s[36:39], s50 offen offset:0 sc1 lds
    buffer_load_dwordx4 v61, s[36:39], s50 offen offset:1024 sc1 lds
    buffer_load_dwordx4 v62, s[36:39], s50 offen offset:2048 sc1 lds
    buffer_load_dwordx4 v63, s[36:39], s50 offen offset:3072 sc1 lds
    s_add_u32 m0, s57, 116736
    s_nop 0
    buffer_load_dwordx4 v64, s[36:39], s50 offen offset:0 sc1 lds
    s_add_u32 s50, s58, 1032192
    s_cmp_ge_u32 s50, s59
    s_cselect_b32 s48, 1327104, 0
    s_sub_u32 s50, s50, s48
    s_waitcnt vmcnt(9)
    s_barrier
    s_add_u32 m0, s57, 126976
    s_nop 0
    buffer_load_dwordx4 v56, s[36:39], s50 offen offset:0 sc1 lds
    buffer_load_dwordx4 v57, s[36:39], s50 offen offset:1024 sc1 lds
    buffer_load_dwordx4 v58, s[36:39], s50 offen offset:2048 sc1 lds
    buffer_load_dwordx4 v59, s[36:39], s50 offen offset:3072 sc1 lds
    s_add_u32 m0, s57, 131072
    s_nop 0
    buffer_load_dwordx4 v60, s[36:39], s50 offen offset:0 sc1 lds
    buffer_load_dwordx4 v61, s[36:39], s50 offen offset:1024 sc1 lds
    buffer_load_dwordx4 v62, s[36:39], s50 offen offset:2048 sc1 lds
    buffer_load_dwordx4 v63, s[36:39], s50 offen offset:3072 sc1 lds
    s_add_u32 m0, s57, 135168
    s_nop 0
    buffer_load_dwordx4 v64, s[36:39], s50 offen offset:0 sc1 lds
    s_add_u32 s50, s58, 1105920
    s_cmp_ge_u32 s50, s59
    s_cselect_b32 s48, 1327104, 0
    s_sub_u32 s50, s50, s48
    s_waitcnt vmcnt(9)
    s_barrier
    s_add_u32 m0, s57, 145408
    s_nop 0
    buffer_load_dwordx4 v56, s[36:39], s50 offen offset:0 sc1 lds
    buffer_load_dwordx4 v57, s[36:39], s50 offen offset:1024 sc1 lds
    buffer_load_dwordx4 v58, s[36:39], s50 offen offset:2048 sc1 lds
    buffer_load_dwordx4 v59, s[36:39], s50 offen offset:3072 sc1 lds
    s_add_u32 m0, s57, 149504
    s_nop 0
    buffer_load_dwordx4 v60, s[36:39], s50 offen offset:0 sc1 lds
    buffer_load_dwordx4 v61, s[36:39], s50 offen offset:1024 sc1 lds
    buffer_load_dwordx4 v62, s[36:39], s50 offen offset:2048 sc1 lds
    buffer_load_dwordx4 v63, s[36:39], s50 offen offset:3072 sc1 lds
    s_add_u32 m0, s57, 153600
    s_nop 0
    buffer_load_dwordx4 v64, s[36:39], s50 offen offset:0 sc1 lds
    s_add_u32 s50, s58, 1179648
    s_cmp_ge_u32 s50, s59
    s_cselect_b32 s48, 1327104, 0
    s_sub_u32 s50, s50, s48
    s_waitcnt vmcnt(9)
    s_barrier
    s_add_u32 m0, s57, 90112
    s_nop 0
    buffer_load_dwordx4 v56, s[36:39], s50 offen offset:0 sc1 lds
    buffer_load_dwordx4 v57, s[36:39], s50 offen offset:1024 sc1 lds
    buffer_load_dwordx4 v58, s[36:39], s50 offen offset:2048 sc1 lds
    buffer_load_dwordx4 v59, s[36:39], s50 offen offset:3072 sc1 lds
    s_add_u32 m0, s57, 94208
    s_nop 0
    buffer_load_dwordx4 v60, s[36:39], s50 offen offset:0 sc1 lds
    buffer_load_dwordx4 v61, s[36:39], s50 offen offset:1024 sc1 lds
    buffer_load_dwordx4 v62, s[36:39], s50 offen offset:2048 sc1 lds
    buffer_load_dwordx4 v63, s[36:39], s50 offen offset:3072 sc1 lds
    s_add_u32 m0, s57, 98304
    s_nop 0
    buffer_load_dwordx4 v64, s[36:39], s50 offen offset:0 sc1 lds
    s_add_u32 s50, s58, 1253376
    s_cmp_ge_u32 s50, s59
    s_cselect_b32 s48, 1327104, 0
    s_sub_u32 s50, s50, s48
    s_waitcnt vmcnt(9)
    s_barrier
    s_add_u32 m0, s57, 108544
    s_nop 0
    buffer_load_dwordx4 v56, s[36:39], s50 offen offset:0 sc1 lds
    buffer_load_dwordx4 v57, s[36:39], s50 offen offset:1024 sc1 lds
    buffer_load_dwordx4 v58, s[36:39], s50 offen offset:2048 sc1 lds
    buffer_load_dwordx4 v59, s[36:39], s50 offen offset:3072 sc1 lds
    s_add_u32 m0, s57, 112640
    s_nop 0
    buffer_load_dwordx4 v60, s[36:39], s50 offen offset:0 sc1 lds
    buffer_load_dwordx4 v61, s[36:39], s50 offen offset:1024 sc1 lds
    buffer_load_dwordx4 v62, s[36:39], s50 offen offset:2048 sc1 lds
    buffer_load_dwordx4 v63, s[36:39], s50 offen offset:3072 sc1 lds
    s_add_u32 m0, s57, 116736
    s_nop 0
    buffer_load_dwordx4 v64, s[36:39], s50 offen offset:0 sc1 lds
    s_lshl_b32 s48, s62, 10
    s_add_u32 m0, s48, 32768
    s_nop 0
    buffer_load_dwordx4 v70, s[36:39], 0 offen sc1 lds
    s_lshl_b32 s48, s62, 10
    s_add_u32 m0, s48, 34816
    s_nop 0
    buffer_load_dwordx4 v71, s[36:39], 0 offen sc1 lds
    s_lshl_b32 s48, s62, 10
    s_add_u32 m0, s48, 36864
    s_nop 0
    buffer_load_dwordx4 v72, s[36:39], 0 offen sc1 lds
    s_lshl_b32 s48, s62, 10
    s_add_u32 m0, s48, 38912
    s_nop 0
    buffer_load_dwordx4 v73, s[36:39], 0 offen sc1 lds
    s_mul_i32 s48, s62, 40960
    s_add_u32 m0, s48, 40960
    s_nop 0
    buffer_load_dwordx4 v74, s[36:39], 0 offen sc1 lds
    s_waitcnt vmcnt(14)
    s_barrier
    s_waitcnt vmcnt(5)
    s_barrier
    s_waitcnt vmcnt(0)
    s_barrier
    s_branch L_m_100
L_m_50:
    v_lshlrev_b32 v29, 1, v2
    v_xor_b32 v29, v29, v1
    v_xor_b32 v30, 8, v29
    v_mul_u32_u24 v28, 4096, v2
    v_lshl_add_u32 v56, v29, 4, v28
    v_lshl_add_u32 v57, v30, 4, v28
    v_add_u32 v58, 30720, v56
    v_add_u32 v59, 46080, v57
    v_add_u32 v57, 15360, v57
    v_add_u32 v60, 65536, v56
    v_add_u32 v61, 65536, v57
    v_add_u32 v62, 65536, v58
    v_add_u32 v63, 65536, v59
    s_mul_i32 s49, s53, 4718592
    s_lshl_b32 s48, s62, 17
    s_add_u32 s49, s49, s48
    s_lshl_b32 s48, s54, 8
    s_add_u32 s49, s49, s48
    s_mul_i32 s58, s64, 262144
    s_add_u32 s58, s58, s49
    s_add_u32 s59, s49, 4718592
    s_cmp_ge_u32 s5, 27
    s_cbranch_scc1 L_m_101
    v_lshlrev_b32 v29, 1, v2
    v_xor_b32 v29, v29, v1
    v_xor_b32 v30, 8, v29
    v_mul_u32_u24 v28, 2359296, v2
    v_lshl_add_u32 v12, v29, 4, v28
    v_lshl_add_u32 v13, v30, 4, v28
    v_add_u32 v14, 16384, v12
    v_add_u32 v15, 24576, v13
    v_add_u32 v13, 8192, v13
    v_add_u32 v16, 9437184, v12
    v_add_u32 v17, 9437184, v13
    v_add_u32 v18, 9437184, v14
    v_add_u32 v19, 9437184, v15
    s_mul_i32 s49, s62, 36864
    s_lshl_b32 s48, s51, 8
    s_add_u32 s49, s49, s48
    s_mul_i32 s60, s63, 73728
    s_add_u32 s60, s60, s49
    s_add_u32 s61, s49, 2359296
    s_branch L_stub_15
L_back_w1:
    s_add_u32 s50, s60, 0
    s_cmp_ge_u32 s50, s61
    s_cselect_b32 s48, 2359296, 0
    s_sub_u32 s50, s50, s48
    s_add_u32 m0, s68, 0
    s_nop 0
    buffer_load_dwordx4 v12, s[40:43], s50 offen offset:0  lds
    buffer_load_dwordx4 v13, s[40:43], s50 offen offset:1024  lds
    buffer_load_dwordx4 v14, s[40:43], s50 offen offset:2048  lds
    buffer_load_dwordx4 v15, s[40:43], s50 offen offset:3072  lds
    s_add_u32 m0, s68, 4096
    s_nop 0
    buffer_load_dwordx4 v16, s[40:43], s50 offen offset:0  lds
    buffer_load_dwordx4 v17, s[40:43], s50 offen offset:1024  lds
    buffer_load_dwordx4 v18, s[40:43], s50 offen offset:2048  lds
    buffer_load_dwordx4 v19, s[40:43], s50 offen offset:3072  lds
    s_add_u32 s50, s60, 73728
    s_cmp_ge_u32 s50, s61
    s_cselect_b32 s48, 2359296, 0
    s_sub_u32 s50, s50, s48
    s_add_u32 m0, s68, 16384
    s_nop 0
    buffer_load_dwordx4 v12, s[40:43], s50 offen offset:0  lds
    buffer_load_dwordx4 v13, s[40:43], s50 offen offset:1024  lds
    buffer_load_dwordx4 v14, s[40:43], s50 offen offset:2048  lds
    buffer_load_dwordx4 v15, s[40:43], s50 offen offset:3072  lds
    s_add_u32 m0, s68, 20480
    s_nop 0
    s_branch L_skip_15
    s_nop 0
L_stub_15:
    s_branch L_stub_16
L_skip_15:
    buffer_load_dwordx4 v16, s[40:43], s50 offen offset:0  lds
    buffer_load_dwordx4 v17, s[40:43], s50 offen offset:1024  lds
    buffer_load_dwordx4 v18, s[40:43], s50 offen offset:2048  lds
    buffer_load_dwordx4 v19, s[40:43], s50 offen offset:3072  lds
    s_barrier
    s_add_u32 s50, s60, 147456
    s_cmp_ge_u32 s50, s61
    s_cselect_b32 s48, 2359296, 0
    s_sub_u32 s50, s50, s48
    s_add_u32 m0, s68, 32768
    s_nop 0
    buffer_load_dwordx4 v12, s[40:43], s50 offen offset:0  lds
    buffer_load_dwordx4 v13, s[40:43], s50 offen offset:1024  lds
    buffer_load_dwordx4 v14, s[40:43], s50 offen offset:2048  lds
    buffer_load_dwordx4 v15, s[40:43], s50 offen offset:3072  lds
    s_add_u32 m0, s68, 36864
    s_nop 0
    buffer_load_dwordx4 v16, s[40:43], s50 offen offset:0  lds
    buffer_load_dwordx4 v17, s[40:43], s50 offen offset:1024  lds
    buffer_load_dwordx4 v18, s[40:43], s50 offen offset:2048  lds
    buffer_load_dwordx4 v19, s[40:43], s50 offen offset:3072  lds
    s_add_u32 s50, s60, 221184
    s_cmp_ge_u32 s50, s61
    s_cselect_b32 s48, 2359296, 0
    s_sub_u32 s50, s50, s48
    s_add_u32 m0, s68, 49152
    s_nop 0
    buffer_load_dwordx4 v12, s[40:43], s50 offen offset:0  lds
    buffer_load_dwordx4 v13, s[40:43], s50 offen offset:1024  lds
    buffer_load_dwordx4 v14, s[40:43], s50 offen offset:2048  lds
    buffer_load_dwordx4 v15, s[40:43], s50 offen offset:3072  lds
    s_add_u32 m0, s68, 53248
    s_nop 0
    buffer_load_dwordx4 v16, s[40:43], s50 offen offset:0  lds
    buffer_load_dwordx4 v17, s[40:43], s50 offen offset:1024  lds
    buffer_load_dwordx4 v18, s[40:43], s50 offen offset:2048  lds
    buffer_load_dwordx4 v19, s[40:43], s50 offen offset:3072  lds
    s_barrier
    s_add_u32 s50, s60, 294912
    s_cmp_ge_u32 s50, s61
    s_cselect_b32 s48, 2359296, 0
    s_sub_u32 s50, s50, s48
    s_add_u32 m0, s68, 65536
    s_nop 0
    buffer_load_dwordx4 v12, s[40:43], s50 offen offset:0  lds
    buffer_load_dwordx4 v13, s[40:43], s50 offen offset:1024  lds
    buffer_load_dwordx4 v14, s[40:43], s50 offen offset:2048  lds
    buffer_load_dwordx4 v15, s[40:43], s50 offen offset:3072  lds
    s_add_u32 m0, s68, 69632
    s_nop 0
    buffer_load_dwordx4 v16, s[40:43], s50 offen offset:0  lds
    buffer_load_dwordx4 v17, s[40:43], s50 offen offset:1024  lds
    buffer_load_dwordx4 v18, s[40:43], s50 offen offset:2048  lds
    buffer_load_dwordx4 v19, s[40:43], s50 offen offset:3072  lds
    s_add_u32 s50, s60, 368640
    s_cmp_ge_u32 s50, s61
    s_cselect_b32 s48, 2359296, 0
    s_sub_u32 s50, s50, s48
    s_add_u32 m0, s68, 81920
    s_nop 0
    buffer_load_dwordx4 v12, s[40:43], s50 offen offset:0  lds
    buffer_load_dwordx4 v13, s[40:43], s50 offen offset:1024  lds
    buffer_load_dwordx4 v14, s[40:43], s50 offen offset:2048  lds
    buffer_load_dwordx4 v15, s[40:43], s50 offen offset:3072  lds
    s_add_u32 m0, s68, 86016
    s_nop 0
    buffer_load_dwordx4 v16, s[40:43], s50 offen offset:0  lds
    buffer_load_dwordx4 v17, s[40:43], s50 offen offset:1024  lds
    buffer_load_dwordx4 v18, s[40:43], s50 offen offset:2048  lds
    buffer_load_dwordx4 v19, s[40:43], s50 offen offset:3072  lds
    s_barrier
    s_waitcnt vmcnt(0)
    s_barrier
    s_barrier
    s_add_u32 s50, s60, 442368
    s_cmp_ge_u32 s50, s61
    s_cselect_b32 s48, 2359296, 0
    s_sub_u32 s50, s50, s48
    s_add_u32 m0, s68, 0
    s_nop 0
    buffer_load_dwordx4 v12, s[40:43], s50 offen offset:0  lds
    buffer_load_dwordx4 v13, s[40:43], s50 offen offset:1024  lds
    buffer_load_dwordx4 v14, s[40:43], s50 offen offset:2048  lds
    buffer_load_dwordx4 v15, s[40:43], s50 offen offset:3072  lds
    s_add_u32 m0, s68, 4096
    s_nop 0
    buffer_load_dwordx4 v16, s[40:43], s50 offen offset:0  lds
    buffer_load_dwordx4 v17, s[40:43], s50 offen offset:1024  lds
    buffer_load_dwordx4 v18, s[40:43], s50 offen offset:2048  lds
    buffer_load_dwordx4 v19, s[40:43], s50 offen offset:3072  lds
    s_add_u32 s50, s60, 516096
    s_cmp_ge_u32 s50, s61
    s_cselect_b32 s48, 2359296, 0
    s_sub_u32 s50, s50, s48
    s_add_u32 m0, s68, 16384
    s_nop 0
    buffer_load_dwordx4 v12, s[40:43], s50 offen offset:0  lds
    buffer_load_dwordx4 v13, s[40:43], s50 offen offset:1024  lds
    buffer_load_dwordx4 v14, s[40:43], s50 offen offset:2048  lds
    buffer_load_dwordx4 v15, s[40:43], s50 offen offset:3072  lds
    s_add_u32 m0, s68, 20480
    s_nop 0
    buffer_load_dwordx4 v16, s[40:43], s50 offen offset:0  lds
    buffer_load_dwordx4 v17, s[40:43], s50 offen offset:1024  lds
    buffer_load_dwordx4 v18, s[40:43], s50 offen offset:2048  lds
    buffer_load_dwordx4 v19, s[40:43], s50 offen offset:3072  lds
    s_add_u32 s50, s60, 589824
    s_cmp_ge_u32 s50, s61
    s_cselect_b32 s48, 2359296, 0
    s_sub_u32 s50, s50, s48
    s_add_u32 m0, s68, 32768
    s_nop 0
    buffer_load_dwordx4 v12, s[40:43], s50 offen offset:0  lds
    buffer_load_dwordx4 v13, s[40:43], s50 offen offset:1024  lds
    buffer_load_dwordx4 v14, s[40:43], s50 offen offset:2048  lds
    buffer_load_dwordx4 v15, s[40:43], s50 offen offset:3072  lds
    s_add_u32 m0, s68, 36864
    s_nop 0
    buffer_load_dwordx4 v16, s[40:43], s50 offen offset:0  lds
    buffer_load_dwordx4 v17, s[40:43], s50 offen offset:1024  lds
    buffer_load_dwordx4 v18, s[40:43], s50 offen offset:2048  lds
    buffer_load_dwordx4 v19, s[40:43], s50 offen offset:3072  lds
    s_add_u32 s50, s60, 663552
    s_cmp_ge_u32 s50, s61
    s_cselect_b32 s48, 2359296, 0
    s_sub_u32 s50, s50, s48
    s_add_u32 m0, s68, 49152
    s_nop 0
    buffer_load_dwordx4 v12, s[40:43], s50 offen offset:0  lds
    buffer_load_dwordx4 v13, s[40:43], s50 offen offset:1024  lds
    buffer_load_dwordx4 v14, s[40:43], s50 offen offset:2048  lds
    buffer_load_dwordx4 v15, s[40:43], s50 offen offset:3072  lds
    s_waitcnt vmcnt(12)
    s_barrier
    s_add_u32 m0, s68, 53248
    s_nop 0
    buffer_load_dwordx4 v16, s[40:43], s50 offen offset:0  lds
    buffer_load_dwordx4 v17, s[40:43], s50 offen offset:1024  lds
    buffer_load_dwordx4 v18, s[40:43], s50 offen offset:2048  lds
    buffer_load_dwordx4 v19, s[40:43], s50 offen offset:3072  lds
    s_barrier
    s_add_u32 s50, s60, 737280
    s_cmp_ge_u32 s50, s61
    s_cselect_b32 s48, 2359296, 0
    s_sub_u32 s50, s50, s48
    s_add_u32 m0, s68, 65536
    s_nop 0
    buffer_load_dwordx4 v12, s[40:43], s50 offen offset:0  lds
    buffer_load_dwordx4 v13, s[40:43], s50 offen offset:1024  lds
    buffer_load_dwordx4 v14, s[40:43], s50 offen offset:2048  lds
    buffer_load_dwordx4 v15, s[40:43], s50 offen offset:3072  lds
    s_add_u32 m0, s68, 69632
    s_nop 0
    buffer_load_dwordx4 v16, s[40:43], s50 offen offset:0  lds
    buffer_load_dwordx4 v17, s[40:43], s50 offen offset:1024  lds
    buffer_load_dwordx4 v18, s[40:43], s50 offen offset:2048  lds
    buffer_load_dwordx4 v19, s[40:43], s50 offen offset:3072  lds
    s_add_u32 s50, s60, 811008
    s_cmp_ge_u32 s50, s61
    s_cselect_b32 s48, 2359296, 0
    s_sub_u32 s50, s50, s48
    s_add_u32 m0, s68, 81920
    s_nop 0
    buffer_load_dwordx4 v12, s[40:43], s50 offen offset:0  lds
    buffer_load_dwordx4 v13, s[40:43], s50 offen offset:1024  lds
    buffer_load_dwordx4 v14, s[40:43], s50 offen offset:2048  lds
    buffer_load_dwordx4 v15, s[40:43], s50 offen offset:3072  lds
    s_add_u32 m0, s68, 86016
    s_nop 0
    buffer_load_dwordx4 v16, s[40:43], s50 offen offset:0  lds
    buffer_load_dwordx4 v17, s[40:43], s50 offen offset:1024  lds
    buffer_load_dwordx4 v18, s[40:43], s50 offen offset:2048  lds
    buffer_load_dwordx4 v19, s[40:43], s50 offen offset:3072  lds
    s_add_u32 s50, s60, 884736
    s_cmp_ge_u32 s50, s61
    s_cselect_b32 s48, 2359296, 0
    s_sub_u32 s50, s50, s48
    s_add_u32 m0, s68, 0
    s_nop 0
    buffer_load_dwordx4 v12, s[40:43], s50 offen offset:0  lds
    buffer_load_dwordx4 v13, s[40:43], s50 offen offset:1024  lds
    buffer_load_dwordx4 v14, s[40:43], s50 offen offset:2048  lds
    buffer_load_dwordx4 v15, s[40:43], s50 offen offset:3072  lds
    s_add_u32 m0, s68, 4096
    s_nop 0
    buffer_load_dwordx4 v16, s[40:43], s50 offen offset:0  lds
    buffer_load_dwordx4 v17, s[40:43], s50 offen offset:1024  lds
    buffer_load_dwordx4 v18, s[40:43], s50 offen offset:2048  lds
    buffer_load_dwordx4 v19, s[40:43], s50 offen offset:3072  lds
    s_add_u32 s50, s60, 958464
    s_cmp_ge_u32 s50, s61
    s_cselect_b32 s48, 2359296, 0
    s_sub_u32 s50, s50, s48
    s_add_u32 m0, s68, 16384
    s_nop 0
    buffer_load_dwordx4 v12, s[40:43], s50 offen offset:0  lds
    buffer_load_dwordx4 v13, s[40:43], s50 offen offset:1024  lds
    buffer_load_dwordx4 v14, s[40:43], s50 offen offset:2048  lds
    buffer_load_dwordx4 v15, s[40:43], s50 offen offset:3072  lds
    s_add_u32 m0, s68, 20480
    s_nop 0
    buffer_load_dwordx4 v16, s[40:43], s50 offen offset:0  lds
    buffer_load_dwordx4 v17, s[40:43], s50 offen offset:1024  lds
    buffer_load_dwordx4 v18, s[40:43], s50 offen offset:2048  lds
    buffer_load_dwordx4 v19, s[40:43], s50 offen offset:3072  lds
    s_waitcnt vmcnt(40)
    s_barrier
    s_waitcnt vmcnt(32)
    s_barrier
    s_add_u32 s50, s60, 1032192
    s_cmp_ge_u32 s50, s61
    s_cselect_b32 s48, 2359296, 0
    s_sub_u32 s50, s50, s48
    s_add_u32 m0, s68, 32768
    s_nop 0
    buffer_load_dwordx4 v12, s[40:43], s50 offen offset:0  lds
    buffer_load_dwordx4 v13, s[40:43], s50 offen offset:1024  lds
    buffer_load_dwordx4 v14, s[40:43], s50 offen offset:2048  lds
    buffer_load_dwordx4 v15, s[40:43], s50 offen offset:3072  lds
    s_add_u32 m0, s68, 36864
    s_nop 0
    buffer_load_dwordx4 v16, s[40:43], s50 offen offset:0  lds
    s_waitcnt vmcnt(29)
    s_barrier
    buffer_load_dwordx4 v17, s[40:43], s50 offen offset:1024  lds
    buffer_load_dwordx4 v18, s[40:43], s50 offen offset:2048  lds
    buffer_load_dwordx4 v19, s[40:43], s50 offen offset:3072  lds
    s_add_u32 s50, s60, 1105920
    s_cmp_ge_u32 s50, s61
    s_cselect_b32 s48, 2359296, 0
    s_sub_u32 s50, s50, s48
    s_add_u32 m0, s68, 49152
    s_nop 0
    buffer_load_dwordx4 v12, s[40:43], s50 offen offset:0  lds
    buffer_load_dwordx4 v13, s[40:43], s50 offen offset:1024  lds
    s_waitcnt vmcnt(26)
    s_barrier
    buffer_load_dwordx4 v14, s[40:43], s50 offen offset:2048  lds
    buffer_load_dwordx4 v15, s[40:43], s50 offen offset:3072  lds
    s_add_u32 m0, s68, 53248
    s_nop 0
    buffer_load_dwordx4 v16, s[40:43], s50 offen offset:0  lds
    buffer_load_dwordx4 v17, s[40:43], s50 offen offset:1024  lds
    buffer_load_dwordx4 v18, s[40:43], s50 offen offset:2048  lds
    s_waitcnt vmcnt(23)
    s_barrier
    buffer_load_dwordx4 v19, s[40:43], s50 offen offset:3072  lds
    s_add_u32 s50, s60, 1179648
    s_cmp_ge_u32 s50, s61
    s_cselect_b32 s48, 2359296, 0
    s_sub_u32 s50, s50, s48
    s_add_u32 m0, s68, 65536
    s_nop 0
    buffer_load_dwordx4 v12, s[40:43], s50 offen offset:0  lds
    buffer_load_dwordx4 v13, s[40:43], s50 offen offset:1024  lds
    buffer_load_dwordx4 v14, s[40:43], s50 offen offset:2048  lds
    buffer_load_dwordx4 v15, s[40:43], s50 offen offset:3072  lds
    s_add_u32 m0, s68, 69632
    s_nop 0
    buffer_load_dwordx4 v16, s[40:43], s50 offen offset:0  lds
    s_waitcnt vmcnt(21)
    s_barrier
    buffer_load_dwordx4 v17, s[40:43], s50 offen offset:1024  lds
    buffer_load_dwordx4 v18, s[40:43], s50 offen offset:2048  lds
    buffer_load_dwordx4 v19, s[40:43], s50 offen offset:3072  lds
    s_add_u32 s50, s60, 1253376
    s_cmp_ge_u32 s50, s61
    s_cselect_b32 s48, 2359296, 0
    s_sub_u32 s50, s50, s48
    s_add_u32 m0, s68, 81920
    s_nop 0
    buffer_load_dwordx4 v12, s[40:43], s50 offen offset:0  lds
    buffer_load_dwordx4 v13, s[40:43], s50 offen offset:1024  lds
    s_barrier
    buffer_load_dwordx4 v14, s[40:43], s50 offen offset:2048  lds
    buffer_load_dwordx4 v15, s[40:43], s50 offen offset:3072  lds
    s_add_u32 m0, s68, 86016
    s_nop 0
    buffer_load_dwordx4 v16, s[40:43], s50 offen offset:0  lds
    buffer_load_dwordx4 v17, s[40:43], s50 offen offset:1024  lds
    buffer_load_dwordx4 v18, s[40:43], s50 offen offset:2048  lds
    s_waitcnt vmcnt(23)
    s_barrier
    buffer_load_dwordx4 v19, s[40:43], s50 offen offset:3072  lds
    s_add_u32 s50, s60, 1327104
    s_cmp_ge_u32 s50, s61
    s_cselect_b32 s48, 2359296, 0
    s_sub_u32 s50, s50, s48
    s_add_u32 m0, s68, 0
    s_nop 0
    buffer_load_dwordx4 v12, s[40:43], s50 offen offset:0  lds
    buffer_load_dwordx4 v13, s[40:43], s50 offen offset:1024  lds
    buffer_load_dwordx4 v14, s[40:43], s50 offen offset:2048  lds
    buffer_load_dwordx4 v15, s[40:43], s50 offen offset:3072  lds
    s_waitcnt vmcnt(20)
    s_barrier
    s_add_u32 m0, s68, 4096
    s_nop 0
    buffer_load_dwordx4 v16, s[40:43], s50 offen offset:0  lds
    buffer_load_dwordx4 v17, s[40:43], s50 offen offset:1024  lds
    buffer_load_dwordx4 v18, s[40:43], s50 offen offset:2048  lds
    buffer_load_dwordx4 v19, s[40:43], s50 offen offset:3072  lds
    s_add_u32 s50, s60, 1400832
    s_cmp_ge_u32 s50, s61
    s_cselect_b32 s48, 2359296, 0
    s_sub_u32 s50, s50, s48
    s_add_u32 m0, s68, 16384
    s_nop 0
    buffer_load_dwordx4 v12, s[40:43], s50 offen offset:0  lds
    s_barrier
    buffer_load_dwordx4 v13, s[40:43], s50 offen offset:1024  lds
    buffer_load_dwordx4 v14, s[40:43], s50 offen offset:2048  lds
    buffer_load_dwordx4 v15, s[40:43], s50 offen offset:3072  lds
    s_add_u32 m0, s68, 20480
    s_nop 0
    buffer_load_dwordx4 v16, s[40:43], s50 offen offset:0  lds
    buffer_load_dwordx4 v17, s[40:43], s50 offen offset:1024  lds
    s_waitcnt vmcnt(22)
    s_barrier
    buffer_load_dwordx4 v18, s[40:43], s50 offen offset:2048  lds
    buffer_load_dwordx4 v19, s[40:43], s50 offen offset:3072  lds
    s_add_u32 s50, s60, 1474560
    s_cmp_ge_u32 s50, s61
    s_cselect_b32 s48, 2359296, 0
    s_sub_u32 s50, s50, s48
    s_add_u32 m0, s68, 32768
    s_nop 0
    buffer_load_dwordx4 v12, s[40:43], s50 offen offset:0  lds
    buffer_load_dwordx4 v13, s[40:43], s50 offen offset:1024  lds
    buffer_load_dwordx4 v14, s[40:43], s50 offen offset:2048  lds
    s_waitcnt vmcnt(19)
    s_barrier
    buffer_load_dwordx4 v15, s[40:43], s50 offen offset:3072  lds
    s_add_u32 m0, s68, 36864
    s_nop 0
    buffer_load_dwordx4 v16, s[40:43], s50 offen offset:0  lds
    buffer_load_dwordx4 v17, s[40:43], s50 offen offset:1024  lds
    buffer_load_dwordx4 v18, s[40:43], s50 offen offset:2048  lds
    buffer_load_dwordx4 v19, s[40:43], s50 offen offset:3072  lds
    s_add_u32 s50, s60, 1548288
    s_cmp_ge_u32 s50, s61
    s_cselect_b32 s48, 2359296, 0
    s_sub_u32 s50, s50, s48
    s_add_u32 m0, s68, 49152
    s_nop 0
    buffer_load_dwordx4 v12, s[40:43], s50 offen offset:0  lds
    s_barrier
    buffer_load_dwordx4 v13, s[40:43], s50 offen offset:1024  lds
    buffer_load_dwordx4 v14, s[40:43], s50 offen offset:2048  lds
    buffer_load_dwordx4 v15, s[40:43], s50 offen offset:3072  lds
    s_add_u32 m0, s68, 53248
    s_nop 0
    buffer_load_dwordx4 v16, s[40:43], s50 offen offset:0  lds
    buffer_load_dwordx4 v17, s[40:43], s50 offen offset:1024  lds
    s_waitcnt vmcnt(22)
    s_barrier
    buffer_load_dwordx4 v18, s[40:43], s50 offen offset:2048  lds
    buffer_load_dwordx4 v19, s[40:43], s50 offen offset:3072  lds
    s_add_u32 s50, s60, 1622016
    s_cmp_ge_u32 s50, s61
    s_cselect_b32 s48, 2359296, 0
    s_sub_u32 s50, s50, s48
    s_add_u32 m0, s68, 65536
    s_nop 0
    buffer_load_dwordx4 v12, s[40:43], s50 offen offset:0  lds
    buffer_load_dwordx4 v13, s[40:43], s50 offen offset:1024  lds
    buffer_load_dwordx4 v14, s[40:43], s50 offen offset:2048  lds
    s_waitcnt vmcnt(19)
    s_barrier
    buffer_load_dwordx4 v15, s[40:43], s50 offen offset:3072  lds
    s_add_u32 m0, s68, 69632
    s_nop 0
    buffer_load_dwordx4 v16, s[40:43], s50 offen offset:0  lds
    buffer_load_dwordx4 v17, s[40:43], s50 offen offset:1024  lds
    buffer_load_dwordx4 v18, s[40:43], s50 offen offset:2048  lds
    buffer_load_dwordx4 v19, s[40:43], s50 offen offset:3072  lds
    s_barrier
    s_add_u32 s50, s60, 1695744
    s_cmp_ge_u32 s50, s61
    s_cselect_b32 s48, 2359296, 0
    s_sub_u32 s50, s50, s48
    s_add_u32 m0, s68, 81920
    s_nop 0
    buffer_load_dwordx4 v12, s[40:43], s50 offen offset:0  lds
    buffer_load_dwordx4 v13, s[40:43], s50 offen offset:1024  lds
    buffer_load_dwordx4 v14, s[40:43], s50 offen offset:2048  lds
    buffer_load_dwordx4 v15, s[40:43], s50 offen offset:3072  lds
    s_add_u32 m0, s68, 86016
    s_nop 0
    buffer_load_dwordx4 v16, s[40:43], s50 offen offset:0  lds
    s_waitcnt vmcnt(21)
    s_barrier
    buffer_load_dwordx4 v17, s[40:43], s50 offen offset:1024  lds
    buffer_load_dwordx4 v18, s[40:43], s50 offen offset:2048  lds
    buffer_load_dwordx4 v19, s[40:43], s50 offen offset:3072  lds
    s_add_u32 s50, s60, 1769472
    s_cmp_ge_u32 s50, s61
    s_cselect_b32 s48, 2359296, 0
    s_sub_u32 s50, s50, s48
    s_add_u32 m0, s68, 0
    s_nop 0
    buffer_load_dwordx4 v12, s[40:43], s50 offen offset:0  lds
    buffer_load_dwordx4 v13, s[40:43], s50 offen offset:1024  lds
    s_waitcnt vmcnt(18)
    s_barrier
    buffer_load_dwordx4 v14, s[40:43], s50 offen offset:2048  lds
    buffer_load_dwordx4 v15, s[40:43], s50 offen offset:3072  lds
    s_add_u32 m0, s68, 4096
    s_nop 0
    buffer_load_dwordx4 v16, s[40:43], s50 offen offset:0  lds
    buffer_load_dwordx4 v17, s[40:43], s50 offen offset:1024  lds
    buffer_load_dwordx4 v18, s[40:43], s50 offen offset:2048  lds
    s_barrier
    buffer_load_dwordx4 v19, s[40:43], s50 offen offset:3072  lds
    s_add_u32 s50, s60, 1843200
    s_cmp_ge_u32 s50, s61
    s_cselect_b32 s48, 2359296, 0
    s_sub_u32 s50, s50, s48
    s_add_u32 m0, s68, 16384
    s_nop 0
    buffer_load_dwordx4 v12, s[40:43], s50 offen offset:0  lds
    buffer_load_dwordx4 v13, s[40:43], s50 offen offset:1024  lds
    buffer_load_dwordx4 v14, s[40:43], s50 offen offset:2048  lds
    buffer_load_dwordx4 v15, s[40:43], s50 offen offset:3072  lds
    s_add_u32 m0, s68, 20480
    s_nop 0
    buffer_load_dwordx4 v16, s[40:43], s50 offen offset:0  lds
    s_waitcnt vmcnt(21)
    s_barrier
    buffer_load_dwordx4 v17, s[40:43], s50 offen offset:1024  lds
    buffer_load_dwordx4 v18, s[40:43], s50 offen offset:2048  lds
    buffer_load_dwordx4 v19, s[40:43], s50 offen offset:3072  lds
    s_add_u32 s50, s60, 1916928
    s_cmp_ge_u32 s50, s61
    s_cselect_b32 s48, 2359296, 0
    s_sub_u32 s50, s50, s48
    s_add_u32 m0, s68, 32768
    s_nop 0
    buffer_load_dwordx4 v12, s[40:43], s50 offen offset:0  lds
    buffer_load_dwordx4 v13, s[40:43], s50 offen offset:1024  lds
    s_waitcnt vmcnt(18)
    s_barrier
    buffer_load_dwordx4 v14, s[40:43], s50 offen offset:2048  lds
    buffer_load_dwordx4 v15, s[40:43], s50 offen offset:3072  lds
    s_add_u32 m0, s68, 36864
    s_nop 0
    buffer_load_dwordx4 v16, s[40:43], s50 offen offset:0  lds
    buffer_load_dwordx4 v17, s[40:43], s50 offen offset:1024  lds
    buffer_load_dwordx4 v18, s[40:43], s50 offen offset:2048  lds
    s_barrier
    buffer_load_dwordx4 v19, s[40:43], s50 offen offset:3072  lds
    s_add_u32 s50, s60, 1990656
    s_cmp_ge_u32 s50, s61
    s_cselect_b32 s48, 2359296, 0
    s_sub_u32 s50, s50, s48
    s_add_u32 m0, s68, 49152
    s_nop 0
    buffer_load_dwordx4 v12, s[40:43], s50 offen offset:0  lds
    buffer_load_dwordx4 v13, s[40:43], s50 offen offset:1024  lds
    buffer_load_dwordx4 v14, s[40:43], s50 offen offset:2048  lds
    buffer_load_dwordx4 v15, s[40:43], s50 offen offset:3072  lds
    s_waitcnt vmcnt(20)
    s_barrier
    s_add_u32 m0, s68, 53248
    s_nop 0
    buffer_load_dwordx4 v16, s[40:43], s50 offen offset:0  lds
    buffer_load_dwordx4 v17, s[40:43], s50 offen offset:1024  lds
    buffer_load_dwordx4 v18, s[40:43], s50 offen offset:2048  lds
    buffer_load_dwordx4 v19, s[40:43], s50 offen offset:3072  lds
    s_add_u32 s50, s60, 2064384
    s_cmp_ge_u32 s50, s61
    s_cselect_b32 s48, 2359296, 0
    s_sub_u32 s50, s50, s48
    s_add_u32 m0, s68, 65536
    s_nop 0
    buffer_load_dwordx4 v12, s[40:43], s50 offen offset:0  lds
    s_waitcnt vmcnt(17)
    s_barrier
    buffer_load_dwordx4 v13, s[40:43], s50 offen offset:1024  lds
    buffer_load_dwordx4 v14, s[40:43], s50 offen offset:2048  lds
    buffer_load_dwordx4 v15, s[40:43], s50 offen offset:3072  lds
    s_add_u32 m0, s68, 69632
    s_nop 0
    buffer_load_dwordx4 v16, s[40:43], s50 offen offset:0  lds
    buffer_load_dwordx4 v17, s[40:43], s50 offen offset:1024  lds
    s_barrier
    buffer_load_dwordx4 v18, s[40:43], s50 offen offset:2048  lds
    buffer_load_dwordx4 v19, s[40:43], s50 offen offset:3072  lds
    s_add_u32 s50, s60, 2138112
    s_cmp_ge_u32 s50, s61
    s_cselect_b32 s48, 2359296, 0
    s_sub_u32 s50, s50, s48
    s_add_u32 m0, s68, 81920
    s_nop 0
    buffer_load_dwordx4 v12, s[40:43], s50 offen offset:0  lds
    buffer_load_dwordx4 v13, s[40:43], s50 offen offset:1024  lds
    buffer_load_dwordx4 v14, s[40:43], s50 offen offset:2048  lds
    s_waitcnt vmcnt(19)
    s_barrier
    buffer_load_dwordx4 v15, s[40:43], s50 offen offset:3072  lds
    s_add_u32 m0, s68, 86016
    s_nop 0
    buffer_load_dwordx4 v16, s[40:43], s50 offen offset:0  lds
    buffer_load_dwordx4 v17, s[40:43], s50 offen offset:1024  lds
    buffer_load_dwordx4 v18, s[40:43], s50 offen offset:2048  lds
    buffer_load_dwordx4 v19, s[40:43], s50 offen offset:3072  lds
    s_add_u32 s50, s60, 2211840
    s_cmp_ge_u32 s50, s61
    s_cselect_b32 s48, 2359296, 0
    s_sub_u32 s50, s50, s48
    s_add_u32 m0, s68, 0
    s_nop 0
    buffer_load_dwordx4 v12, s[40:43], s50 offen offset:0  lds
    s_waitcnt vmcnt(17)
    s_barrier
    buffer_load_dwordx4 v13, s[40:43], s50 offen offset:1024  lds
    buffer_load_dwordx4 v14, s[40:43], s50 offen offset:2048  lds
    buffer_load_dwordx4 v15, s[40:43], s50 offen offset:3072  lds
    s_add_u32 m0, s68, 4096
    s_nop 0
    buffer_load_dwordx4 v16, s[40:43], s50 offen offset:0  lds
    buffer_load_dwordx4 v17, s[40:43], s50 offen offset:1024  lds
    s_barrier
    buffer_load_dwordx4 v18, s[40:43], s50 offen offset:2048  lds
    buffer_load_dwordx4 v19, s[40:43], s50 offen offset:3072  lds
    s_add_u32 s50, s60, 2285568
    s_cmp_ge_u32 s50, s61
    s_cselect_b32 s48, 2359296, 0
    s_sub_u32 s50, s50, s48
    s_add_u32 m0, s68, 16384
    s_nop 0
    buffer_load_dwordx4 v12, s[40:43], s50 offen offset:0  lds
    buffer_load_dwordx4 v13, s[40:43], s50 offen offset:1024  lds
    buffer_load_dwordx4 v14, s[40:43], s50 offen offset:2048  lds
    s_waitcnt vmcnt(19)
    s_barrier
    buffer_load_dwordx4 v15, s[40:43], s50 offen offset:3072  lds
    s_add_u32 m0, s68, 20480
    s_nop 0
    buffer_load_dwordx4 v16, s[40:43], s50 offen offset:0  lds
    buffer_load_dwordx4 v17, s[40:43], s50 offen offset:1024  lds
    buffer_load_dwordx4 v18, s[40:43], s50 offen offset:2048  lds
    buffer_load_dwordx4 v19, s[40:43], s50 offen offset:3072  lds
    s_waitcnt vmcnt(16)
    s_barrier
    s_add_u32 s50, s58, 0
    s_cmp_ge_u32 s50, s59
    s_cselect_b32 s48, 4718592, 0
    s_sub_u32 s50, s50, s48
    s_add_u32 m0, s68, 32768
    s_nop 0
    buffer_load_dwordx4 v56, s[44:47], s50 offen offset:0  lds
    buffer_load_dwordx4 v57, s[44:47], s50 offen offset:1024  lds
    buffer_load_dwordx4 v58, s[44:47], s50 offen offset:2048  lds
    buffer_load_dwordx4 v59, s[44:47], s50 offen offset:3072  lds
    s_add_u32 m0, s68, 36864
    s_nop 0
    buffer_load_dwordx4 v60, s[44:47], s50 offen offset:0  lds
    buffer_load_dwordx4 v61, s[44:47], s50 offen offset:1024  lds
    buffer_load_dwordx4 v62, s[44:47], s50 offen offset:2048  lds
    buffer_load_dwordx4 v63, s[44:47], s50 offen offset:3072  lds
    s_add_u32 s50, s58, 262144
    s_cmp_ge_u32 s50, s59
    s_cselect_b32 s48, 4718592, 0
    s_sub_u32 s50, s50, s48
    s_add_u32 m0, s68, 49152
    s_nop 0
    buffer_load_dwordx4 v56, s[44:47], s50 offen offset:0  lds
    buffer_load_dwordx4 v57, s[44:47], s50 offen offset:1024  lds
    s_waitcnt vmcnt(18)
    s_barrier
    buffer_load_dwordx4 v58, s[44:47], s50 offen offset:2048  lds
    buffer_load_dwordx4 v59, s[44:47], s50 offen offset:3072  lds
    s_add_u32 m0, s68, 53248
    s_nop 0
    buffer_load_dwordx4 v60, s[44:47], s50 offen offset:0  lds
    buffer_load_dwordx4 v61, s[44:47], s50 offen offset:1024  lds
    buffer_load_dwordx4 v62, s[44:47], s50 offen offset:2048  lds
    buffer_load_dwordx4 v63, s[44:47], s50 offen offset:3072  lds
    s_add_u32 s50, s58, 524288
    s_cmp_ge_u32 s50, s59
    s_cselect_b32 s48, 4718592, 0
    s_sub_u32 s50, s50, s48
    s_add_u32 m0, s68, 65536
    s_nop 0
    buffer_load_dwordx4 v56, s[44:47], s50 offen offset:0  lds
    buffer_load_dwordx4 v57, s[44:47], s50 offen offset:1024  lds
    buffer_load_dwordx4 v58, s[44:47], s50 offen offset:2048  lds
    buffer_load_dwordx4 v59, s[44:47], s50 offen offset:3072  lds
    s_add_u32 m0, s68, 69632
    s_nop 0
    buffer_load_dwordx4 v60, s[44:47], s50 offen offset:0  lds
    buffer_load_dwordx4 v61, s[44:47], s50 offen offset:1024  lds
    s_waitcnt vmcnt(22)
    s_barrier
    buffer_load_dwordx4 v62, s[44:47], s50 offen offset:2048  lds
    buffer_load_dwordx4 v63, s[44:47], s50 offen offset:3072  lds
    s_add_u32 s50, s58, 786432
    s_cmp_ge_u32 s50, s59
    s_cselect_b32 s48, 4718592, 0
    s_sub_u32 s50, s50, s48
    s_add_u32 m0, s68, 81920
    s_nop 0
    buffer_load_dwordx4 v56, s[44:47], s50 offen offset:0  lds
    buffer_load_dwordx4 v57, s[44:47], s50 offen offset:1024  lds
    buffer_load_dwordx4 v58, s[44:47], s50 offen offset:2048  lds
    buffer_load_dwordx4 v59, s[44:47], s50 offen offset:3072  lds
    s_add_u32 m0, s68, 86016
    s_nop 0
    buffer_load_dwordx4 v60, s[44:47], s50 offen offset:0  lds
    buffer_load_dwordx4 v61, s[44:47], s50 offen offset:1024  lds
    buffer_load_dwordx4 v62, s[44:47], s50 offen offset:2048  lds
    buffer_load_dwordx4 v63, s[44:47], s50 offen offset:3072  lds
    s_barrier
    s_branch L_m_102
L_m_101:
    s_sub_u32 s56, s5, 27
    s_branch L_skip_16
L_stub_16:
    s_branch L_back_w1
L_skip_16:
    s_lshl_b32 s56, s56, 1
    s_add_u32 s56, s56, s62
    s_add_u32 s56, s56, 96
    s_barrier
L_m_103:
    s_cmp_ge_u32 s56, 116
    s_cbranch_scc1 L_m_104
    s_mul_i32 s48, s56, 820
    s_lshr_b32 s48, s48, 13
    s_mul_i32 s49, s48, 10
    s_sub_u32 s49, s56, s49
    s_lshl_b32 s49, s49, 6
    v_add_u32 v22, s49, v0
    s_and_b32 s49, s4, 7
    s_mul_i32 s49, s49, 4
    s_add_u32 s48, s48, s49
    s_add_u32 s48, s48, 26
    s_and_b32 s48, s48, 31
    s_mul_i32 s48, s48, 73728
    s_mul_i32 s49, s4, 1152
    s_and_b32 s49, s49, -256
    s_add_u32 s48, s48, s49
    v_mul_u32_u24 v23, 820, v22
    v_lshrrev_b32 v23, 13, v23
    v_mul_u32_u24 v24, 10, v23
    v_sub_u32 v24, v22, v24
    v_and_b32 v22, 7, v23
    v_lshrrev_b32 v23, 3, v23
    v_lshl_add_u32 v22, v22, 8, v23
    v_mul_u32_u24 v22, 9216, v22
    v_lshl_add_u32 v22, v24, 7, v22
    buffer_load_dword v25, v22, s[40:43], s48 offen
    s_add_u32 s56, s56, 10
    s_branch L_m_103
L_m_104:
    s_barrier
    s_barrier
    s_barrier
    s_barrier
    s_barrier
    s_add_u32 s50, s58, 0
    s_cmp_ge_u32 s50, s59
    s_cselect_b32 s48, 4718592, 0
    s_sub_u32 s50, s50, s48
    s_add_u32 m0, s68, 32768
    s_nop 0
    buffer_load_dwordx4 v56, s[44:47], s50 offen offset:0  lds
    buffer_load_dwordx4 v57, s[44:47], s50 offen offset:1024  lds
    buffer_load_dwordx4 v58, s[44:47], s50 offen offset:2048  lds
    buffer_load_dwordx4 v59, s[44:47], s50 offen offset:3072  lds
    s_add_u32 m0, s68, 36864
    s_nop 0
    buffer_load_dwordx4 v60, s[44:47], s50 offen offset:0  lds
    buffer_load_dwordx4 v61, s[44:47], s50 offen offset:1024  lds
    buffer_load_dwordx4 v62, s[44:47], s50 offen offset:2048  lds
    buffer_load_dwordx4 v63, s[44:47], s50 offen offset:3072  lds
    s_add_u32 s50, s58, 262144
    s_cmp_ge_u32 s50, s59
    s_cselect_b32 s48, 4718592, 0
    s_sub_u32 s50, s50, s48
    s_add_u32 m0, s68, 49152
    s_nop 0
    buffer_load_dwordx4 v56, s[44:47], s50 offen offset:0  lds
    buffer_load_dwordx4 v57, s[44:47], s50 offen offset:1024  lds
    buffer_load_dwordx4 v58, s[44:47], s50 offen offset:2048  lds
    buffer_load_dwordx4 v59, s[44:47], s50 offen offset:3072  lds
    s_add_u32 m0, s68, 53248
    s_nop 0
    buffer_load_dwordx4 v60, s[44:47], s50 offen offset:0  lds
    buffer_load_dwordx4 v61, s[44:47], s50 offen offset:1024  lds
    buffer_load_dwordx4 v62, s[44:47], s50 offen offset:2048  lds
    buffer_load_dwordx4 v63, s[44:47], s50 offen offset:3072  lds
    s_add_u32 s50, s58, 524288
    s_cmp_ge_u32 s50, s59
    s_cselect_b32 s48, 4718592, 0
    s_sub_u32 s50, s50, s48
    s_add_u32 m0, s68, 65536
    s_nop 0
    buffer_load_dwordx4 v56, s[44:47], s50 offen offset:0  lds
    buffer_load_dwordx4 v57, s[44:47], s50 offen offset:1024  lds
    buffer_load_dwordx4 v58, s[44:47], s50 offen offset:2048  lds
    buffer_load_dwordx4 v59, s[44:47], s50 offen offset:3072  lds
    s_add_u32 m0, s68, 69632
    s_nop 0
    buffer_load_dwordx4 v60, s[44:47], s50 offen offset:0  lds
    buffer_load_dwordx4 v61, s[44:47], s50 offen offset:1024  lds
    buffer_load_dwordx4 v62, s[44:47], s50 offen offset:2048  lds
    buffer_load_dwordx4 v63, s[44:47], s50 offen offset:3072  lds
    s_add_u32 s50, s58, 786432
    s_cmp_ge_u32 s50, s59
    s_cselect_b32 s48, 4718592, 0
    s_sub_u32 s50, s50, s48
    s_add_u32 m0, s68, 81920
    s_nop 0
    buffer_load_dwordx4 v56, s[44:47], s50 offen offset:0  lds
    buffer_load_dwordx4 v57, s[44:47], s50 offen offset:1024  lds
    buffer_load_dwordx4 v58, s[44:47], s50 offen offset:2048  lds
    buffer_load_dwordx4 v59, s[44:47], s50 offen offset:3072  lds
    s_add_u32 m0, s68, 86016
    s_nop 0
    buffer_load_dwordx4 v60, s[44:47], s50 offen offset:0  lds
    buffer_load_dwordx4 v61, s[44:47], s50 offen offset:1024  lds
    buffer_load_dwordx4 v62, s[44:47], s50 offen offset:2048  lds
    buffer_load_dwordx4 v63, s[44:47], s50 offen offset:3072  lds
L_m_102:
    s_add_u32 s50, s58, 1048576
    s_cmp_ge_u32 s50, s59
    s_cselect_b32 s48, 4718592, 0
    s_sub_u32 s50, s50, s48
    s_add_u32 m0, s68, 0
    s_nop 0
    buffer_load_dwordx4 v56, s[44:47], s50 offen offset:0  lds
    buffer_load_dwordx4 v57, s[44:47], s50 offen offset:1024  lds
    buffer_load_dwordx4 v58, s[44:47], s50 offen offset:2048  lds
    buffer_load_dwordx4 v59, s[44:47], s50 offen offset:3072  lds
    s_add_u32 m0, s68, 4096
    s_nop 0
    buffer_load_dwordx4 v60, s[44:47], s50 offen offset:0  lds
    buffer_load_dwordx4 v61, s[44:47], s50 offen offset:1024  lds
    buffer_load_dwordx4 v62, s[44:47], s50 offen offset:2048  lds
    buffer_load_dwordx4 v63, s[44:47], s50 offen offset:3072  lds
    s_add_u32 s50, s58, 1310720
    s_cmp_ge_u32 s50, s59
    s_cselect_b32 s48, 4718592, 0
    s_sub_u32 s50, s50, s48
    s_add_u32 m0, s68, 16384
    s_nop 0
    buffer_load_dwordx4 v56, s[44:47], s50 offen offset:0  lds
    buffer_load_dwordx4 v57, s[44:47], s50 offen offset:1024  lds
    buffer_load_dwordx4 v58, s[44:47], s50 offen offset:2048  lds
    buffer_load_dwordx4 v59, s[44:47], s50 offen offset:3072  lds
    s_add_u32 m0, s68, 20480
    s_nop 0
    buffer_load_dwordx4 v60, s[44:47], s50 offen offset:0  lds
    buffer_load_dwordx4 v61, s[44:47], s50 offen offset:1024  lds
    buffer_load_dwordx4 v62, s[44:47], s50 offen offset:2048  lds
    buffer_load_dwordx4 v63, s[44:47], s50 offen offset:3072  lds
    s_nop 0
L_back_w2:
    s_waitcnt vmcnt(0)
    s_barrier
    s_barrier
    s_add_u32 s50, s58, 1572864
    s_cmp_ge_u32 s50, s59
    s_cselect_b32 s48, 4718592, 0
    s_sub_u32 s50, s50, s48
    s_add_u32 m0, s68, 0
    s_nop 0
    buffer_load_dwordx4 v56, s[44:47], s50 offen offset:0  lds
    buffer_load_dwordx4 v57, s[44:47], s50 offen offset:1024  lds
    buffer_load_dwordx4 v58, s[44:47], s50 offen offset:2048  lds
    buffer_load_dwordx4 v59, s[44:47], s50 offen offset:3072  lds
    s_add_u32 m0, s68, 4096
    s_nop 0
    buffer_load_dwordx4 v60, s[44:47], s50 offen offset:0  lds
    buffer_load_dwordx4 v61, s[44:47], s50 offen offset:1024  lds
    buffer_load_dwordx4 v62, s[44:47], s50 offen offset:2048  lds
    buffer_load_dwordx4 v63, s[44:47], s50 offen offset:3072  lds
    s_barrier
    s_add_u32 s50, s58, 1835008
    s_cmp_ge_u32 s50, s59
    s_cselect_b32 s48, 4718592, 0
    s_sub_u32 s50, s50, s48
    s_add_u32 m0, s68, 16384
    s_nop 0
    buffer_load_dwordx4 v56, s[44:47], s50 offen offset:0  lds
    buffer_load_dwordx4 v57, s[44:47], s50 offen offset:1024  lds
    buffer_load_dwordx4 v58, s[44:47], s50 offen offset:2048  lds
    buffer_load_dwordx4 v59, s[44:47], s50 offen offset:3072  lds
    s_add_u32 m0, s68, 20480
    s_nop 0
    buffer_load_dwordx4 v60, s[44:47], s50 offen offset:0  lds
    buffer_load_dwordx4 v61, s[44:47], s50 offen offset:1024  lds
    buffer_load_dwordx4 v62, s[44:47], s50 offen offset:2048  lds
    buffer_load_dwordx4 v63, s[44:47], s50 offen offset:3072  lds
    s_add_u32 s50, s58, 2097152
    s_cmp_ge_u32 s50, s59
    s_cselect_b32 s48, 4718592, 0
    s_sub_u32 s50, s50, s48
    s_add_u32 m0, s68, 32768
    s_nop 0
    buffer_load_dwordx4 v56, s[44:47], s50 offen offset:0  lds
    buffer_load_dwordx4 v57, s[44:47], s50 offen offset:1024  lds
    buffer_load_dwordx4 v58, s[44:47], s50 offen offset:2048  lds
    buffer_load_dwordx4 v59, s[44:47], s50 offen offset:3072  lds
    s_add_u32 m0, s68, 36864
    s_nop 0
    buffer_load_dwordx4 v60, s[44:47], s50 offen offset:0  lds
    buffer_load_dwordx4 v61, s[44:47], s50 offen offset:1024  lds
    buffer_load_dwordx4 v62, s[44:47], s50 offen offset:2048  lds
    buffer_load_dwordx4 v63, s[44:47], s50 offen offset:3072  lds
    s_add_u32 s50, s58, 2359296
    s_cmp_ge_u32 s50, s59
    s_cselect_b32 s48, 4718592, 0
    s_sub_u32 s50, s50, s48
    s_add_u32 m0, s68, 49152
    s_nop 0
    buffer_load_dwordx4 v56, s[44:47], s50 offen offset:0  lds
    buffer_load_dwordx4 v57, s[44:47], s50 offen offset:1024  lds
    buffer_load_dwordx4 v58, s[44:47], s50 offen offset:2048  lds
    buffer_load_dwordx4 v59, s[44:47], s50 offen offset:3072  lds
    s_add_u32 m0, s68, 53248
    s_nop 0
    buffer_load_dwordx4 v60, s[44:47], s50 offen offset:0  lds
    buffer_load_dwordx4 v61, s[44:47], s50 offen offset:1024  lds
    buffer_load_dwordx4 v62, s[44:47], s50 offen offset:2048  lds
    buffer_load_dwordx4 v63, s[44:47], s50 offen offset:3072  lds
    v_mov_b64 v[100:101], -1
    v_mov_b64 v[102:103], -1
    v_mov_b32 v104, v3
    v_mov_b32 v105, v3
    v_mov_b32 v106, v3
    v_mov_b32 v107, v3
    v_lshlrev_b32 v110, 4, v0
    s_lshl_b32 s48, s2, 7
    s_add_u32 s48, s48, 38797312
    v_add_u32 v108, s48, v110
    s_cmp_eq_u32 s62, 0
    s_cselect_b32 s48, 8, 0
    v_cmp_gt_u32 vcc, s48, v0
    v_mov_b32 v109, 2146435072
    s_nop 0
    v_cndmask_b32 v108, v109, v108, vcc
    v_min_u32 v109, 2, v0
    v_add_u32 v109, 1, v109
    v_lshlrev_b32 v109, 1, v109
    v_xor_b32 v109, s2, v109
    v_lshlrev_b32 v109, 7, v109
    v_add_u32 v109, 38797312, v109
    v_lshlrev_b32 v111, 4, v0
    s_mul_i32 s56, s2, 27648
    s_lshl_b32 s48, s62, 10
    s_add_u32 s56, s56, s48
    s_add_u32 s56, s56, 27262976
    s_waitcnt vmcnt(24)
    s_barrier
    s_add_u32 s50, s58, 2621440
    s_cmp_ge_u32 s50, s59
    s_cselect_b32 s48, 4718592, 0
    s_sub_u32 s50, s50, s48
    s_add_u32 m0, s68, 65536
    s_nop 0
    buffer_load_dwordx4 v56, s[44:47], s50 offen offset:0  lds
    buffer_load_dwordx4 v57, s[44:47], s50 offen offset:1024  lds
    buffer_load_dwordx4 v58, s[44:47], s50 offen offset:2048  lds
    buffer_load_dwordx4 v59, s[44:47], s50 offen offset:3072  lds
    s_waitcnt vmcnt(20)
    s_barrier
    s_add_u32 m0, s68, 69632
    s_nop 0
    buffer_load_dwordx4 v60, s[44:47], s50 offen offset:0  lds
    buffer_load_dwordx4 v61, s[44:47], s50 offen offset:1024  lds
    buffer_load_dwordx4 v62, s[44:47], s50 offen offset:2048  lds
    buffer_load_dwordx4 v63, s[44:47], s50 offen offset:3072  lds
    s_waitcnt vmcnt(16)
    s_barrier
    s_add_u32 s57, s56, 0
    buffer_store_dwordx4 v[100:103], v111, s[36:39], s57 offen sc1
    s_add_u32 s50, s58, 2883584
    s_cmp_ge_u32 s50, s59
    s_cselect_b32 s48, 4718592, 0
    s_sub_u32 s50, s50, s48
    s_add_u32 m0, s68, 0
    s_nop 0
    buffer_load_dwordx4 v56, s[44:47], s50 offen offset:0  lds
    buffer_load_dwordx4 v57, s[44:47], s50 offen offset:1024  lds
    buffer_load_dwordx4 v58, s[44:47], s50 offen offset:2048  lds
    buffer_load_dwordx4 v59, s[44:47], s50 offen offset:3072  lds
    s_waitcnt vmcnt(13)
    s_barrier
    s_add_u32 s57, s56, 2048
    buffer_store_dwordx4 v[100:103], v111, s[36:39], s57 offen sc1
    s_add_u32 s57, s56, 4096
    buffer_store_dwordx4 v[100:103], v111, s[36:39], s57 offen sc1
    s_add_u32 m0, s68, 4096
    s_nop 0
    buffer_load_dwordx4 v60, s[44:47], s50 offen offset:0  lds
    buffer_load_dwordx4 v61, s[44:47], s50 offen offset:1024  lds
    buffer_load_dwordx4 v62, s[44:47], s50 offen offset:2048  lds
    buffer_load_dwordx4 v63, s[44:47], s50 offen offset:3072  lds
    s_barrier
    s_add_u32 s57, s56, 6144
    buffer_store_dwordx4 v[100:103], v111, s[36:39], s57 offen sc1
    s_add_u32 s57, s56, 8192
    buffer_store_dwordx4 v[100:103], v111, s[36:39], s57 offen sc1
    s_add_u32 s50, s58, 3145728
    s_cmp_ge_u32 s50, s59
    s_cselect_b32 s48, 4718592, 0
    s_sub_u32 s50, s50, s48
    s_add_u32 m0, s68, 16384
    s_nop 0
    buffer_load_dwordx4 v56, s[44:47], s50 offen offset:0  lds
    buffer_load_dwordx4 v57, s[44:47], s50 offen offset:1024  lds
    buffer_load_dwordx4 v58, s[44:47], s50 offen offset:2048  lds
    buffer_load_dwordx4 v59, s[44:47], s50 offen offset:3072  lds
    s_waitcnt vmcnt(17)
    s_barrier
    s_add_u32 s57, s56, 10240
    buffer_store_dwordx4 v[100:103], v111, s[36:39], s57 offen sc1
    s_add_u32 s57, s56, 12288
    buffer_store_dwordx4 v[100:103], v111, s[36:39], s57 offen sc1
    s_add_u32 m0, s68, 20480
    s_nop 0
    buffer_load_dwordx4 v60, s[44:47], s50 offen offset:0  lds
    buffer_load_dwordx4 v61, s[44:47], s50 offen offset:1024  lds
    buffer_load_dwordx4 v62, s[44:47], s50 offen offset:2048  lds
    buffer_load_dwordx4 v63, s[44:47], s50 offen offset:3072  lds
    s_barrier
    s_add_u32 s57, s56, 14336
    buffer_store_dwordx4 v[100:103], v111, s[36:39], s57 offen sc1
    s_add_u32 s50, s58, 3407872
    s_cmp_ge_u32 s50, s59
    s_cselect_b32 s48, 4718592, 0
    s_sub_u32 s50, s50, s48
    s_add_u32 m0, s68, 32768
    s_nop 0
    buffer_load_dwordx4 v56, s[44:47], s50 offen offset:0  lds
    buffer_load_dwordx4 v57, s[44:47], s50 offen offset:1024  lds
    buffer_load_dwordx4 v58, s[44:47], s50 offen offset:2048  lds
    buffer_load_dwordx4 v59, s[44:47], s50 offen offset:3072  lds
    s_waitcnt vmcnt(17)
    s_barrier
    s_add_u32 s57, s56, 16384
    buffer_store_dwordx4 v[100:103], v111, s[36:39], s57 offen sc1
    s_add_u32 s57, s56, 18432
    buffer_store_dwordx4 v[100:103], v111, s[36:39], s57 offen sc1
    s_add_u32 m0, s68, 36864
    s_nop 0
    buffer_load_dwordx4 v60, s[44:47], s50 offen offset:0  lds
    buffer_load_dwordx4 v61, s[44:47], s50 offen offset:1024  lds
    buffer_load_dwordx4 v62, s[44:47], s50 offen offset:2048  lds
    buffer_load_dwordx4 v63, s[44:47], s50 offen offset:3072  lds
    s_barrier
    s_add_u32 s57, s56, 20480
    buffer_store_dwordx4 v[100:103], v111, s[36:39], s57 offen sc1
    s_add_u32 s57, s56, 22528
    buffer_store_dwordx4 v[100:103], v111, s[36:39], s57 offen sc1
    s_add_u32 s50, s58, 3670016
    s_cmp_ge_u32 s50, s59
    s_cselect_b32 s48, 4718592, 0
    s_sub_u32 s50, s50, s48
    s_add_u32 m0, s68, 49152
    s_nop 0
    buffer_load_dwordx4 v56, s[44:47], s50 offen offset:0  lds
    buffer_load_dwordx4 v57, s[44:47], s50 offen offset:1024  lds
    buffer_load_dwordx4 v58, s[44:47], s50 offen offset:2048  lds
    buffer_load_dwordx4 v59, s[44:47], s50 offen offset:3072  lds
    s_waitcnt vmcnt(17)
    s_barrier
    s_add_u32 s57, s56, 24576
    buffer_store_dwordx4 v[100:103], v111, s[36:39], s57 offen sc1
    s_mul_i32 s57, s62, -2048
    s_add_u32 s57, s57, 26624
    s_add_u32 s57, s57, s56
    buffer_store_dwordx4 v[100:103], v111, s[36:39], s57 offen sc1
    s_add_u32 m0, s68, 53248
    s_nop 0
    buffer_load_dwordx4 v60, s[44:47], s50 offen offset:0  lds
    buffer_load_dwordx4 v61, s[44:47], s50 offen offset:1024  lds
    buffer_load_dwordx4 v62, s[44:47], s50 offen offset:2048  lds
    buffer_load_dwordx4 v63, s[44:47], s50 offen offset:3072  lds
    s_barrier
    s_add_u32 s50, s58, 3932160
    s_cmp_ge_u32 s50, s59
    s_cselect_b32 s48, 4718592, 0
    s_sub_u32 s50, s50, s48
    s_add_u32 m0, s68, 65536
    s_nop 0
    buffer_load_dwordx4 v56, s[44:47], s50 offen offset:0  lds
    buffer_load_dwordx4 v57, s[44:47], s50 offen offset:1024  lds
    buffer_load_dwordx4 v58, s[44:47], s50 offen offset:2048  lds
    buffer_load_dwordx4 v59, s[44:47], s50 offen offset:3072  lds
    s_barrier
    s_add_u32 m0, s68, 69632
    s_nop 0
    buffer_load_dwordx4 v60, s[44:47], s50 offen offset:0  lds
    buffer_load_dwordx4 v61, s[44:47], s50 offen offset:1024  lds
    buffer_load_dwordx4 v62, s[44:47], s50 offen offset:2048  lds
    buffer_load_dwordx4 v63, s[44:47], s50 offen offset:3072  lds
    s_waitcnt vmcnt(12)
    s_barrier
    buffer_store_dwordx4 v[104:107], v108, s[36:39], 0 offen sc1
    s_add_u32 s50, s58, 4194304
    s_cmp_ge_u32 s50, s59
    s_cselect_b32 s48, 4718592, 0
    s_sub_u32 s50, s50, s48
    s_add_u32 m0, s68, 0
    s_nop 0
    buffer_load_dwordx4 v56, s[44:47], s50 offen offset:0  lds
    buffer_load_dwordx4 v57, s[44:47], s50 offen offset:1024  lds
    buffer_load_dwordx4 v58, s[44:47], s50 offen offset:2048  lds
    buffer_load_dwordx4 v59, s[44:47], s50 offen offset:3072  lds
    s_waitcnt vmcnt(25)
    s_barrier
    s_add_u32 m0, s68, 4096
    s_nop 0
    buffer_load_dwordx4 v60, s[44:47], s50 offen offset:0  lds
    buffer_load_dwordx4 v61, s[44:47], s50 offen offset:1024  lds
    buffer_load_dwordx4 v62, s[44:47], s50 offen offset:2048  lds
    buffer_load_dwordx4 v63, s[44:47], s50 offen offset:3072  lds
    s_waitcnt vmcnt(17)
    s_barrier
    s_add_u32 s50, s58, 4456448
    s_cmp_ge_u32 s50, s59
    s_cselect_b32 s48, 4718592, 0
    s_sub_u32 s50, s50, s48
    s_add_u32 m0, s68, 16384
    s_nop 0
    buffer_load_dwordx4 v56, s[44:47], s50 offen offset:0  lds
    buffer_load_dwordx4 v57, s[44:47], s50 offen offset:1024  lds
    buffer_load_dwordx4 v58, s[44:47], s50 offen offset:2048  lds
    buffer_load_dwordx4 v59, s[44:47], s50 offen offset:3072  lds
    s_waitcnt vmcnt(13)
    s_barrier
    buffer_load_dword v110, v109, s[36:39], 0 offen sc1
    s_add_u32 m0, s68, 20480
    s_nop 0
    buffer_load_dwordx4 v60, s[44:47], s50 offen offset:0  lds
    buffer_load_dwordx4 v61, s[44:47], s50 offen offset:1024  lds
    buffer_load_dwordx4 v62, s[44:47], s50 offen offset:2048  lds
    buffer_load_dwordx4 v63, s[44:47], s50 offen offset:3072  lds
    s_waitcnt vmcnt(9)
    s_barrier
    s_waitcnt vmcnt(0)
    s_waitcnt vmcnt(4)
    v_cmp_ne_u32 vcc, v3, v110
    s_nop 0
    s_cbranch_vccz L_m_105
Lp_m_106:
    buffer_load_dword v110, v109, s[36:39], 0 offen sc1
    s_waitcnt vmcnt(0)
    v_cmp_ne_u32 vcc, v3, v110
    s_nop 0
    s_cbranch_vccz Le_m_107
    s_sub_u32 s7, s7, 1
    s_cbranch_scc1 Le_m_107
    s_mov_b64 exec, vcc
    s_sleep 1
    s_branch Lp_m_106
Le_m_107:
    s_mov_b64 exec, -1
    s_max_i32 s7, s7, 0
L_m_105:
    s_barrier
    s_barrier
L_m_100:
    v_lshlrev_b32 v100, 4, v0
    v_lshlrev_b32 v101, 2, v0
    s_mul_i32 s48, s3, 2304
    s_mul_i32 s60, s2, 27648
    s_add_u32 s60, s60, s48
    s_add_u32 s60, s60, 27272192
    s_add_u32 s61, s60, 9216
    s_mul_i32 s63, s3, 4608
    s_add_u32 s63, s63, 49152
    v_add_u32 v102, s63, v100
    v_add_u32 v103, s63, v101
Lp_m_108:
    s_add_u32 m0, s63, 2304
    s_nop 0
    buffer_load_dwordx4 v100, s[36:39], s61 offen sc1 lds
    buffer_load_dwordx4 v100, s[36:39], s61 offen offset:1024 sc1 lds
    buffer_load_dword v101, s[36:39], s61 offen offset:2048 sc1 lds
    s_add_u32 m0, s63, 0
    s_nop 0
    buffer_load_dwordx4 v100, s[36:39], s60 offen sc1 lds
    buffer_load_dwordx4 v100, s[36:39], s60 offen offset:1024 sc1 lds
    buffer_load_dword v101, s[36:39], s60 offen offset:2048 sc1 lds
    s_waitcnt vmcnt(0)
    ds_read_b32 v104, v102 offset:0
    ds_read_b32 v105, v102 offset:1024
    ds_read_b32 v106, v103 offset:2048
    ds_read_b32 v107, v102 offset:2304
    ds_read_b32 v108, v102 offset:3328
    ds_read_b32 v109, v103 offset:4352
    s_waitcnt lgkmcnt(3)
    v_max3_u32 v110, v104, v105, v106
    s_waitcnt lgkmcnt(2)
    v_max_u32 v110, v110, v107
    s_waitcnt lgkmcnt(1)
    v_max_u32 v110, v110, v108
    s_waitcnt lgkmcnt(0)
    v_max_u32 v110, v110, v109
    v_cmp_eq_u32 vcc, -1, v110
    s_nop 0
    s_cbranch_vccz Le_m_109
    s_sub_u32 s7, s7, 1
    s_cbranch_scc1 Le_m_109
    s_sleep 1
    s_branch Lp_m_108
Le_m_109:
    s_max_i32 s7, s7, 0
    s_barrier
L_end:
L_exit:
    s_endpgm
L_code_end:
.section .rodata,"a"
.p2align 6
.amdhsa_kernel adaLN_cond__spectral_gfnet__mixer_token_mlp__prompt_kernel
  .amdhsa_next_free_vgpr 256
  .amdhsa_next_free_sgpr 70
  .amdhsa_accum_offset 256
  .amdhsa_group_segment_fixed_size 0
  .amdhsa_kernarg_size 104
  .amdhsa_user_sgpr_count 2
  .amdhsa_user_sgpr_kernarg_segment_ptr 1
  .amdhsa_system_sgpr_workgroup_id_x 1
.end_amdhsa_kernel
```

```asm
; @launch grid=(256,1,1) block=(512,1,1) lds=163840
.amdgcn_target "amdgcn-amd-amdhsa--gfx950"
.text
.globl adaLN_cond__spectral_gfnet__mixer_token_mlp__prompt_kernel
.p2align 8
.type adaLN_cond__spectral_gfnet__mixer_token_mlp__prompt_kernel,@function
adaLN_cond__spectral_gfnet__mixer_token_mlp__prompt_kernel:
    s_cmp_ge_u32 s2, 256
    s_cbranch_scc1 L_exit
    s_load_dwordx16 s[8:23], s[0:1], 0
    s_load_dwordx8 s[24:31], s[0:1], 64
    s_load_dwordx2 s[32:33], s[0:1], 96
    v_readfirstlane_b32 s4, v0
    s_lshr_b32 s5, s2, 3
    s_lshr_b32 s4, s4, 6
    s_cmp_lg_u32 s4, s5
    s_cbranch_scc1 L_nopf
    s_getpc_b64 s[52:53]
L_pc:
    s_sub_u32 s52, s52, L_pc-adaLN_cond__spectral_gfnet__mixer_token_mlp__prompt_kernel
    s_subb_u32 s53, s53, 0
    s_mov_b32 s54, L_code_end-adaLN_cond__spectral_gfnet__mixer_token_mlp__prompt_kernel
    s_mov_b32 s55, 0x20000
    v_lshlrev_b32 v1, 7, v0
    buffer_load_dword v255, v1, s[52:55], 0 offen
    v_add_u32 v1, 65536, v1
    buffer_load_dword v255, v1, s[52:55], 0 offen
L_nopf:
    v_lshrrev_b32 v1, 6, v0
    v_and_b32 v0, 63, v0
    v_readfirstlane_b32 s34, v1
    v_and_b32 v1, 15, v0
    v_lshrrev_b32 v2, 4, v0
    s_and_b32 s4, s2, 7
    s_lshr_b32 s5, s2, 3
    s_lshl_b32 s6, s4, 5
    s_add_u32 s6, s6, s5
    s_mov_b32 s7, 100000
    s_and_b32 s3, s34, 3
    s_cmp_ge_u32 s34, 4
    s_cbranch_scc0 L_C
L_H:
    v_lshlrev_b32 v16, 4, v0
    v_mov_b32 v30, 2146435072
    v_mov_b32 v12, 2146435072
    v_mov_b32 v18, 2146435072
    s_sub_u32 s63, 255, s2
    s_mul_i32 s62, s63, 171
    s_lshr_b32 s62, s62, 9
    s_mul_i32 s48, s62, 3
    s_sub_u32 s61, s63, s48
    s_cmp_ge_u32 s63, 54
    s_cbranch_scc1 L_m_30
    v_lshrrev_b32 v4, 3, v0
    v_and_b32 v5, 7, v0
    v_and_b32 v6, 6, v4
    v_xor_b32 v5, v5, v6
    v_mul_u32_u24 v4, 6912, v4
    v_lshl_add_u32 v12, v5, 4, v4
    s_lshl_b32 s48, s61, 2
    s_add_u32 s48, s48, s3
    s_mul_i32 s48, s48, 331776
    s_lshl_b32 s49, s62, 7
    s_add_u32 s47, s48, s49
    s_lshl_b32 s50, s3, 8
    v_lshl_add_u32 v27, v0, 2, s50
    s_mul_i32 s49, s61, 384
    v_add_u32 v9, s49, v27
    v_add_u32 v12, s47, v12
    s_waitcnt lgkmcnt(0)
    s_mov_b32 s40, s26
    s_mov_b32 s41, s27
    s_mov_b32 s42, 3981312
    s_mov_b32 s43, 0x20000
    s_mul_i32 m0, s3, 6144
    s_mov_b32 s59, 0
    buffer_load_dwordx4 v12, s[40:43], s59 offen lds
    s_add_u32 m0, m0, 1024
    s_add_u32 s59, s59, 55296
    buffer_load_dwordx4 v12, s[40:43], s59 offen lds
    s_add_u32 m0, m0, 1024
    s_add_u32 s59, s59, 55296
    buffer_load_dwordx4 v12, s[40:43], s59 offen lds
    s_add_u32 m0, m0, 1024
    s_add_u32 s59, s59, 55296
    buffer_load_dwordx4 v12, s[40:43], s59 offen lds
    s_add_u32 m0, m0, 1024
    s_add_u32 s59, s59, 55296
    buffer_load_dwordx4 v12, s[40:43], s59 offen lds
    s_add_u32 m0, m0, 1024
    s_add_u32 s59, s59, 55296
    buffer_load_dwordx4 v12, s[40:43], s59 offen lds
    s_mov_b32 s44, s24
    s_mov_b32 s45, s25
    s_mov_b32 s46, 1152
    s_mov_b32 s47, 0x20000
    buffer_load_dword v26, v9, s[44:47], 0 offen
    s_mov_b32 s36, s32
    s_mov_b32 s37, s33
    s_mov_b32 s38, 50331648
    s_mov_b32 s39, 0x20000
    v_mov_b32 v7, 32768
    buffer_load_dword v3, v7, s[36:39], 0 offen sc1
    v_lshrrev_b32 v4, 2, v0
    v_bfe_u32 v5, v4, 1, 2
    v_xor_b32 v5, s3, v5
    v_lshlrev_b32 v5, 5, v5
    v_lshlrev_b32 v4, 7, v4
    v_and_b32 v6, 3, v0
    v_lshlrev_b32 v6, 3, v6
    v_add3_u32 v28, v4, v5, v6
    v_lshlrev_b32 v29, 3, v2
    v_add_u32 v29, 90112, v29
    s_mul_i32 s48, s3, 3456
    s_mul_i32 s49, s61, 1152
    s_add_u32 s48, s48, s49
    s_lshl_b32 s49, s62, 6
    s_add_u32 s48, s48, s49
    s_add_u32 s48, s48, 15204352
    v_mul_u32_u24 v4, 13824, v2
    v_lshl_add_u32 v4, v1, 2, v4
    v_add_u32 v30, s48, v4
    v_add_u32 v31, 55296, v30
    v_mov_b32 v5, 0
    s_mov_b32 s48, 0
    buffer_store_dword v5, v30, s[36:39], s48 offen sc1
    buffer_store_dword v5, v31, s[36:39], s48 offen sc1
    s_lshr_b32 s51, s5, 2
    s_lshl_b32 s51, s51, 3
    s_add_u32 s51, s51, s4
    s_and_b32 s60, s5, 3
    s_lshl_b32 s35, s51, 2
    s_add_u32 s35, s35, s60
    s_lshl_b32 s35, s35, 14
    s_bfe_u32 s48, s6, 0x20002
    s_lshl_b32 s48, s48, 6
    s_lshr_b32 s49, s6, 4
    s_lshl_b32 s49, s49, 2
    s_add_u32 s48, s48, s49
    s_and_b32 s49, s6, 3
    s_add_u32 s48, s48, s49
    s_lshl_b32 s48, s48, 4
    s_lshl_b32 s49, s3, 16
    s_add_u32 s48, s48, s49
    s_add_u32 s48, s48, 15728640
    v_mov_b32 v17, 2146435072
    v_writelane_b32 v17, s48, 0
    s_add_u32 s48, s48, 16384
    s_add_u32 s48, s2, 160
    s_lshl_b32 s48, s48, 7
    s_add_u32 s48, s48, 557056
    s_lshl_b32 s49, s3, 8
    s_add_u32 s49, s49, s5
    s_cmp_lt_u32 s49, 12
    s_cselect_b32 s48, s48, 2146435072
    v_mov_b32 v19, 2146435072
    v_writelane_b32 v19, s48, 0
    s_or_b32 s48, s2, s3
    s_cmp_eq_u32 s48, 0
    s_cselect_b32 s48, 0, 2146435072
    s_add_u32 s48, s48, 32768
    v_writelane_b32 v19, s48, 1
    buffer_load_dword v220, v17, s[36:39], 0 offen
    s_waitcnt vmcnt(3)
    s_setprio 2
    v_lshlrev_b32 v4, 16, v26
    v_and_b32 v5, 0xffff0000, v26
    v_mul_f32 v6, 0xbfb8aa3b, v4
    v_mul_f32 v7, 0xbfb8aa3b, v5
    v_exp_f32 v6, v6
    v_exp_f32 v7, v7
    v_add_f32 v6, 1.0, v6
    v_add_f32 v7, 1.0, v7
    v_rcp_f32 v6, v6
    v_rcp_f32 v7, v7
    v_mul_f32 v4, v4, v6
    v_mul_f32 v5, v5, v7
    v_cvt_pk_bf16_f32 v26, v4, v5
    v_add_u32 v27, 90112, v27
    ds_write_b32 v27, v26
    s_mov_b32 s48, 0x9e3779b1
    v_mul_lo_u32 v3, v3, s48
    v_add_u32 v3, 0x7f4a7c15, v3
    v_or_b32 v3, 0x01010101, v3
    s_waitcnt lgkmcnt(0)
    s_barrier
    ds_read_b64_tr_b16 v[132:133], v28 offset:0
    ds_read_b64_tr_b16 v[134:135], v28 offset:2048
    ds_read2_b64 v[136:139], v29 offset0:0 offset1:4
    ds_read_b64_tr_b16 v[140:141], v28 offset:4096
    ds_read_b64_tr_b16 v[142:143], v28 offset:6144
    ds_read2_b64 v[144:147], v29 offset0:8 offset1:12
    ds_read_b64_tr_b16 v[148:149], v28 offset:8192
    ds_read_b64_tr_b16 v[150:151], v28 offset:10240
    ds_read2_b64 v[152:155], v29 offset0:16 offset1:20
    ds_read_b64_tr_b16 v[156:157], v28 offset:12288
    ds_read_b64_tr_b16 v[158:159], v28 offset:14336
    ds_read2_b64 v[160:163], v29 offset0:24 offset1:28
    ds_read_b64_tr_b16 v[164:165], v28 offset:16384
    ds_read_b64_tr_b16 v[166:167], v28 offset:18432
    ds_read2_b64 v[168:171], v29 offset0:32 offset1:36
    ds_read_b64_tr_b16 v[172:173], v28 offset:20480
    ds_read_b64_tr_b16 v[174:175], v28 offset:22528
    ds_read2_b64 v[176:179], v29 offset0:40 offset1:44
    v_and_b32 v4, 3, v1
    v_or_b32 v4, 0x07060500, v4
    s_waitcnt lgkmcnt(14)
    v_mfma_f32_16x16x32_bf16 v[36:39], v[136:139], v[132:135], 0
    s_waitcnt lgkmcnt(12)
    v_mfma_f32_16x16x32_bf16 v[36:39], v[144:147], v[140:143], v[36:39]
    s_waitcnt lgkmcnt(9)
    v_mfma_f32_16x16x32_bf16 v[36:39], v[152:155], v[148:151], v[36:39]
    s_waitcnt lgkmcnt(6)
    v_mfma_f32_16x16x32_bf16 v[36:39], v[160:163], v[156:159], v[36:39]
    s_waitcnt lgkmcnt(3)
    v_mfma_f32_16x16x32_bf16 v[36:39], v[168:171], v[164:167], v[36:39]
    s_waitcnt lgkmcnt(0)
    v_mfma_f32_16x16x32_bf16 v[36:39], v[176:179], v[172:175], v[36:39]
    s_nop 7
    v_add_u32 v40, 0x80, v36
    v_perm_b32 v40, v40, v3, v4
    s_waitcnt vmcnt(1)
    s_mov_b32 s48, 0
    buffer_store_dword v40, v30, s[36:39], s48 offen sc1
    buffer_store_dword v40, v31, s[36:39], s48 offen sc1
    s_setprio 0
    s_mov_b32 s63, 999
    s_branch L_m_34
L_C:
    v_lshrrev_b32 v18, 5, v0
    v_and_b32 v19, 31, v0
    v_mul_u32_u24 v20, 294912, v18
    v_lshl_add_u32 v20, v19, 2, v20
    s_mul_i32 s62, s3, 589824
    s_mul_i32 s48, s6, 1152
    s_add_u32 s62, s62, s48
    s_waitcnt lgkmcnt(0)
    s_mov_b32 s40, s8
    s_mov_b32 s41, s9
    s_mov_b32 s42, 2359296
    s_mov_b32 s43, 0x20000
    buffer_load_dword v9, v20, s[40:43], s62 offen offset:0
    buffer_load_dword v10, v20, s[40:43], s62 offen offset:128
    buffer_load_dword v11, v20, s[40:43], s62 offen offset:256
    buffer_load_dword v12, v20, s[40:43], s62 offen offset:384
    buffer_load_dword v13, v20, s[40:43], s62 offen offset:512
    buffer_load_dword v14, v20, s[40:43], s62 offen offset:640
    buffer_load_dword v15, v20, s[40:43], s62 offen offset:768
    buffer_load_dword v16, v20, s[40:43], s62 offen offset:896
    buffer_load_dword v17, v20, s[40:43], s62 offen offset:1024
    s_mov_b32 s36, s32
    s_mov_b32 s37, s33
    s_mov_b32 s38, 50331648
    s_mov_b32 s39, 0x20000
    v_mov_b32 v21, 32768
    buffer_load_dword v3, v21, s[36:39], 0 offen sc1
    s_mul_i32 s52, s4, 27
    s_add_u32 s52, s52, s5
    s_mul_i32 s51, s52, 171
    s_lshr_b32 s51, s51, 10
    s_mul_i32 s48, s51, 6
    s_sub_u32 s52, s52, s48
    s_lshr_b32 s53, s4, 1
    s_and_b32 s54, s4, 1
    s_lshl_b32 s54, s54, 3
    s_lshr_b32 s48, s5, 2
    s_add_u32 s54, s54, s48
    s_and_b32 s55, s5, 3
    s_mov_b32 s44, s18
    s_mov_b32 s45, s19
    s_mov_b32 s46, 9216
    s_mov_b32 s47, 0x20000
    s_mov_b32 s64, s22
    s_mov_b32 s65, s23
    s_mov_b32 s66, 4096
    s_mov_b32 s67, 0x20000
    s_lshl_b32 s48, s51, 8
    s_lshl_b32 s49, s3, 6
    s_add_u32 s48, s48, s49
    v_lshl_add_u32 v22, v2, 3, s48
    buffer_load_dwordx2 v[4:5], v22, s[44:47], 0 offen
    buffer_load_dwordx2 v[6:7], v22, s[44:47], 0 offen offset:32
    s_lshl_b32 s48, s54, 8
    s_add_u32 s48, s48, s49
    s_lshr_b32 s49, s53, 1
    s_lshl_b32 s49, s49, 5
    s_add_u32 s48, s48, s49
    v_lshl_add_u32 v23, v1, 1, s48
    buffer_load_ushort v8, v23, s[64:67], 0 offen
    s_bfe_u32 s56, s6, 0x10002
    s_lshl_b32 s56, s56, 7
    s_lshr_b32 s57, s6, 3
    s_lshl_b32 s57, s57, 2
    s_add_u32 s56, s56, s57
    s_and_b32 s57, s6, 3
    s_add_u32 s56, s56, s57
    s_lshl_b32 s48, s56, 4
    s_lshl_b32 s49, s3, 16
    s_add_u32 s48, s48, s49
    s_add_u32 s48, s48, 16252928
    v_mov_b32 v24, 2146435072
    v_writelane_b32 v24, s48, 0
    s_add_u32 s48, s48, 16384
    s_lshl_b32 s56, s52, 6
    s_add_u32 s56, s56, s51
    s_lshl_b32 s48, s56, 4
    s_lshl_b32 s49, s3, 16
    s_add_u32 s48, s48, s49
    s_add_u32 s48, s48, 16515072
    v_mov_b32 v25, 2146435072
    v_writelane_b32 v25, s48, 0
    s_add_u32 s48, s48, 16384
    s_add_u32 s48, s2, 216
    s_lshl_b32 s48, s48, 7
    s_add_u32 s48, s48, 622592
    s_lshl_b32 s49, s3, 8
    s_add_u32 s49, s49, s5
    s_cmp_lt_u32 s49, 5
    s_cselect_b32 s48, s48, 2146435072
    v_writelane_b32 v25, s48, 8
    buffer_load_dword v90, v24, s[36:39], 0 offen
    buffer_load_dword v91, v25, s[36:39], 0 offen
    s_branch L_aligned
.p2align 12
L_aligned:
    v_lshlrev_b32 v36, 4, v0
    v_mul_u32_u24 v148, 1184, v18
    v_lshl_add_u32 v148, v19, 2, v148
    s_mul_i32 s48, s3, 2368
    s_add_u32 s48, s48, 100352
    v_add_u32 v148, s48, v148
    v_lshrrev_b32 v220, 1, v1
    v_and_b32 v221, 1, v1
    v_and_b32 v222, 1, v220
    v_cvt_f32_u32 v220, v220
    v_cvt_f32_u32 v221, v221
    v_mul_f32 v220, 0x3e000000, v220
    v_mul_f32 v221, 0x3e800000, v221
    v_mul_u32_u24 v222, 0x8000, v222
    v_lshl_or_b32 v222, v222, 16, v222
    s_lshl_b32 s48, s3, 10
    s_add_u32 s48, s48, 109952
    v_add_u32 v223, s48, v36
    s_mov_b32 s63, 0x3de38e39
    s_add_u32 s48, s3, 0
    s_mul_i32 s49, s48, 43
    s_lshr_b32 s49, s49, 7
    s_mul_i32 s50, s49, 3
    s_sub_u32 s50, s48, s50
    s_lshl_b32 s50, s50, 2
    v_add_u32 v224, s50, v2
    v_cmp_gt_u32 vcc, 9, v224
    v_mul_u32_u24 v224, s49, v224
    v_cvt_f32_u32 v224, v224
    v_fma_f32 v224, v224, s63, v221
    v_add_f32 v225, v224, v220
    v_fma_f32 v226, v220, 2.0, v224
    v_add_f32 v227, v226, v220
    v_cos_f32 v224, v224
    v_cos_f32 v225, v225
    v_cos_f32 v226, v226
    v_cos_f32 v227, v227
    v_cvt_pk_bf16_f32 v232, v224, v225
    v_cvt_pk_bf16_f32 v233, v226, v227
    v_cndmask_b32 v232, 0, v232, vcc
    v_cndmask_b32 v233, 0, v233, vcc
    v_xor_b32 v234, v222, v232
    v_xor_b32 v235, v222, v233
    ds_write_b128 v223, v[232:235] offset:0
    s_add_u32 s48, s3, 4
    s_mul_i32 s49, s48, 43
    s_lshr_b32 s49, s49, 7
    s_mul_i32 s50, s49, 3
    s_sub_u32 s50, s48, s50
    s_lshl_b32 s50, s50, 2
    v_add_u32 v224, s50, v2
    v_cmp_gt_u32 vcc, 9, v224
    v_mul_u32_u24 v224, s49, v224
    v_cvt_f32_u32 v224, v224
    v_fma_f32 v224, v224, s63, v221
    v_add_f32 v225, v224, v220
    v_fma_f32 v226, v220, 2.0, v224
    v_add_f32 v227, v226, v220
    v_cos_f32 v224, v224
    v_cos_f32 v225, v225
    v_cos_f32 v226, v226
    v_cos_f32 v227, v227
    v_cvt_pk_bf16_f32 v236, v224, v225
    v_cvt_pk_bf16_f32 v237, v226, v227
    v_cndmask_b32 v236, 0, v236, vcc
    v_cndmask_b32 v237, 0, v237, vcc
    v_xor_b32 v238, v222, v236
    v_xor_b32 v239, v222, v237
    ds_write_b128 v223, v[236:239] offset:4096
    s_add_u32 s48, s3, 8
    s_mul_i32 s49, s48, 43
    s_lshr_b32 s49, s49, 7
    s_mul_i32 s50, s49, 3
    s_sub_u32 s50, s48, s50
    s_lshl_b32 s50, s50, 2
    v_add_u32 v224, s50, v2
    v_cmp_gt_u32 vcc, 9, v224
    v_mul_u32_u24 v224, s49, v224
    v_cvt_f32_u32 v224, v224
    v_fma_f32 v224, v224, s63, v221
    v_add_f32 v225, v224, v220
    v_fma_f32 v226, v220, 2.0, v224
    v_add_f32 v227, v226, v220
    v_cos_f32 v224, v224
    v_cos_f32 v225, v225
    v_cos_f32 v226, v226
    v_cos_f32 v227, v227
    v_cvt_pk_bf16_f32 v232, v224, v225
    v_cvt_pk_bf16_f32 v233, v226, v227
    v_cndmask_b32 v232, 0, v232, vcc
    v_cndmask_b32 v233, 0, v233, vcc
    v_xor_b32 v234, v222, v232
    v_xor_b32 v235, v222, v233
    ds_write_b128 v223, v[232:235] offset:8192
    s_add_u32 s48, s3, 12
    s_mul_i32 s49, s48, 43
    s_lshr_b32 s49, s49, 7
    s_mul_i32 s50, s49, 3
    s_sub_u32 s50, s48, s50
    s_lshl_b32 s50, s50, 2
    v_add_u32 v224, s50, v2
    v_cmp_gt_u32 vcc, 9, v224
    v_mul_u32_u24 v224, s49, v224
    v_cvt_f32_u32 v224, v224
    v_fma_f32 v224, v224, s63, v221
    v_add_f32 v225, v224, v220
    v_fma_f32 v226, v220, 2.0, v224
    v_add_f32 v227, v226, v220
    v_cos_f32 v224, v224
    v_cos_f32 v225, v225
    v_cos_f32 v226, v226
    v_cos_f32 v227, v227
    v_cvt_pk_bf16_f32 v236, v224, v225
    v_cvt_pk_bf16_f32 v237, v226, v227
    v_cndmask_b32 v236, 0, v236, vcc
    v_cndmask_b32 v237, 0, v237, vcc
    v_xor_b32 v238, v222, v236
    v_xor_b32 v239, v222, v237
    ds_write_b128 v223, v[236:239] offset:12288
    v_lshrrev_b32 v22, 5, v0
    v_lshlrev_b32 v22, 2, v22
    s_lshl_b32 s48, s3, 3
    s_add_u32 s48, s48, 109824
    v_add_u32 v22, s48, v22
    v_bfe_u32 v18, v0, 2, 2
    v_mul_u32_u24 v18, 1184, v18
    v_and_b32 v19, 3, v0
    v_lshl_add_u32 v18, v19, 3, v18
    s_lshl_b32 s48, s3, 5
    s_add_u32 s48, s48, 100352
    v_add_u32 v19, s48, v18
    v_lshl_add_u32 v18, v2, 7, v19
    v_mov_b32 v20, 109824
    v_add_u32 v21, 109952, v36
    s_waitcnt vmcnt(14)
    ds_write_b32 v148, v9 offset:0
    v_lshlrev_b32 v106, 16, v9
    v_and_b32 v107, 0xffff0000, v9
    s_waitcnt vmcnt(13)
    ds_write_b32 v148, v10 offset:128
    v_lshlrev_b32 v108, 16, v10
    v_and_b32 v109, 0xffff0000, v10
    s_waitcnt vmcnt(12)
    ds_write_b32 v148, v11 offset:256
    v_lshlrev_b32 v110, 16, v11
    v_and_b32 v111, 0xffff0000, v11
    s_waitcnt vmcnt(11)
    ds_write_b32 v148, v12 offset:384
    v_lshlrev_b32 v112, 16, v12
    v_and_b32 v113, 0xffff0000, v12
    s_waitcnt vmcnt(10)
    ds_write_b32 v148, v13 offset:512
    v_lshlrev_b32 v114, 16, v13
    v_and_b32 v115, 0xffff0000, v13
    s_waitcnt vmcnt(9)
    ds_write_b32 v148, v14 offset:640
    v_lshlrev_b32 v116, 16, v14
    v_and_b32 v117, 0xffff0000, v14
    s_waitcnt vmcnt(8)
    ds_write_b32 v148, v15 offset:768
    v_lshlrev_b32 v118, 16, v15
    v_and_b32 v119, 0xffff0000, v15
    s_waitcnt vmcnt(7)
    ds_write_b32 v148, v16 offset:896
    v_lshlrev_b32 v120, 16, v16
    v_and_b32 v121, 0xffff0000, v16
    s_waitcnt vmcnt(6)
    ds_write_b32 v148, v17 offset:1024
    v_lshlrev_b32 v122, 16, v17
    v_and_b32 v123, 0xffff0000, v17
    v_pk_add_f32 v[24:25], v[106:107], v[108:109]
    v_pk_mul_f32 v[26:27], v[106:107], v[106:107]
    v_pk_fma_f32 v[26:27], v[108:109], v[108:109], v[26:27]
    v_pk_add_f32 v[24:25], v[24:25], v[110:111]
    v_pk_fma_f32 v[26:27], v[110:111], v[110:111], v[26:27]
    v_pk_add_f32 v[24:25], v[24:25], v[112:113]
    v_pk_fma_f32 v[26:27], v[112:113], v[112:113], v[26:27]
    v_pk_add_f32 v[24:25], v[24:25], v[114:115]
    v_pk_fma_f32 v[26:27], v[114:115], v[114:115], v[26:27]
    v_pk_add_f32 v[24:25], v[24:25], v[116:117]
    v_pk_fma_f32 v[26:27], v[116:117], v[116:117], v[26:27]
    v_pk_add_f32 v[24:25], v[24:25], v[118:119]
    v_pk_fma_f32 v[26:27], v[118:119], v[118:119], v[26:27]
    v_pk_add_f32 v[24:25], v[24:25], v[120:121]
    v_pk_fma_f32 v[26:27], v[120:121], v[120:121], v[26:27]
    v_pk_add_f32 v[24:25], v[24:25], v[122:123]
    v_pk_fma_f32 v[26:27], v[122:123], v[122:123], v[26:27]
    v_add_f32 v24, v24, v25
    v_add_f32 v25, v26, v27
    s_nop 0
    v_add_f32_dpp v24, v24, v24 quad_perm:[1,0,3,2] row_mask:0xf bank_mask:0xf
    v_add_f32_dpp v25, v25, v25 quad_perm:[1,0,3,2] row_mask:0xf bank_mask:0xf
    s_nop 0
    v_add_f32_dpp v24, v24, v24 quad_perm:[2,3,0,1] row_mask:0xf bank_mask:0xf
    v_add_f32_dpp v25, v25, v25 quad_perm:[2,3,0,1] row_mask:0xf bank_mask:0xf
    s_nop 0
    v_add_f32_dpp v24, v24, v24 row_half_mirror row_mask:0xf bank_mask:0xf
    v_add_f32_dpp v25, v25, v25 row_half_mirror row_mask:0xf bank_mask:0xf
    s_nop 0
    v_add_f32_dpp v24, v24, v24 row_mirror row_mask:0xf bank_mask:0xf
    v_add_f32_dpp v25, v25, v25 row_mirror row_mask:0xf bank_mask:0xf
    v_mov_b32 v26, v24
    v_mov_b32 v27, v25
    s_nop 0
    v_permlane16_swap_b32 v24, v26
    v_permlane16_swap_b32 v25, v27
    v_add_f32 v24, v24, v26
    v_add_f32 v25, v25, v27
    v_mul_f32 v24, 0xbae38e39, v24
    v_mul_f32 v25, 0x3ae38e39, v25
    v_fma_f32 v25, -v24, v24, v25
    v_max_f32 v25, 0, v25
    v_add_f32 v25, 0x3727c5ac, v25
    v_rsq_f32 v26, v25
    s_nop 0
    v_mul_f32 v24, v24, v26
    ds_write_b32 v22, v26
    ds_write_b32 v22, v24 offset:32
    s_waitcnt lgkmcnt(0)
    s_barrier
    ds_read_b128 v[132:135], v20 offset:0
    ds_read_b128 v[136:139], v20 offset:16
    ds_read_b128 v[140:143], v20 offset:32
    ds_read_b128 v[144:147], v20 offset:48
    ds_read_b64_tr_b16 v[148:149], v18 offset:0
    ds_read_b64_tr_b16 v[150:151], v18 offset:4736
    ds_read_b64_tr_b16 v[152:153], v18 offset:512
    ds_read_b64_tr_b16 v[154:155], v18 offset:5248
    ds_read_b64_tr_b16 v[156:157], v19 offset:1024
    ds_read_b64_tr_b16 v[158:159], v19 offset:5760
    ds_read_b128 v[160:163], v21 offset:0
    ds_read_b128 v[164:167], v21 offset:1024
    ds_read_b128 v[168:171], v21 offset:2048
    ds_read_b128 v[172:175], v21 offset:3072
    ds_read_b128 v[176:179], v21 offset:4096
    ds_read_b128 v[180:183], v21 offset:5120
    ds_read_b128 v[184:187], v21 offset:6144
    ds_read_b128 v[188:191], v21 offset:7168
    ds_read_b128 v[192:195], v21 offset:8192
    ds_read_b128 v[196:199], v21 offset:9216
    ds_read_b128 v[200:203], v21 offset:10240
    ds_read_b128 v[204:207], v21 offset:11264
    ds_read_b128 v[208:211], v21 offset:12288
    ds_read_b128 v[212:215], v21 offset:13312
    ds_read_b128 v[216:219], v21 offset:14336
    s_lshl_b32 s48, s3, 4
    v_add_u32 v24, s48, v1
    v_cvt_f32_u32 v24, v24
    v_mul_f32 v24, 0x3c800000, v24
    v_cvt_f32_u32 v26, v2
    v_mul_f32 v26, 4.0, v26
    v_mul_f32 v25, v26, v24
    v_cos_f32 v19, v25
    v_sin_f32 v20, v25
    s_nop 0
    v_cvt_pk_bf16_f32 v40, v19, v20
    v_cvt_pk_bf16_f32 v44, -v20, v19
    v_fma_f32 v21, v24, 1.0, v25
    v_cos_f32 v22, v21
    v_sin_f32 v23, v21
    s_nop 0
    v_cvt_pk_bf16_f32 v41, v22, v23
    v_cvt_pk_bf16_f32 v45, -v23, v22
    v_fma_f32 v18, v24, 2.0, v25
    v_cos_f32 v19, v18
    v_sin_f32 v20, v18
    s_nop 0
    v_cvt_pk_bf16_f32 v42, v19, v20
    v_cvt_pk_bf16_f32 v46, -v20, v19
    v_add_f32 v21, v18, v24
    v_cos_f32 v22, v21
    v_sin_f32 v23, v21
    s_nop 0
    v_cvt_pk_bf16_f32 v43, v22, v23
    v_cvt_pk_bf16_f32 v47, -v23, v22
    v_add_f32 v26, 0x41800000, v26
    v_mul_f32 v25, v26, v24
    v_cos_f32 v19, v25
    v_sin_f32 v20, v25
    s_nop 0
    v_cvt_pk_bf16_f32 v48, v19, v20
    v_cvt_pk_bf16_f32 v52, -v20, v19
    v_fma_f32 v21, v24, 1.0, v25
    v_cos_f32 v22, v21
    v_sin_f32 v23, v21
    s_nop 0
    v_cvt_pk_bf16_f32 v49, v22, v23
    v_cvt_pk_bf16_f32 v53, -v23, v22
    v_fma_f32 v18, v24, 2.0, v25
    v_cos_f32 v19, v18
    v_sin_f32 v20, v18
    s_nop 0
    v_cvt_pk_bf16_f32 v50, v19, v20
    v_cvt_pk_bf16_f32 v54, -v20, v19
    v_add_f32 v21, v18, v24
    v_cos_f32 v22, v21
    v_sin_f32 v23, v21
    s_nop 0
    v_cvt_pk_bf16_f32 v51, v22, v23
    v_cvt_pk_bf16_f32 v55, -v23, v22
    v_add_f32 v26, 0x41800000, v26
    v_mul_f32 v25, v26, v24
    v_cos_f32 v19, v25
    v_sin_f32 v20, v25
    s_nop 0
    v_cvt_pk_bf16_f32 v56, v19, v20
    v_cvt_pk_bf16_f32 v60, -v20, v19
    v_fma_f32 v21, v24, 1.0, v25
    v_cos_f32 v22, v21
    v_sin_f32 v23, v21
    s_nop 0
    v_cvt_pk_bf16_f32 v57, v22, v23
    v_cvt_pk_bf16_f32 v61, -v23, v22
    v_fma_f32 v18, v24, 2.0, v25
    v_cos_f32 v19, v18
    v_sin_f32 v20, v18
    s_nop 0
    v_cvt_pk_bf16_f32 v58, v19, v20
    v_cvt_pk_bf16_f32 v62, -v20, v19
    v_add_f32 v21, v18, v24
    v_cos_f32 v22, v21
    v_sin_f32 v23, v21
    s_nop 0
    v_cvt_pk_bf16_f32 v59, v22, v23
    v_cvt_pk_bf16_f32 v63, -v23, v22
    v_add_f32 v26, 0x41800000, v26
    v_mul_f32 v25, v26, v24
    v_cos_f32 v19, v25
    v_sin_f32 v20, v25
    s_nop 0
    v_cvt_pk_bf16_f32 v64, v19, v20
    v_cvt_pk_bf16_f32 v68, -v20, v19
    v_fma_f32 v21, v24, 1.0, v25
    v_cos_f32 v22, v21
    v_sin_f32 v23, v21
    s_nop 0
    v_cvt_pk_bf16_f32 v65, v22, v23
    v_cvt_pk_bf16_f32 v69, -v23, v22
    v_fma_f32 v18, v24, 2.0, v25
    v_cos_f32 v19, v18
    v_sin_f32 v20, v18
    s_nop 0
    v_cvt_pk_bf16_f32 v66, v19, v20
    v_cvt_pk_bf16_f32 v70, -v20, v19
    v_add_f32 v21, v18, v24
    v_cos_f32 v22, v21
    v_sin_f32 v23, v21
    s_nop 0
    v_cvt_pk_bf16_f32 v67, v22, v23
    v_cvt_pk_bf16_f32 v71, -v23, v22
    v_mul_f32 v37, 0x3de38e39, v24
    v_mul_f32 v22, 0x3f800000, v37
    v_cos_f32 v98, v22
    v_sin_f32 v99, v22
    v_mul_f32 v22, 0x40000000, v37
    v_cos_f32 v100, v22
    v_sin_f32 v101, v22
    v_mul_f32 v22, 0x40400000, v37
    v_cos_f32 v102, v22
    v_sin_f32 v103, v22
    v_mul_f32 v22, 0x40800000, v37
    v_cos_f32 v104, v22
    v_sin_f32 v105, v22
L_m_1:
    s_waitcnt lgkmcnt(14)
    v_lshlrev_b32 v106, 16, v148
    v_and_b32 v107, 0xffff0000, v148
    v_pk_fma_f32 v[106:107], v[106:107], v[132:133], v[140:141]
    v_lshlrev_b32 v108, 16, v149
    v_and_b32 v109, 0xffff0000, v149
    v_pk_fma_f32 v[108:109], v[108:109], v[134:135], v[142:143]
    v_lshlrev_b32 v110, 16, v150
    v_and_b32 v111, 0xffff0000, v150
    v_pk_fma_f32 v[110:111], v[110:111], v[136:137], v[144:145]
    v_lshlrev_b32 v112, 16, v151
    v_and_b32 v113, 0xffff0000, v151
    v_pk_fma_f32 v[112:113], v[112:113], v[138:139], v[146:147]
    v_lshlrev_b32 v114, 16, v152
    v_and_b32 v115, 0xffff0000, v152
    v_pk_fma_f32 v[114:115], v[114:115], v[132:133], v[140:141]
    v_lshlrev_b32 v116, 16, v153
    v_and_b32 v117, 0xffff0000, v153
    v_pk_fma_f32 v[116:117], v[116:117], v[134:135], v[142:143]
    v_lshlrev_b32 v118, 16, v154
    v_and_b32 v119, 0xffff0000, v154
    v_pk_fma_f32 v[118:119], v[118:119], v[136:137], v[144:145]
    v_lshlrev_b32 v120, 16, v155
    v_and_b32 v121, 0xffff0000, v155
    v_pk_fma_f32 v[120:121], v[120:121], v[138:139], v[146:147]
    v_lshlrev_b32 v122, 16, v156
    v_and_b32 v123, 0xffff0000, v156
    v_pk_fma_f32 v[122:123], v[122:123], v[132:133], v[140:141]
    v_lshlrev_b32 v124, 16, v157
    v_and_b32 v125, 0xffff0000, v157
    v_pk_fma_f32 v[124:125], v[124:125], v[134:135], v[142:143]
    v_lshlrev_b32 v126, 16, v158
    v_and_b32 v127, 0xffff0000, v158
    v_pk_fma_f32 v[126:127], v[126:127], v[136:137], v[144:145]
    v_lshlrev_b32 v128, 16, v159
    v_and_b32 v129, 0xffff0000, v159
    v_pk_fma_f32 v[128:129], v[128:129], v[138:139], v[146:147]
    s_waitcnt lgkmcnt(0)
    s_cmp_ge_u32 s2, 202
    s_cbranch_scc1 L_m_2
    v_and_b32 v220, 7, v1
    v_cvt_f32_u32 v220, v220
    v_mul_f32 v220, 0x3e000000, v220
    v_and_b32 v221, 1, v2
    v_cvt_f32_u32 v221, v221
    v_mul_f32 v221, 4.0, v221
    v_mul_f32 v221, v221, v220
    v_lshrrev_b32 v222, 3, v1
    v_lshrrev_b32 v223, 1, v2
    s_lshl_b32 s48, s3, 10
    s_add_u32 s48, s48, 147456
    v_add_u32 v224, s48, v36
    s_add_u32 s48, s3, 0
    s_mul_i32 s49, s48, 43
    s_lshr_b32 s49, s49, 7
    s_mul_i32 s50, s49, 3
    s_sub_u32 s50, s48, s50
    s_lshl_b32 s50, s50, 1
    s_lshl_b32 s49, s49, 1
    v_add_u32 v225, s49, v222
    v_add_u32 v226, s50, v223
    v_cmp_gt_u32 vcc, 9, v225
    v_cmp_gt_u32 s[48:49], 5, v226
    v_mul_u32_u24 v225, v225, v226
    v_cvt_f32_u32 v225, v225
    s_and_b64 vcc, vcc, s[48:49]
    v_fma_f32 v225, v225, s63, v221
    v_cos_f32 v226, v225
    v_sin_f32 v227, v225
    s_nop 0
    v_cvt_pk_bf16_f32 v232, v226, -v227
    v_add_f32 v225, v225, v220
    v_cos_f32 v228, v225
    v_sin_f32 v229, v225
    s_nop 0
    v_cvt_pk_bf16_f32 v233, v228, -v229
    v_add_f32 v225, v225, v220
    v_cos_f32 v226, v225
    v_sin_f32 v227, v225
    s_nop 0
    v_cvt_pk_bf16_f32 v234, v226, -v227
    v_add_f32 v225, v225, v220
    v_cos_f32 v228, v225
    v_sin_f32 v229, v225
    s_nop 0
    v_cvt_pk_bf16_f32 v235, v228, -v229
    v_cndmask_b32 v232, 0, v232, vcc
    v_cndmask_b32 v233, 0, v233, vcc
    v_cndmask_b32 v234, 0, v234, vcc
    v_cndmask_b32 v235, 0, v235, vcc
    ds_write_b128 v224, v[232:235] offset:0
    s_add_u32 s48, s3, 4
    s_mul_i32 s49, s48, 43
    s_lshr_b32 s49, s49, 7
    s_mul_i32 s50, s49, 3
    s_sub_u32 s50, s48, s50
    s_lshl_b32 s50, s50, 1
    s_lshl_b32 s49, s49, 1
    v_add_u32 v225, s49, v222
    v_add_u32 v226, s50, v223
    v_cmp_gt_u32 vcc, 9, v225
    v_cmp_gt_u32 s[48:49], 5, v226
    v_mul_u32_u24 v225, v225, v226
    v_cvt_f32_u32 v225, v225
    s_and_b64 vcc, vcc, s[48:49]
    v_fma_f32 v225, v225, s63, v221
    v_cos_f32 v226, v225
    v_sin_f32 v227, v225
    s_nop 0
    v_cvt_pk_bf16_f32 v236, v226, -v227
    v_add_f32 v225, v225, v220
    v_cos_f32 v228, v225
    v_sin_f32 v229, v225
    s_nop 0
    v_cvt_pk_bf16_f32 v237, v228, -v229
    v_add_f32 v225, v225, v220
    v_cos_f32 v226, v225
    v_sin_f32 v227, v225
    s_nop 0
    v_cvt_pk_bf16_f32 v238, v226, -v227
    v_add_f32 v225, v225, v220
    v_cos_f32 v228, v225
    v_sin_f32 v229, v225
    s_nop 0
    v_cvt_pk_bf16_f32 v239, v228, -v229
    v_cndmask_b32 v236, 0, v236, vcc
    v_cndmask_b32 v237, 0, v237, vcc
    v_cndmask_b32 v238, 0, v238, vcc
    v_cndmask_b32 v239, 0, v239, vcc
    ds_write_b128 v224, v[236:239] offset:4096
    s_add_u32 s48, s3, 8
    s_mul_i32 s49, s48, 43
    s_lshr_b32 s49, s49, 7
    s_mul_i32 s50, s49, 3
    s_sub_u32 s50, s48, s50
    s_lshl_b32 s50, s50, 1
    s_lshl_b32 s49, s49, 1
    v_add_u32 v225, s49, v222
    v_add_u32 v226, s50, v223
    v_cmp_gt_u32 vcc, 9, v225
    v_cmp_gt_u32 s[48:49], 5, v226
    v_mul_u32_u24 v225, v225, v226
    v_cvt_f32_u32 v225, v225
    s_and_b64 vcc, vcc, s[48:49]
    v_fma_f32 v225, v225, s63, v221
    v_cos_f32 v226, v225
    v_sin_f32 v227, v225
    s_nop 0
    v_cvt_pk_bf16_f32 v232, v226, -v227
    v_add_f32 v225, v225, v220
    v_cos_f32 v228, v225
    v_sin_f32 v229, v225
    s_nop 0
    v_cvt_pk_bf16_f32 v233, v228, -v229
    v_add_f32 v225, v225, v220
    v_cos_f32 v226, v225
    v_sin_f32 v227, v225
    s_nop 0
    v_cvt_pk_bf16_f32 v234, v226, -v227
    v_add_f32 v225, v225, v220
    v_cos_f32 v228, v225
    v_sin_f32 v229, v225
    s_nop 0
    v_cvt_pk_bf16_f32 v235, v228, -v229
    v_cndmask_b32 v232, 0, v232, vcc
    v_cndmask_b32 v233, 0, v233, vcc
    v_cndmask_b32 v234, 0, v234, vcc
    v_cndmask_b32 v235, 0, v235, vcc
    ds_write_b128 v224, v[232:235] offset:8192
    s_add_u32 s48, s3, 12
    s_mul_i32 s49, s48, 43
    s_lshr_b32 s49, s49, 7
    s_mul_i32 s50, s49, 3
    s_sub_u32 s50, s48, s50
    s_lshl_b32 s50, s50, 1
    s_lshl_b32 s49, s49, 1
    v_add_u32 v225, s49, v222
    v_add_u32 v226, s50, v223
    v_cmp_gt_u32 vcc, 9, v225
    v_cmp_gt_u32 s[48:49], 5, v226
    v_mul_u32_u24 v225, v225, v226
    v_cvt_f32_u32 v225, v225
    s_and_b64 vcc, vcc, s[48:49]
    v_fma_f32 v225, v225, s63, v221
    v_cos_f32 v226, v225
    v_sin_f32 v227, v225
    s_nop 0
    v_cvt_pk_bf16_f32 v236, v226, -v227
    v_add_f32 v225, v225, v220
    v_cos_f32 v228, v225
    v_sin_f32 v229, v225
    s_nop 0
    v_cvt_pk_bf16_f32 v237, v228, -v229
    v_add_f32 v225, v225, v220
    v_cos_f32 v226, v225
    v_sin_f32 v227, v225
    s_nop 0
    v_cvt_pk_bf16_f32 v238, v226, -v227
    v_add_f32 v225, v225, v220
    v_cos_f32 v228, v225
    v_sin_f32 v229, v225
    s_nop 0
    v_cvt_pk_bf16_f32 v239, v228, -v229
    v_cndmask_b32 v236, 0, v236, vcc
    v_cndmask_b32 v237, 0, v237, vcc
    v_cndmask_b32 v238, 0, v238, vcc
    v_cndmask_b32 v239, 0, v239, vcc
    ds_write_b128 v224, v[236:239] offset:12288
L_m_2:
    v_lshrrev_b32 v22, 1, v2
    v_cvt_f32_u32 v22, v22
    v_add_f32 v23, 1.0, v22
    v_mul_f32 v23, 0x35638e39, v23
    v_mul_f32 v24, v22, v37
    v_cos_f32 v25, v24
    v_sin_f32 v26, v24
    v_mul_f32 v30, v23, v25
    v_mul_f32 v31, v23, v26
    v_add_f32 v22, 2.0, v22
    v_mul_f32 v24, v22, v37
    v_cos_f32 v25, v24
    v_sin_f32 v26, v24
    v_mul_f32 v32, 0x35e38e39, v25
    v_mul_f32 v33, 0x35e38e39, v26
    v_add_f32 v22, 2.0, v22
    v_mul_f32 v24, v22, v37
    v_cos_f32 v25, v24
    v_sin_f32 v26, v24
    v_mul_f32 v34, 0x35e38e39, v25
    v_mul_f32 v35, 0x35e38e39, v26
    s_mov_b32 s48, 0x9e3779b1
    s_waitcnt vmcnt(5)
    v_mul_lo_u32 v3, v3, s48
    v_add_u32 v3, 0x7f4a7c15, v3
    v_or_b32 v3, 0x01010101, v3
    s_lshl_b32 s48, s3, 6
    s_add_u32 s48, s48, 126336
    v_mul_u32_u24 v18, 576, v2
    v_lshl_add_u32 v18, v1, 2, v18
    v_add_u32 v18, s48, v18
    v_mul_u32_u24 v19, 288, v1
    v_lshl_add_u32 v19, v2, 4, v19
    v_add_u32 v19, 126336, v19
    v_bfe_u32 v27, v1, 1, 2
    v_xor_b32 v27, v27, v2
    v_lshl_add_u32 v27, v1, 2, v27
    s_mul_i32 s48, s3, 3072
    s_add_u32 s48, s48, 77824
    v_lshl_add_u32 v27, v27, 4, s48
    v_add_u32 v28, s48, v36
    v_lshrrev_b32 v20, 3, v0
    v_xor_b32 v20, v20, v0
    v_and_b32 v20, 3, v20
    v_lshlrev_b32 v20, 4, v20
    v_lshrrev_b32 v21, 2, v0
    v_lshl_add_u32 v20, v21, 16, v20
    s_lshl_b32 s48, s3, 14
    s_lshl_b32 s49, s6, 6
    s_add_u32 s48, s48, s49
    s_add_u32 s48, s48, 4194304
    v_add_u32 v20, s48, v20
    v_add_u32 v21, 1048576, v20
    v_add_u32 v22, 2097152, v20
    v_cmp_gt_u32 vcc, 32, v0
    v_mov_b32 v23, 2146435072
    s_nop 0
    v_cndmask_b32 v22, v23, v22, vcc
    s_lshl_b32 s58, s3, 12
    s_add_u32 s58, s58, 61440
    v_lshl_add_u32 v93, v1, 2, s58
    s_waitcnt vmcnt(1)
    v_lshl_add_u32 v90, v2, 6, v93
    v_add_u32 v93, 512, v93
    s_waitcnt vmcnt(0)
    v_add_u32 v91, 1152, v90
    v_add_u32 v92, 2304, v90
    v_add_u32 v94, 1152, v93
    v_add_u32 v95, 2304, v93
    v_cmp_gt_u32 vcc, 24, v0
    s_nop 1
    v_cndmask_b32 v96, v23, v36, vcc
    s_mul_i32 s59, s4, 13824
    s_mul_i32 s48, s3, 3456
    s_add_u32 s59, s59, s48
    s_add_u32 s59, s59, 15204352
    v_min_u32 v97, 496, v36
    s_mul_i32 s48, s3, 2560
    s_mul_i32 s60, s6, 10240
    s_add_u32 s60, s60, s48
    s_add_u32 s60, s60, 8388608
    v_mov_b64 v[144:145], -1
    v_mov_b64 v[146:147], -1
    v_and_b32 v24, 3, v1
    v_lshlrev_b32 v24, 3, v24
    v_bfe_u32 v24, v3, v24, 8
    s_mov_b32 m0, s58
    s_branch L_stub_1
L_back_c1:
    s_waitcnt vmcnt(0) lgkmcnt(0)
Lp_m_3:
    buffer_load_dwordx4 v36, s[36:39], s59 offen offset:0 sc1 lds
    buffer_load_dwordx4 v36, s[36:39], s59 offen offset:1024 sc1 lds
    buffer_load_dwordx4 v36, s[36:39], s59 offen offset:2048 sc1 lds
    buffer_load_dwordx4 v96, s[36:39], s59 offen offset:3072 sc1 lds
    s_waitcnt vmcnt(0)
    ds_read2_b32 v[72:73], v90 offset0:0 offset1:144
    ds_read2_b32 v[74:75], v90 offset0:64 offset1:208
    ds_read2_b32 v[76:77], v93 offset0:0 offset1:144
    ds_read2_b32 v[78:79], v91 offset0:0 offset1:144
    ds_read2_b32 v[80:81], v91 offset0:64 offset1:208
    ds_read2_b32 v[82:83], v94 offset0:0 offset1:144
    ds_read2_b32 v[84:85], v92 offset0:0 offset1:144
    ds_read2_b32 v[86:87], v92 offset0:64 offset1:208
    ds_read2_b32 v[88:89], v95 offset0:0 offset1:144
    s_waitcnt lgkmcnt(8)
    v_xor_b32 v72, v72, v24
    v_xor_b32 v73, v73, v24
    v_or_b32 v26, v72, v73
    s_waitcnt lgkmcnt(7)
    v_xor_b32 v74, v74, v24
    v_xor_b32 v75, v75, v24
    v_or3_b32 v26, v74, v75, v26
    s_waitcnt lgkmcnt(6)
    v_xor_b32 v76, v76, v24
    v_xor_b32 v77, v77, v24
    v_or3_b32 v26, v76, v77, v26
    s_waitcnt lgkmcnt(5)
    v_xor_b32 v78, v78, v24
    v_xor_b32 v79, v79, v24
    v_or3_b32 v26, v78, v79, v26
    s_waitcnt lgkmcnt(4)
    v_xor_b32 v80, v80, v24
    v_xor_b32 v81, v81, v24
    v_or3_b32 v26, v80, v81, v26
    s_waitcnt lgkmcnt(3)
    v_xor_b32 v82, v82, v24
    v_xor_b32 v83, v83, v24
    v_or3_b32 v26, v82, v83, v26
    s_waitcnt lgkmcnt(2)
    v_xor_b32 v84, v84, v24
    v_xor_b32 v85, v85, v24
    v_or3_b32 v26, v84, v85, v26
    s_waitcnt lgkmcnt(1)
    v_xor_b32 v86, v86, v24
    v_xor_b32 v87, v87, v24
    v_or3_b32 v26, v86, v87, v26
    s_waitcnt lgkmcnt(0)
    v_xor_b32 v88, v88, v24
    v_xor_b32 v89, v89, v24
    v_or3_b32 v26, v88, v89, v26
    v_and_b32 v26, 0xff, v26
    v_cmp_ne_u32 vcc, 0, v26
    s_nop 0
    s_cbranch_vccz Le_m_4
    s_sub_u32 s7, s7, 1
    s_cbranch_scc1 Le_m_4
    s_sleep 1
    s_branch Lp_m_3
Le_m_4:
    s_max_i32 s7, s7, 0
    buffer_store_dwordx4 v[144:147], v36, s[36:39], s60 offen offset:0 sc1
    buffer_store_dwordx4 v[144:147], v36, s[36:39], s60 offen offset:1024 sc1
    buffer_store_dwordx4 v[144:147], v97, s[36:39], s60 offen offset:2048 sc1
    v_pk_add_f32 v[72:73], v[72:73], v[78:79]
    v_pk_add_f32 v[74:75], v[74:75], v[80:81]
    v_pk_add_f32 v[76:77], v[76:77], v[82:83]
    v_pk_add_f32 v[72:73], v[72:73], v[84:85]
    v_pk_add_f32 v[74:75], v[74:75], v[86:87]
    v_pk_add_f32 v[76:77], v[76:77], v[88:89]
    v_cvt_pk_bf16_f32 v78, v72, v73
    v_and_b32 v73, 0xffff0000, v78
    v_add_f32 v73, 1.0, v73
    v_lshlrev_b32 v72, 16, v78
    v_cvt_pk_bf16_f32 v73, 0, v73
    v_pk_fma_f32 v[106:107], v[106:107], v[72:73], v[72:73] op_sel:[0,1,0] op_sel_hi:[1,1,0]
    s_branch L_skip_1
L_stub_1:
    s_branch L_stub_2
L_skip_1:
    v_pk_fma_f32 v[108:109], v[108:109], v[72:73], v[72:73] op_sel:[0,1,0] op_sel_hi:[1,1,0]
    v_pk_fma_f32 v[110:111], v[110:111], v[72:73], v[72:73] op_sel:[0,1,0] op_sel_hi:[1,1,0]
    v_pk_fma_f32 v[112:113], v[112:113], v[72:73], v[72:73] op_sel:[0,1,0] op_sel_hi:[1,1,0]
    v_cvt_pk_bf16_f32 v148, v106, v107
    v_cvt_pk_bf16_f32 v149, v108, v109
    v_cvt_pk_bf16_f32 v150, v110, v111
    v_cvt_pk_bf16_f32 v151, v112, v113
    v_cvt_pk_bf16_f32 v80, v74, v75
    v_and_b32 v75, 0xffff0000, v80
    v_add_f32 v75, 1.0, v75
    v_lshlrev_b32 v74, 16, v80
    v_cvt_pk_bf16_f32 v75, 0, v75
    v_pk_fma_f32 v[114:115], v[114:115], v[74:75], v[74:75] op_sel:[0,1,0] op_sel_hi:[1,1,0]
    v_pk_fma_f32 v[116:117], v[116:117], v[74:75], v[74:75] op_sel:[0,1,0] op_sel_hi:[1,1,0]
    v_pk_fma_f32 v[118:119], v[118:119], v[74:75], v[74:75] op_sel:[0,1,0] op_sel_hi:[1,1,0]
    v_pk_fma_f32 v[120:121], v[120:121], v[74:75], v[74:75] op_sel:[0,1,0] op_sel_hi:[1,1,0]
    v_cvt_pk_bf16_f32 v152, v114, v115
    v_cvt_pk_bf16_f32 v153, v116, v117
    v_cvt_pk_bf16_f32 v154, v118, v119
    v_cvt_pk_bf16_f32 v155, v120, v121
    v_cvt_pk_bf16_f32 v82, v76, v77
    v_and_b32 v77, 0xffff0000, v82
    v_add_f32 v77, 1.0, v77
    v_lshlrev_b32 v76, 16, v82
    v_cvt_pk_bf16_f32 v77, 0, v77
    v_pk_fma_f32 v[122:123], v[122:123], v[76:77], v[76:77] op_sel:[0,1,0] op_sel_hi:[1,1,0]
    v_pk_fma_f32 v[124:125], v[124:125], v[76:77], v[76:77] op_sel:[0,1,0] op_sel_hi:[1,1,0]
    v_pk_fma_f32 v[126:127], v[126:127], v[76:77], v[76:77] op_sel:[0,1,0] op_sel_hi:[1,1,0]
    v_pk_fma_f32 v[128:129], v[128:129], v[76:77], v[76:77] op_sel:[0,1,0] op_sel_hi:[1,1,0]
    v_cvt_pk_bf16_f32 v156, v122, v123
    v_cvt_pk_bf16_f32 v157, v124, v125
    v_cvt_pk_bf16_f32 v158, v126, v127
    v_cvt_pk_bf16_f32 v159, v128, v129
    v_mfma_f32_16x16x32_bf16 v[224:227], v[172:175], v[148:151], 0
    v_mfma_f32_16x16x32_bf16 v[224:227], v[176:179], v[152:155], v[224:227]
    v_mfma_f32_16x16x32_bf16 v[224:227], v[180:183], v[156:159], v[224:227]
    v_mfma_f32_16x16x32_bf16 v[228:231], v[184:187], v[148:151], 0
    v_mfma_f32_16x16x32_bf16 v[228:231], v[188:191], v[152:155], v[228:231]
    v_mfma_f32_16x16x32_bf16 v[228:231], v[192:195], v[156:159], v[228:231]
    v_mfma_f32_16x16x32_bf16 v[232:235], v[196:199], v[148:151], 0
    s_nop 3
    v_mul_f32 v114, v224, v98
    v_mul_f32 v115, v225, v98
    v_mfma_f32_16x16x32_bf16 v[232:235], v[200:203], v[152:155], v[232:235]
    v_fmac_f32 v114, v225, v99
    v_fma_f32 v115, -v224, v99, v115
    v_mfma_f32_16x16x32_bf16 v[232:235], v[204:207], v[156:159], v[232:235]
    v_cvt_pk_bf16_f32 v116, v114, v115
    ds_write_b32 v18, v116 offset:2304
    v_mfma_f32_16x16x32_bf16 v[236:239], v[208:211], v[148:151], 0
    v_mul_f32 v118, v226, v98
    v_mul_f32 v119, v227, v98
    v_mfma_f32_16x16x32_bf16 v[236:239], v[212:215], v[152:155], v[236:239]
    v_fmac_f32 v118, v227, v99
    v_fma_f32 v119, -v226, v99, v119
    v_mfma_f32_16x16x32_bf16 v[236:239], v[216:219], v[156:159], v[236:239]
    v_cvt_pk_bf16_f32 v120, v118, v119
    ds_write_b32 v18, v120 offset:2592
    v_mfma_f32_16x16x32_bf16 v[220:223], v[160:163], v[148:151], 0
    v_mul_f32 v106, v228, v100
    v_mul_f32 v107, v229, v100
    v_mfma_f32_16x16x32_bf16 v[220:223], v[164:167], v[152:155], v[220:223]
    v_fmac_f32 v106, v229, v101
    v_fma_f32 v107, -v228, v101, v107
    v_mfma_f32_16x16x32_bf16 v[220:223], v[168:171], v[156:159], v[220:223]
    v_cvt_pk_bf16_f32 v108, v106, v107
    ds_write_b32 v18, v108 offset:4608
    v_mul_f32 v110, v230, v100
    v_mul_f32 v111, v231, v100
    v_fmac_f32 v110, v231, v101
    v_fma_f32 v111, -v230, v101, v111
    v_cvt_pk_bf16_f32 v112, v110, v111
    ds_write_b32 v18, v112 offset:4896
    v_mul_f32 v114, v232, v102
    v_mul_f32 v115, v233, v102
    v_fmac_f32 v114, v233, v103
    v_fma_f32 v115, -v232, v103, v115
    v_cvt_pk_bf16_f32 v116, v114, v115
    ds_write_b32 v18, v116 offset:6912
    v_mul_f32 v118, v234, v102
    v_mul_f32 v119, v235, v102
    v_fmac_f32 v118, v235, v103
    v_fma_f32 v119, -v234, v103, v119
    v_cvt_pk_bf16_f32 v120, v118, v119
    ds_write_b32 v18, v120 offset:7200
    v_mul_f32 v106, v236, v104
    v_mul_f32 v107, v237, v104
    v_fmac_f32 v106, v237, v105
    v_fma_f32 v107, -v236, v105, v107
    v_cvt_pk_bf16_f32 v108, v106, v107
    ds_write_b32 v18, v108 offset:9216
    v_mul_f32 v110, v238, v104
    v_mul_f32 v111, v239, v104
    v_fmac_f32 v110, v239, v105
    v_fma_f32 v111, -v238, v105, v111
    v_cvt_pk_bf16_f32 v112, v110, v111
    ds_write_b32 v18, v112 offset:9504
    v_cvt_pk_bf16_f32 v108, v220, v221
    ds_write_b32 v18, v108 offset:0
    v_cvt_pk_bf16_f32 v112, v222, v223
    ds_write_b32 v18, v112 offset:288
    s_waitcnt lgkmcnt(0)
    s_barrier
    ds_read_b128 v[160:163], v19 offset:0
    ds_read_b128 v[164:167], v19 offset:64
    ds_read_b128 v[168:171], v19 offset:128
    ds_read_b128 v[172:175], v19 offset:192
    ds_read_b128 v[176:179], v19 offset:4608
    ds_read_b128 v[180:183], v19 offset:4672
    ds_read_b128 v[184:187], v19 offset:4736
    ds_read_b128 v[188:191], v19 offset:4800
    ds_read_b128 v[192:195], v19 offset:9216
    ds_read_b128 v[196:199], v19 offset:9280
    ds_read_b128 v[200:203], v19 offset:9344
    ds_read_b128 v[204:207], v19 offset:9408
    s_waitcnt lgkmcnt(11)
    v_mfma_f32_16x16x32_bf16 v[220:223], v[40:43], v[160:163], 0
    v_mfma_f32_16x16x32_bf16 v[224:227], v[44:47], v[160:163], 0
    s_waitcnt lgkmcnt(10)
    v_mfma_f32_16x16x32_bf16 v[220:223], v[48:51], v[164:167], v[220:223]
    v_mfma_f32_16x16x32_bf16 v[224:227], v[52:55], v[164:167], v[224:227]
    s_waitcnt lgkmcnt(9)
    v_mfma_f32_16x16x32_bf16 v[220:223], v[56:59], v[168:171], v[220:223]
    v_mfma_f32_16x16x32_bf16 v[224:227], v[60:63], v[168:171], v[224:227]
    s_waitcnt lgkmcnt(8)
    v_mfma_f32_16x16x32_bf16 v[220:223], v[64:67], v[172:175], v[220:223]
    v_mfma_f32_16x16x32_bf16 v[224:227], v[68:71], v[172:175], v[224:227]
    s_waitcnt lgkmcnt(7)
    v_mfma_f32_16x16x32_bf16 v[228:231], v[40:43], v[176:179], 0
    v_mfma_f32_16x16x32_bf16 v[232:235], v[44:47], v[176:179], 0
    s_waitcnt lgkmcnt(6)
    v_mfma_f32_16x16x32_bf16 v[228:231], v[48:51], v[180:183], v[228:231]
    v_mfma_f32_16x16x32_bf16 v[232:235], v[52:55], v[180:183], v[232:235]
    s_waitcnt lgkmcnt(5)
    v_mfma_f32_16x16x32_bf16 v[228:231], v[56:59], v[184:187], v[228:231]
    v_cvt_pk_bf16_f32 v148, v220, v224
    v_mfma_f32_16x16x32_bf16 v[232:235], v[60:63], v[184:187], v[232:235]
    v_cvt_pk_bf16_f32 v149, v221, v225
    s_waitcnt lgkmcnt(4)
    v_mfma_f32_16x16x32_bf16 v[228:231], v[64:67], v[188:191], v[228:231]
    v_cvt_pk_bf16_f32 v150, v222, v226
    v_mfma_f32_16x16x32_bf16 v[232:235], v[68:71], v[188:191], v[232:235]
    v_cvt_pk_bf16_f32 v151, v223, v227
    ds_write_b128 v27, v[148:151] offset:0
    ds_read_b128 v[132:135], v28 offset:0
    s_waitcnt lgkmcnt(5)
    v_mfma_f32_16x16x32_bf16 v[236:239], v[40:43], v[192:195], 0
    v_mfma_f32_16x16x32_bf16 v[240:243], v[44:47], v[192:195], 0
    s_waitcnt lgkmcnt(4)
    v_mfma_f32_16x16x32_bf16 v[236:239], v[48:51], v[196:199], v[236:239]
    v_mfma_f32_16x16x32_bf16 v[240:243], v[52:55], v[196:199], v[240:243]
    s_waitcnt lgkmcnt(3)
    v_mfma_f32_16x16x32_bf16 v[236:239], v[56:59], v[200:203], v[236:239]
    v_cvt_pk_bf16_f32 v152, v228, v232
    v_mfma_f32_16x16x32_bf16 v[240:243], v[60:63], v[200:203], v[240:243]
    v_cvt_pk_bf16_f32 v153, v229, v233
    s_waitcnt lgkmcnt(2)
    v_mfma_f32_16x16x32_bf16 v[236:239], v[64:67], v[204:207], v[236:239]
    v_cvt_pk_bf16_f32 v154, v230, v234
    v_mfma_f32_16x16x32_bf16 v[240:243], v[68:71], v[204:207], v[240:243]
    v_cvt_pk_bf16_f32 v155, v231, v235
    ds_write_b128 v27, v[152:155] offset:1024
    ds_read_b128 v[136:139], v28 offset:1024
    s_waitcnt lgkmcnt(2)
    buffer_store_dwordx4 v[132:135], v20, s[36:39], 0 offen sc1
    s_nop 2
    v_cvt_pk_bf16_f32 v156, v236, v240
    v_cvt_pk_bf16_f32 v157, v237, v241
    v_cvt_pk_bf16_f32 v158, v238, v242
    v_cvt_pk_bf16_f32 v159, v239, v243
    ds_write_b128 v27, v[156:159] offset:2048
    ds_read_b128 v[140:143], v28 offset:2048
    s_waitcnt lgkmcnt(2)
    buffer_store_dwordx4 v[136:139], v21, s[36:39], 0 offen sc1
    s_waitcnt lgkmcnt(0)
    buffer_store_dwordx4 v[140:143], v22, s[36:39], 0 offen sc1
    v_lshrrev_b32 v18, 2, v1
    v_and_b32 v18, 2, v18
    v_xor_b32 v18, v18, v2
    v_lshlrev_b32 v18, 4, v18
    v_lshl_add_u32 v18, v1, 8, v18
    v_add_u32 v18, 98304, v18
    v_and_b32 v19, 7, v1
    v_lshlrev_b32 v19, 8, v19
    v_lshl_add_u32 v19, v2, 4, v19
    v_add_u32 v19, 98304, v19
    v_and_b32 v23, 3, v1
    v_xor_b32 v24, 0, v23
    v_lshl_add_u32 v72, v24, 6, v18
    v_lshl_add_u32 v76, v24, 6, v19
    v_xor_b32 v24, 1, v23
    v_lshl_add_u32 v73, v24, 6, v18
    v_lshl_add_u32 v77, v24, 6, v19
    v_xor_b32 v24, 2, v23
    v_lshl_add_u32 v74, v24, 6, v18
    v_lshl_add_u32 v78, v24, 6, v19
    v_xor_b32 v24, 3, v23
    v_lshl_add_u32 v75, v24, 6, v18
    v_lshl_add_u32 v79, v24, 6, v19
    v_and_b32 v18, 7, v1
    v_mul_u32_u24 v18, 2320, v18
    v_lshl_add_u32 v18, v2, 4, v18
    s_lshl_b32 s48, s3, 6
    s_add_u32 s48, s48, 116736
    v_add_u32 v18, s48, v18
    v_lshrrev_b32 v19, 3, v1
    v_lshl_add_u32 v225, v19, 8, v18
    v_cmp_gt_u32 vcc, 8, v1
    v_mov_b32 v23, 133248
    s_nop 0
    v_cndmask_b32 v224, v23, v18, vcc
    v_lshrrev_b32 v23, 5, v0
    s_lshl_b32 s48, s3, 1
    v_add_u32 v23, s48, v23
    v_and_b32 v24, 31, v0
    v_mul_u32_u24 v18, 2320, v23
    v_lshl_add_u32 v18, v24, 3, v18
    v_add_u32 v226, 116736, v18
    v_mul_u32_u24 v18, 1184, v23
    v_lshl_add_u32 v18, v24, 2, v18
    v_add_u32 v227, 135808, v18
    v_mul_u32_u24 v18, 1152, v23
    v_lshl_add_u32 v18, v24, 2, v18
    v_add_u32 v231, 98304, v18
    v_lshlrev_b32 v18, 3, v24
    v_add_u32 v228, 108544, v18
    v_add_u32 v37, 108800, v18
    v_bfe_u32 v18, v0, 2, 2
    v_mul_u32_u24 v18, 1184, v18
    v_and_b32 v19, 3, v0
    v_lshl_add_u32 v18, v19, 3, v18
    v_lshl_add_u32 v18, v2, 5, v18
    s_lshl_b32 s48, s3, 7
    s_add_u32 s48, s48, 135808
    v_add_u32 v229, s48, v18
    v_add_u32 v230, 147456, v36
    v_min_u32 v232, 496, v36
    s_mul_i32 s48, s3, 2560
    s_mul_i32 s66, s6, 10240
    s_add_u32 s66, s66, s48
    s_add_u32 s66, s66, 8388608
    s_add_u32 s48, s48, 98304
    v_add_u32 v233, s48, v36
    v_add_u32 v234, s48, v232
    s_lshr_b32 s48, s4, 1
    s_lshl_b32 s48, s48, 12
    s_mul_i32 s49, s3, 640
    s_add_u32 s48, s48, s49
    s_add_u32 s48, s48, 294912
    v_min_u32 v235, 624, v36
    v_add_u32 v235, s48, v235
    s_waitcnt vmcnt(0)
    s_waitcnt vmcnt(0)
    s_barrier
    s_cmp_lt_u32 s2, 202
    s_cbranch_scc1 L_m_5
    v_and_b32 v188, 7, v1
    v_cvt_f32_u32 v188, v188
    v_mul_f32 v188, 0x3e000000, v188
    v_and_b32 v189, 1, v2
    v_cvt_f32_u32 v189, v189
    v_mul_f32 v189, 4.0, v189
    v_mul_f32 v189, v189, v188
    v_lshrrev_b32 v190, 3, v1
    v_lshrrev_b32 v191, 1, v2
    s_lshl_b32 s48, s3, 10
    s_add_u32 s48, s48, 147456
    v_add_u32 v192, s48, v36
    s_add_u32 s48, s3, 0
    s_mul_i32 s49, s48, 43
    s_lshr_b32 s49, s49, 7
    s_mul_i32 s50, s49, 3
    s_sub_u32 s50, s48, s50
    s_lshl_b32 s50, s50, 1
    s_lshl_b32 s49, s49, 1
    v_add_u32 v193, s49, v190
    v_add_u32 v194, s50, v191
    v_cmp_gt_u32 vcc, 9, v193
    v_cmp_gt_u32 s[48:49], 5, v194
    v_mul_u32_u24 v193, v193, v194
    v_cvt_f32_u32 v193, v193
    s_and_b64 vcc, vcc, s[48:49]
    v_fma_f32 v193, v193, s63, v189
    v_cos_f32 v194, v193
    v_sin_f32 v195, v193
    s_nop 0
    v_cvt_pk_bf16_f32 v200, v194, -v195
    v_add_f32 v193, v193, v188
    v_cos_f32 v196, v193
    v_sin_f32 v197, v193
    s_nop 0
    v_cvt_pk_bf16_f32 v201, v196, -v197
    v_add_f32 v193, v193, v188
    v_cos_f32 v194, v193
    v_sin_f32 v195, v193
    s_nop 0
    v_cvt_pk_bf16_f32 v202, v194, -v195
    v_add_f32 v193, v193, v188
    v_cos_f32 v196, v193
    v_sin_f32 v197, v193
    s_nop 0
    v_cvt_pk_bf16_f32 v203, v196, -v197
    v_cndmask_b32 v200, 0, v200, vcc
    v_cndmask_b32 v201, 0, v201, vcc
    v_cndmask_b32 v202, 0, v202, vcc
    v_cndmask_b32 v203, 0, v203, vcc
    ds_write_b128 v192, v[200:203] offset:0
    s_add_u32 s48, s3, 4
    s_mul_i32 s49, s48, 43
    s_lshr_b32 s49, s49, 7
    s_mul_i32 s50, s49, 3
    s_sub_u32 s50, s48, s50
    s_lshl_b32 s50, s50, 1
    s_lshl_b32 s49, s49, 1
    v_add_u32 v193, s49, v190
    v_add_u32 v194, s50, v191
    v_cmp_gt_u32 vcc, 9, v193
    v_cmp_gt_u32 s[48:49], 5, v194
    v_mul_u32_u24 v193, v193, v194
    v_cvt_f32_u32 v193, v193
    s_and_b64 vcc, vcc, s[48:49]
    v_fma_f32 v193, v193, s63, v189
    v_cos_f32 v194, v193
    v_sin_f32 v195, v193
    s_nop 0
    v_cvt_pk_bf16_f32 v204, v194, -v195
    v_add_f32 v193, v193, v188
    v_cos_f32 v196, v193
    v_sin_f32 v197, v193
    s_nop 0
    v_cvt_pk_bf16_f32 v205, v196, -v197
    v_add_f32 v193, v193, v188
    v_cos_f32 v194, v193
    v_sin_f32 v195, v193
    s_nop 0
    v_cvt_pk_bf16_f32 v206, v194, -v195
    v_add_f32 v193, v193, v188
    v_cos_f32 v196, v193
    v_sin_f32 v197, v193
    s_nop 0
    v_cvt_pk_bf16_f32 v207, v196, -v197
    v_cndmask_b32 v204, 0, v204, vcc
    v_cndmask_b32 v205, 0, v205, vcc
    v_cndmask_b32 v206, 0, v206, vcc
    v_cndmask_b32 v207, 0, v207, vcc
    ds_write_b128 v192, v[204:207] offset:4096
    s_add_u32 s48, s3, 8
    s_mul_i32 s49, s48, 43
    s_lshr_b32 s49, s49, 7
    s_mul_i32 s50, s49, 3
    s_sub_u32 s50, s48, s50
    s_lshl_b32 s50, s50, 1
    s_lshl_b32 s49, s49, 1
    v_add_u32 v193, s49, v190
    v_add_u32 v194, s50, v191
    v_cmp_gt_u32 vcc, 9, v193
    v_cmp_gt_u32 s[48:49], 5, v194
    v_mul_u32_u24 v193, v193, v194
    v_cvt_f32_u32 v193, v193
    s_and_b64 vcc, vcc, s[48:49]
    v_fma_f32 v193, v193, s63, v189
    v_cos_f32 v194, v193
    v_sin_f32 v195, v193
    s_nop 0
    v_cvt_pk_bf16_f32 v200, v194, -v195
    v_add_f32 v193, v193, v188
    v_cos_f32 v196, v193
    v_sin_f32 v197, v193
    s_nop 0
    v_cvt_pk_bf16_f32 v201, v196, -v197
    v_add_f32 v193, v193, v188
    v_cos_f32 v194, v193
    v_sin_f32 v195, v193
    s_nop 0
    v_cvt_pk_bf16_f32 v202, v194, -v195
    v_add_f32 v193, v193, v188
    v_cos_f32 v196, v193
    v_sin_f32 v197, v193
    s_nop 0
    v_cvt_pk_bf16_f32 v203, v196, -v197
    v_cndmask_b32 v200, 0, v200, vcc
    v_cndmask_b32 v201, 0, v201, vcc
    v_cndmask_b32 v202, 0, v202, vcc
    v_cndmask_b32 v203, 0, v203, vcc
    ds_write_b128 v192, v[200:203] offset:8192
    s_add_u32 s48, s3, 12
    s_mul_i32 s49, s48, 43
    s_lshr_b32 s49, s49, 7
    s_mul_i32 s50, s49, 3
    s_sub_u32 s50, s48, s50
    s_lshl_b32 s50, s50, 1
    s_lshl_b32 s49, s49, 1
    v_add_u32 v193, s49, v190
    v_add_u32 v194, s50, v191
    v_cmp_gt_u32 vcc, 9, v193
    v_cmp_gt_u32 s[48:49], 5, v194
    v_mul_u32_u24 v193, v193, v194
    v_cvt_f32_u32 v193, v193
    s_and_b64 vcc, vcc, s[48:49]
    v_fma_f32 v193, v193, s63, v189
    v_cos_f32 v194, v193
    v_sin_f32 v195, v193
    s_nop 0
    v_cvt_pk_bf16_f32 v204, v194, -v195
    v_add_f32 v193, v193, v188
    v_cos_f32 v196, v193
    v_sin_f32 v197, v193
    s_nop 0
    v_cvt_pk_bf16_f32 v205, v196, -v197
    v_add_f32 v193, v193, v188
    v_cos_f32 v194, v193
    v_sin_f32 v195, v193
    s_nop 0
    v_cvt_pk_bf16_f32 v206, v194, -v195
    v_add_f32 v193, v193, v188
    v_cos_f32 v196, v193
    v_sin_f32 v197, v193
    s_nop 0
    v_cvt_pk_bf16_f32 v207, v196, -v197
    v_cndmask_b32 v204, 0, v204, vcc
    v_cndmask_b32 v205, 0, v205, vcc
    v_cndmask_b32 v206, 0, v206, vcc
    v_cndmask_b32 v207, 0, v207, vcc
    ds_write_b128 v192, v[204:207] offset:12288
L_m_5:
    s_lshl_b32 s58, s3, 10
    v_add_u32 v18, s58, v36
    v_add_u32 v19, 4096, v18
    v_min_u32 v19, 6896, v19
    v_min_u32 v20, 2288, v18
    v_add_u32 v20, 6912, v20
    s_mov_b32 s56, 0x0c0c0400
    s_mov_b32 s57, 0x04000c0c
    s_mov_b32 s58, 196608
    s_mov_b32 s59, 205824
    s_mov_b32 s60, 215040
    s_waitcnt lgkmcnt(0)
    s_cmp_ge_u32 s5, 20
    s_cbranch_scc1 L_m_6
    s_barrier
L_m_6:
    buffer_load_dwordx4 v[80:83], v18, s[36:39], s58 offen sc1
    buffer_load_dwordx4 v[84:87], v18, s[36:39], s59 offen sc1
    buffer_load_dwordx4 v[92:95], v19, s[36:39], s58 offen sc1
    buffer_load_dwordx4 v[96:99], v19, s[36:39], s59 offen sc1
    s_cmp_ge_u32 s5, 20
    s_cbranch_scc1 L_m_7
    s_barrier
L_m_7:
    s_waitcnt vmcnt(0)
    v_perm_b32 v22, v81, v80, s56
    v_perm_b32 v23, v83, v82, s57
    v_or_b32 v22, v22, v23
    v_cmp_ne_u32 vcc, v3, v22
    v_perm_b32 v22, v85, v84, s56
    v_perm_b32 v23, v87, v86, s57
    v_or_b32 v22, v22, v23
    v_cmp_ne_u32 s[48:49], v3, v22
    s_nop 0
    s_or_b64 vcc, vcc, s[48:49]
    v_perm_b32 v22, v93, v92, s56
    v_perm_b32 v23, v95, v94, s57
    v_or_b32 v22, v22, v23
    v_cmp_ne_u32 s[48:49], v3, v22
    s_nop 0
    s_or_b64 vcc, vcc, s[48:49]
    v_perm_b32 v22, v97, v96, s56
    v_perm_b32 v23, v99, v98, s57
    v_or_b32 v22, v22, v23
    v_cmp_ne_u32 s[48:49], v3, v22
    s_nop 0
    s_or_b64 vcc, vcc, s[48:49]
    s_cbranch_vccz L_m_8
Lp_m_9:
    buffer_load_dwordx4 v[80:83], v18, s[36:39], s58 offen sc1
    buffer_load_dwordx4 v[84:87], v18, s[36:39], s59 offen sc1
    buffer_load_dwordx4 v[92:95], v19, s[36:39], s58 offen sc1
    buffer_load_dwordx4 v[96:99], v19, s[36:39], s59 offen sc1
    s_waitcnt vmcnt(0)
    v_perm_b32 v22, v81, v80, s56
    v_perm_b32 v23, v83, v82, s57
    v_or_b32 v22, v22, v23
    v_cmp_ne_u32 vcc, v3, v22
    v_perm_b32 v22, v85, v84, s56
    v_perm_b32 v23, v87, v86, s57
    v_or_b32 v22, v22, v23
    v_cmp_ne_u32 s[48:49], v3, v22
    s_nop 0
    s_or_b64 vcc, vcc, s[48:49]
    v_perm_b32 v22, v93, v92, s56
    v_perm_b32 v23, v95, v94, s57
    v_or_b32 v22, v22, v23
    v_cmp_ne_u32 s[48:49], v3, v22
    s_nop 0
    s_or_b64 vcc, vcc, s[48:49]
    v_perm_b32 v22, v97, v96, s56
    v_perm_b32 v23, v99, v98, s57
    v_or_b32 v22, v22, v23
    v_cmp_ne_u32 s[48:49], v3, v22
    s_nop 0
    s_or_b64 vcc, vcc, s[48:49]
    s_cbranch_vccz Le_m_10
    s_sub_u32 s7, s7, 1
    s_cbranch_scc1 Le_m_10
    s_sleep 1
    s_branch Lp_m_9
Le_m_10:
    s_max_i32 s7, s7, 0
L_m_8:
    v_cmp_le_u32 vcc, 4608, v19
    s_nop 1
    v_cndmask_b32 v22, 0, 1.0, vcc
    v_and_b32 v80, 0xffffff00, v80
    v_and_b32 v81, 0xffffff00, v81
    v_and_b32 v82, 0xffffff00, v82
    v_and_b32 v83, 0xffffff00, v83
    v_and_b32 v84, 0xffffff00, v84
    v_and_b32 v85, 0xffffff00, v85
    v_and_b32 v86, 0xffffff00, v86
    v_and_b32 v87, 0xffffff00, v87
    v_pk_add_f32 v[80:81], v[80:81], v[84:85]
    v_pk_add_f32 v[82:83], v[82:83], v[86:87]
    v_cvt_pk_bf16_f32 v80, 0, v80
    v_cvt_pk_bf16_f32 v81, 0, v81
    v_cvt_pk_bf16_f32 v82, 0, v82
    v_cvt_pk_bf16_f32 v83, 0, v83
    v_and_b32 v92, 0xffffff00, v92
    v_and_b32 v93, 0xffffff00, v93
    v_and_b32 v94, 0xffffff00, v94
    v_and_b32 v95, 0xffffff00, v95
    v_and_b32 v96, 0xffffff00, v96
    v_and_b32 v97, 0xffffff00, v97
    v_and_b32 v98, 0xffffff00, v98
    v_and_b32 v99, 0xffffff00, v99
    v_pk_add_f32 v[92:93], v[92:93], v[96:97]
    v_pk_add_f32 v[94:95], v[94:95], v[98:99]
    v_cvt_pk_bf16_f32 v92, 0, v92
    v_cvt_pk_bf16_f32 v93, 0, v93
    v_cvt_pk_bf16_f32 v94, 0, v94
    v_cvt_pk_bf16_f32 v95, 0, v95
    v_add_f32 v92, v92, v22
    v_add_f32 v93, v93, v22
    v_add_f32 v94, v94, v22
    v_add_f32 v95, v95, v22
    v_cvt_pk_bf16_f32 v92, 0, v92
    v_cvt_pk_bf16_f32 v93, 0, v93
    v_cvt_pk_bf16_f32 v94, 0, v94
    v_cvt_pk_bf16_f32 v95, 0, v95
    v_add_u32 v22, 108544, v18
    v_add_u32 v23, 108544, v19
    ds_write_b128 v22, v[80:83]
    ds_write_b128 v23, v[92:95]
    s_cmp_lg_u32 s2, 255
    s_cbranch_scc1 L_m_11
    s_mov_b32 s50, 4608
    buffer_store_dwordx4 v[80:83], v18, s[36:39], s50 offen sc1
    buffer_store_dwordx4 v[92:95], v19, s[36:39], s50 offen sc1
Lp_m_12:
    buffer_load_dwordx4 v[104:107], v20, s[36:39], s58 offen sc1
    buffer_load_dwordx4 v[108:111], v20, s[36:39], s59 offen sc1
    s_waitcnt vmcnt(0)
    v_perm_b32 v22, v105, v104, s56
    v_perm_b32 v23, v107, v106, s57
    v_or_b32 v22, v22, v23
    v_cmp_ne_u32 vcc, v3, v22
    v_perm_b32 v22, v109, v108, s56
    v_perm_b32 v23, v111, v110, s57
    v_or_b32 v22, v22, v23
    v_cmp_ne_u32 s[48:49], v3, v22
    s_nop 0
    s_or_b64 vcc, vcc, s[48:49]
    s_cbranch_vccz Le_m_13
    s_sub_u32 s7, s7, 1
    s_cbranch_scc1 Le_m_13
    s_sleep 1
    s_branch Lp_m_12
Le_m_13:
    s_max_i32 s7, s7, 0
    v_and_b32 v104, 0xffffff00, v104
    v_and_b32 v105, 0xffffff00, v105
    v_and_b32 v106, 0xffffff00, v106
    v_and_b32 v107, 0xffffff00, v107
    v_and_b32 v108, 0xffffff00, v108
    v_and_b32 v109, 0xffffff00, v109
    v_and_b32 v110, 0xffffff00, v110
    v_and_b32 v111, 0xffffff00, v111
    v_pk_add_f32 v[104:105], v[104:105], v[108:109]
    v_pk_add_f32 v[106:107], v[106:107], v[110:111]
    v_cvt_pk_bf16_f32 v104, 0, v104
    v_cvt_pk_bf16_f32 v105, 0, v105
    v_cvt_pk_bf16_f32 v106, 0, v106
    v_cvt_pk_bf16_f32 v107, 0, v107
    buffer_store_dwordx4 v[104:107], v20, s[36:39], s50 offen sc1
L_m_11:
    v_lshlrev_b32 v236, 16, v9
    v_and_b32 v237, 0xffff0000, v9
    v_lshlrev_b32 v238, 16, v10
    v_and_b32 v239, 0xffff0000, v10
    v_lshlrev_b32 v240, 16, v11
    v_and_b32 v241, 0xffff0000, v11
    v_lshlrev_b32 v242, 16, v12
    v_and_b32 v243, 0xffff0000, v12
    v_lshlrev_b32 v244, 16, v13
    v_and_b32 v245, 0xffff0000, v13
    v_lshlrev_b32 v246, 16, v14
    v_and_b32 v247, 0xffff0000, v14
    v_lshlrev_b32 v248, 16, v15
    v_and_b32 v249, 0xffff0000, v15
    v_lshlrev_b32 v250, 16, v16
    v_and_b32 v251, 0xffff0000, v16
    v_lshlrev_b32 v252, 16, v17
    v_and_b32 v253, 0xffff0000, v17
    s_cmp_ge_u32 s5, 20
    s_cbranch_scc1 L_m_14
    ds_read_b128 v[128:131], v230 offset:0
    ds_read_b128 v[132:135], v230 offset:1024
    ds_read_b128 v[136:139], v230 offset:2048
    ds_read_b128 v[140:143], v230 offset:3072
    ds_read_b128 v[144:147], v230 offset:4096
    ds_read_b128 v[148:151], v230 offset:5120
    ds_read_b128 v[152:155], v230 offset:6144
    ds_read_b128 v[156:159], v230 offset:7168
    ds_read_b128 v[160:163], v230 offset:8192
    ds_read_b128 v[164:167], v230 offset:9216
    ds_read_b128 v[168:171], v230 offset:10240
    ds_read_b128 v[172:175], v230 offset:11264
    ds_read_b128 v[176:179], v230 offset:12288
    ds_read_b128 v[180:183], v230 offset:13312
    ds_read_b128 v[184:187], v230 offset:14336
    s_waitcnt lgkmcnt(0)
    s_barrier
    s_branch L_m_15
L_m_14:
    s_waitcnt lgkmcnt(0)
    s_barrier
    ds_read_b128 v[128:131], v230 offset:0
    ds_read_b128 v[132:135], v230 offset:1024
    ds_read_b128 v[136:139], v230 offset:2048
    ds_read_b128 v[140:143], v230 offset:3072
    ds_read_b128 v[144:147], v230 offset:4096
    ds_read_b128 v[148:151], v230 offset:5120
    ds_read_b128 v[152:155], v230 offset:6144
    ds_read_b128 v[156:159], v230 offset:7168
    ds_read_b128 v[160:163], v230 offset:8192
    ds_read_b128 v[164:167], v230 offset:9216
    ds_read_b128 v[168:171], v230 offset:10240
    ds_read_b128 v[172:175], v230 offset:11264
    ds_read_b128 v[176:179], v230 offset:12288
    ds_read_b128 v[180:183], v230 offset:13312
    ds_read_b128 v[184:187], v230 offset:14336
    s_lshl_b32 s50, s2, 7
    s_add_u32 s50, s50, 557056
    v_mov_b32 v18, 0
Lp_m_16:
    buffer_load_dword v19, v18, s[36:39], s50 offen sc1
    s_waitcnt vmcnt(0)
    v_cmp_ne_u32 vcc, v3, v19
    s_nop 0
    s_cbranch_vccz Le_m_17
    s_sub_u32 s7, s7, 1
    s_cbranch_scc1 Le_m_17
    s_sleep 4
    s_branch Lp_m_16
Le_m_17:
    s_max_i32 s7, s7, 0
    s_waitcnt lgkmcnt(0)
L_m_15:
Lp_m_18:
    buffer_load_dwordx4 v[212:215], v36, s[36:39], s66 offen offset:0 sc1
    buffer_load_dwordx4 v[216:219], v36, s[36:39], s66 offen offset:1024 sc1
    buffer_load_dwordx4 v[220:223], v232, s[36:39], s66 offen offset:2048 sc1
    s_waitcnt vmcnt(0)
    v_max3_u32 v18, v212, v216, v220
    v_cmp_eq_u32 vcc, -1, v18
    s_nop 0
    s_cbranch_vccz Le_m_19
    s_sub_u32 s7, s7, 1
    s_cbranch_scc1 Le_m_19
    s_mov_b64 exec, vcc
    s_sleep 1
    s_branch Lp_m_18
Le_m_19:
    s_mov_b64 exec, -1
    s_max_i32 s7, s7, 0
    ds_write_b128 v233, v[212:215] offset:0
    s_branch L_skip_2
    s_nop 0
L_stub_2:
    s_branch L_back_c1
L_skip_2:
    ds_write_b128 v233, v[216:219] offset:1024
    ds_write_b128 v234, v[220:223] offset:2048
    s_waitcnt lgkmcnt(0)
    s_barrier
    ds_read_b128 v[80:83], v72 offset:0
    ds_read_b128 v[84:87], v73 offset:0
    ds_read_b128 v[88:91], v74 offset:0
    ds_read_b128 v[92:95], v75 offset:0
    ds_read_b128 v[96:99], v72 offset:4096
    ds_read_b128 v[100:103], v73 offset:4096
    ds_read_b128 v[104:107], v74 offset:4096
    ds_read_b128 v[108:111], v75 offset:4096
    ds_read_b128 v[112:115], v76 offset:8192
    ds_read_b128 v[116:119], v77 offset:8192
    ds_read_b128 v[120:123], v78 offset:8192
    ds_read_b128 v[124:127], v79 offset:8192
    s_waitcnt lgkmcnt(11)
    v_mfma_f32_16x16x32_bf16 v[188:191], v[80:83], v[44:47], 0
    v_mfma_f32_16x16x32_bf16 v[192:195], v[80:83], v[40:43], 0
    s_waitcnt lgkmcnt(10)
    v_mfma_f32_16x16x32_bf16 v[188:191], v[84:87], v[52:55], v[188:191]
    v_mfma_f32_16x16x32_bf16 v[192:195], v[84:87], v[48:51], v[192:195]
    s_waitcnt lgkmcnt(9)
    v_mfma_f32_16x16x32_bf16 v[188:191], v[88:91], v[60:63], v[188:191]
    v_mfma_f32_16x16x32_bf16 v[192:195], v[88:91], v[56:59], v[192:195]
    s_waitcnt lgkmcnt(8)
    v_mfma_f32_16x16x32_bf16 v[188:191], v[92:95], v[68:71], v[188:191]
    v_mfma_f32_16x16x32_bf16 v[192:195], v[92:95], v[64:67], v[192:195]
    s_waitcnt lgkmcnt(7)
    v_mfma_f32_16x16x32_bf16 v[196:199], v[96:99], v[44:47], 0
    v_mfma_f32_16x16x32_bf16 v[200:203], v[96:99], v[40:43], 0
    s_waitcnt lgkmcnt(6)
    v_mfma_f32_16x16x32_bf16 v[196:199], v[100:103], v[52:55], v[196:199]
    v_mfma_f32_16x16x32_bf16 v[200:203], v[100:103], v[48:51], v[200:203]
    s_waitcnt lgkmcnt(5)
    v_mfma_f32_16x16x32_bf16 v[196:199], v[104:107], v[60:63], v[196:199]
    v_mul_f32 v18, v188, v30
    v_mul_f32 v19, v192, v30
    v_mfma_f32_16x16x32_bf16 v[200:203], v[104:107], v[56:59], v[200:203]
    v_fma_f32 v18, -v192, v31, v18
    v_fmac_f32 v19, v188, v31
    s_waitcnt lgkmcnt(4)
    v_mfma_f32_16x16x32_bf16 v[196:199], v[108:111], v[68:71], v[196:199]
    v_cvt_pk_bf16_f32 v212, v18, v19
    v_mul_f32 v20, v189, v30
    v_mfma_f32_16x16x32_bf16 v[200:203], v[108:111], v[64:67], v[200:203]
    v_mul_f32 v21, v193, v30
    v_fma_f32 v20, -v193, v31, v20
    s_waitcnt lgkmcnt(3)
    v_mfma_f32_16x16x32_bf16 v[204:207], v[112:115], v[44:47], 0
    v_fmac_f32 v21, v189, v31
    v_cvt_pk_bf16_f32 v213, v20, v21
    v_mfma_f32_16x16x32_bf16 v[208:211], v[112:115], v[40:43], 0
    v_mul_f32 v22, v190, v30
    v_mul_f32 v23, v194, v30
    s_waitcnt lgkmcnt(2)
    v_mfma_f32_16x16x32_bf16 v[204:207], v[116:119], v[52:55], v[204:207]
    v_fma_f32 v22, -v194, v31, v22
    v_fmac_f32 v23, v190, v31
    v_mfma_f32_16x16x32_bf16 v[208:211], v[116:119], v[48:51], v[208:211]
    v_cvt_pk_bf16_f32 v214, v22, v23
    v_mul_f32 v24, v191, v30
    s_waitcnt lgkmcnt(1)
    v_mfma_f32_16x16x32_bf16 v[204:207], v[120:123], v[60:63], v[204:207]
    v_mul_f32 v25, v195, v30
    v_fma_f32 v24, -v195, v31, v24
    v_mfma_f32_16x16x32_bf16 v[208:211], v[120:123], v[56:59], v[208:211]
    v_fmac_f32 v25, v191, v31
    v_cvt_pk_bf16_f32 v215, v24, v25
    s_waitcnt lgkmcnt(0)
    v_mfma_f32_16x16x32_bf16 v[204:207], v[124:127], v[68:71], v[204:207]
    v_mul_f32 v18, v196, v32
    v_mul_f32 v19, v200, v32
    v_mfma_f32_16x16x32_bf16 v[208:211], v[124:127], v[64:67], v[208:211]
    v_fma_f32 v18, -v200, v33, v18
    v_fmac_f32 v19, v196, v33
    v_mfma_f32_16x16x32_bf16 v[80:83], v[212:215], v[128:131], 0
    v_cvt_pk_bf16_f32 v216, v18, v19
    v_mul_f32 v20, v197, v32
    v_mfma_f32_16x16x32_bf16 v[84:87], v[212:215], v[140:143], 0
    v_mul_f32 v21, v201, v32
    v_fma_f32 v20, -v201, v33, v20
    v_mfma_f32_16x16x32_bf16 v[88:91], v[212:215], v[152:155], 0
    v_fmac_f32 v21, v197, v33
    v_cvt_pk_bf16_f32 v217, v20, v21
    v_mfma_f32_16x16x32_bf16 v[92:95], v[212:215], v[164:167], 0
    v_mul_f32 v22, v198, v32
    v_mul_f32 v23, v202, v32
    v_mfma_f32_16x16x32_bf16 v[96:99], v[212:215], v[176:179], 0
    v_fma_f32 v22, -v202, v33, v22
    v_fmac_f32 v23, v198, v33
    v_cvt_pk_bf16_f32 v218, v22, v23
    v_mul_f32 v24, v199, v32
    v_mul_f32 v25, v203, v32
    v_fma_f32 v24, -v203, v33, v24
    v_fmac_f32 v25, v199, v33
    v_cvt_pk_bf16_f32 v219, v24, v25
    s_nop 1
    v_mfma_f32_16x16x32_bf16 v[80:83], v[216:219], v[132:135], v[80:83]
    v_mul_f32 v18, v204, v34
    v_mul_f32 v19, v208, v34
    v_mfma_f32_16x16x32_bf16 v[84:87], v[216:219], v[144:147], v[84:87]
    v_fma_f32 v18, -v208, v35, v18
    v_fmac_f32 v19, v204, v35
    v_mfma_f32_16x16x32_bf16 v[88:91], v[216:219], v[156:159], v[88:91]
    v_cvt_pk_bf16_f32 v220, v18, v19
    v_mul_f32 v20, v205, v34
    v_mfma_f32_16x16x32_bf16 v[92:95], v[216:219], v[168:171], v[92:95]
    v_mul_f32 v21, v209, v34
    v_fma_f32 v20, -v209, v35, v20
    v_mfma_f32_16x16x32_bf16 v[96:99], v[216:219], v[180:183], v[96:99]
    v_fmac_f32 v21, v205, v35
    v_cvt_pk_bf16_f32 v221, v20, v21
    v_mul_f32 v22, v206, v34
    v_mul_f32 v23, v210, v34
    v_fma_f32 v22, -v210, v35, v22
    v_fmac_f32 v23, v206, v35
    v_cvt_pk_bf16_f32 v222, v22, v23
    v_mul_f32 v24, v207, v34
    v_mul_f32 v25, v211, v34
    v_fma_f32 v24, -v211, v35, v24
    v_fmac_f32 v25, v207, v35
    v_cvt_pk_bf16_f32 v223, v24, v25
    s_nop 1
    v_mfma_f32_16x16x32_bf16 v[80:83], v[220:223], v[136:139], v[80:83]
    v_mfma_f32_16x16x32_bf16 v[84:87], v[220:223], v[148:151], v[84:87]
    v_mfma_f32_16x16x32_bf16 v[88:91], v[220:223], v[160:163], v[88:91]
    v_mfma_f32_16x16x32_bf16 v[92:95], v[220:223], v[172:175], v[92:95]
    v_mfma_f32_16x16x32_bf16 v[96:99], v[220:223], v[184:187], v[96:99]
    ds_read2st64_b64 v[40:43], v228 offset0:0 offset1:1
    ds_read2st64_b64 v[44:47], v37 offset0:0 offset1:1
    ds_read2st64_b64 v[48:51], v228 offset0:2 offset1:3
    ds_read2st64_b64 v[52:55], v37 offset0:2 offset1:3
    ds_read_b64 v[56:57], v228 offset:2048
    ds_write_b128 v225, v[80:83] offset:0
    ds_write_b128 v225, v[84:87] offset:512
    ds_write_b128 v225, v[88:91] offset:1024
    ds_write_b128 v225, v[92:95] offset:1536
    ds_write_b128 v224, v[96:99] offset:2048
    ds_read2st64_b64 v[188:191], v228 offset0:9 offset1:10
    ds_read2st64_b64 v[192:195], v37 offset0:9 offset1:10
    ds_read2st64_b64 v[196:199], v228 offset0:11 offset1:12
    ds_read2st64_b64 v[200:203], v37 offset0:11 offset1:12
    ds_read_b64 v[204:205], v228 offset:6656
    ds_read2st64_b64 v[128:131], v37 offset0:4 offset1:5
    ds_read2st64_b64 v[132:135], v228 offset0:5 offset1:6
    ds_read2st64_b64 v[136:139], v37 offset0:6 offset1:7
    ds_read2st64_b64 v[140:143], v228 offset0:7 offset1:8
    ds_read_b64 v[144:145], v228 offset:4352
    s_waitcnt lgkmcnt(10)
    s_barrier
    ds_read_b64 v[100:101], v226 offset:0
    ds_read_b64 v[102:103], v226 offset:256
    ds_read_b64 v[104:105], v226 offset:512
    ds_read_b64 v[106:107], v226 offset:768
    ds_read_b64 v[108:109], v226 offset:1024
    ds_read_b64 v[110:111], v226 offset:1280
    ds_read_b64 v[112:113], v226 offset:1536
    ds_read_b64 v[114:115], v226 offset:1792
    ds_read_b64 v[116:117], v226 offset:2048
    s_mul_i32 s48, s6, 9216
    s_lshl_b32 s49, s3, 10
    s_add_u32 s48, s48, s49
    s_add_u32 s48, s48, 16777216
    s_add_u32 s49, s48, 4096
    s_add_u32 s50, s48, 8192
    s_waitcnt lgkmcnt(8)
    v_pk_fma_f32 v[236:237], v[100:101], v[40:41], v[236:237]
    s_waitcnt lgkmcnt(7)
    v_pk_fma_f32 v[238:239], v[102:103], v[44:45], v[238:239]
    s_waitcnt lgkmcnt(6)
    v_pk_fma_f32 v[240:241], v[104:105], v[42:43], v[240:241]
    s_waitcnt lgkmcnt(5)
    v_pk_fma_f32 v[242:243], v[106:107], v[46:47], v[242:243]
    s_waitcnt lgkmcnt(4)
    v_pk_fma_f32 v[244:245], v[108:109], v[48:49], v[244:245]
    s_waitcnt lgkmcnt(3)
    v_pk_fma_f32 v[246:247], v[110:111], v[52:53], v[246:247]
    s_waitcnt lgkmcnt(2)
    v_pk_fma_f32 v[248:249], v[112:113], v[50:51], v[248:249]
    s_waitcnt lgkmcnt(1)
    v_pk_fma_f32 v[250:251], v[114:115], v[54:55], v[250:251]
    s_waitcnt lgkmcnt(0)
    v_pk_fma_f32 v[252:253], v[116:117], v[56:57], v[252:253]
    v_pk_add_f32 v[24:25], v[236:237], v[238:239]
    v_pk_mul_f32 v[26:27], v[236:237], v[236:237]
    v_pk_fma_f32 v[26:27], v[238:239], v[238:239], v[26:27]
    v_pk_add_f32 v[24:25], v[24:25], v[240:241]
    v_pk_fma_f32 v[26:27], v[240:241], v[240:241], v[26:27]
    v_pk_add_f32 v[24:25], v[24:25], v[242:243]
    v_pk_fma_f32 v[26:27], v[242:243], v[242:243], v[26:27]
    v_pk_add_f32 v[24:25], v[24:25], v[244:245]
    v_pk_fma_f32 v[26:27], v[244:245], v[244:245], v[26:27]
    v_pk_add_f32 v[24:25], v[24:25], v[246:247]
    v_pk_fma_f32 v[26:27], v[246:247], v[246:247], v[26:27]
    v_pk_add_f32 v[24:25], v[24:25], v[248:249]
    v_pk_fma_f32 v[26:27], v[248:249], v[248:249], v[26:27]
    v_pk_add_f32 v[24:25], v[24:25], v[250:251]
    v_pk_fma_f32 v[26:27], v[250:251], v[250:251], v[26:27]
    v_pk_add_f32 v[24:25], v[24:25], v[252:253]
    v_pk_fma_f32 v[26:27], v[252:253], v[252:253], v[26:27]
    v_add_f32 v24, v24, v25
    v_add_f32 v25, v26, v27
    s_nop 0
    v_add_f32_dpp v24, v24, v24 quad_perm:[1,0,3,2] row_mask:0xf bank_mask:0xf
    v_add_f32_dpp v25, v25, v25 quad_perm:[1,0,3,2] row_mask:0xf bank_mask:0xf
    s_nop 0
    v_add_f32_dpp v24, v24, v24 quad_perm:[2,3,0,1] row_mask:0xf bank_mask:0xf
    v_add_f32_dpp v25, v25, v25 quad_perm:[2,3,0,1] row_mask:0xf bank_mask:0xf
    s_nop 0
    v_add_f32_dpp v24, v24, v24 row_half_mirror row_mask:0xf bank_mask:0xf
    v_add_f32_dpp v25, v25, v25 row_half_mirror row_mask:0xf bank_mask:0xf
    s_nop 0
    v_add_f32_dpp v24, v24, v24 row_mirror row_mask:0xf bank_mask:0xf
    v_add_f32_dpp v25, v25, v25 row_mirror row_mask:0xf bank_mask:0xf
    v_mov_b32 v26, v24
    v_mov_b32 v27, v25
    s_nop 0
    v_permlane16_swap_b32 v24, v26
    v_permlane16_swap_b32 v25, v27
    v_add_f32 v24, v24, v26
    v_add_f32 v25, v25, v27
    v_mul_f32 v24, 0xbae38e39, v24
    v_mul_f32 v25, 0x3ae38e39, v25
    v_fma_f32 v25, -v24, v24, v25
    v_max_f32 v25, 0, v25
    v_add_f32 v25, 0x3727c5ac, v25
    v_rsq_f32 v26, v25
    s_nop 0
    v_mul_f32 v24, v24, v26
    v_pk_fma_f32 v[100:101], v[236:237], v[26:27], v[24:25] op_sel_hi:[1,0,0]
    v_pk_fma_f32 v[102:103], v[238:239], v[26:27], v[24:25] op_sel_hi:[1,0,0]
    v_pk_fma_f32 v[104:105], v[240:241], v[26:27], v[24:25] op_sel_hi:[1,0,0]
    v_pk_fma_f32 v[106:107], v[242:243], v[26:27], v[24:25] op_sel_hi:[1,0,0]
    v_pk_fma_f32 v[108:109], v[244:245], v[26:27], v[24:25] op_sel_hi:[1,0,0]
    v_pk_fma_f32 v[110:111], v[246:247], v[26:27], v[24:25] op_sel_hi:[1,0,0]
    v_pk_fma_f32 v[112:113], v[248:249], v[26:27], v[24:25] op_sel_hi:[1,0,0]
    v_pk_fma_f32 v[114:115], v[250:251], v[26:27], v[24:25] op_sel_hi:[1,0,0]
    v_pk_fma_f32 v[116:117], v[252:253], v[26:27], v[24:25] op_sel_hi:[1,0,0]
    v_pk_fma_f32 v[100:101], v[100:101], v[188:189], v[128:129]
    v_pk_fma_f32 v[102:103], v[102:103], v[192:193], v[132:133]
    v_pk_fma_f32 v[104:105], v[104:105], v[190:191], v[130:131]
    v_pk_fma_f32 v[106:107], v[106:107], v[194:195], v[134:135]
    v_pk_fma_f32 v[108:109], v[108:109], v[196:197], v[136:137]
    v_pk_fma_f32 v[110:111], v[110:111], v[200:201], v[140:141]
    v_pk_fma_f32 v[112:113], v[112:113], v[198:199], v[138:139]
    v_pk_fma_f32 v[114:115], v[114:115], v[202:203], v[142:143]
    v_pk_fma_f32 v[116:117], v[116:117], v[204:205], v[144:145]
    v_pk_add_f32 v[24:25], v[100:101], v[102:103]
    v_pk_mul_f32 v[26:27], v[100:101], v[100:101]
    v_pk_fma_f32 v[26:27], v[102:103], v[102:103], v[26:27]
    v_pk_add_f32 v[24:25], v[24:25], v[104:105]
    v_pk_fma_f32 v[26:27], v[104:105], v[104:105], v[26:27]
    v_pk_add_f32 v[24:25], v[24:25], v[106:107]
    v_pk_fma_f32 v[26:27], v[106:107], v[106:107], v[26:27]
    v_pk_add_f32 v[24:25], v[24:25], v[108:109]
    v_pk_fma_f32 v[26:27], v[108:109], v[108:109], v[26:27]
    v_pk_add_f32 v[24:25], v[24:25], v[110:111]
    v_pk_fma_f32 v[26:27], v[110:111], v[110:111], v[26:27]
    v_pk_add_f32 v[24:25], v[24:25], v[112:113]
    v_pk_fma_f32 v[26:27], v[112:113], v[112:113], v[26:27]
    v_pk_add_f32 v[24:25], v[24:25], v[114:115]
    v_pk_fma_f32 v[26:27], v[114:115], v[114:115], v[26:27]
    v_pk_add_f32 v[24:25], v[24:25], v[116:117]
    v_pk_fma_f32 v[26:27], v[116:117], v[116:117], v[26:27]
    v_add_f32 v24, v24, v25
    v_add_f32 v25, v26, v27
    s_nop 0
    v_add_f32_dpp v24, v24, v24 quad_perm:[1,0,3,2] row_mask:0xf bank_mask:0xf
    v_add_f32_dpp v25, v25, v25 quad_perm:[1,0,3,2] row_mask:0xf bank_mask:0xf
    s_nop 0
    v_add_f32_dpp v24, v24, v24 quad_perm:[2,3,0,1] row_mask:0xf bank_mask:0xf
    v_add_f32_dpp v25, v25, v25 quad_perm:[2,3,0,1] row_mask:0xf bank_mask:0xf
    s_nop 0
    v_add_f32_dpp v24, v24, v24 row_half_mirror row_mask:0xf bank_mask:0xf
    v_add_f32_dpp v25, v25, v25 row_half_mirror row_mask:0xf bank_mask:0xf
    s_nop 0
    v_add_f32_dpp v24, v24, v24 row_mirror row_mask:0xf bank_mask:0xf
    v_add_f32_dpp v25, v25, v25 row_mirror row_mask:0xf bank_mask:0xf
    v_mov_b32 v26, v24
    v_mov_b32 v27, v25
    s_nop 0
    v_permlane16_swap_b32 v24, v26
    v_permlane16_swap_b32 v25, v27
    v_add_f32 v24, v24, v26
    v_add_f32 v25, v25, v27
    v_mul_f32 v24, 0xbae38e39, v24
    v_mul_f32 v25, 0x3ae38e39, v25
    v_fma_f32 v25, -v24, v24, v25
    v_max_f32 v25, 0, v25
    v_add_f32 v25, 0x3727c5ac, v25
    v_rsq_f32 v26, v25
    s_nop 0
    v_mul_f32 v24, v24, v26
    v_pk_fma_f32 v[100:101], v[100:101], v[26:27], v[24:25] op_sel_hi:[1,0,0]
    v_cvt_pk_bf16_f32 v9, v100, v101
    v_pk_fma_f32 v[102:103], v[102:103], v[26:27], v[24:25] op_sel_hi:[1,0,0]
    v_cvt_pk_bf16_f32 v10, v102, v103
    ds_write2_b32 v227, v9, v10 offset0:0 offset1:32
    v_pk_fma_f32 v[104:105], v[104:105], v[26:27], v[24:25] op_sel_hi:[1,0,0]
    v_cvt_pk_bf16_f32 v11, v104, v105
    v_pk_fma_f32 v[106:107], v[106:107], v[26:27], v[24:25] op_sel_hi:[1,0,0]
    v_cvt_pk_bf16_f32 v12, v106, v107
    ds_write2_b32 v227, v11, v12 offset0:64 offset1:96
    v_pk_fma_f32 v[108:109], v[108:109], v[26:27], v[24:25] op_sel_hi:[1,0,0]
    v_cvt_pk_bf16_f32 v13, v108, v109
    v_pk_fma_f32 v[110:111], v[110:111], v[26:27], v[24:25] op_sel_hi:[1,0,0]
    v_cvt_pk_bf16_f32 v14, v110, v111
    ds_write2_b32 v227, v13, v14 offset0:128 offset1:160
    v_pk_fma_f32 v[112:113], v[112:113], v[26:27], v[24:25] op_sel_hi:[1,0,0]
    v_cvt_pk_bf16_f32 v15, v112, v113
    v_pk_fma_f32 v[114:115], v[114:115], v[26:27], v[24:25] op_sel_hi:[1,0,0]
    v_cvt_pk_bf16_f32 v16, v114, v115
    ds_write2_b32 v227, v15, v16 offset0:192 offset1:224
    v_pk_fma_f32 v[116:117], v[116:117], v[26:27], v[24:25] op_sel_hi:[1,0,0]
    v_cvt_pk_bf16_f32 v17, v116, v117
    ds_write_b32 v227, v17 offset:1024
    s_waitcnt lgkmcnt(0)
    s_barrier
    ds_read_b64_tr_b16 v[188:189], v229 offset:0
    ds_read_b64_tr_b16 v[190:191], v229 offset:4736
    ds_read_b64_tr_b16 v[192:193], v229 offset:512
    ds_read_b64_tr_b16 v[194:195], v229 offset:5248
    ds_read_b64_tr_b16 v[196:197], v229 offset:1024
    ds_read_b64_tr_b16 v[198:199], v229 offset:5760
    s_waitcnt lgkmcnt(4)
    buffer_store_dwordx4 v[188:191], v36, s[36:39], s48 offen sc1
    s_waitcnt lgkmcnt(2)
    buffer_store_dwordx4 v[192:195], v36, s[36:39], s49 offen sc1
    s_waitcnt lgkmcnt(0)
    s_cmp_lg_u32 s3, 0
    s_cbranch_scc1 L_m_20
    buffer_store_dwordx4 v[196:199], v36, s[36:39], s50 offen sc1
L_m_20:
    v_cvt_pk_bf16_f32 v9, v236, v237
    v_cvt_pk_bf16_f32 v10, v238, v239
    v_cvt_pk_bf16_f32 v11, v240, v241
    v_cvt_pk_bf16_f32 v12, v242, v243
    v_cvt_pk_bf16_f32 v13, v244, v245
    v_cvt_pk_bf16_f32 v14, v246, v247
    v_cvt_pk_bf16_f32 v15, v248, v249
    v_cvt_pk_bf16_f32 v16, v250, v251
    v_cvt_pk_bf16_f32 v17, v252, v253
    ds_write2_b32 v231, v9, v10 offset0:0 offset1:32
    ds_write2_b32 v231, v11, v12 offset0:64 offset1:96
    ds_write2_b32 v231, v13, v14 offset0:128 offset1:160
    ds_write2_b32 v231, v15, v16 offset0:192 offset1:224
    ds_write_b32 v231, v17 offset:1024
    s_waitcnt lgkmcnt(0)
    s_barrier
    s_cmp_ge_u32 s5, 27
    s_cbranch_scc1 L_m_21
    v_lshrrev_b32 v10, 2, v0
    v_and_b32 v11, 7, v10
    s_lshl_b32 s59, s3, 1
    s_add_u32 s59, s59, 0
    v_xor_b32 v11, s59, v11
    v_xor_b32 v12, 1, v11
    v_and_b32 v13, 3, v0
    v_lshlrev_b32 v13, 3, v13
    v_lshl_add_u32 v10, v10, 8, v13
    v_lshl_add_u32 v20, v11, 5, v10
    v_lshl_add_u32 v21, v12, 5, v10
    v_add_u32 v24, 0, v20
    v_add_u32 v25, 0, v21
    ds_read_b64_tr_b16 v[92:93], v24 offset:0
    ds_read_b64_tr_b16 v[94:95], v24 offset:4096
    ds_read_b64_tr_b16 v[96:97], v25 offset:0
    ds_read_b64_tr_b16 v[98:99], v25 offset:4096
    ds_read_b64_tr_b16 v[100:101], v24 offset:8192
    ds_read_b64_tr_b16 v[102:103], v24 offset:12288
    ds_read_b64_tr_b16 v[104:105], v25 offset:8192
    ds_read_b64_tr_b16 v[106:107], v25 offset:12288
    ds_read_b64_tr_b16 v[108:109], v24 offset:16384
    ds_read_b64_tr_b16 v[110:111], v24 offset:20480
    ds_read_b64_tr_b16 v[112:113], v25 offset:16384
    ds_read_b64_tr_b16 v[114:115], v25 offset:20480
    ds_read_b64_tr_b16 v[116:117], v24 offset:24576
    ds_read_b64_tr_b16 v[118:119], v24 offset:28672
    ds_read_b64_tr_b16 v[120:121], v25 offset:24576
    ds_read_b64_tr_b16 v[122:123], v25 offset:28672
    ds_read_b64_tr_b16 v[124:125], v24 offset:32768
    ds_read_b64_tr_b16 v[126:127], v24 offset:36864
    ds_read_b64_tr_b16 v[128:129], v25 offset:32768
    ds_read_b64_tr_b16 v[130:131], v25 offset:36864
    ds_read_b64_tr_b16 v[132:133], v24 offset:40960
    ds_read_b64_tr_b16 v[134:135], v24 offset:45056
    ds_read_b64_tr_b16 v[136:137], v25 offset:40960
    ds_read_b64_tr_b16 v[138:139], v25 offset:45056
    v_add_u32 v24, 49152, v20
    v_add_u32 v25, 49152, v21
    ds_read_b64_tr_b16 v[140:141], v24 offset:0
    ds_read_b64_tr_b16 v[142:143], v24 offset:4096
    ds_read_b64_tr_b16 v[144:145], v25 offset:0
    ds_read_b64_tr_b16 v[146:147], v25 offset:4096
    ds_read_b64_tr_b16 v[148:149], v24 offset:8192
    ds_read_b64_tr_b16 v[150:151], v24 offset:12288
    ds_read_b64_tr_b16 v[152:153], v25 offset:8192
    ds_read_b64_tr_b16 v[154:155], v25 offset:12288
    ds_read_b64_tr_b16 v[156:157], v24 offset:16384
    ds_read_b64_tr_b16 v[158:159], v24 offset:20480
    ds_read_b64_tr_b16 v[160:161], v25 offset:16384
    ds_read_b64_tr_b16 v[162:163], v25 offset:20480
    ds_read_b64_tr_b16 v[164:165], v24 offset:24576
    ds_read_b64_tr_b16 v[166:167], v24 offset:28672
    ds_read_b64_tr_b16 v[168:169], v25 offset:24576
    ds_read_b64_tr_b16 v[170:171], v25 offset:28672
    ds_read_b64_tr_b16 v[172:173], v24 offset:32768
    ds_read_b64_tr_b16 v[174:175], v24 offset:36864
    ds_read_b64_tr_b16 v[176:177], v25 offset:32768
    ds_read_b64_tr_b16 v[178:179], v25 offset:36864
    ds_read_b64_tr_b16 v[180:181], v24 offset:40960
    ds_read_b64_tr_b16 v[182:183], v24 offset:45056
    ds_read_b64_tr_b16 v[184:185], v25 offset:40960
    ds_read_b64_tr_b16 v[186:187], v25 offset:45056
    s_waitcnt vmcnt(0) lgkmcnt(0)
    s_barrier
    v_mul_u32_u24 v18, 1536, v2
    v_lshl_add_u32 v18, v1, 4, v18
    v_add_u32 v18, 98304, v18
    v_lshlrev_b32 v204, 16, v4
    v_and_b32 v205, 0xffff0000, v4
    v_lshlrev_b32 v206, 16, v5
    v_and_b32 v207, 0xffff0000, v5
    v_lshlrev_b32 v208, 16, v6
    v_and_b32 v209, 0xffff0000, v6
    v_lshlrev_b32 v210, 16, v7
    v_and_b32 v211, 0xffff0000, v7
    v_mov_b64 v[212:213], v[204:205]
    v_mov_b64 v[214:215], v[206:207]
    v_mov_b64 v[216:217], v[208:209]
    v_mov_b64 v[218:219], v[210:211]
    v_mov_b64 v[220:221], v[204:205]
    v_mov_b64 v[222:223], v[206:207]
    v_mov_b64 v[224:225], v[208:209]
    v_mov_b64 v[226:227], v[210:211]
    v_mov_b64 v[228:229], v[204:205]
    v_mov_b64 v[230:231], v[206:207]
    v_mov_b64 v[232:233], v[208:209]
    v_mov_b64 v[234:235], v[210:211]
    v_mov_b64 v[236:237], v[204:205]
    v_mov_b64 v[238:239], v[206:207]
    v_mov_b64 v[240:241], v[208:209]
    v_mov_b64 v[242:243], v[210:211]
    v_mov_b64 v[244:245], v[204:205]
    v_mov_b64 v[246:247], v[206:207]
    v_mov_b64 v[248:249], v[208:209]
    v_mov_b64 v[250:251], v[210:211]
    s_barrier
    v_add_u32 v24, 0, v20
    v_add_u32 v25, 0, v21
    ds_read_b64_tr_b16 v[188:189], v24 offset:0
    ds_read_b64_tr_b16 v[190:191], v24 offset:4096
    ds_read_b64_tr_b16 v[192:193], v25 offset:0
    ds_read_b64_tr_b16 v[194:195], v25 offset:4096
    ds_read_b64_tr_b16 v[196:197], v24 offset:8192
    ds_read_b64_tr_b16 v[198:199], v24 offset:12288
    ds_read_b64_tr_b16 v[200:201], v25 offset:8192
    ds_read_b64_tr_b16 v[202:203], v25 offset:12288
    ds_read_b64_tr_b16 v[52:53], v24 offset:16384
    ds_read_b64_tr_b16 v[54:55], v24 offset:20480
    ds_read_b64_tr_b16 v[56:57], v25 offset:16384
    ds_read_b64_tr_b16 v[58:59], v25 offset:20480
    ds_read_b64_tr_b16 v[60:61], v24 offset:24576
    ds_read_b64_tr_b16 v[62:63], v24 offset:28672
    ds_read_b64_tr_b16 v[64:65], v25 offset:24576
    ds_read_b64_tr_b16 v[66:67], v25 offset:28672
    s_waitcnt lgkmcnt(0)
    s_barrier
    s_branch L_stub_3
L_back_c2:
    v_add_u32 v24, 49152, v20
    v_add_u32 v25, 49152, v21
    s_barrier
    ds_read_b64_tr_b16 v[76:77], v20 offset:32768
    ds_read_b128 v[28:31], v18 offset:0
    ds_read_b64_tr_b16 v[78:79], v20 offset:36864
    ds_read_b128 v[32:35], v18 offset:256
    ds_read_b64_tr_b16 v[80:81], v21 offset:32768
    ds_read_b128 v[36:39], v18 offset:512
    ds_read_b64_tr_b16 v[82:83], v21 offset:36864
    ds_read_b128 v[40:43], v18 offset:768
    ds_read_b128 v[44:47], v18 offset:1024
    ds_read_b128 v[48:51], v18 offset:1280
    s_waitcnt lgkmcnt(7)
    v_mfma_f32_16x16x32_bf16 v[204:207], v[76:79], v[28:31], v[204:207]
    ds_read_b64_tr_b16 v[84:85], v20 offset:40960
    s_waitcnt lgkmcnt(4)
    v_mfma_f32_16x16x32_bf16 v[208:211], v[80:83], v[28:31], v[208:211]
    ds_read_b128 v[28:31], v18 offset:6144
    v_mfma_f32_16x16x32_bf16 v[212:215], v[76:79], v[32:35], v[212:215]
    ds_read_b64_tr_b16 v[86:87], v20 offset:45056
    v_mfma_f32_16x16x32_bf16 v[216:219], v[80:83], v[32:35], v[216:219]
    ds_read_b128 v[32:35], v18 offset:6400
    v_mfma_f32_16x16x32_bf16 v[220:223], v[76:79], v[36:39], v[220:223]
    ds_read_b64_tr_b16 v[88:89], v21 offset:40960
    v_mfma_f32_16x16x32_bf16 v[224:227], v[80:83], v[36:39], v[224:227]
    ds_read_b128 v[36:39], v18 offset:6656
    s_waitcnt lgkmcnt(8)
    v_mfma_f32_16x16x32_bf16 v[228:231], v[76:79], v[40:43], v[228:231]
    ds_read_b64_tr_b16 v[90:91], v21 offset:45056
    v_mfma_f32_16x16x32_bf16 v[232:235], v[80:83], v[40:43], v[232:235]
    ds_read_b128 v[40:43], v18 offset:6912
    s_waitcnt lgkmcnt(9)
    v_mfma_f32_16x16x32_bf16 v[236:239], v[76:79], v[44:47], v[236:239]
    v_mfma_f32_16x16x32_bf16 v[240:243], v[80:83], v[44:47], v[240:243]
    ds_read_b128 v[44:47], v18 offset:7168
    s_waitcnt lgkmcnt(9)
    v_mfma_f32_16x16x32_bf16 v[244:247], v[76:79], v[48:51], v[244:247]
    v_mfma_f32_16x16x32_bf16 v[248:251], v[80:83], v[48:51], v[248:251]
    ds_read_b128 v[48:51], v18 offset:7424
    s_waitcnt lgkmcnt(3)
    v_mfma_f32_16x16x32_bf16 v[204:207], v[84:87], v[28:31], v[204:207]
    s_barrier
    ds_read_b64_tr_b16 v[76:77], v24 offset:0
    v_mfma_f32_16x16x32_bf16 v[208:211], v[88:91], v[28:31], v[208:211]
    ds_read_b128 v[28:31], v18 offset:12288
    v_mfma_f32_16x16x32_bf16 v[212:215], v[84:87], v[32:35], v[212:215]
    ds_read_b64_tr_b16 v[78:79], v24 offset:4096
    v_mfma_f32_16x16x32_bf16 v[216:219], v[88:91], v[32:35], v[216:219]
    ds_read_b128 v[32:35], v18 offset:12544
    v_mfma_f32_16x16x32_bf16 v[220:223], v[84:87], v[36:39], v[220:223]
    ds_read_b64_tr_b16 v[80:81], v25 offset:0
    v_mfma_f32_16x16x32_bf16 v[224:227], v[88:91], v[36:39], v[224:227]
    ds_read_b128 v[36:39], v18 offset:12800
    s_waitcnt lgkmcnt(8)
    v_mfma_f32_16x16x32_bf16 v[228:231], v[84:87], v[40:43], v[228:231]
    ds_read_b64_tr_b16 v[82:83], v25 offset:4096
    v_mfma_f32_16x16x32_bf16 v[232:235], v[88:91], v[40:43], v[232:235]
    ds_read_b128 v[40:43], v18 offset:13056
    s_waitcnt lgkmcnt(9)
    v_mfma_f32_16x16x32_bf16 v[236:239], v[84:87], v[44:47], v[236:239]
    v_mfma_f32_16x16x32_bf16 v[240:243], v[88:91], v[44:47], v[240:243]
    ds_read_b128 v[44:47], v18 offset:13312
    s_waitcnt lgkmcnt(9)
    v_mfma_f32_16x16x32_bf16 v[244:247], v[84:87], v[48:51], v[244:247]
    v_mfma_f32_16x16x32_bf16 v[248:251], v[88:91], v[48:51], v[248:251]
    ds_read_b128 v[48:51], v18 offset:13568
    s_waitcnt lgkmcnt(3)
    v_mfma_f32_16x16x32_bf16 v[204:207], v[76:79], v[28:31], v[204:207]
    ds_read_b64_tr_b16 v[84:85], v24 offset:8192
    v_mfma_f32_16x16x32_bf16 v[208:211], v[80:83], v[28:31], v[208:211]
    ds_read_b128 v[28:31], v18 offset:18432
    v_mfma_f32_16x16x32_bf16 v[212:215], v[76:79], v[32:35], v[212:215]
    ds_read_b64_tr_b16 v[86:87], v24 offset:12288
    v_mfma_f32_16x16x32_bf16 v[216:219], v[80:83], v[32:35], v[216:219]
    ds_read_b128 v[32:35], v18 offset:18688
    v_mfma_f32_16x16x32_bf16 v[220:223], v[76:79], v[36:39], v[220:223]
    ds_read_b64_tr_b16 v[88:89], v25 offset:8192
    v_mfma_f32_16x16x32_bf16 v[224:227], v[80:83], v[36:39], v[224:227]
    ds_read_b128 v[36:39], v18 offset:18944
    s_waitcnt lgkmcnt(8)
    v_mfma_f32_16x16x32_bf16 v[228:231], v[76:79], v[40:43], v[228:231]
    ds_read_b64_tr_b16 v[90:91], v25 offset:12288
    v_mfma_f32_16x16x32_bf16 v[232:235], v[80:83], v[40:43], v[232:235]
    ds_read_b128 v[40:43], v18 offset:19200
    s_waitcnt lgkmcnt(9)
    v_mfma_f32_16x16x32_bf16 v[236:239], v[76:79], v[44:47], v[236:239]
    v_mfma_f32_16x16x32_bf16 v[240:243], v[80:83], v[44:47], v[240:243]
    ds_read_b128 v[44:47], v18 offset:19456
    s_waitcnt lgkmcnt(9)
    v_mfma_f32_16x16x32_bf16 v[244:247], v[76:79], v[48:51], v[244:247]
    v_mfma_f32_16x16x32_bf16 v[248:251], v[80:83], v[48:51], v[248:251]
    ds_read_b128 v[48:51], v18 offset:19712
    s_waitcnt lgkmcnt(3)
    v_mfma_f32_16x16x32_bf16 v[204:207], v[84:87], v[28:31], v[204:207]
    s_barrier
    ds_read_b64_tr_b16 v[76:77], v24 offset:16384
    v_mfma_f32_16x16x32_bf16 v[208:211], v[88:91], v[28:31], v[208:211]
    ds_read_b128 v[28:31], v18 offset:24576
    v_mfma_f32_16x16x32_bf16 v[212:215], v[84:87], v[32:35], v[212:215]
    ds_read_b64_tr_b16 v[78:79], v24 offset:20480
    v_mfma_f32_16x16x32_bf16 v[216:219], v[88:91], v[32:35], v[216:219]
    ds_read_b128 v[32:35], v18 offset:24832
    v_mfma_f32_16x16x32_bf16 v[220:223], v[84:87], v[36:39], v[220:223]
    ds_read_b64_tr_b16 v[80:81], v25 offset:16384
    v_mfma_f32_16x16x32_bf16 v[224:227], v[88:91], v[36:39], v[224:227]
    ds_read_b128 v[36:39], v18 offset:25088
    s_waitcnt lgkmcnt(8)
    v_mfma_f32_16x16x32_bf16 v[228:231], v[84:87], v[40:43], v[228:231]
    ds_read_b64_tr_b16 v[82:83], v25 offset:20480
    v_mfma_f32_16x16x32_bf16 v[232:235], v[88:91], v[40:43], v[232:235]
    ds_read_b128 v[40:43], v18 offset:25344
    s_waitcnt lgkmcnt(9)
    v_mfma_f32_16x16x32_bf16 v[236:239], v[84:87], v[44:47], v[236:239]
    v_mfma_f32_16x16x32_bf16 v[240:243], v[88:91], v[44:47], v[240:243]
    ds_read_b128 v[44:47], v18 offset:25600
    s_waitcnt lgkmcnt(9)
    v_mfma_f32_16x16x32_bf16 v[244:247], v[84:87], v[48:51], v[244:247]
    v_mfma_f32_16x16x32_bf16 v[248:251], v[88:91], v[48:51], v[248:251]
    ds_read_b128 v[48:51], v18 offset:25856
    s_waitcnt lgkmcnt(3)
    v_mfma_f32_16x16x32_bf16 v[204:207], v[76:79], v[28:31], v[204:207]
    ds_read_b64_tr_b16 v[84:85], v24 offset:24576
    v_mfma_f32_16x16x32_bf16 v[208:211], v[80:83], v[28:31], v[208:211]
    ds_read_b128 v[28:31], v18 offset:30720
    v_mfma_f32_16x16x32_bf16 v[212:215], v[76:79], v[32:35], v[212:215]
    ds_read_b64_tr_b16 v[86:87], v24 offset:28672
    v_mfma_f32_16x16x32_bf16 v[216:219], v[80:83], v[32:35], v[216:219]
    s_branch L_skip_3
    s_nop 0
L_stub_3:
    s_branch L_stub_4
L_skip_3:
    ds_read_b128 v[32:35], v18 offset:30976
    v_mfma_f32_16x16x32_bf16 v[220:223], v[76:79], v[36:39], v[220:223]
    ds_read_b64_tr_b16 v[88:89], v25 offset:24576
    v_mfma_f32_16x16x32_bf16 v[224:227], v[80:83], v[36:39], v[224:227]
    ds_read_b128 v[36:39], v18 offset:31232
    s_waitcnt lgkmcnt(8)
    v_mfma_f32_16x16x32_bf16 v[228:231], v[76:79], v[40:43], v[228:231]
    ds_read_b64_tr_b16 v[90:91], v25 offset:28672
    v_mfma_f32_16x16x32_bf16 v[232:235], v[80:83], v[40:43], v[232:235]
    ds_read_b128 v[40:43], v18 offset:31488
    s_waitcnt lgkmcnt(9)
    v_mfma_f32_16x16x32_bf16 v[236:239], v[76:79], v[44:47], v[236:239]
    v_mfma_f32_16x16x32_bf16 v[240:243], v[80:83], v[44:47], v[240:243]
    ds_read_b128 v[44:47], v18 offset:31744
    s_waitcnt lgkmcnt(9)
    v_mfma_f32_16x16x32_bf16 v[244:247], v[76:79], v[48:51], v[244:247]
    v_mfma_f32_16x16x32_bf16 v[248:251], v[80:83], v[48:51], v[248:251]
    ds_read_b128 v[48:51], v18 offset:32000
    s_waitcnt lgkmcnt(3)
    v_mfma_f32_16x16x32_bf16 v[204:207], v[84:87], v[28:31], v[204:207]
    s_barrier
    ds_read_b64_tr_b16 v[76:77], v24 offset:32768
    v_mfma_f32_16x16x32_bf16 v[208:211], v[88:91], v[28:31], v[208:211]
    ds_read_b128 v[28:31], v18 offset:36864
    v_mfma_f32_16x16x32_bf16 v[212:215], v[84:87], v[32:35], v[212:215]
    ds_read_b64_tr_b16 v[78:79], v24 offset:36864
    v_mfma_f32_16x16x32_bf16 v[216:219], v[88:91], v[32:35], v[216:219]
    ds_read_b128 v[32:35], v18 offset:37120
    v_mfma_f32_16x16x32_bf16 v[220:223], v[84:87], v[36:39], v[220:223]
    ds_read_b64_tr_b16 v[80:81], v25 offset:32768
    v_mfma_f32_16x16x32_bf16 v[224:227], v[88:91], v[36:39], v[224:227]
    ds_read_b128 v[36:39], v18 offset:37376
    s_waitcnt lgkmcnt(8)
    v_mfma_f32_16x16x32_bf16 v[228:231], v[84:87], v[40:43], v[228:231]
    ds_read_b64_tr_b16 v[82:83], v25 offset:36864
    v_mfma_f32_16x16x32_bf16 v[232:235], v[88:91], v[40:43], v[232:235]
    ds_read_b128 v[40:43], v18 offset:37632
    s_waitcnt lgkmcnt(9)
    v_mfma_f32_16x16x32_bf16 v[236:239], v[84:87], v[44:47], v[236:239]
    v_mfma_f32_16x16x32_bf16 v[240:243], v[88:91], v[44:47], v[240:243]
    ds_read_b128 v[44:47], v18 offset:37888
    s_waitcnt lgkmcnt(9)
    v_mfma_f32_16x16x32_bf16 v[244:247], v[84:87], v[48:51], v[244:247]
    v_mfma_f32_16x16x32_bf16 v[248:251], v[88:91], v[48:51], v[248:251]
    ds_read_b128 v[48:51], v18 offset:38144
    s_waitcnt lgkmcnt(3)
    v_mfma_f32_16x16x32_bf16 v[204:207], v[76:79], v[28:31], v[204:207]
    ds_read_b64_tr_b16 v[84:85], v24 offset:40960
    v_mfma_f32_16x16x32_bf16 v[208:211], v[80:83], v[28:31], v[208:211]
    ds_read_b128 v[28:31], v18 offset:43008
    v_mfma_f32_16x16x32_bf16 v[212:215], v[76:79], v[32:35], v[212:215]
    ds_read_b64_tr_b16 v[86:87], v24 offset:45056
    v_mfma_f32_16x16x32_bf16 v[216:219], v[80:83], v[32:35], v[216:219]
    ds_read_b128 v[32:35], v18 offset:43264
    v_mfma_f32_16x16x32_bf16 v[220:223], v[76:79], v[36:39], v[220:223]
    ds_read_b64_tr_b16 v[88:89], v25 offset:40960
    v_mfma_f32_16x16x32_bf16 v[224:227], v[80:83], v[36:39], v[224:227]
    ds_read_b128 v[36:39], v18 offset:43520
    s_waitcnt lgkmcnt(8)
    v_mfma_f32_16x16x32_bf16 v[228:231], v[76:79], v[40:43], v[228:231]
    ds_read_b64_tr_b16 v[90:91], v25 offset:45056
    v_mfma_f32_16x16x32_bf16 v[232:235], v[80:83], v[40:43], v[232:235]
    ds_read_b128 v[40:43], v18 offset:43776
    s_waitcnt lgkmcnt(9)
    v_mfma_f32_16x16x32_bf16 v[236:239], v[76:79], v[44:47], v[236:239]
    v_mfma_f32_16x16x32_bf16 v[240:243], v[80:83], v[44:47], v[240:243]
    ds_read_b128 v[44:47], v18 offset:44032
    s_waitcnt lgkmcnt(9)
    v_mfma_f32_16x16x32_bf16 v[244:247], v[76:79], v[48:51], v[244:247]
    v_mfma_f32_16x16x32_bf16 v[248:251], v[80:83], v[48:51], v[248:251]
    ds_read_b128 v[48:51], v18 offset:44288
    s_waitcnt lgkmcnt(3)
    v_mfma_f32_16x16x32_bf16 v[204:207], v[84:87], v[28:31], v[204:207]
    s_barrier
    ds_read_b64_tr_b16 v[76:77], v20 offset:0
    v_mfma_f32_16x16x32_bf16 v[208:211], v[88:91], v[28:31], v[208:211]
    ds_read_b128 v[28:31], v18 offset:49152
    v_mfma_f32_16x16x32_bf16 v[212:215], v[84:87], v[32:35], v[212:215]
    ds_read_b64_tr_b16 v[78:79], v20 offset:4096
    v_mfma_f32_16x16x32_bf16 v[216:219], v[88:91], v[32:35], v[216:219]
    ds_read_b128 v[32:35], v18 offset:49408
    v_mfma_f32_16x16x32_bf16 v[220:223], v[84:87], v[36:39], v[220:223]
    ds_read_b64_tr_b16 v[80:81], v21 offset:0
    v_mfma_f32_16x16x32_bf16 v[224:227], v[88:91], v[36:39], v[224:227]
    ds_read_b128 v[36:39], v18 offset:49664
    s_waitcnt lgkmcnt(8)
    v_mfma_f32_16x16x32_bf16 v[228:231], v[84:87], v[40:43], v[228:231]
    ds_read_b64_tr_b16 v[82:83], v21 offset:4096
    v_mfma_f32_16x16x32_bf16 v[232:235], v[88:91], v[40:43], v[232:235]
    ds_read_b128 v[40:43], v18 offset:49920
    s_waitcnt lgkmcnt(9)
    v_mfma_f32_16x16x32_bf16 v[236:239], v[84:87], v[44:47], v[236:239]
    v_mfma_f32_16x16x32_bf16 v[240:243], v[88:91], v[44:47], v[240:243]
    ds_read_b128 v[44:47], v18 offset:50176
    s_waitcnt lgkmcnt(9)
    v_mfma_f32_16x16x32_bf16 v[244:247], v[84:87], v[48:51], v[244:247]
    v_mfma_f32_16x16x32_bf16 v[248:251], v[88:91], v[48:51], v[248:251]
    ds_read_b128 v[48:51], v18 offset:50432
    s_waitcnt lgkmcnt(3)
    v_mfma_f32_16x16x32_bf16 v[204:207], v[76:79], v[28:31], v[204:207]
    ds_read_b64_tr_b16 v[84:85], v20 offset:8192
    v_mfma_f32_16x16x32_bf16 v[208:211], v[80:83], v[28:31], v[208:211]
    ds_read_b128 v[28:31], v18 offset:55296
    v_mfma_f32_16x16x32_bf16 v[212:215], v[76:79], v[32:35], v[212:215]
    ds_read_b64_tr_b16 v[86:87], v20 offset:12288
    v_mfma_f32_16x16x32_bf16 v[216:219], v[80:83], v[32:35], v[216:219]
    ds_read_b128 v[32:35], v18 offset:55552
    v_mfma_f32_16x16x32_bf16 v[220:223], v[76:79], v[36:39], v[220:223]
    ds_read_b64_tr_b16 v[88:89], v21 offset:8192
    v_mfma_f32_16x16x32_bf16 v[224:227], v[80:83], v[36:39], v[224:227]
    ds_read_b128 v[36:39], v18 offset:55808
    s_waitcnt lgkmcnt(8)
    v_mfma_f32_16x16x32_bf16 v[228:231], v[76:79], v[40:43], v[228:231]
    ds_read_b64_tr_b16 v[90:91], v21 offset:12288
    v_mfma_f32_16x16x32_bf16 v[232:235], v[80:83], v[40:43], v[232:235]
    ds_read_b128 v[40:43], v18 offset:56064
    s_waitcnt lgkmcnt(9)
    v_mfma_f32_16x16x32_bf16 v[236:239], v[76:79], v[44:47], v[236:239]
    v_mfma_f32_16x16x32_bf16 v[240:243], v[80:83], v[44:47], v[240:243]
    ds_read_b128 v[44:47], v18 offset:56320
    s_waitcnt lgkmcnt(9)
    v_mfma_f32_16x16x32_bf16 v[244:247], v[76:79], v[48:51], v[244:247]
    v_mfma_f32_16x16x32_bf16 v[248:251], v[80:83], v[48:51], v[248:251]
    ds_read_b128 v[48:51], v18 offset:56576
    s_waitcnt lgkmcnt(3)
    v_mfma_f32_16x16x32_bf16 v[204:207], v[84:87], v[28:31], v[204:207]
    s_barrier
    ds_read_b64_tr_b16 v[76:77], v20 offset:16384
    v_mfma_f32_16x16x32_bf16 v[208:211], v[88:91], v[28:31], v[208:211]
    ds_read_b128 v[28:31], v18 offset:0
    v_mfma_f32_16x16x32_bf16 v[212:215], v[84:87], v[32:35], v[212:215]
    ds_read_b64_tr_b16 v[78:79], v20 offset:20480
    v_mfma_f32_16x16x32_bf16 v[216:219], v[88:91], v[32:35], v[216:219]
    ds_read_b128 v[32:35], v18 offset:256
    v_mfma_f32_16x16x32_bf16 v[220:223], v[84:87], v[36:39], v[220:223]
    ds_read_b64_tr_b16 v[80:81], v21 offset:16384
    v_mfma_f32_16x16x32_bf16 v[224:227], v[88:91], v[36:39], v[224:227]
    ds_read_b128 v[36:39], v18 offset:512
    s_waitcnt lgkmcnt(8)
    v_mfma_f32_16x16x32_bf16 v[228:231], v[84:87], v[40:43], v[228:231]
    ds_read_b64_tr_b16 v[82:83], v21 offset:20480
    v_mfma_f32_16x16x32_bf16 v[232:235], v[88:91], v[40:43], v[232:235]
    ds_read_b128 v[40:43], v18 offset:768
    s_waitcnt lgkmcnt(9)
    v_mfma_f32_16x16x32_bf16 v[236:239], v[84:87], v[44:47], v[236:239]
    v_mfma_f32_16x16x32_bf16 v[240:243], v[88:91], v[44:47], v[240:243]
    ds_read_b128 v[44:47], v18 offset:1024
    s_waitcnt lgkmcnt(9)
    v_mfma_f32_16x16x32_bf16 v[244:247], v[84:87], v[48:51], v[244:247]
    v_mfma_f32_16x16x32_bf16 v[248:251], v[88:91], v[48:51], v[248:251]
    ds_read_b128 v[48:51], v18 offset:1280
    s_waitcnt lgkmcnt(3)
    v_mfma_f32_16x16x32_bf16 v[204:207], v[76:79], v[28:31], v[204:207]
    ds_read_b64_tr_b16 v[84:85], v20 offset:24576
    v_mfma_f32_16x16x32_bf16 v[208:211], v[80:83], v[28:31], v[208:211]
    ds_read_b128 v[28:31], v18 offset:6144
    v_mfma_f32_16x16x32_bf16 v[212:215], v[76:79], v[32:35], v[212:215]
    ds_read_b64_tr_b16 v[86:87], v20 offset:28672
    v_mfma_f32_16x16x32_bf16 v[216:219], v[80:83], v[32:35], v[216:219]
    ds_read_b128 v[32:35], v18 offset:6400
    v_mfma_f32_16x16x32_bf16 v[220:223], v[76:79], v[36:39], v[220:223]
    ds_read_b64_tr_b16 v[88:89], v21 offset:24576
    v_mfma_f32_16x16x32_bf16 v[224:227], v[80:83], v[36:39], v[224:227]
    ds_read_b128 v[36:39], v18 offset:6656
    s_waitcnt lgkmcnt(8)
    v_mfma_f32_16x16x32_bf16 v[228:231], v[76:79], v[40:43], v[228:231]
    ds_read_b64_tr_b16 v[90:91], v21 offset:28672
    v_mfma_f32_16x16x32_bf16 v[232:235], v[80:83], v[40:43], v[232:235]
    ds_read_b128 v[40:43], v18 offset:6912
    s_waitcnt lgkmcnt(9)
    v_mfma_f32_16x16x32_bf16 v[236:239], v[76:79], v[44:47], v[236:239]
    v_mfma_f32_16x16x32_bf16 v[240:243], v[80:83], v[44:47], v[240:243]
    ds_read_b128 v[44:47], v18 offset:7168
    s_waitcnt lgkmcnt(9)
    v_mfma_f32_16x16x32_bf16 v[244:247], v[76:79], v[48:51], v[244:247]
    v_mfma_f32_16x16x32_bf16 v[248:251], v[80:83], v[48:51], v[248:251]
    ds_read_b128 v[48:51], v18 offset:7424
    s_waitcnt lgkmcnt(3)
    v_mfma_f32_16x16x32_bf16 v[204:207], v[84:87], v[28:31], v[204:207]
    s_barrier
    v_mfma_f32_16x16x32_bf16 v[208:211], v[88:91], v[28:31], v[208:211]
    ds_read_b128 v[28:31], v18 offset:12288
    v_mfma_f32_16x16x32_bf16 v[212:215], v[84:87], v[32:35], v[212:215]
    v_mfma_f32_16x16x32_bf16 v[216:219], v[88:91], v[32:35], v[216:219]
    ds_read_b128 v[32:35], v18 offset:12544
    v_mfma_f32_16x16x32_bf16 v[220:223], v[84:87], v[36:39], v[220:223]
    v_mfma_f32_16x16x32_bf16 v[224:227], v[88:91], v[36:39], v[224:227]
    ds_read_b128 v[36:39], v18 offset:12800
    s_waitcnt lgkmcnt(5)
    v_mfma_f32_16x16x32_bf16 v[228:231], v[84:87], v[40:43], v[228:231]
    v_mfma_f32_16x16x32_bf16 v[232:235], v[88:91], v[40:43], v[232:235]
    ds_read_b128 v[40:43], v18 offset:13056
    s_waitcnt lgkmcnt(5)
    v_mfma_f32_16x16x32_bf16 v[236:239], v[84:87], v[44:47], v[236:239]
    v_mfma_f32_16x16x32_bf16 v[240:243], v[88:91], v[44:47], v[240:243]
    ds_read_b128 v[44:47], v18 offset:13312
    s_waitcnt lgkmcnt(5)
    v_mfma_f32_16x16x32_bf16 v[244:247], v[84:87], v[48:51], v[244:247]
    v_mfma_f32_16x16x32_bf16 v[248:251], v[88:91], v[48:51], v[248:251]
    ds_read_b128 v[48:51], v18 offset:13568
    s_waitcnt lgkmcnt(3)
    v_mfma_f32_16x16x32_bf16 v[204:207], v[92:95], v[28:31], v[204:207]
    v_mfma_f32_16x16x32_bf16 v[208:211], v[96:99], v[28:31], v[208:211]
    ds_read_b128 v[28:31], v18 offset:18432
    v_mfma_f32_16x16x32_bf16 v[212:215], v[92:95], v[32:35], v[212:215]
    v_mfma_f32_16x16x32_bf16 v[216:219], v[96:99], v[32:35], v[216:219]
    ds_read_b128 v[32:35], v18 offset:18688
    v_mfma_f32_16x16x32_bf16 v[220:223], v[92:95], v[36:39], v[220:223]
    v_mfma_f32_16x16x32_bf16 v[224:227], v[96:99], v[36:39], v[224:227]
    ds_read_b128 v[36:39], v18 offset:18944
    s_waitcnt lgkmcnt(5)
    v_mfma_f32_16x16x32_bf16 v[228:231], v[92:95], v[40:43], v[228:231]
    v_mfma_f32_16x16x32_bf16 v[232:235], v[96:99], v[40:43], v[232:235]
    ds_read_b128 v[40:43], v18 offset:19200
    s_waitcnt lgkmcnt(5)
    v_mfma_f32_16x16x32_bf16 v[236:239], v[92:95], v[44:47], v[236:239]
    v_mfma_f32_16x16x32_bf16 v[240:243], v[96:99], v[44:47], v[240:243]
    ds_read_b128 v[44:47], v18 offset:19456
    s_waitcnt lgkmcnt(5)
    v_mfma_f32_16x16x32_bf16 v[244:247], v[92:95], v[48:51], v[244:247]
    v_mfma_f32_16x16x32_bf16 v[248:251], v[96:99], v[48:51], v[248:251]
    ds_read_b128 v[48:51], v18 offset:19712
    s_waitcnt lgkmcnt(3)
    v_mfma_f32_16x16x32_bf16 v[204:207], v[100:103], v[28:31], v[204:207]
    s_barrier
    ds_read_b64_tr_b16 v[76:77], v20 offset:32768
    v_mfma_f32_16x16x32_bf16 v[208:211], v[104:107], v[28:31], v[208:211]
    ds_read_b128 v[28:31], v18 offset:24576
    v_mfma_f32_16x16x32_bf16 v[212:215], v[100:103], v[32:35], v[212:215]
    ds_read_b64_tr_b16 v[78:79], v20 offset:36864
    v_mfma_f32_16x16x32_bf16 v[216:219], v[104:107], v[32:35], v[216:219]
    ds_read_b128 v[32:35], v18 offset:24832
    v_mfma_f32_16x16x32_bf16 v[220:223], v[100:103], v[36:39], v[220:223]
    ds_read_b64_tr_b16 v[80:81], v21 offset:32768
    v_mfma_f32_16x16x32_bf16 v[224:227], v[104:107], v[36:39], v[224:227]
    ds_read_b128 v[36:39], v18 offset:25088
    s_waitcnt lgkmcnt(8)
    v_mfma_f32_16x16x32_bf16 v[228:231], v[100:103], v[40:43], v[228:231]
    ds_read_b64_tr_b16 v[82:83], v21 offset:36864
    v_mfma_f32_16x16x32_bf16 v[232:235], v[104:107], v[40:43], v[232:235]
    ds_read_b128 v[40:43], v18 offset:25344
    s_waitcnt lgkmcnt(9)
    v_mfma_f32_16x16x32_bf16 v[236:239], v[100:103], v[44:47], v[236:239]
    v_mfma_f32_16x16x32_bf16 v[240:243], v[104:107], v[44:47], v[240:243]
    ds_read_b128 v[44:47], v18 offset:25600
    s_waitcnt lgkmcnt(9)
    v_mfma_f32_16x16x32_bf16 v[244:247], v[100:103], v[48:51], v[244:247]
    v_mfma_f32_16x16x32_bf16 v[248:251], v[104:107], v[48:51], v[248:251]
    ds_read_b128 v[48:51], v18 offset:25856
    s_waitcnt lgkmcnt(3)
    v_mfma_f32_16x16x32_bf16 v[204:207], v[76:79], v[28:31], v[204:207]
    ds_read_b64_tr_b16 v[84:85], v20 offset:40960
    v_mfma_f32_16x16x32_bf16 v[208:211], v[80:83], v[28:31], v[208:211]
    ds_read_b128 v[28:31], v18 offset:30720
    v_mfma_f32_16x16x32_bf16 v[212:215], v[76:79], v[32:35], v[212:215]
    ds_read_b64_tr_b16 v[86:87], v20 offset:45056
    v_mfma_f32_16x16x32_bf16 v[216:219], v[80:83], v[32:35], v[216:219]
    ds_read_b128 v[32:35], v18 offset:30976
    v_mfma_f32_16x16x32_bf16 v[220:223], v[76:79], v[36:39], v[220:223]
    ds_read_b64_tr_b16 v[88:89], v21 offset:40960
    v_mfma_f32_16x16x32_bf16 v[224:227], v[80:83], v[36:39], v[224:227]
    ds_read_b128 v[36:39], v18 offset:31232
    s_waitcnt lgkmcnt(8)
    v_mfma_f32_16x16x32_bf16 v[228:231], v[76:79], v[40:43], v[228:231]
    ds_read_b64_tr_b16 v[90:91], v21 offset:45056
    v_mfma_f32_16x16x32_bf16 v[232:235], v[80:83], v[40:43], v[232:235]
    ds_read_b128 v[40:43], v18 offset:31488
    s_waitcnt lgkmcnt(9)
    v_mfma_f32_16x16x32_bf16 v[236:239], v[76:79], v[44:47], v[236:239]
    v_mfma_f32_16x16x32_bf16 v[240:243], v[80:83], v[44:47], v[240:243]
    ds_read_b128 v[44:47], v18 offset:31744
    s_waitcnt lgkmcnt(9)
    v_mfma_f32_16x16x32_bf16 v[244:247], v[76:79], v[48:51], v[244:247]
    v_mfma_f32_16x16x32_bf16 v[248:251], v[80:83], v[48:51], v[248:251]
    ds_read_b128 v[48:51], v18 offset:32000
    s_waitcnt lgkmcnt(3)
    v_mfma_f32_16x16x32_bf16 v[204:207], v[84:87], v[28:31], v[204:207]
    s_barrier
    ds_read_b64_tr_b16 v[76:77], v24 offset:0
    v_mfma_f32_16x16x32_bf16 v[208:211], v[88:91], v[28:31], v[208:211]
    ds_read_b128 v[28:31], v18 offset:36864
    v_mfma_f32_16x16x32_bf16 v[212:215], v[84:87], v[32:35], v[212:215]
    ds_read_b64_tr_b16 v[78:79], v24 offset:4096
    v_mfma_f32_16x16x32_bf16 v[216:219], v[88:91], v[32:35], v[216:219]
    ds_read_b128 v[32:35], v18 offset:37120
    v_mfma_f32_16x16x32_bf16 v[220:223], v[84:87], v[36:39], v[220:223]
    ds_read_b64_tr_b16 v[80:81], v25 offset:0
    v_mfma_f32_16x16x32_bf16 v[224:227], v[88:91], v[36:39], v[224:227]
    ds_read_b128 v[36:39], v18 offset:37376
    s_waitcnt lgkmcnt(8)
    v_mfma_f32_16x16x32_bf16 v[228:231], v[84:87], v[40:43], v[228:231]
    ds_read_b64_tr_b16 v[82:83], v25 offset:4096
    v_mfma_f32_16x16x32_bf16 v[232:235], v[88:91], v[40:43], v[232:235]
    ds_read_b128 v[40:43], v18 offset:37632
    s_waitcnt lgkmcnt(9)
    v_mfma_f32_16x16x32_bf16 v[236:239], v[84:87], v[44:47], v[236:239]
    v_mfma_f32_16x16x32_bf16 v[240:243], v[88:91], v[44:47], v[240:243]
    ds_read_b128 v[44:47], v18 offset:37888
    s_waitcnt lgkmcnt(9)
    v_mfma_f32_16x16x32_bf16 v[244:247], v[84:87], v[48:51], v[244:247]
    v_mfma_f32_16x16x32_bf16 v[248:251], v[88:91], v[48:51], v[248:251]
    ds_read_b128 v[48:51], v18 offset:38144
    s_waitcnt lgkmcnt(3)
    v_mfma_f32_16x16x32_bf16 v[204:207], v[76:79], v[28:31], v[204:207]
    ds_read_b64_tr_b16 v[84:85], v24 offset:8192
    v_mfma_f32_16x16x32_bf16 v[208:211], v[80:83], v[28:31], v[208:211]
    ds_read_b128 v[28:31], v18 offset:43008
    v_mfma_f32_16x16x32_bf16 v[212:215], v[76:79], v[32:35], v[212:215]
    ds_read_b64_tr_b16 v[86:87], v24 offset:12288
    v_mfma_f32_16x16x32_bf16 v[216:219], v[80:83], v[32:35], v[216:219]
    ds_read_b128 v[32:35], v18 offset:43264
    v_mfma_f32_16x16x32_bf16 v[220:223], v[76:79], v[36:39], v[220:223]
    ds_read_b64_tr_b16 v[88:89], v25 offset:8192
    v_mfma_f32_16x16x32_bf16 v[224:227], v[80:83], v[36:39], v[224:227]
    ds_read_b128 v[36:39], v18 offset:43520
    s_waitcnt lgkmcnt(8)
    v_mfma_f32_16x16x32_bf16 v[228:231], v[76:79], v[40:43], v[228:231]
    ds_read_b64_tr_b16 v[90:91], v25 offset:12288
    v_mfma_f32_16x16x32_bf16 v[232:235], v[80:83], v[40:43], v[232:235]
    ds_read_b128 v[40:43], v18 offset:43776
    s_waitcnt lgkmcnt(9)
    v_mfma_f32_16x16x32_bf16 v[236:239], v[76:79], v[44:47], v[236:239]
    v_mfma_f32_16x16x32_bf16 v[240:243], v[80:83], v[44:47], v[240:243]
    ds_read_b128 v[44:47], v18 offset:44032
    s_waitcnt lgkmcnt(9)
    v_mfma_f32_16x16x32_bf16 v[244:247], v[76:79], v[48:51], v[244:247]
    v_mfma_f32_16x16x32_bf16 v[248:251], v[80:83], v[48:51], v[248:251]
    ds_read_b128 v[48:51], v18 offset:44288
    s_waitcnt lgkmcnt(3)
    v_mfma_f32_16x16x32_bf16 v[204:207], v[84:87], v[28:31], v[204:207]
    s_barrier
    v_mfma_f32_16x16x32_bf16 v[208:211], v[88:91], v[28:31], v[208:211]
    ds_read_b128 v[28:31], v18 offset:49152
    v_mfma_f32_16x16x32_bf16 v[212:215], v[84:87], v[32:35], v[212:215]
    v_mfma_f32_16x16x32_bf16 v[216:219], v[88:91], v[32:35], v[216:219]
    ds_read_b128 v[32:35], v18 offset:49408
    v_mfma_f32_16x16x32_bf16 v[220:223], v[84:87], v[36:39], v[220:223]
    v_mfma_f32_16x16x32_bf16 v[224:227], v[88:91], v[36:39], v[224:227]
    ds_read_b128 v[36:39], v18 offset:49664
    s_waitcnt lgkmcnt(5)
    v_mfma_f32_16x16x32_bf16 v[228:231], v[84:87], v[40:43], v[228:231]
    v_mfma_f32_16x16x32_bf16 v[232:235], v[88:91], v[40:43], v[232:235]
    ds_read_b128 v[40:43], v18 offset:49920
    s_waitcnt lgkmcnt(5)
    v_mfma_f32_16x16x32_bf16 v[236:239], v[84:87], v[44:47], v[236:239]
    v_mfma_f32_16x16x32_bf16 v[240:243], v[88:91], v[44:47], v[240:243]
    ds_read_b128 v[44:47], v18 offset:50176
    s_waitcnt lgkmcnt(5)
    v_mfma_f32_16x16x32_bf16 v[244:247], v[84:87], v[48:51], v[244:247]
    v_mfma_f32_16x16x32_bf16 v[248:251], v[88:91], v[48:51], v[248:251]
    ds_read_b128 v[48:51], v18 offset:50432
    s_waitcnt lgkmcnt(3)
    v_mfma_f32_16x16x32_bf16 v[204:207], v[108:111], v[28:31], v[204:207]
    v_mfma_f32_16x16x32_bf16 v[208:211], v[112:115], v[28:31], v[208:211]
    ds_read_b128 v[28:31], v18 offset:55296
    v_mfma_f32_16x16x32_bf16 v[212:215], v[108:111], v[32:35], v[212:215]
    v_mfma_f32_16x16x32_bf16 v[216:219], v[112:115], v[32:35], v[216:219]
    ds_read_b128 v[32:35], v18 offset:55552
    v_mfma_f32_16x16x32_bf16 v[220:223], v[108:111], v[36:39], v[220:223]
    v_mfma_f32_16x16x32_bf16 v[224:227], v[112:115], v[36:39], v[224:227]
    ds_read_b128 v[36:39], v18 offset:55808
    s_waitcnt lgkmcnt(5)
    v_mfma_f32_16x16x32_bf16 v[228:231], v[108:111], v[40:43], v[228:231]
    v_mfma_f32_16x16x32_bf16 v[232:235], v[112:115], v[40:43], v[232:235]
    ds_read_b128 v[40:43], v18 offset:56064
    s_waitcnt lgkmcnt(5)
    v_mfma_f32_16x16x32_bf16 v[236:239], v[108:111], v[44:47], v[236:239]
    v_mfma_f32_16x16x32_bf16 v[240:243], v[112:115], v[44:47], v[240:243]
    ds_read_b128 v[44:47], v18 offset:56320
    s_waitcnt lgkmcnt(5)
    v_mfma_f32_16x16x32_bf16 v[244:247], v[108:111], v[48:51], v[244:247]
    v_mfma_f32_16x16x32_bf16 v[248:251], v[112:115], v[48:51], v[248:251]
    ds_read_b128 v[48:51], v18 offset:56576
    s_waitcnt lgkmcnt(3)
    v_mfma_f32_16x16x32_bf16 v[204:207], v[116:119], v[28:31], v[204:207]
    s_barrier
    ds_read_b64_tr_b16 v[76:77], v24 offset:16384
    v_mfma_f32_16x16x32_bf16 v[208:211], v[120:123], v[28:31], v[208:211]
    ds_read_b128 v[28:31], v18 offset:0
    v_mfma_f32_16x16x32_bf16 v[212:215], v[116:119], v[32:35], v[212:215]
    ds_read_b64_tr_b16 v[78:79], v24 offset:20480
    v_mfma_f32_16x16x32_bf16 v[216:219], v[120:123], v[32:35], v[216:219]
    ds_read_b128 v[32:35], v18 offset:256
    v_mfma_f32_16x16x32_bf16 v[220:223], v[116:119], v[36:39], v[220:223]
    ds_read_b64_tr_b16 v[80:81], v25 offset:16384
    v_mfma_f32_16x16x32_bf16 v[224:227], v[120:123], v[36:39], v[224:227]
    ds_read_b128 v[36:39], v18 offset:512
    s_waitcnt lgkmcnt(8)
    v_mfma_f32_16x16x32_bf16 v[228:231], v[116:119], v[40:43], v[228:231]
    ds_read_b64_tr_b16 v[82:83], v25 offset:20480
    v_mfma_f32_16x16x32_bf16 v[232:235], v[120:123], v[40:43], v[232:235]
    ds_read_b128 v[40:43], v18 offset:768
    s_waitcnt lgkmcnt(9)
    v_mfma_f32_16x16x32_bf16 v[236:239], v[116:119], v[44:47], v[236:239]
    v_mfma_f32_16x16x32_bf16 v[240:243], v[120:123], v[44:47], v[240:243]
    ds_read_b128 v[44:47], v18 offset:1024
    s_waitcnt lgkmcnt(9)
    v_mfma_f32_16x16x32_bf16 v[244:247], v[116:119], v[48:51], v[244:247]
    v_mfma_f32_16x16x32_bf16 v[248:251], v[120:123], v[48:51], v[248:251]
    ds_read_b128 v[48:51], v18 offset:1280
    s_waitcnt lgkmcnt(3)
    v_mfma_f32_16x16x32_bf16 v[204:207], v[76:79], v[28:31], v[204:207]
    ds_read_b64_tr_b16 v[84:85], v24 offset:24576
    v_mfma_f32_16x16x32_bf16 v[208:211], v[80:83], v[28:31], v[208:211]
    ds_read_b128 v[28:31], v18 offset:6144
    v_mfma_f32_16x16x32_bf16 v[212:215], v[76:79], v[32:35], v[212:215]
    ds_read_b64_tr_b16 v[86:87], v24 offset:28672
    v_mfma_f32_16x16x32_bf16 v[216:219], v[80:83], v[32:35], v[216:219]
    ds_read_b128 v[32:35], v18 offset:6400
    v_mfma_f32_16x16x32_bf16 v[220:223], v[76:79], v[36:39], v[220:223]
    ds_read_b64_tr_b16 v[88:89], v25 offset:24576
    v_mfma_f32_16x16x32_bf16 v[224:227], v[80:83], v[36:39], v[224:227]
    ds_read_b128 v[36:39], v18 offset:6656
    s_waitcnt lgkmcnt(8)
    v_mfma_f32_16x16x32_bf16 v[228:231], v[76:79], v[40:43], v[228:231]
    ds_read_b64_tr_b16 v[90:91], v25 offset:28672
    v_mfma_f32_16x16x32_bf16 v[232:235], v[80:83], v[40:43], v[232:235]
    ds_read_b128 v[40:43], v18 offset:6912
    s_waitcnt lgkmcnt(9)
    v_mfma_f32_16x16x32_bf16 v[236:239], v[76:79], v[44:47], v[236:239]
    v_mfma_f32_16x16x32_bf16 v[240:243], v[80:83], v[44:47], v[240:243]
    ds_read_b128 v[44:47], v18 offset:7168
    s_waitcnt lgkmcnt(9)
    v_mfma_f32_16x16x32_bf16 v[244:247], v[76:79], v[48:51], v[244:247]
    v_mfma_f32_16x16x32_bf16 v[248:251], v[80:83], v[48:51], v[248:251]
    ds_read_b128 v[48:51], v18 offset:7424
    s_waitcnt lgkmcnt(3)
    v_mfma_f32_16x16x32_bf16 v[204:207], v[84:87], v[28:31], v[204:207]
    s_barrier
    ds_read_b64_tr_b16 v[76:77], v24 offset:32768
    v_mfma_f32_16x16x32_bf16 v[208:211], v[88:91], v[28:31], v[208:211]
    ds_read_b128 v[28:31], v18 offset:12288
    v_mfma_f32_16x16x32_bf16 v[212:215], v[84:87], v[32:35], v[212:215]
    ds_read_b64_tr_b16 v[78:79], v24 offset:36864
    v_mfma_f32_16x16x32_bf16 v[216:219], v[88:91], v[32:35], v[216:219]
    ds_read_b128 v[32:35], v18 offset:12544
    v_mfma_f32_16x16x32_bf16 v[220:223], v[84:87], v[36:39], v[220:223]
    ds_read_b64_tr_b16 v[80:81], v25 offset:32768
    v_mfma_f32_16x16x32_bf16 v[224:227], v[88:91], v[36:39], v[224:227]
    ds_read_b128 v[36:39], v18 offset:12800
    s_waitcnt lgkmcnt(8)
    v_mfma_f32_16x16x32_bf16 v[228:231], v[84:87], v[40:43], v[228:231]
    ds_read_b64_tr_b16 v[82:83], v25 offset:36864
    v_mfma_f32_16x16x32_bf16 v[232:235], v[88:91], v[40:43], v[232:235]
    ds_read_b128 v[40:43], v18 offset:13056
    s_waitcnt lgkmcnt(9)
    v_mfma_f32_16x16x32_bf16 v[236:239], v[84:87], v[44:47], v[236:239]
    v_mfma_f32_16x16x32_bf16 v[240:243], v[88:91], v[44:47], v[240:243]
    ds_read_b128 v[44:47], v18 offset:13312
    s_waitcnt lgkmcnt(9)
    v_mfma_f32_16x16x32_bf16 v[244:247], v[84:87], v[48:51], v[244:247]
    v_mfma_f32_16x16x32_bf16 v[248:251], v[88:91], v[48:51], v[248:251]
    ds_read_b128 v[48:51], v18 offset:13568
    s_waitcnt lgkmcnt(3)
    v_mfma_f32_16x16x32_bf16 v[204:207], v[76:79], v[28:31], v[204:207]
    ds_read_b64_tr_b16 v[84:85], v24 offset:40960
    v_mfma_f32_16x16x32_bf16 v[208:211], v[80:83], v[28:31], v[208:211]
    ds_read_b128 v[28:31], v18 offset:18432
    v_mfma_f32_16x16x32_bf16 v[212:215], v[76:79], v[32:35], v[212:215]
    ds_read_b64_tr_b16 v[86:87], v24 offset:45056
    v_mfma_f32_16x16x32_bf16 v[216:219], v[80:83], v[32:35], v[216:219]
    ds_read_b128 v[32:35], v18 offset:18688
    v_mfma_f32_16x16x32_bf16 v[220:223], v[76:79], v[36:39], v[220:223]
    ds_read_b64_tr_b16 v[88:89], v25 offset:40960
    v_mfma_f32_16x16x32_bf16 v[224:227], v[80:83], v[36:39], v[224:227]
    ds_read_b128 v[36:39], v18 offset:18944
    s_waitcnt lgkmcnt(8)
    v_mfma_f32_16x16x32_bf16 v[228:231], v[76:79], v[40:43], v[228:231]
    ds_read_b64_tr_b16 v[90:91], v25 offset:45056
    v_mfma_f32_16x16x32_bf16 v[232:235], v[80:83], v[40:43], v[232:235]
    ds_read_b128 v[40:43], v18 offset:19200
    s_waitcnt lgkmcnt(9)
    v_mfma_f32_16x16x32_bf16 v[236:239], v[76:79], v[44:47], v[236:239]
    v_mfma_f32_16x16x32_bf16 v[240:243], v[80:83], v[44:47], v[240:243]
    ds_read_b128 v[44:47], v18 offset:19456
    s_waitcnt lgkmcnt(9)
    v_mfma_f32_16x16x32_bf16 v[244:247], v[76:79], v[48:51], v[244:247]
    v_mfma_f32_16x16x32_bf16 v[248:251], v[80:83], v[48:51], v[248:251]
    ds_read_b128 v[48:51], v18 offset:19712
    s_waitcnt lgkmcnt(3)
    v_mfma_f32_16x16x32_bf16 v[204:207], v[84:87], v[28:31], v[204:207]
    s_barrier
    v_mfma_f32_16x16x32_bf16 v[208:211], v[88:91], v[28:31], v[208:211]
    ds_read_b128 v[28:31], v18 offset:24576
    v_mfma_f32_16x16x32_bf16 v[212:215], v[84:87], v[32:35], v[212:215]
    v_mfma_f32_16x16x32_bf16 v[216:219], v[88:91], v[32:35], v[216:219]
    ds_read_b128 v[32:35], v18 offset:24832
    v_mfma_f32_16x16x32_bf16 v[220:223], v[84:87], v[36:39], v[220:223]
    v_mfma_f32_16x16x32_bf16 v[224:227], v[88:91], v[36:39], v[224:227]
    ds_read_b128 v[36:39], v18 offset:25088
    s_waitcnt lgkmcnt(5)
    v_mfma_f32_16x16x32_bf16 v[228:231], v[84:87], v[40:43], v[228:231]
    v_mfma_f32_16x16x32_bf16 v[232:235], v[88:91], v[40:43], v[232:235]
    ds_read_b128 v[40:43], v18 offset:25344
    s_waitcnt lgkmcnt(5)
    v_mfma_f32_16x16x32_bf16 v[236:239], v[84:87], v[44:47], v[236:239]
    v_mfma_f32_16x16x32_bf16 v[240:243], v[88:91], v[44:47], v[240:243]
    ds_read_b128 v[44:47], v18 offset:25600
    s_waitcnt lgkmcnt(5)
    v_mfma_f32_16x16x32_bf16 v[244:247], v[84:87], v[48:51], v[244:247]
    v_mfma_f32_16x16x32_bf16 v[248:251], v[88:91], v[48:51], v[248:251]
    ds_read_b128 v[48:51], v18 offset:25856
    s_waitcnt lgkmcnt(3)
    v_mfma_f32_16x16x32_bf16 v[204:207], v[124:127], v[28:31], v[204:207]
    v_mfma_f32_16x16x32_bf16 v[208:211], v[128:131], v[28:31], v[208:211]
    ds_read_b128 v[28:31], v18 offset:30720
    v_mfma_f32_16x16x32_bf16 v[212:215], v[124:127], v[32:35], v[212:215]
    v_mfma_f32_16x16x32_bf16 v[216:219], v[128:131], v[32:35], v[216:219]
    ds_read_b128 v[32:35], v18 offset:30976
    v_mfma_f32_16x16x32_bf16 v[220:223], v[124:127], v[36:39], v[220:223]
    v_mfma_f32_16x16x32_bf16 v[224:227], v[128:131], v[36:39], v[224:227]
    ds_read_b128 v[36:39], v18 offset:31232
    s_waitcnt lgkmcnt(5)
    v_mfma_f32_16x16x32_bf16 v[228:231], v[124:127], v[40:43], v[228:231]
    v_mfma_f32_16x16x32_bf16 v[232:235], v[128:131], v[40:43], v[232:235]
    ds_read_b128 v[40:43], v18 offset:31488
    s_waitcnt lgkmcnt(5)
    v_mfma_f32_16x16x32_bf16 v[236:239], v[124:127], v[44:47], v[236:239]
    v_mfma_f32_16x16x32_bf16 v[240:243], v[128:131], v[44:47], v[240:243]
    ds_read_b128 v[44:47], v18 offset:31744
    s_waitcnt lgkmcnt(5)
    v_mfma_f32_16x16x32_bf16 v[244:247], v[124:127], v[48:51], v[244:247]
    v_mfma_f32_16x16x32_bf16 v[248:251], v[128:131], v[48:51], v[248:251]
    ds_read_b128 v[48:51], v18 offset:32000
    s_waitcnt lgkmcnt(3)
    v_mfma_f32_16x16x32_bf16 v[204:207], v[132:135], v[28:31], v[204:207]
    s_barrier
    ds_read_b64_tr_b16 v[76:77], v20 offset:0
    v_mfma_f32_16x16x32_bf16 v[208:211], v[136:139], v[28:31], v[208:211]
    ds_read_b128 v[28:31], v18 offset:36864
    v_mfma_f32_16x16x32_bf16 v[212:215], v[132:135], v[32:35], v[212:215]
    ds_read_b64_tr_b16 v[78:79], v20 offset:4096
    v_mfma_f32_16x16x32_bf16 v[216:219], v[136:139], v[32:35], v[216:219]
    ds_read_b128 v[32:35], v18 offset:37120
    v_mfma_f32_16x16x32_bf16 v[220:223], v[132:135], v[36:39], v[220:223]
    ds_read_b64_tr_b16 v[80:81], v21 offset:0
    v_mfma_f32_16x16x32_bf16 v[224:227], v[136:139], v[36:39], v[224:227]
    ds_read_b128 v[36:39], v18 offset:37376
    s_waitcnt lgkmcnt(8)
    v_mfma_f32_16x16x32_bf16 v[228:231], v[132:135], v[40:43], v[228:231]
    ds_read_b64_tr_b16 v[82:83], v21 offset:4096
    v_mfma_f32_16x16x32_bf16 v[232:235], v[136:139], v[40:43], v[232:235]
    ds_read_b128 v[40:43], v18 offset:37632
    s_waitcnt lgkmcnt(9)
    v_mfma_f32_16x16x32_bf16 v[236:239], v[132:135], v[44:47], v[236:239]
    v_mfma_f32_16x16x32_bf16 v[240:243], v[136:139], v[44:47], v[240:243]
    ds_read_b128 v[44:47], v18 offset:37888
    s_waitcnt lgkmcnt(9)
    v_mfma_f32_16x16x32_bf16 v[244:247], v[132:135], v[48:51], v[244:247]
    v_mfma_f32_16x16x32_bf16 v[248:251], v[136:139], v[48:51], v[248:251]
    ds_read_b128 v[48:51], v18 offset:38144
    s_waitcnt lgkmcnt(3)
    v_mfma_f32_16x16x32_bf16 v[204:207], v[76:79], v[28:31], v[204:207]
    ds_read_b64_tr_b16 v[84:85], v20 offset:8192
    v_mfma_f32_16x16x32_bf16 v[208:211], v[80:83], v[28:31], v[208:211]
    ds_read_b128 v[28:31], v18 offset:43008
    v_mfma_f32_16x16x32_bf16 v[212:215], v[76:79], v[32:35], v[212:215]
    ds_read_b64_tr_b16 v[86:87], v20 offset:12288
    v_mfma_f32_16x16x32_bf16 v[216:219], v[80:83], v[32:35], v[216:219]
    ds_read_b128 v[32:35], v18 offset:43264
    s_branch L_skip_4
    s_nop 0
L_stub_4:
    s_branch L_stub_5
L_skip_4:
    v_mfma_f32_16x16x32_bf16 v[220:223], v[76:79], v[36:39], v[220:223]
    ds_read_b64_tr_b16 v[88:89], v21 offset:8192
    v_mfma_f32_16x16x32_bf16 v[224:227], v[80:83], v[36:39], v[224:227]
    ds_read_b128 v[36:39], v18 offset:43520
    s_waitcnt lgkmcnt(8)
    v_mfma_f32_16x16x32_bf16 v[228:231], v[76:79], v[40:43], v[228:231]
    ds_read_b64_tr_b16 v[90:91], v21 offset:12288
    v_mfma_f32_16x16x32_bf16 v[232:235], v[80:83], v[40:43], v[232:235]
    ds_read_b128 v[40:43], v18 offset:43776
    s_waitcnt lgkmcnt(9)
    v_mfma_f32_16x16x32_bf16 v[236:239], v[76:79], v[44:47], v[236:239]
    v_mfma_f32_16x16x32_bf16 v[240:243], v[80:83], v[44:47], v[240:243]
    ds_read_b128 v[44:47], v18 offset:44032
    s_waitcnt lgkmcnt(9)
    v_mfma_f32_16x16x32_bf16 v[244:247], v[76:79], v[48:51], v[244:247]
    v_mfma_f32_16x16x32_bf16 v[248:251], v[80:83], v[48:51], v[248:251]
    ds_read_b128 v[48:51], v18 offset:44288
    s_waitcnt lgkmcnt(3)
    v_mfma_f32_16x16x32_bf16 v[204:207], v[84:87], v[28:31], v[204:207]
    s_barrier
    ds_read_b64_tr_b16 v[76:77], v20 offset:16384
    v_mfma_f32_16x16x32_bf16 v[208:211], v[88:91], v[28:31], v[208:211]
    ds_read_b128 v[28:31], v18 offset:49152
    v_mfma_f32_16x16x32_bf16 v[212:215], v[84:87], v[32:35], v[212:215]
    ds_read_b64_tr_b16 v[78:79], v20 offset:20480
    v_mfma_f32_16x16x32_bf16 v[216:219], v[88:91], v[32:35], v[216:219]
    ds_read_b128 v[32:35], v18 offset:49408
    v_mfma_f32_16x16x32_bf16 v[220:223], v[84:87], v[36:39], v[220:223]
    ds_read_b64_tr_b16 v[80:81], v21 offset:16384
    v_mfma_f32_16x16x32_bf16 v[224:227], v[88:91], v[36:39], v[224:227]
    ds_read_b128 v[36:39], v18 offset:49664
    s_waitcnt lgkmcnt(8)
    v_mfma_f32_16x16x32_bf16 v[228:231], v[84:87], v[40:43], v[228:231]
    ds_read_b64_tr_b16 v[82:83], v21 offset:20480
    v_mfma_f32_16x16x32_bf16 v[232:235], v[88:91], v[40:43], v[232:235]
    ds_read_b128 v[40:43], v18 offset:49920
    s_waitcnt lgkmcnt(9)
    v_mfma_f32_16x16x32_bf16 v[236:239], v[84:87], v[44:47], v[236:239]
    v_mfma_f32_16x16x32_bf16 v[240:243], v[88:91], v[44:47], v[240:243]
    ds_read_b128 v[44:47], v18 offset:50176
    s_waitcnt lgkmcnt(9)
    v_mfma_f32_16x16x32_bf16 v[244:247], v[84:87], v[48:51], v[244:247]
    v_mfma_f32_16x16x32_bf16 v[248:251], v[88:91], v[48:51], v[248:251]
    ds_read_b128 v[48:51], v18 offset:50432
    s_waitcnt lgkmcnt(3)
    v_mfma_f32_16x16x32_bf16 v[204:207], v[76:79], v[28:31], v[204:207]
    ds_read_b64_tr_b16 v[84:85], v20 offset:24576
    v_mfma_f32_16x16x32_bf16 v[208:211], v[80:83], v[28:31], v[208:211]
    ds_read_b128 v[28:31], v18 offset:55296
    v_mfma_f32_16x16x32_bf16 v[212:215], v[76:79], v[32:35], v[212:215]
    ds_read_b64_tr_b16 v[86:87], v20 offset:28672
    v_mfma_f32_16x16x32_bf16 v[216:219], v[80:83], v[32:35], v[216:219]
    ds_read_b128 v[32:35], v18 offset:55552
    v_mfma_f32_16x16x32_bf16 v[220:223], v[76:79], v[36:39], v[220:223]
    ds_read_b64_tr_b16 v[88:89], v21 offset:24576
    v_mfma_f32_16x16x32_bf16 v[224:227], v[80:83], v[36:39], v[224:227]
    ds_read_b128 v[36:39], v18 offset:55808
    s_waitcnt lgkmcnt(8)
    v_mfma_f32_16x16x32_bf16 v[228:231], v[76:79], v[40:43], v[228:231]
    ds_read_b64_tr_b16 v[90:91], v21 offset:28672
    v_mfma_f32_16x16x32_bf16 v[232:235], v[80:83], v[40:43], v[232:235]
    ds_read_b128 v[40:43], v18 offset:56064
    s_waitcnt lgkmcnt(9)
    v_mfma_f32_16x16x32_bf16 v[236:239], v[76:79], v[44:47], v[236:239]
    v_mfma_f32_16x16x32_bf16 v[240:243], v[80:83], v[44:47], v[240:243]
    ds_read_b128 v[44:47], v18 offset:56320
    s_waitcnt lgkmcnt(9)
    v_mfma_f32_16x16x32_bf16 v[244:247], v[76:79], v[48:51], v[244:247]
    v_mfma_f32_16x16x32_bf16 v[248:251], v[80:83], v[48:51], v[248:251]
    ds_read_b128 v[48:51], v18 offset:56576
    s_waitcnt lgkmcnt(3)
    v_mfma_f32_16x16x32_bf16 v[204:207], v[84:87], v[28:31], v[204:207]
    s_barrier
    v_mfma_f32_16x16x32_bf16 v[208:211], v[88:91], v[28:31], v[208:211]
    ds_read_b128 v[28:31], v18 offset:0
    v_mfma_f32_16x16x32_bf16 v[212:215], v[84:87], v[32:35], v[212:215]
    v_mfma_f32_16x16x32_bf16 v[216:219], v[88:91], v[32:35], v[216:219]
    ds_read_b128 v[32:35], v18 offset:256
    v_mfma_f32_16x16x32_bf16 v[220:223], v[84:87], v[36:39], v[220:223]
    v_mfma_f32_16x16x32_bf16 v[224:227], v[88:91], v[36:39], v[224:227]
    ds_read_b128 v[36:39], v18 offset:512
    s_waitcnt lgkmcnt(5)
    v_mfma_f32_16x16x32_bf16 v[228:231], v[84:87], v[40:43], v[228:231]
    v_mfma_f32_16x16x32_bf16 v[232:235], v[88:91], v[40:43], v[232:235]
    ds_read_b128 v[40:43], v18 offset:768
    s_waitcnt lgkmcnt(5)
    v_mfma_f32_16x16x32_bf16 v[236:239], v[84:87], v[44:47], v[236:239]
    v_mfma_f32_16x16x32_bf16 v[240:243], v[88:91], v[44:47], v[240:243]
    ds_read_b128 v[44:47], v18 offset:1024
    s_waitcnt lgkmcnt(5)
    v_mfma_f32_16x16x32_bf16 v[244:247], v[84:87], v[48:51], v[244:247]
    v_mfma_f32_16x16x32_bf16 v[248:251], v[88:91], v[48:51], v[248:251]
    ds_read_b128 v[48:51], v18 offset:1280
    s_waitcnt lgkmcnt(3)
    v_mfma_f32_16x16x32_bf16 v[204:207], v[140:143], v[28:31], v[204:207]
    v_mfma_f32_16x16x32_bf16 v[208:211], v[144:147], v[28:31], v[208:211]
    ds_read_b128 v[28:31], v18 offset:6144
    v_mfma_f32_16x16x32_bf16 v[212:215], v[140:143], v[32:35], v[212:215]
    v_mfma_f32_16x16x32_bf16 v[216:219], v[144:147], v[32:35], v[216:219]
    ds_read_b128 v[32:35], v18 offset:6400
    v_mfma_f32_16x16x32_bf16 v[220:223], v[140:143], v[36:39], v[220:223]
    v_mfma_f32_16x16x32_bf16 v[224:227], v[144:147], v[36:39], v[224:227]
    ds_read_b128 v[36:39], v18 offset:6656
    s_waitcnt lgkmcnt(5)
    v_mfma_f32_16x16x32_bf16 v[228:231], v[140:143], v[40:43], v[228:231]
    v_mfma_f32_16x16x32_bf16 v[232:235], v[144:147], v[40:43], v[232:235]
    ds_read_b128 v[40:43], v18 offset:6912
    s_waitcnt lgkmcnt(5)
    v_mfma_f32_16x16x32_bf16 v[236:239], v[140:143], v[44:47], v[236:239]
    v_mfma_f32_16x16x32_bf16 v[240:243], v[144:147], v[44:47], v[240:243]
    ds_read_b128 v[44:47], v18 offset:7168
    s_waitcnt lgkmcnt(5)
    v_mfma_f32_16x16x32_bf16 v[244:247], v[140:143], v[48:51], v[244:247]
    v_mfma_f32_16x16x32_bf16 v[248:251], v[144:147], v[48:51], v[248:251]
    ds_read_b128 v[48:51], v18 offset:7424
    s_waitcnt lgkmcnt(3)
    v_mfma_f32_16x16x32_bf16 v[204:207], v[148:151], v[28:31], v[204:207]
    s_barrier
    ds_read_b64_tr_b16 v[76:77], v20 offset:32768
    v_mfma_f32_16x16x32_bf16 v[208:211], v[152:155], v[28:31], v[208:211]
    ds_read_b128 v[28:31], v18 offset:12288
    v_mfma_f32_16x16x32_bf16 v[212:215], v[148:151], v[32:35], v[212:215]
    ds_read_b64_tr_b16 v[78:79], v20 offset:36864
    v_mfma_f32_16x16x32_bf16 v[216:219], v[152:155], v[32:35], v[216:219]
    ds_read_b128 v[32:35], v18 offset:12544
    v_mfma_f32_16x16x32_bf16 v[220:223], v[148:151], v[36:39], v[220:223]
    ds_read_b64_tr_b16 v[80:81], v21 offset:32768
    v_mfma_f32_16x16x32_bf16 v[224:227], v[152:155], v[36:39], v[224:227]
    ds_read_b128 v[36:39], v18 offset:12800
    s_waitcnt lgkmcnt(8)
    v_mfma_f32_16x16x32_bf16 v[228:231], v[148:151], v[40:43], v[228:231]
    ds_read_b64_tr_b16 v[82:83], v21 offset:36864
    v_mfma_f32_16x16x32_bf16 v[232:235], v[152:155], v[40:43], v[232:235]
    ds_read_b128 v[40:43], v18 offset:13056
    s_waitcnt lgkmcnt(9)
    v_mfma_f32_16x16x32_bf16 v[236:239], v[148:151], v[44:47], v[236:239]
    v_mfma_f32_16x16x32_bf16 v[240:243], v[152:155], v[44:47], v[240:243]
    ds_read_b128 v[44:47], v18 offset:13312
    s_waitcnt lgkmcnt(9)
    v_mfma_f32_16x16x32_bf16 v[244:247], v[148:151], v[48:51], v[244:247]
    v_mfma_f32_16x16x32_bf16 v[248:251], v[152:155], v[48:51], v[248:251]
    ds_read_b128 v[48:51], v18 offset:13568
    s_waitcnt lgkmcnt(3)
    v_mfma_f32_16x16x32_bf16 v[204:207], v[76:79], v[28:31], v[204:207]
    ds_read_b64_tr_b16 v[84:85], v20 offset:40960
    v_mfma_f32_16x16x32_bf16 v[208:211], v[80:83], v[28:31], v[208:211]
    ds_read_b128 v[28:31], v18 offset:18432
    v_mfma_f32_16x16x32_bf16 v[212:215], v[76:79], v[32:35], v[212:215]
    ds_read_b64_tr_b16 v[86:87], v20 offset:45056
    v_mfma_f32_16x16x32_bf16 v[216:219], v[80:83], v[32:35], v[216:219]
    ds_read_b128 v[32:35], v18 offset:18688
    v_mfma_f32_16x16x32_bf16 v[220:223], v[76:79], v[36:39], v[220:223]
    ds_read_b64_tr_b16 v[88:89], v21 offset:40960
    v_mfma_f32_16x16x32_bf16 v[224:227], v[80:83], v[36:39], v[224:227]
    ds_read_b128 v[36:39], v18 offset:18944
    s_waitcnt lgkmcnt(8)
    v_mfma_f32_16x16x32_bf16 v[228:231], v[76:79], v[40:43], v[228:231]
    ds_read_b64_tr_b16 v[90:91], v21 offset:45056
    v_mfma_f32_16x16x32_bf16 v[232:235], v[80:83], v[40:43], v[232:235]
    ds_read_b128 v[40:43], v18 offset:19200
    s_waitcnt lgkmcnt(9)
    v_mfma_f32_16x16x32_bf16 v[236:239], v[76:79], v[44:47], v[236:239]
    v_mfma_f32_16x16x32_bf16 v[240:243], v[80:83], v[44:47], v[240:243]
    ds_read_b128 v[44:47], v18 offset:19456
    s_waitcnt lgkmcnt(9)
    v_mfma_f32_16x16x32_bf16 v[244:247], v[76:79], v[48:51], v[244:247]
    v_mfma_f32_16x16x32_bf16 v[248:251], v[80:83], v[48:51], v[248:251]
    ds_read_b128 v[48:51], v18 offset:19712
    s_waitcnt lgkmcnt(3)
    v_mfma_f32_16x16x32_bf16 v[204:207], v[84:87], v[28:31], v[204:207]
    s_barrier
    ds_read_b64_tr_b16 v[76:77], v24 offset:0
    v_mfma_f32_16x16x32_bf16 v[208:211], v[88:91], v[28:31], v[208:211]
    ds_read_b128 v[28:31], v18 offset:24576
    v_mfma_f32_16x16x32_bf16 v[212:215], v[84:87], v[32:35], v[212:215]
    ds_read_b64_tr_b16 v[78:79], v24 offset:4096
    v_mfma_f32_16x16x32_bf16 v[216:219], v[88:91], v[32:35], v[216:219]
    ds_read_b128 v[32:35], v18 offset:24832
    v_mfma_f32_16x16x32_bf16 v[220:223], v[84:87], v[36:39], v[220:223]
    ds_read_b64_tr_b16 v[80:81], v25 offset:0
    v_mfma_f32_16x16x32_bf16 v[224:227], v[88:91], v[36:39], v[224:227]
    ds_read_b128 v[36:39], v18 offset:25088
    s_waitcnt lgkmcnt(8)
    v_mfma_f32_16x16x32_bf16 v[228:231], v[84:87], v[40:43], v[228:231]
    ds_read_b64_tr_b16 v[82:83], v25 offset:4096
    v_mfma_f32_16x16x32_bf16 v[232:235], v[88:91], v[40:43], v[232:235]
    ds_read_b128 v[40:43], v18 offset:25344
    s_waitcnt lgkmcnt(9)
    v_mfma_f32_16x16x32_bf16 v[236:239], v[84:87], v[44:47], v[236:239]
    v_mfma_f32_16x16x32_bf16 v[240:243], v[88:91], v[44:47], v[240:243]
    ds_read_b128 v[44:47], v18 offset:25600
    s_waitcnt lgkmcnt(9)
    v_mfma_f32_16x16x32_bf16 v[244:247], v[84:87], v[48:51], v[244:247]
    v_mfma_f32_16x16x32_bf16 v[248:251], v[88:91], v[48:51], v[248:251]
    ds_read_b128 v[48:51], v18 offset:25856
    s_waitcnt lgkmcnt(3)
    v_mfma_f32_16x16x32_bf16 v[204:207], v[76:79], v[28:31], v[204:207]
    ds_read_b64_tr_b16 v[84:85], v24 offset:8192
    v_mfma_f32_16x16x32_bf16 v[208:211], v[80:83], v[28:31], v[208:211]
    ds_read_b128 v[28:31], v18 offset:30720
    v_mfma_f32_16x16x32_bf16 v[212:215], v[76:79], v[32:35], v[212:215]
    ds_read_b64_tr_b16 v[86:87], v24 offset:12288
    v_mfma_f32_16x16x32_bf16 v[216:219], v[80:83], v[32:35], v[216:219]
    ds_read_b128 v[32:35], v18 offset:30976
    v_mfma_f32_16x16x32_bf16 v[220:223], v[76:79], v[36:39], v[220:223]
    ds_read_b64_tr_b16 v[88:89], v25 offset:8192
    v_mfma_f32_16x16x32_bf16 v[224:227], v[80:83], v[36:39], v[224:227]
    ds_read_b128 v[36:39], v18 offset:31232
    s_waitcnt lgkmcnt(8)
    v_mfma_f32_16x16x32_bf16 v[228:231], v[76:79], v[40:43], v[228:231]
    ds_read_b64_tr_b16 v[90:91], v25 offset:12288
    v_mfma_f32_16x16x32_bf16 v[232:235], v[80:83], v[40:43], v[232:235]
    ds_read_b128 v[40:43], v18 offset:31488
    s_waitcnt lgkmcnt(9)
    v_mfma_f32_16x16x32_bf16 v[236:239], v[76:79], v[44:47], v[236:239]
    v_mfma_f32_16x16x32_bf16 v[240:243], v[80:83], v[44:47], v[240:243]
    ds_read_b128 v[44:47], v18 offset:31744
    s_waitcnt lgkmcnt(9)
    v_mfma_f32_16x16x32_bf16 v[244:247], v[76:79], v[48:51], v[244:247]
    v_mfma_f32_16x16x32_bf16 v[248:251], v[80:83], v[48:51], v[248:251]
    ds_read_b128 v[48:51], v18 offset:32000
    s_waitcnt lgkmcnt(3)
    v_mfma_f32_16x16x32_bf16 v[204:207], v[84:87], v[28:31], v[204:207]
    s_barrier
    v_mfma_f32_16x16x32_bf16 v[208:211], v[88:91], v[28:31], v[208:211]
    ds_read_b128 v[28:31], v18 offset:36864
    v_mfma_f32_16x16x32_bf16 v[212:215], v[84:87], v[32:35], v[212:215]
    v_mfma_f32_16x16x32_bf16 v[216:219], v[88:91], v[32:35], v[216:219]
    ds_read_b128 v[32:35], v18 offset:37120
    v_mfma_f32_16x16x32_bf16 v[220:223], v[84:87], v[36:39], v[220:223]
    v_mfma_f32_16x16x32_bf16 v[224:227], v[88:91], v[36:39], v[224:227]
    ds_read_b128 v[36:39], v18 offset:37376
    s_waitcnt lgkmcnt(5)
    v_mfma_f32_16x16x32_bf16 v[228:231], v[84:87], v[40:43], v[228:231]
    v_mfma_f32_16x16x32_bf16 v[232:235], v[88:91], v[40:43], v[232:235]
    ds_read_b128 v[40:43], v18 offset:37632
    s_waitcnt lgkmcnt(5)
    v_mfma_f32_16x16x32_bf16 v[236:239], v[84:87], v[44:47], v[236:239]
    v_mfma_f32_16x16x32_bf16 v[240:243], v[88:91], v[44:47], v[240:243]
    ds_read_b128 v[44:47], v18 offset:37888
    s_waitcnt lgkmcnt(5)
    v_mfma_f32_16x16x32_bf16 v[244:247], v[84:87], v[48:51], v[244:247]
    v_mfma_f32_16x16x32_bf16 v[248:251], v[88:91], v[48:51], v[248:251]
    ds_read_b128 v[48:51], v18 offset:38144
    s_waitcnt lgkmcnt(3)
    v_mfma_f32_16x16x32_bf16 v[204:207], v[156:159], v[28:31], v[204:207]
    v_mfma_f32_16x16x32_bf16 v[208:211], v[160:163], v[28:31], v[208:211]
    ds_read_b128 v[28:31], v18 offset:43008
    v_mfma_f32_16x16x32_bf16 v[212:215], v[156:159], v[32:35], v[212:215]
    v_mfma_f32_16x16x32_bf16 v[216:219], v[160:163], v[32:35], v[216:219]
    ds_read_b128 v[32:35], v18 offset:43264
    v_mfma_f32_16x16x32_bf16 v[220:223], v[156:159], v[36:39], v[220:223]
    v_mfma_f32_16x16x32_bf16 v[224:227], v[160:163], v[36:39], v[224:227]
    ds_read_b128 v[36:39], v18 offset:43520
    s_waitcnt lgkmcnt(5)
    v_mfma_f32_16x16x32_bf16 v[228:231], v[156:159], v[40:43], v[228:231]
    v_mfma_f32_16x16x32_bf16 v[232:235], v[160:163], v[40:43], v[232:235]
    ds_read_b128 v[40:43], v18 offset:43776
    s_waitcnt lgkmcnt(5)
    v_mfma_f32_16x16x32_bf16 v[236:239], v[156:159], v[44:47], v[236:239]
    v_mfma_f32_16x16x32_bf16 v[240:243], v[160:163], v[44:47], v[240:243]
    ds_read_b128 v[44:47], v18 offset:44032
    s_waitcnt lgkmcnt(5)
    v_mfma_f32_16x16x32_bf16 v[244:247], v[156:159], v[48:51], v[244:247]
    v_mfma_f32_16x16x32_bf16 v[248:251], v[160:163], v[48:51], v[248:251]
    ds_read_b128 v[48:51], v18 offset:44288
    s_waitcnt lgkmcnt(3)
    v_mfma_f32_16x16x32_bf16 v[204:207], v[164:167], v[28:31], v[204:207]
    s_barrier
    ds_read_b64_tr_b16 v[76:77], v24 offset:16384
    v_mfma_f32_16x16x32_bf16 v[208:211], v[168:171], v[28:31], v[208:211]
    ds_read_b128 v[28:31], v18 offset:49152
    v_mfma_f32_16x16x32_bf16 v[212:215], v[164:167], v[32:35], v[212:215]
    ds_read_b64_tr_b16 v[78:79], v24 offset:20480
    v_mfma_f32_16x16x32_bf16 v[216:219], v[168:171], v[32:35], v[216:219]
    ds_read_b128 v[32:35], v18 offset:49408
    v_mfma_f32_16x16x32_bf16 v[220:223], v[164:167], v[36:39], v[220:223]
    ds_read_b64_tr_b16 v[80:81], v25 offset:16384
    v_mfma_f32_16x16x32_bf16 v[224:227], v[168:171], v[36:39], v[224:227]
    ds_read_b128 v[36:39], v18 offset:49664
    s_waitcnt lgkmcnt(8)
    v_mfma_f32_16x16x32_bf16 v[228:231], v[164:167], v[40:43], v[228:231]
    ds_read_b64_tr_b16 v[82:83], v25 offset:20480
    v_mfma_f32_16x16x32_bf16 v[232:235], v[168:171], v[40:43], v[232:235]
    ds_read_b128 v[40:43], v18 offset:49920
    s_waitcnt lgkmcnt(9)
    v_mfma_f32_16x16x32_bf16 v[236:239], v[164:167], v[44:47], v[236:239]
    v_mfma_f32_16x16x32_bf16 v[240:243], v[168:171], v[44:47], v[240:243]
    ds_read_b128 v[44:47], v18 offset:50176
    s_waitcnt lgkmcnt(9)
    v_mfma_f32_16x16x32_bf16 v[244:247], v[164:167], v[48:51], v[244:247]
    v_mfma_f32_16x16x32_bf16 v[248:251], v[168:171], v[48:51], v[248:251]
    ds_read_b128 v[48:51], v18 offset:50432
    s_waitcnt lgkmcnt(3)
    v_mfma_f32_16x16x32_bf16 v[204:207], v[76:79], v[28:31], v[204:207]
    ds_read_b64_tr_b16 v[84:85], v24 offset:24576
    v_mfma_f32_16x16x32_bf16 v[208:211], v[80:83], v[28:31], v[208:211]
    ds_read_b128 v[28:31], v18 offset:55296
    v_mfma_f32_16x16x32_bf16 v[212:215], v[76:79], v[32:35], v[212:215]
    ds_read_b64_tr_b16 v[86:87], v24 offset:28672
    v_mfma_f32_16x16x32_bf16 v[216:219], v[80:83], v[32:35], v[216:219]
    ds_read_b128 v[32:35], v18 offset:55552
    v_mfma_f32_16x16x32_bf16 v[220:223], v[76:79], v[36:39], v[220:223]
    ds_read_b64_tr_b16 v[88:89], v25 offset:24576
    v_mfma_f32_16x16x32_bf16 v[224:227], v[80:83], v[36:39], v[224:227]
    ds_read_b128 v[36:39], v18 offset:55808
    s_waitcnt lgkmcnt(8)
    v_mfma_f32_16x16x32_bf16 v[228:231], v[76:79], v[40:43], v[228:231]
    ds_read_b64_tr_b16 v[90:91], v25 offset:28672
    v_mfma_f32_16x16x32_bf16 v[232:235], v[80:83], v[40:43], v[232:235]
    ds_read_b128 v[40:43], v18 offset:56064
    s_waitcnt lgkmcnt(9)
    v_mfma_f32_16x16x32_bf16 v[236:239], v[76:79], v[44:47], v[236:239]
    v_mfma_f32_16x16x32_bf16 v[240:243], v[80:83], v[44:47], v[240:243]
    ds_read_b128 v[44:47], v18 offset:56320
    s_waitcnt lgkmcnt(9)
    v_mfma_f32_16x16x32_bf16 v[244:247], v[76:79], v[48:51], v[244:247]
    v_mfma_f32_16x16x32_bf16 v[248:251], v[80:83], v[48:51], v[248:251]
    ds_read_b128 v[48:51], v18 offset:56576
    s_waitcnt lgkmcnt(3)
    v_mfma_f32_16x16x32_bf16 v[204:207], v[84:87], v[28:31], v[204:207]
    s_barrier
    ds_read_b64_tr_b16 v[76:77], v24 offset:32768
    v_mfma_f32_16x16x32_bf16 v[208:211], v[88:91], v[28:31], v[208:211]
    ds_read_b128 v[28:31], v18 offset:0
    v_mfma_f32_16x16x32_bf16 v[212:215], v[84:87], v[32:35], v[212:215]
    ds_read_b64_tr_b16 v[78:79], v24 offset:36864
    v_mfma_f32_16x16x32_bf16 v[216:219], v[88:91], v[32:35], v[216:219]
    ds_read_b128 v[32:35], v18 offset:256
    v_mfma_f32_16x16x32_bf16 v[220:223], v[84:87], v[36:39], v[220:223]
    ds_read_b64_tr_b16 v[80:81], v25 offset:32768
    v_mfma_f32_16x16x32_bf16 v[224:227], v[88:91], v[36:39], v[224:227]
    ds_read_b128 v[36:39], v18 offset:512
    s_waitcnt lgkmcnt(8)
    v_mfma_f32_16x16x32_bf16 v[228:231], v[84:87], v[40:43], v[228:231]
    ds_read_b64_tr_b16 v[82:83], v25 offset:36864
    v_mfma_f32_16x16x32_bf16 v[232:235], v[88:91], v[40:43], v[232:235]
    ds_read_b128 v[40:43], v18 offset:768
    s_waitcnt lgkmcnt(9)
    v_mfma_f32_16x16x32_bf16 v[236:239], v[84:87], v[44:47], v[236:239]
    v_mfma_f32_16x16x32_bf16 v[240:243], v[88:91], v[44:47], v[240:243]
    ds_read_b128 v[44:47], v18 offset:1024
    s_waitcnt lgkmcnt(9)
    v_mfma_f32_16x16x32_bf16 v[244:247], v[84:87], v[48:51], v[244:247]
    v_mfma_f32_16x16x32_bf16 v[248:251], v[88:91], v[48:51], v[248:251]
    ds_read_b128 v[48:51], v18 offset:1280
    s_waitcnt lgkmcnt(3)
    v_mfma_f32_16x16x32_bf16 v[204:207], v[76:79], v[28:31], v[204:207]
    ds_read_b64_tr_b16 v[84:85], v24 offset:40960
    v_mfma_f32_16x16x32_bf16 v[208:211], v[80:83], v[28:31], v[208:211]
    ds_read_b128 v[28:31], v18 offset:6144
    v_mfma_f32_16x16x32_bf16 v[212:215], v[76:79], v[32:35], v[212:215]
    ds_read_b64_tr_b16 v[86:87], v24 offset:45056
    v_mfma_f32_16x16x32_bf16 v[216:219], v[80:83], v[32:35], v[216:219]
    ds_read_b128 v[32:35], v18 offset:6400
    v_mfma_f32_16x16x32_bf16 v[220:223], v[76:79], v[36:39], v[220:223]
    ds_read_b64_tr_b16 v[88:89], v25 offset:40960
    v_mfma_f32_16x16x32_bf16 v[224:227], v[80:83], v[36:39], v[224:227]
    ds_read_b128 v[36:39], v18 offset:6656
    s_waitcnt lgkmcnt(8)
    v_mfma_f32_16x16x32_bf16 v[228:231], v[76:79], v[40:43], v[228:231]
    ds_read_b64_tr_b16 v[90:91], v25 offset:45056
    v_mfma_f32_16x16x32_bf16 v[232:235], v[80:83], v[40:43], v[232:235]
    ds_read_b128 v[40:43], v18 offset:6912
    s_waitcnt lgkmcnt(9)
    v_mfma_f32_16x16x32_bf16 v[236:239], v[76:79], v[44:47], v[236:239]
    v_mfma_f32_16x16x32_bf16 v[240:243], v[80:83], v[44:47], v[240:243]
    ds_read_b128 v[44:47], v18 offset:7168
    s_waitcnt lgkmcnt(9)
    v_mfma_f32_16x16x32_bf16 v[244:247], v[76:79], v[48:51], v[244:247]
    v_mfma_f32_16x16x32_bf16 v[248:251], v[80:83], v[48:51], v[248:251]
    ds_read_b128 v[48:51], v18 offset:7424
    s_waitcnt lgkmcnt(3)
    v_mfma_f32_16x16x32_bf16 v[204:207], v[84:87], v[28:31], v[204:207]
    s_barrier
    v_mfma_f32_16x16x32_bf16 v[208:211], v[88:91], v[28:31], v[208:211]
    ds_read_b128 v[28:31], v18 offset:12288
    v_mfma_f32_16x16x32_bf16 v[212:215], v[84:87], v[32:35], v[212:215]
    v_mfma_f32_16x16x32_bf16 v[216:219], v[88:91], v[32:35], v[216:219]
    ds_read_b128 v[32:35], v18 offset:12544
    v_mfma_f32_16x16x32_bf16 v[220:223], v[84:87], v[36:39], v[220:223]
    v_mfma_f32_16x16x32_bf16 v[224:227], v[88:91], v[36:39], v[224:227]
    ds_read_b128 v[36:39], v18 offset:12800
    s_waitcnt lgkmcnt(5)
    v_mfma_f32_16x16x32_bf16 v[228:231], v[84:87], v[40:43], v[228:231]
    v_mfma_f32_16x16x32_bf16 v[232:235], v[88:91], v[40:43], v[232:235]
    ds_read_b128 v[40:43], v18 offset:13056
    s_waitcnt lgkmcnt(5)
    v_mfma_f32_16x16x32_bf16 v[236:239], v[84:87], v[44:47], v[236:239]
    v_mfma_f32_16x16x32_bf16 v[240:243], v[88:91], v[44:47], v[240:243]
    ds_read_b128 v[44:47], v18 offset:13312
    s_waitcnt lgkmcnt(5)
    v_mfma_f32_16x16x32_bf16 v[244:247], v[84:87], v[48:51], v[244:247]
    v_mfma_f32_16x16x32_bf16 v[248:251], v[88:91], v[48:51], v[248:251]
    ds_read_b128 v[48:51], v18 offset:13568
    s_waitcnt lgkmcnt(3)
    v_mfma_f32_16x16x32_bf16 v[204:207], v[172:175], v[28:31], v[204:207]
    v_mfma_f32_16x16x32_bf16 v[208:211], v[176:179], v[28:31], v[208:211]
    ds_read_b128 v[28:31], v18 offset:18432
    v_mfma_f32_16x16x32_bf16 v[212:215], v[172:175], v[32:35], v[212:215]
    v_mfma_f32_16x16x32_bf16 v[216:219], v[176:179], v[32:35], v[216:219]
    ds_read_b128 v[32:35], v18 offset:18688
    v_mfma_f32_16x16x32_bf16 v[220:223], v[172:175], v[36:39], v[220:223]
    v_mfma_f32_16x16x32_bf16 v[224:227], v[176:179], v[36:39], v[224:227]
    ds_read_b128 v[36:39], v18 offset:18944
    s_waitcnt lgkmcnt(5)
    v_mfma_f32_16x16x32_bf16 v[228:231], v[172:175], v[40:43], v[228:231]
    v_mfma_f32_16x16x32_bf16 v[232:235], v[176:179], v[40:43], v[232:235]
    ds_read_b128 v[40:43], v18 offset:19200
    s_waitcnt lgkmcnt(5)
    v_mfma_f32_16x16x32_bf16 v[236:239], v[172:175], v[44:47], v[236:239]
    v_mfma_f32_16x16x32_bf16 v[240:243], v[176:179], v[44:47], v[240:243]
    ds_read_b128 v[44:47], v18 offset:19456
    s_waitcnt lgkmcnt(5)
    v_mfma_f32_16x16x32_bf16 v[244:247], v[172:175], v[48:51], v[244:247]
    v_mfma_f32_16x16x32_bf16 v[248:251], v[176:179], v[48:51], v[248:251]
    ds_read_b128 v[48:51], v18 offset:19712
    s_waitcnt lgkmcnt(3)
    v_mfma_f32_16x16x32_bf16 v[204:207], v[180:183], v[28:31], v[204:207]
    s_barrier
    ds_read_b64_tr_b16 v[76:77], v20 offset:0
    v_mfma_f32_16x16x32_bf16 v[208:211], v[184:187], v[28:31], v[208:211]
    ds_read_b128 v[28:31], v18 offset:24576
    v_mfma_f32_16x16x32_bf16 v[212:215], v[180:183], v[32:35], v[212:215]
    ds_read_b64_tr_b16 v[78:79], v20 offset:4096
    v_mfma_f32_16x16x32_bf16 v[216:219], v[184:187], v[32:35], v[216:219]
    ds_read_b128 v[32:35], v18 offset:24832
    v_mfma_f32_16x16x32_bf16 v[220:223], v[180:183], v[36:39], v[220:223]
    ds_read_b64_tr_b16 v[80:81], v21 offset:0
    v_mfma_f32_16x16x32_bf16 v[224:227], v[184:187], v[36:39], v[224:227]
    ds_read_b128 v[36:39], v18 offset:25088
    s_waitcnt lgkmcnt(8)
    v_mfma_f32_16x16x32_bf16 v[228:231], v[180:183], v[40:43], v[228:231]
    ds_read_b64_tr_b16 v[82:83], v21 offset:4096
    v_mfma_f32_16x16x32_bf16 v[232:235], v[184:187], v[40:43], v[232:235]
    ds_read_b128 v[40:43], v18 offset:25344
    s_waitcnt lgkmcnt(9)
    v_mfma_f32_16x16x32_bf16 v[236:239], v[180:183], v[44:47], v[236:239]
    v_mfma_f32_16x16x32_bf16 v[240:243], v[184:187], v[44:47], v[240:243]
    ds_read_b128 v[44:47], v18 offset:25600
    s_waitcnt lgkmcnt(9)
    v_mfma_f32_16x16x32_bf16 v[244:247], v[180:183], v[48:51], v[244:247]
    v_mfma_f32_16x16x32_bf16 v[248:251], v[184:187], v[48:51], v[248:251]
    ds_read_b128 v[48:51], v18 offset:25856
    s_waitcnt lgkmcnt(3)
    v_mfma_f32_16x16x32_bf16 v[204:207], v[76:79], v[28:31], v[204:207]
    ds_read_b64_tr_b16 v[84:85], v20 offset:8192
    v_mfma_f32_16x16x32_bf16 v[208:211], v[80:83], v[28:31], v[208:211]
    ds_read_b128 v[28:31], v18 offset:30720
    v_mfma_f32_16x16x32_bf16 v[212:215], v[76:79], v[32:35], v[212:215]
    ds_read_b64_tr_b16 v[86:87], v20 offset:12288
    v_mfma_f32_16x16x32_bf16 v[216:219], v[80:83], v[32:35], v[216:219]
    ds_read_b128 v[32:35], v18 offset:30976
    v_mfma_f32_16x16x32_bf16 v[220:223], v[76:79], v[36:39], v[220:223]
    ds_read_b64_tr_b16 v[88:89], v21 offset:8192
    v_mfma_f32_16x16x32_bf16 v[224:227], v[80:83], v[36:39], v[224:227]
    ds_read_b128 v[36:39], v18 offset:31232
    s_waitcnt lgkmcnt(8)
    v_mfma_f32_16x16x32_bf16 v[228:231], v[76:79], v[40:43], v[228:231]
    ds_read_b64_tr_b16 v[90:91], v21 offset:12288
    v_mfma_f32_16x16x32_bf16 v[232:235], v[80:83], v[40:43], v[232:235]
    ds_read_b128 v[40:43], v18 offset:31488
    s_waitcnt lgkmcnt(9)
    v_mfma_f32_16x16x32_bf16 v[236:239], v[76:79], v[44:47], v[236:239]
    v_mfma_f32_16x16x32_bf16 v[240:243], v[80:83], v[44:47], v[240:243]
    ds_read_b128 v[44:47], v18 offset:31744
    s_waitcnt lgkmcnt(9)
    v_mfma_f32_16x16x32_bf16 v[244:247], v[76:79], v[48:51], v[244:247]
    v_mfma_f32_16x16x32_bf16 v[248:251], v[80:83], v[48:51], v[248:251]
    ds_read_b128 v[48:51], v18 offset:32000
    s_waitcnt lgkmcnt(3)
    v_mfma_f32_16x16x32_bf16 v[204:207], v[84:87], v[28:31], v[204:207]
    s_barrier
    ds_read_b64_tr_b16 v[76:77], v20 offset:16384
    v_mfma_f32_16x16x32_bf16 v[208:211], v[88:91], v[28:31], v[208:211]
    ds_read_b128 v[28:31], v18 offset:36864
    v_mfma_f32_16x16x32_bf16 v[212:215], v[84:87], v[32:35], v[212:215]
    ds_read_b64_tr_b16 v[78:79], v20 offset:20480
    v_mfma_f32_16x16x32_bf16 v[216:219], v[88:91], v[32:35], v[216:219]
    ds_read_b128 v[32:35], v18 offset:37120
    v_mfma_f32_16x16x32_bf16 v[220:223], v[84:87], v[36:39], v[220:223]
    ds_read_b64_tr_b16 v[80:81], v21 offset:16384
    v_mfma_f32_16x16x32_bf16 v[224:227], v[88:91], v[36:39], v[224:227]
    ds_read_b128 v[36:39], v18 offset:37376
    s_waitcnt lgkmcnt(8)
    v_mfma_f32_16x16x32_bf16 v[228:231], v[84:87], v[40:43], v[228:231]
    ds_read_b64_tr_b16 v[82:83], v21 offset:20480
    v_mfma_f32_16x16x32_bf16 v[232:235], v[88:91], v[40:43], v[232:235]
    ds_read_b128 v[40:43], v18 offset:37632
    s_waitcnt lgkmcnt(9)
    v_mfma_f32_16x16x32_bf16 v[236:239], v[84:87], v[44:47], v[236:239]
    v_mfma_f32_16x16x32_bf16 v[240:243], v[88:91], v[44:47], v[240:243]
    ds_read_b128 v[44:47], v18 offset:37888
    s_waitcnt lgkmcnt(9)
    v_mfma_f32_16x16x32_bf16 v[244:247], v[84:87], v[48:51], v[244:247]
    v_mfma_f32_16x16x32_bf16 v[248:251], v[88:91], v[48:51], v[248:251]
    ds_read_b128 v[48:51], v18 offset:38144
    s_waitcnt lgkmcnt(3)
    v_mfma_f32_16x16x32_bf16 v[204:207], v[76:79], v[28:31], v[204:207]
    ds_read_b64_tr_b16 v[84:85], v20 offset:24576
    v_mfma_f32_16x16x32_bf16 v[208:211], v[80:83], v[28:31], v[208:211]
    ds_read_b128 v[28:31], v18 offset:43008
    v_mfma_f32_16x16x32_bf16 v[212:215], v[76:79], v[32:35], v[212:215]
    ds_read_b64_tr_b16 v[86:87], v20 offset:28672
    v_mfma_f32_16x16x32_bf16 v[216:219], v[80:83], v[32:35], v[216:219]
    ds_read_b128 v[32:35], v18 offset:43264
    v_mfma_f32_16x16x32_bf16 v[220:223], v[76:79], v[36:39], v[220:223]
    ds_read_b64_tr_b16 v[88:89], v21 offset:24576
    v_mfma_f32_16x16x32_bf16 v[224:227], v[80:83], v[36:39], v[224:227]
    ds_read_b128 v[36:39], v18 offset:43520
    s_waitcnt lgkmcnt(8)
    v_mfma_f32_16x16x32_bf16 v[228:231], v[76:79], v[40:43], v[228:231]
    ds_read_b64_tr_b16 v[90:91], v21 offset:28672
    v_mfma_f32_16x16x32_bf16 v[232:235], v[80:83], v[40:43], v[232:235]
    ds_read_b128 v[40:43], v18 offset:43776
    s_waitcnt lgkmcnt(9)
    v_mfma_f32_16x16x32_bf16 v[236:239], v[76:79], v[44:47], v[236:239]
    v_mfma_f32_16x16x32_bf16 v[240:243], v[80:83], v[44:47], v[240:243]
    ds_read_b128 v[44:47], v18 offset:44032
    s_waitcnt lgkmcnt(9)
    v_mfma_f32_16x16x32_bf16 v[244:247], v[76:79], v[48:51], v[244:247]
    v_mfma_f32_16x16x32_bf16 v[248:251], v[80:83], v[48:51], v[248:251]
    ds_read_b128 v[48:51], v18 offset:44288
    s_waitcnt lgkmcnt(3)
    v_mfma_f32_16x16x32_bf16 v[204:207], v[84:87], v[28:31], v[204:207]
    s_barrier
    v_mfma_f32_16x16x32_bf16 v[208:211], v[88:91], v[28:31], v[208:211]
    ds_read_b128 v[28:31], v18 offset:49152
    v_mfma_f32_16x16x32_bf16 v[212:215], v[84:87], v[32:35], v[212:215]
    v_mfma_f32_16x16x32_bf16 v[216:219], v[88:91], v[32:35], v[216:219]
    ds_read_b128 v[32:35], v18 offset:49408
    v_mfma_f32_16x16x32_bf16 v[220:223], v[84:87], v[36:39], v[220:223]
    v_mfma_f32_16x16x32_bf16 v[224:227], v[88:91], v[36:39], v[224:227]
    ds_read_b128 v[36:39], v18 offset:49664
    s_waitcnt lgkmcnt(5)
    v_mfma_f32_16x16x32_bf16 v[228:231], v[84:87], v[40:43], v[228:231]
    v_mfma_f32_16x16x32_bf16 v[232:235], v[88:91], v[40:43], v[232:235]
    ds_read_b128 v[40:43], v18 offset:49920
    s_waitcnt lgkmcnt(5)
    v_mfma_f32_16x16x32_bf16 v[236:239], v[84:87], v[44:47], v[236:239]
    v_mfma_f32_16x16x32_bf16 v[240:243], v[88:91], v[44:47], v[240:243]
    ds_read_b128 v[44:47], v18 offset:50176
    s_waitcnt lgkmcnt(5)
    v_mfma_f32_16x16x32_bf16 v[244:247], v[84:87], v[48:51], v[244:247]
    v_mfma_f32_16x16x32_bf16 v[248:251], v[88:91], v[48:51], v[248:251]
    ds_read_b128 v[48:51], v18 offset:50432
    s_waitcnt lgkmcnt(3)
    v_mfma_f32_16x16x32_bf16 v[204:207], v[188:191], v[28:31], v[204:207]
    v_mfma_f32_16x16x32_bf16 v[208:211], v[192:195], v[28:31], v[208:211]
    ds_read_b128 v[28:31], v18 offset:55296
    v_mfma_f32_16x16x32_bf16 v[212:215], v[188:191], v[32:35], v[212:215]
    v_mfma_f32_16x16x32_bf16 v[216:219], v[192:195], v[32:35], v[216:219]
    ds_read_b128 v[32:35], v18 offset:55552
    v_mfma_f32_16x16x32_bf16 v[220:223], v[188:191], v[36:39], v[220:223]
    v_mfma_f32_16x16x32_bf16 v[224:227], v[192:195], v[36:39], v[224:227]
    ds_read_b128 v[36:39], v18 offset:55808
    s_waitcnt lgkmcnt(5)
    v_mfma_f32_16x16x32_bf16 v[228:231], v[188:191], v[40:43], v[228:231]
    v_mfma_f32_16x16x32_bf16 v[232:235], v[192:195], v[40:43], v[232:235]
    ds_read_b128 v[40:43], v18 offset:56064
    s_waitcnt lgkmcnt(5)
    s_branch L_skip_5
    s_nop 0
L_stub_5:
    s_branch L_stub_6
L_skip_5:
    v_mfma_f32_16x16x32_bf16 v[236:239], v[188:191], v[44:47], v[236:239]
    v_mfma_f32_16x16x32_bf16 v[240:243], v[192:195], v[44:47], v[240:243]
    ds_read_b128 v[44:47], v18 offset:56320
    s_waitcnt lgkmcnt(5)
    v_mfma_f32_16x16x32_bf16 v[244:247], v[188:191], v[48:51], v[244:247]
    v_mfma_f32_16x16x32_bf16 v[248:251], v[192:195], v[48:51], v[248:251]
    ds_read_b128 v[48:51], v18 offset:56576
    s_waitcnt lgkmcnt(3)
    v_mfma_f32_16x16x32_bf16 v[204:207], v[196:199], v[28:31], v[204:207]
    s_barrier
    ds_read_b64_tr_b16 v[76:77], v20 offset:32768
    v_mfma_f32_16x16x32_bf16 v[208:211], v[200:203], v[28:31], v[208:211]
    ds_read_b128 v[28:31], v18 offset:0
    v_mfma_f32_16x16x32_bf16 v[212:215], v[196:199], v[32:35], v[212:215]
    ds_read_b64_tr_b16 v[78:79], v20 offset:36864
    v_mfma_f32_16x16x32_bf16 v[216:219], v[200:203], v[32:35], v[216:219]
    ds_read_b128 v[32:35], v18 offset:256
    v_mfma_f32_16x16x32_bf16 v[220:223], v[196:199], v[36:39], v[220:223]
    ds_read_b64_tr_b16 v[80:81], v21 offset:32768
    v_mfma_f32_16x16x32_bf16 v[224:227], v[200:203], v[36:39], v[224:227]
    ds_read_b128 v[36:39], v18 offset:512
    s_waitcnt lgkmcnt(8)
    v_mfma_f32_16x16x32_bf16 v[228:231], v[196:199], v[40:43], v[228:231]
    ds_read_b64_tr_b16 v[82:83], v21 offset:36864
    v_mfma_f32_16x16x32_bf16 v[232:235], v[200:203], v[40:43], v[232:235]
    ds_read_b128 v[40:43], v18 offset:768
    s_waitcnt lgkmcnt(9)
    v_mfma_f32_16x16x32_bf16 v[236:239], v[196:199], v[44:47], v[236:239]
    v_mfma_f32_16x16x32_bf16 v[240:243], v[200:203], v[44:47], v[240:243]
    ds_read_b128 v[44:47], v18 offset:1024
    s_waitcnt lgkmcnt(9)
    v_mfma_f32_16x16x32_bf16 v[244:247], v[196:199], v[48:51], v[244:247]
    v_mfma_f32_16x16x32_bf16 v[248:251], v[200:203], v[48:51], v[248:251]
    ds_read_b128 v[48:51], v18 offset:1280
    s_waitcnt lgkmcnt(3)
    v_mfma_f32_16x16x32_bf16 v[204:207], v[76:79], v[28:31], v[204:207]
    ds_read_b64_tr_b16 v[84:85], v20 offset:40960
    v_mfma_f32_16x16x32_bf16 v[208:211], v[80:83], v[28:31], v[208:211]
    ds_read_b128 v[28:31], v18 offset:6144
    v_mfma_f32_16x16x32_bf16 v[212:215], v[76:79], v[32:35], v[212:215]
    ds_read_b64_tr_b16 v[86:87], v20 offset:45056
    v_mfma_f32_16x16x32_bf16 v[216:219], v[80:83], v[32:35], v[216:219]
    ds_read_b128 v[32:35], v18 offset:6400
    v_mfma_f32_16x16x32_bf16 v[220:223], v[76:79], v[36:39], v[220:223]
    ds_read_b64_tr_b16 v[88:89], v21 offset:40960
    v_mfma_f32_16x16x32_bf16 v[224:227], v[80:83], v[36:39], v[224:227]
    ds_read_b128 v[36:39], v18 offset:6656
    s_waitcnt lgkmcnt(8)
    v_mfma_f32_16x16x32_bf16 v[228:231], v[76:79], v[40:43], v[228:231]
    ds_read_b64_tr_b16 v[90:91], v21 offset:45056
    v_mfma_f32_16x16x32_bf16 v[232:235], v[80:83], v[40:43], v[232:235]
    ds_read_b128 v[40:43], v18 offset:6912
    s_waitcnt lgkmcnt(9)
    v_mfma_f32_16x16x32_bf16 v[236:239], v[76:79], v[44:47], v[236:239]
    v_mfma_f32_16x16x32_bf16 v[240:243], v[80:83], v[44:47], v[240:243]
    ds_read_b128 v[44:47], v18 offset:7168
    s_waitcnt lgkmcnt(9)
    v_mfma_f32_16x16x32_bf16 v[244:247], v[76:79], v[48:51], v[244:247]
    v_mfma_f32_16x16x32_bf16 v[248:251], v[80:83], v[48:51], v[248:251]
    ds_read_b128 v[48:51], v18 offset:7424
    s_waitcnt lgkmcnt(3)
    v_mfma_f32_16x16x32_bf16 v[204:207], v[84:87], v[28:31], v[204:207]
    s_barrier
    ds_read_b64_tr_b16 v[76:77], v24 offset:0
    v_mfma_f32_16x16x32_bf16 v[208:211], v[88:91], v[28:31], v[208:211]
    ds_read_b128 v[28:31], v18 offset:12288
    v_mfma_f32_16x16x32_bf16 v[212:215], v[84:87], v[32:35], v[212:215]
    ds_read_b64_tr_b16 v[78:79], v24 offset:4096
    v_mfma_f32_16x16x32_bf16 v[216:219], v[88:91], v[32:35], v[216:219]
    ds_read_b128 v[32:35], v18 offset:12544
    v_mfma_f32_16x16x32_bf16 v[220:223], v[84:87], v[36:39], v[220:223]
    ds_read_b64_tr_b16 v[80:81], v25 offset:0
    v_mfma_f32_16x16x32_bf16 v[224:227], v[88:91], v[36:39], v[224:227]
    ds_read_b128 v[36:39], v18 offset:12800
    s_waitcnt lgkmcnt(8)
    v_mfma_f32_16x16x32_bf16 v[228:231], v[84:87], v[40:43], v[228:231]
    ds_read_b64_tr_b16 v[82:83], v25 offset:4096
    v_mfma_f32_16x16x32_bf16 v[232:235], v[88:91], v[40:43], v[232:235]
    ds_read_b128 v[40:43], v18 offset:13056
    s_waitcnt lgkmcnt(9)
    v_mfma_f32_16x16x32_bf16 v[236:239], v[84:87], v[44:47], v[236:239]
    v_mfma_f32_16x16x32_bf16 v[240:243], v[88:91], v[44:47], v[240:243]
    ds_read_b128 v[44:47], v18 offset:13312
    s_waitcnt lgkmcnt(9)
    v_mfma_f32_16x16x32_bf16 v[244:247], v[84:87], v[48:51], v[244:247]
    v_mfma_f32_16x16x32_bf16 v[248:251], v[88:91], v[48:51], v[248:251]
    ds_read_b128 v[48:51], v18 offset:13568
    s_waitcnt lgkmcnt(3)
    v_mfma_f32_16x16x32_bf16 v[204:207], v[76:79], v[28:31], v[204:207]
    ds_read_b64_tr_b16 v[84:85], v24 offset:8192
    v_mfma_f32_16x16x32_bf16 v[208:211], v[80:83], v[28:31], v[208:211]
    ds_read_b128 v[28:31], v18 offset:18432
    v_mfma_f32_16x16x32_bf16 v[212:215], v[76:79], v[32:35], v[212:215]
    ds_read_b64_tr_b16 v[86:87], v24 offset:12288
    v_mfma_f32_16x16x32_bf16 v[216:219], v[80:83], v[32:35], v[216:219]
    ds_read_b128 v[32:35], v18 offset:18688
    v_mfma_f32_16x16x32_bf16 v[220:223], v[76:79], v[36:39], v[220:223]
    ds_read_b64_tr_b16 v[88:89], v25 offset:8192
    v_mfma_f32_16x16x32_bf16 v[224:227], v[80:83], v[36:39], v[224:227]
    ds_read_b128 v[36:39], v18 offset:18944
    s_waitcnt lgkmcnt(8)
    v_mfma_f32_16x16x32_bf16 v[228:231], v[76:79], v[40:43], v[228:231]
    ds_read_b64_tr_b16 v[90:91], v25 offset:12288
    v_mfma_f32_16x16x32_bf16 v[232:235], v[80:83], v[40:43], v[232:235]
    ds_read_b128 v[40:43], v18 offset:19200
    s_waitcnt lgkmcnt(9)
    v_mfma_f32_16x16x32_bf16 v[236:239], v[76:79], v[44:47], v[236:239]
    v_mfma_f32_16x16x32_bf16 v[240:243], v[80:83], v[44:47], v[240:243]
    ds_read_b128 v[44:47], v18 offset:19456
    s_waitcnt lgkmcnt(9)
    v_mfma_f32_16x16x32_bf16 v[244:247], v[76:79], v[48:51], v[244:247]
    v_mfma_f32_16x16x32_bf16 v[248:251], v[80:83], v[48:51], v[248:251]
    ds_read_b128 v[48:51], v18 offset:19712
    s_waitcnt lgkmcnt(3)
    v_mfma_f32_16x16x32_bf16 v[204:207], v[84:87], v[28:31], v[204:207]
    s_barrier
    v_mfma_f32_16x16x32_bf16 v[208:211], v[88:91], v[28:31], v[208:211]
    ds_read_b128 v[28:31], v18 offset:24576
    v_mfma_f32_16x16x32_bf16 v[212:215], v[84:87], v[32:35], v[212:215]
    v_mfma_f32_16x16x32_bf16 v[216:219], v[88:91], v[32:35], v[216:219]
    ds_read_b128 v[32:35], v18 offset:24832
    v_mfma_f32_16x16x32_bf16 v[220:223], v[84:87], v[36:39], v[220:223]
    v_mfma_f32_16x16x32_bf16 v[224:227], v[88:91], v[36:39], v[224:227]
    ds_read_b128 v[36:39], v18 offset:25088
    s_waitcnt lgkmcnt(5)
    v_mfma_f32_16x16x32_bf16 v[228:231], v[84:87], v[40:43], v[228:231]
    v_mfma_f32_16x16x32_bf16 v[232:235], v[88:91], v[40:43], v[232:235]
    ds_read_b128 v[40:43], v18 offset:25344
    s_waitcnt lgkmcnt(5)
    v_mfma_f32_16x16x32_bf16 v[236:239], v[84:87], v[44:47], v[236:239]
    v_mfma_f32_16x16x32_bf16 v[240:243], v[88:91], v[44:47], v[240:243]
    ds_read_b128 v[44:47], v18 offset:25600
    s_waitcnt lgkmcnt(5)
    v_mfma_f32_16x16x32_bf16 v[244:247], v[84:87], v[48:51], v[244:247]
    v_mfma_f32_16x16x32_bf16 v[248:251], v[88:91], v[48:51], v[248:251]
    ds_read_b128 v[48:51], v18 offset:25856
    s_waitcnt lgkmcnt(3)
    v_mfma_f32_16x16x32_bf16 v[204:207], v[52:55], v[28:31], v[204:207]
    v_mfma_f32_16x16x32_bf16 v[208:211], v[56:59], v[28:31], v[208:211]
    ds_read_b128 v[28:31], v18 offset:30720
    v_mfma_f32_16x16x32_bf16 v[212:215], v[52:55], v[32:35], v[212:215]
    v_mfma_f32_16x16x32_bf16 v[216:219], v[56:59], v[32:35], v[216:219]
    ds_read_b128 v[32:35], v18 offset:30976
    v_mfma_f32_16x16x32_bf16 v[220:223], v[52:55], v[36:39], v[220:223]
    v_mfma_f32_16x16x32_bf16 v[224:227], v[56:59], v[36:39], v[224:227]
    ds_read_b128 v[36:39], v18 offset:31232
    s_waitcnt lgkmcnt(5)
    v_mfma_f32_16x16x32_bf16 v[228:231], v[52:55], v[40:43], v[228:231]
    v_mfma_f32_16x16x32_bf16 v[232:235], v[56:59], v[40:43], v[232:235]
    ds_read_b128 v[40:43], v18 offset:31488
    s_waitcnt lgkmcnt(5)
    v_mfma_f32_16x16x32_bf16 v[236:239], v[52:55], v[44:47], v[236:239]
    v_mfma_f32_16x16x32_bf16 v[240:243], v[56:59], v[44:47], v[240:243]
    ds_read_b128 v[44:47], v18 offset:31744
    s_waitcnt lgkmcnt(5)
    v_mfma_f32_16x16x32_bf16 v[244:247], v[52:55], v[48:51], v[244:247]
    v_mfma_f32_16x16x32_bf16 v[248:251], v[56:59], v[48:51], v[248:251]
    ds_read_b128 v[48:51], v18 offset:32000
    s_waitcnt lgkmcnt(3)
    v_mfma_f32_16x16x32_bf16 v[204:207], v[60:63], v[28:31], v[204:207]
    s_barrier
    ds_read_b64_tr_b16 v[76:77], v24 offset:16384
    v_mfma_f32_16x16x32_bf16 v[208:211], v[64:67], v[28:31], v[208:211]
    ds_read_b128 v[28:31], v18 offset:36864
    v_mfma_f32_16x16x32_bf16 v[212:215], v[60:63], v[32:35], v[212:215]
    ds_read_b64_tr_b16 v[78:79], v24 offset:20480
    v_mfma_f32_16x16x32_bf16 v[216:219], v[64:67], v[32:35], v[216:219]
    ds_read_b128 v[32:35], v18 offset:37120
    v_mfma_f32_16x16x32_bf16 v[220:223], v[60:63], v[36:39], v[220:223]
    ds_read_b64_tr_b16 v[80:81], v25 offset:16384
    v_mfma_f32_16x16x32_bf16 v[224:227], v[64:67], v[36:39], v[224:227]
    ds_read_b128 v[36:39], v18 offset:37376
    s_waitcnt lgkmcnt(8)
    v_mfma_f32_16x16x32_bf16 v[228:231], v[60:63], v[40:43], v[228:231]
    ds_read_b64_tr_b16 v[82:83], v25 offset:20480
    v_mfma_f32_16x16x32_bf16 v[232:235], v[64:67], v[40:43], v[232:235]
    ds_read_b128 v[40:43], v18 offset:37632
    s_waitcnt lgkmcnt(9)
    v_mfma_f32_16x16x32_bf16 v[236:239], v[60:63], v[44:47], v[236:239]
    v_mfma_f32_16x16x32_bf16 v[240:243], v[64:67], v[44:47], v[240:243]
    ds_read_b128 v[44:47], v18 offset:37888
    s_waitcnt lgkmcnt(9)
    v_mfma_f32_16x16x32_bf16 v[244:247], v[60:63], v[48:51], v[244:247]
    v_mfma_f32_16x16x32_bf16 v[248:251], v[64:67], v[48:51], v[248:251]
    ds_read_b128 v[48:51], v18 offset:38144
    s_waitcnt lgkmcnt(3)
    v_mfma_f32_16x16x32_bf16 v[204:207], v[76:79], v[28:31], v[204:207]
    ds_read_b64_tr_b16 v[84:85], v24 offset:24576
    v_mfma_f32_16x16x32_bf16 v[208:211], v[80:83], v[28:31], v[208:211]
    ds_read_b128 v[28:31], v18 offset:43008
    v_mfma_f32_16x16x32_bf16 v[212:215], v[76:79], v[32:35], v[212:215]
    ds_read_b64_tr_b16 v[86:87], v24 offset:28672
    v_mfma_f32_16x16x32_bf16 v[216:219], v[80:83], v[32:35], v[216:219]
    ds_read_b128 v[32:35], v18 offset:43264
    v_mfma_f32_16x16x32_bf16 v[220:223], v[76:79], v[36:39], v[220:223]
    ds_read_b64_tr_b16 v[88:89], v25 offset:24576
    v_mfma_f32_16x16x32_bf16 v[224:227], v[80:83], v[36:39], v[224:227]
    ds_read_b128 v[36:39], v18 offset:43520
    s_waitcnt lgkmcnt(8)
    v_mfma_f32_16x16x32_bf16 v[228:231], v[76:79], v[40:43], v[228:231]
    ds_read_b64_tr_b16 v[90:91], v25 offset:28672
    v_mfma_f32_16x16x32_bf16 v[232:235], v[80:83], v[40:43], v[232:235]
    ds_read_b128 v[40:43], v18 offset:43776
    s_waitcnt lgkmcnt(9)
    v_mfma_f32_16x16x32_bf16 v[236:239], v[76:79], v[44:47], v[236:239]
    v_mfma_f32_16x16x32_bf16 v[240:243], v[80:83], v[44:47], v[240:243]
    ds_read_b128 v[44:47], v18 offset:44032
    s_waitcnt lgkmcnt(9)
    v_mfma_f32_16x16x32_bf16 v[244:247], v[76:79], v[48:51], v[244:247]
    v_mfma_f32_16x16x32_bf16 v[248:251], v[80:83], v[48:51], v[248:251]
    ds_read_b128 v[48:51], v18 offset:44288
    s_waitcnt lgkmcnt(3)
    v_mfma_f32_16x16x32_bf16 v[204:207], v[84:87], v[28:31], v[204:207]
    s_barrier
    ds_read_b64_tr_b16 v[76:77], v24 offset:32768
    v_mfma_f32_16x16x32_bf16 v[208:211], v[88:91], v[28:31], v[208:211]
    ds_read_b128 v[28:31], v18 offset:49152
    v_mfma_f32_16x16x32_bf16 v[212:215], v[84:87], v[32:35], v[212:215]
    ds_read_b64_tr_b16 v[78:79], v24 offset:36864
    v_mfma_f32_16x16x32_bf16 v[216:219], v[88:91], v[32:35], v[216:219]
    ds_read_b128 v[32:35], v18 offset:49408
    v_mfma_f32_16x16x32_bf16 v[220:223], v[84:87], v[36:39], v[220:223]
    ds_read_b64_tr_b16 v[80:81], v25 offset:32768
    v_mfma_f32_16x16x32_bf16 v[224:227], v[88:91], v[36:39], v[224:227]
    ds_read_b128 v[36:39], v18 offset:49664
    s_waitcnt lgkmcnt(8)
    v_mfma_f32_16x16x32_bf16 v[228:231], v[84:87], v[40:43], v[228:231]
    ds_read_b64_tr_b16 v[82:83], v25 offset:36864
    v_mfma_f32_16x16x32_bf16 v[232:235], v[88:91], v[40:43], v[232:235]
    ds_read_b128 v[40:43], v18 offset:49920
    s_waitcnt lgkmcnt(9)
    v_mfma_f32_16x16x32_bf16 v[236:239], v[84:87], v[44:47], v[236:239]
    v_mfma_f32_16x16x32_bf16 v[240:243], v[88:91], v[44:47], v[240:243]
    ds_read_b128 v[44:47], v18 offset:50176
    s_waitcnt lgkmcnt(9)
    v_mfma_f32_16x16x32_bf16 v[244:247], v[84:87], v[48:51], v[244:247]
    v_mfma_f32_16x16x32_bf16 v[248:251], v[88:91], v[48:51], v[248:251]
    ds_read_b128 v[48:51], v18 offset:50432
    s_waitcnt lgkmcnt(3)
    v_mfma_f32_16x16x32_bf16 v[204:207], v[76:79], v[28:31], v[204:207]
    ds_read_b64_tr_b16 v[84:85], v24 offset:40960
    v_mfma_f32_16x16x32_bf16 v[208:211], v[80:83], v[28:31], v[208:211]
    ds_read_b128 v[28:31], v18 offset:55296
    v_mfma_f32_16x16x32_bf16 v[212:215], v[76:79], v[32:35], v[212:215]
    ds_read_b64_tr_b16 v[86:87], v24 offset:45056
    v_mfma_f32_16x16x32_bf16 v[216:219], v[80:83], v[32:35], v[216:219]
    ds_read_b128 v[32:35], v18 offset:55552
    v_mfma_f32_16x16x32_bf16 v[220:223], v[76:79], v[36:39], v[220:223]
    ds_read_b64_tr_b16 v[88:89], v25 offset:40960
    v_mfma_f32_16x16x32_bf16 v[224:227], v[80:83], v[36:39], v[224:227]
    ds_read_b128 v[36:39], v18 offset:55808
    s_waitcnt lgkmcnt(8)
    v_mfma_f32_16x16x32_bf16 v[228:231], v[76:79], v[40:43], v[228:231]
    ds_read_b64_tr_b16 v[90:91], v25 offset:45056
    v_mfma_f32_16x16x32_bf16 v[232:235], v[80:83], v[40:43], v[232:235]
    ds_read_b128 v[40:43], v18 offset:56064
    s_waitcnt lgkmcnt(9)
    v_mfma_f32_16x16x32_bf16 v[236:239], v[76:79], v[44:47], v[236:239]
    v_mfma_f32_16x16x32_bf16 v[240:243], v[80:83], v[44:47], v[240:243]
    ds_read_b128 v[44:47], v18 offset:56320
    s_waitcnt lgkmcnt(9)
    v_mfma_f32_16x16x32_bf16 v[244:247], v[76:79], v[48:51], v[244:247]
    v_mfma_f32_16x16x32_bf16 v[248:251], v[80:83], v[48:51], v[248:251]
    ds_read_b128 v[48:51], v18 offset:56576
    s_waitcnt lgkmcnt(3)
    v_mfma_f32_16x16x32_bf16 v[204:207], v[84:87], v[28:31], v[204:207]
    s_barrier
    ds_read_b64_tr_b16 v[76:77], v20 offset:0
    v_mfma_f32_16x16x32_bf16 v[208:211], v[88:91], v[28:31], v[208:211]
    ds_read_b128 v[28:31], v18 offset:0
    v_mfma_f32_16x16x32_bf16 v[212:215], v[84:87], v[32:35], v[212:215]
    ds_read_b64_tr_b16 v[78:79], v20 offset:4096
    v_mfma_f32_16x16x32_bf16 v[216:219], v[88:91], v[32:35], v[216:219]
    ds_read_b128 v[32:35], v18 offset:256
    v_mfma_f32_16x16x32_bf16 v[220:223], v[84:87], v[36:39], v[220:223]
    ds_read_b64_tr_b16 v[80:81], v21 offset:0
    v_mfma_f32_16x16x32_bf16 v[224:227], v[88:91], v[36:39], v[224:227]
    ds_read_b128 v[36:39], v18 offset:512
    s_waitcnt lgkmcnt(8)
    v_mfma_f32_16x16x32_bf16 v[228:231], v[84:87], v[40:43], v[228:231]
    ds_read_b64_tr_b16 v[82:83], v21 offset:4096
    v_mfma_f32_16x16x32_bf16 v[232:235], v[88:91], v[40:43], v[232:235]
    ds_read_b128 v[40:43], v18 offset:768
    s_waitcnt lgkmcnt(9)
    v_mfma_f32_16x16x32_bf16 v[236:239], v[84:87], v[44:47], v[236:239]
    v_mfma_f32_16x16x32_bf16 v[240:243], v[88:91], v[44:47], v[240:243]
    ds_read_b128 v[44:47], v18 offset:1024
    s_waitcnt lgkmcnt(9)
    v_mfma_f32_16x16x32_bf16 v[244:247], v[84:87], v[48:51], v[244:247]
    v_mfma_f32_16x16x32_bf16 v[248:251], v[88:91], v[48:51], v[248:251]
    ds_read_b128 v[48:51], v18 offset:1280
    s_waitcnt lgkmcnt(3)
    v_mfma_f32_16x16x32_bf16 v[204:207], v[76:79], v[28:31], v[204:207]
    ds_read_b64_tr_b16 v[84:85], v20 offset:8192
    v_mfma_f32_16x16x32_bf16 v[208:211], v[80:83], v[28:31], v[208:211]
    ds_read_b128 v[28:31], v18 offset:6144
    v_mfma_f32_16x16x32_bf16 v[212:215], v[76:79], v[32:35], v[212:215]
    ds_read_b64_tr_b16 v[86:87], v20 offset:12288
    v_mfma_f32_16x16x32_bf16 v[216:219], v[80:83], v[32:35], v[216:219]
    ds_read_b128 v[32:35], v18 offset:6400
    v_mfma_f32_16x16x32_bf16 v[220:223], v[76:79], v[36:39], v[220:223]
    ds_read_b64_tr_b16 v[88:89], v21 offset:8192
    v_mfma_f32_16x16x32_bf16 v[224:227], v[80:83], v[36:39], v[224:227]
    ds_read_b128 v[36:39], v18 offset:6656
    s_waitcnt lgkmcnt(8)
    v_mfma_f32_16x16x32_bf16 v[228:231], v[76:79], v[40:43], v[228:231]
    ds_read_b64_tr_b16 v[90:91], v21 offset:12288
    v_mfma_f32_16x16x32_bf16 v[232:235], v[80:83], v[40:43], v[232:235]
    ds_read_b128 v[40:43], v18 offset:6912
    s_waitcnt lgkmcnt(9)
    v_mfma_f32_16x16x32_bf16 v[236:239], v[76:79], v[44:47], v[236:239]
    v_mfma_f32_16x16x32_bf16 v[240:243], v[80:83], v[44:47], v[240:243]
    ds_read_b128 v[44:47], v18 offset:7168
    s_waitcnt lgkmcnt(9)
    v_mfma_f32_16x16x32_bf16 v[244:247], v[76:79], v[48:51], v[244:247]
    v_mfma_f32_16x16x32_bf16 v[248:251], v[80:83], v[48:51], v[248:251]
    ds_read_b128 v[48:51], v18 offset:7424
    s_waitcnt lgkmcnt(3)
    v_mfma_f32_16x16x32_bf16 v[204:207], v[84:87], v[28:31], v[204:207]
    s_barrier
    ds_read_b64_tr_b16 v[76:77], v20 offset:16384
    v_mfma_f32_16x16x32_bf16 v[208:211], v[88:91], v[28:31], v[208:211]
    ds_read_b128 v[28:31], v18 offset:12288
    v_mfma_f32_16x16x32_bf16 v[212:215], v[84:87], v[32:35], v[212:215]
    ds_read_b64_tr_b16 v[78:79], v20 offset:20480
    v_mfma_f32_16x16x32_bf16 v[216:219], v[88:91], v[32:35], v[216:219]
    ds_read_b128 v[32:35], v18 offset:12544
    v_mfma_f32_16x16x32_bf16 v[220:223], v[84:87], v[36:39], v[220:223]
    ds_read_b64_tr_b16 v[80:81], v21 offset:16384
    v_mfma_f32_16x16x32_bf16 v[224:227], v[88:91], v[36:39], v[224:227]
    ds_read_b128 v[36:39], v18 offset:12800
    s_waitcnt lgkmcnt(8)
    v_mfma_f32_16x16x32_bf16 v[228:231], v[84:87], v[40:43], v[228:231]
    ds_read_b64_tr_b16 v[82:83], v21 offset:20480
    v_mfma_f32_16x16x32_bf16 v[232:235], v[88:91], v[40:43], v[232:235]
    ds_read_b128 v[40:43], v18 offset:13056
    s_waitcnt lgkmcnt(9)
    v_mfma_f32_16x16x32_bf16 v[236:239], v[84:87], v[44:47], v[236:239]
    v_mfma_f32_16x16x32_bf16 v[240:243], v[88:91], v[44:47], v[240:243]
    ds_read_b128 v[44:47], v18 offset:13312
    s_waitcnt lgkmcnt(9)
    v_mfma_f32_16x16x32_bf16 v[244:247], v[84:87], v[48:51], v[244:247]
    v_mfma_f32_16x16x32_bf16 v[248:251], v[88:91], v[48:51], v[248:251]
    ds_read_b128 v[48:51], v18 offset:13568
    s_waitcnt lgkmcnt(3)
    v_mfma_f32_16x16x32_bf16 v[204:207], v[76:79], v[28:31], v[204:207]
    ds_read_b64_tr_b16 v[84:85], v20 offset:24576
    v_mfma_f32_16x16x32_bf16 v[208:211], v[80:83], v[28:31], v[208:211]
    ds_read_b128 v[28:31], v18 offset:18432
    v_mfma_f32_16x16x32_bf16 v[212:215], v[76:79], v[32:35], v[212:215]
    ds_read_b64_tr_b16 v[86:87], v20 offset:28672
    v_mfma_f32_16x16x32_bf16 v[216:219], v[80:83], v[32:35], v[216:219]
    ds_read_b128 v[32:35], v18 offset:18688
    v_mfma_f32_16x16x32_bf16 v[220:223], v[76:79], v[36:39], v[220:223]
    ds_read_b64_tr_b16 v[88:89], v21 offset:24576
    v_mfma_f32_16x16x32_bf16 v[224:227], v[80:83], v[36:39], v[224:227]
    ds_read_b128 v[36:39], v18 offset:18944
    s_waitcnt lgkmcnt(8)
    v_mfma_f32_16x16x32_bf16 v[228:231], v[76:79], v[40:43], v[228:231]
    ds_read_b64_tr_b16 v[90:91], v21 offset:28672
    v_mfma_f32_16x16x32_bf16 v[232:235], v[80:83], v[40:43], v[232:235]
    ds_read_b128 v[40:43], v18 offset:19200
    s_waitcnt lgkmcnt(9)
    v_mfma_f32_16x16x32_bf16 v[236:239], v[76:79], v[44:47], v[236:239]
    v_mfma_f32_16x16x32_bf16 v[240:243], v[80:83], v[44:47], v[240:243]
    ds_read_b128 v[44:47], v18 offset:19456
    s_waitcnt lgkmcnt(9)
    v_mfma_f32_16x16x32_bf16 v[244:247], v[76:79], v[48:51], v[244:247]
    v_mfma_f32_16x16x32_bf16 v[248:251], v[80:83], v[48:51], v[248:251]
    ds_read_b128 v[48:51], v18 offset:19712
    s_waitcnt lgkmcnt(0)
    s_barrier
    v_mfma_f32_16x16x32_bf16 v[204:207], v[84:87], v[28:31], v[204:207]
    v_mfma_f32_16x16x32_bf16 v[208:211], v[88:91], v[28:31], v[208:211]
    v_mfma_f32_16x16x32_bf16 v[212:215], v[84:87], v[32:35], v[212:215]
    v_mfma_f32_16x16x32_bf16 v[216:219], v[88:91], v[32:35], v[216:219]
    v_mfma_f32_16x16x32_bf16 v[220:223], v[84:87], v[36:39], v[220:223]
    v_mfma_f32_16x16x32_bf16 v[224:227], v[88:91], v[36:39], v[224:227]
    v_mfma_f32_16x16x32_bf16 v[228:231], v[84:87], v[40:43], v[228:231]
    v_mfma_f32_16x16x32_bf16 v[232:235], v[88:91], v[40:43], v[232:235]
    v_mfma_f32_16x16x32_bf16 v[236:239], v[84:87], v[44:47], v[236:239]
    v_mfma_f32_16x16x32_bf16 v[240:243], v[88:91], v[44:47], v[240:243]
    v_mfma_f32_16x16x32_bf16 v[244:247], v[84:87], v[48:51], v[244:247]
    v_mfma_f32_16x16x32_bf16 v[248:251], v[88:91], v[48:51], v[248:251]
    s_lshl_b32 s48, s51, 2
    s_add_u32 s48, s48, s3
    s_mul_i32 s48, s48, 36864
    s_mul_i32 s49, s52, 1536
    s_add_u32 s48, s48, s49
    s_add_u32 s48, s48, 20971520
    v_mul_u32_u24 v22, 9216, v2
    v_lshl_add_u32 v22, v1, 4, v22
    s_mov_b32 s60, 0xbdd2d3e8
    v_mov_b32 v4, 0xc0135761
    v_pk_mul_f32 v[28:29], v[204:205], v[204:205]
    v_pk_mul_f32 v[30:31], v[206:207], v[206:207]
    v_pk_mul_f32 v[32:33], v[208:209], v[208:209]
    v_pk_mul_f32 v[34:35], v[210:211], v[210:211]
    v_pk_fma_f32 v[28:29], v[28:29], s[60:61], v[4:5] op_sel_hi:[1,0,0]
    v_pk_fma_f32 v[30:31], v[30:31], s[60:61], v[4:5] op_sel_hi:[1,0,0]
    v_pk_fma_f32 v[32:33], v[32:33], s[60:61], v[4:5] op_sel_hi:[1,0,0]
    v_pk_fma_f32 v[34:35], v[34:35], s[60:61], v[4:5] op_sel_hi:[1,0,0]
    v_pk_mul_f32 v[28:29], v[28:29], v[204:205]
    v_pk_mul_f32 v[30:31], v[30:31], v[206:207]
    v_pk_mul_f32 v[32:33], v[32:33], v[208:209]
    v_pk_mul_f32 v[34:35], v[34:35], v[210:211]
    v_exp_f32 v28, v28
    v_exp_f32 v29, v29
    v_exp_f32 v30, v30
    v_exp_f32 v31, v31
    v_exp_f32 v32, v32
    v_exp_f32 v33, v33
    v_exp_f32 v34, v34
    v_exp_f32 v35, v35
    v_pk_add_f32 v[28:29], v[28:29], 1.0 op_sel_hi:[1,0]
    v_pk_add_f32 v[30:31], v[30:31], 1.0 op_sel_hi:[1,0]
    v_pk_add_f32 v[32:33], v[32:33], 1.0 op_sel_hi:[1,0]
    v_pk_add_f32 v[34:35], v[34:35], 1.0 op_sel_hi:[1,0]
    v_rcp_f32 v28, v28
    v_rcp_f32 v29, v29
    v_rcp_f32 v30, v30
    v_rcp_f32 v31, v31
    v_rcp_f32 v32, v32
    v_rcp_f32 v33, v33
    v_rcp_f32 v34, v34
    v_rcp_f32 v35, v35
    v_pk_mul_f32 v[28:29], v[28:29], v[204:205]
    v_pk_mul_f32 v[30:31], v[30:31], v[206:207]
    v_pk_mul_f32 v[32:33], v[32:33], v[208:209]
    v_pk_mul_f32 v[34:35], v[34:35], v[210:211]
    v_cvt_pk_bf16_f32 v76, v28, v29
    v_cvt_pk_bf16_f32 v77, v30, v31
    v_cvt_pk_bf16_f32 v78, v32, v33
    v_cvt_pk_bf16_f32 v79, v34, v35
    buffer_store_dwordx4 v[76:79], v22, s[36:39], s48 offen offset:0 sc1
    v_pk_mul_f32 v[36:37], v[212:213], v[212:213]
    v_pk_mul_f32 v[38:39], v[214:215], v[214:215]
    v_pk_mul_f32 v[40:41], v[216:217], v[216:217]
    v_pk_mul_f32 v[42:43], v[218:219], v[218:219]
    v_pk_fma_f32 v[36:37], v[36:37], s[60:61], v[4:5] op_sel_hi:[1,0,0]
    v_pk_fma_f32 v[38:39], v[38:39], s[60:61], v[4:5] op_sel_hi:[1,0,0]
    v_pk_fma_f32 v[40:41], v[40:41], s[60:61], v[4:5] op_sel_hi:[1,0,0]
    v_pk_fma_f32 v[42:43], v[42:43], s[60:61], v[4:5] op_sel_hi:[1,0,0]
    v_pk_mul_f32 v[36:37], v[36:37], v[212:213]
    v_pk_mul_f32 v[38:39], v[38:39], v[214:215]
    v_pk_mul_f32 v[40:41], v[40:41], v[216:217]
    v_pk_mul_f32 v[42:43], v[42:43], v[218:219]
    v_exp_f32 v36, v36
    v_exp_f32 v37, v37
    v_exp_f32 v38, v38
    v_exp_f32 v39, v39
    v_exp_f32 v40, v40
    v_exp_f32 v41, v41
    v_exp_f32 v42, v42
    v_exp_f32 v43, v43
    v_pk_add_f32 v[36:37], v[36:37], 1.0 op_sel_hi:[1,0]
    v_pk_add_f32 v[38:39], v[38:39], 1.0 op_sel_hi:[1,0]
    v_pk_add_f32 v[40:41], v[40:41], 1.0 op_sel_hi:[1,0]
    v_pk_add_f32 v[42:43], v[42:43], 1.0 op_sel_hi:[1,0]
    v_rcp_f32 v36, v36
    v_rcp_f32 v37, v37
    v_rcp_f32 v38, v38
    v_rcp_f32 v39, v39
    v_rcp_f32 v40, v40
    v_rcp_f32 v41, v41
    v_rcp_f32 v42, v42
    v_rcp_f32 v43, v43
    v_pk_mul_f32 v[36:37], v[36:37], v[212:213]
    v_pk_mul_f32 v[38:39], v[38:39], v[214:215]
    v_pk_mul_f32 v[40:41], v[40:41], v[216:217]
    v_pk_mul_f32 v[42:43], v[42:43], v[218:219]
    v_cvt_pk_bf16_f32 v80, v36, v37
    v_cvt_pk_bf16_f32 v81, v38, v39
    v_cvt_pk_bf16_f32 v82, v40, v41
    v_cvt_pk_bf16_f32 v83, v42, v43
    buffer_store_dwordx4 v[80:83], v22, s[36:39], s48 offen offset:256 sc1
    v_pk_mul_f32 v[28:29], v[220:221], v[220:221]
    v_pk_mul_f32 v[30:31], v[222:223], v[222:223]
    v_pk_mul_f32 v[32:33], v[224:225], v[224:225]
    v_pk_mul_f32 v[34:35], v[226:227], v[226:227]
    v_pk_fma_f32 v[28:29], v[28:29], s[60:61], v[4:5] op_sel_hi:[1,0,0]
    v_pk_fma_f32 v[30:31], v[30:31], s[60:61], v[4:5] op_sel_hi:[1,0,0]
    v_pk_fma_f32 v[32:33], v[32:33], s[60:61], v[4:5] op_sel_hi:[1,0,0]
    v_pk_fma_f32 v[34:35], v[34:35], s[60:61], v[4:5] op_sel_hi:[1,0,0]
    v_pk_mul_f32 v[28:29], v[28:29], v[220:221]
    v_pk_mul_f32 v[30:31], v[30:31], v[222:223]
    v_pk_mul_f32 v[32:33], v[32:33], v[224:225]
    v_pk_mul_f32 v[34:35], v[34:35], v[226:227]
    v_exp_f32 v28, v28
    v_exp_f32 v29, v29
    v_exp_f32 v30, v30
    v_exp_f32 v31, v31
    v_exp_f32 v32, v32
    v_exp_f32 v33, v33
    v_exp_f32 v34, v34
    v_exp_f32 v35, v35
    v_pk_add_f32 v[28:29], v[28:29], 1.0 op_sel_hi:[1,0]
    v_pk_add_f32 v[30:31], v[30:31], 1.0 op_sel_hi:[1,0]
    v_pk_add_f32 v[32:33], v[32:33], 1.0 op_sel_hi:[1,0]
    v_pk_add_f32 v[34:35], v[34:35], 1.0 op_sel_hi:[1,0]
    v_rcp_f32 v28, v28
    v_rcp_f32 v29, v29
    v_rcp_f32 v30, v30
    v_rcp_f32 v31, v31
    v_rcp_f32 v32, v32
    v_rcp_f32 v33, v33
    v_rcp_f32 v34, v34
    v_rcp_f32 v35, v35
    v_pk_mul_f32 v[28:29], v[28:29], v[220:221]
    v_pk_mul_f32 v[30:31], v[30:31], v[222:223]
    v_pk_mul_f32 v[32:33], v[32:33], v[224:225]
    v_pk_mul_f32 v[34:35], v[34:35], v[226:227]
    v_cvt_pk_bf16_f32 v76, v28, v29
    v_cvt_pk_bf16_f32 v77, v30, v31
    v_cvt_pk_bf16_f32 v78, v32, v33
    v_cvt_pk_bf16_f32 v79, v34, v35
    buffer_store_dwordx4 v[76:79], v22, s[36:39], s48 offen offset:512 sc1
    v_pk_mul_f32 v[36:37], v[228:229], v[228:229]
    v_pk_mul_f32 v[38:39], v[230:231], v[230:231]
    v_pk_mul_f32 v[40:41], v[232:233], v[232:233]
    v_pk_mul_f32 v[42:43], v[234:235], v[234:235]
    v_pk_fma_f32 v[36:37], v[36:37], s[60:61], v[4:5] op_sel_hi:[1,0,0]
    v_pk_fma_f32 v[38:39], v[38:39], s[60:61], v[4:5] op_sel_hi:[1,0,0]
    v_pk_fma_f32 v[40:41], v[40:41], s[60:61], v[4:5] op_sel_hi:[1,0,0]
    v_pk_fma_f32 v[42:43], v[42:43], s[60:61], v[4:5] op_sel_hi:[1,0,0]
    v_pk_mul_f32 v[36:37], v[36:37], v[228:229]
    v_pk_mul_f32 v[38:39], v[38:39], v[230:231]
    v_pk_mul_f32 v[40:41], v[40:41], v[232:233]
    v_pk_mul_f32 v[42:43], v[42:43], v[234:235]
    v_exp_f32 v36, v36
    v_exp_f32 v37, v37
    v_exp_f32 v38, v38
    v_exp_f32 v39, v39
    v_exp_f32 v40, v40
    v_exp_f32 v41, v41
    v_exp_f32 v42, v42
    v_exp_f32 v43, v43
    v_pk_add_f32 v[36:37], v[36:37], 1.0 op_sel_hi:[1,0]
    v_pk_add_f32 v[38:39], v[38:39], 1.0 op_sel_hi:[1,0]
    v_pk_add_f32 v[40:41], v[40:41], 1.0 op_sel_hi:[1,0]
    v_pk_add_f32 v[42:43], v[42:43], 1.0 op_sel_hi:[1,0]
    v_rcp_f32 v36, v36
    v_rcp_f32 v37, v37
    v_rcp_f32 v38, v38
    v_rcp_f32 v39, v39
    v_rcp_f32 v40, v40
    v_rcp_f32 v41, v41
    v_rcp_f32 v42, v42
    v_rcp_f32 v43, v43
    v_pk_mul_f32 v[36:37], v[36:37], v[228:229]
    v_pk_mul_f32 v[38:39], v[38:39], v[230:231]
    v_pk_mul_f32 v[40:41], v[40:41], v[232:233]
    v_pk_mul_f32 v[42:43], v[42:43], v[234:235]
    v_cvt_pk_bf16_f32 v80, v36, v37
    v_cvt_pk_bf16_f32 v81, v38, v39
    v_cvt_pk_bf16_f32 v82, v40, v41
    v_cvt_pk_bf16_f32 v83, v42, v43
    buffer_store_dwordx4 v[80:83], v22, s[36:39], s48 offen offset:768 sc1
    v_pk_mul_f32 v[28:29], v[236:237], v[236:237]
    v_pk_mul_f32 v[30:31], v[238:239], v[238:239]
    v_pk_mul_f32 v[32:33], v[240:241], v[240:241]
    v_pk_mul_f32 v[34:35], v[242:243], v[242:243]
    v_pk_fma_f32 v[28:29], v[28:29], s[60:61], v[4:5] op_sel_hi:[1,0,0]
    v_pk_fma_f32 v[30:31], v[30:31], s[60:61], v[4:5] op_sel_hi:[1,0,0]
    v_pk_fma_f32 v[32:33], v[32:33], s[60:61], v[4:5] op_sel_hi:[1,0,0]
    v_pk_fma_f32 v[34:35], v[34:35], s[60:61], v[4:5] op_sel_hi:[1,0,0]
    v_pk_mul_f32 v[28:29], v[28:29], v[236:237]
    v_pk_mul_f32 v[30:31], v[30:31], v[238:239]
    v_pk_mul_f32 v[32:33], v[32:33], v[240:241]
    v_pk_mul_f32 v[34:35], v[34:35], v[242:243]
    v_exp_f32 v28, v28
    v_exp_f32 v29, v29
    v_exp_f32 v30, v30
    v_exp_f32 v31, v31
    v_exp_f32 v32, v32
    v_exp_f32 v33, v33
    v_exp_f32 v34, v34
    v_exp_f32 v35, v35
    v_pk_add_f32 v[28:29], v[28:29], 1.0 op_sel_hi:[1,0]
    v_pk_add_f32 v[30:31], v[30:31], 1.0 op_sel_hi:[1,0]
    v_pk_add_f32 v[32:33], v[32:33], 1.0 op_sel_hi:[1,0]
    s_branch L_skip_6
    s_nop 0
L_stub_6:
    s_branch L_stub_7
L_skip_6:
    v_pk_add_f32 v[34:35], v[34:35], 1.0 op_sel_hi:[1,0]
    v_rcp_f32 v28, v28
    v_rcp_f32 v29, v29
    v_rcp_f32 v30, v30
    v_rcp_f32 v31, v31
    v_rcp_f32 v32, v32
    v_rcp_f32 v33, v33
    v_rcp_f32 v34, v34
    v_rcp_f32 v35, v35
    v_pk_mul_f32 v[28:29], v[28:29], v[236:237]
    v_pk_mul_f32 v[30:31], v[30:31], v[238:239]
    v_pk_mul_f32 v[32:33], v[32:33], v[240:241]
    v_pk_mul_f32 v[34:35], v[34:35], v[242:243]
    v_cvt_pk_bf16_f32 v76, v28, v29
    v_cvt_pk_bf16_f32 v77, v30, v31
    v_cvt_pk_bf16_f32 v78, v32, v33
    v_cvt_pk_bf16_f32 v79, v34, v35
    buffer_store_dwordx4 v[76:79], v22, s[36:39], s48 offen offset:1024 sc1
    v_pk_mul_f32 v[36:37], v[244:245], v[244:245]
    v_pk_mul_f32 v[38:39], v[246:247], v[246:247]
    v_pk_mul_f32 v[40:41], v[248:249], v[248:249]
    v_pk_mul_f32 v[42:43], v[250:251], v[250:251]
    v_pk_fma_f32 v[36:37], v[36:37], s[60:61], v[4:5] op_sel_hi:[1,0,0]
    v_pk_fma_f32 v[38:39], v[38:39], s[60:61], v[4:5] op_sel_hi:[1,0,0]
    v_pk_fma_f32 v[40:41], v[40:41], s[60:61], v[4:5] op_sel_hi:[1,0,0]
    v_pk_fma_f32 v[42:43], v[42:43], s[60:61], v[4:5] op_sel_hi:[1,0,0]
    v_pk_mul_f32 v[36:37], v[36:37], v[244:245]
    v_pk_mul_f32 v[38:39], v[38:39], v[246:247]
    v_pk_mul_f32 v[40:41], v[40:41], v[248:249]
    v_pk_mul_f32 v[42:43], v[42:43], v[250:251]
    v_exp_f32 v36, v36
    v_exp_f32 v37, v37
    v_exp_f32 v38, v38
    v_exp_f32 v39, v39
    v_exp_f32 v40, v40
    v_exp_f32 v41, v41
    v_exp_f32 v42, v42
    v_exp_f32 v43, v43
    v_pk_add_f32 v[36:37], v[36:37], 1.0 op_sel_hi:[1,0]
    v_pk_add_f32 v[38:39], v[38:39], 1.0 op_sel_hi:[1,0]
    v_pk_add_f32 v[40:41], v[40:41], 1.0 op_sel_hi:[1,0]
    v_pk_add_f32 v[42:43], v[42:43], 1.0 op_sel_hi:[1,0]
    v_rcp_f32 v36, v36
    v_rcp_f32 v37, v37
    v_rcp_f32 v38, v38
    v_rcp_f32 v39, v39
    v_rcp_f32 v40, v40
    v_rcp_f32 v41, v41
    v_rcp_f32 v42, v42
    v_rcp_f32 v43, v43
    v_pk_mul_f32 v[36:37], v[36:37], v[244:245]
    v_pk_mul_f32 v[38:39], v[38:39], v[246:247]
    v_pk_mul_f32 v[40:41], v[40:41], v[248:249]
    v_pk_mul_f32 v[42:43], v[42:43], v[250:251]
    v_cvt_pk_bf16_f32 v80, v36, v37
    v_cvt_pk_bf16_f32 v81, v38, v39
    v_cvt_pk_bf16_f32 v82, v40, v41
    v_cvt_pk_bf16_f32 v83, v42, v43
    buffer_store_dwordx4 v[80:83], v22, s[36:39], s48 offen offset:1280 sc1
    s_branch L_m_22
L_m_21:
    s_waitcnt vmcnt(0)
    s_barrier
    s_mov_b32 s40, s16
    s_mov_b32 s41, s17
    s_mov_b32 s42, 18874368
    s_mov_b32 s43, 0x20000
    s_mov_b32 s44, s20
    s_mov_b32 s45, s21
    s_mov_b32 s46, 18874368
    s_mov_b32 s47, 0x20000
    s_mul_i32 s56, s3, 5
    s_add_u32 s56, s56, s5
    s_sub_u32 s56, s56, 27
    s_add_u32 s57, s56, 116
    s_add_u32 s56, s56, 0
L_m_23:
    s_cmp_ge_u32 s57, 320
    s_cbranch_scc1 L_m_24
    s_mul_i32 s48, s57, 820
    s_lshr_b32 s48, s48, 13
    s_mul_i32 s49, s48, 10
    s_sub_u32 s49, s57, s49
    s_lshl_b32 s49, s49, 6
    v_add_u32 v10, s49, v0
    s_and_b32 s49, s4, 7
    s_mul_i32 s49, s49, 4
    s_add_u32 s48, s48, s49
    s_add_u32 s48, s48, 26
    s_and_b32 s48, s48, 31
    s_mul_i32 s48, s48, 73728
    s_mul_i32 s49, s4, 1152
    s_and_b32 s49, s49, -256
    s_add_u32 s48, s48, s49
    v_mul_u32_u24 v11, 820, v10
    v_lshrrev_b32 v11, 13, v11
    v_mul_u32_u24 v12, 10, v11
    v_sub_u32 v12, v10, v12
    v_and_b32 v10, 7, v11
    v_lshrrev_b32 v11, 3, v11
    v_lshl_add_u32 v10, v10, 8, v11
    v_mul_u32_u24 v10, 9216, v10
    v_lshl_add_u32 v10, v12, 7, v10
    buffer_load_dword v13, v10, s[40:43], s48 offen
    s_add_u32 s57, s57, 20
    s_branch L_m_23
L_m_24:
    v_lshrrev_b32 v14, 4, v0
    v_and_b32 v15, 15, v0
    v_lshlrev_b32 v14, 12, v14
    v_lshl_add_u32 v14, v15, 7, v14
    s_lshr_b32 s48, s4, 1
    s_mul_i32 s48, s48, 4718592
    s_and_b32 s49, s4, 1
    s_lshl_b32 s49, s49, 11
    s_add_u32 s48, s48, s49
    v_add_u32 v14, s48, v14
    s_mov_b32 s50, 0
L_m_25:
    s_cmp_ge_u32 s56, 84
    s_cbranch_scc1 L_m_26
    s_add_u32 s48, s56, s50
    s_cmp_ge_u32 s48, 288
    s_cselect_b32 s49, 288, 0
    s_sub_u32 s48, s48, s49
    s_lshl_b32 s48, s48, 14
    buffer_load_dword v17, v14, s[44:47], s48 offen
    s_add_u32 s56, s56, 20
    s_branch L_m_25
L_m_26:
    s_waitcnt vmcnt(0)
    s_waitcnt vmcnt(0)
    s_barrier
    s_branch L_skip_7
L_stub_7:
    s_branch L_back_c2
L_skip_7:
L_m_22:
    s_lshr_b32 s58, s53, 1
    v_lshrrev_b32 v10, 2, v0
    v_and_b32 v11, 7, v10
    s_lshl_b32 s59, s3, 1
    s_add_u32 s59, s59, s58
    v_xor_b32 v11, s59, v11
    v_xor_b32 v12, 1, v11
    v_and_b32 v13, 3, v0
    v_lshlrev_b32 v13, 3, v13
    v_lshl_add_u32 v10, v10, 8, v13
    v_lshl_add_u32 v20, v11, 5, v10
    v_lshl_add_u32 v21, v12, 5, v10
    s_barrier
    v_add_u32 v24, 0, v20
    v_add_u32 v25, 0, v21
    ds_read_b64_tr_b16 v[92:93], v24 offset:32768
    ds_read_b64_tr_b16 v[94:95], v24 offset:36864
    ds_read_b64_tr_b16 v[96:97], v25 offset:32768
    ds_read_b64_tr_b16 v[98:99], v25 offset:36864
    ds_read_b64_tr_b16 v[100:101], v24 offset:40960
    ds_read_b64_tr_b16 v[102:103], v24 offset:45056
    ds_read_b64_tr_b16 v[104:105], v25 offset:40960
    ds_read_b64_tr_b16 v[106:107], v25 offset:45056
    ds_read_b64_tr_b16 v[156:157], v24 offset:0
    ds_read_b64_tr_b16 v[158:159], v24 offset:4096
    ds_read_b64_tr_b16 v[160:161], v25 offset:0
    ds_read_b64_tr_b16 v[162:163], v25 offset:4096
    ds_read_b64_tr_b16 v[164:165], v24 offset:8192
    ds_read_b64_tr_b16 v[166:167], v24 offset:12288
    ds_read_b64_tr_b16 v[168:169], v25 offset:8192
    ds_read_b64_tr_b16 v[170:171], v25 offset:12288
    ds_read_b64_tr_b16 v[172:173], v24 offset:16384
    ds_read_b64_tr_b16 v[174:175], v24 offset:20480
    ds_read_b64_tr_b16 v[176:177], v25 offset:16384
    ds_read_b64_tr_b16 v[178:179], v25 offset:20480
    ds_read_b64_tr_b16 v[180:181], v24 offset:24576
    ds_read_b64_tr_b16 v[182:183], v24 offset:28672
    ds_read_b64_tr_b16 v[184:185], v25 offset:24576
    ds_read_b64_tr_b16 v[186:187], v25 offset:28672
    v_add_u32 v24, 49152, v20
    v_add_u32 v25, 49152, v21
    ds_read_b64_tr_b16 v[108:109], v24 offset:0
    ds_read_b64_tr_b16 v[110:111], v24 offset:4096
    ds_read_b64_tr_b16 v[112:113], v25 offset:0
    ds_read_b64_tr_b16 v[114:115], v25 offset:4096
    ds_read_b64_tr_b16 v[116:117], v24 offset:8192
    ds_read_b64_tr_b16 v[118:119], v24 offset:12288
    ds_read_b64_tr_b16 v[120:121], v25 offset:8192
    ds_read_b64_tr_b16 v[122:123], v25 offset:12288
    ds_read_b64_tr_b16 v[124:125], v24 offset:16384
    ds_read_b64_tr_b16 v[126:127], v24 offset:20480
    ds_read_b64_tr_b16 v[128:129], v25 offset:16384
    ds_read_b64_tr_b16 v[130:131], v25 offset:20480
    ds_read_b64_tr_b16 v[132:133], v24 offset:24576
    ds_read_b64_tr_b16 v[134:135], v24 offset:28672
    ds_read_b64_tr_b16 v[136:137], v25 offset:24576
    ds_read_b64_tr_b16 v[138:139], v25 offset:28672
    ds_read_b64_tr_b16 v[140:141], v24 offset:32768
    ds_read_b64_tr_b16 v[142:143], v24 offset:36864
    ds_read_b64_tr_b16 v[144:145], v25 offset:32768
    ds_read_b64_tr_b16 v[146:147], v25 offset:36864
    ds_read_b64_tr_b16 v[148:149], v24 offset:40960
    ds_read_b64_tr_b16 v[150:151], v24 offset:45056
    ds_read_b64_tr_b16 v[152:153], v25 offset:40960
    ds_read_b64_tr_b16 v[154:155], v25 offset:45056
    s_waitcnt lgkmcnt(0)
    s_barrier
    s_waitcnt vmcnt(0)
    s_barrier
    s_and_b32 s58, s53, 1
    s_mul_i32 s48, s58, 1280
    s_sub_u32 s49, 1280, s48
    v_mul_u32_u24 v10, 2304, v2
    v_add_u32 v10, 90112, v10
    v_lshl_add_u32 v12, v1, 4, v10
    v_add_u32 v18, s48, v12
    v_add_u32 v22, s49, v12
    s_lshl_b32 s48, s58, 3
    v_xor_b32 v11, s48, v1
    v_lshl_add_u32 v19, v11, 4, v10
    v_add_u32 v19, 1024, v19
    v_lshlrev_b32 v9, 4, v0
    v_lshlrev_b32 v8, 16, v8
    v_cmp_gt_u32 vcc, 32, v0
    s_nop 1
    v_cndmask_b32 v10, 0, v8, vcc
    v_mov_b32 v188, v8
    v_mov_b32 v189, v8
    v_mov_b32 v190, v8
    v_mov_b32 v191, v8
    v_mov_b64 v[192:193], 0
    v_mov_b64 v[194:195], 0
    v_mov_b32 v196, v8
    v_mov_b32 v197, v8
    v_mov_b32 v198, v8
    v_mov_b32 v199, v8
    v_mov_b64 v[200:201], 0
    v_mov_b64 v[202:203], 0
    v_mov_b32 v204, v8
    v_mov_b32 v205, v8
    v_mov_b32 v206, v8
    v_mov_b32 v207, v8
    v_mov_b64 v[208:209], 0
    v_mov_b64 v[210:211], 0
    v_mov_b32 v212, v8
    v_mov_b32 v213, v8
    v_mov_b32 v214, v8
    v_mov_b32 v215, v8
    v_mov_b64 v[216:217], 0
    v_mov_b64 v[218:219], 0
    v_mov_b32 v220, v10
    v_mov_b32 v221, v10
    v_mov_b32 v222, v10
    v_mov_b32 v223, v10
    v_mov_b64 v[224:225], 0
    v_mov_b64 v[226:227], 0
    v_mov_b64 v[228:229], 0
    v_mov_b64 v[230:231], 0
    v_mov_b64 v[232:233], 0
    v_mov_b64 v[234:235], 0
    v_mov_b64 v[236:237], 0
    v_mov_b64 v[238:239], 0
    v_mov_b64 v[240:241], 0
    v_mov_b64 v[242:243], 0
    v_mov_b64 v[244:245], 0
    v_mov_b64 v[246:247], 0
    v_mov_b64 v[248:249], 0
    v_mov_b64 v[250:251], 0
    v_mov_b64 v[252:253], 0
    v_mov_b64 v[254:255], 0
    v_mov_b64 v[64:65], 0
    v_mov_b64 v[66:67], 0
    s_mov_b32 s44, s28
    s_mov_b32 s45, s29
    s_mov_b32 s46, 2359296
    s_mov_b32 s47, 0x20000
    s_mul_i32 s48, s3, 2304
    s_add_u32 s48, s48, 32768
    v_mul_u32_u24 v10, 144, v1
    v_lshl_add_u32 v10, v2, 3, v10
    v_add_u32 v10, s48, v10
    v_add_u32 v7, s48, v9
    s_lshl_b32 s49, s58, 4
    v_add_u32 v4, s49, v10
    s_lshl_b32 s49, s58, 7
    s_sub_u32 s49, 128, s49
    v_add_u32 v10, s49, v10
    v_cmp_gt_u32 vcc, 32, v0
    v_mov_b32 v11, 82432
    s_nop 0
    v_cndmask_b32 v5, v11, v10, vcc
    v_lshlrev_b32 v10, 4, v2
    v_add_u32 v10, 81920, v10
    s_lshl_b32 s49, s58, 5
    v_add_u32 v6, s49, v10
    s_lshl_b32 s49, s58, 8
    s_sub_u32 s49, 256, s49
    v_add_u32 v23, s49, v10
    s_lshl_b32 s48, s59, 4
    s_lshl_b32 s49, s54, 7
    s_add_u32 s48, s48, s49
    s_mul_i32 s48, s48, 1152
    s_mul_i32 s49, s55, 288
    s_add_u32 s62, s48, s49
    s_mul_i32 s49, s58, 144
    s_add_u32 s62, s62, s49
    v_add_u32 v10, 0, v0
    v_mul_u32_u24 v11, 911, v10
    v_lshrrev_b32 v11, 13, v11
    v_mul_u32_u24 v11, 1008, v11
    v_lshl_add_u32 v68, v10, 4, v11
    v_add_u32 v10, 64, v0
    v_mul_u32_u24 v11, 911, v10
    v_lshrrev_b32 v11, 13, v11
    v_mul_u32_u24 v11, 1008, v11
    v_lshl_add_u32 v69, v10, 4, v11
    v_add_u32 v10, 128, v0
    v_mul_u32_u24 v11, 911, v10
    v_lshrrev_b32 v11, 13, v11
    v_mul_u32_u24 v11, 1008, v11
    v_lshl_add_u32 v70, v10, 4, v11
    v_cmp_gt_u32 vcc, 16, v0
    v_mov_b32 v11, 2146435072
    s_nop 0
    v_cndmask_b32 v70, v11, v70, vcc
    s_mul_i32 s48, s3, 2304
    s_add_u32 s48, s48, 27262976
    s_mul_i32 s64, s2, 27648
    s_add_u32 s64, s64, s48
    v_and_b32 v10, 3, v0
    v_cmp_eq_u32 vcc, 0, v10
    v_lshlrev_b32 v27, 2, v0
    s_nop 0
    v_cndmask_b32 v26, v11, v27, vcc
    s_mul_i32 s49, s3, 4608
    s_add_u32 s49, s49, 49152
    v_add_u32 v71, s49, v9
    v_add_u32 v72, 73728, v18
    v_add_u32 v75, 73728, v19
    v_add_u32 v74, 73728, v22
    s_xor_b32 s65, s2, 2
    s_mul_i32 s65, s65, 27648
    s_add_u32 s65, s65, s48
    s_add_u32 s65, s65, 0
    s_xor_b32 s66, s2, 4
    s_mul_i32 s66, s66, 27648
    s_add_u32 s66, s66, s48
    s_add_u32 s66, s66, 9216
    s_xor_b32 s67, s2, 6
    s_mul_i32 s67, s67, 27648
    s_add_u32 s67, s67, s48
    s_add_u32 s67, s67, 18432
    s_branch L_stub_8
L_back_c3:
    v_add_u32 v24, 49152, v20
    v_add_u32 v25, 49152, v21
    s_barrier
    ds_read_b64_tr_b16 v[80:81], v21 offset:0
    ds_read_b64_tr_b16 v[82:83], v21 offset:4096
    ds_read_b64_tr_b16 v[76:77], v20 offset:0
    ds_read_b64_tr_b16 v[78:79], v20 offset:4096
    ds_read_b128 v[28:31], v18 offset:0
    ds_read_b128 v[32:35], v18 offset:256
    ds_read_b128 v[36:39], v18 offset:512
    ds_read_b128 v[40:43], v18 offset:768
    ds_read_b128 v[44:47], v19 offset:0
    ds_read_b128 v[48:51], v22 offset:0
    ds_read_b128 v[52:55], v22 offset:256
    ds_read_b128 v[56:59], v22 offset:512
    ds_read_b128 v[60:63], v22 offset:768
    s_waitcnt lgkmcnt(6)
    v_mfma_f32_16x16x32_bf16 v[192:195], v[28:31], v[80:83], v[192:195]
    ds_read_b64_tr_b16 v[88:89], v21 offset:8192
    v_mfma_f32_16x16x32_bf16 v[188:191], v[28:31], v[76:79], v[188:191]
    ds_read_b128 v[28:31], v18 offset:9216
    v_mfma_f32_16x16x32_bf16 v[200:203], v[32:35], v[80:83], v[200:203]
    ds_read_b64_tr_b16 v[90:91], v21 offset:12288
    v_mfma_f32_16x16x32_bf16 v[196:199], v[32:35], v[76:79], v[196:199]
    ds_read_b128 v[32:35], v18 offset:9472
    v_mfma_f32_16x16x32_bf16 v[208:211], v[36:39], v[80:83], v[208:211]
    ds_read_b64_tr_b16 v[84:85], v20 offset:8192
    v_mfma_f32_16x16x32_bf16 v[204:207], v[36:39], v[76:79], v[204:207]
    ds_read_b128 v[36:39], v18 offset:9728
    s_waitcnt lgkmcnt(9)
    v_mfma_f32_16x16x32_bf16 v[216:219], v[40:43], v[80:83], v[216:219]
    ds_read_b64_tr_b16 v[86:87], v20 offset:12288
    v_mfma_f32_16x16x32_bf16 v[212:215], v[40:43], v[76:79], v[212:215]
    ds_read_b128 v[40:43], v18 offset:9984
    v_mfma_f32_16x16x32_bf16 v[224:227], v[44:47], v[80:83], v[224:227]
    v_mfma_f32_16x16x32_bf16 v[220:223], v[44:47], v[76:79], v[220:223]
    ds_read_b128 v[44:47], v19 offset:9216
    v_mfma_f32_16x16x32_bf16 v[232:235], v[48:51], v[80:83], v[232:235]
    v_mfma_f32_16x16x32_bf16 v[228:231], v[48:51], v[76:79], v[228:231]
    ds_read_b128 v[48:51], v22 offset:9216
    s_waitcnt lgkmcnt(10)
    v_mfma_f32_16x16x32_bf16 v[240:243], v[52:55], v[80:83], v[240:243]
    v_mfma_f32_16x16x32_bf16 v[236:239], v[52:55], v[76:79], v[236:239]
    ds_read_b128 v[52:55], v22 offset:9472
    v_mfma_f32_16x16x32_bf16 v[248:251], v[56:59], v[80:83], v[248:251]
    v_mfma_f32_16x16x32_bf16 v[244:247], v[56:59], v[76:79], v[244:247]
    ds_read_b128 v[56:59], v22 offset:9728
    v_mfma_f32_16x16x32_bf16 v[64:67], v[60:63], v[80:83], v[64:67]
    v_mfma_f32_16x16x32_bf16 v[252:255], v[60:63], v[76:79], v[252:255]
    ds_read_b128 v[60:63], v22 offset:9984
    s_waitcnt lgkmcnt(6)
    v_mfma_f32_16x16x32_bf16 v[192:195], v[28:31], v[88:91], v[192:195]
    s_barrier
    ds_read_b64_tr_b16 v[80:81], v21 offset:16384
    v_mfma_f32_16x16x32_bf16 v[188:191], v[28:31], v[84:87], v[188:191]
    ds_read_b128 v[28:31], v18 offset:18432
    v_mfma_f32_16x16x32_bf16 v[200:203], v[32:35], v[88:91], v[200:203]
    ds_read_b64_tr_b16 v[82:83], v21 offset:20480
    v_mfma_f32_16x16x32_bf16 v[196:199], v[32:35], v[84:87], v[196:199]
    ds_read_b128 v[32:35], v18 offset:18688
    v_mfma_f32_16x16x32_bf16 v[208:211], v[36:39], v[88:91], v[208:211]
    ds_read_b64_tr_b16 v[76:77], v20 offset:16384
    v_mfma_f32_16x16x32_bf16 v[204:207], v[36:39], v[84:87], v[204:207]
    ds_read_b128 v[36:39], v18 offset:18944
    s_waitcnt lgkmcnt(9)
    v_mfma_f32_16x16x32_bf16 v[216:219], v[40:43], v[88:91], v[216:219]
    ds_read_b64_tr_b16 v[78:79], v20 offset:20480
    v_mfma_f32_16x16x32_bf16 v[212:215], v[40:43], v[84:87], v[212:215]
    ds_read_b128 v[40:43], v18 offset:19200
    v_mfma_f32_16x16x32_bf16 v[224:227], v[44:47], v[88:91], v[224:227]
    v_mfma_f32_16x16x32_bf16 v[220:223], v[44:47], v[84:87], v[220:223]
    ds_read_b128 v[44:47], v19 offset:18432
    v_mfma_f32_16x16x32_bf16 v[232:235], v[48:51], v[88:91], v[232:235]
    v_mfma_f32_16x16x32_bf16 v[228:231], v[48:51], v[84:87], v[228:231]
    ds_read_b128 v[48:51], v22 offset:18432
    s_waitcnt lgkmcnt(10)
    v_mfma_f32_16x16x32_bf16 v[240:243], v[52:55], v[88:91], v[240:243]
    v_mfma_f32_16x16x32_bf16 v[236:239], v[52:55], v[84:87], v[236:239]
    ds_read_b128 v[52:55], v22 offset:18688
    v_mfma_f32_16x16x32_bf16 v[248:251], v[56:59], v[88:91], v[248:251]
    v_mfma_f32_16x16x32_bf16 v[244:247], v[56:59], v[84:87], v[244:247]
    ds_read_b128 v[56:59], v22 offset:18944
    v_mfma_f32_16x16x32_bf16 v[64:67], v[60:63], v[88:91], v[64:67]
    v_mfma_f32_16x16x32_bf16 v[252:255], v[60:63], v[84:87], v[252:255]
    ds_read_b128 v[60:63], v22 offset:19200
    s_waitcnt lgkmcnt(6)
    v_mfma_f32_16x16x32_bf16 v[192:195], v[28:31], v[80:83], v[192:195]
    ds_read_b64_tr_b16 v[88:89], v21 offset:24576
    v_mfma_f32_16x16x32_bf16 v[188:191], v[28:31], v[76:79], v[188:191]
    ds_read_b128 v[28:31], v18 offset:27648
    v_mfma_f32_16x16x32_bf16 v[200:203], v[32:35], v[80:83], v[200:203]
    ds_read_b64_tr_b16 v[90:91], v21 offset:28672
    v_mfma_f32_16x16x32_bf16 v[196:199], v[32:35], v[76:79], v[196:199]
    ds_read_b128 v[32:35], v18 offset:27904
    v_mfma_f32_16x16x32_bf16 v[208:211], v[36:39], v[80:83], v[208:211]
    ds_read_b64_tr_b16 v[84:85], v20 offset:24576
    v_mfma_f32_16x16x32_bf16 v[204:207], v[36:39], v[76:79], v[204:207]
    ds_read_b128 v[36:39], v18 offset:28160
    s_waitcnt lgkmcnt(9)
    v_mfma_f32_16x16x32_bf16 v[216:219], v[40:43], v[80:83], v[216:219]
    ds_read_b64_tr_b16 v[86:87], v20 offset:28672
    v_mfma_f32_16x16x32_bf16 v[212:215], v[40:43], v[76:79], v[212:215]
    ds_read_b128 v[40:43], v18 offset:28416
    v_mfma_f32_16x16x32_bf16 v[224:227], v[44:47], v[80:83], v[224:227]
    v_mfma_f32_16x16x32_bf16 v[220:223], v[44:47], v[76:79], v[220:223]
    ds_read_b128 v[44:47], v19 offset:27648
    v_mfma_f32_16x16x32_bf16 v[232:235], v[48:51], v[80:83], v[232:235]
    v_mfma_f32_16x16x32_bf16 v[228:231], v[48:51], v[76:79], v[228:231]
    ds_read_b128 v[48:51], v22 offset:27648
    s_waitcnt lgkmcnt(10)
    v_mfma_f32_16x16x32_bf16 v[240:243], v[52:55], v[80:83], v[240:243]
    v_mfma_f32_16x16x32_bf16 v[236:239], v[52:55], v[76:79], v[236:239]
    ds_read_b128 v[52:55], v22 offset:27904
    v_mfma_f32_16x16x32_bf16 v[248:251], v[56:59], v[80:83], v[248:251]
    v_mfma_f32_16x16x32_bf16 v[244:247], v[56:59], v[76:79], v[244:247]
    ds_read_b128 v[56:59], v22 offset:28160
    v_mfma_f32_16x16x32_bf16 v[64:67], v[60:63], v[80:83], v[64:67]
    v_mfma_f32_16x16x32_bf16 v[252:255], v[60:63], v[76:79], v[252:255]
    ds_read_b128 v[60:63], v22 offset:28416
    s_waitcnt lgkmcnt(6)
    v_mfma_f32_16x16x32_bf16 v[192:195], v[28:31], v[88:91], v[192:195]
    s_barrier
    ds_read_b64_tr_b16 v[80:81], v21 offset:32768
    v_mfma_f32_16x16x32_bf16 v[188:191], v[28:31], v[84:87], v[188:191]
    ds_read_b128 v[28:31], v18 offset:36864
    v_mfma_f32_16x16x32_bf16 v[200:203], v[32:35], v[88:91], v[200:203]
    ds_read_b64_tr_b16 v[82:83], v21 offset:36864
    v_mfma_f32_16x16x32_bf16 v[196:199], v[32:35], v[84:87], v[196:199]
    ds_read_b128 v[32:35], v18 offset:37120
    v_mfma_f32_16x16x32_bf16 v[208:211], v[36:39], v[88:91], v[208:211]
    ds_read_b64_tr_b16 v[76:77], v20 offset:32768
    v_mfma_f32_16x16x32_bf16 v[204:207], v[36:39], v[84:87], v[204:207]
    ds_read_b128 v[36:39], v18 offset:37376
    s_waitcnt lgkmcnt(9)
    v_mfma_f32_16x16x32_bf16 v[216:219], v[40:43], v[88:91], v[216:219]
    ds_read_b64_tr_b16 v[78:79], v20 offset:36864
    v_mfma_f32_16x16x32_bf16 v[212:215], v[40:43], v[84:87], v[212:215]
    ds_read_b128 v[40:43], v18 offset:37632
    v_mfma_f32_16x16x32_bf16 v[224:227], v[44:47], v[88:91], v[224:227]
    v_mfma_f32_16x16x32_bf16 v[220:223], v[44:47], v[84:87], v[220:223]
    ds_read_b128 v[44:47], v19 offset:36864
    v_mfma_f32_16x16x32_bf16 v[232:235], v[48:51], v[88:91], v[232:235]
    v_mfma_f32_16x16x32_bf16 v[228:231], v[48:51], v[84:87], v[228:231]
    ds_read_b128 v[48:51], v22 offset:36864
    s_waitcnt lgkmcnt(10)
    v_mfma_f32_16x16x32_bf16 v[240:243], v[52:55], v[88:91], v[240:243]
    v_mfma_f32_16x16x32_bf16 v[236:239], v[52:55], v[84:87], v[236:239]
    ds_read_b128 v[52:55], v22 offset:37120
    v_mfma_f32_16x16x32_bf16 v[248:251], v[56:59], v[88:91], v[248:251]
    v_mfma_f32_16x16x32_bf16 v[244:247], v[56:59], v[84:87], v[244:247]
    ds_read_b128 v[56:59], v22 offset:37376
    v_mfma_f32_16x16x32_bf16 v[64:67], v[60:63], v[88:91], v[64:67]
    v_mfma_f32_16x16x32_bf16 v[252:255], v[60:63], v[84:87], v[252:255]
    ds_read_b128 v[60:63], v22 offset:37632
    s_waitcnt lgkmcnt(6)
    v_mfma_f32_16x16x32_bf16 v[192:195], v[28:31], v[80:83], v[192:195]
    ds_read_b64_tr_b16 v[88:89], v21 offset:40960
    v_mfma_f32_16x16x32_bf16 v[188:191], v[28:31], v[76:79], v[188:191]
    ds_read_b128 v[28:31], v18 offset:46080
    v_mfma_f32_16x16x32_bf16 v[200:203], v[32:35], v[80:83], v[200:203]
    ds_read_b64_tr_b16 v[90:91], v21 offset:45056
    v_mfma_f32_16x16x32_bf16 v[196:199], v[32:35], v[76:79], v[196:199]
    ds_read_b128 v[32:35], v18 offset:46336
    v_mfma_f32_16x16x32_bf16 v[208:211], v[36:39], v[80:83], v[208:211]
    ds_read_b64_tr_b16 v[84:85], v20 offset:40960
    v_mfma_f32_16x16x32_bf16 v[204:207], v[36:39], v[76:79], v[204:207]
    ds_read_b128 v[36:39], v18 offset:46592
    s_waitcnt lgkmcnt(9)
    v_mfma_f32_16x16x32_bf16 v[216:219], v[40:43], v[80:83], v[216:219]
    ds_read_b64_tr_b16 v[86:87], v20 offset:45056
    v_mfma_f32_16x16x32_bf16 v[212:215], v[40:43], v[76:79], v[212:215]
    ds_read_b128 v[40:43], v18 offset:46848
    v_mfma_f32_16x16x32_bf16 v[224:227], v[44:47], v[80:83], v[224:227]
    v_mfma_f32_16x16x32_bf16 v[220:223], v[44:47], v[76:79], v[220:223]
    ds_read_b128 v[44:47], v19 offset:46080
    v_mfma_f32_16x16x32_bf16 v[232:235], v[48:51], v[80:83], v[232:235]
    v_mfma_f32_16x16x32_bf16 v[228:231], v[48:51], v[76:79], v[228:231]
    ds_read_b128 v[48:51], v22 offset:46080
    s_waitcnt lgkmcnt(10)
    v_mfma_f32_16x16x32_bf16 v[240:243], v[52:55], v[80:83], v[240:243]
    v_mfma_f32_16x16x32_bf16 v[236:239], v[52:55], v[76:79], v[236:239]
    ds_read_b128 v[52:55], v22 offset:46336
    v_mfma_f32_16x16x32_bf16 v[248:251], v[56:59], v[80:83], v[248:251]
    v_mfma_f32_16x16x32_bf16 v[244:247], v[56:59], v[76:79], v[244:247]
    ds_read_b128 v[56:59], v22 offset:46592
    v_mfma_f32_16x16x32_bf16 v[64:67], v[60:63], v[80:83], v[64:67]
    v_mfma_f32_16x16x32_bf16 v[252:255], v[60:63], v[76:79], v[252:255]
    ds_read_b128 v[60:63], v22 offset:46848
    s_waitcnt lgkmcnt(6)
    v_mfma_f32_16x16x32_bf16 v[192:195], v[28:31], v[88:91], v[192:195]
    s_barrier
    ds_read_b64_tr_b16 v[80:81], v25 offset:0
    v_mfma_f32_16x16x32_bf16 v[188:191], v[28:31], v[84:87], v[188:191]
    ds_read_b128 v[28:31], v18 offset:55296
    v_mfma_f32_16x16x32_bf16 v[200:203], v[32:35], v[88:91], v[200:203]
    ds_read_b64_tr_b16 v[82:83], v25 offset:4096
    v_mfma_f32_16x16x32_bf16 v[196:199], v[32:35], v[84:87], v[196:199]
    ds_read_b128 v[32:35], v18 offset:55552
    v_mfma_f32_16x16x32_bf16 v[208:211], v[36:39], v[88:91], v[208:211]
    ds_read_b64_tr_b16 v[76:77], v24 offset:0
    v_mfma_f32_16x16x32_bf16 v[204:207], v[36:39], v[84:87], v[204:207]
    ds_read_b128 v[36:39], v18 offset:55808
    s_waitcnt lgkmcnt(9)
    v_mfma_f32_16x16x32_bf16 v[216:219], v[40:43], v[88:91], v[216:219]
    ds_read_b64_tr_b16 v[78:79], v24 offset:4096
    v_mfma_f32_16x16x32_bf16 v[212:215], v[40:43], v[84:87], v[212:215]
    ds_read_b128 v[40:43], v18 offset:56064
    v_mfma_f32_16x16x32_bf16 v[224:227], v[44:47], v[88:91], v[224:227]
    v_mfma_f32_16x16x32_bf16 v[220:223], v[44:47], v[84:87], v[220:223]
    ds_read_b128 v[44:47], v19 offset:55296
    v_mfma_f32_16x16x32_bf16 v[232:235], v[48:51], v[88:91], v[232:235]
    v_mfma_f32_16x16x32_bf16 v[228:231], v[48:51], v[84:87], v[228:231]
    ds_read_b128 v[48:51], v22 offset:55296
    s_waitcnt lgkmcnt(10)
    v_mfma_f32_16x16x32_bf16 v[240:243], v[52:55], v[88:91], v[240:243]
    v_mfma_f32_16x16x32_bf16 v[236:239], v[52:55], v[84:87], v[236:239]
    ds_read_b128 v[52:55], v22 offset:55552
    v_mfma_f32_16x16x32_bf16 v[248:251], v[56:59], v[88:91], v[248:251]
    v_mfma_f32_16x16x32_bf16 v[244:247], v[56:59], v[84:87], v[244:247]
    ds_read_b128 v[56:59], v22 offset:55808
    v_mfma_f32_16x16x32_bf16 v[64:67], v[60:63], v[88:91], v[64:67]
    v_mfma_f32_16x16x32_bf16 v[252:255], v[60:63], v[84:87], v[252:255]
    ds_read_b128 v[60:63], v22 offset:56064
    s_waitcnt lgkmcnt(6)
    v_mfma_f32_16x16x32_bf16 v[192:195], v[28:31], v[80:83], v[192:195]
    ds_read_b64_tr_b16 v[88:89], v25 offset:8192
    v_mfma_f32_16x16x32_bf16 v[188:191], v[28:31], v[76:79], v[188:191]
    ds_read_b128 v[28:31], v18 offset:64512
    v_mfma_f32_16x16x32_bf16 v[200:203], v[32:35], v[80:83], v[200:203]
    ds_read_b64_tr_b16 v[90:91], v25 offset:12288
    v_mfma_f32_16x16x32_bf16 v[196:199], v[32:35], v[76:79], v[196:199]
    ds_read_b128 v[32:35], v18 offset:64768
    v_mfma_f32_16x16x32_bf16 v[208:211], v[36:39], v[80:83], v[208:211]
    ds_read_b64_tr_b16 v[84:85], v24 offset:8192
    v_mfma_f32_16x16x32_bf16 v[204:207], v[36:39], v[76:79], v[204:207]
    ds_read_b128 v[36:39], v18 offset:65024
    s_waitcnt lgkmcnt(9)
    v_mfma_f32_16x16x32_bf16 v[216:219], v[40:43], v[80:83], v[216:219]
    ds_read_b64_tr_b16 v[86:87], v24 offset:12288
    v_mfma_f32_16x16x32_bf16 v[212:215], v[40:43], v[76:79], v[212:215]
    ds_read_b128 v[40:43], v18 offset:65280
    v_mfma_f32_16x16x32_bf16 v[224:227], v[44:47], v[80:83], v[224:227]
    v_mfma_f32_16x16x32_bf16 v[220:223], v[44:47], v[76:79], v[220:223]
    ds_read_b128 v[44:47], v19 offset:64512
    v_mfma_f32_16x16x32_bf16 v[232:235], v[48:51], v[80:83], v[232:235]
    v_mfma_f32_16x16x32_bf16 v[228:231], v[48:51], v[76:79], v[228:231]
    ds_read_b128 v[48:51], v22 offset:64512
    s_waitcnt lgkmcnt(10)
    v_mfma_f32_16x16x32_bf16 v[240:243], v[52:55], v[80:83], v[240:243]
    v_mfma_f32_16x16x32_bf16 v[236:239], v[52:55], v[76:79], v[236:239]
    ds_read_b128 v[52:55], v22 offset:64768
    v_mfma_f32_16x16x32_bf16 v[248:251], v[56:59], v[80:83], v[248:251]
    v_mfma_f32_16x16x32_bf16 v[244:247], v[56:59], v[76:79], v[244:247]
    ds_read_b128 v[56:59], v22 offset:65024
    v_mfma_f32_16x16x32_bf16 v[64:67], v[60:63], v[80:83], v[64:67]
    v_mfma_f32_16x16x32_bf16 v[252:255], v[60:63], v[76:79], v[252:255]
    ds_read_b128 v[60:63], v22 offset:65280
    s_waitcnt lgkmcnt(6)
    v_mfma_f32_16x16x32_bf16 v[192:195], v[28:31], v[88:91], v[192:195]
    s_barrier
    v_mfma_f32_16x16x32_bf16 v[188:191], v[28:31], v[84:87], v[188:191]
    ds_read_b128 v[28:31], v18 offset:0
    v_mfma_f32_16x16x32_bf16 v[200:203], v[32:35], v[88:91], v[200:203]
    v_mfma_f32_16x16x32_bf16 v[196:199], v[32:35], v[84:87], v[196:199]
    ds_read_b128 v[32:35], v18 offset:256
    v_mfma_f32_16x16x32_bf16 v[208:211], v[36:39], v[88:91], v[208:211]
    v_mfma_f32_16x16x32_bf16 v[204:207], v[36:39], v[84:87], v[204:207]
    ds_read_b128 v[36:39], v18 offset:512
    s_waitcnt lgkmcnt(6)
    v_mfma_f32_16x16x32_bf16 v[216:219], v[40:43], v[88:91], v[216:219]
    v_mfma_f32_16x16x32_bf16 v[212:215], v[40:43], v[84:87], v[212:215]
    ds_read_b128 v[40:43], v18 offset:768
    v_mfma_f32_16x16x32_bf16 v[224:227], v[44:47], v[88:91], v[224:227]
    v_mfma_f32_16x16x32_bf16 v[220:223], v[44:47], v[84:87], v[220:223]
    ds_read_b128 v[44:47], v19 offset:0
    v_mfma_f32_16x16x32_bf16 v[232:235], v[48:51], v[88:91], v[232:235]
    v_mfma_f32_16x16x32_bf16 v[228:231], v[48:51], v[84:87], v[228:231]
    s_branch L_skip_8
L_stub_8:
    s_branch L_stub_9
L_skip_8:
    ds_read_b128 v[48:51], v22 offset:0
    s_waitcnt lgkmcnt(6)
    v_mfma_f32_16x16x32_bf16 v[240:243], v[52:55], v[88:91], v[240:243]
    v_mfma_f32_16x16x32_bf16 v[236:239], v[52:55], v[84:87], v[236:239]
    ds_read_b128 v[52:55], v22 offset:256
    v_mfma_f32_16x16x32_bf16 v[248:251], v[56:59], v[88:91], v[248:251]
    v_mfma_f32_16x16x32_bf16 v[244:247], v[56:59], v[84:87], v[244:247]
    ds_read_b128 v[56:59], v22 offset:512
    v_mfma_f32_16x16x32_bf16 v[64:67], v[60:63], v[88:91], v[64:67]
    v_mfma_f32_16x16x32_bf16 v[252:255], v[60:63], v[84:87], v[252:255]
    ds_read_b128 v[60:63], v22 offset:768
    s_waitcnt lgkmcnt(6)
    v_mfma_f32_16x16x32_bf16 v[192:195], v[28:31], v[96:99], v[192:195]
    v_mfma_f32_16x16x32_bf16 v[188:191], v[28:31], v[92:95], v[188:191]
    ds_read_b128 v[28:31], v18 offset:9216
    v_mfma_f32_16x16x32_bf16 v[200:203], v[32:35], v[96:99], v[200:203]
    v_mfma_f32_16x16x32_bf16 v[196:199], v[32:35], v[92:95], v[196:199]
    ds_read_b128 v[32:35], v18 offset:9472
    v_mfma_f32_16x16x32_bf16 v[208:211], v[36:39], v[96:99], v[208:211]
    v_mfma_f32_16x16x32_bf16 v[204:207], v[36:39], v[92:95], v[204:207]
    ds_read_b128 v[36:39], v18 offset:9728
    s_waitcnt lgkmcnt(6)
    v_mfma_f32_16x16x32_bf16 v[216:219], v[40:43], v[96:99], v[216:219]
    v_mfma_f32_16x16x32_bf16 v[212:215], v[40:43], v[92:95], v[212:215]
    ds_read_b128 v[40:43], v18 offset:9984
    v_mfma_f32_16x16x32_bf16 v[224:227], v[44:47], v[96:99], v[224:227]
    v_mfma_f32_16x16x32_bf16 v[220:223], v[44:47], v[92:95], v[220:223]
    ds_read_b128 v[44:47], v19 offset:9216
    v_mfma_f32_16x16x32_bf16 v[232:235], v[48:51], v[96:99], v[232:235]
    v_mfma_f32_16x16x32_bf16 v[228:231], v[48:51], v[92:95], v[228:231]
    ds_read_b128 v[48:51], v22 offset:9216
    s_waitcnt lgkmcnt(6)
    v_mfma_f32_16x16x32_bf16 v[240:243], v[52:55], v[96:99], v[240:243]
    v_mfma_f32_16x16x32_bf16 v[236:239], v[52:55], v[92:95], v[236:239]
    ds_read_b128 v[52:55], v22 offset:9472
    v_mfma_f32_16x16x32_bf16 v[248:251], v[56:59], v[96:99], v[248:251]
    v_mfma_f32_16x16x32_bf16 v[244:247], v[56:59], v[92:95], v[244:247]
    ds_read_b128 v[56:59], v22 offset:9728
    v_mfma_f32_16x16x32_bf16 v[64:67], v[60:63], v[96:99], v[64:67]
    v_mfma_f32_16x16x32_bf16 v[252:255], v[60:63], v[92:95], v[252:255]
    ds_read_b128 v[60:63], v22 offset:9984
    s_waitcnt lgkmcnt(6)
    v_mfma_f32_16x16x32_bf16 v[192:195], v[28:31], v[104:107], v[192:195]
    s_barrier
    ds_read_b64_tr_b16 v[80:81], v25 offset:16384
    v_mfma_f32_16x16x32_bf16 v[188:191], v[28:31], v[100:103], v[188:191]
    ds_read_b128 v[28:31], v18 offset:18432
    v_mfma_f32_16x16x32_bf16 v[200:203], v[32:35], v[104:107], v[200:203]
    ds_read_b64_tr_b16 v[82:83], v25 offset:20480
    v_mfma_f32_16x16x32_bf16 v[196:199], v[32:35], v[100:103], v[196:199]
    ds_read_b128 v[32:35], v18 offset:18688
    v_mfma_f32_16x16x32_bf16 v[208:211], v[36:39], v[104:107], v[208:211]
    ds_read_b64_tr_b16 v[76:77], v24 offset:16384
    v_mfma_f32_16x16x32_bf16 v[204:207], v[36:39], v[100:103], v[204:207]
    ds_read_b128 v[36:39], v18 offset:18944
    s_waitcnt lgkmcnt(9)
    v_mfma_f32_16x16x32_bf16 v[216:219], v[40:43], v[104:107], v[216:219]
    ds_read_b64_tr_b16 v[78:79], v24 offset:20480
    v_mfma_f32_16x16x32_bf16 v[212:215], v[40:43], v[100:103], v[212:215]
    ds_read_b128 v[40:43], v18 offset:19200
    v_mfma_f32_16x16x32_bf16 v[224:227], v[44:47], v[104:107], v[224:227]
    v_mfma_f32_16x16x32_bf16 v[220:223], v[44:47], v[100:103], v[220:223]
    ds_read_b128 v[44:47], v19 offset:18432
    v_mfma_f32_16x16x32_bf16 v[232:235], v[48:51], v[104:107], v[232:235]
    v_mfma_f32_16x16x32_bf16 v[228:231], v[48:51], v[100:103], v[228:231]
    ds_read_b128 v[48:51], v22 offset:18432
    s_waitcnt lgkmcnt(10)
    v_mfma_f32_16x16x32_bf16 v[240:243], v[52:55], v[104:107], v[240:243]
    v_mfma_f32_16x16x32_bf16 v[236:239], v[52:55], v[100:103], v[236:239]
    ds_read_b128 v[52:55], v22 offset:18688
    v_mfma_f32_16x16x32_bf16 v[248:251], v[56:59], v[104:107], v[248:251]
    v_mfma_f32_16x16x32_bf16 v[244:247], v[56:59], v[100:103], v[244:247]
    ds_read_b128 v[56:59], v22 offset:18944
    v_mfma_f32_16x16x32_bf16 v[64:67], v[60:63], v[104:107], v[64:67]
    v_mfma_f32_16x16x32_bf16 v[252:255], v[60:63], v[100:103], v[252:255]
    ds_read_b128 v[60:63], v22 offset:19200
    s_waitcnt lgkmcnt(6)
    v_mfma_f32_16x16x32_bf16 v[192:195], v[28:31], v[80:83], v[192:195]
    ds_read_b64_tr_b16 v[88:89], v25 offset:24576
    v_mfma_f32_16x16x32_bf16 v[188:191], v[28:31], v[76:79], v[188:191]
    ds_read_b128 v[28:31], v18 offset:27648
    v_mfma_f32_16x16x32_bf16 v[200:203], v[32:35], v[80:83], v[200:203]
    ds_read_b64_tr_b16 v[90:91], v25 offset:28672
    v_mfma_f32_16x16x32_bf16 v[196:199], v[32:35], v[76:79], v[196:199]
    ds_read_b128 v[32:35], v18 offset:27904
    v_mfma_f32_16x16x32_bf16 v[208:211], v[36:39], v[80:83], v[208:211]
    ds_read_b64_tr_b16 v[84:85], v24 offset:24576
    v_mfma_f32_16x16x32_bf16 v[204:207], v[36:39], v[76:79], v[204:207]
    ds_read_b128 v[36:39], v18 offset:28160
    s_waitcnt lgkmcnt(9)
    v_mfma_f32_16x16x32_bf16 v[216:219], v[40:43], v[80:83], v[216:219]
    ds_read_b64_tr_b16 v[86:87], v24 offset:28672
    v_mfma_f32_16x16x32_bf16 v[212:215], v[40:43], v[76:79], v[212:215]
    ds_read_b128 v[40:43], v18 offset:28416
    v_mfma_f32_16x16x32_bf16 v[224:227], v[44:47], v[80:83], v[224:227]
    v_mfma_f32_16x16x32_bf16 v[220:223], v[44:47], v[76:79], v[220:223]
    ds_read_b128 v[44:47], v19 offset:27648
    v_mfma_f32_16x16x32_bf16 v[232:235], v[48:51], v[80:83], v[232:235]
    v_mfma_f32_16x16x32_bf16 v[228:231], v[48:51], v[76:79], v[228:231]
    ds_read_b128 v[48:51], v22 offset:27648
    s_waitcnt lgkmcnt(10)
    v_mfma_f32_16x16x32_bf16 v[240:243], v[52:55], v[80:83], v[240:243]
    v_mfma_f32_16x16x32_bf16 v[236:239], v[52:55], v[76:79], v[236:239]
    ds_read_b128 v[52:55], v22 offset:27904
    v_mfma_f32_16x16x32_bf16 v[248:251], v[56:59], v[80:83], v[248:251]
    v_mfma_f32_16x16x32_bf16 v[244:247], v[56:59], v[76:79], v[244:247]
    ds_read_b128 v[56:59], v22 offset:28160
    v_mfma_f32_16x16x32_bf16 v[64:67], v[60:63], v[80:83], v[64:67]
    v_mfma_f32_16x16x32_bf16 v[252:255], v[60:63], v[76:79], v[252:255]
    ds_read_b128 v[60:63], v22 offset:28416
    s_waitcnt lgkmcnt(6)
    v_mfma_f32_16x16x32_bf16 v[192:195], v[28:31], v[88:91], v[192:195]
    s_barrier
    v_mfma_f32_16x16x32_bf16 v[188:191], v[28:31], v[84:87], v[188:191]
    ds_read_b128 v[28:31], v18 offset:36864
    v_mfma_f32_16x16x32_bf16 v[200:203], v[32:35], v[88:91], v[200:203]
    v_mfma_f32_16x16x32_bf16 v[196:199], v[32:35], v[84:87], v[196:199]
    ds_read_b128 v[32:35], v18 offset:37120
    v_mfma_f32_16x16x32_bf16 v[208:211], v[36:39], v[88:91], v[208:211]
    v_mfma_f32_16x16x32_bf16 v[204:207], v[36:39], v[84:87], v[204:207]
    ds_read_b128 v[36:39], v18 offset:37376
    s_waitcnt lgkmcnt(6)
    v_mfma_f32_16x16x32_bf16 v[216:219], v[40:43], v[88:91], v[216:219]
    v_mfma_f32_16x16x32_bf16 v[212:215], v[40:43], v[84:87], v[212:215]
    ds_read_b128 v[40:43], v18 offset:37632
    v_mfma_f32_16x16x32_bf16 v[224:227], v[44:47], v[88:91], v[224:227]
    v_mfma_f32_16x16x32_bf16 v[220:223], v[44:47], v[84:87], v[220:223]
    ds_read_b128 v[44:47], v19 offset:36864
    v_mfma_f32_16x16x32_bf16 v[232:235], v[48:51], v[88:91], v[232:235]
    v_mfma_f32_16x16x32_bf16 v[228:231], v[48:51], v[84:87], v[228:231]
    ds_read_b128 v[48:51], v22 offset:36864
    s_waitcnt lgkmcnt(6)
    v_mfma_f32_16x16x32_bf16 v[240:243], v[52:55], v[88:91], v[240:243]
    v_mfma_f32_16x16x32_bf16 v[236:239], v[52:55], v[84:87], v[236:239]
    ds_read_b128 v[52:55], v22 offset:37120
    v_mfma_f32_16x16x32_bf16 v[248:251], v[56:59], v[88:91], v[248:251]
    v_mfma_f32_16x16x32_bf16 v[244:247], v[56:59], v[84:87], v[244:247]
    ds_read_b128 v[56:59], v22 offset:37376
    v_mfma_f32_16x16x32_bf16 v[64:67], v[60:63], v[88:91], v[64:67]
    v_mfma_f32_16x16x32_bf16 v[252:255], v[60:63], v[84:87], v[252:255]
    ds_read_b128 v[60:63], v22 offset:37632
    s_waitcnt lgkmcnt(6)
    v_mfma_f32_16x16x32_bf16 v[192:195], v[28:31], v[112:115], v[192:195]
    v_mfma_f32_16x16x32_bf16 v[188:191], v[28:31], v[108:111], v[188:191]
    ds_read_b128 v[28:31], v18 offset:46080
    v_mfma_f32_16x16x32_bf16 v[200:203], v[32:35], v[112:115], v[200:203]
    v_mfma_f32_16x16x32_bf16 v[196:199], v[32:35], v[108:111], v[196:199]
    ds_read_b128 v[32:35], v18 offset:46336
    v_mfma_f32_16x16x32_bf16 v[208:211], v[36:39], v[112:115], v[208:211]
    v_mfma_f32_16x16x32_bf16 v[204:207], v[36:39], v[108:111], v[204:207]
    ds_read_b128 v[36:39], v18 offset:46592
    s_waitcnt lgkmcnt(6)
    v_mfma_f32_16x16x32_bf16 v[216:219], v[40:43], v[112:115], v[216:219]
    v_mfma_f32_16x16x32_bf16 v[212:215], v[40:43], v[108:111], v[212:215]
    ds_read_b128 v[40:43], v18 offset:46848
    v_mfma_f32_16x16x32_bf16 v[224:227], v[44:47], v[112:115], v[224:227]
    v_mfma_f32_16x16x32_bf16 v[220:223], v[44:47], v[108:111], v[220:223]
    ds_read_b128 v[44:47], v19 offset:46080
    v_mfma_f32_16x16x32_bf16 v[232:235], v[48:51], v[112:115], v[232:235]
    v_mfma_f32_16x16x32_bf16 v[228:231], v[48:51], v[108:111], v[228:231]
    ds_read_b128 v[48:51], v22 offset:46080
    s_waitcnt lgkmcnt(6)
    v_mfma_f32_16x16x32_bf16 v[240:243], v[52:55], v[112:115], v[240:243]
    v_mfma_f32_16x16x32_bf16 v[236:239], v[52:55], v[108:111], v[236:239]
    ds_read_b128 v[52:55], v22 offset:46336
    v_mfma_f32_16x16x32_bf16 v[248:251], v[56:59], v[112:115], v[248:251]
    v_mfma_f32_16x16x32_bf16 v[244:247], v[56:59], v[108:111], v[244:247]
    ds_read_b128 v[56:59], v22 offset:46592
    v_mfma_f32_16x16x32_bf16 v[64:67], v[60:63], v[112:115], v[64:67]
    v_mfma_f32_16x16x32_bf16 v[252:255], v[60:63], v[108:111], v[252:255]
    ds_read_b128 v[60:63], v22 offset:46848
    s_waitcnt lgkmcnt(6)
    v_mfma_f32_16x16x32_bf16 v[192:195], v[28:31], v[120:123], v[192:195]
    s_barrier
    ds_read_b64_tr_b16 v[80:81], v21 offset:0
    v_mfma_f32_16x16x32_bf16 v[188:191], v[28:31], v[116:119], v[188:191]
    ds_read_b128 v[28:31], v18 offset:55296
    v_mfma_f32_16x16x32_bf16 v[200:203], v[32:35], v[120:123], v[200:203]
    ds_read_b64_tr_b16 v[82:83], v21 offset:4096
    v_mfma_f32_16x16x32_bf16 v[196:199], v[32:35], v[116:119], v[196:199]
    ds_read_b128 v[32:35], v18 offset:55552
    v_mfma_f32_16x16x32_bf16 v[208:211], v[36:39], v[120:123], v[208:211]
    ds_read_b64_tr_b16 v[76:77], v20 offset:0
    v_mfma_f32_16x16x32_bf16 v[204:207], v[36:39], v[116:119], v[204:207]
    ds_read_b128 v[36:39], v18 offset:55808
    s_waitcnt lgkmcnt(9)
    v_mfma_f32_16x16x32_bf16 v[216:219], v[40:43], v[120:123], v[216:219]
    ds_read_b64_tr_b16 v[78:79], v20 offset:4096
    v_mfma_f32_16x16x32_bf16 v[212:215], v[40:43], v[116:119], v[212:215]
    ds_read_b128 v[40:43], v18 offset:56064
    v_mfma_f32_16x16x32_bf16 v[224:227], v[44:47], v[120:123], v[224:227]
    v_mfma_f32_16x16x32_bf16 v[220:223], v[44:47], v[116:119], v[220:223]
    ds_read_b128 v[44:47], v19 offset:55296
    v_mfma_f32_16x16x32_bf16 v[232:235], v[48:51], v[120:123], v[232:235]
    v_mfma_f32_16x16x32_bf16 v[228:231], v[48:51], v[116:119], v[228:231]
    ds_read_b128 v[48:51], v22 offset:55296
    s_waitcnt lgkmcnt(10)
    v_mfma_f32_16x16x32_bf16 v[240:243], v[52:55], v[120:123], v[240:243]
    v_mfma_f32_16x16x32_bf16 v[236:239], v[52:55], v[116:119], v[236:239]
    ds_read_b128 v[52:55], v22 offset:55552
    v_mfma_f32_16x16x32_bf16 v[248:251], v[56:59], v[120:123], v[248:251]
    v_mfma_f32_16x16x32_bf16 v[244:247], v[56:59], v[116:119], v[244:247]
    ds_read_b128 v[56:59], v22 offset:55808
    v_mfma_f32_16x16x32_bf16 v[64:67], v[60:63], v[120:123], v[64:67]
    v_mfma_f32_16x16x32_bf16 v[252:255], v[60:63], v[116:119], v[252:255]
    ds_read_b128 v[60:63], v22 offset:56064
    s_waitcnt lgkmcnt(6)
    v_mfma_f32_16x16x32_bf16 v[192:195], v[28:31], v[80:83], v[192:195]
    ds_read_b64_tr_b16 v[88:89], v21 offset:8192
    v_mfma_f32_16x16x32_bf16 v[188:191], v[28:31], v[76:79], v[188:191]
    ds_read_b128 v[28:31], v18 offset:64512
    v_mfma_f32_16x16x32_bf16 v[200:203], v[32:35], v[80:83], v[200:203]
    ds_read_b64_tr_b16 v[90:91], v21 offset:12288
    v_mfma_f32_16x16x32_bf16 v[196:199], v[32:35], v[76:79], v[196:199]
    ds_read_b128 v[32:35], v18 offset:64768
    v_mfma_f32_16x16x32_bf16 v[208:211], v[36:39], v[80:83], v[208:211]
    ds_read_b64_tr_b16 v[84:85], v20 offset:8192
    v_mfma_f32_16x16x32_bf16 v[204:207], v[36:39], v[76:79], v[204:207]
    ds_read_b128 v[36:39], v18 offset:65024
    s_waitcnt lgkmcnt(9)
    v_mfma_f32_16x16x32_bf16 v[216:219], v[40:43], v[80:83], v[216:219]
    ds_read_b64_tr_b16 v[86:87], v20 offset:12288
    v_mfma_f32_16x16x32_bf16 v[212:215], v[40:43], v[76:79], v[212:215]
    ds_read_b128 v[40:43], v18 offset:65280
    v_mfma_f32_16x16x32_bf16 v[224:227], v[44:47], v[80:83], v[224:227]
    v_mfma_f32_16x16x32_bf16 v[220:223], v[44:47], v[76:79], v[220:223]
    ds_read_b128 v[44:47], v19 offset:64512
    v_mfma_f32_16x16x32_bf16 v[232:235], v[48:51], v[80:83], v[232:235]
    v_mfma_f32_16x16x32_bf16 v[228:231], v[48:51], v[76:79], v[228:231]
    ds_read_b128 v[48:51], v22 offset:64512
    s_waitcnt lgkmcnt(10)
    v_mfma_f32_16x16x32_bf16 v[240:243], v[52:55], v[80:83], v[240:243]
    v_mfma_f32_16x16x32_bf16 v[236:239], v[52:55], v[76:79], v[236:239]
    ds_read_b128 v[52:55], v22 offset:64768
    v_mfma_f32_16x16x32_bf16 v[248:251], v[56:59], v[80:83], v[248:251]
    v_mfma_f32_16x16x32_bf16 v[244:247], v[56:59], v[76:79], v[244:247]
    ds_read_b128 v[56:59], v22 offset:65024
    v_mfma_f32_16x16x32_bf16 v[64:67], v[60:63], v[80:83], v[64:67]
    v_mfma_f32_16x16x32_bf16 v[252:255], v[60:63], v[76:79], v[252:255]
    ds_read_b128 v[60:63], v22 offset:65280
    s_waitcnt lgkmcnt(6)
    v_mfma_f32_16x16x32_bf16 v[192:195], v[28:31], v[88:91], v[192:195]
    s_barrier
    v_mfma_f32_16x16x32_bf16 v[188:191], v[28:31], v[84:87], v[188:191]
    ds_read_b128 v[28:31], v18 offset:0
    v_mfma_f32_16x16x32_bf16 v[200:203], v[32:35], v[88:91], v[200:203]
    v_mfma_f32_16x16x32_bf16 v[196:199], v[32:35], v[84:87], v[196:199]
    ds_read_b128 v[32:35], v18 offset:256
    v_mfma_f32_16x16x32_bf16 v[208:211], v[36:39], v[88:91], v[208:211]
    v_mfma_f32_16x16x32_bf16 v[204:207], v[36:39], v[84:87], v[204:207]
    ds_read_b128 v[36:39], v18 offset:512
    s_waitcnt lgkmcnt(6)
    v_mfma_f32_16x16x32_bf16 v[216:219], v[40:43], v[88:91], v[216:219]
    v_mfma_f32_16x16x32_bf16 v[212:215], v[40:43], v[84:87], v[212:215]
    ds_read_b128 v[40:43], v18 offset:768
    v_mfma_f32_16x16x32_bf16 v[224:227], v[44:47], v[88:91], v[224:227]
    v_mfma_f32_16x16x32_bf16 v[220:223], v[44:47], v[84:87], v[220:223]
    ds_read_b128 v[44:47], v19 offset:0
    v_mfma_f32_16x16x32_bf16 v[232:235], v[48:51], v[88:91], v[232:235]
    v_mfma_f32_16x16x32_bf16 v[228:231], v[48:51], v[84:87], v[228:231]
    ds_read_b128 v[48:51], v22 offset:0
    s_waitcnt lgkmcnt(6)
    v_mfma_f32_16x16x32_bf16 v[240:243], v[52:55], v[88:91], v[240:243]
    v_mfma_f32_16x16x32_bf16 v[236:239], v[52:55], v[84:87], v[236:239]
    ds_read_b128 v[52:55], v22 offset:256
    v_mfma_f32_16x16x32_bf16 v[248:251], v[56:59], v[88:91], v[248:251]
    v_mfma_f32_16x16x32_bf16 v[244:247], v[56:59], v[84:87], v[244:247]
    ds_read_b128 v[56:59], v22 offset:512
    v_mfma_f32_16x16x32_bf16 v[64:67], v[60:63], v[88:91], v[64:67]
    v_mfma_f32_16x16x32_bf16 v[252:255], v[60:63], v[84:87], v[252:255]
    ds_read_b128 v[60:63], v22 offset:768
    s_waitcnt lgkmcnt(6)
    v_mfma_f32_16x16x32_bf16 v[192:195], v[28:31], v[128:131], v[192:195]
    v_mfma_f32_16x16x32_bf16 v[188:191], v[28:31], v[124:127], v[188:191]
    ds_read_b128 v[28:31], v18 offset:9216
    v_mfma_f32_16x16x32_bf16 v[200:203], v[32:35], v[128:131], v[200:203]
    v_mfma_f32_16x16x32_bf16 v[196:199], v[32:35], v[124:127], v[196:199]
    ds_read_b128 v[32:35], v18 offset:9472
    v_mfma_f32_16x16x32_bf16 v[208:211], v[36:39], v[128:131], v[208:211]
    v_mfma_f32_16x16x32_bf16 v[204:207], v[36:39], v[124:127], v[204:207]
    ds_read_b128 v[36:39], v18 offset:9728
    s_waitcnt lgkmcnt(6)
    v_mfma_f32_16x16x32_bf16 v[216:219], v[40:43], v[128:131], v[216:219]
    v_mfma_f32_16x16x32_bf16 v[212:215], v[40:43], v[124:127], v[212:215]
    ds_read_b128 v[40:43], v18 offset:9984
    v_mfma_f32_16x16x32_bf16 v[224:227], v[44:47], v[128:131], v[224:227]
    v_mfma_f32_16x16x32_bf16 v[220:223], v[44:47], v[124:127], v[220:223]
    ds_read_b128 v[44:47], v19 offset:9216
    v_mfma_f32_16x16x32_bf16 v[232:235], v[48:51], v[128:131], v[232:235]
    v_mfma_f32_16x16x32_bf16 v[228:231], v[48:51], v[124:127], v[228:231]
    ds_read_b128 v[48:51], v22 offset:9216
    s_waitcnt lgkmcnt(6)
    v_mfma_f32_16x16x32_bf16 v[240:243], v[52:55], v[128:131], v[240:243]
    v_mfma_f32_16x16x32_bf16 v[236:239], v[52:55], v[124:127], v[236:239]
    ds_read_b128 v[52:55], v22 offset:9472
    v_mfma_f32_16x16x32_bf16 v[248:251], v[56:59], v[128:131], v[248:251]
    v_mfma_f32_16x16x32_bf16 v[244:247], v[56:59], v[124:127], v[244:247]
    ds_read_b128 v[56:59], v22 offset:9728
    v_mfma_f32_16x16x32_bf16 v[64:67], v[60:63], v[128:131], v[64:67]
    v_mfma_f32_16x16x32_bf16 v[252:255], v[60:63], v[124:127], v[252:255]
    ds_read_b128 v[60:63], v22 offset:9984
    s_waitcnt lgkmcnt(6)
    v_mfma_f32_16x16x32_bf16 v[192:195], v[28:31], v[136:139], v[192:195]
    s_barrier
    ds_read_b64_tr_b16 v[80:81], v21 offset:16384
    v_mfma_f32_16x16x32_bf16 v[188:191], v[28:31], v[132:135], v[188:191]
    ds_read_b128 v[28:31], v18 offset:18432
    v_mfma_f32_16x16x32_bf16 v[200:203], v[32:35], v[136:139], v[200:203]
    ds_read_b64_tr_b16 v[82:83], v21 offset:20480
    v_mfma_f32_16x16x32_bf16 v[196:199], v[32:35], v[132:135], v[196:199]
    ds_read_b128 v[32:35], v18 offset:18688
    v_mfma_f32_16x16x32_bf16 v[208:211], v[36:39], v[136:139], v[208:211]
    ds_read_b64_tr_b16 v[76:77], v20 offset:16384
    v_mfma_f32_16x16x32_bf16 v[204:207], v[36:39], v[132:135], v[204:207]
    ds_read_b128 v[36:39], v18 offset:18944
    s_waitcnt lgkmcnt(9)
    v_mfma_f32_16x16x32_bf16 v[216:219], v[40:43], v[136:139], v[216:219]
    ds_read_b64_tr_b16 v[78:79], v20 offset:20480
    v_mfma_f32_16x16x32_bf16 v[212:215], v[40:43], v[132:135], v[212:215]
    ds_read_b128 v[40:43], v18 offset:19200
    v_mfma_f32_16x16x32_bf16 v[224:227], v[44:47], v[136:139], v[224:227]
    v_mfma_f32_16x16x32_bf16 v[220:223], v[44:47], v[132:135], v[220:223]
    ds_read_b128 v[44:47], v19 offset:18432
    v_mfma_f32_16x16x32_bf16 v[232:235], v[48:51], v[136:139], v[232:235]
    v_mfma_f32_16x16x32_bf16 v[228:231], v[48:51], v[132:135], v[228:231]
    ds_read_b128 v[48:51], v22 offset:18432
    s_waitcnt lgkmcnt(10)
    v_mfma_f32_16x16x32_bf16 v[240:243], v[52:55], v[136:139], v[240:243]
    v_mfma_f32_16x16x32_bf16 v[236:239], v[52:55], v[132:135], v[236:239]
    ds_read_b128 v[52:55], v22 offset:18688
    v_mfma_f32_16x16x32_bf16 v[248:251], v[56:59], v[136:139], v[248:251]
    v_mfma_f32_16x16x32_bf16 v[244:247], v[56:59], v[132:135], v[244:247]
    ds_read_b128 v[56:59], v22 offset:18944
    v_mfma_f32_16x16x32_bf16 v[64:67], v[60:63], v[136:139], v[64:67]
    v_mfma_f32_16x16x32_bf16 v[252:255], v[60:63], v[132:135], v[252:255]
    ds_read_b128 v[60:63], v22 offset:19200
    s_waitcnt lgkmcnt(6)
    v_mfma_f32_16x16x32_bf16 v[192:195], v[28:31], v[80:83], v[192:195]
    ds_read_b64_tr_b16 v[88:89], v21 offset:24576
    v_mfma_f32_16x16x32_bf16 v[188:191], v[28:31], v[76:79], v[188:191]
    ds_read_b128 v[28:31], v18 offset:27648
    v_mfma_f32_16x16x32_bf16 v[200:203], v[32:35], v[80:83], v[200:203]
    ds_read_b64_tr_b16 v[90:91], v21 offset:28672
    v_mfma_f32_16x16x32_bf16 v[196:199], v[32:35], v[76:79], v[196:199]
    ds_read_b128 v[32:35], v18 offset:27904
    v_mfma_f32_16x16x32_bf16 v[208:211], v[36:39], v[80:83], v[208:211]
    ds_read_b64_tr_b16 v[84:85], v20 offset:24576
    v_mfma_f32_16x16x32_bf16 v[204:207], v[36:39], v[76:79], v[204:207]
    ds_read_b128 v[36:39], v18 offset:28160
    s_waitcnt lgkmcnt(9)
    v_mfma_f32_16x16x32_bf16 v[216:219], v[40:43], v[80:83], v[216:219]
    ds_read_b64_tr_b16 v[86:87], v20 offset:28672
    v_mfma_f32_16x16x32_bf16 v[212:215], v[40:43], v[76:79], v[212:215]
    ds_read_b128 v[40:43], v18 offset:28416
    v_mfma_f32_16x16x32_bf16 v[224:227], v[44:47], v[80:83], v[224:227]
    v_mfma_f32_16x16x32_bf16 v[220:223], v[44:47], v[76:79], v[220:223]
    ds_read_b128 v[44:47], v19 offset:27648
    v_mfma_f32_16x16x32_bf16 v[232:235], v[48:51], v[80:83], v[232:235]
    v_mfma_f32_16x16x32_bf16 v[228:231], v[48:51], v[76:79], v[228:231]
    ds_read_b128 v[48:51], v22 offset:27648
    s_waitcnt lgkmcnt(10)
    v_mfma_f32_16x16x32_bf16 v[240:243], v[52:55], v[80:83], v[240:243]
    v_mfma_f32_16x16x32_bf16 v[236:239], v[52:55], v[76:79], v[236:239]
    ds_read_b128 v[52:55], v22 offset:27904
    v_mfma_f32_16x16x32_bf16 v[248:251], v[56:59], v[80:83], v[248:251]
    v_mfma_f32_16x16x32_bf16 v[244:247], v[56:59], v[76:79], v[244:247]
    ds_read_b128 v[56:59], v22 offset:28160
    v_mfma_f32_16x16x32_bf16 v[64:67], v[60:63], v[80:83], v[64:67]
    v_mfma_f32_16x16x32_bf16 v[252:255], v[60:63], v[76:79], v[252:255]
    ds_read_b128 v[60:63], v22 offset:28416
    s_waitcnt lgkmcnt(6)
    v_mfma_f32_16x16x32_bf16 v[192:195], v[28:31], v[88:91], v[192:195]
    s_barrier
    v_mfma_f32_16x16x32_bf16 v[188:191], v[28:31], v[84:87], v[188:191]
    ds_read_b128 v[28:31], v18 offset:36864
    v_mfma_f32_16x16x32_bf16 v[200:203], v[32:35], v[88:91], v[200:203]
    v_mfma_f32_16x16x32_bf16 v[196:199], v[32:35], v[84:87], v[196:199]
    ds_read_b128 v[32:35], v18 offset:37120
    v_mfma_f32_16x16x32_bf16 v[208:211], v[36:39], v[88:91], v[208:211]
    v_mfma_f32_16x16x32_bf16 v[204:207], v[36:39], v[84:87], v[204:207]
    ds_read_b128 v[36:39], v18 offset:37376
    s_waitcnt lgkmcnt(6)
    v_mfma_f32_16x16x32_bf16 v[216:219], v[40:43], v[88:91], v[216:219]
    v_mfma_f32_16x16x32_bf16 v[212:215], v[40:43], v[84:87], v[212:215]
    ds_read_b128 v[40:43], v18 offset:37632
    v_mfma_f32_16x16x32_bf16 v[224:227], v[44:47], v[88:91], v[224:227]
    v_mfma_f32_16x16x32_bf16 v[220:223], v[44:47], v[84:87], v[220:223]
    ds_read_b128 v[44:47], v19 offset:36864
    v_mfma_f32_16x16x32_bf16 v[232:235], v[48:51], v[88:91], v[232:235]
    v_mfma_f32_16x16x32_bf16 v[228:231], v[48:51], v[84:87], v[228:231]
    ds_read_b128 v[48:51], v22 offset:36864
    s_waitcnt lgkmcnt(6)
    v_mfma_f32_16x16x32_bf16 v[240:243], v[52:55], v[88:91], v[240:243]
    v_mfma_f32_16x16x32_bf16 v[236:239], v[52:55], v[84:87], v[236:239]
    ds_read_b128 v[52:55], v22 offset:37120
    v_mfma_f32_16x16x32_bf16 v[248:251], v[56:59], v[88:91], v[248:251]
    v_mfma_f32_16x16x32_bf16 v[244:247], v[56:59], v[84:87], v[244:247]
    ds_read_b128 v[56:59], v22 offset:37376
    v_mfma_f32_16x16x32_bf16 v[64:67], v[60:63], v[88:91], v[64:67]
    v_mfma_f32_16x16x32_bf16 v[252:255], v[60:63], v[84:87], v[252:255]
    ds_read_b128 v[60:63], v22 offset:37632
    s_waitcnt lgkmcnt(6)
    v_mfma_f32_16x16x32_bf16 v[192:195], v[28:31], v[144:147], v[192:195]
    v_mfma_f32_16x16x32_bf16 v[188:191], v[28:31], v[140:143], v[188:191]
    ds_read_b128 v[28:31], v18 offset:46080
    v_mfma_f32_16x16x32_bf16 v[200:203], v[32:35], v[144:147], v[200:203]
    v_mfma_f32_16x16x32_bf16 v[196:199], v[32:35], v[140:143], v[196:199]
    ds_read_b128 v[32:35], v18 offset:46336
    v_mfma_f32_16x16x32_bf16 v[208:211], v[36:39], v[144:147], v[208:211]
    v_mfma_f32_16x16x32_bf16 v[204:207], v[36:39], v[140:143], v[204:207]
    ds_read_b128 v[36:39], v18 offset:46592
    s_waitcnt lgkmcnt(6)
    v_mfma_f32_16x16x32_bf16 v[216:219], v[40:43], v[144:147], v[216:219]
    v_mfma_f32_16x16x32_bf16 v[212:215], v[40:43], v[140:143], v[212:215]
    ds_read_b128 v[40:43], v18 offset:46848
    v_mfma_f32_16x16x32_bf16 v[224:227], v[44:47], v[144:147], v[224:227]
    v_mfma_f32_16x16x32_bf16 v[220:223], v[44:47], v[140:143], v[220:223]
    ds_read_b128 v[44:47], v19 offset:46080
    v_mfma_f32_16x16x32_bf16 v[232:235], v[48:51], v[144:147], v[232:235]
    v_mfma_f32_16x16x32_bf16 v[228:231], v[48:51], v[140:143], v[228:231]
    ds_read_b128 v[48:51], v22 offset:46080
    s_waitcnt lgkmcnt(6)
    v_mfma_f32_16x16x32_bf16 v[240:243], v[52:55], v[144:147], v[240:243]
    v_mfma_f32_16x16x32_bf16 v[236:239], v[52:55], v[140:143], v[236:239]
    ds_read_b128 v[52:55], v22 offset:46336
    v_mfma_f32_16x16x32_bf16 v[248:251], v[56:59], v[144:147], v[248:251]
    v_mfma_f32_16x16x32_bf16 v[244:247], v[56:59], v[140:143], v[244:247]
    ds_read_b128 v[56:59], v22 offset:46592
    v_mfma_f32_16x16x32_bf16 v[64:67], v[60:63], v[144:147], v[64:67]
    v_mfma_f32_16x16x32_bf16 v[252:255], v[60:63], v[140:143], v[252:255]
    ds_read_b128 v[60:63], v22 offset:46848
    s_waitcnt lgkmcnt(6)
    v_mfma_f32_16x16x32_bf16 v[192:195], v[28:31], v[152:155], v[192:195]
    s_barrier
    v_mfma_f32_16x16x32_bf16 v[188:191], v[28:31], v[148:151], v[188:191]
    ds_read_b128 v[28:31], v18 offset:55296
    v_mfma_f32_16x16x32_bf16 v[200:203], v[32:35], v[152:155], v[200:203]
    v_mfma_f32_16x16x32_bf16 v[196:199], v[32:35], v[148:151], v[196:199]
    ds_read_b128 v[32:35], v18 offset:55552
    v_mfma_f32_16x16x32_bf16 v[208:211], v[36:39], v[152:155], v[208:211]
    v_mfma_f32_16x16x32_bf16 v[204:207], v[36:39], v[148:151], v[204:207]
    ds_read_b128 v[36:39], v18 offset:55808
    s_waitcnt lgkmcnt(6)
    v_mfma_f32_16x16x32_bf16 v[216:219], v[40:43], v[152:155], v[216:219]
    v_mfma_f32_16x16x32_bf16 v[212:215], v[40:43], v[148:151], v[212:215]
    ds_read_b128 v[40:43], v18 offset:56064
    v_mfma_f32_16x16x32_bf16 v[224:227], v[44:47], v[152:155], v[224:227]
    v_mfma_f32_16x16x32_bf16 v[220:223], v[44:47], v[148:151], v[220:223]
    ds_read_b128 v[44:47], v19 offset:55296
    v_mfma_f32_16x16x32_bf16 v[232:235], v[48:51], v[152:155], v[232:235]
    v_mfma_f32_16x16x32_bf16 v[228:231], v[48:51], v[148:151], v[228:231]
    ds_read_b128 v[48:51], v22 offset:55296
    s_waitcnt lgkmcnt(6)
    v_mfma_f32_16x16x32_bf16 v[240:243], v[52:55], v[152:155], v[240:243]
    v_mfma_f32_16x16x32_bf16 v[236:239], v[52:55], v[148:151], v[236:239]
    ds_read_b128 v[52:55], v22 offset:55552
    v_mfma_f32_16x16x32_bf16 v[248:251], v[56:59], v[152:155], v[248:251]
    v_mfma_f32_16x16x32_bf16 v[244:247], v[56:59], v[148:151], v[244:247]
    ds_read_b128 v[56:59], v22 offset:55808
    v_mfma_f32_16x16x32_bf16 v[64:67], v[60:63], v[152:155], v[64:67]
    v_mfma_f32_16x16x32_bf16 v[252:255], v[60:63], v[148:151], v[252:255]
    ds_read_b128 v[60:63], v22 offset:56064
    s_waitcnt lgkmcnt(6)
    v_mfma_f32_16x16x32_bf16 v[192:195], v[28:31], v[160:163], v[192:195]
    v_mfma_f32_16x16x32_bf16 v[188:191], v[28:31], v[156:159], v[188:191]
    ds_read_b128 v[28:31], v18 offset:64512
    v_mfma_f32_16x16x32_bf16 v[200:203], v[32:35], v[160:163], v[200:203]
    v_mfma_f32_16x16x32_bf16 v[196:199], v[32:35], v[156:159], v[196:199]
    ds_read_b128 v[32:35], v18 offset:64768
    v_mfma_f32_16x16x32_bf16 v[208:211], v[36:39], v[160:163], v[208:211]
    v_mfma_f32_16x16x32_bf16 v[204:207], v[36:39], v[156:159], v[204:207]
    ds_read_b128 v[36:39], v18 offset:65024
    s_waitcnt lgkmcnt(6)
    v_mfma_f32_16x16x32_bf16 v[216:219], v[40:43], v[160:163], v[216:219]
    v_mfma_f32_16x16x32_bf16 v[212:215], v[40:43], v[156:159], v[212:215]
    ds_read_b128 v[40:43], v18 offset:65280
    v_mfma_f32_16x16x32_bf16 v[224:227], v[44:47], v[160:163], v[224:227]
    v_mfma_f32_16x16x32_bf16 v[220:223], v[44:47], v[156:159], v[220:223]
    ds_read_b128 v[44:47], v19 offset:64512
    v_mfma_f32_16x16x32_bf16 v[232:235], v[48:51], v[160:163], v[232:235]
    v_mfma_f32_16x16x32_bf16 v[228:231], v[48:51], v[156:159], v[228:231]
    ds_read_b128 v[48:51], v22 offset:64512
    s_waitcnt lgkmcnt(6)
    v_mfma_f32_16x16x32_bf16 v[240:243], v[52:55], v[160:163], v[240:243]
    v_mfma_f32_16x16x32_bf16 v[236:239], v[52:55], v[156:159], v[236:239]
    ds_read_b128 v[52:55], v22 offset:64768
    v_mfma_f32_16x16x32_bf16 v[248:251], v[56:59], v[160:163], v[248:251]
    v_mfma_f32_16x16x32_bf16 v[244:247], v[56:59], v[156:159], v[244:247]
    ds_read_b128 v[56:59], v22 offset:65024
    v_mfma_f32_16x16x32_bf16 v[64:67], v[60:63], v[160:163], v[64:67]
    v_mfma_f32_16x16x32_bf16 v[252:255], v[60:63], v[156:159], v[252:255]
    ds_read_b128 v[60:63], v22 offset:65280
    s_waitcnt lgkmcnt(6)
    v_mfma_f32_16x16x32_bf16 v[192:195], v[28:31], v[168:171], v[192:195]
    s_barrier
    v_mfma_f32_16x16x32_bf16 v[188:191], v[28:31], v[164:167], v[188:191]
    ds_read_b128 v[28:31], v18 offset:0
    v_mfma_f32_16x16x32_bf16 v[200:203], v[32:35], v[168:171], v[200:203]
    v_mfma_f32_16x16x32_bf16 v[196:199], v[32:35], v[164:167], v[196:199]
    ds_read_b128 v[32:35], v18 offset:256
    v_mfma_f32_16x16x32_bf16 v[208:211], v[36:39], v[168:171], v[208:211]
    v_mfma_f32_16x16x32_bf16 v[204:207], v[36:39], v[164:167], v[204:207]
    ds_read_b128 v[36:39], v18 offset:512
    s_waitcnt lgkmcnt(6)
    v_mfma_f32_16x16x32_bf16 v[216:219], v[40:43], v[168:171], v[216:219]
    v_mfma_f32_16x16x32_bf16 v[212:215], v[40:43], v[164:167], v[212:215]
    ds_read_b128 v[40:43], v18 offset:768
    v_mfma_f32_16x16x32_bf16 v[224:227], v[44:47], v[168:171], v[224:227]
    v_mfma_f32_16x16x32_bf16 v[220:223], v[44:47], v[164:167], v[220:223]
    ds_read_b128 v[44:47], v19 offset:0
    v_mfma_f32_16x16x32_bf16 v[232:235], v[48:51], v[168:171], v[232:235]
    v_mfma_f32_16x16x32_bf16 v[228:231], v[48:51], v[164:167], v[228:231]
    ds_read_b128 v[48:51], v22 offset:0
    s_waitcnt lgkmcnt(6)
    v_mfma_f32_16x16x32_bf16 v[240:243], v[52:55], v[168:171], v[240:243]
    v_mfma_f32_16x16x32_bf16 v[236:239], v[52:55], v[164:167], v[236:239]
    ds_read_b128 v[52:55], v22 offset:256
    v_mfma_f32_16x16x32_bf16 v[248:251], v[56:59], v[168:171], v[248:251]
    v_mfma_f32_16x16x32_bf16 v[244:247], v[56:59], v[164:167], v[244:247]
    ds_read_b128 v[56:59], v22 offset:512
    v_mfma_f32_16x16x32_bf16 v[64:67], v[60:63], v[168:171], v[64:67]
    v_mfma_f32_16x16x32_bf16 v[252:255], v[60:63], v[164:167], v[252:255]
    ds_read_b128 v[60:63], v22 offset:768
    s_waitcnt lgkmcnt(6)
    v_mfma_f32_16x16x32_bf16 v[192:195], v[28:31], v[176:179], v[192:195]
    v_mfma_f32_16x16x32_bf16 v[188:191], v[28:31], v[172:175], v[188:191]
    ds_read_b128 v[28:31], v18 offset:9216
    v_mfma_f32_16x16x32_bf16 v[200:203], v[32:35], v[176:179], v[200:203]
    v_mfma_f32_16x16x32_bf16 v[196:199], v[32:35], v[172:175], v[196:199]
    ds_read_b128 v[32:35], v18 offset:9472
    v_mfma_f32_16x16x32_bf16 v[208:211], v[36:39], v[176:179], v[208:211]
    v_mfma_f32_16x16x32_bf16 v[204:207], v[36:39], v[172:175], v[204:207]
    ds_read_b128 v[36:39], v18 offset:9728
    s_waitcnt lgkmcnt(6)
    v_mfma_f32_16x16x32_bf16 v[216:219], v[40:43], v[176:179], v[216:219]
    v_mfma_f32_16x16x32_bf16 v[212:215], v[40:43], v[172:175], v[212:215]
    ds_read_b128 v[40:43], v18 offset:9984
    v_mfma_f32_16x16x32_bf16 v[224:227], v[44:47], v[176:179], v[224:227]
    v_mfma_f32_16x16x32_bf16 v[220:223], v[44:47], v[172:175], v[220:223]
    ds_read_b128 v[44:47], v19 offset:9216
    s_branch L_skip_9
    s_nop 0
L_stub_9:
    s_branch L_stub_10
L_skip_9:
    v_mfma_f32_16x16x32_bf16 v[232:235], v[48:51], v[176:179], v[232:235]
    v_mfma_f32_16x16x32_bf16 v[228:231], v[48:51], v[172:175], v[228:231]
    ds_read_b128 v[48:51], v22 offset:9216
    s_waitcnt lgkmcnt(6)
    v_mfma_f32_16x16x32_bf16 v[240:243], v[52:55], v[176:179], v[240:243]
    v_mfma_f32_16x16x32_bf16 v[236:239], v[52:55], v[172:175], v[236:239]
    ds_read_b128 v[52:55], v22 offset:9472
    v_mfma_f32_16x16x32_bf16 v[248:251], v[56:59], v[176:179], v[248:251]
    v_mfma_f32_16x16x32_bf16 v[244:247], v[56:59], v[172:175], v[244:247]
    ds_read_b128 v[56:59], v22 offset:9728
    v_mfma_f32_16x16x32_bf16 v[64:67], v[60:63], v[176:179], v[64:67]
    v_mfma_f32_16x16x32_bf16 v[252:255], v[60:63], v[172:175], v[252:255]
    ds_read_b128 v[60:63], v22 offset:9984
    s_waitcnt lgkmcnt(6)
    v_mfma_f32_16x16x32_bf16 v[192:195], v[28:31], v[184:187], v[192:195]
    s_barrier
    ds_read_b64_tr_b16 v[80:81], v21 offset:32768
    v_mfma_f32_16x16x32_bf16 v[188:191], v[28:31], v[180:183], v[188:191]
    ds_read_b128 v[28:31], v18 offset:18432
    v_mfma_f32_16x16x32_bf16 v[200:203], v[32:35], v[184:187], v[200:203]
    ds_read_b64_tr_b16 v[82:83], v21 offset:36864
    v_mfma_f32_16x16x32_bf16 v[196:199], v[32:35], v[180:183], v[196:199]
    ds_read_b128 v[32:35], v18 offset:18688
    v_mfma_f32_16x16x32_bf16 v[208:211], v[36:39], v[184:187], v[208:211]
    ds_read_b64_tr_b16 v[76:77], v20 offset:32768
    v_mfma_f32_16x16x32_bf16 v[204:207], v[36:39], v[180:183], v[204:207]
    ds_read_b128 v[36:39], v18 offset:18944
    s_waitcnt lgkmcnt(9)
    v_mfma_f32_16x16x32_bf16 v[216:219], v[40:43], v[184:187], v[216:219]
    ds_read_b64_tr_b16 v[78:79], v20 offset:36864
    v_mfma_f32_16x16x32_bf16 v[212:215], v[40:43], v[180:183], v[212:215]
    ds_read_b128 v[40:43], v18 offset:19200
    v_mfma_f32_16x16x32_bf16 v[224:227], v[44:47], v[184:187], v[224:227]
    v_mfma_f32_16x16x32_bf16 v[220:223], v[44:47], v[180:183], v[220:223]
    ds_read_b128 v[44:47], v19 offset:18432
    v_mfma_f32_16x16x32_bf16 v[232:235], v[48:51], v[184:187], v[232:235]
    v_mfma_f32_16x16x32_bf16 v[228:231], v[48:51], v[180:183], v[228:231]
    ds_read_b128 v[48:51], v22 offset:18432
    s_waitcnt lgkmcnt(10)
    v_mfma_f32_16x16x32_bf16 v[240:243], v[52:55], v[184:187], v[240:243]
    v_mfma_f32_16x16x32_bf16 v[236:239], v[52:55], v[180:183], v[236:239]
    ds_read_b128 v[52:55], v22 offset:18688
    v_mfma_f32_16x16x32_bf16 v[248:251], v[56:59], v[184:187], v[248:251]
    v_mfma_f32_16x16x32_bf16 v[244:247], v[56:59], v[180:183], v[244:247]
    ds_read_b128 v[56:59], v22 offset:18944
    v_mfma_f32_16x16x32_bf16 v[64:67], v[60:63], v[184:187], v[64:67]
    v_mfma_f32_16x16x32_bf16 v[252:255], v[60:63], v[180:183], v[252:255]
    ds_read_b128 v[60:63], v22 offset:19200
    s_waitcnt lgkmcnt(6)
    v_mfma_f32_16x16x32_bf16 v[192:195], v[28:31], v[80:83], v[192:195]
    ds_read_b64_tr_b16 v[88:89], v21 offset:40960
    v_mfma_f32_16x16x32_bf16 v[188:191], v[28:31], v[76:79], v[188:191]
    ds_read_b128 v[28:31], v18 offset:27648
    v_mfma_f32_16x16x32_bf16 v[200:203], v[32:35], v[80:83], v[200:203]
    ds_read_b64_tr_b16 v[90:91], v21 offset:45056
    v_mfma_f32_16x16x32_bf16 v[196:199], v[32:35], v[76:79], v[196:199]
    ds_read_b128 v[32:35], v18 offset:27904
    v_mfma_f32_16x16x32_bf16 v[208:211], v[36:39], v[80:83], v[208:211]
    ds_read_b64_tr_b16 v[84:85], v20 offset:40960
    v_mfma_f32_16x16x32_bf16 v[204:207], v[36:39], v[76:79], v[204:207]
    ds_read_b128 v[36:39], v18 offset:28160
    s_waitcnt lgkmcnt(9)
    v_mfma_f32_16x16x32_bf16 v[216:219], v[40:43], v[80:83], v[216:219]
    ds_read_b64_tr_b16 v[86:87], v20 offset:45056
    v_mfma_f32_16x16x32_bf16 v[212:215], v[40:43], v[76:79], v[212:215]
    ds_read_b128 v[40:43], v18 offset:28416
    v_mfma_f32_16x16x32_bf16 v[224:227], v[44:47], v[80:83], v[224:227]
    v_mfma_f32_16x16x32_bf16 v[220:223], v[44:47], v[76:79], v[220:223]
    ds_read_b128 v[44:47], v19 offset:27648
    v_mfma_f32_16x16x32_bf16 v[232:235], v[48:51], v[80:83], v[232:235]
    v_mfma_f32_16x16x32_bf16 v[228:231], v[48:51], v[76:79], v[228:231]
    ds_read_b128 v[48:51], v22 offset:27648
    s_waitcnt lgkmcnt(10)
    v_mfma_f32_16x16x32_bf16 v[240:243], v[52:55], v[80:83], v[240:243]
    v_mfma_f32_16x16x32_bf16 v[236:239], v[52:55], v[76:79], v[236:239]
    ds_read_b128 v[52:55], v22 offset:27904
    v_mfma_f32_16x16x32_bf16 v[248:251], v[56:59], v[80:83], v[248:251]
    v_mfma_f32_16x16x32_bf16 v[244:247], v[56:59], v[76:79], v[244:247]
    ds_read_b128 v[56:59], v22 offset:28160
    v_mfma_f32_16x16x32_bf16 v[64:67], v[60:63], v[80:83], v[64:67]
    v_mfma_f32_16x16x32_bf16 v[252:255], v[60:63], v[76:79], v[252:255]
    ds_read_b128 v[60:63], v22 offset:28416
    s_waitcnt lgkmcnt(6)
    v_mfma_f32_16x16x32_bf16 v[192:195], v[28:31], v[88:91], v[192:195]
    s_barrier
    ds_read_b64_tr_b16 v[80:81], v25 offset:0
    v_mfma_f32_16x16x32_bf16 v[188:191], v[28:31], v[84:87], v[188:191]
    ds_read_b128 v[28:31], v18 offset:36864
    v_mfma_f32_16x16x32_bf16 v[200:203], v[32:35], v[88:91], v[200:203]
    ds_read_b64_tr_b16 v[82:83], v25 offset:4096
    v_mfma_f32_16x16x32_bf16 v[196:199], v[32:35], v[84:87], v[196:199]
    ds_read_b128 v[32:35], v18 offset:37120
    v_mfma_f32_16x16x32_bf16 v[208:211], v[36:39], v[88:91], v[208:211]
    ds_read_b64_tr_b16 v[92:93], v24 offset:0
    v_mfma_f32_16x16x32_bf16 v[204:207], v[36:39], v[84:87], v[204:207]
    ds_read_b128 v[36:39], v18 offset:37376
    s_waitcnt lgkmcnt(9)
    v_mfma_f32_16x16x32_bf16 v[216:219], v[40:43], v[88:91], v[216:219]
    ds_read_b64_tr_b16 v[94:95], v24 offset:4096
    v_mfma_f32_16x16x32_bf16 v[212:215], v[40:43], v[84:87], v[212:215]
    ds_read_b128 v[40:43], v18 offset:37632
    v_mfma_f32_16x16x32_bf16 v[224:227], v[44:47], v[88:91], v[224:227]
    v_mfma_f32_16x16x32_bf16 v[220:223], v[44:47], v[84:87], v[220:223]
    ds_read_b128 v[44:47], v19 offset:36864
    v_mfma_f32_16x16x32_bf16 v[232:235], v[48:51], v[88:91], v[232:235]
    v_mfma_f32_16x16x32_bf16 v[228:231], v[48:51], v[84:87], v[228:231]
    ds_read_b128 v[48:51], v22 offset:36864
    s_waitcnt lgkmcnt(10)
    v_mfma_f32_16x16x32_bf16 v[240:243], v[52:55], v[88:91], v[240:243]
    v_mfma_f32_16x16x32_bf16 v[236:239], v[52:55], v[84:87], v[236:239]
    ds_read_b128 v[52:55], v22 offset:37120
    v_mfma_f32_16x16x32_bf16 v[248:251], v[56:59], v[88:91], v[248:251]
    v_mfma_f32_16x16x32_bf16 v[244:247], v[56:59], v[84:87], v[244:247]
    ds_read_b128 v[56:59], v22 offset:37376
    v_mfma_f32_16x16x32_bf16 v[64:67], v[60:63], v[88:91], v[64:67]
    v_mfma_f32_16x16x32_bf16 v[252:255], v[60:63], v[84:87], v[252:255]
    ds_read_b128 v[60:63], v22 offset:37632
    s_waitcnt lgkmcnt(7)
    v_mfma_f32_16x16x32_bf16 v[192:195], v[28:31], v[80:83], v[192:195]
    ds_read_b128 v[28:31], v18 offset:46080
    ds_read_b64_tr_b16 v[88:89], v25 offset:8192
    v_mfma_f32_16x16x32_bf16 v[200:203], v[32:35], v[80:83], v[200:203]
    ds_read_b128 v[32:35], v18 offset:46336
    ds_read_b64_tr_b16 v[90:91], v25 offset:12288
    v_mfma_f32_16x16x32_bf16 v[208:211], v[36:39], v[80:83], v[208:211]
    ds_read_b128 v[36:39], v18 offset:46592
    s_waitcnt lgkmcnt(8)
    v_mfma_f32_16x16x32_bf16 v[216:219], v[40:43], v[80:83], v[216:219]
    ds_read_b128 v[40:43], v18 offset:46848
    v_mfma_f32_16x16x32_bf16 v[224:227], v[44:47], v[80:83], v[224:227]
    ds_read_b128 v[44:47], v19 offset:46080
    v_mfma_f32_16x16x32_bf16 v[232:235], v[48:51], v[80:83], v[232:235]
    ds_read_b128 v[48:51], v22 offset:46080
    ds_read_b64_tr_b16 v[96:97], v24 offset:8192
    s_waitcnt lgkmcnt(9)
    v_mfma_f32_16x16x32_bf16 v[240:243], v[52:55], v[80:83], v[240:243]
    ds_read_b128 v[52:55], v22 offset:46336
    ds_read_b64_tr_b16 v[98:99], v24 offset:12288
    v_mfma_f32_16x16x32_bf16 v[248:251], v[56:59], v[80:83], v[248:251]
    ds_read_b128 v[56:59], v22 offset:46592
    v_mfma_f32_16x16x32_bf16 v[64:67], v[60:63], v[80:83], v[64:67]
    ds_read_b128 v[60:63], v22 offset:46848
    s_waitcnt lgkmcnt(8)
    v_mfma_f32_16x16x32_bf16 v[192:195], v[28:31], v[88:91], v[192:195]
    s_barrier
    ds_read_b128 v[28:31], v18 offset:55296
    ds_read_b64_tr_b16 v[80:81], v25 offset:16384
    v_mfma_f32_16x16x32_bf16 v[200:203], v[32:35], v[88:91], v[200:203]
    ds_read_b128 v[32:35], v18 offset:55552
    ds_read_b64_tr_b16 v[82:83], v25 offset:20480
    v_mfma_f32_16x16x32_bf16 v[208:211], v[36:39], v[88:91], v[208:211]
    ds_read_b128 v[36:39], v18 offset:55808
    s_waitcnt lgkmcnt(10)
    v_mfma_f32_16x16x32_bf16 v[216:219], v[40:43], v[88:91], v[216:219]
    ds_read_b128 v[40:43], v18 offset:56064
    v_mfma_f32_16x16x32_bf16 v[224:227], v[44:47], v[88:91], v[224:227]
    ds_read_b128 v[44:47], v19 offset:55296
    v_mfma_f32_16x16x32_bf16 v[232:235], v[48:51], v[88:91], v[232:235]
    ds_read_b128 v[48:51], v22 offset:55296
    ds_read_b64_tr_b16 v[100:101], v24 offset:16384
    s_waitcnt lgkmcnt(9)
    v_mfma_f32_16x16x32_bf16 v[240:243], v[52:55], v[88:91], v[240:243]
    ds_read_b128 v[52:55], v22 offset:55552
    ds_read_b64_tr_b16 v[102:103], v24 offset:20480
    v_mfma_f32_16x16x32_bf16 v[248:251], v[56:59], v[88:91], v[248:251]
    ds_read_b128 v[56:59], v22 offset:55808
    v_mfma_f32_16x16x32_bf16 v[64:67], v[60:63], v[88:91], v[64:67]
    ds_read_b128 v[60:63], v22 offset:56064
    s_waitcnt lgkmcnt(8)
    v_mfma_f32_16x16x32_bf16 v[192:195], v[28:31], v[80:83], v[192:195]
    ds_read_b128 v[28:31], v18 offset:64512
    ds_read_b64_tr_b16 v[88:89], v25 offset:24576
    v_mfma_f32_16x16x32_bf16 v[200:203], v[32:35], v[80:83], v[200:203]
    ds_read_b128 v[32:35], v18 offset:64768
    ds_read_b64_tr_b16 v[90:91], v25 offset:28672
    v_mfma_f32_16x16x32_bf16 v[208:211], v[36:39], v[80:83], v[208:211]
    ds_read_b128 v[36:39], v18 offset:65024
    s_waitcnt lgkmcnt(10)
    v_mfma_f32_16x16x32_bf16 v[216:219], v[40:43], v[80:83], v[216:219]
    ds_read_b128 v[40:43], v18 offset:65280
    v_mfma_f32_16x16x32_bf16 v[224:227], v[44:47], v[80:83], v[224:227]
    ds_read_b128 v[44:47], v19 offset:64512
    v_mfma_f32_16x16x32_bf16 v[232:235], v[48:51], v[80:83], v[232:235]
    ds_read_b128 v[48:51], v22 offset:64512
    ds_read_b64_tr_b16 v[104:105], v24 offset:24576
    s_waitcnt lgkmcnt(9)
    v_mfma_f32_16x16x32_bf16 v[240:243], v[52:55], v[80:83], v[240:243]
    ds_read_b128 v[52:55], v22 offset:64768
    ds_read_b64_tr_b16 v[106:107], v24 offset:28672
    v_mfma_f32_16x16x32_bf16 v[248:251], v[56:59], v[80:83], v[248:251]
    ds_read_b128 v[56:59], v22 offset:65024
    v_mfma_f32_16x16x32_bf16 v[64:67], v[60:63], v[80:83], v[64:67]
    ds_read_b128 v[60:63], v22 offset:65280
    s_waitcnt lgkmcnt(8)
    v_mfma_f32_16x16x32_bf16 v[192:195], v[28:31], v[88:91], v[192:195]
    s_barrier
    ds_read_b128 v[28:31], v18 offset:0
    ds_read_b64_tr_b16 v[80:81], v21 offset:0
    v_mfma_f32_16x16x32_bf16 v[200:203], v[32:35], v[88:91], v[200:203]
    ds_read_b128 v[32:35], v18 offset:256
    ds_read_b64_tr_b16 v[82:83], v21 offset:4096
    v_mfma_f32_16x16x32_bf16 v[208:211], v[36:39], v[88:91], v[208:211]
    ds_read_b128 v[36:39], v18 offset:512
    s_waitcnt lgkmcnt(10)
    v_mfma_f32_16x16x32_bf16 v[216:219], v[40:43], v[88:91], v[216:219]
    ds_read_b128 v[40:43], v18 offset:768
    v_mfma_f32_16x16x32_bf16 v[224:227], v[44:47], v[88:91], v[224:227]
    ds_read_b128 v[44:47], v19 offset:0
    v_mfma_f32_16x16x32_bf16 v[232:235], v[48:51], v[88:91], v[232:235]
    ds_read_b128 v[48:51], v22 offset:0
    ds_read_b64_tr_b16 v[108:109], v20 offset:0
    s_waitcnt lgkmcnt(9)
    v_mfma_f32_16x16x32_bf16 v[240:243], v[52:55], v[88:91], v[240:243]
    ds_read_b128 v[52:55], v22 offset:256
    ds_read_b64_tr_b16 v[110:111], v20 offset:4096
    v_mfma_f32_16x16x32_bf16 v[248:251], v[56:59], v[88:91], v[248:251]
    ds_read_b128 v[56:59], v22 offset:512
    v_mfma_f32_16x16x32_bf16 v[64:67], v[60:63], v[88:91], v[64:67]
    ds_read_b128 v[60:63], v22 offset:768
    s_waitcnt lgkmcnt(8)
    v_mfma_f32_16x16x32_bf16 v[192:195], v[28:31], v[80:83], v[192:195]
    ds_read_b128 v[28:31], v18 offset:9216
    ds_read_b64_tr_b16 v[88:89], v21 offset:8192
    v_mfma_f32_16x16x32_bf16 v[200:203], v[32:35], v[80:83], v[200:203]
    ds_read_b128 v[32:35], v18 offset:9472
    ds_read_b64_tr_b16 v[90:91], v21 offset:12288
    v_mfma_f32_16x16x32_bf16 v[208:211], v[36:39], v[80:83], v[208:211]
    ds_read_b128 v[36:39], v18 offset:9728
    s_waitcnt lgkmcnt(10)
    v_mfma_f32_16x16x32_bf16 v[216:219], v[40:43], v[80:83], v[216:219]
    ds_read_b128 v[40:43], v18 offset:9984
    v_mfma_f32_16x16x32_bf16 v[224:227], v[44:47], v[80:83], v[224:227]
    ds_read_b128 v[44:47], v19 offset:9216
    v_mfma_f32_16x16x32_bf16 v[232:235], v[48:51], v[80:83], v[232:235]
    ds_read_b128 v[48:51], v22 offset:9216
    ds_read_b64_tr_b16 v[112:113], v20 offset:8192
    s_waitcnt lgkmcnt(9)
    v_mfma_f32_16x16x32_bf16 v[240:243], v[52:55], v[80:83], v[240:243]
    ds_read_b128 v[52:55], v22 offset:9472
    ds_read_b64_tr_b16 v[114:115], v20 offset:12288
    v_mfma_f32_16x16x32_bf16 v[248:251], v[56:59], v[80:83], v[248:251]
    ds_read_b128 v[56:59], v22 offset:9728
    v_mfma_f32_16x16x32_bf16 v[64:67], v[60:63], v[80:83], v[64:67]
    ds_read_b128 v[60:63], v22 offset:9984
    s_waitcnt lgkmcnt(8)
    v_mfma_f32_16x16x32_bf16 v[192:195], v[28:31], v[88:91], v[192:195]
    s_barrier
    ds_read_b128 v[28:31], v18 offset:18432
    ds_read_b64_tr_b16 v[80:81], v21 offset:16384
    v_mfma_f32_16x16x32_bf16 v[200:203], v[32:35], v[88:91], v[200:203]
    ds_read_b128 v[32:35], v18 offset:18688
    ds_read_b64_tr_b16 v[82:83], v21 offset:20480
    v_mfma_f32_16x16x32_bf16 v[208:211], v[36:39], v[88:91], v[208:211]
    ds_read_b128 v[36:39], v18 offset:18944
    s_waitcnt lgkmcnt(10)
    v_mfma_f32_16x16x32_bf16 v[216:219], v[40:43], v[88:91], v[216:219]
    ds_read_b128 v[40:43], v18 offset:19200
    v_mfma_f32_16x16x32_bf16 v[224:227], v[44:47], v[88:91], v[224:227]
    ds_read_b128 v[44:47], v19 offset:18432
    v_mfma_f32_16x16x32_bf16 v[232:235], v[48:51], v[88:91], v[232:235]
    ds_read_b128 v[48:51], v22 offset:18432
    ds_read_b64_tr_b16 v[116:117], v20 offset:16384
    s_waitcnt lgkmcnt(9)
    v_mfma_f32_16x16x32_bf16 v[240:243], v[52:55], v[88:91], v[240:243]
    ds_read_b128 v[52:55], v22 offset:18688
    ds_read_b64_tr_b16 v[118:119], v20 offset:20480
    v_mfma_f32_16x16x32_bf16 v[248:251], v[56:59], v[88:91], v[248:251]
    ds_read_b128 v[56:59], v22 offset:18944
    v_mfma_f32_16x16x32_bf16 v[64:67], v[60:63], v[88:91], v[64:67]
    ds_read_b128 v[60:63], v22 offset:19200
    s_waitcnt lgkmcnt(8)
    v_mfma_f32_16x16x32_bf16 v[192:195], v[28:31], v[80:83], v[192:195]
    ds_read_b128 v[28:31], v18 offset:27648
    ds_read_b64_tr_b16 v[88:89], v21 offset:24576
    v_mfma_f32_16x16x32_bf16 v[200:203], v[32:35], v[80:83], v[200:203]
    ds_read_b128 v[32:35], v18 offset:27904
    ds_read_b64_tr_b16 v[90:91], v21 offset:28672
    v_mfma_f32_16x16x32_bf16 v[208:211], v[36:39], v[80:83], v[208:211]
    ds_read_b128 v[36:39], v18 offset:28160
    s_waitcnt lgkmcnt(10)
    v_mfma_f32_16x16x32_bf16 v[216:219], v[40:43], v[80:83], v[216:219]
    ds_read_b128 v[40:43], v18 offset:28416
    v_mfma_f32_16x16x32_bf16 v[224:227], v[44:47], v[80:83], v[224:227]
    ds_read_b128 v[44:47], v19 offset:27648
    v_mfma_f32_16x16x32_bf16 v[232:235], v[48:51], v[80:83], v[232:235]
    ds_read_b128 v[48:51], v22 offset:27648
    ds_read_b64_tr_b16 v[120:121], v20 offset:24576
    s_waitcnt lgkmcnt(9)
    v_mfma_f32_16x16x32_bf16 v[240:243], v[52:55], v[80:83], v[240:243]
    ds_read_b128 v[52:55], v22 offset:27904
    ds_read_b64_tr_b16 v[122:123], v20 offset:28672
    v_mfma_f32_16x16x32_bf16 v[248:251], v[56:59], v[80:83], v[248:251]
    ds_read_b128 v[56:59], v22 offset:28160
    v_mfma_f32_16x16x32_bf16 v[64:67], v[60:63], v[80:83], v[64:67]
    ds_read_b128 v[60:63], v22 offset:28416
    s_waitcnt lgkmcnt(8)
    v_mfma_f32_16x16x32_bf16 v[192:195], v[28:31], v[88:91], v[192:195]
    v_mfma_f32_16x16x32_bf16 v[200:203], v[32:35], v[88:91], v[200:203]
    v_mfma_f32_16x16x32_bf16 v[208:211], v[36:39], v[88:91], v[208:211]
    s_waitcnt lgkmcnt(5)
    v_mfma_f32_16x16x32_bf16 v[216:219], v[40:43], v[88:91], v[216:219]
    v_mfma_f32_16x16x32_bf16 v[224:227], v[44:47], v[88:91], v[224:227]
    v_mfma_f32_16x16x32_bf16 v[232:235], v[48:51], v[88:91], v[232:235]
    s_waitcnt lgkmcnt(0)
    v_mfma_f32_16x16x32_bf16 v[240:243], v[52:55], v[88:91], v[240:243]
    v_mfma_f32_16x16x32_bf16 v[248:251], v[56:59], v[88:91], v[248:251]
    v_mfma_f32_16x16x32_bf16 v[64:67], v[60:63], v[88:91], v[64:67]
    v_mfma_f32_16x16x32_bf16 v[220:223], v[44:47], v[120:123], v[220:223]
    ds_read_b128 v[44:47], v19 offset:36864
    v_mfma_f32_16x16x32_bf16 v[228:231], v[48:51], v[120:123], v[228:231]
    ds_read_b128 v[48:51], v22 offset:36864
    v_mfma_f32_16x16x32_bf16 v[236:239], v[52:55], v[120:123], v[236:239]
    ds_read_b128 v[52:55], v22 offset:37120
    v_mfma_f32_16x16x32_bf16 v[244:247], v[56:59], v[120:123], v[244:247]
    ds_read_b128 v[56:59], v22 offset:37376
    v_mfma_f32_16x16x32_bf16 v[252:255], v[60:63], v[120:123], v[252:255]
    ds_read_b128 v[60:63], v22 offset:37632
    v_mfma_f32_16x16x32_bf16 v[188:191], v[28:31], v[120:123], v[188:191]
    ds_read_b128 v[28:31], v18 offset:36864
    v_mfma_f32_16x16x32_bf16 v[196:199], v[32:35], v[120:123], v[196:199]
    ds_read_b128 v[32:35], v18 offset:37120
    v_mfma_f32_16x16x32_bf16 v[204:207], v[36:39], v[120:123], v[204:207]
    ds_read_b128 v[36:39], v18 offset:37376
    v_mfma_f32_16x16x32_bf16 v[212:215], v[40:43], v[120:123], v[212:215]
    ds_read_b128 v[40:43], v18 offset:37632
    s_waitcnt lgkmcnt(4)
    v_mfma_f32_16x16x32_bf16 v[220:223], v[44:47], v[92:95], v[220:223]
    ds_read_b128 v[44:47], v19 offset:46080
    v_cvt_pk_bf16_f32 v144, v224, v225
    v_cvt_pk_bf16_f32 v156, v226, v227
    v_mfma_f32_16x16x32_bf16 v[228:231], v[48:51], v[92:95], v[228:231]
    ds_read_b128 v[48:51], v22 offset:46080
    v_permlane32_swap_b32 v144, v156
    s_nop 1
    v_mov_b32_dpp v157, v156 quad_perm:[1,1,1,1] row_mask:0xf bank_mask:0xf
    v_mfma_f32_16x16x32_bf16 v[236:239], v[52:55], v[92:95], v[236:239]
    ds_read_b128 v[52:55], v22 offset:46336
    v_mov_b32_dpp v158, v156 quad_perm:[2,2,2,2] row_mask:0xf bank_mask:0xf
    v_mov_b32_dpp v159, v156 quad_perm:[3,3,3,3] row_mask:0xf bank_mask:0xf
    v_mfma_f32_16x16x32_bf16 v[244:247], v[56:59], v[92:95], v[244:247]
    ds_read_b128 v[56:59], v22 offset:46592
    v_cvt_pk_bf16_f32 v148, v232, v233
    v_cvt_pk_bf16_f32 v149, v234, v235
    v_mfma_f32_16x16x32_bf16 v[252:255], v[60:63], v[92:95], v[252:255]
    ds_read_b128 v[60:63], v22 offset:46848
    v_cvt_pk_bf16_f32 v150, v240, v241
    v_cvt_pk_bf16_f32 v151, v242, v243
    s_waitcnt lgkmcnt(0)
    v_mfma_f32_16x16x32_bf16 v[220:223], v[44:47], v[96:99], v[220:223]
    ds_read_b128 v[44:47], v19 offset:55296
    buffer_store_dwordx4 v[148:151], v9, s[36:39], s67 offen offset:0 sc1
    v_cvt_pk_bf16_f32 v152, v248, v249
    v_mfma_f32_16x16x32_bf16 v[228:231], v[48:51], v[96:99], v[228:231]
    ds_read_b128 v[48:51], v22 offset:55296
    v_cvt_pk_bf16_f32 v153, v250, v251
    v_cvt_pk_bf16_f32 v154, v64, v65
    v_mfma_f32_16x16x32_bf16 v[236:239], v[52:55], v[96:99], v[236:239]
    ds_read_b128 v[52:55], v22 offset:55552
    v_cvt_pk_bf16_f32 v155, v66, v67
    buffer_store_dwordx4 v[152:155], v9, s[36:39], s67 offen offset:1024 sc1
    v_mfma_f32_16x16x32_bf16 v[244:247], v[56:59], v[96:99], v[244:247]
    ds_read_b128 v[56:59], v22 offset:55808
    buffer_store_dwordx4 v[156:159], v26, s[36:39], s67 offen offset:2048 sc1
    v_mov_b32_dpp v145, v144 quad_perm:[1,1,1,1] row_mask:0xf bank_mask:0xf
    v_mfma_f32_16x16x32_bf16 v[252:255], v[60:63], v[96:99], v[252:255]
    ds_read_b128 v[60:63], v22 offset:56064
    v_mov_b32_dpp v146, v144 quad_perm:[2,2,2,2] row_mask:0xf bank_mask:0xf
    v_mov_b32_dpp v147, v144 quad_perm:[3,3,3,3] row_mask:0xf bank_mask:0xf
    s_waitcnt lgkmcnt(0)
    v_mfma_f32_16x16x32_bf16 v[220:223], v[44:47], v[100:103], v[220:223]
    ds_read_b128 v[44:47], v19 offset:64512
    v_cvt_pk_bf16_f32 v136, v192, v193
    v_cvt_pk_bf16_f32 v137, v194, v195
    v_mfma_f32_16x16x32_bf16 v[228:231], v[48:51], v[100:103], v[228:231]
    ds_read_b128 v[48:51], v22 offset:64512
    v_cvt_pk_bf16_f32 v138, v200, v201
    v_cvt_pk_bf16_f32 v139, v202, v203
    v_mfma_f32_16x16x32_bf16 v[236:239], v[52:55], v[100:103], v[236:239]
    ds_read_b128 v[52:55], v22 offset:64768
    buffer_store_dwordx4 v[136:139], v9, s[36:39], s66 offen offset:0 sc1
    v_cvt_pk_bf16_f32 v140, v208, v209
    v_mfma_f32_16x16x32_bf16 v[244:247], v[56:59], v[100:103], v[244:247]
    ds_read_b128 v[56:59], v22 offset:65024
    v_cvt_pk_bf16_f32 v141, v210, v211
    v_cvt_pk_bf16_f32 v142, v216, v217
    v_mfma_f32_16x16x32_bf16 v[252:255], v[60:63], v[100:103], v[252:255]
    ds_read_b128 v[60:63], v22 offset:65280
    v_cvt_pk_bf16_f32 v143, v218, v219
    buffer_store_dwordx4 v[140:143], v9, s[36:39], s66 offen offset:1024 sc1
    s_waitcnt lgkmcnt(0)
    v_mfma_f32_16x16x32_bf16 v[220:223], v[44:47], v[104:107], v[220:223]
    ds_read_b128 v[44:47], v19 offset:0
    buffer_store_dwordx4 v[144:147], v26, s[36:39], s66 offen offset:2048 sc1
    v_mfma_f32_16x16x32_bf16 v[228:231], v[48:51], v[104:107], v[228:231]
    ds_read_b128 v[48:51], v22 offset:0
    v_mfma_f32_16x16x32_bf16 v[236:239], v[52:55], v[104:107], v[236:239]
    ds_read_b128 v[52:55], v22 offset:256
    v_mfma_f32_16x16x32_bf16 v[244:247], v[56:59], v[104:107], v[244:247]
    ds_read_b128 v[56:59], v22 offset:512
    v_mfma_f32_16x16x32_bf16 v[252:255], v[60:63], v[104:107], v[252:255]
    ds_read_b128 v[60:63], v22 offset:768
    s_waitcnt lgkmcnt(0)
    v_mfma_f32_16x16x32_bf16 v[220:223], v[44:47], v[108:111], v[220:223]
    ds_read_b128 v[44:47], v19 offset:9216
    v_mfma_f32_16x16x32_bf16 v[228:231], v[48:51], v[108:111], v[228:231]
    ds_read_b128 v[48:51], v22 offset:9216
    v_mfma_f32_16x16x32_bf16 v[236:239], v[52:55], v[108:111], v[236:239]
    ds_read_b128 v[52:55], v22 offset:9472
    v_mfma_f32_16x16x32_bf16 v[244:247], v[56:59], v[108:111], v[244:247]
    ds_read_b128 v[56:59], v22 offset:9728
    v_mfma_f32_16x16x32_bf16 v[252:255], v[60:63], v[108:111], v[252:255]
    ds_read_b128 v[60:63], v22 offset:9984
    s_waitcnt lgkmcnt(0)
    v_mfma_f32_16x16x32_bf16 v[220:223], v[44:47], v[112:115], v[220:223]
    ds_read_b128 v[44:47], v19 offset:18432
    v_mfma_f32_16x16x32_bf16 v[228:231], v[48:51], v[112:115], v[228:231]
    ds_read_b128 v[48:51], v22 offset:18432
    v_mfma_f32_16x16x32_bf16 v[236:239], v[52:55], v[112:115], v[236:239]
    ds_read_b128 v[52:55], v22 offset:18688
    v_mfma_f32_16x16x32_bf16 v[244:247], v[56:59], v[112:115], v[244:247]
    ds_read_b128 v[56:59], v22 offset:18944
    v_mfma_f32_16x16x32_bf16 v[252:255], v[60:63], v[112:115], v[252:255]
    ds_read_b128 v[60:63], v22 offset:19200
    s_waitcnt lgkmcnt(0)
    v_mfma_f32_16x16x32_bf16 v[220:223], v[44:47], v[116:119], v[220:223]
    v_mfma_f32_16x16x32_bf16 v[228:231], v[48:51], v[116:119], v[228:231]
    v_mfma_f32_16x16x32_bf16 v[236:239], v[52:55], v[116:119], v[236:239]
    v_mfma_f32_16x16x32_bf16 v[244:247], v[56:59], v[116:119], v[244:247]
    v_mfma_f32_16x16x32_bf16 v[252:255], v[60:63], v[116:119], v[252:255]
    v_mfma_f32_16x16x32_bf16 v[188:191], v[28:31], v[92:95], v[188:191]
    ds_read_b128 v[28:31], v18 offset:46080
    v_mfma_f32_16x16x32_bf16 v[196:199], v[32:35], v[92:95], v[196:199]
    ds_read_b128 v[32:35], v18 offset:46336
    v_mfma_f32_16x16x32_bf16 v[204:207], v[36:39], v[92:95], v[204:207]
    ds_read_b128 v[36:39], v18 offset:46592
    v_mfma_f32_16x16x32_bf16 v[212:215], v[40:43], v[92:95], v[212:215]
    ds_read_b128 v[40:43], v18 offset:46848
    s_waitcnt lgkmcnt(0)
    v_mfma_f32_16x16x32_bf16 v[188:191], v[28:31], v[96:99], v[188:191]
    ds_read_b128 v[28:31], v18 offset:55296
    v_cvt_pk_bf16_f32 v13, v220, v221
    v_cvt_pk_bf16_f32 v132, v222, v223
    v_mfma_f32_16x16x32_bf16 v[196:199], v[32:35], v[96:99], v[196:199]
    ds_read_b128 v[32:35], v18 offset:55552
    v_permlane32_swap_b32 v13, v132
    s_nop 1
    v_mov_b32_dpp v133, v132 quad_perm:[1,1,1,1] row_mask:0xf bank_mask:0xf
    v_mfma_f32_16x16x32_bf16 v[204:207], v[36:39], v[96:99], v[204:207]
    ds_read_b128 v[36:39], v18 offset:55808
    v_mov_b32_dpp v134, v132 quad_perm:[2,2,2,2] row_mask:0xf bank_mask:0xf
    v_mov_b32_dpp v135, v132 quad_perm:[3,3,3,3] row_mask:0xf bank_mask:0xf
    v_mfma_f32_16x16x32_bf16 v[212:215], v[40:43], v[96:99], v[212:215]
    ds_read_b128 v[40:43], v18 offset:56064
    v_cvt_pk_bf16_f32 v124, v228, v229
    v_cvt_pk_bf16_f32 v125, v230, v231
    s_waitcnt lgkmcnt(0)
    v_mfma_f32_16x16x32_bf16 v[188:191], v[28:31], v[100:103], v[188:191]
    ds_read_b128 v[28:31], v18 offset:64512
    v_cvt_pk_bf16_f32 v126, v236, v237
    v_cvt_pk_bf16_f32 v127, v238, v239
    v_mfma_f32_16x16x32_bf16 v[196:199], v[32:35], v[100:103], v[196:199]
    ds_read_b128 v[32:35], v18 offset:64768
    buffer_store_dwordx4 v[124:127], v9, s[36:39], s65 offen offset:0 sc1
    v_cvt_pk_bf16_f32 v128, v244, v245
    v_mfma_f32_16x16x32_bf16 v[204:207], v[36:39], v[100:103], v[204:207]
    ds_read_b128 v[36:39], v18 offset:65024
    v_cvt_pk_bf16_f32 v129, v246, v247
    v_cvt_pk_bf16_f32 v130, v252, v253
    v_mfma_f32_16x16x32_bf16 v[212:215], v[40:43], v[100:103], v[212:215]
    ds_read_b128 v[40:43], v18 offset:65280
    v_cvt_pk_bf16_f32 v131, v254, v255
    buffer_store_dwordx4 v[128:131], v9, s[36:39], s65 offen offset:1024 sc1
    s_waitcnt lgkmcnt(0)
    v_mfma_f32_16x16x32_bf16 v[188:191], v[28:31], v[104:107], v[188:191]
    ds_read_b128 v[28:31], v18 offset:0
    buffer_store_dwordx4 v[132:135], v26, s[36:39], s65 offen offset:2048 sc1
    v_lshrrev_b32 v10, 2, v1
    v_mfma_f32_16x16x32_bf16 v[196:199], v[32:35], v[104:107], v[196:199]
    ds_read_b128 v[32:35], v18 offset:256
    v_and_b32 v11, 1, v1
    v_lshlrev_b32 v11, 4, v11
    v_mfma_f32_16x16x32_bf16 v[204:207], v[36:39], v[104:107], v[204:207]
    ds_read_b128 v[36:39], v18 offset:512
    v_mov_b32 v12, 0x3f80
    v_lshlrev_b32 v11, v11, v12
    v_mfma_f32_16x16x32_bf16 v[212:215], v[40:43], v[104:107], v[212:215]
    ds_read_b128 v[40:43], v18 offset:768
    v_and_b32 v12, 2, v1
    v_add_u32 v13, v10, v12
    s_waitcnt lgkmcnt(0)
    v_mfma_f32_16x16x32_bf16 v[188:191], v[28:31], v[108:111], v[188:191]
    ds_read_b128 v[28:31], v18 offset:9216
    v_cmp_eq_u32 vcc, v10, v2
    s_nop 1
    v_cndmask_b32 v80, 0, v11, vcc
    v_mfma_f32_16x16x32_bf16 v[196:199], v[32:35], v[108:111], v[196:199]
    ds_read_b128 v[32:35], v18 offset:9472
    v_cmp_eq_u32 vcc, v13, v2
    s_nop 1
    v_cndmask_b32 v76, 0, v11, vcc
    v_mfma_f32_16x16x32_bf16 v[204:207], v[36:39], v[108:111], v[204:207]
    ds_read_b128 v[36:39], v18 offset:9728
    v_cmp_gt_u32 vcc, 8, v1
    s_nop 1
    v_cndmask_b32 v76, 0, v76, vcc
    v_mfma_f32_16x16x32_bf16 v[212:215], v[40:43], v[108:111], v[212:215]
    ds_read_b128 v[40:43], v18 offset:9984
    v_cmp_eq_u32 vcc, 0, v12
    s_nop 1
    v_cndmask_b32 v81, v80, 0, vcc
    s_waitcnt lgkmcnt(0)
    v_mfma_f32_16x16x32_bf16 v[188:191], v[28:31], v[112:115], v[188:191]
    ds_read_b128 v[28:31], v18 offset:18432
    v_cndmask_b32 v80, 0, v80, vcc
    v_mov_b32 v77, v76
    v_mfma_f32_16x16x32_bf16 v[196:199], v[32:35], v[112:115], v[196:199]
    ds_read_b128 v[32:35], v18 offset:18688
    v_mov_b64 v[78:79], 0
    v_mov_b64 v[82:83], 0
    s_nop 0
    v_mfma_f32_16x16x32_bf16 v[204:207], v[36:39], v[112:115], v[204:207]
    ds_read_b128 v[36:39], v18 offset:18944
    v_mfma_f32_16x16x32_bf16 v[212:215], v[40:43], v[112:115], v[212:215]
    ds_read_b128 v[40:43], v18 offset:19200
    s_waitcnt lgkmcnt(0)
    v_mfma_f32_16x16x32_bf16 v[188:191], v[28:31], v[116:119], v[188:191]
    v_mfma_f32_16x16x32_bf16 v[196:199], v[32:35], v[116:119], v[196:199]
    v_mfma_f32_16x16x32_bf16 v[204:207], v[36:39], v[116:119], v[204:207]
    v_mfma_f32_16x16x32_bf16 v[212:215], v[40:43], v[116:119], v[212:215]
    s_barrier
    ds_read_b64 v[28:29], v4 offset:0
    ds_read_b128 v[160:163], v6 offset:0
    ds_read_b64 v[30:31], v4 offset:32
    ds_read_b128 v[164:167], v6 offset:64
    ds_read_b64 v[32:33], v4 offset:64
    ds_read_b128 v[168:171], v6 offset:128
    ds_read_b64 v[34:35], v4 offset:96
    ds_read_b128 v[172:175], v6 offset:192
    ds_read_b64 v[36:37], v5
    ds_read_b128 v[176:179], v23
    s_mul_i32 s49, s3, 4608
    s_add_u32 s49, s49, 49152
    v_add_u32 v73, s49, v27
    s_waitcnt lgkmcnt(9)
    v_lshlrev_b32 v44, 16, v28
    v_and_b32 v45, 0xffff0000, v28
    v_lshlrev_b32 v46, 16, v29
    v_and_b32 v47, 0xffff0000, v29
    s_waitcnt lgkmcnt(7)
    v_lshlrev_b32 v48, 16, v30
    v_and_b32 v49, 0xffff0000, v30
    v_lshlrev_b32 v50, 16, v31
    v_and_b32 v51, 0xffff0000, v31
    s_waitcnt lgkmcnt(5)
    v_lshlrev_b32 v52, 16, v32
    s_branch L_skip_10
L_stub_10:
    s_branch L_back_c3
L_skip_10:
    v_and_b32 v53, 0xffff0000, v32
    v_lshlrev_b32 v54, 16, v33
    v_and_b32 v55, 0xffff0000, v33
    s_waitcnt lgkmcnt(3)
    v_lshlrev_b32 v56, 16, v34
    v_and_b32 v57, 0xffff0000, v34
    v_lshlrev_b32 v58, 16, v35
    v_and_b32 v59, 0xffff0000, v35
    s_waitcnt lgkmcnt(1)
    v_lshlrev_b32 v60, 16, v36
    v_and_b32 v61, 0xffff0000, v36
    v_lshlrev_b32 v62, 16, v37
    v_and_b32 v63, 0xffff0000, v37
    s_waitcnt vmcnt(0)
    v_mov_b32 v133, 0
    v_mov_b64 v[134:135], 0
    v_mov_b64 v[146:147], 0
    buffer_load_dwordx4 v[124:127], v9, s[36:39], s64 offen offset:0 sc1
    buffer_load_dwordx4 v[128:131], v9, s[36:39], s64 offen offset:1024 sc1
    buffer_load_dword v132, v27, s[36:39], s64 offen offset:2048 sc1
    s_barrier
    ds_read_b128 v[136:139], v71 offset:0
    ds_read_b128 v[140:143], v71 offset:1024
    ds_read_b128 v[148:151], v71 offset:2304
    ds_read_b128 v[152:155], v71 offset:3328
    ds_read_b32 v144, v73 offset:2048
    ds_read_b32 v145, v73 offset:4352
    s_waitcnt lgkmcnt(5)
    v_mfma_f32_16x16x32_bf16 v[188:191], v[80:83], v[136:139], v[188:191]
    v_mfma_f32_16x16x32_bf16 v[196:199], v[78:81], v[136:139], v[196:199]
    s_waitcnt lgkmcnt(4)
    v_mfma_f32_16x16x32_bf16 v[204:207], v[80:83], v[140:143], v[204:207]
    v_mfma_f32_16x16x32_bf16 v[212:215], v[78:81], v[140:143], v[212:215]
    s_waitcnt lgkmcnt(3)
    v_mfma_f32_16x16x32_bf16 v[188:191], v[80:83], v[148:151], v[188:191]
    v_mfma_f32_16x16x32_bf16 v[196:199], v[78:81], v[148:151], v[196:199]
    s_waitcnt lgkmcnt(2)
    v_mfma_f32_16x16x32_bf16 v[204:207], v[80:83], v[152:155], v[204:207]
    v_mfma_f32_16x16x32_bf16 v[212:215], v[78:81], v[152:155], v[212:215]
    s_waitcnt lgkmcnt(0)
    v_mfma_f32_16x16x32_bf16 v[220:223], v[76:79], v[144:147], v[220:223]
    s_waitcnt vmcnt(0)
    v_max3_u32 v10, v124, v128, v132
    v_cmp_eq_u32 vcc, -1, v10
    s_nop 0
    s_cbranch_vccz L_m_27
Lp_m_28:
    buffer_load_dwordx4 v[124:127], v9, s[36:39], s64 offen offset:0 sc1
    buffer_load_dwordx4 v[128:131], v9, s[36:39], s64 offen offset:1024 sc1
    buffer_load_dword v132, v27, s[36:39], s64 offen offset:2048 sc1
    s_waitcnt vmcnt(0)
    v_max3_u32 v10, v124, v128, v132
    v_cmp_eq_u32 vcc, -1, v10
    s_nop 0
    s_cbranch_vccz Le_m_29
    s_sub_u32 s7, s7, 1
    s_cbranch_scc1 Le_m_29
    s_mov_b64 exec, vcc
    s_sleep 1
    s_branch Lp_m_28
Le_m_29:
    s_mov_b64 exec, -1
    s_max_i32 s7, s7, 0
L_m_27:
    v_mfma_f32_16x16x32_bf16 v[188:191], v[80:83], v[124:127], v[188:191]
    v_mfma_f32_16x16x32_bf16 v[196:199], v[78:81], v[124:127], v[196:199]
    v_mfma_f32_16x16x32_bf16 v[204:207], v[80:83], v[128:131], v[204:207]
    v_mfma_f32_16x16x32_bf16 v[212:215], v[78:81], v[128:131], v[212:215]
    v_mfma_f32_16x16x32_bf16 v[220:223], v[76:79], v[132:135], v[220:223]
    s_nop 3
    v_pk_fma_f32 v[44:45], v[188:189], v[160:161], v[44:45]
    v_pk_fma_f32 v[46:47], v[190:191], v[162:163], v[46:47]
    v_cvt_pk_bf16_f32 v28, v44, v45
    v_cvt_pk_bf16_f32 v29, v46, v47
    ds_write_b64 v4, v[28:29] offset:0
    v_pk_fma_f32 v[48:49], v[196:197], v[164:165], v[48:49]
    v_pk_fma_f32 v[50:51], v[198:199], v[166:167], v[50:51]
    v_cvt_pk_bf16_f32 v30, v48, v49
    v_cvt_pk_bf16_f32 v31, v50, v51
    ds_write_b64 v4, v[30:31] offset:32
    v_pk_fma_f32 v[52:53], v[204:205], v[168:169], v[52:53]
    v_pk_fma_f32 v[54:55], v[206:207], v[170:171], v[54:55]
    v_cvt_pk_bf16_f32 v32, v52, v53
    v_cvt_pk_bf16_f32 v33, v54, v55
    ds_write_b64 v4, v[32:33] offset:64
    v_pk_fma_f32 v[56:57], v[212:213], v[172:173], v[56:57]
    v_pk_fma_f32 v[58:59], v[214:215], v[174:175], v[58:59]
    v_cvt_pk_bf16_f32 v34, v56, v57
    v_cvt_pk_bf16_f32 v35, v58, v59
    ds_write_b64 v4, v[34:35] offset:96
    v_pk_fma_f32 v[60:61], v[220:221], v[176:177], v[60:61]
    v_pk_fma_f32 v[62:63], v[222:223], v[178:179], v[62:63]
    v_cvt_pk_bf16_f32 v36, v60, v61
    v_cvt_pk_bf16_f32 v37, v62, v63
    ds_write_b64 v5, v[36:37]
    ds_read_b128 v[160:163], v7 offset:0
    ds_read_b128 v[164:167], v7 offset:1024
    ds_read_b128 v[168:171], v7 offset:2048
    s_waitcnt lgkmcnt(2)
    buffer_store_dwordx4 v[160:163], v68, s[44:47], s62 offen sc1
    s_waitcnt lgkmcnt(1)
    buffer_store_dwordx4 v[164:167], v69, s[44:47], s62 offen sc1
    s_waitcnt lgkmcnt(0)
    buffer_store_dwordx4 v[168:171], v70, s[44:47], s62 offen sc1
    s_branch L_end
L_m_30:
    s_sub_u32 s61, s63, 54
    s_lshr_b32 s62, s61, 1
    s_add_u32 s62, s62, 18
    s_and_b32 s61, s61, 1
    s_cmp_ge_u32 s5, 16
    s_cbranch_scc1 L_m_35
    s_lshl_b32 s67, s4, 4
    s_add_u32 s67, s67, s5
    s_and_b32 s67, s67, 127
    s_lshl_b32 s48, s3, 9
    s_add_u32 s48, s48, s67
    s_mul_i32 s69, s3, 6144
    s_add_u32 s69, s69, 36864
    s_cmp_eq_u32 s67, 0
    s_cselect_b32 s68, 38, 0
    s_add_u32 s68, s68, 152
    v_mov_b32 v8, 2146435072
    v_add_u32 v4, 0, v0
    v_mul_u32_u24 v5, 1725, v4
    v_lshrrev_b32 v5, 16, v5
    v_mul_u32_u24 v6, 38, v5
    v_sub_u32 v6, v4, v6
    v_cmp_gt_u32 vcc, s68, v4
    v_lshl_add_u32 v5, v5, 7, s48
    v_and_b32 v5, 2047, v5
    v_mul_u32_u24 v5, 578, v5
    v_and_b32 v5, 0xfffffff0, v5
    v_lshl_add_u32 v5, v6, 4, v5
    v_cndmask_b32 v20, v8, v5, vcc
    v_add_u32 v4, 64, v0
    v_mul_u32_u24 v5, 1725, v4
    v_lshrrev_b32 v5, 16, v5
    v_mul_u32_u24 v6, 38, v5
    v_sub_u32 v6, v4, v6
    v_cmp_gt_u32 vcc, s68, v4
    v_lshl_add_u32 v5, v5, 7, s48
    v_and_b32 v5, 2047, v5
    v_mul_u32_u24 v5, 578, v5
    v_and_b32 v5, 0xfffffff0, v5
    v_lshl_add_u32 v5, v6, 4, v5
    v_cndmask_b32 v21, v8, v5, vcc
    v_add_u32 v4, 128, v0
    v_mul_u32_u24 v5, 1725, v4
    v_lshrrev_b32 v5, 16, v5
    v_mul_u32_u24 v6, 38, v5
    v_sub_u32 v6, v4, v6
    v_cmp_gt_u32 vcc, s68, v4
    v_lshl_add_u32 v5, v5, 7, s48
    v_and_b32 v5, 2047, v5
    v_mul_u32_u24 v5, 578, v5
    v_and_b32 v5, 0xfffffff0, v5
    v_lshl_add_u32 v5, v6, 4, v5
    v_cndmask_b32 v22, v8, v5, vcc
    s_waitcnt lgkmcnt(0)
    s_mov_b32 s36, s32
    s_mov_b32 s37, s33
    s_mov_b32 s38, 50331648
    s_mov_b32 s39, 0x20000
    s_mov_b32 s40, s26
    s_mov_b32 s41, s27
    s_mov_b32 s42, 3981312
    s_mov_b32 s43, 0x20000
    v_mov_b32 v4, 32768
    buffer_load_dword v3, v4, s[36:39], 0 offen sc1
    s_lshr_b32 s51, s5, 2
    s_lshl_b32 s51, s51, 3
    s_add_u32 s51, s51, s4
    s_and_b32 s60, s5, 3
    s_lshl_b32 s35, s51, 2
    s_add_u32 s35, s35, s60
    s_lshl_b32 s35, s35, 14
    s_bfe_u32 s48, s6, 0x20002
    s_lshl_b32 s48, s48, 6
    s_lshr_b32 s49, s6, 4
    s_lshl_b32 s49, s49, 2
    s_add_u32 s48, s48, s49
    s_and_b32 s49, s6, 3
    s_add_u32 s48, s48, s49
    s_lshl_b32 s48, s48, 4
    s_lshl_b32 s49, s3, 16
    s_add_u32 s48, s48, s49
    s_add_u32 s48, s48, 15728640
    v_mov_b32 v17, 2146435072
    v_writelane_b32 v17, s48, 0
    s_add_u32 s48, s48, 16384
    s_add_u32 s48, s2, 160
    s_lshl_b32 s48, s48, 7
    s_add_u32 s48, s48, 557056
    s_lshl_b32 s49, s3, 8
    s_add_u32 s49, s49, s5
    s_cmp_lt_u32 s49, 12
    s_cselect_b32 s48, s48, 2146435072
    v_mov_b32 v19, 2146435072
    v_writelane_b32 v19, s48, 0
    s_or_b32 s48, s2, s3
    s_cmp_eq_u32 s48, 0
    s_cselect_b32 s48, 0, 2146435072
    s_add_u32 s48, s48, 32768
    v_writelane_b32 v19, s48, 1
    buffer_load_dword v220, v17, s[36:39], 0 offen
    buffer_load_dword v221, v19, s[36:39], 0 offen
    v_cvt_f32_u32 v218, v2
    v_mul_f32 v218, 4.0, v218
    v_cvt_f32_u32 v219, v1
    v_cvt_f32_u32 v13, s4
    v_mul_f32 v10, 0x3d800000, v219
    v_fmac_f32 v10, 0x3c000000, v13
    v_mul_f32 v11, v218, v10
    v_cos_f32 v5, v11
    v_sin_f32 v6, v11
    s_nop 0
    v_cvt_pk_bf16_f32 v52, v5, v6
    v_cvt_pk_bf16_f32 v56, -v6, v5
    v_fma_f32 v7, v10, 1.0, v11
    v_cos_f32 v8, v7
    v_sin_f32 v9, v7
    s_nop 0
    v_cvt_pk_bf16_f32 v53, v8, v9
    v_cvt_pk_bf16_f32 v57, -v9, v8
    v_fma_f32 v4, v10, 2.0, v11
    v_cos_f32 v5, v4
    v_sin_f32 v6, v4
    s_nop 0
    v_cvt_pk_bf16_f32 v54, v5, v6
    v_cvt_pk_bf16_f32 v58, -v6, v5
    v_add_f32 v7, v4, v10
    v_cos_f32 v8, v7
    v_sin_f32 v9, v7
    s_nop 0
    v_cvt_pk_bf16_f32 v55, v8, v9
    v_cvt_pk_bf16_f32 v59, -v9, v8
    s_lshl_b32 s48, s3, 5
    s_add_u32 s48, s48, s4
    v_cvt_f32_u32 v14, s48
    v_mul_f32 v14, 0x3a000000, v14
    v_mul_f32 v10, 0x3d800000, v219
    v_add_f32 v10, v10, v14
    v_mul_f32 v11, v218, v10
    v_cos_f32 v5, v11
    v_sin_f32 v6, v11
    s_nop 0
    v_cvt_pk_bf16_f32 v68, v5, v6
    v_cvt_pk_bf16_f32 v72, -v6, v5
    v_fma_f32 v7, v10, 1.0, v11
    v_cos_f32 v8, v7
    v_sin_f32 v9, v7
    s_nop 0
    v_cvt_pk_bf16_f32 v69, v8, v9
    v_cvt_pk_bf16_f32 v73, -v9, v8
    v_fma_f32 v4, v10, 2.0, v11
    v_cos_f32 v5, v4
    v_sin_f32 v6, v4
    s_nop 0
    v_cvt_pk_bf16_f32 v70, v5, v6
    v_cvt_pk_bf16_f32 v74, -v6, v5
    v_add_f32 v7, v4, v10
    v_cos_f32 v8, v7
    v_sin_f32 v9, v7
    s_nop 0
    v_cvt_pk_bf16_f32 v71, v8, v9
    v_cvt_pk_bf16_f32 v75, -v9, v8
    v_add_f32 v10, 0x3b800000, v10
    v_mul_f32 v11, v218, v10
    v_cos_f32 v5, v11
    v_sin_f32 v6, v11
    s_nop 0
    v_cvt_pk_bf16_f32 v76, v5, v6
    v_cvt_pk_bf16_f32 v80, -v6, v5
    v_fma_f32 v7, v10, 1.0, v11
    v_cos_f32 v8, v7
    v_sin_f32 v9, v7
    s_nop 0
    v_cvt_pk_bf16_f32 v77, v8, v9
    v_cvt_pk_bf16_f32 v81, -v9, v8
    v_fma_f32 v4, v10, 2.0, v11
    v_cos_f32 v5, v4
    v_sin_f32 v6, v4
    s_nop 0
    v_cvt_pk_bf16_f32 v78, v5, v6
    v_cvt_pk_bf16_f32 v82, -v6, v5
    v_add_f32 v7, v4, v10
    v_cos_f32 v8, v7
    v_sin_f32 v9, v7
    s_nop 0
    v_cvt_pk_bf16_f32 v79, v8, v9
    v_cvt_pk_bf16_f32 v83, -v9, v8
    v_add_f32 v10, 0x3b800000, v10
    v_mul_f32 v11, v218, v10
    v_cos_f32 v5, v11
    v_sin_f32 v6, v11
    s_nop 0
    v_cvt_pk_bf16_f32 v84, v5, v6
    v_cvt_pk_bf16_f32 v88, -v6, v5
    v_fma_f32 v7, v10, 1.0, v11
    v_cos_f32 v8, v7
    v_sin_f32 v9, v7
    s_nop 0
    v_cvt_pk_bf16_f32 v85, v8, v9
    v_cvt_pk_bf16_f32 v89, -v9, v8
    v_fma_f32 v4, v10, 2.0, v11
    v_cos_f32 v5, v4
    v_sin_f32 v6, v4
    s_nop 0
    v_cvt_pk_bf16_f32 v86, v5, v6
    v_cvt_pk_bf16_f32 v90, -v6, v5
    v_add_f32 v7, v4, v10
    v_cos_f32 v8, v7
    v_sin_f32 v9, v7
    s_nop 0
    v_cvt_pk_bf16_f32 v87, v8, v9
    v_cvt_pk_bf16_f32 v91, -v9, v8
    v_add_f32 v10, 0x3b800000, v10
    v_mul_f32 v11, v218, v10
    v_cos_f32 v5, v11
    v_sin_f32 v6, v11
    s_nop 0
    v_cvt_pk_bf16_f32 v92, v5, v6
    v_cvt_pk_bf16_f32 v96, -v6, v5
    v_fma_f32 v7, v10, 1.0, v11
    v_cos_f32 v8, v7
    v_sin_f32 v9, v7
    s_nop 0
    v_cvt_pk_bf16_f32 v93, v8, v9
    v_cvt_pk_bf16_f32 v97, -v9, v8
    v_fma_f32 v4, v10, 2.0, v11
    v_cos_f32 v5, v4
    v_sin_f32 v6, v4
    s_nop 0
    v_cvt_pk_bf16_f32 v94, v5, v6
    v_cvt_pk_bf16_f32 v98, -v6, v5
    v_add_f32 v7, v4, v10
    v_cos_f32 v8, v7
    v_sin_f32 v9, v7
    s_nop 0
    v_cvt_pk_bf16_f32 v95, v8, v9
    v_cvt_pk_bf16_f32 v99, -v9, v8
    s_barrier
    s_mov_b32 s52, s10
    s_mov_b32 s53, s11
    s_mov_b32 s54, 1183744
    s_mov_b32 s55, 0x20000
    s_mov_b32 s56, s12
    s_mov_b32 s57, s13
    s_mov_b32 s58, 1183744
    s_mov_b32 s59, 0x20000
    s_add_u32 m0, s69, 0
    s_nop 0
    buffer_load_dwordx4 v20, s[52:55], 0 offen lds
    s_add_u32 m0, s69, 1024
    s_nop 0
    buffer_load_dwordx4 v21, s[52:55], 0 offen lds
    s_add_u32 m0, s69, 2048
    s_nop 0
    buffer_load_dwordx4 v22, s[52:55], 0 offen lds
    s_add_u32 m0, s69, 3072
    s_nop 0
    buffer_load_dwordx4 v20, s[56:59], 0 offen lds
    s_add_u32 m0, s69, 4096
    s_nop 0
    buffer_load_dwordx4 v21, s[56:59], 0 offen lds
    s_add_u32 m0, s69, 5120
    s_nop 0
    buffer_load_dwordx4 v22, s[56:59], 0 offen lds
    s_lshl_b32 s48, s67, 1
    s_and_b32 s48, s48, 15
    s_add_u32 s48, s48, s69
    v_and_b32 v4, 1, v2
    v_lshrrev_b32 v5, 1, v2
    v_mul_u32_u24 v6, 144, v4
    v_mad_u32_u24 v6, v1, 9, v6
    v_add_lshl_u32 v6, v6, v5, 1
    v_add_u32 v20, s48, v6
    s_cmp_eq_u32 s67, 0
    s_cselect_b32 s49, 608, 0
    s_add_u32 s48, s48, s49
    s_add_u32 s48, s48, 568
    v_sub_u32 v21, s48, v6
    v_lshl_add_u32 v4, v5, 5, v4
    v_lshlrev_b32 v4, 14, v4
    v_lshl_add_u32 v23, v1, 4, v4
    v_add_u32 v24, 1048576, v23
    v_add_u32 v25, 2097152, v23
    v_cmp_gt_u32 vcc, 32, v0
    v_mov_b32 v8, 2146435072
    s_nop 0
    v_cndmask_b32 v25, v8, v25, vcc
    s_lshl_b32 s48, s67, 2
    s_add_u32 s48, s48, s3
    s_lshl_b32 s48, s48, 4
    s_add_u32 s48, s48, 262144
    v_writelane_b32 v18, s48, 0
    buffer_load_dword v222, v18, s[36:39], 0 offen
    s_mov_b32 s48, s67
    s_mov_b32 s49, s3
    s_and_b32 s50, s48, 7
    s_lshr_b32 s48, s48, 3
    s_lshl_b32 s58, s50, 16
    s_lshl_b32 s59, s48, 10
    s_add_u32 s58, s58, s59
    s_lshl_b32 s59, s49, 8
    s_add_u32 s58, s58, s59
    s_add_u32 s56, s58, 1048576
    s_sub_u32 s48, 128, s67
    s_and_b32 s48, s48, 127
    s_sub_u32 s49, 3, s3
    s_and_b32 s50, s48, 7
    s_lshr_b32 s48, s48, 3
    s_lshl_b32 s58, s50, 16
    s_lshl_b32 s59, s48, 10
    s_add_u32 s58, s58, s59
    s_lshl_b32 s59, s49, 8
    s_add_u32 s58, s58, s59
    s_add_u32 s57, s58, 1081344
    s_waitcnt vmcnt(0)
    s_mov_b32 s48, 0x9e3779b1
    v_mul_lo_u32 v3, v3, s48
    v_add_u32 v3, 0x7f4a7c15, v3
    v_or_b32 v3, 0x01010101, v3
    ds_read_u16 v132, v20 offset:0
    ds_read_u16 v136, v20 offset:3072
    ds_read_u16 v133, v20 offset:608
    ds_read_u16 v137, v20 offset:3680
    ds_read_u16 v134, v20 offset:1216
    ds_read_u16 v138, v20 offset:4288
    ds_read_u16 v135, v20 offset:1824
    ds_read_u16 v139, v20 offset:4896
    ds_read_u16 v140, v20 offset:4
    ds_read_u16 v144, v20 offset:3076
    ds_read_u16 v141, v20 offset:612
    ds_read_u16 v145, v20 offset:3684
    ds_read_u16 v142, v20 offset:1220
    ds_read_u16 v146, v20 offset:4292
    ds_read_u16 v143, v20 offset:1828
    ds_read_u16 v147, v20 offset:4900
    ds_read_u16 v148, v20 offset:8
    ds_read_u16 v152, v20 offset:3080
    ds_read_u16 v149, v20 offset:616
    ds_read_u16 v153, v20 offset:3688
    ds_read_u16 v150, v20 offset:1224
    ds_read_u16 v154, v20 offset:4296
    ds_read_u16 v151, v20 offset:1832
    ds_read_u16 v155, v20 offset:4904
    ds_read_u16 v156, v21 offset:1832
    ds_read_u16 v160, v21 offset:4904
    ds_read_u16 v157, v21 offset:1224
    ds_read_u16 v161, v21 offset:4296
    ds_read_u16 v158, v21 offset:616
    ds_read_u16 v162, v21 offset:3688
    ds_read_u16 v159, v21 offset:8
    ds_read_u16 v163, v21 offset:3080
    ds_read_u16 v164, v21 offset:1828
    ds_read_u16 v168, v21 offset:4900
    ds_read_u16 v165, v21 offset:1220
    ds_read_u16 v169, v21 offset:4292
    ds_read_u16 v166, v21 offset:612
    ds_read_u16 v170, v21 offset:3684
    ds_read_u16 v167, v21 offset:4
    ds_read_u16 v171, v21 offset:3076
    ds_read_u16 v172, v21 offset:1824
    ds_read_u16 v176, v21 offset:4896
    ds_read_u16 v173, v21 offset:1216
    ds_read_u16 v177, v21 offset:4288
    ds_read_u16 v174, v21 offset:608
    ds_read_u16 v178, v21 offset:3680
    ds_read_u16 v175, v21 offset:0
    ds_read_u16 v179, v21 offset:3072
    s_waitcnt lgkmcnt(14)
    v_lshl_or_b32 v132, v136, 16, v132
    v_lshl_or_b32 v133, v137, 16, v133
    v_lshl_or_b32 v134, v138, 16, v134
    v_lshl_or_b32 v135, v139, 16, v135
    buffer_store_dwordx4 v[132:135], v23, s[36:39], s56 offen sc1
    v_lshl_or_b32 v140, v144, 16, v140
    v_lshl_or_b32 v141, v145, 16, v141
    v_lshl_or_b32 v142, v146, 16, v142
    v_lshl_or_b32 v143, v147, 16, v143
    buffer_store_dwordx4 v[140:143], v24, s[36:39], s56 offen sc1
    v_lshl_or_b32 v148, v152, 16, v148
    v_lshl_or_b32 v149, v153, 16, v149
    v_lshl_or_b32 v150, v154, 16, v150
    v_lshl_or_b32 v151, v155, 16, v151
    buffer_store_dwordx4 v[148:151], v25, s[36:39], s56 offen sc1
    v_lshl_or_b32 v156, v160, 16, v156
    v_lshl_or_b32 v157, v161, 16, v157
    v_lshl_or_b32 v158, v162, 16, v158
    v_lshl_or_b32 v159, v163, 16, v159
    v_xor_b32 v156, 0x80000000, v156
    v_xor_b32 v157, 0x80000000, v157
    v_xor_b32 v158, 0x80000000, v158
    v_xor_b32 v159, 0x80000000, v159
    buffer_store_dwordx4 v[156:159], v23, s[36:39], s57 offen sc1
    v_lshl_or_b32 v164, v168, 16, v164
    s_waitcnt lgkmcnt(12)
    v_lshl_or_b32 v165, v169, 16, v165
    s_waitcnt lgkmcnt(10)
    v_lshl_or_b32 v166, v170, 16, v166
    s_waitcnt lgkmcnt(8)
    v_lshl_or_b32 v167, v171, 16, v167
    v_xor_b32 v164, 0x80000000, v164
    v_xor_b32 v165, 0x80000000, v165
    v_xor_b32 v166, 0x80000000, v166
    v_xor_b32 v167, 0x80000000, v167
    buffer_store_dwordx4 v[164:167], v24, s[36:39], s57 offen sc1
    s_waitcnt lgkmcnt(6)
    v_lshl_or_b32 v172, v176, 16, v172
    s_waitcnt lgkmcnt(4)
    v_lshl_or_b32 v173, v177, 16, v173
    s_waitcnt lgkmcnt(2)
    v_lshl_or_b32 v174, v178, 16, v174
    s_waitcnt lgkmcnt(0)
    v_lshl_or_b32 v175, v179, 16, v175
    v_xor_b32 v172, 0x80000000, v172
    v_xor_b32 v173, 0x80000000, v173
    v_xor_b32 v174, 0x80000000, v174
    v_xor_b32 v175, 0x80000000, v175
    buffer_store_dwordx4 v[172:175], v25, s[36:39], s57 offen sc1
    s_branch L_m_34
L_m_35:
    v_lshrrev_b32 v4, 3, v0
    v_and_b32 v5, 7, v0
    v_and_b32 v6, 6, v4
    v_xor_b32 v5, v5, v6
    v_mul_u32_u24 v4, 6912, v4
    v_lshl_add_u32 v12, v5, 4, v4
    s_lshl_b32 s48, s61, 2
    s_add_u32 s48, s48, s3
    s_mul_i32 s48, s48, 497664
    s_lshl_b32 s49, s62, 7
    s_add_u32 s47, s48, s49
    s_lshl_b32 s50, s3, 8
    v_lshl_add_u32 v27, v0, 2, s50
    s_mul_i32 s49, s61, 576
    v_add_u32 v9, s49, v27
    v_add_u32 v12, s47, v12
    v_lshrrev_b32 v4, 2, v0
    v_bfe_u32 v5, v4, 1, 2
    v_xor_b32 v5, s3, v5
    v_lshlrev_b32 v5, 5, v5
    v_lshlrev_b32 v4, 7, v4
    v_and_b32 v6, 3, v0
    v_lshlrev_b32 v6, 3, v6
    v_add3_u32 v28, v4, v5, v6
    v_lshlrev_b32 v29, 3, v2
    v_add_u32 v29, 90112, v29
    s_mul_i32 s49, s61, 9216
    s_lshl_b32 s50, s62, 8
    s_add_u32 s49, s49, s50
    s_lshl_b32 s50, s3, 6
    s_add_u32 s49, s49, s50
    s_add_u32 s49, s49, 192000
    v_lshl_add_u32 v4, v1, 2, s49
    v_cmp_gt_u32 vcc, 16, v0
    v_mov_b32 v5, 2146435072
    s_nop 0
    v_cndmask_b32 v30, v5, v4, vcc
    s_waitcnt lgkmcnt(0)
    s_mov_b32 s36, s32
    s_mov_b32 s37, s33
    s_mov_b32 s38, 50331648
    s_mov_b32 s39, 0x20000
    s_mov_b32 s40, s26
    s_mov_b32 s41, s27
    s_mov_b32 s42, 3981312
    s_mov_b32 s43, 0x20000
    v_mov_b32 v4, 32768
    buffer_load_dword v3, v4, s[36:39], 0 offen sc1
    s_mov_b32 s44, s24
    s_mov_b32 s45, s25
    s_mov_b32 s46, 1152
    s_mov_b32 s47, 0x20000
    buffer_load_dword v26, v9, s[44:47], 0 offen
    s_lshr_b32 s51, s5, 2
    s_lshl_b32 s51, s51, 3
    s_add_u32 s51, s51, s4
    s_and_b32 s60, s5, 3
    s_lshl_b32 s35, s51, 2
    s_add_u32 s35, s35, s60
    s_lshl_b32 s35, s35, 14
    s_bfe_u32 s48, s6, 0x20002
    s_lshl_b32 s48, s48, 6
    s_lshr_b32 s49, s6, 4
    s_lshl_b32 s49, s49, 2
    s_add_u32 s48, s48, s49
    s_and_b32 s49, s6, 3
    s_add_u32 s48, s48, s49
    s_lshl_b32 s48, s48, 4
    s_lshl_b32 s49, s3, 16
    s_add_u32 s48, s48, s49
    s_add_u32 s48, s48, 15728640
    v_mov_b32 v17, 2146435072
    v_writelane_b32 v17, s48, 0
    s_add_u32 s48, s48, 16384
    s_add_u32 s48, s2, 160
    s_lshl_b32 s48, s48, 7
    s_add_u32 s48, s48, 557056
    s_lshl_b32 s49, s3, 8
    s_add_u32 s49, s49, s5
    s_cmp_lt_u32 s49, 12
    s_cselect_b32 s48, s48, 2146435072
    v_mov_b32 v19, 2146435072
    v_writelane_b32 v19, s48, 0
    s_or_b32 s48, s2, s3
    s_cmp_eq_u32 s48, 0
    s_cselect_b32 s48, 0, 2146435072
    s_add_u32 s48, s48, 32768
    v_writelane_b32 v19, s48, 1
    buffer_load_dword v220, v17, s[36:39], 0 offen
    buffer_load_dword v221, v19, s[36:39], 0 offen
    buffer_load_dword v222, v30, s[36:39], 0 offen
    s_cmp_ge_u32 s63, 126
    s_cbranch_scc1 L_m_37
    s_mul_i32 m0, s3, 9216
    s_mov_b32 s59, 0
    buffer_load_dwordx4 v12, s[40:43], s59 offen lds
    s_add_u32 m0, m0, 1024
    s_add_u32 s59, s59, 55296
    buffer_load_dwordx4 v12, s[40:43], s59 offen lds
    s_add_u32 m0, m0, 1024
    s_add_u32 s59, s59, 55296
L_m_37:
    s_barrier
    s_waitcnt vmcnt(0)
    s_cmp_ge_u32 s63, 126
    s_cbranch_scc1 L_m_38
    buffer_load_dwordx4 v12, s[40:43], s59 offen lds
    s_add_u32 m0, m0, 1024
    s_add_u32 s59, s59, 55296
    buffer_load_dwordx4 v12, s[40:43], s59 offen lds
    s_add_u32 m0, m0, 1024
    s_add_u32 s59, s59, 55296
    buffer_load_dwordx4 v12, s[40:43], s59 offen lds
    s_add_u32 m0, m0, 1024
    s_add_u32 s59, s59, 55296
    buffer_load_dwordx4 v12, s[40:43], s59 offen lds
    s_add_u32 m0, m0, 1024
    s_add_u32 s59, s59, 55296
    buffer_load_dwordx4 v12, s[40:43], s59 offen lds
    s_add_u32 m0, m0, 1024
    s_add_u32 s59, s59, 55296
    buffer_load_dwordx4 v12, s[40:43], s59 offen lds
    s_add_u32 m0, m0, 1024
    s_add_u32 s59, s59, 55296
    buffer_load_dwordx4 v12, s[40:43], s59 offen lds
L_m_38:
    s_mov_b32 s48, 0x9e3779b1
    v_mul_lo_u32 v3, v3, s48
    v_add_u32 v3, 0x7f4a7c15, v3
    v_or_b32 v3, 0x01010101, v3
    v_lshlrev_b32 v4, 16, v26
    v_and_b32 v5, 0xffff0000, v26
    v_mul_f32 v6, 0xbfb8aa3b, v4
    v_mul_f32 v7, 0xbfb8aa3b, v5
    v_exp_f32 v6, v6
    v_exp_f32 v7, v7
    v_add_f32 v6, 1.0, v6
    v_add_f32 v7, 1.0, v7
    v_rcp_f32 v6, v6
    v_rcp_f32 v7, v7
    v_mul_f32 v4, v4, v6
    v_mul_f32 v5, v5, v7
    v_cvt_pk_bf16_f32 v26, v4, v5
    v_add_u32 v27, 90112, v27
    ds_write_b32 v27, v26
    s_cmp_ge_u32 s5, 20
    s_cbranch_scc1 L_m_39
    v_cvt_f32_u32 v218, v2
    v_mul_f32 v218, 4.0, v218
    v_cvt_f32_u32 v219, v1
    v_cvt_f32_u32 v13, s4
    v_mul_f32 v10, 0x3d800000, v219
    v_fmac_f32 v10, 0x3c000000, v13
    v_mul_f32 v11, v218, v10
    v_cos_f32 v5, v11
    v_sin_f32 v6, v11
    s_nop 0
    v_cvt_pk_bf16_f32 v52, v5, v6
    v_cvt_pk_bf16_f32 v56, -v6, v5
    v_fma_f32 v7, v10, 1.0, v11
    v_cos_f32 v8, v7
    v_sin_f32 v9, v7
    s_nop 0
    v_cvt_pk_bf16_f32 v53, v8, v9
    v_cvt_pk_bf16_f32 v57, -v9, v8
    v_fma_f32 v4, v10, 2.0, v11
    v_cos_f32 v5, v4
    v_sin_f32 v6, v4
    s_nop 0
    v_cvt_pk_bf16_f32 v54, v5, v6
    v_cvt_pk_bf16_f32 v58, -v6, v5
    v_add_f32 v7, v4, v10
    v_cos_f32 v8, v7
    v_sin_f32 v9, v7
    s_nop 0
    v_cvt_pk_bf16_f32 v55, v8, v9
    v_cvt_pk_bf16_f32 v59, -v9, v8
    s_lshl_b32 s48, s3, 5
    s_add_u32 s48, s48, s4
    v_cvt_f32_u32 v14, s48
    v_mul_f32 v14, 0x3a000000, v14
    v_mul_f32 v10, 0x3d800000, v219
    v_add_f32 v10, v10, v14
    v_mul_f32 v11, v218, v10
    v_cos_f32 v5, v11
    v_sin_f32 v6, v11
    s_nop 0
    v_cvt_pk_bf16_f32 v68, v5, v6
    v_cvt_pk_bf16_f32 v72, -v6, v5
    v_fma_f32 v7, v10, 1.0, v11
    v_cos_f32 v8, v7
    v_sin_f32 v9, v7
    s_nop 0
    v_cvt_pk_bf16_f32 v69, v8, v9
    v_cvt_pk_bf16_f32 v73, -v9, v8
    v_fma_f32 v4, v10, 2.0, v11
    v_cos_f32 v5, v4
    v_sin_f32 v6, v4
    s_nop 0
    v_cvt_pk_bf16_f32 v70, v5, v6
    v_cvt_pk_bf16_f32 v74, -v6, v5
    v_add_f32 v7, v4, v10
    v_cos_f32 v8, v7
    v_sin_f32 v9, v7
    s_nop 0
    v_cvt_pk_bf16_f32 v71, v8, v9
    v_cvt_pk_bf16_f32 v75, -v9, v8
    v_add_f32 v10, 0x3b800000, v10
    v_mul_f32 v11, v218, v10
    v_cos_f32 v5, v11
    v_sin_f32 v6, v11
    s_nop 0
    v_cvt_pk_bf16_f32 v76, v5, v6
    v_cvt_pk_bf16_f32 v80, -v6, v5
    v_fma_f32 v7, v10, 1.0, v11
    v_cos_f32 v8, v7
    v_sin_f32 v9, v7
    s_nop 0
    v_cvt_pk_bf16_f32 v77, v8, v9
    v_cvt_pk_bf16_f32 v81, -v9, v8
    v_fma_f32 v4, v10, 2.0, v11
    v_cos_f32 v5, v4
    v_sin_f32 v6, v4
    s_nop 0
    v_cvt_pk_bf16_f32 v78, v5, v6
    v_cvt_pk_bf16_f32 v82, -v6, v5
    v_add_f32 v7, v4, v10
    v_cos_f32 v8, v7
    v_sin_f32 v9, v7
    s_nop 0
    v_cvt_pk_bf16_f32 v79, v8, v9
    v_cvt_pk_bf16_f32 v83, -v9, v8
    v_add_f32 v10, 0x3b800000, v10
    v_mul_f32 v11, v218, v10
    v_cos_f32 v5, v11
    v_sin_f32 v6, v11
    s_nop 0
    v_cvt_pk_bf16_f32 v84, v5, v6
    v_cvt_pk_bf16_f32 v88, -v6, v5
    v_fma_f32 v7, v10, 1.0, v11
    v_cos_f32 v8, v7
    v_sin_f32 v9, v7
    s_nop 0
    v_cvt_pk_bf16_f32 v85, v8, v9
    v_cvt_pk_bf16_f32 v89, -v9, v8
    v_fma_f32 v4, v10, 2.0, v11
    v_cos_f32 v5, v4
    v_sin_f32 v6, v4
    s_nop 0
    v_cvt_pk_bf16_f32 v86, v5, v6
    v_cvt_pk_bf16_f32 v90, -v6, v5
    v_add_f32 v7, v4, v10
    v_cos_f32 v8, v7
    v_sin_f32 v9, v7
    s_nop 0
    v_cvt_pk_bf16_f32 v87, v8, v9
    v_cvt_pk_bf16_f32 v91, -v9, v8
    v_add_f32 v10, 0x3b800000, v10
    v_mul_f32 v11, v218, v10
    v_cos_f32 v5, v11
    v_sin_f32 v6, v11
    s_nop 0
    v_cvt_pk_bf16_f32 v92, v5, v6
    v_cvt_pk_bf16_f32 v96, -v6, v5
    v_fma_f32 v7, v10, 1.0, v11
    v_cos_f32 v8, v7
    v_sin_f32 v9, v7
    s_nop 0
    v_cvt_pk_bf16_f32 v93, v8, v9
    v_cvt_pk_bf16_f32 v97, -v9, v8
    v_fma_f32 v4, v10, 2.0, v11
    v_cos_f32 v5, v4
    v_sin_f32 v6, v4
    s_nop 0
    v_cvt_pk_bf16_f32 v94, v5, v6
    v_cvt_pk_bf16_f32 v98, -v6, v5
    v_add_f32 v7, v4, v10
    v_cos_f32 v8, v7
    v_sin_f32 v9, v7
    s_nop 0
    v_cvt_pk_bf16_f32 v95, v8, v9
    v_cvt_pk_bf16_f32 v99, -v9, v8
L_m_39:
L_m_34:
    s_waitcnt lgkmcnt(0)
    s_barrier
    s_cmp_ge_u32 s5, 20
    s_cbranch_scc1 L_m_40
    s_waitcnt vmcnt(0)
    buffer_store_dword v3, v18, s[36:39], 0 offen sc1
    v_mul_f32 v10, 0x3d800000, v219
    v_fmac_f32 v14, 0x3d800000, v218
    v_mul_f32 v11, v219, v14
    v_cos_f32 v5, v11
    v_sin_f32 v6, v11
    s_nop 0
    v_cvt_pk_bf16_f32 v100, v5, -v6
    v_cvt_pk_bf16_f32 v104, v6, v5
    v_fma_f32 v7, v10, 1.0, v11
    v_cos_f32 v8, v7
    v_sin_f32 v9, v7
    s_nop 0
    v_cvt_pk_bf16_f32 v101, v8, -v9
    v_cvt_pk_bf16_f32 v105, v9, v8
    v_fma_f32 v4, v10, 2.0, v11
    v_cos_f32 v5, v4
    v_sin_f32 v6, v4
    s_nop 0
    v_cvt_pk_bf16_f32 v102, v5, -v6
    v_cvt_pk_bf16_f32 v106, v6, v5
    v_add_f32 v7, v4, v10
    v_cos_f32 v8, v7
    v_sin_f32 v9, v7
    s_nop 0
    v_cvt_pk_bf16_f32 v103, v8, -v9
    v_cvt_pk_bf16_f32 v107, v9, v8
    v_add_f32 v14, 0x3b800000, v14
    v_mul_f32 v11, v219, v14
    v_cos_f32 v5, v11
    v_sin_f32 v6, v11
    s_nop 0
    v_cvt_pk_bf16_f32 v108, v5, -v6
    v_cvt_pk_bf16_f32 v112, v6, v5
    v_fma_f32 v7, v10, 1.0, v11
    v_cos_f32 v8, v7
    v_sin_f32 v9, v7
    s_nop 0
    v_cvt_pk_bf16_f32 v109, v8, -v9
    v_cvt_pk_bf16_f32 v113, v9, v8
    v_fma_f32 v4, v10, 2.0, v11
    v_cos_f32 v5, v4
    v_sin_f32 v6, v4
    s_nop 0
    v_cvt_pk_bf16_f32 v110, v5, -v6
    v_cvt_pk_bf16_f32 v114, v6, v5
    v_add_f32 v7, v4, v10
    v_cos_f32 v8, v7
    v_sin_f32 v9, v7
    s_nop 0
    v_cvt_pk_bf16_f32 v111, v8, -v9
    v_cvt_pk_bf16_f32 v115, v9, v8
    v_add_f32 v14, 0x3b800000, v14
    v_mul_f32 v11, v219, v14
    v_cos_f32 v5, v11
    v_sin_f32 v6, v11
    s_nop 0
    v_cvt_pk_bf16_f32 v116, v5, -v6
    v_cvt_pk_bf16_f32 v120, v6, v5
    v_fma_f32 v7, v10, 1.0, v11
    v_cos_f32 v8, v7
    v_sin_f32 v9, v7
    s_nop 0
    v_cvt_pk_bf16_f32 v117, v8, -v9
    v_cvt_pk_bf16_f32 v121, v9, v8
    v_fma_f32 v4, v10, 2.0, v11
    v_cos_f32 v5, v4
    v_sin_f32 v6, v4
    s_nop 0
    v_cvt_pk_bf16_f32 v118, v5, -v6
    v_cvt_pk_bf16_f32 v122, v6, v5
    v_add_f32 v7, v4, v10
    v_cos_f32 v8, v7
    v_sin_f32 v9, v7
    s_nop 0
    v_cvt_pk_bf16_f32 v119, v8, -v9
    v_cvt_pk_bf16_f32 v123, v9, v8
    v_add_f32 v14, 0x3b800000, v14
    v_mul_f32 v11, v219, v14
    v_cos_f32 v5, v11
    v_sin_f32 v6, v11
    s_nop 0
    v_cvt_pk_bf16_f32 v124, v5, -v6
    v_cvt_pk_bf16_f32 v128, v6, v5
    v_fma_f32 v7, v10, 1.0, v11
    v_cos_f32 v8, v7
    v_sin_f32 v9, v7
    s_nop 0
    v_cvt_pk_bf16_f32 v125, v8, -v9
    v_cvt_pk_bf16_f32 v129, v9, v8
    v_fma_f32 v4, v10, 2.0, v11
    v_cos_f32 v5, v4
    v_sin_f32 v6, v4
    s_nop 0
    v_cvt_pk_bf16_f32 v126, v5, -v6
    v_cvt_pk_bf16_f32 v130, v6, v5
    v_add_f32 v7, v4, v10
    v_cos_f32 v8, v7
    v_sin_f32 v9, v7
    s_nop 0
    v_cvt_pk_bf16_f32 v127, v8, -v9
    v_cvt_pk_bf16_f32 v131, v9, v8
    v_mul_f32 v13, 0x3c000000, v13
    v_fmac_f32 v13, 0x3d800000, v218
    v_mul_f32 v11, v219, v13
    v_cos_f32 v5, v11
    v_sin_f32 v6, v11
    s_nop 0
    v_cvt_pk_bf16_f32 v60, v5, -v6
    v_cvt_pk_bf16_f32 v64, v6, v5
    v_fma_f32 v7, v10, 1.0, v11
    v_cos_f32 v8, v7
    v_sin_f32 v9, v7
    s_nop 0
    v_cvt_pk_bf16_f32 v61, v8, -v9
    v_cvt_pk_bf16_f32 v65, v9, v8
    v_fma_f32 v4, v10, 2.0, v11
    v_cos_f32 v5, v4
    v_sin_f32 v6, v4
    s_nop 0
    v_cvt_pk_bf16_f32 v62, v5, -v6
    v_cvt_pk_bf16_f32 v66, v6, v5
    v_add_f32 v7, v4, v10
    v_cos_f32 v8, v7
    v_sin_f32 v9, v7
    s_nop 0
    v_cvt_pk_bf16_f32 v63, v8, -v9
    v_cvt_pk_bf16_f32 v67, v9, v8
L_m_40:
    s_branch L_stub_11
L_back_h1:
    s_waitcnt vmcnt(0)
    s_lshl_b32 s48, s3, 5
    s_add_u32 s48, s48, s4
    v_lshrrev_b32 v8, 2, v1
    v_lshl_add_u32 v8, v8, 3, s48
    s_cmp_lt_u32 s60, 2
    s_cselect_b32 s48, 1, -1
    v_mul_i32_i24 v8, s48, v8
    v_and_b32 v8, 127, v8
    v_and_b32 v7, 3, v1
    v_lshl_add_u32 v8, v8, 2, v7
    v_lshlrev_b32 v15, 4, v8
    s_mov_b32 s64, 262144
    s_cmp_ge_u32 s5, 20
    s_cbranch_scc1 L_m_41
    buffer_load_dword v18, v15, s[36:39], s64 offen sc1
L_m_41:
    s_barrier
    buffer_store_dword v3, v17, s[36:39], 0 offen sc1
    s_cmp_ge_u32 s63, 126
    s_cbranch_scc1 L_m_42
    ds_read_b64_tr_b16 v[132:133], v28 offset:0
    ds_read_b64_tr_b16 v[134:135], v28 offset:2048
    ds_read2_b64 v[136:139], v29 offset0:0 offset1:4
    ds_read_b64_tr_b16 v[140:141], v28 offset:4096
    ds_read_b64_tr_b16 v[142:143], v28 offset:6144
    ds_read2_b64 v[144:147], v29 offset0:8 offset1:12
    ds_read_b64_tr_b16 v[148:149], v28 offset:8192
    ds_read_b64_tr_b16 v[150:151], v28 offset:10240
    ds_read2_b64 v[152:155], v29 offset0:16 offset1:20
    ds_read_b64_tr_b16 v[156:157], v28 offset:12288
    ds_read_b64_tr_b16 v[158:159], v28 offset:14336
    ds_read2_b64 v[160:163], v29 offset0:24 offset1:28
    ds_read_b64_tr_b16 v[164:165], v28 offset:16384
    ds_read_b64_tr_b16 v[166:167], v28 offset:18432
    ds_read2_b64 v[168:171], v29 offset0:32 offset1:36
    ds_read_b64_tr_b16 v[172:173], v28 offset:20480
    ds_read_b64_tr_b16 v[174:175], v28 offset:22528
    ds_read2_b64 v[176:179], v29 offset0:40 offset1:44
    ds_read_b64_tr_b16 v[180:181], v28 offset:24576
    ds_read_b64_tr_b16 v[182:183], v28 offset:26624
    ds_read2_b64 v[184:187], v29 offset0:48 offset1:52
    ds_read_b64_tr_b16 v[188:189], v28 offset:28672
    ds_read_b64_tr_b16 v[190:191], v28 offset:30720
    ds_read2_b64 v[192:195], v29 offset0:56 offset1:60
    ds_read_b64_tr_b16 v[196:197], v28 offset:32768
    ds_read_b64_tr_b16 v[198:199], v28 offset:34816
    ds_read2_b64 v[200:203], v29 offset0:64 offset1:68
    v_and_b32 v4, 3, v1
    v_or_b32 v4, 0x07060500, v4
    s_waitcnt lgkmcnt(14)
    v_mfma_f32_16x16x32_bf16 v[36:39], v[136:139], v[132:135], 0
    v_mfma_f32_16x16x32_bf16 v[36:39], v[144:147], v[140:143], v[36:39]
    v_mfma_f32_16x16x32_bf16 v[36:39], v[152:155], v[148:151], v[36:39]
    v_mfma_f32_16x16x32_bf16 v[36:39], v[160:163], v[156:159], v[36:39]
    s_waitcnt lgkmcnt(12)
    v_mfma_f32_16x16x32_bf16 v[36:39], v[168:171], v[164:167], v[36:39]
    s_waitcnt lgkmcnt(9)
    v_mfma_f32_16x16x32_bf16 v[36:39], v[176:179], v[172:175], v[36:39]
    s_waitcnt lgkmcnt(6)
    v_mfma_f32_16x16x32_bf16 v[36:39], v[184:187], v[180:183], v[36:39]
    s_waitcnt lgkmcnt(3)
    v_mfma_f32_16x16x32_bf16 v[36:39], v[192:195], v[188:191], v[36:39]
    s_waitcnt lgkmcnt(0)
    v_mfma_f32_16x16x32_bf16 v[36:39], v[200:203], v[196:199], v[36:39]
    s_nop 7
    v_add_u32 v40, 0x80, v36
    v_perm_b32 v40, v40, v3, v4
    s_mov_b32 s48, 0
    buffer_store_dword v40, v30, s[36:39], s48 offen sc1
L_m_42:
    s_cmp_lt_u32 s5, 20
    s_cbranch_scc1 L_m_32
    s_mov_b32 s52, s16
    s_mov_b32 s53, s17
    s_mov_b32 s54, 18874368
    s_mov_b32 s55, 0x20000
    s_mul_i32 s58, s3, 12
    s_add_u32 s58, s58, s5
    s_add_u32 s58, s58, -20
L_m_43:
    s_cmp_ge_u32 s58, 96
    s_cbranch_scc1 L_m_44
    s_mul_i32 s48, s58, 820
    s_lshr_b32 s48, s48, 13
    s_mul_i32 s49, s48, 10
    s_sub_u32 s49, s58, s49
    s_lshl_b32 s49, s49, 6
    v_add_u32 v220, s49, v0
    s_and_b32 s49, s4, 7
    s_mul_i32 s49, s49, 4
    s_add_u32 s48, s48, s49
    s_add_u32 s48, s48, 26
    s_and_b32 s48, s48, 31
    s_mul_i32 s48, s48, 73728
    s_mul_i32 s49, s4, 1152
    s_and_b32 s49, s49, -256
    s_add_u32 s48, s48, s49
    v_mul_u32_u24 v221, 820, v220
    v_lshrrev_b32 v221, 13, v221
    v_mul_u32_u24 v222, 10, v221
    v_sub_u32 v222, v220, v222
    v_and_b32 v220, 7, v221
    v_lshrrev_b32 v221, 3, v221
    v_lshl_add_u32 v220, v220, 8, v221
    v_mul_u32_u24 v220, 9216, v220
    v_lshl_add_u32 v220, v222, 7, v220
    buffer_load_dword v223, v220, s[52:55], s48 offen
    s_add_u32 s58, s58, 48
    s_branch L_m_43
L_m_44:
    s_waitcnt vmcnt(0)
    s_barrier
    s_branch L_m_33
    s_branch L_skip_11
L_stub_11:
    s_branch L_stub_12
L_skip_11:
L_m_32:
    s_setprio 1
    s_lshl_b32 s54, s3, 8
    s_add_u32 s52, s35, s54
    s_add_u32 s52, s52, 4194304
    s_lshl_b32 s53, s3, 12
    s_add_u32 s53, s53, s35
    s_add_u32 s53, s53, 1048576
    v_and_b32 v4, 3, v1
    v_lshrrev_b32 v5, 2, v1
    v_lshlrev_b32 v6, 6, v4
    v_lshl_add_u32 v6, v5, 4, v6
    v_lshl_add_u32 v217, v2, 12, v6
    v_mul_u32_u24 v212, 1040, v1
    v_lshl_add_u32 v212, v2, 6, v212
    v_add_u32 v212, s54, v212
    s_mul_i32 s48, s3, 4160
    v_add_u32 v214, s48, v16
    v_lshl_add_u32 v6, v2, 2, v4
    v_mul_u32_u24 v215, 1056, v6
    v_lshl_add_u32 v215, v5, 4, v215
    v_add_u32 v215, s54, v215
    s_mul_i32 s48, s3, 4224
    v_add_u32 v213, s48, v16
    s_and_b32 s66, s51, 3
    s_xor_b32 s66, s66, s60
    s_lshl_b32 s66, s66, 6
    s_lshl_b32 s48, s51, 8
    s_add_u32 s66, s66, s48
    s_mul_i32 s48, s3, 40960
    s_add_u32 s66, s66, s48
    s_add_u32 s66, s66, 8388608
    s_add_u32 s67, s66, 163840
    s_add_u32 s68, s66, 327680
    s_add_u32 s69, s66, 491520
    s_lshr_b32 s48, s51, 2
    s_and_b32 s48, s48, 2
    v_xor_b32 v4, s48, v4
    v_lshl_add_u32 v5, v2, 6, v5
    v_mul_u32_u24 v216, 10240, v5
    v_lshl_add_u32 v216, v4, 4, v216
    s_lshr_b32 s65, s4, 1
    s_lshl_b32 s65, s65, 16
    s_add_u32 s65, s65, 15728640
    s_lshl_b32 s48, s3, 10
    s_add_u32 s65, s65, s48
    v_lshlrev_b32 v218, 4, v0
    s_waitcnt vmcnt(1)
    v_cmp_ne_u32 vcc, v3, v18
    s_nop 0
    s_cbranch_vccz L_m_45
Lp_m_46:
    buffer_load_dword v18, v15, s[36:39], s64 offen sc1
    s_waitcnt vmcnt(0)
    v_cmp_ne_u32 vcc, v3, v18
    s_nop 0
    s_cbranch_vccz Le_m_47
    s_sub_u32 s7, s7, 1
    s_cbranch_scc1 Le_m_47
    s_sleep 1
    s_branch Lp_m_46
Le_m_47:
    s_max_i32 s7, s7, 0
L_m_45:
    buffer_load_dwordx4 v[224:227], v16, s[36:39], s53 offen offset:0 sc1
    buffer_load_dwordx4 v[228:231], v16, s[36:39], s53 offen offset:1024 sc1
    buffer_load_dwordx4 v[232:235], v16, s[36:39], s53 offen offset:2048 sc1
    buffer_load_dwordx4 v[236:239], v16, s[36:39], s53 offen offset:3072 sc1
    s_waitcnt vmcnt(0)
Lp_m_48:
    buffer_load_dword v4, v218, s[36:39], s65 offen sc1
    s_waitcnt vmcnt(0)
    v_cmp_ne_u32 vcc, v3, v4
    s_nop 0
    s_cbranch_vccz Le_m_49
    s_sub_u32 s7, s7, 1
    s_cbranch_scc1 Le_m_49
    s_mov_b64 exec, vcc
    s_sleep 1
    s_branch Lp_m_48
Le_m_49:
    s_mov_b64 exec, -1
    s_max_i32 s7, s7, 0
    buffer_load_dwordx4 v[36:39], v217, s[36:39], s52 offen offset:0 sc1
    buffer_load_dwordx4 v[40:43], v217, s[36:39], s52 offen offset:1024 sc1
    buffer_load_dwordx4 v[44:47], v217, s[36:39], s52 offen offset:2048 sc1
    buffer_load_dwordx4 v[48:51], v217, s[36:39], s52 offen offset:3072 sc1
    v_lshlrev_b32 v132, 16, v224
    v_and_b32 v136, 0xffff0000, v224
    v_lshlrev_b32 v133, 16, v225
    v_and_b32 v137, 0xffff0000, v225
    v_lshlrev_b32 v134, 16, v226
    v_and_b32 v138, 0xffff0000, v226
    v_lshlrev_b32 v135, 16, v227
    v_and_b32 v139, 0xffff0000, v227
    v_lshlrev_b32 v140, 16, v228
    v_and_b32 v144, 0xffff0000, v228
    v_lshlrev_b32 v141, 16, v229
    v_and_b32 v145, 0xffff0000, v229
    v_lshlrev_b32 v142, 16, v230
    v_and_b32 v146, 0xffff0000, v230
    v_lshlrev_b32 v143, 16, v231
    v_and_b32 v147, 0xffff0000, v231
    v_lshlrev_b32 v148, 16, v232
    v_and_b32 v152, 0xffff0000, v232
    v_lshlrev_b32 v149, 16, v233
    v_and_b32 v153, 0xffff0000, v233
    v_lshlrev_b32 v150, 16, v234
    v_and_b32 v154, 0xffff0000, v234
    v_lshlrev_b32 v151, 16, v235
    v_and_b32 v155, 0xffff0000, v235
    v_lshlrev_b32 v156, 16, v236
    v_and_b32 v160, 0xffff0000, v236
    v_lshlrev_b32 v157, 16, v237
    v_and_b32 v161, 0xffff0000, v237
    v_lshlrev_b32 v158, 16, v238
    v_and_b32 v162, 0xffff0000, v238
    v_lshlrev_b32 v159, 16, v239
    v_and_b32 v163, 0xffff0000, v239
    s_waitcnt vmcnt(2)
    v_swap_b32 v37, v40
    s_waitcnt vmcnt(1)
    v_swap_b32 v38, v44
    s_waitcnt vmcnt(0)
    v_swap_b32 v39, v48
    s_nop 1
    v_mfma_f32_16x16x32_bf16 v[164:167], v[36:39], v[52:55], 0
    v_mfma_f32_16x16x32_bf16 v[168:171], v[36:39], v[56:59], 0
    v_swap_b32 v42, v45
    v_swap_b32 v43, v49
    s_nop 1
    v_mfma_f32_16x16x32_bf16 v[172:175], v[40:43], v[52:55], 0
    v_mfma_f32_16x16x32_bf16 v[176:179], v[40:43], v[56:59], 0
    v_swap_b32 v47, v50
    s_nop 1
    v_mfma_f32_16x16x32_bf16 v[180:183], v[44:47], v[52:55], 0
    v_mfma_f32_16x16x32_bf16 v[184:187], v[44:47], v[56:59], 0
    v_mfma_f32_16x16x32_bf16 v[188:191], v[48:51], v[52:55], 0
    v_mfma_f32_16x16x32_bf16 v[192:195], v[48:51], v[56:59], 0
    v_cvt_pk_bf16_f32 v196, v164, v168
    v_cvt_pk_bf16_f32 v197, v165, v169
    v_cvt_pk_bf16_f32 v198, v166, v170
    v_cvt_pk_bf16_f32 v199, v167, v171
    ds_write_b128 v212, v[196:199] offset:36864
    v_cvt_pk_bf16_f32 v200, v172, v176
    v_cvt_pk_bf16_f32 v201, v173, v177
    v_cvt_pk_bf16_f32 v202, v174, v178
    v_cvt_pk_bf16_f32 v203, v175, v179
    ds_write_b128 v212, v[200:203] offset:36880
    v_cvt_pk_bf16_f32 v204, v180, v184
    v_cvt_pk_bf16_f32 v205, v181, v185
    v_cvt_pk_bf16_f32 v206, v182, v186
    v_cvt_pk_bf16_f32 v207, v183, v187
    ds_write_b128 v212, v[204:207] offset:36896
    v_cvt_pk_bf16_f32 v208, v188, v192
    v_cvt_pk_bf16_f32 v209, v189, v193
    v_cvt_pk_bf16_f32 v210, v190, v194
    v_cvt_pk_bf16_f32 v211, v191, v195
    ds_write_b128 v212, v[208:211] offset:36912
    s_waitcnt lgkmcnt(0)
    s_barrier
    ds_read_b128 v[36:39], v214 offset:36864
    ds_read_b128 v[40:43], v214 offset:37904
    ds_read_b128 v[44:47], v214 offset:38944
    ds_read_b128 v[48:51], v214 offset:39984
    s_waitcnt lgkmcnt(3)
    v_mfma_f32_16x16x32_bf16 v[164:167], v[68:71], v[36:39], 0
    v_mfma_f32_16x16x32_bf16 v[168:171], v[72:75], v[36:39], 0
    s_waitcnt lgkmcnt(2)
    v_mfma_f32_16x16x32_bf16 v[172:175], v[76:79], v[40:43], 0
    v_mfma_f32_16x16x32_bf16 v[176:179], v[80:83], v[40:43], 0
    s_waitcnt lgkmcnt(1)
    v_mfma_f32_16x16x32_bf16 v[180:183], v[84:87], v[44:47], 0
    v_mfma_f32_16x16x32_bf16 v[184:187], v[88:91], v[44:47], 0
    s_waitcnt lgkmcnt(0)
    v_mfma_f32_16x16x32_bf16 v[188:191], v[92:95], v[48:51], 0
    v_mfma_f32_16x16x32_bf16 v[192:195], v[96:99], v[48:51], 0
    v_pk_mul_f32 v[4:5], v[164:165], v[132:133]
    v_pk_mul_f32 v[6:7], v[168:169], v[132:133]
    v_pk_fma_f32 v[4:5], v[168:169], v[136:137], v[4:5] neg_lo:[1,0,0] neg_hi:[1,0,0]
    v_pk_fma_f32 v[6:7], v[164:165], v[136:137], v[6:7]
    v_cvt_pk_bf16_f32 v196, v4, v6
    v_cvt_pk_bf16_f32 v197, v5, v7
    v_pk_mul_f32 v[8:9], v[166:167], v[134:135]
    v_pk_mul_f32 v[10:11], v[170:171], v[134:135]
    v_pk_fma_f32 v[8:9], v[170:171], v[138:139], v[8:9] neg_lo:[1,0,0] neg_hi:[1,0,0]
    v_pk_fma_f32 v[10:11], v[166:167], v[138:139], v[10:11]
    v_cvt_pk_bf16_f32 v198, v8, v10
    v_cvt_pk_bf16_f32 v199, v9, v11
    v_pk_mul_f32 v[4:5], v[172:173], v[140:141]
    v_pk_mul_f32 v[6:7], v[176:177], v[140:141]
    v_pk_fma_f32 v[4:5], v[176:177], v[144:145], v[4:5] neg_lo:[1,0,0] neg_hi:[1,0,0]
    v_pk_fma_f32 v[6:7], v[172:173], v[144:145], v[6:7]
    v_cvt_pk_bf16_f32 v200, v4, v6
    v_cvt_pk_bf16_f32 v201, v5, v7
    v_mfma_f32_16x16x32_bf16 v[164:167], v[100:103], v[196:199], 0
    v_pk_mul_f32 v[8:9], v[174:175], v[142:143]
    v_pk_mul_f32 v[10:11], v[178:179], v[142:143]
    v_pk_fma_f32 v[8:9], v[178:179], v[146:147], v[8:9] neg_lo:[1,0,0] neg_hi:[1,0,0]
    v_pk_fma_f32 v[10:11], v[174:175], v[146:147], v[10:11]
    v_cvt_pk_bf16_f32 v202, v8, v10
    v_cvt_pk_bf16_f32 v203, v9, v11
    v_mfma_f32_16x16x32_bf16 v[168:171], v[104:107], v[196:199], 0
    v_pk_mul_f32 v[4:5], v[180:181], v[148:149]
    v_pk_mul_f32 v[6:7], v[184:185], v[148:149]
    v_pk_fma_f32 v[4:5], v[184:185], v[152:153], v[4:5] neg_lo:[1,0,0] neg_hi:[1,0,0]
    v_pk_fma_f32 v[6:7], v[180:181], v[152:153], v[6:7]
    v_cvt_pk_bf16_f32 v204, v4, v6
    v_cvt_pk_bf16_f32 v205, v5, v7
    v_mfma_f32_16x16x32_bf16 v[172:175], v[108:111], v[200:203], 0
    v_pk_mul_f32 v[8:9], v[182:183], v[150:151]
    v_pk_mul_f32 v[10:11], v[186:187], v[150:151]
    v_pk_fma_f32 v[8:9], v[186:187], v[154:155], v[8:9] neg_lo:[1,0,0] neg_hi:[1,0,0]
    v_pk_fma_f32 v[10:11], v[182:183], v[154:155], v[10:11]
    v_cvt_pk_bf16_f32 v206, v8, v10
    v_cvt_pk_bf16_f32 v207, v9, v11
    v_mfma_f32_16x16x32_bf16 v[176:179], v[112:115], v[200:203], 0
    v_pk_mul_f32 v[4:5], v[188:189], v[156:157]
    v_pk_mul_f32 v[6:7], v[192:193], v[156:157]
    v_pk_fma_f32 v[4:5], v[192:193], v[160:161], v[4:5] neg_lo:[1,0,0] neg_hi:[1,0,0]
    v_pk_fma_f32 v[6:7], v[188:189], v[160:161], v[6:7]
    v_cvt_pk_bf16_f32 v208, v4, v6
    v_cvt_pk_bf16_f32 v209, v5, v7
    v_mfma_f32_16x16x32_bf16 v[180:183], v[116:119], v[204:207], 0
    v_pk_mul_f32 v[8:9], v[190:191], v[158:159]
    v_pk_mul_f32 v[10:11], v[194:195], v[158:159]
    v_pk_fma_f32 v[8:9], v[194:195], v[162:163], v[8:9] neg_lo:[1,0,0] neg_hi:[1,0,0]
    v_pk_fma_f32 v[10:11], v[190:191], v[162:163], v[10:11]
    v_cvt_pk_bf16_f32 v210, v8, v10
    v_cvt_pk_bf16_f32 v211, v9, v11
    v_mfma_f32_16x16x32_bf16 v[184:187], v[120:123], v[204:207], 0
    v_cvt_pk_bf16_f32 v36, v164, v168
    v_cvt_pk_bf16_f32 v40, v165, v169
    v_cvt_pk_bf16_f32 v44, v166, v170
    v_cvt_pk_bf16_f32 v48, v167, v171
    v_mfma_f32_16x16x32_bf16 v[188:191], v[124:127], v[208:211], 0
    v_mfma_f32_16x16x32_bf16 v[192:195], v[128:131], v[208:211], 0
    v_cvt_pk_bf16_f32 v37, v172, v176
    v_cvt_pk_bf16_f32 v41, v173, v177
    v_cvt_pk_bf16_f32 v45, v174, v178
    v_cvt_pk_bf16_f32 v49, v175, v179
    v_cvt_pk_bf16_f32 v38, v180, v184
    v_cvt_pk_bf16_f32 v42, v181, v185
    v_cvt_pk_bf16_f32 v46, v182, v186
    v_cvt_pk_bf16_f32 v50, v183, v187
    v_cvt_pk_bf16_f32 v39, v188, v192
    ds_write_b128 v215, v[36:39] offset:53504
    v_cvt_pk_bf16_f32 v43, v189, v193
    ds_write_b128 v215, v[40:43] offset:53568
    v_cvt_pk_bf16_f32 v47, v190, v194
    ds_write_b128 v215, v[44:47] offset:53632
    v_cvt_pk_bf16_f32 v51, v191, v195
    ds_write_b128 v215, v[48:51] offset:53696
    s_waitcnt lgkmcnt(0)
    s_barrier
    ds_read_b128 v[196:199], v213 offset:53504
    ds_read_b128 v[200:203], v213 offset:54560
    ds_read_b128 v[204:207], v213 offset:55616
    ds_read_b128 v[208:211], v213 offset:56672
    s_waitcnt lgkmcnt(3)
    v_mfma_f32_16x16x32_bf16 v[164:167], v[60:63], v[196:199], 0
    v_mfma_f32_16x16x32_bf16 v[168:171], v[64:67], v[196:199], 0
    s_waitcnt lgkmcnt(2)
    v_mfma_f32_16x16x32_bf16 v[172:175], v[60:63], v[200:203], 0
    v_mfma_f32_16x16x32_bf16 v[176:179], v[64:67], v[200:203], 0
    s_waitcnt lgkmcnt(1)
    v_mfma_f32_16x16x32_bf16 v[180:183], v[60:63], v[204:207], 0
    v_mfma_f32_16x16x32_bf16 v[184:187], v[64:67], v[204:207], 0
    s_waitcnt lgkmcnt(0)
    v_mfma_f32_16x16x32_bf16 v[188:191], v[60:63], v[208:211], 0
    v_mfma_f32_16x16x32_bf16 v[192:195], v[64:67], v[208:211], 0
    v_cvt_pk_bf16_f32 v36, v168, v164
    v_cvt_pk_bf16_f32 v40, v169, v165
    v_cvt_pk_bf16_f32 v44, v170, v166
    v_cvt_pk_bf16_f32 v48, v171, v167
    v_cvt_pk_bf16_f32 v37, v176, v172
    v_cvt_pk_bf16_f32 v41, v177, v173
    v_cvt_pk_bf16_f32 v45, v178, v174
    v_cvt_pk_bf16_f32 v49, v179, v175
    v_cvt_pk_bf16_f32 v38, v184, v180
    v_cvt_pk_bf16_f32 v42, v185, v181
    v_cvt_pk_bf16_f32 v46, v186, v182
    s_branch L_skip_12
L_stub_12:
    s_branch L_back_h1
L_skip_12:
    v_cvt_pk_bf16_f32 v50, v187, v183
    v_cvt_pk_bf16_f32 v39, v192, v188
    buffer_store_dwordx4 v[36:39], v216, s[36:39], s66 offen sc1
    v_cvt_pk_bf16_f32 v43, v193, v189
    buffer_store_dwordx4 v[40:43], v216, s[36:39], s67 offen sc1
    v_cvt_pk_bf16_f32 v47, v194, v190
    buffer_store_dwordx4 v[44:47], v216, s[36:39], s68 offen sc1
    v_cvt_pk_bf16_f32 v51, v195, v191
    buffer_store_dwordx4 v[48:51], v216, s[36:39], s69 offen sc1
    buffer_store_dword v3, v19, s[36:39], 0 offen sc1
    s_setprio 0
    s_waitcnt vmcnt(0)
    s_barrier
L_m_33:
    v_lshlrev_b32 v8, 4, v0
    s_mul_i32 s52, s4, 27
    s_add_u32 s52, s52, s5
    s_mul_i32 s51, s52, 171
    s_lshr_b32 s51, s51, 10
    s_mul_i32 s48, s51, 6
    s_sub_u32 s52, s52, s48
    s_lshr_b32 s53, s4, 1
    s_and_b32 s54, s4, 1
    s_lshl_b32 s54, s54, 3
    s_lshr_b32 s48, s5, 2
    s_add_u32 s54, s54, s48
    s_and_b32 s55, s5, 3
    s_mov_b32 s40, s16
    s_mov_b32 s41, s17
    s_mov_b32 s42, 18874368
    s_mov_b32 s43, 0x20000
    s_mov_b32 s44, s20
    s_mov_b32 s45, s21
    s_mov_b32 s46, 18874368
    s_mov_b32 s47, 0x20000
    s_and_b32 s62, s3, 1
    s_and_b32 s63, s4, 7
    s_mul_i32 s63, s63, 4
    s_add_u32 s63, s63, 26
    s_mul_i32 s48, s51, 0
    s_add_u32 s63, s63, s48
    s_and_b32 s63, s63, 31
    s_mov_b32 s64, 0
    s_lshl_b32 s68, s62, 13
    s_cmp_ge_u32 s3, 2
    s_cbranch_scc1 L_m_50
    s_branch L_stub_13
L_back_a1:
    s_mul_i32 s56, s62, 27
    s_add_u32 s56, s56, s5
    s_add_u32 s56, s56, 116
    s_cmp_lt_u32 s5, 27
    s_cselect_b32 s56, s56, 999
    s_barrier
    v_mov_b64 v[28:29], -1
    v_mov_b64 v[30:31], -1
    s_lshl_b32 s56, s2, 1
    s_add_u32 s56, s56, s62
    s_add_u32 s48, s56, 0
    s_cmp_ge_u32 s48, 1152
    s_cbranch_scc1 L_m_51
    s_mov_b32 s49, s48
    s_cmp_ge_u32 s49, 288
    s_cselect_b32 s50, 1008, 0
    s_add_u32 s48, s48, s50
    s_cmp_ge_u32 s49, 576
    s_cselect_b32 s50, 1008, 0
    s_add_u32 s48, s48, s50
    s_cmp_ge_u32 s49, 864
    s_cselect_b32 s50, 1008, 0
    s_add_u32 s48, s48, s50
    s_lshl_b32 s48, s48, 10
    s_add_u32 s48, s48, 21413888
    buffer_store_dwordx4 v[28:31], v8, s[36:39], s48 offen sc1
L_m_51:
    s_add_u32 s48, s56, 512
    s_cmp_ge_u32 s48, 1152
    s_cbranch_scc1 L_m_52
    s_mov_b32 s49, s48
    s_cmp_ge_u32 s49, 288
    s_cselect_b32 s50, 1008, 0
    s_add_u32 s48, s48, s50
    s_cmp_ge_u32 s49, 576
    s_cselect_b32 s50, 1008, 0
    s_add_u32 s48, s48, s50
    s_cmp_ge_u32 s49, 864
    s_cselect_b32 s50, 1008, 0
    s_add_u32 s48, s48, s50
    s_lshl_b32 s48, s48, 10
    s_add_u32 s48, s48, 21413888
    buffer_store_dwordx4 v[28:31], v8, s[36:39], s48 offen sc1
L_m_52:
    s_add_u32 s48, s56, 1024
    s_cmp_ge_u32 s48, 1152
    s_cbranch_scc1 L_m_53
    s_mov_b32 s49, s48
    s_cmp_ge_u32 s49, 288
    s_cselect_b32 s50, 1008, 0
    s_add_u32 s48, s48, s50
    s_cmp_ge_u32 s49, 576
    s_cselect_b32 s50, 1008, 0
    s_add_u32 s48, s48, s50
    s_cmp_ge_u32 s49, 864
    s_cselect_b32 s50, 1008, 0
    s_add_u32 s48, s48, s50
    s_lshl_b32 s48, s48, 10
    s_add_u32 s48, s48, 21413888
    buffer_store_dwordx4 v[28:31], v8, s[36:39], s48 offen sc1
L_m_53:
    s_bfe_u32 s56, s6, 0x10002
    s_lshl_b32 s56, s56, 7
    s_lshr_b32 s57, s6, 3
    s_lshl_b32 s57, s57, 2
    s_add_u32 s56, s56, s57
    s_and_b32 s57, s6, 3
    s_add_u32 s56, s56, s57
    s_lshl_b32 s48, s56, 4
    s_lshl_b32 s49, s3, 16
    s_add_u32 s48, s48, s49
    s_add_u32 s48, s48, 16252928
    v_mov_b32 v10, 2146435072
    v_writelane_b32 v10, s48, 0
    s_add_u32 s48, s48, 16384
    s_lshl_b32 s56, s52, 6
    s_add_u32 s56, s56, s51
    s_lshl_b32 s48, s56, 4
    s_lshl_b32 s49, s3, 16
    s_add_u32 s48, s48, s49
    s_add_u32 s48, s48, 16515072
    v_mov_b32 v11, 2146435072
    v_writelane_b32 v11, s48, 0
    s_add_u32 s48, s48, 16384
    s_add_u32 s48, s2, 216
    s_lshl_b32 s48, s48, 7
    s_add_u32 s48, s48, 622592
    s_lshl_b32 s49, s3, 8
    s_add_u32 s49, s49, s5
    s_cmp_lt_u32 s49, 5
    s_cselect_b32 s48, s48, 2146435072
    v_writelane_b32 v11, s48, 8
    s_lshr_b32 s65, s4, 2
    s_lshl_b32 s65, s65, 16
    s_add_u32 s66, s65, 16515072
    s_lshl_b32 s48, s62, 11
    s_add_u32 s65, s65, s48
    s_add_u32 s65, s65, 16252928
    s_add_u32 s69, s65, 1024
    v_lshlrev_b32 v27, 4, v0
    s_mul_i32 s67, s52, 1536
    s_mul_i32 s48, s62, 36864
    s_add_u32 s67, s67, s48
    s_add_u32 s67, s67, 16777216
    v_add_u32 v14, 7680, v8
    v_cmp_gt_u32 vcc, 32, v0
    s_nop 1
    v_cndmask_b32 v13, v14, v8, vcc
    v_add_u32 v15, 18432, v8
    v_add_u32 v16, 18432, v13
    v_add_u32 v17, 18432, v14
    s_mul_i32 s68, s62, 6144
    s_mul_i32 s58, s63, 73728
    s_add_u32 s58, s58, s67
    s_add_u32 s59, s67, 2359296
    s_barrier
    s_mul_i32 s56, s62, 288
    s_mul_i32 s57, s6, 1152
    s_add_u32 s57, s57, 12582912
    v_add_u32 v4, 0, v0
    v_min_u32 v4, 287, v4
    v_add_u32 v4, s56, v4
    v_mul_u32_u24 v5, 911, v4
    v_lshrrev_b32 v5, 16, v5
    v_mul_u32_u24 v5, 293760, v5
    v_lshl_add_u32 v22, v4, 4, v5
    v_lshlrev_b32 v4, 4, v4
    v_add_u32 v6, 98304, v4
    v_add_u32 v4, 64, v0
    v_min_u32 v4, 287, v4
    v_add_u32 v4, s56, v4
    v_mul_u32_u24 v5, 911, v4
    v_lshrrev_b32 v5, 16, v5
    v_mul_u32_u24 v5, 293760, v5
    v_lshl_add_u32 v23, v4, 4, v5
    v_add_u32 v4, 128, v0
    v_min_u32 v4, 287, v4
    v_add_u32 v4, s56, v4
    v_mul_u32_u24 v5, 911, v4
    v_lshrrev_b32 v5, 16, v5
    v_mul_u32_u24 v5, 293760, v5
    v_lshl_add_u32 v24, v4, 4, v5
    v_add_u32 v4, 192, v0
    v_min_u32 v4, 287, v4
    v_add_u32 v4, s56, v4
    v_mul_u32_u24 v5, 911, v4
    v_lshrrev_b32 v5, 16, v5
    v_mul_u32_u24 v5, 293760, v5
    v_lshl_add_u32 v25, v4, 4, v5
    v_add_u32 v4, 256, v0
    v_min_u32 v4, 287, v4
    v_add_u32 v4, s56, v4
    v_mul_u32_u24 v5, 911, v4
    v_lshrrev_b32 v5, 16, v5
    v_mul_u32_u24 v5, 293760, v5
    v_lshl_add_u32 v26, v4, 4, v5
    v_lshlrev_b32 v4, 4, v4
    v_add_u32 v7, 98304, v4
    s_barrier
    s_barrier
    ds_read_b128 v[28:31], v6 offset:0
    ds_read_b128 v[32:35], v6 offset:1024
    ds_read_b128 v[36:39], v6 offset:2048
    ds_read_b128 v[40:43], v6 offset:3072
    ds_read_b128 v[44:47], v7 offset:0
    s_lshl_b32 s48, s62, 8
    s_add_u32 s48, s48, s6
    s_lshl_b32 s48, s48, 7
    s_add_u32 s48, s48, 15990784
    v_add_u32 v54, s48, v8
    v_cmp_gt_u32 vcc, 8, v0
    v_mov_b32 v4, 2146435072
    s_nop 0
    v_cndmask_b32 v54, v4, v54, vcc
    s_waitcnt vmcnt(0)
    v_mov_b32 v48, v3
    v_mov_b32 v49, v3
    v_mov_b32 v50, v3
    v_mov_b32 v51, v3
    s_cmp_ge_u32 s5, 27
    s_cbranch_scc1 L_m_54
    v_lshrrev_b32 v52, 4, v0
    v_and_b32 v53, 15, v0
    v_lshlrev_b32 v52, 12, v52
    v_lshl_add_u32 v52, v53, 7, v52
    s_lshr_b32 s48, s4, 1
    s_mul_i32 s48, s48, 4718592
    s_and_b32 s49, s4, 1
    s_lshl_b32 s49, s49, 11
    s_add_u32 s48, s48, s49
    v_add_u32 v52, s48, v52
    s_mov_b32 s35, 0
    s_mov_b32 s49, s35
    s_mul_i32 s48, s62, 1
    s_add_u32 s49, s49, s48
    s_bfm_b32 s48, s5, 0
    s_and_b32 s48, s48, 0
    s_bcnt1_i32_b32 s48, s48
    s_sub_u32 s12, s5, s48
    s_mul_i32 s35, s12, 4
    s_add_u32 s35, s35, 84
    s_add_u32 s35, s35, s49
    s_min_u32 s35, s35, 191
    s_lshl_b32 s8, s35, 14
    s_mul_i32 s35, s12, 4
    s_add_u32 s35, s35, 86
    s_add_u32 s35, s35, s49
    s_min_u32 s35, s35, 191
    s_lshl_b32 s9, s35, 14
    s_mul_i32 s35, s12, 132
    s_lshr_b32 s35, s35, 8
    s_add_u32 s35, s35, 0
    s_mul_i32 s48, s62, 0
    s_add_u32 s35, s35, s48
    s_mov_b32 s48, 0
    s_bitcmp1_b32 s48, s5
    s_cselect_b32 s35, 999, s35
    s_add_u32 s50, s58, 589824
    s_cmp_ge_u32 s50, s59
    s_cselect_b32 s48, 2359296, 0
    s_sub_u32 s50, s50, s48
    s_waitcnt lgkmcnt(0)
    s_barrier
    buffer_store_dword v3, v10, s[36:39], 0 offen sc1
    v_add_u32 v76, 0, v0
    v_mul_u32_u24 v77, 1821, v76
    v_lshrrev_b32 v77, 18, v77
    v_mul_u32_u24 v77, 6912, v77
    v_lshl_add_u32 v77, v76, 4, v77
    v_subrev_u32 v56, 0, v77
    v_add_u32 v76, 64, v0
    v_mul_u32_u24 v77, 1821, v76
    v_lshrrev_b32 v77, 18, v77
    v_mul_u32_u24 v77, 6912, v77
    v_lshl_add_u32 v77, v76, 4, v77
    v_subrev_u32 v57, 1024, v77
    v_add_u32 v76, 128, v0
    v_mul_u32_u24 v77, 1821, v76
    v_lshrrev_b32 v77, 18, v77
    v_mul_u32_u24 v77, 6912, v77
    v_lshl_add_u32 v77, v76, 4, v77
    v_subrev_u32 v58, 2048, v77
    v_add_u32 v76, 192, v0
    v_mul_u32_u24 v77, 1821, v76
    v_lshrrev_b32 v77, 18, v77
    v_mul_u32_u24 v77, 6912, v77
    v_lshl_add_u32 v77, v76, 4, v77
    v_subrev_u32 v59, 3072, v77
    v_add_u32 v76, 256, v0
    v_mul_u32_u24 v77, 1821, v76
    v_lshrrev_b32 v77, 18, v77
    v_mul_u32_u24 v77, 6912, v77
    v_lshl_add_u32 v77, v76, 4, v77
    v_subrev_u32 v60, 0, v77
    v_add_u32 v76, 320, v0
    v_mul_u32_u24 v77, 1821, v76
    v_lshrrev_b32 v77, 18, v77
    v_mul_u32_u24 v77, 6912, v77
    v_lshl_add_u32 v77, v76, 4, v77
    v_subrev_u32 v61, 1024, v77
    v_add_u32 v76, 384, v0
    v_mul_u32_u24 v77, 1821, v76
    v_lshrrev_b32 v77, 18, v77
    v_mul_u32_u24 v77, 6912, v77
    v_lshl_add_u32 v77, v76, 4, v77
    v_subrev_u32 v62, 2048, v77
    v_add_u32 v76, 448, v0
    v_mul_u32_u24 v77, 1821, v76
    v_lshrrev_b32 v77, 18, v77
    v_mul_u32_u24 v77, 6912, v77
    v_lshl_add_u32 v77, v76, 4, v77
    v_subrev_u32 v63, 3072, v77
    v_add_u32 v76, 512, v0
    v_mul_u32_u24 v77, 1821, v76
    v_lshrrev_b32 v77, 18, v77
    v_mul_u32_u24 v77, 6912, v77
    v_lshl_add_u32 v77, v76, 4, v77
    v_subrev_u32 v64, 0, v77
    s_mul_i32 s48, s55, 3
    s_add_u32 s49, s48, 2
    s_lshr_b32 s48, s48, 1
    s_lshr_b32 s49, s49, 1
    v_mov_b32 v76, s48
    v_mov_b32 v77, s49
    v_cmp_gt_u32 vcc, 32, v0
    s_nop 1
    v_cndmask_b32 v76, v77, v76, vcc
    v_and_b32 v77, 31, v0
    v_min_u32 v77, 8, v77
    v_lshl_add_u32 v76, v76, 6, v77
    s_mul_i32 s48, s53, 9
    v_add_u32 v76, s48, v76
    v_lshlrev_b32 v66, 4, v76
    s_lshr_b32 s48, s54, 3
    s_lshl_b32 s48, s48, 2
    s_and_b32 s49, s54, 1
    s_lshl_b32 s49, s49, 1
    s_add_u32 s48, s48, s49
    s_add_u32 s48, s48, s62
    s_lshl_b32 s48, s48, 13
    s_add_u32 s48, s48, 15990784
    v_lshl_add_u32 v67, v0, 7, s48
    v_mov_b32 v68, 0
    s_lshl_b32 s48, s54, 7
    s_lshr_b32 s49, s53, 1
    s_lshl_b32 s49, s49, 4
    s_add_u32 s48, s48, s49
    s_mul_i32 s48, s48, 1152
    s_mul_i32 s49, s55, 288
    s_add_u32 s48, s48, s49
    s_and_b32 s49, s53, 1
    s_mul_i32 s49, s49, 144
    s_add_u32 s48, s48, s49
    s_add_u32 s12, s48, 12582912
    s_lshl_b32 s13, s62, 6
    v_add_u32 v76, s13, v0
    v_mul_u32_u24 v77, 911, v76
    v_lshrrev_b32 v77, 13, v77
    v_mul_u32_u24 v78, 9, v77
    v_sub_u32 v78, v76, v78
    v_and_b32 v76, 48, v77
    v_add_u32 v77, v77, v76
    v_mul_u32_u24 v77, 1152, v77
    v_lshl_add_u32 v77, v78, 4, v77
    v_add_u32 v70, s12, v77
    s_add_u32 s13, s13, 128
    v_add_u32 v76, s13, v0
    v_mul_u32_u24 v77, 911, v76
    v_lshrrev_b32 v77, 13, v77
    v_mul_u32_u24 v78, 9, v77
    v_sub_u32 v78, v76, v78
    v_and_b32 v76, 48, v77
    v_add_u32 v77, v77, v76
    v_mul_u32_u24 v77, 1152, v77
    v_lshl_add_u32 v77, v78, 4, v77
    v_add_u32 v71, s12, v77
    s_add_u32 s13, s13, 128
    v_add_u32 v76, s13, v0
    v_mul_u32_u24 v77, 911, v76
    v_lshrrev_b32 v77, 13, v77
    v_mul_u32_u24 v78, 9, v77
    v_sub_u32 v78, v76, v78
    v_and_b32 v76, 48, v77
    v_add_u32 v77, v77, v76
    v_mul_u32_u24 v77, 1152, v77
    v_lshl_add_u32 v77, v78, 4, v77
    v_add_u32 v72, s12, v77
    s_add_u32 s13, s13, 128
    v_add_u32 v76, s13, v0
    v_mul_u32_u24 v77, 911, v76
    v_lshrrev_b32 v77, 13, v77
    v_mul_u32_u24 v78, 9, v77
    v_sub_u32 v78, v76, v78
    v_and_b32 v76, 48, v77
    v_add_u32 v77, v77, v76
    v_mul_u32_u24 v77, 1152, v77
    v_lshl_add_u32 v77, v78, 4, v77
    v_add_u32 v73, s12, v77
    s_add_u32 s13, s13, 128
    v_add_u32 v76, s13, v0
    v_mul_u32_u24 v77, 911, v76
    v_lshrrev_b32 v77, 13, v77
    v_mul_u32_u24 v78, 9, v77
    v_sub_u32 v78, v76, v78
    v_and_b32 v76, 48, v77
    v_add_u32 v77, v77, v76
    v_mul_u32_u24 v77, 1152, v77
    v_lshl_add_u32 v77, v78, 4, v77
    v_add_u32 v74, s12, v77
    s_add_u32 s13, s13, 128
    s_mul_i32 s48, s55, 576
    s_and_b32 s49, s53, 1
    s_mul_i32 s49, s49, 288
    s_add_u32 s48, s48, s49
    s_add_u32 s48, s48, 11520
    v_min_u32 v76, 272, v8
    v_add_u32 v76, s48, v76
    s_cmp_eq_u32 s62, 1
    s_cselect_b64 vcc, -1, 0
    v_cndmask_b32 v74, v74, v76, vcc
    s_waitcnt vmcnt(0)
    s_barrier
    buffer_store_dwordx4 v[28:31], v22, s[36:39], s57 offen sc1
    buffer_store_dwordx4 v[32:35], v23, s[36:39], s57 offen sc1
    buffer_store_dwordx4 v[36:39], v24, s[36:39], s57 offen sc1
    buffer_store_dwordx4 v[40:43], v25, s[36:39], s57 offen sc1
    buffer_store_dwordx4 v[44:47], v26, s[36:39], s57 offen sc1
    s_barrier
    s_waitcnt vmcnt(0)
    buffer_store_dwordx4 v[48:51], v54, s[36:39], 0 offen sc1
Lp_m_56:
    buffer_load_dword v4, v27, s[36:39], s65 offen sc1
    buffer_load_dword v5, v27, s[36:39], s69 offen sc1
    s_waitcnt vmcnt(0)
    v_cmp_ne_u32 vcc, v3, v4
    v_cmp_ne_u32 s[48:49], v3, v5
    s_nop 0
    s_or_b64 vcc, vcc, s[48:49]
    s_cbranch_vccz Le_m_57
    s_sub_u32 s7, s7, 1
    s_cbranch_scc1 Le_m_57
    s_mov_b64 exec, vcc
    s_sleep 1
    s_branch Lp_m_56
Le_m_57:
    s_mov_b64 exec, -1
    s_max_i32 s7, s7, 0
    s_add_u32 m0, s68, 98304
    s_nop 0
    buffer_load_dwordx4 v8, s[36:39], s50 offen offset:0 sc1 lds
    buffer_load_dwordx4 v13, s[36:39], s50 offen offset:1024 sc1 lds
    buffer_load_dwordx4 v14, s[36:39], s50 offen offset:2048 sc1 lds
    s_add_u32 m0, s68, 101376
    s_nop 0
    buffer_load_dwordx4 v15, s[36:39], s50 offen offset:0 sc1 lds
    buffer_load_dwordx4 v16, s[36:39], s50 offen offset:1024 sc1 lds
    buffer_load_dwordx4 v17, s[36:39], s50 offen offset:2048 sc1 lds
    s_add_u32 s50, s58, 663552
    s_cmp_ge_u32 s50, s59
    s_cselect_b32 s48, 2359296, 0
    s_sub_u32 s50, s50, s48
    s_add_u32 m0, s68, 110592
    s_nop 0
    buffer_load_dwordx4 v8, s[36:39], s50 offen offset:0 sc1 lds
    buffer_load_dwordx4 v13, s[36:39], s50 offen offset:1024 sc1 lds
    buffer_load_dwordx4 v14, s[36:39], s50 offen offset:2048 sc1 lds
    s_add_u32 m0, s68, 113664
    s_nop 0
    buffer_load_dwordx4 v15, s[36:39], s50 offen offset:0 sc1 lds
    buffer_load_dwordx4 v16, s[36:39], s50 offen offset:1024 sc1 lds
    buffer_load_dwordx4 v17, s[36:39], s50 offen offset:2048 sc1 lds
    s_add_u32 s50, s58, 737280
    s_cmp_ge_u32 s50, s59
    s_cselect_b32 s48, 2359296, 0
    s_sub_u32 s50, s50, s48
    s_waitcnt vmcnt(6)
    s_barrier
    s_add_u32 m0, s68, 122880
    s_nop 0
    buffer_load_dwordx4 v8, s[36:39], s50 offen offset:0 sc1 lds
    buffer_load_dwordx4 v13, s[36:39], s50 offen offset:1024 sc1 lds
    buffer_load_dwordx4 v14, s[36:39], s50 offen offset:2048 sc1 lds
    s_add_u32 m0, s68, 125952
    s_nop 0
    buffer_load_dwordx4 v15, s[36:39], s50 offen offset:0 sc1 lds
    buffer_load_dwordx4 v16, s[36:39], s50 offen offset:1024 sc1 lds
    buffer_load_dwordx4 v17, s[36:39], s50 offen offset:2048 sc1 lds
    s_add_u32 s50, s58, 811008
    s_cmp_ge_u32 s50, s59
    s_cselect_b32 s48, 2359296, 0
    s_sub_u32 s50, s50, s48
    s_add_u32 m0, s68, 135168
    s_nop 0
    buffer_load_dwordx4 v8, s[36:39], s50 offen offset:0 sc1 lds
    buffer_load_dwordx4 v13, s[36:39], s50 offen offset:1024 sc1 lds
    buffer_load_dwordx4 v14, s[36:39], s50 offen offset:2048 sc1 lds
    s_add_u32 m0, s68, 138240
    s_nop 0
    buffer_load_dwordx4 v15, s[36:39], s50 offen offset:0 sc1 lds
    buffer_load_dwordx4 v16, s[36:39], s50 offen offset:1024 sc1 lds
    buffer_load_dwordx4 v17, s[36:39], s50 offen offset:2048 sc1 lds
    s_add_u32 s50, s58, 884736
    s_cmp_ge_u32 s50, s59
    s_cselect_b32 s48, 2359296, 0
    s_sub_u32 s50, s50, s48
    s_cmp_lg_u32 s35, 0
    s_cbranch_scc1 L_m_58
    buffer_load_dword v53, v52, s[44:47], s8 offen
    buffer_load_dword v53, v52, s[44:47], s9 offen
L_m_58:
    s_waitcnt vmcnt(12)
    s_barrier
    s_add_u32 m0, s68, 147456
    s_nop 0
    buffer_load_dwordx4 v8, s[36:39], s50 offen offset:0 sc1 lds
    buffer_load_dwordx4 v13, s[36:39], s50 offen offset:1024 sc1 lds
    buffer_load_dwordx4 v14, s[36:39], s50 offen offset:2048 sc1 lds
    s_add_u32 m0, s68, 150528
    s_nop 0
    buffer_load_dwordx4 v15, s[36:39], s50 offen offset:0 sc1 lds
    buffer_load_dwordx4 v16, s[36:39], s50 offen offset:1024 sc1 lds
    buffer_load_dwordx4 v17, s[36:39], s50 offen offset:2048 sc1 lds
    s_add_u32 s50, s58, 958464
    s_cmp_ge_u32 s50, s59
    s_cselect_b32 s48, 2359296, 0
    s_sub_u32 s50, s50, s48
    s_cmp_lg_u32 s35, 1
    s_cbranch_scc1 L_m_59
    buffer_load_dword v53, v52, s[44:47], s8 offen
    buffer_load_dword v53, v52, s[44:47], s9 offen
L_m_59:
    s_waitcnt vmcnt(12)
    s_barrier
    s_add_u32 m0, s68, 98304
    s_nop 0
    buffer_load_dwordx4 v8, s[36:39], s50 offen offset:0 sc1 lds
    buffer_load_dwordx4 v13, s[36:39], s50 offen offset:1024 sc1 lds
    buffer_load_dwordx4 v14, s[36:39], s50 offen offset:2048 sc1 lds
    s_add_u32 m0, s68, 101376
    s_nop 0
    buffer_load_dwordx4 v15, s[36:39], s50 offen offset:0 sc1 lds
    buffer_load_dwordx4 v16, s[36:39], s50 offen offset:1024 sc1 lds
    buffer_load_dwordx4 v17, s[36:39], s50 offen offset:2048 sc1 lds
    s_add_u32 s50, s58, 0
    s_cmp_ge_u32 s50, s59
    s_cselect_b32 s48, 2359296, 0
    s_sub_u32 s50, s50, s48
    s_cmp_lg_u32 s35, 2
    s_cbranch_scc1 L_m_60
    buffer_load_dword v53, v52, s[44:47], s8 offen
    buffer_load_dword v53, v52, s[44:47], s9 offen
L_m_60:
    s_waitcnt vmcnt(12)
    s_barrier
    s_add_u32 m0, s68, 110592
    s_nop 0
    buffer_load_dwordx4 v8, s[36:39], s50 offen offset:0 sc1 lds
    buffer_load_dwordx4 v13, s[36:39], s50 offen offset:1024 sc1 lds
    buffer_load_dwordx4 v14, s[36:39], s50 offen offset:2048 sc1 lds
    s_add_u32 m0, s68, 113664
    s_nop 0
    buffer_load_dwordx4 v15, s[36:39], s50 offen offset:0 sc1 lds
    buffer_load_dwordx4 v16, s[36:39], s50 offen offset:1024 sc1 lds
    buffer_load_dwordx4 v17, s[36:39], s50 offen offset:2048 sc1 lds
    s_add_u32 s50, s58, 1032192
    s_cmp_ge_u32 s50, s59
    s_cselect_b32 s48, 2359296, 0
    s_sub_u32 s50, s50, s48
    s_cmp_lg_u32 s35, 3
    s_cbranch_scc1 L_m_61
    buffer_load_dword v53, v52, s[44:47], s8 offen
    buffer_load_dword v53, v52, s[44:47], s9 offen
L_m_61:
    s_waitcnt vmcnt(12)
    s_barrier
    s_add_u32 m0, s68, 122880
    s_nop 0
    buffer_load_dwordx4 v8, s[36:39], s50 offen offset:0 sc1 lds
    buffer_load_dwordx4 v13, s[36:39], s50 offen offset:1024 sc1 lds
    buffer_load_dwordx4 v14, s[36:39], s50 offen offset:2048 sc1 lds
    s_add_u32 m0, s68, 125952
    s_nop 0
    buffer_load_dwordx4 v15, s[36:39], s50 offen offset:0 sc1 lds
    buffer_load_dwordx4 v16, s[36:39], s50 offen offset:1024 sc1 lds
    buffer_load_dwordx4 v17, s[36:39], s50 offen offset:2048 sc1 lds
    s_add_u32 s50, s58, 1105920
    s_cmp_ge_u32 s50, s59
    s_cselect_b32 s48, 2359296, 0
    s_sub_u32 s50, s50, s48
    s_cmp_lg_u32 s35, 4
    s_cbranch_scc1 L_m_62
    buffer_load_dword v53, v52, s[44:47], s8 offen
    buffer_load_dword v53, v52, s[44:47], s9 offen
L_m_62:
    s_waitcnt vmcnt(12)
    s_barrier
    s_add_u32 m0, s68, 135168
    s_nop 0
    buffer_load_dwordx4 v8, s[36:39], s50 offen offset:0 sc1 lds
    buffer_load_dwordx4 v13, s[36:39], s50 offen offset:1024 sc1 lds
    buffer_load_dwordx4 v14, s[36:39], s50 offen offset:2048 sc1 lds
    s_add_u32 m0, s68, 138240
    s_nop 0
    buffer_load_dwordx4 v15, s[36:39], s50 offen offset:0 sc1 lds
    buffer_load_dwordx4 v16, s[36:39], s50 offen offset:1024 sc1 lds
    buffer_load_dwordx4 v17, s[36:39], s50 offen offset:2048 sc1 lds
    s_add_u32 s50, s58, 73728
    s_cmp_ge_u32 s50, s59
    s_cselect_b32 s48, 2359296, 0
    s_sub_u32 s50, s50, s48
    s_cmp_lg_u32 s35, 5
    s_cbranch_scc1 L_m_63
    buffer_load_dword v53, v52, s[44:47], s8 offen
    buffer_load_dword v53, v52, s[44:47], s9 offen
L_m_63:
    s_waitcnt vmcnt(12)
    s_barrier
    s_add_u32 m0, s68, 147456
    s_nop 0
    buffer_load_dwordx4 v8, s[36:39], s50 offen offset:0 sc1 lds
    buffer_load_dwordx4 v13, s[36:39], s50 offen offset:1024 sc1 lds
    buffer_load_dwordx4 v14, s[36:39], s50 offen offset:2048 sc1 lds
    s_add_u32 m0, s68, 150528
    s_nop 0
    buffer_load_dwordx4 v15, s[36:39], s50 offen offset:0 sc1 lds
    buffer_load_dwordx4 v16, s[36:39], s50 offen offset:1024 sc1 lds
    buffer_load_dwordx4 v17, s[36:39], s50 offen offset:2048 sc1 lds
    s_add_u32 s50, s58, 1179648
    s_cmp_ge_u32 s50, s59
    s_cselect_b32 s48, 2359296, 0
    s_sub_u32 s50, s50, s48
    s_cmp_lg_u32 s35, 6
    s_cbranch_scc1 L_m_64
    buffer_load_dword v53, v52, s[44:47], s8 offen
    buffer_load_dword v53, v52, s[44:47], s9 offen
L_m_64:
    s_waitcnt vmcnt(12)
    s_barrier
    s_add_u32 m0, s68, 98304
    s_nop 0
    buffer_load_dwordx4 v8, s[36:39], s50 offen offset:0 sc1 lds
    buffer_load_dwordx4 v13, s[36:39], s50 offen offset:1024 sc1 lds
    buffer_load_dwordx4 v14, s[36:39], s50 offen offset:2048 sc1 lds
    s_add_u32 m0, s68, 101376
    s_nop 0
    buffer_load_dwordx4 v15, s[36:39], s50 offen offset:0 sc1 lds
    buffer_load_dwordx4 v16, s[36:39], s50 offen offset:1024 sc1 lds
    buffer_load_dwordx4 v17, s[36:39], s50 offen offset:2048 sc1 lds
    s_add_u32 s50, s58, 1253376
    s_cmp_ge_u32 s50, s59
    s_cselect_b32 s48, 2359296, 0
    s_sub_u32 s50, s50, s48
    s_cmp_lg_u32 s35, 7
    s_cbranch_scc1 L_m_65
    buffer_load_dword v53, v52, s[44:47], s8 offen
    buffer_load_dword v53, v52, s[44:47], s9 offen
L_m_65:
    s_waitcnt vmcnt(12)
    s_barrier
    s_add_u32 m0, s68, 110592
    s_nop 0
    buffer_load_dwordx4 v8, s[36:39], s50 offen offset:0 sc1 lds
    buffer_load_dwordx4 v13, s[36:39], s50 offen offset:1024 sc1 lds
    buffer_load_dwordx4 v14, s[36:39], s50 offen offset:2048 sc1 lds
    s_add_u32 m0, s68, 113664
    s_nop 0
    buffer_load_dwordx4 v15, s[36:39], s50 offen offset:0 sc1 lds
    buffer_load_dwordx4 v16, s[36:39], s50 offen offset:1024 sc1 lds
    buffer_load_dwordx4 v17, s[36:39], s50 offen offset:2048 sc1 lds
    s_add_u32 s50, s58, 147456
    s_cmp_ge_u32 s50, s59
    s_cselect_b32 s48, 2359296, 0
    s_sub_u32 s50, s50, s48
    s_cmp_lg_u32 s35, 8
    s_cbranch_scc1 L_m_66
    buffer_load_dword v53, v52, s[44:47], s8 offen
    buffer_load_dword v53, v52, s[44:47], s9 offen
L_m_66:
    s_waitcnt vmcnt(12)
    s_barrier
    s_add_u32 m0, s68, 122880
    s_nop 0
    buffer_load_dwordx4 v8, s[36:39], s50 offen offset:0 sc1 lds
    buffer_load_dwordx4 v13, s[36:39], s50 offen offset:1024 sc1 lds
    buffer_load_dwordx4 v14, s[36:39], s50 offen offset:2048 sc1 lds
    s_add_u32 m0, s68, 125952
    s_nop 0
    buffer_load_dwordx4 v15, s[36:39], s50 offen offset:0 sc1 lds
    s_branch L_skip_13
    s_nop 0
L_stub_13:
    s_branch L_back_a1
L_skip_13:
    buffer_load_dwordx4 v16, s[36:39], s50 offen offset:1024 sc1 lds
    buffer_load_dwordx4 v17, s[36:39], s50 offen offset:2048 sc1 lds
    s_add_u32 s50, s58, 1327104
    s_cmp_ge_u32 s50, s59
    s_cselect_b32 s48, 2359296, 0
    s_sub_u32 s50, s50, s48
    s_cmp_lg_u32 s35, 9
    s_cbranch_scc1 L_m_67
    buffer_load_dword v53, v52, s[44:47], s8 offen
    buffer_load_dword v53, v52, s[44:47], s9 offen
L_m_67:
    s_waitcnt vmcnt(12)
    s_barrier
    s_add_u32 m0, s68, 135168
    s_nop 0
    buffer_load_dwordx4 v8, s[36:39], s50 offen offset:0 sc1 lds
    buffer_load_dwordx4 v13, s[36:39], s50 offen offset:1024 sc1 lds
    buffer_load_dwordx4 v14, s[36:39], s50 offen offset:2048 sc1 lds
    s_add_u32 m0, s68, 138240
    s_nop 0
    buffer_load_dwordx4 v15, s[36:39], s50 offen offset:0 sc1 lds
    buffer_load_dwordx4 v16, s[36:39], s50 offen offset:1024 sc1 lds
    buffer_load_dwordx4 v17, s[36:39], s50 offen offset:2048 sc1 lds
    s_add_u32 s50, s58, 1400832
    s_cmp_ge_u32 s50, s59
    s_cselect_b32 s48, 2359296, 0
    s_sub_u32 s50, s50, s48
    s_cmp_lg_u32 s35, 10
    s_cbranch_scc1 L_m_68
    buffer_load_dword v53, v52, s[44:47], s8 offen
    buffer_load_dword v53, v52, s[44:47], s9 offen
L_m_68:
    s_waitcnt vmcnt(12)
    s_barrier
    s_add_u32 m0, s68, 147456
    s_nop 0
    buffer_load_dwordx4 v8, s[36:39], s50 offen offset:0 sc1 lds
    buffer_load_dwordx4 v13, s[36:39], s50 offen offset:1024 sc1 lds
    buffer_load_dwordx4 v14, s[36:39], s50 offen offset:2048 sc1 lds
    s_add_u32 m0, s68, 150528
    s_nop 0
    buffer_load_dwordx4 v15, s[36:39], s50 offen offset:0 sc1 lds
    buffer_load_dwordx4 v16, s[36:39], s50 offen offset:1024 sc1 lds
    buffer_load_dwordx4 v17, s[36:39], s50 offen offset:2048 sc1 lds
    s_add_u32 s50, s58, 221184
    s_cmp_ge_u32 s50, s59
    s_cselect_b32 s48, 2359296, 0
    s_sub_u32 s50, s50, s48
    s_cmp_lg_u32 s35, 11
    s_cbranch_scc1 L_m_69
    buffer_load_dword v53, v52, s[44:47], s8 offen
    buffer_load_dword v53, v52, s[44:47], s9 offen
L_m_69:
    s_waitcnt vmcnt(12)
    s_barrier
    s_add_u32 m0, s68, 98304
    s_nop 0
    buffer_load_dwordx4 v8, s[36:39], s50 offen offset:0 sc1 lds
    buffer_load_dwordx4 v13, s[36:39], s50 offen offset:1024 sc1 lds
    buffer_load_dwordx4 v14, s[36:39], s50 offen offset:2048 sc1 lds
    s_add_u32 m0, s68, 101376
    s_nop 0
    buffer_load_dwordx4 v15, s[36:39], s50 offen offset:0 sc1 lds
    buffer_load_dwordx4 v16, s[36:39], s50 offen offset:1024 sc1 lds
    buffer_load_dwordx4 v17, s[36:39], s50 offen offset:2048 sc1 lds
    s_add_u32 s50, s58, 1474560
    s_cmp_ge_u32 s50, s59
    s_cselect_b32 s48, 2359296, 0
    s_sub_u32 s50, s50, s48
    s_cmp_lg_u32 s35, 12
    s_cbranch_scc1 L_m_70
    buffer_load_dword v53, v52, s[44:47], s8 offen
    buffer_load_dword v53, v52, s[44:47], s9 offen
L_m_70:
    s_waitcnt vmcnt(12)
    s_barrier
    s_add_u32 m0, s68, 110592
    s_nop 0
    buffer_load_dwordx4 v8, s[36:39], s50 offen offset:0 sc1 lds
    buffer_load_dwordx4 v13, s[36:39], s50 offen offset:1024 sc1 lds
    buffer_load_dwordx4 v14, s[36:39], s50 offen offset:2048 sc1 lds
    s_add_u32 m0, s68, 113664
    s_nop 0
    buffer_load_dwordx4 v15, s[36:39], s50 offen offset:0 sc1 lds
    buffer_load_dwordx4 v16, s[36:39], s50 offen offset:1024 sc1 lds
    buffer_load_dwordx4 v17, s[36:39], s50 offen offset:2048 sc1 lds
    s_add_u32 s50, s58, 1548288
    s_cmp_ge_u32 s50, s59
    s_cselect_b32 s48, 2359296, 0
    s_sub_u32 s50, s50, s48
    s_cmp_lg_u32 s35, 13
    s_cbranch_scc1 L_m_71
    buffer_load_dword v53, v52, s[44:47], s8 offen
    buffer_load_dword v53, v52, s[44:47], s9 offen
L_m_71:
    s_waitcnt vmcnt(12)
    s_barrier
    s_add_u32 m0, s68, 122880
    s_nop 0
    buffer_load_dwordx4 v8, s[36:39], s50 offen offset:0 sc1 lds
    buffer_load_dwordx4 v13, s[36:39], s50 offen offset:1024 sc1 lds
    buffer_load_dwordx4 v14, s[36:39], s50 offen offset:2048 sc1 lds
    s_add_u32 m0, s68, 125952
    s_nop 0
    buffer_load_dwordx4 v15, s[36:39], s50 offen offset:0 sc1 lds
    buffer_load_dwordx4 v16, s[36:39], s50 offen offset:1024 sc1 lds
    buffer_load_dwordx4 v17, s[36:39], s50 offen offset:2048 sc1 lds
    s_add_u32 s50, s58, 294912
    s_cmp_ge_u32 s50, s59
    s_cselect_b32 s48, 2359296, 0
    s_sub_u32 s50, s50, s48
    s_waitcnt vmcnt(12)
    s_barrier
    s_add_u32 m0, s68, 135168
    s_nop 0
    buffer_load_dwordx4 v8, s[36:39], s50 offen offset:0 sc1 lds
    buffer_load_dwordx4 v13, s[36:39], s50 offen offset:1024 sc1 lds
    buffer_load_dwordx4 v14, s[36:39], s50 offen offset:2048 sc1 lds
    s_add_u32 m0, s68, 138240
    s_nop 0
    buffer_load_dwordx4 v15, s[36:39], s50 offen offset:0 sc1 lds
    buffer_load_dwordx4 v16, s[36:39], s50 offen offset:1024 sc1 lds
    buffer_load_dwordx4 v17, s[36:39], s50 offen offset:2048 sc1 lds
    s_add_u32 s50, s58, 1622016
    s_cmp_ge_u32 s50, s59
    s_cselect_b32 s48, 2359296, 0
    s_sub_u32 s50, s50, s48
    s_waitcnt vmcnt(12)
    s_barrier
    s_add_u32 m0, s68, 147456
    s_nop 0
    buffer_load_dwordx4 v8, s[36:39], s50 offen offset:0 sc1 lds
    buffer_load_dwordx4 v13, s[36:39], s50 offen offset:1024 sc1 lds
    buffer_load_dwordx4 v14, s[36:39], s50 offen offset:2048 sc1 lds
    s_add_u32 m0, s68, 150528
    s_nop 0
    buffer_load_dwordx4 v15, s[36:39], s50 offen offset:0 sc1 lds
    buffer_load_dwordx4 v16, s[36:39], s50 offen offset:1024 sc1 lds
    buffer_load_dwordx4 v17, s[36:39], s50 offen offset:2048 sc1 lds
    s_add_u32 s50, s58, 1695744
    s_cmp_ge_u32 s50, s59
    s_cselect_b32 s48, 2359296, 0
    s_sub_u32 s50, s50, s48
    s_waitcnt vmcnt(12)
    s_barrier
    s_add_u32 m0, s68, 98304
    s_nop 0
    buffer_load_dwordx4 v8, s[36:39], s50 offen offset:0 sc1 lds
    buffer_load_dwordx4 v13, s[36:39], s50 offen offset:1024 sc1 lds
    buffer_load_dwordx4 v14, s[36:39], s50 offen offset:2048 sc1 lds
    s_add_u32 m0, s68, 101376
    s_nop 0
    buffer_load_dwordx4 v15, s[36:39], s50 offen offset:0 sc1 lds
    buffer_load_dwordx4 v16, s[36:39], s50 offen offset:1024 sc1 lds
    buffer_load_dwordx4 v17, s[36:39], s50 offen offset:2048 sc1 lds
    s_add_u32 s50, s58, 368640
    s_cmp_ge_u32 s50, s59
    s_cselect_b32 s48, 2359296, 0
    s_sub_u32 s50, s50, s48
    s_waitcnt vmcnt(12)
    s_barrier
    s_add_u32 m0, s68, 110592
    s_nop 0
    buffer_load_dwordx4 v8, s[36:39], s50 offen offset:0 sc1 lds
    buffer_load_dwordx4 v13, s[36:39], s50 offen offset:1024 sc1 lds
    buffer_load_dwordx4 v14, s[36:39], s50 offen offset:2048 sc1 lds
    s_add_u32 m0, s68, 113664
    s_nop 0
    buffer_load_dwordx4 v15, s[36:39], s50 offen offset:0 sc1 lds
    buffer_load_dwordx4 v16, s[36:39], s50 offen offset:1024 sc1 lds
    buffer_load_dwordx4 v17, s[36:39], s50 offen offset:2048 sc1 lds
    s_add_u32 s50, s58, 1769472
    s_cmp_ge_u32 s50, s59
    s_cselect_b32 s48, 2359296, 0
    s_sub_u32 s50, s50, s48
    s_waitcnt vmcnt(12)
    s_barrier
    s_add_u32 m0, s68, 122880
    s_nop 0
    buffer_load_dwordx4 v8, s[36:39], s50 offen offset:0 sc1 lds
    buffer_load_dwordx4 v13, s[36:39], s50 offen offset:1024 sc1 lds
    buffer_load_dwordx4 v14, s[36:39], s50 offen offset:2048 sc1 lds
    s_add_u32 m0, s68, 125952
    s_nop 0
    buffer_load_dwordx4 v15, s[36:39], s50 offen offset:0 sc1 lds
    buffer_load_dwordx4 v16, s[36:39], s50 offen offset:1024 sc1 lds
    buffer_load_dwordx4 v17, s[36:39], s50 offen offset:2048 sc1 lds
    s_add_u32 s50, s58, 1843200
    s_cmp_ge_u32 s50, s59
    s_cselect_b32 s48, 2359296, 0
    s_sub_u32 s50, s50, s48
    s_waitcnt vmcnt(12)
    s_barrier
    s_add_u32 m0, s68, 135168
    s_nop 0
    buffer_load_dwordx4 v8, s[36:39], s50 offen offset:0 sc1 lds
    buffer_load_dwordx4 v13, s[36:39], s50 offen offset:1024 sc1 lds
    buffer_load_dwordx4 v14, s[36:39], s50 offen offset:2048 sc1 lds
    s_add_u32 m0, s68, 138240
    s_nop 0
    buffer_load_dwordx4 v15, s[36:39], s50 offen offset:0 sc1 lds
    buffer_load_dwordx4 v16, s[36:39], s50 offen offset:1024 sc1 lds
    buffer_load_dwordx4 v17, s[36:39], s50 offen offset:2048 sc1 lds
    s_add_u32 s50, s58, 442368
    s_cmp_ge_u32 s50, s59
    s_cselect_b32 s48, 2359296, 0
    s_sub_u32 s50, s50, s48
    s_waitcnt vmcnt(12)
    s_barrier
    s_add_u32 m0, s68, 147456
    s_nop 0
    buffer_load_dwordx4 v8, s[36:39], s50 offen offset:0 sc1 lds
    buffer_load_dwordx4 v13, s[36:39], s50 offen offset:1024 sc1 lds
    buffer_load_dwordx4 v14, s[36:39], s50 offen offset:2048 sc1 lds
    s_add_u32 m0, s68, 150528
    s_nop 0
    buffer_load_dwordx4 v15, s[36:39], s50 offen offset:0 sc1 lds
    buffer_load_dwordx4 v16, s[36:39], s50 offen offset:1024 sc1 lds
    buffer_load_dwordx4 v17, s[36:39], s50 offen offset:2048 sc1 lds
    s_add_u32 s50, s58, 1916928
    s_cmp_ge_u32 s50, s59
    s_cselect_b32 s48, 2359296, 0
    s_sub_u32 s50, s50, s48
    s_waitcnt vmcnt(12)
    s_barrier
    s_add_u32 m0, s68, 98304
    s_nop 0
    buffer_load_dwordx4 v8, s[36:39], s50 offen offset:0 sc1 lds
    buffer_load_dwordx4 v13, s[36:39], s50 offen offset:1024 sc1 lds
    buffer_load_dwordx4 v14, s[36:39], s50 offen offset:2048 sc1 lds
    s_add_u32 m0, s68, 101376
    s_nop 0
    buffer_load_dwordx4 v15, s[36:39], s50 offen offset:0 sc1 lds
    buffer_load_dwordx4 v16, s[36:39], s50 offen offset:1024 sc1 lds
    buffer_load_dwordx4 v17, s[36:39], s50 offen offset:2048 sc1 lds
    s_add_u32 s50, s58, 1990656
    s_cmp_ge_u32 s50, s59
    s_cselect_b32 s48, 2359296, 0
    s_sub_u32 s50, s50, s48
    s_waitcnt vmcnt(12)
    s_barrier
    s_add_u32 m0, s68, 110592
    s_nop 0
    buffer_load_dwordx4 v8, s[36:39], s50 offen offset:0 sc1 lds
    buffer_load_dwordx4 v13, s[36:39], s50 offen offset:1024 sc1 lds
    buffer_load_dwordx4 v14, s[36:39], s50 offen offset:2048 sc1 lds
    s_add_u32 m0, s68, 113664
    s_nop 0
    buffer_load_dwordx4 v15, s[36:39], s50 offen offset:0 sc1 lds
    buffer_load_dwordx4 v16, s[36:39], s50 offen offset:1024 sc1 lds
    buffer_load_dwordx4 v17, s[36:39], s50 offen offset:2048 sc1 lds
    s_add_u32 s50, s58, 516096
    s_cmp_ge_u32 s50, s59
    s_cselect_b32 s48, 2359296, 0
    s_sub_u32 s50, s50, s48
    s_waitcnt vmcnt(12)
    s_barrier
    s_add_u32 m0, s68, 122880
    s_nop 0
    buffer_load_dwordx4 v8, s[36:39], s50 offen offset:0 sc1 lds
    buffer_load_dwordx4 v13, s[36:39], s50 offen offset:1024 sc1 lds
    buffer_load_dwordx4 v14, s[36:39], s50 offen offset:2048 sc1 lds
    s_add_u32 m0, s68, 125952
    s_nop 0
    buffer_load_dwordx4 v15, s[36:39], s50 offen offset:0 sc1 lds
    buffer_load_dwordx4 v16, s[36:39], s50 offen offset:1024 sc1 lds
    buffer_load_dwordx4 v17, s[36:39], s50 offen offset:2048 sc1 lds
    s_add_u32 s50, s58, 2064384
    s_cmp_ge_u32 s50, s59
    s_cselect_b32 s48, 2359296, 0
    s_sub_u32 s50, s50, s48
    s_waitcnt vmcnt(12)
    s_barrier
    s_add_u32 m0, s68, 135168
    s_nop 0
    buffer_load_dwordx4 v8, s[36:39], s50 offen offset:0 sc1 lds
    buffer_load_dwordx4 v13, s[36:39], s50 offen offset:1024 sc1 lds
    buffer_load_dwordx4 v14, s[36:39], s50 offen offset:2048 sc1 lds
    s_add_u32 m0, s68, 138240
    s_nop 0
    buffer_load_dwordx4 v15, s[36:39], s50 offen offset:0 sc1 lds
    buffer_load_dwordx4 v16, s[36:39], s50 offen offset:1024 sc1 lds
    buffer_load_dwordx4 v17, s[36:39], s50 offen offset:2048 sc1 lds
    s_add_u32 s50, s58, 2138112
    s_cmp_ge_u32 s50, s59
    s_cselect_b32 s48, 2359296, 0
    s_sub_u32 s50, s50, s48
    s_waitcnt vmcnt(12)
    s_barrier
    s_add_u32 m0, s68, 147456
    s_nop 0
    buffer_load_dwordx4 v8, s[36:39], s50 offen offset:0 sc1 lds
    buffer_load_dwordx4 v13, s[36:39], s50 offen offset:1024 sc1 lds
    buffer_load_dwordx4 v14, s[36:39], s50 offen offset:2048 sc1 lds
    s_add_u32 m0, s68, 150528
    s_nop 0
    buffer_load_dwordx4 v15, s[36:39], s50 offen offset:0 sc1 lds
    buffer_load_dwordx4 v16, s[36:39], s50 offen offset:1024 sc1 lds
    buffer_load_dwordx4 v17, s[36:39], s50 offen offset:2048 sc1 lds
    s_add_u32 s50, s58, 2211840
    s_cmp_ge_u32 s50, s59
    s_cselect_b32 s48, 2359296, 0
    s_sub_u32 s50, s50, s48
    s_waitcnt vmcnt(12)
    s_barrier
    s_add_u32 m0, s68, 98304
    s_nop 0
    buffer_load_dwordx4 v8, s[36:39], s50 offen offset:0 sc1 lds
    buffer_load_dwordx4 v13, s[36:39], s50 offen offset:1024 sc1 lds
    buffer_load_dwordx4 v14, s[36:39], s50 offen offset:2048 sc1 lds
    s_add_u32 m0, s68, 101376
    s_nop 0
    buffer_load_dwordx4 v15, s[36:39], s50 offen offset:0 sc1 lds
    buffer_load_dwordx4 v16, s[36:39], s50 offen offset:1024 sc1 lds
    buffer_load_dwordx4 v17, s[36:39], s50 offen offset:2048 sc1 lds
    s_add_u32 s50, s58, 2285568
    s_cmp_ge_u32 s50, s59
    s_cselect_b32 s48, 2359296, 0
    s_sub_u32 s50, s50, s48
    s_waitcnt vmcnt(12)
    s_barrier
    s_add_u32 m0, s68, 110592
    s_nop 0
    buffer_load_dwordx4 v8, s[36:39], s50 offen offset:0 sc1 lds
    buffer_load_dwordx4 v13, s[36:39], s50 offen offset:1024 sc1 lds
    buffer_load_dwordx4 v14, s[36:39], s50 offen offset:2048 sc1 lds
    s_add_u32 m0, s68, 113664
    s_nop 0
    buffer_load_dwordx4 v15, s[36:39], s50 offen offset:0 sc1 lds
    buffer_load_dwordx4 v16, s[36:39], s50 offen offset:1024 sc1 lds
    buffer_load_dwordx4 v17, s[36:39], s50 offen offset:2048 sc1 lds
    buffer_load_dword v68, v67, s[36:39], 0 offen sc1
    s_waitcnt vmcnt(12)
    s_barrier
    s_waitcnt vmcnt(6)
    s_barrier
    s_waitcnt vmcnt(0)
    s_barrier
    s_branch L_m_55
L_m_54:
    s_waitcnt lgkmcnt(0)
    buffer_store_dwordx4 v[28:31], v22, s[36:39], s57 offen sc1
    buffer_store_dwordx4 v[32:35], v23, s[36:39], s57 offen sc1
    buffer_store_dwordx4 v[36:39], v24, s[36:39], s57 offen sc1
    buffer_store_dwordx4 v[40:43], v25, s[36:39], s57 offen sc1
    buffer_store_dwordx4 v[44:47], v26, s[36:39], s57 offen sc1
    s_waitcnt vmcnt(0)
    s_barrier
    buffer_store_dword v3, v10, s[36:39], 0 offen sc1
    buffer_store_dwordx4 v[48:51], v54, s[36:39], 0 offen sc1
    v_add_u32 v76, 0, v0
    v_mul_u32_u24 v77, 1821, v76
    v_lshrrev_b32 v77, 18, v77
    v_mul_u32_u24 v77, 6912, v77
    v_lshl_add_u32 v77, v76, 4, v77
    v_subrev_u32 v56, 0, v77
    v_add_u32 v76, 64, v0
    v_mul_u32_u24 v77, 1821, v76
    v_lshrrev_b32 v77, 18, v77
    v_mul_u32_u24 v77, 6912, v77
    v_lshl_add_u32 v77, v76, 4, v77
    v_subrev_u32 v57, 1024, v77
    v_add_u32 v76, 128, v0
    v_mul_u32_u24 v77, 1821, v76
    v_lshrrev_b32 v77, 18, v77
    v_mul_u32_u24 v77, 6912, v77
    v_lshl_add_u32 v77, v76, 4, v77
    v_subrev_u32 v58, 2048, v77
    v_add_u32 v76, 192, v0
    v_mul_u32_u24 v77, 1821, v76
    v_lshrrev_b32 v77, 18, v77
    v_mul_u32_u24 v77, 6912, v77
    v_lshl_add_u32 v77, v76, 4, v77
    v_subrev_u32 v59, 3072, v77
    v_add_u32 v76, 256, v0
    v_mul_u32_u24 v77, 1821, v76
    v_lshrrev_b32 v77, 18, v77
    v_mul_u32_u24 v77, 6912, v77
    v_lshl_add_u32 v77, v76, 4, v77
    v_subrev_u32 v60, 0, v77
    v_add_u32 v76, 320, v0
    v_mul_u32_u24 v77, 1821, v76
    v_lshrrev_b32 v77, 18, v77
    v_mul_u32_u24 v77, 6912, v77
    v_lshl_add_u32 v77, v76, 4, v77
    v_subrev_u32 v61, 1024, v77
    v_add_u32 v76, 384, v0
    v_mul_u32_u24 v77, 1821, v76
    v_lshrrev_b32 v77, 18, v77
    v_mul_u32_u24 v77, 6912, v77
    v_lshl_add_u32 v77, v76, 4, v77
    v_subrev_u32 v62, 2048, v77
    v_add_u32 v76, 448, v0
    v_mul_u32_u24 v77, 1821, v76
    v_lshrrev_b32 v77, 18, v77
    v_mul_u32_u24 v77, 6912, v77
    v_lshl_add_u32 v77, v76, 4, v77
    v_subrev_u32 v63, 3072, v77
    v_add_u32 v76, 512, v0
    v_mul_u32_u24 v77, 1821, v76
    v_lshrrev_b32 v77, 18, v77
    v_mul_u32_u24 v77, 6912, v77
    v_lshl_add_u32 v77, v76, 4, v77
    v_subrev_u32 v64, 0, v77
    s_mul_i32 s48, s55, 3
    s_add_u32 s49, s48, 2
    s_lshr_b32 s48, s48, 1
    s_lshr_b32 s49, s49, 1
    v_mov_b32 v76, s48
    v_mov_b32 v77, s49
    v_cmp_gt_u32 vcc, 32, v0
    s_nop 1
    v_cndmask_b32 v76, v77, v76, vcc
    v_and_b32 v77, 31, v0
    v_min_u32 v77, 8, v77
    v_lshl_add_u32 v76, v76, 6, v77
    s_mul_i32 s48, s53, 9
    v_add_u32 v76, s48, v76
    v_lshlrev_b32 v66, 4, v76
    s_lshr_b32 s48, s54, 3
    s_lshl_b32 s48, s48, 2
    s_and_b32 s49, s54, 1
    s_lshl_b32 s49, s49, 1
    s_add_u32 s48, s48, s49
    s_add_u32 s48, s48, s62
    s_lshl_b32 s48, s48, 13
    s_add_u32 s48, s48, 15990784
    v_lshl_add_u32 v67, v0, 7, s48
    v_mov_b32 v68, 0
    s_lshl_b32 s48, s54, 7
    s_lshr_b32 s49, s53, 1
    s_lshl_b32 s49, s49, 4
    s_add_u32 s48, s48, s49
    s_mul_i32 s48, s48, 1152
    s_mul_i32 s49, s55, 288
    s_add_u32 s48, s48, s49
    s_and_b32 s49, s53, 1
    s_mul_i32 s49, s49, 144
    s_add_u32 s48, s48, s49
    s_add_u32 s12, s48, 12582912
    s_lshl_b32 s13, s62, 6
    v_add_u32 v76, s13, v0
    v_mul_u32_u24 v77, 911, v76
    v_lshrrev_b32 v77, 13, v77
    v_mul_u32_u24 v78, 9, v77
    v_sub_u32 v78, v76, v78
    v_and_b32 v76, 48, v77
    v_add_u32 v77, v77, v76
    v_mul_u32_u24 v77, 1152, v77
    v_lshl_add_u32 v77, v78, 4, v77
    v_add_u32 v70, s12, v77
    s_add_u32 s13, s13, 128
    v_add_u32 v76, s13, v0
    v_mul_u32_u24 v77, 911, v76
    v_lshrrev_b32 v77, 13, v77
    v_mul_u32_u24 v78, 9, v77
    v_sub_u32 v78, v76, v78
    v_and_b32 v76, 48, v77
    v_add_u32 v77, v77, v76
    v_mul_u32_u24 v77, 1152, v77
    v_lshl_add_u32 v77, v78, 4, v77
    v_add_u32 v71, s12, v77
    s_add_u32 s13, s13, 128
    v_add_u32 v76, s13, v0
    v_mul_u32_u24 v77, 911, v76
    v_lshrrev_b32 v77, 13, v77
    v_mul_u32_u24 v78, 9, v77
    v_sub_u32 v78, v76, v78
    v_and_b32 v76, 48, v77
    v_add_u32 v77, v77, v76
    v_mul_u32_u24 v77, 1152, v77
    v_lshl_add_u32 v77, v78, 4, v77
    v_add_u32 v72, s12, v77
    s_add_u32 s13, s13, 128
    v_add_u32 v76, s13, v0
    v_mul_u32_u24 v77, 911, v76
    v_lshrrev_b32 v77, 13, v77
    v_mul_u32_u24 v78, 9, v77
    v_sub_u32 v78, v76, v78
    v_and_b32 v76, 48, v77
    v_add_u32 v77, v77, v76
    v_mul_u32_u24 v77, 1152, v77
    v_lshl_add_u32 v77, v78, 4, v77
    v_add_u32 v73, s12, v77
    s_add_u32 s13, s13, 128
    v_add_u32 v76, s13, v0
    v_mul_u32_u24 v77, 911, v76
    v_lshrrev_b32 v77, 13, v77
    v_mul_u32_u24 v78, 9, v77
    v_sub_u32 v78, v76, v78
    v_and_b32 v76, 48, v77
    v_add_u32 v77, v77, v76
    v_mul_u32_u24 v77, 1152, v77
    v_lshl_add_u32 v77, v78, 4, v77
    v_add_u32 v74, s12, v77
    s_add_u32 s13, s13, 128
    s_mul_i32 s48, s55, 576
    s_and_b32 s49, s53, 1
    s_mul_i32 s49, s49, 288
    s_add_u32 s48, s48, s49
    s_add_u32 s48, s48, 11520
    v_min_u32 v76, 272, v8
    v_add_u32 v76, s48, v76
    s_cmp_eq_u32 s62, 1
    s_cselect_b64 vcc, -1, 0
    v_cndmask_b32 v74, v74, v76, vcc
    s_waitcnt vmcnt(0)
Lp_m_72:
    buffer_load_dword v4, v27, s[36:39], s65 offen sc1
    buffer_load_dword v5, v27, s[36:39], s69 offen sc1
    s_waitcnt vmcnt(0)
    v_cmp_ne_u32 vcc, v3, v4
    v_cmp_ne_u32 s[48:49], v3, v5
    s_nop 0
    s_or_b64 vcc, vcc, s[48:49]
    s_cbranch_vccz Le_m_73
    s_sub_u32 s7, s7, 1
    s_cbranch_scc1 Le_m_73
    s_mov_b64 exec, vcc
    s_sleep 1
    s_branch Lp_m_72
Le_m_73:
    s_mov_b64 exec, -1
    s_max_i32 s7, s7, 0
L_m_55:
    s_mul_i32 s67, s55, 2304
    s_mul_i32 s48, s53, 1327104
    s_add_u32 s67, s67, s48
    s_mul_i32 s48, s62, 36864
    s_add_u32 s67, s67, s48
    s_add_u32 s67, s67, 20971520
    s_mul_i32 s57, s62, 9216
    s_add_u32 s48, s57, 90112
    v_add_u32 v85, s48, v8
    v_add_u32 v90, 73728, v85
    s_mul_i32 s58, s64, 73728
    s_add_u32 s58, s58, s67
    s_add_u32 s59, s67, 1327104
    s_waitcnt vmcnt(0)
    v_cmp_ne_u32 vcc, v3, v68
    s_nop 0
    s_cbranch_vccz L_m_74
Lp_m_75:
    buffer_load_dword v68, v67, s[36:39], 0 offen sc1
    s_waitcnt vmcnt(0)
    v_cmp_ne_u32 vcc, v3, v68
    s_nop 0
    s_cbranch_vccz Le_m_76
    s_sub_u32 s7, s7, 1
    s_cbranch_scc1 Le_m_76
    s_mov_b64 exec, vcc
    s_sleep 1
    s_branch Lp_m_75
Le_m_76:
    s_mov_b64 exec, -1
    s_max_i32 s7, s7, 0
L_m_74:
    v_lshrrev_b32 v52, 4, v0
    v_and_b32 v53, 15, v0
    v_lshlrev_b32 v52, 12, v52
    v_lshl_add_u32 v52, v53, 7, v52
    s_lshr_b32 s48, s4, 1
    s_mul_i32 s48, s48, 4718592
    s_and_b32 s49, s4, 1
    s_lshl_b32 s49, s49, 11
    s_add_u32 s48, s48, s49
    v_add_u32 v52, s48, v52
    s_mov_b32 s35, 0
    s_mov_b32 s49, s35
    s_mul_i32 s48, s62, 1
    s_add_u32 s49, s49, s48
    s_bfm_b32 s48, s5, 0
    s_and_b32 s48, s48, 0
    s_bcnt1_i32_b32 s48, s48
    s_sub_u32 s12, s5, s48
    s_mul_i32 s35, s12, 3
    s_add_u32 s35, s35, 192
    s_add_u32 s35, s35, s49
    s_min_u32 s35, s35, 287
    s_lshl_b32 s8, s35, 14
    s_mul_i32 s35, s12, 3
    s_add_u32 s35, s35, 194
    s_sub_u32 s35, s35, s62
    s_sub_u32 s35, s35, s62
    s_add_u32 s35, s35, s49
    s_min_u32 s35, s35, 287
    s_lshl_b32 s9, s35, 14
    s_mul_i32 s35, s12, 64
    s_lshr_b32 s35, s35, 8
    s_add_u32 s35, s35, 0
    s_mul_i32 s48, s62, 0
    s_add_u32 s35, s35, s48
    s_mov_b32 s48, 0
    s_bitcmp1_b32 s48, s5
    s_cselect_b32 s35, 999, s35
    s_barrier
    s_branch L_stub_14
L_back_a2:
    s_barrier
    s_barrier
    s_barrier
    s_cmp_ge_u32 s5, 27
    s_cbranch_scc1 L_m_77
    buffer_store_dword v3, v11, s[36:39], 0 offen sc1
    s_branch L_m_78
L_m_77:
    s_lshl_b32 s50, s2, 7
    s_add_u32 s50, s50, 622592
    v_mov_b32 v28, 0
Lp_m_79:
    buffer_load_dword v29, v28, s[36:39], s50 offen sc1
    s_waitcnt vmcnt(0)
    v_cmp_ne_u32 vcc, v3, v29
    s_nop 0
    s_cbranch_vccz Le_m_80
    s_sub_u32 s7, s7, 1
    s_cbranch_scc1 Le_m_80
    s_sleep 4
    s_branch Lp_m_79
Le_m_80:
    s_max_i32 s7, s7, 0
L_m_78:
    s_add_u32 s50, s58, 442368
    s_cmp_ge_u32 s50, s59
    s_cselect_b32 s48, 1327104, 0
    s_sub_u32 s50, s50, s48
    s_add_u32 m0, s57, 90112
    s_nop 0
    buffer_load_dwordx4 v56, s[36:39], s50 offen offset:0 sc1 lds
    buffer_load_dwordx4 v57, s[36:39], s50 offen offset:1024 sc1 lds
    buffer_load_dwordx4 v58, s[36:39], s50 offen offset:2048 sc1 lds
    buffer_load_dwordx4 v59, s[36:39], s50 offen offset:3072 sc1 lds
    s_add_u32 m0, s57, 94208
    s_nop 0
    buffer_load_dwordx4 v60, s[36:39], s50 offen offset:0 sc1 lds
    buffer_load_dwordx4 v61, s[36:39], s50 offen offset:1024 sc1 lds
    buffer_load_dwordx4 v62, s[36:39], s50 offen offset:2048 sc1 lds
    buffer_load_dwordx4 v63, s[36:39], s50 offen offset:3072 sc1 lds
    s_add_u32 m0, s57, 98304
    s_nop 0
    buffer_load_dwordx4 v64, s[36:39], s50 offen offset:0 sc1 lds
    s_add_u32 s50, s58, 516096
    s_cmp_ge_u32 s50, s59
    s_cselect_b32 s48, 1327104, 0
    s_sub_u32 s50, s50, s48
    s_add_u32 m0, s57, 108544
    s_nop 0
    buffer_load_dwordx4 v56, s[36:39], s50 offen offset:0 sc1 lds
    buffer_load_dwordx4 v57, s[36:39], s50 offen offset:1024 sc1 lds
    buffer_load_dwordx4 v58, s[36:39], s50 offen offset:2048 sc1 lds
    buffer_load_dwordx4 v59, s[36:39], s50 offen offset:3072 sc1 lds
    s_add_u32 m0, s57, 112640
    s_nop 0
    buffer_load_dwordx4 v60, s[36:39], s50 offen offset:0 sc1 lds
    buffer_load_dwordx4 v61, s[36:39], s50 offen offset:1024 sc1 lds
    buffer_load_dwordx4 v62, s[36:39], s50 offen offset:2048 sc1 lds
    buffer_load_dwordx4 v63, s[36:39], s50 offen offset:3072 sc1 lds
    s_add_u32 m0, s57, 116736
    s_nop 0
    buffer_load_dwordx4 v64, s[36:39], s50 offen offset:0 sc1 lds
    s_add_u32 s50, s58, 589824
    s_cmp_ge_u32 s50, s59
    s_cselect_b32 s48, 1327104, 0
    s_sub_u32 s50, s50, s48
    s_add_u32 m0, s57, 126976
    s_nop 0
    buffer_load_dwordx4 v56, s[36:39], s50 offen offset:0 sc1 lds
    buffer_load_dwordx4 v57, s[36:39], s50 offen offset:1024 sc1 lds
    buffer_load_dwordx4 v58, s[36:39], s50 offen offset:2048 sc1 lds
    buffer_load_dwordx4 v59, s[36:39], s50 offen offset:3072 sc1 lds
    s_add_u32 m0, s57, 131072
    s_nop 0
    buffer_load_dwordx4 v60, s[36:39], s50 offen offset:0 sc1 lds
    buffer_load_dwordx4 v61, s[36:39], s50 offen offset:1024 sc1 lds
    buffer_load_dwordx4 v62, s[36:39], s50 offen offset:2048 sc1 lds
    buffer_load_dwordx4 v63, s[36:39], s50 offen offset:3072 sc1 lds
    s_add_u32 m0, s57, 135168
    s_nop 0
    buffer_load_dwordx4 v64, s[36:39], s50 offen offset:0 sc1 lds
    s_add_u32 s50, s58, 663552
    s_cmp_ge_u32 s50, s59
    s_cselect_b32 s48, 1327104, 0
    s_sub_u32 s50, s50, s48
    s_waitcnt vmcnt(18)
L_m_81:
    ds_read_b32 v76, v85 offset:0
    ds_read_b32 v77, v85 offset:1024
    ds_read_b32 v78, v85 offset:2048
    s_branch L_skip_14
    s_nop 0
L_stub_14:
    s_branch L_back_a2
L_skip_14:
    ds_read_b32 v79, v85 offset:3072
    ds_read_b32 v80, v85 offset:4096
    ds_read_b32 v81, v85 offset:5120
    ds_read_b32 v82, v85 offset:6144
    ds_read_b32 v83, v85 offset:7168
    ds_read_b32 v84, v85 offset:8192
    s_waitcnt lgkmcnt(6)
    v_max3_u32 v76, v76, v77, v78
    s_waitcnt lgkmcnt(4)
    v_max3_u32 v76, v76, v79, v80
    s_waitcnt lgkmcnt(2)
    v_max3_u32 v76, v76, v81, v82
    s_waitcnt lgkmcnt(0)
    v_max3_u32 v76, v76, v83, v84
    v_cmp_eq_u32 vcc, -1, v76
    s_nop 0
    s_cbranch_vccz L_m_82
    s_sub_u32 s7, s7, 1
    s_cbranch_scc1 L_m_82
    s_mov_b32 s14, m0
    s_sleep 2
    s_add_u32 s15, s58, 442368
    s_cmp_ge_u32 s15, s59
    s_cselect_b32 s48, 1327104, 0
    s_sub_u32 s15, s15, s48
    s_add_u32 m0, s57, 90112
    s_nop 0
    buffer_load_dwordx4 v56, s[36:39], s15 offen offset:0 sc1 lds
    buffer_load_dwordx4 v57, s[36:39], s15 offen offset:1024 sc1 lds
    buffer_load_dwordx4 v58, s[36:39], s15 offen offset:2048 sc1 lds
    buffer_load_dwordx4 v59, s[36:39], s15 offen offset:3072 sc1 lds
    s_add_u32 m0, s57, 94208
    s_nop 0
    buffer_load_dwordx4 v60, s[36:39], s15 offen offset:0 sc1 lds
    buffer_load_dwordx4 v61, s[36:39], s15 offen offset:1024 sc1 lds
    buffer_load_dwordx4 v62, s[36:39], s15 offen offset:2048 sc1 lds
    buffer_load_dwordx4 v63, s[36:39], s15 offen offset:3072 sc1 lds
    s_add_u32 m0, s57, 98304
    s_nop 0
    buffer_load_dwordx4 v64, s[36:39], s15 offen offset:0 sc1 lds
    s_mov_b32 m0, s14
    s_waitcnt vmcnt(0)
    s_branch L_m_81
L_m_82:
    s_max_i32 s7, s7, 0
    s_barrier
    s_add_u32 m0, s57, 145408
    s_nop 0
    buffer_load_dwordx4 v56, s[36:39], s50 offen offset:0 sc1 lds
    buffer_load_dwordx4 v57, s[36:39], s50 offen offset:1024 sc1 lds
    buffer_load_dwordx4 v58, s[36:39], s50 offen offset:2048 sc1 lds
    buffer_load_dwordx4 v59, s[36:39], s50 offen offset:3072 sc1 lds
    s_add_u32 m0, s57, 149504
    s_nop 0
    buffer_load_dwordx4 v60, s[36:39], s50 offen offset:0 sc1 lds
    buffer_load_dwordx4 v61, s[36:39], s50 offen offset:1024 sc1 lds
    buffer_load_dwordx4 v62, s[36:39], s50 offen offset:2048 sc1 lds
    buffer_load_dwordx4 v63, s[36:39], s50 offen offset:3072 sc1 lds
    s_add_u32 m0, s57, 153600
    s_nop 0
    buffer_load_dwordx4 v64, s[36:39], s50 offen offset:0 sc1 lds
    s_add_u32 s50, s58, 0
    s_cmp_ge_u32 s50, s59
    s_cselect_b32 s48, 1327104, 0
    s_sub_u32 s50, s50, s48
    s_cmp_lg_u32 s35, 0
    s_cbranch_scc1 L_m_83
    buffer_load_dword v53, v52, s[44:47], s8 offen
    s_cmp_lg_u32 s62, 0
    s_cbranch_scc1 L_m_83
    buffer_load_dword v53, v52, s[44:47], s9 offen
L_m_83:
    s_waitcnt vmcnt(18)
L_m_84:
    ds_read_b32 v76, v85 offset:18432
    ds_read_b32 v77, v85 offset:19456
    ds_read_b32 v78, v85 offset:20480
    ds_read_b32 v79, v85 offset:21504
    ds_read_b32 v80, v85 offset:22528
    ds_read_b32 v81, v85 offset:23552
    ds_read_b32 v82, v85 offset:24576
    ds_read_b32 v83, v85 offset:25600
    ds_read_b32 v84, v85 offset:26624
    s_waitcnt lgkmcnt(6)
    v_max3_u32 v76, v76, v77, v78
    s_waitcnt lgkmcnt(4)
    v_max3_u32 v76, v76, v79, v80
    s_waitcnt lgkmcnt(2)
    v_max3_u32 v76, v76, v81, v82
    s_waitcnt lgkmcnt(0)
    v_max3_u32 v76, v76, v83, v84
    v_cmp_eq_u32 vcc, -1, v76
    s_nop 0
    s_cbranch_vccz L_m_85
    s_sub_u32 s7, s7, 1
    s_cbranch_scc1 L_m_85
    s_mov_b32 s14, m0
    s_sleep 2
    s_add_u32 s15, s58, 516096
    s_cmp_ge_u32 s15, s59
    s_cselect_b32 s48, 1327104, 0
    s_sub_u32 s15, s15, s48
    s_add_u32 m0, s57, 108544
    s_nop 0
    buffer_load_dwordx4 v56, s[36:39], s15 offen offset:0 sc1 lds
    buffer_load_dwordx4 v57, s[36:39], s15 offen offset:1024 sc1 lds
    buffer_load_dwordx4 v58, s[36:39], s15 offen offset:2048 sc1 lds
    buffer_load_dwordx4 v59, s[36:39], s15 offen offset:3072 sc1 lds
    s_add_u32 m0, s57, 112640
    s_nop 0
    buffer_load_dwordx4 v60, s[36:39], s15 offen offset:0 sc1 lds
    buffer_load_dwordx4 v61, s[36:39], s15 offen offset:1024 sc1 lds
    buffer_load_dwordx4 v62, s[36:39], s15 offen offset:2048 sc1 lds
    buffer_load_dwordx4 v63, s[36:39], s15 offen offset:3072 sc1 lds
    s_add_u32 m0, s57, 116736
    s_nop 0
    buffer_load_dwordx4 v64, s[36:39], s15 offen offset:0 sc1 lds
    s_mov_b32 m0, s14
    s_waitcnt vmcnt(0)
    s_branch L_m_84
L_m_85:
    s_max_i32 s7, s7, 0
    s_barrier
    buffer_load_dword v28, v66, s[36:39], s66 offen sc1
    s_cmp_lg_u32 s35, 1
    s_cbranch_scc1 L_m_86
    buffer_load_dword v53, v52, s[44:47], s8 offen
    s_cmp_lg_u32 s62, 0
    s_cbranch_scc1 L_m_86
    buffer_load_dword v53, v52, s[44:47], s9 offen
L_m_86:
    s_waitcnt vmcnt(10)
L_m_87:
    ds_read_b32 v76, v85 offset:36864
    ds_read_b32 v77, v85 offset:37888
    ds_read_b32 v78, v85 offset:38912
    ds_read_b32 v79, v85 offset:39936
    ds_read_b32 v80, v85 offset:40960
    ds_read_b32 v81, v85 offset:41984
    ds_read_b32 v82, v85 offset:43008
    ds_read_b32 v83, v85 offset:44032
    ds_read_b32 v84, v85 offset:45056
    s_waitcnt lgkmcnt(6)
    v_max3_u32 v76, v76, v77, v78
    s_waitcnt lgkmcnt(4)
    v_max3_u32 v76, v76, v79, v80
    s_waitcnt lgkmcnt(2)
    v_max3_u32 v76, v76, v81, v82
    s_waitcnt lgkmcnt(0)
    v_max3_u32 v76, v76, v83, v84
    v_cmp_eq_u32 vcc, -1, v76
    s_nop 0
    s_cbranch_vccz L_m_88
    s_sub_u32 s7, s7, 1
    s_cbranch_scc1 L_m_88
    s_mov_b32 s14, m0
    s_sleep 2
    s_add_u32 s15, s58, 589824
    s_cmp_ge_u32 s15, s59
    s_cselect_b32 s48, 1327104, 0
    s_sub_u32 s15, s15, s48
    s_add_u32 m0, s57, 126976
    s_nop 0
    buffer_load_dwordx4 v56, s[36:39], s15 offen offset:0 sc1 lds
    buffer_load_dwordx4 v57, s[36:39], s15 offen offset:1024 sc1 lds
    buffer_load_dwordx4 v58, s[36:39], s15 offen offset:2048 sc1 lds
    buffer_load_dwordx4 v59, s[36:39], s15 offen offset:3072 sc1 lds
    s_add_u32 m0, s57, 131072
    s_nop 0
    buffer_load_dwordx4 v60, s[36:39], s15 offen offset:0 sc1 lds
    buffer_load_dwordx4 v61, s[36:39], s15 offen offset:1024 sc1 lds
    buffer_load_dwordx4 v62, s[36:39], s15 offen offset:2048 sc1 lds
    buffer_load_dwordx4 v63, s[36:39], s15 offen offset:3072 sc1 lds
    s_add_u32 m0, s57, 135168
    s_nop 0
    buffer_load_dwordx4 v64, s[36:39], s15 offen offset:0 sc1 lds
    s_mov_b32 m0, s14
    s_waitcnt vmcnt(0)
    s_branch L_m_87
L_m_88:
    s_max_i32 s7, s7, 0
    s_barrier
    s_waitcnt vmcnt(0)
    v_cmp_ne_u32 vcc, v3, v28
    s_nop 0
    s_cbranch_vccz L_m_89
Lp_m_90:
    buffer_load_dword v28, v66, s[36:39], s66 offen sc1
    s_waitcnt vmcnt(0)
    v_cmp_ne_u32 vcc, v3, v28
    s_nop 0
    s_cbranch_vccz Le_m_91
    s_sub_u32 s7, s7, 1
    s_cbranch_scc1 Le_m_91
    s_mov_b64 exec, vcc
    s_sleep 1
    s_branch Lp_m_90
Le_m_91:
    s_mov_b64 exec, -1
    s_max_i32 s7, s7, 0
L_m_89:
    s_add_u32 m0, s57, 90112
    s_nop 0
    buffer_load_dwordx4 v56, s[36:39], s50 offen offset:0 sc1 lds
    buffer_load_dwordx4 v57, s[36:39], s50 offen offset:1024 sc1 lds
    buffer_load_dwordx4 v58, s[36:39], s50 offen offset:2048 sc1 lds
    buffer_load_dwordx4 v59, s[36:39], s50 offen offset:3072 sc1 lds
    s_add_u32 m0, s57, 94208
    s_nop 0
    buffer_load_dwordx4 v60, s[36:39], s50 offen offset:0 sc1 lds
    buffer_load_dwordx4 v61, s[36:39], s50 offen offset:1024 sc1 lds
    buffer_load_dwordx4 v62, s[36:39], s50 offen offset:2048 sc1 lds
    buffer_load_dwordx4 v63, s[36:39], s50 offen offset:3072 sc1 lds
    s_add_u32 m0, s57, 98304
    s_nop 0
    buffer_load_dwordx4 v64, s[36:39], s50 offen offset:0 sc1 lds
    s_add_u32 s50, s58, 737280
    s_cmp_ge_u32 s50, s59
    s_cselect_b32 s48, 1327104, 0
    s_sub_u32 s50, s50, s48
    s_cmp_lg_u32 s35, 2
    s_cbranch_scc1 L_m_92
    buffer_load_dword v53, v52, s[44:47], s8 offen
    s_cmp_lg_u32 s62, 0
    s_cbranch_scc1 L_m_92
    buffer_load_dword v53, v52, s[44:47], s9 offen
L_m_92:
    s_waitcnt vmcnt(10)
L_m_93:
    ds_read_b32 v76, v85 offset:55296
    ds_read_b32 v77, v85 offset:56320
    ds_read_b32 v78, v85 offset:57344
    ds_read_b32 v79, v85 offset:58368
    ds_read_b32 v80, v85 offset:59392
    ds_read_b32 v81, v85 offset:60416
    ds_read_b32 v82, v85 offset:61440
    ds_read_b32 v83, v85 offset:62464
    ds_read_b32 v84, v85 offset:63488
    s_waitcnt lgkmcnt(6)
    v_max3_u32 v76, v76, v77, v78
    s_waitcnt lgkmcnt(4)
    v_max3_u32 v76, v76, v79, v80
    s_waitcnt lgkmcnt(2)
    v_max3_u32 v76, v76, v81, v82
    s_waitcnt lgkmcnt(0)
    v_max3_u32 v76, v76, v83, v84
    v_cmp_eq_u32 vcc, -1, v76
    s_nop 0
    s_cbranch_vccz L_m_94
    s_sub_u32 s7, s7, 1
    s_cbranch_scc1 L_m_94
    s_mov_b32 s14, m0
    s_sleep 2
    s_add_u32 s15, s58, 663552
    s_cmp_ge_u32 s15, s59
    s_cselect_b32 s48, 1327104, 0
    s_sub_u32 s15, s15, s48
    s_add_u32 m0, s57, 145408
    s_nop 0
    buffer_load_dwordx4 v56, s[36:39], s15 offen offset:0 sc1 lds
    buffer_load_dwordx4 v57, s[36:39], s15 offen offset:1024 sc1 lds
    buffer_load_dwordx4 v58, s[36:39], s15 offen offset:2048 sc1 lds
    buffer_load_dwordx4 v59, s[36:39], s15 offen offset:3072 sc1 lds
    s_add_u32 m0, s57, 149504
    s_nop 0
    buffer_load_dwordx4 v60, s[36:39], s15 offen offset:0 sc1 lds
    buffer_load_dwordx4 v61, s[36:39], s15 offen offset:1024 sc1 lds
    buffer_load_dwordx4 v62, s[36:39], s15 offen offset:2048 sc1 lds
    buffer_load_dwordx4 v63, s[36:39], s15 offen offset:3072 sc1 lds
    s_add_u32 m0, s57, 153600
    s_nop 0
    buffer_load_dwordx4 v64, s[36:39], s15 offen offset:0 sc1 lds
    s_mov_b32 m0, s14
    s_waitcnt vmcnt(0)
    s_branch L_m_93
L_m_94:
    s_max_i32 s7, s7, 0
    s_barrier
    s_add_u32 m0, s57, 108544
    s_nop 0
    buffer_load_dwordx4 v56, s[36:39], s50 offen offset:0 sc1 lds
    buffer_load_dwordx4 v57, s[36:39], s50 offen offset:1024 sc1 lds
    buffer_load_dwordx4 v58, s[36:39], s50 offen offset:2048 sc1 lds
    buffer_load_dwordx4 v59, s[36:39], s50 offen offset:3072 sc1 lds
    s_add_u32 m0, s57, 112640
    s_nop 0
    buffer_load_dwordx4 v60, s[36:39], s50 offen offset:0 sc1 lds
    buffer_load_dwordx4 v61, s[36:39], s50 offen offset:1024 sc1 lds
    buffer_load_dwordx4 v62, s[36:39], s50 offen offset:2048 sc1 lds
    buffer_load_dwordx4 v63, s[36:39], s50 offen offset:3072 sc1 lds
    s_add_u32 m0, s57, 116736
    s_nop 0
    buffer_load_dwordx4 v64, s[36:39], s50 offen offset:0 sc1 lds
    s_add_u32 s50, s58, 73728
    s_cmp_ge_u32 s50, s59
    s_cselect_b32 s48, 1327104, 0
    s_sub_u32 s50, s50, s48
    s_cmp_lg_u32 s35, 3
    s_cbranch_scc1 L_m_95
    buffer_load_dword v53, v52, s[44:47], s8 offen
    s_cmp_lg_u32 s62, 0
    s_cbranch_scc1 L_m_95
    buffer_load_dword v53, v52, s[44:47], s9 offen
L_m_95:
    s_waitcnt vmcnt(9)
    s_barrier
    s_add_u32 m0, s57, 126976
    s_nop 0
    buffer_load_dwordx4 v56, s[36:39], s50 offen offset:0 sc1 lds
    buffer_load_dwordx4 v57, s[36:39], s50 offen offset:1024 sc1 lds
    buffer_load_dwordx4 v58, s[36:39], s50 offen offset:2048 sc1 lds
    buffer_load_dwordx4 v59, s[36:39], s50 offen offset:3072 sc1 lds
    s_add_u32 m0, s57, 131072
    s_nop 0
    buffer_load_dwordx4 v60, s[36:39], s50 offen offset:0 sc1 lds
    buffer_load_dwordx4 v61, s[36:39], s50 offen offset:1024 sc1 lds
    buffer_load_dwordx4 v62, s[36:39], s50 offen offset:2048 sc1 lds
    buffer_load_dwordx4 v63, s[36:39], s50 offen offset:3072 sc1 lds
    s_add_u32 m0, s57, 135168
    s_nop 0
    buffer_load_dwordx4 v64, s[36:39], s50 offen offset:0 sc1 lds
    s_add_u32 s50, s58, 811008
    s_cmp_ge_u32 s50, s59
    s_cselect_b32 s48, 1327104, 0
    s_sub_u32 s50, s50, s48
    s_cmp_lg_u32 s35, 4
    s_cbranch_scc1 L_m_96
    buffer_load_dword v53, v52, s[44:47], s8 offen
    s_cmp_lg_u32 s62, 0
    s_cbranch_scc1 L_m_96
    buffer_load_dword v53, v52, s[44:47], s9 offen
L_m_96:
    s_waitcnt vmcnt(9)
    s_barrier
    s_add_u32 m0, s57, 145408
    s_nop 0
    buffer_load_dwordx4 v56, s[36:39], s50 offen offset:0 sc1 lds
    buffer_load_dwordx4 v57, s[36:39], s50 offen offset:1024 sc1 lds
    buffer_load_dwordx4 v58, s[36:39], s50 offen offset:2048 sc1 lds
    buffer_load_dwordx4 v59, s[36:39], s50 offen offset:3072 sc1 lds
    s_add_u32 m0, s57, 149504
    s_nop 0
    buffer_load_dwordx4 v60, s[36:39], s50 offen offset:0 sc1 lds
    buffer_load_dwordx4 v61, s[36:39], s50 offen offset:1024 sc1 lds
    buffer_load_dwordx4 v62, s[36:39], s50 offen offset:2048 sc1 lds
    buffer_load_dwordx4 v63, s[36:39], s50 offen offset:3072 sc1 lds
    s_add_u32 m0, s57, 153600
    s_nop 0
    buffer_load_dwordx4 v64, s[36:39], s50 offen offset:0 sc1 lds
    s_add_u32 s50, s58, 147456
    s_cmp_ge_u32 s50, s59
    s_cselect_b32 s48, 1327104, 0
    s_sub_u32 s50, s50, s48
    s_cmp_lg_u32 s35, 5
    s_cbranch_scc1 L_m_97
    buffer_load_dword v53, v52, s[44:47], s8 offen
    s_cmp_lg_u32 s62, 0
    s_cbranch_scc1 L_m_97
    buffer_load_dword v53, v52, s[44:47], s9 offen
L_m_97:
    s_waitcnt vmcnt(9)
    s_barrier
    s_add_u32 m0, s57, 90112
    s_nop 0
    buffer_load_dwordx4 v56, s[36:39], s50 offen offset:0 sc1 lds
    buffer_load_dwordx4 v57, s[36:39], s50 offen offset:1024 sc1 lds
    buffer_load_dwordx4 v58, s[36:39], s50 offen offset:2048 sc1 lds
    buffer_load_dwordx4 v59, s[36:39], s50 offen offset:3072 sc1 lds
    s_add_u32 m0, s57, 94208
    s_nop 0
    buffer_load_dwordx4 v60, s[36:39], s50 offen offset:0 sc1 lds
    buffer_load_dwordx4 v61, s[36:39], s50 offen offset:1024 sc1 lds
    buffer_load_dwordx4 v62, s[36:39], s50 offen offset:2048 sc1 lds
    buffer_load_dwordx4 v63, s[36:39], s50 offen offset:3072 sc1 lds
    s_add_u32 m0, s57, 98304
    s_nop 0
    buffer_load_dwordx4 v64, s[36:39], s50 offen offset:0 sc1 lds
    s_add_u32 s50, s58, 884736
    s_cmp_ge_u32 s50, s59
    s_cselect_b32 s48, 1327104, 0
    s_sub_u32 s50, s50, s48
    s_cmp_lg_u32 s35, 6
    s_cbranch_scc1 L_m_98
    buffer_load_dword v53, v52, s[44:47], s8 offen
    s_cmp_lg_u32 s62, 0
    s_cbranch_scc1 L_m_98
    buffer_load_dword v53, v52, s[44:47], s9 offen
L_m_98:
    s_waitcnt vmcnt(9)
    s_barrier
    s_add_u32 m0, s57, 108544
    s_nop 0
    buffer_load_dwordx4 v56, s[36:39], s50 offen offset:0 sc1 lds
    buffer_load_dwordx4 v57, s[36:39], s50 offen offset:1024 sc1 lds
    buffer_load_dwordx4 v58, s[36:39], s50 offen offset:2048 sc1 lds
    buffer_load_dwordx4 v59, s[36:39], s50 offen offset:3072 sc1 lds
    s_add_u32 m0, s57, 112640
    s_nop 0
    buffer_load_dwordx4 v60, s[36:39], s50 offen offset:0 sc1 lds
    buffer_load_dwordx4 v61, s[36:39], s50 offen offset:1024 sc1 lds
    buffer_load_dwordx4 v62, s[36:39], s50 offen offset:2048 sc1 lds
    buffer_load_dwordx4 v63, s[36:39], s50 offen offset:3072 sc1 lds
    s_add_u32 m0, s57, 116736
    s_nop 0
    buffer_load_dwordx4 v64, s[36:39], s50 offen offset:0 sc1 lds
    s_add_u32 s50, s58, 221184
    s_cmp_ge_u32 s50, s59
    s_cselect_b32 s48, 1327104, 0
    s_sub_u32 s50, s50, s48
    s_cmp_lg_u32 s35, 7
    s_cbranch_scc1 L_m_99
    buffer_load_dword v53, v52, s[44:47], s8 offen
    s_cmp_lg_u32 s62, 0
    s_cbranch_scc1 L_m_99
    buffer_load_dword v53, v52, s[44:47], s9 offen
L_m_99:
    s_waitcnt vmcnt(9)
    s_barrier
    s_add_u32 m0, s57, 126976
    s_nop 0
    buffer_load_dwordx4 v56, s[36:39], s50 offen offset:0 sc1 lds
    buffer_load_dwordx4 v57, s[36:39], s50 offen offset:1024 sc1 lds
    buffer_load_dwordx4 v58, s[36:39], s50 offen offset:2048 sc1 lds
    buffer_load_dwordx4 v59, s[36:39], s50 offen offset:3072 sc1 lds
    s_add_u32 m0, s57, 131072
    s_nop 0
    buffer_load_dwordx4 v60, s[36:39], s50 offen offset:0 sc1 lds
    buffer_load_dwordx4 v61, s[36:39], s50 offen offset:1024 sc1 lds
    buffer_load_dwordx4 v62, s[36:39], s50 offen offset:2048 sc1 lds
    buffer_load_dwordx4 v63, s[36:39], s50 offen offset:3072 sc1 lds
    s_add_u32 m0, s57, 135168
    s_nop 0
    buffer_load_dwordx4 v64, s[36:39], s50 offen offset:0 sc1 lds
    s_add_u32 s50, s58, 294912
    s_cmp_ge_u32 s50, s59
    s_cselect_b32 s48, 1327104, 0
    s_sub_u32 s50, s50, s48
    s_waitcnt vmcnt(9)
    s_barrier
    s_add_u32 m0, s57, 145408
    s_nop 0
    buffer_load_dwordx4 v56, s[36:39], s50 offen offset:0 sc1 lds
    buffer_load_dwordx4 v57, s[36:39], s50 offen offset:1024 sc1 lds
    buffer_load_dwordx4 v58, s[36:39], s50 offen offset:2048 sc1 lds
    buffer_load_dwordx4 v59, s[36:39], s50 offen offset:3072 sc1 lds
    s_add_u32 m0, s57, 149504
    s_nop 0
    buffer_load_dwordx4 v60, s[36:39], s50 offen offset:0 sc1 lds
    buffer_load_dwordx4 v61, s[36:39], s50 offen offset:1024 sc1 lds
    buffer_load_dwordx4 v62, s[36:39], s50 offen offset:2048 sc1 lds
    buffer_load_dwordx4 v63, s[36:39], s50 offen offset:3072 sc1 lds
    s_add_u32 m0, s57, 153600
    s_nop 0
    buffer_load_dwordx4 v64, s[36:39], s50 offen offset:0 sc1 lds
    s_add_u32 s50, s58, 368640
    s_cmp_ge_u32 s50, s59
    s_cselect_b32 s48, 1327104, 0
    s_sub_u32 s50, s50, s48
    s_waitcnt vmcnt(9)
    s_barrier
    s_add_u32 m0, s57, 90112
    s_nop 0
    buffer_load_dwordx4 v56, s[36:39], s50 offen offset:0 sc1 lds
    buffer_load_dwordx4 v57, s[36:39], s50 offen offset:1024 sc1 lds
    buffer_load_dwordx4 v58, s[36:39], s50 offen offset:2048 sc1 lds
    buffer_load_dwordx4 v59, s[36:39], s50 offen offset:3072 sc1 lds
    s_add_u32 m0, s57, 94208
    s_nop 0
    buffer_load_dwordx4 v60, s[36:39], s50 offen offset:0 sc1 lds
    buffer_load_dwordx4 v61, s[36:39], s50 offen offset:1024 sc1 lds
    buffer_load_dwordx4 v62, s[36:39], s50 offen offset:2048 sc1 lds
    buffer_load_dwordx4 v63, s[36:39], s50 offen offset:3072 sc1 lds
    s_add_u32 m0, s57, 98304
    s_nop 0
    buffer_load_dwordx4 v64, s[36:39], s50 offen offset:0 sc1 lds
    s_add_u32 s50, s58, 958464
    s_cmp_ge_u32 s50, s59
    s_cselect_b32 s48, 1327104, 0
    s_sub_u32 s50, s50, s48
    s_waitcnt vmcnt(9)
    s_barrier
    s_add_u32 m0, s57, 108544
    s_nop 0
    buffer_load_dwordx4 v56, s[36:39], s50 offen offset:0 sc1 lds
    buffer_load_dwordx4 v57, s[36:39], s50 offen offset:1024 sc1 lds
    buffer_load_dwordx4 v58, s[36:39], s50 offen offset:2048 sc1 lds
    buffer_load_dwordx4 v59, s[36:39], s50 offen offset:3072 sc1 lds
    s_add_u32 m0, s57, 112640
    s_nop 0
    buffer_load_dwordx4 v60, s[36:39], s50 offen offset:0 sc1 lds
    buffer_load_dwordx4 v61, s[36:39], s50 offen offset:1024 sc1 lds
    buffer_load_dwordx4 v62, s[36:39], s50 offen offset:2048 sc1 lds
    buffer_load_dwordx4 v63, s[36:39], s50 offen offset:3072 sc1 lds
    s_add_u32 m0, s57, 116736
    s_nop 0
    buffer_load_dwordx4 v64, s[36:39], s50 offen offset:0 sc1 lds
    s_add_u32 s50, s58, 1032192
    s_cmp_ge_u32 s50, s59
    s_cselect_b32 s48, 1327104, 0
    s_sub_u32 s50, s50, s48
    s_waitcnt vmcnt(9)
    s_barrier
    s_add_u32 m0, s57, 126976
    s_nop 0
    buffer_load_dwordx4 v56, s[36:39], s50 offen offset:0 sc1 lds
    buffer_load_dwordx4 v57, s[36:39], s50 offen offset:1024 sc1 lds
    buffer_load_dwordx4 v58, s[36:39], s50 offen offset:2048 sc1 lds
    buffer_load_dwordx4 v59, s[36:39], s50 offen offset:3072 sc1 lds
    s_add_u32 m0, s57, 131072
    s_nop 0
    buffer_load_dwordx4 v60, s[36:39], s50 offen offset:0 sc1 lds
    buffer_load_dwordx4 v61, s[36:39], s50 offen offset:1024 sc1 lds
    buffer_load_dwordx4 v62, s[36:39], s50 offen offset:2048 sc1 lds
    buffer_load_dwordx4 v63, s[36:39], s50 offen offset:3072 sc1 lds
    s_add_u32 m0, s57, 135168
    s_nop 0
    buffer_load_dwordx4 v64, s[36:39], s50 offen offset:0 sc1 lds
    s_add_u32 s50, s58, 1105920
    s_cmp_ge_u32 s50, s59
    s_cselect_b32 s48, 1327104, 0
    s_sub_u32 s50, s50, s48
    s_waitcnt vmcnt(9)
    s_barrier
    s_add_u32 m0, s57, 145408
    s_nop 0
    buffer_load_dwordx4 v56, s[36:39], s50 offen offset:0 sc1 lds
    buffer_load_dwordx4 v57, s[36:39], s50 offen offset:1024 sc1 lds
    buffer_load_dwordx4 v58, s[36:39], s50 offen offset:2048 sc1 lds
    buffer_load_dwordx4 v59, s[36:39], s50 offen offset:3072 sc1 lds
    s_add_u32 m0, s57, 149504
    s_nop 0
    buffer_load_dwordx4 v60, s[36:39], s50 offen offset:0 sc1 lds
    buffer_load_dwordx4 v61, s[36:39], s50 offen offset:1024 sc1 lds
    buffer_load_dwordx4 v62, s[36:39], s50 offen offset:2048 sc1 lds
    buffer_load_dwordx4 v63, s[36:39], s50 offen offset:3072 sc1 lds
    s_add_u32 m0, s57, 153600
    s_nop 0
    buffer_load_dwordx4 v64, s[36:39], s50 offen offset:0 sc1 lds
    s_add_u32 s50, s58, 1179648
    s_cmp_ge_u32 s50, s59
    s_cselect_b32 s48, 1327104, 0
    s_sub_u32 s50, s50, s48
    s_waitcnt vmcnt(9)
    s_barrier
    s_add_u32 m0, s57, 90112
    s_nop 0
    buffer_load_dwordx4 v56, s[36:39], s50 offen offset:0 sc1 lds
    buffer_load_dwordx4 v57, s[36:39], s50 offen offset:1024 sc1 lds
    buffer_load_dwordx4 v58, s[36:39], s50 offen offset:2048 sc1 lds
    buffer_load_dwordx4 v59, s[36:39], s50 offen offset:3072 sc1 lds
    s_add_u32 m0, s57, 94208
    s_nop 0
    buffer_load_dwordx4 v60, s[36:39], s50 offen offset:0 sc1 lds
    buffer_load_dwordx4 v61, s[36:39], s50 offen offset:1024 sc1 lds
    buffer_load_dwordx4 v62, s[36:39], s50 offen offset:2048 sc1 lds
    buffer_load_dwordx4 v63, s[36:39], s50 offen offset:3072 sc1 lds
    s_add_u32 m0, s57, 98304
    s_nop 0
    buffer_load_dwordx4 v64, s[36:39], s50 offen offset:0 sc1 lds
    s_add_u32 s50, s58, 1253376
    s_cmp_ge_u32 s50, s59
    s_cselect_b32 s48, 1327104, 0
    s_sub_u32 s50, s50, s48
    s_waitcnt vmcnt(9)
    s_barrier
    s_add_u32 m0, s57, 108544
    s_nop 0
    buffer_load_dwordx4 v56, s[36:39], s50 offen offset:0 sc1 lds
    buffer_load_dwordx4 v57, s[36:39], s50 offen offset:1024 sc1 lds
    buffer_load_dwordx4 v58, s[36:39], s50 offen offset:2048 sc1 lds
    buffer_load_dwordx4 v59, s[36:39], s50 offen offset:3072 sc1 lds
    s_add_u32 m0, s57, 112640
    s_nop 0
    buffer_load_dwordx4 v60, s[36:39], s50 offen offset:0 sc1 lds
    buffer_load_dwordx4 v61, s[36:39], s50 offen offset:1024 sc1 lds
    buffer_load_dwordx4 v62, s[36:39], s50 offen offset:2048 sc1 lds
    buffer_load_dwordx4 v63, s[36:39], s50 offen offset:3072 sc1 lds
    s_add_u32 m0, s57, 116736
    s_nop 0
    buffer_load_dwordx4 v64, s[36:39], s50 offen offset:0 sc1 lds
    s_lshl_b32 s48, s62, 10
    s_add_u32 m0, s48, 32768
    s_nop 0
    buffer_load_dwordx4 v70, s[36:39], 0 offen sc1 lds
    s_lshl_b32 s48, s62, 10
    s_add_u32 m0, s48, 34816
    s_nop 0
    buffer_load_dwordx4 v71, s[36:39], 0 offen sc1 lds
    s_lshl_b32 s48, s62, 10
    s_add_u32 m0, s48, 36864
    s_nop 0
    buffer_load_dwordx4 v72, s[36:39], 0 offen sc1 lds
    s_lshl_b32 s48, s62, 10
    s_add_u32 m0, s48, 38912
    s_nop 0
    buffer_load_dwordx4 v73, s[36:39], 0 offen sc1 lds
    s_mul_i32 s48, s62, 40960
    s_add_u32 m0, s48, 40960
    s_nop 0
    buffer_load_dwordx4 v74, s[36:39], 0 offen sc1 lds
    s_waitcnt vmcnt(14)
    s_barrier
    s_waitcnt vmcnt(5)
    s_barrier
    s_waitcnt vmcnt(0)
    s_barrier
    s_branch L_m_100
L_m_50:
    v_lshlrev_b32 v29, 1, v2
    v_xor_b32 v29, v29, v1
    v_xor_b32 v30, 8, v29
    v_mul_u32_u24 v28, 4096, v2
    v_lshl_add_u32 v29, v29, 4, v28
    v_lshl_add_u32 v30, v30, 4, v28
    v_add_u32 v58, 30720, v29
    v_add_u32 v59, 46080, v30
    v_add_u32 v57, 15360, v30
    v_mov_b32 v56, v29
    v_add_u32 v60, 65536, v56
    v_add_u32 v61, 65536, v57
    v_add_u32 v62, 65536, v58
    v_add_u32 v63, 65536, v59
    s_mul_i32 s49, s53, 4718592
    s_lshl_b32 s48, s62, 17
    s_add_u32 s49, s49, s48
    s_lshl_b32 s48, s54, 8
    s_add_u32 s49, s49, s48
    s_mul_i32 s58, s64, 262144
    s_add_u32 s58, s58, s49
    s_add_u32 s59, s49, 4718592
    s_cmp_ge_u32 s5, 27
    s_cbranch_scc1 L_m_101
    v_lshlrev_b32 v29, 1, v2
    v_xor_b32 v29, v29, v1
    v_xor_b32 v30, 8, v29
    v_mul_u32_u24 v28, 2359296, v2
    v_lshl_add_u32 v29, v29, 4, v28
    v_lshl_add_u32 v30, v30, 4, v28
    v_add_u32 v14, 16384, v29
    v_add_u32 v15, 24576, v30
    v_add_u32 v13, 8192, v30
    v_mov_b32 v12, v29
    v_add_u32 v16, 9437184, v12
    v_add_u32 v17, 9437184, v13
    v_add_u32 v18, 9437184, v14
    v_add_u32 v19, 9437184, v15
    s_mul_i32 s49, s62, 36864
    s_lshl_b32 s48, s51, 8
    s_add_u32 s49, s49, s48
    s_mul_i32 s60, s63, 73728
    s_add_u32 s60, s60, s49
    s_add_u32 s61, s49, 2359296
    s_branch L_stub_15
L_back_w1:
    s_add_u32 s50, s60, 0
    s_cmp_ge_u32 s50, s61
    s_cselect_b32 s48, 2359296, 0
    s_sub_u32 s50, s50, s48
    s_add_u32 m0, s68, 0
    s_nop 0
    buffer_load_dwordx4 v12, s[40:43], s50 offen offset:0  lds
    buffer_load_dwordx4 v13, s[40:43], s50 offen offset:1024  lds
    buffer_load_dwordx4 v14, s[40:43], s50 offen offset:2048  lds
    buffer_load_dwordx4 v15, s[40:43], s50 offen offset:3072  lds
    s_add_u32 m0, s68, 4096
    s_nop 0
    buffer_load_dwordx4 v16, s[40:43], s50 offen offset:0  lds
    s_branch L_skip_15
    s_nop 0
L_stub_15:
    s_branch L_stub_16
L_skip_15:
    buffer_load_dwordx4 v17, s[40:43], s50 offen offset:1024  lds
    buffer_load_dwordx4 v18, s[40:43], s50 offen offset:2048  lds
    buffer_load_dwordx4 v19, s[40:43], s50 offen offset:3072  lds
    s_add_u32 s50, s60, 73728
    s_cmp_ge_u32 s50, s61
    s_cselect_b32 s48, 2359296, 0
    s_sub_u32 s50, s50, s48
    s_add_u32 m0, s68, 16384
    s_nop 0
    buffer_load_dwordx4 v12, s[40:43], s50 offen offset:0  lds
    buffer_load_dwordx4 v13, s[40:43], s50 offen offset:1024  lds
    buffer_load_dwordx4 v14, s[40:43], s50 offen offset:2048  lds
    buffer_load_dwordx4 v15, s[40:43], s50 offen offset:3072  lds
    s_add_u32 m0, s68, 20480
    s_nop 0
    buffer_load_dwordx4 v16, s[40:43], s50 offen offset:0  lds
    buffer_load_dwordx4 v17, s[40:43], s50 offen offset:1024  lds
    buffer_load_dwordx4 v18, s[40:43], s50 offen offset:2048  lds
    buffer_load_dwordx4 v19, s[40:43], s50 offen offset:3072  lds
    s_barrier
    s_add_u32 s50, s60, 147456
    s_cmp_ge_u32 s50, s61
    s_cselect_b32 s48, 2359296, 0
    s_sub_u32 s50, s50, s48
    s_add_u32 m0, s68, 32768
    s_nop 0
    buffer_load_dwordx4 v12, s[40:43], s50 offen offset:0  lds
    buffer_load_dwordx4 v13, s[40:43], s50 offen offset:1024  lds
    buffer_load_dwordx4 v14, s[40:43], s50 offen offset:2048  lds
    buffer_load_dwordx4 v15, s[40:43], s50 offen offset:3072  lds
    s_add_u32 m0, s68, 36864
    s_nop 0
    buffer_load_dwordx4 v16, s[40:43], s50 offen offset:0  lds
    buffer_load_dwordx4 v17, s[40:43], s50 offen offset:1024  lds
    buffer_load_dwordx4 v18, s[40:43], s50 offen offset:2048  lds
    buffer_load_dwordx4 v19, s[40:43], s50 offen offset:3072  lds
    s_add_u32 s50, s60, 221184
    s_cmp_ge_u32 s50, s61
    s_cselect_b32 s48, 2359296, 0
    s_sub_u32 s50, s50, s48
    s_add_u32 m0, s68, 49152
    s_nop 0
    buffer_load_dwordx4 v12, s[40:43], s50 offen offset:0  lds
    buffer_load_dwordx4 v13, s[40:43], s50 offen offset:1024  lds
    buffer_load_dwordx4 v14, s[40:43], s50 offen offset:2048  lds
    buffer_load_dwordx4 v15, s[40:43], s50 offen offset:3072  lds
    s_add_u32 m0, s68, 53248
    s_nop 0
    buffer_load_dwordx4 v16, s[40:43], s50 offen offset:0  lds
    buffer_load_dwordx4 v17, s[40:43], s50 offen offset:1024  lds
    buffer_load_dwordx4 v18, s[40:43], s50 offen offset:2048  lds
    buffer_load_dwordx4 v19, s[40:43], s50 offen offset:3072  lds
    s_barrier
    s_add_u32 s50, s60, 294912
    s_cmp_ge_u32 s50, s61
    s_cselect_b32 s48, 2359296, 0
    s_sub_u32 s50, s50, s48
    s_add_u32 m0, s68, 65536
    s_nop 0
    buffer_load_dwordx4 v12, s[40:43], s50 offen offset:0  lds
    buffer_load_dwordx4 v13, s[40:43], s50 offen offset:1024  lds
    buffer_load_dwordx4 v14, s[40:43], s50 offen offset:2048  lds
    buffer_load_dwordx4 v15, s[40:43], s50 offen offset:3072  lds
    s_add_u32 m0, s68, 69632
    s_nop 0
    buffer_load_dwordx4 v16, s[40:43], s50 offen offset:0  lds
    buffer_load_dwordx4 v17, s[40:43], s50 offen offset:1024  lds
    buffer_load_dwordx4 v18, s[40:43], s50 offen offset:2048  lds
    buffer_load_dwordx4 v19, s[40:43], s50 offen offset:3072  lds
    s_add_u32 s50, s60, 368640
    s_cmp_ge_u32 s50, s61
    s_cselect_b32 s48, 2359296, 0
    s_sub_u32 s50, s50, s48
    s_add_u32 m0, s68, 81920
    s_nop 0
    buffer_load_dwordx4 v12, s[40:43], s50 offen offset:0  lds
    buffer_load_dwordx4 v13, s[40:43], s50 offen offset:1024  lds
    buffer_load_dwordx4 v14, s[40:43], s50 offen offset:2048  lds
    buffer_load_dwordx4 v15, s[40:43], s50 offen offset:3072  lds
    s_add_u32 m0, s68, 86016
    s_nop 0
    buffer_load_dwordx4 v16, s[40:43], s50 offen offset:0  lds
    buffer_load_dwordx4 v17, s[40:43], s50 offen offset:1024  lds
    buffer_load_dwordx4 v18, s[40:43], s50 offen offset:2048  lds
    buffer_load_dwordx4 v19, s[40:43], s50 offen offset:3072  lds
    s_barrier
    s_waitcnt vmcnt(0)
    s_barrier
    s_barrier
    s_add_u32 s50, s60, 442368
    s_cmp_ge_u32 s50, s61
    s_cselect_b32 s48, 2359296, 0
    s_sub_u32 s50, s50, s48
    s_add_u32 m0, s68, 0
    s_nop 0
    buffer_load_dwordx4 v12, s[40:43], s50 offen offset:0  lds
    buffer_load_dwordx4 v13, s[40:43], s50 offen offset:1024  lds
    buffer_load_dwordx4 v14, s[40:43], s50 offen offset:2048  lds
    buffer_load_dwordx4 v15, s[40:43], s50 offen offset:3072  lds
    s_add_u32 m0, s68, 4096
    s_nop 0
    buffer_load_dwordx4 v16, s[40:43], s50 offen offset:0  lds
    buffer_load_dwordx4 v17, s[40:43], s50 offen offset:1024  lds
    buffer_load_dwordx4 v18, s[40:43], s50 offen offset:2048  lds
    buffer_load_dwordx4 v19, s[40:43], s50 offen offset:3072  lds
    s_add_u32 s50, s60, 516096
    s_cmp_ge_u32 s50, s61
    s_cselect_b32 s48, 2359296, 0
    s_sub_u32 s50, s50, s48
    s_add_u32 m0, s68, 16384
    s_nop 0
    buffer_load_dwordx4 v12, s[40:43], s50 offen offset:0  lds
    buffer_load_dwordx4 v13, s[40:43], s50 offen offset:1024  lds
    buffer_load_dwordx4 v14, s[40:43], s50 offen offset:2048  lds
    buffer_load_dwordx4 v15, s[40:43], s50 offen offset:3072  lds
    s_add_u32 m0, s68, 20480
    s_nop 0
    buffer_load_dwordx4 v16, s[40:43], s50 offen offset:0  lds
    buffer_load_dwordx4 v17, s[40:43], s50 offen offset:1024  lds
    buffer_load_dwordx4 v18, s[40:43], s50 offen offset:2048  lds
    buffer_load_dwordx4 v19, s[40:43], s50 offen offset:3072  lds
    s_add_u32 s50, s60, 589824
    s_cmp_ge_u32 s50, s61
    s_cselect_b32 s48, 2359296, 0
    s_sub_u32 s50, s50, s48
    s_add_u32 m0, s68, 32768
    s_nop 0
    buffer_load_dwordx4 v12, s[40:43], s50 offen offset:0  lds
    buffer_load_dwordx4 v13, s[40:43], s50 offen offset:1024  lds
    buffer_load_dwordx4 v14, s[40:43], s50 offen offset:2048  lds
    buffer_load_dwordx4 v15, s[40:43], s50 offen offset:3072  lds
    s_add_u32 m0, s68, 36864
    s_nop 0
    buffer_load_dwordx4 v16, s[40:43], s50 offen offset:0  lds
    buffer_load_dwordx4 v17, s[40:43], s50 offen offset:1024  lds
    buffer_load_dwordx4 v18, s[40:43], s50 offen offset:2048  lds
    buffer_load_dwordx4 v19, s[40:43], s50 offen offset:3072  lds
    s_add_u32 s50, s60, 663552
    s_cmp_ge_u32 s50, s61
    s_cselect_b32 s48, 2359296, 0
    s_sub_u32 s50, s50, s48
    s_add_u32 m0, s68, 49152
    s_nop 0
    buffer_load_dwordx4 v12, s[40:43], s50 offen offset:0  lds
    buffer_load_dwordx4 v13, s[40:43], s50 offen offset:1024  lds
    buffer_load_dwordx4 v14, s[40:43], s50 offen offset:2048  lds
    buffer_load_dwordx4 v15, s[40:43], s50 offen offset:3072  lds
    s_waitcnt vmcnt(12)
    s_barrier
    s_add_u32 m0, s68, 53248
    s_nop 0
    buffer_load_dwordx4 v16, s[40:43], s50 offen offset:0  lds
    buffer_load_dwordx4 v17, s[40:43], s50 offen offset:1024  lds
    buffer_load_dwordx4 v18, s[40:43], s50 offen offset:2048  lds
    buffer_load_dwordx4 v19, s[40:43], s50 offen offset:3072  lds
    s_barrier
    s_add_u32 s50, s60, 737280
    s_cmp_ge_u32 s50, s61
    s_cselect_b32 s48, 2359296, 0
    s_sub_u32 s50, s50, s48
    s_add_u32 m0, s68, 65536
    s_nop 0
    buffer_load_dwordx4 v12, s[40:43], s50 offen offset:0  lds
    buffer_load_dwordx4 v13, s[40:43], s50 offen offset:1024  lds
    buffer_load_dwordx4 v14, s[40:43], s50 offen offset:2048  lds
    buffer_load_dwordx4 v15, s[40:43], s50 offen offset:3072  lds
    s_add_u32 m0, s68, 69632
    s_nop 0
    buffer_load_dwordx4 v16, s[40:43], s50 offen offset:0  lds
    buffer_load_dwordx4 v17, s[40:43], s50 offen offset:1024  lds
    buffer_load_dwordx4 v18, s[40:43], s50 offen offset:2048  lds
    buffer_load_dwordx4 v19, s[40:43], s50 offen offset:3072  lds
    s_add_u32 s50, s60, 811008
    s_cmp_ge_u32 s50, s61
    s_cselect_b32 s48, 2359296, 0
    s_sub_u32 s50, s50, s48
    s_add_u32 m0, s68, 81920
    s_nop 0
    buffer_load_dwordx4 v12, s[40:43], s50 offen offset:0  lds
    buffer_load_dwordx4 v13, s[40:43], s50 offen offset:1024  lds
    buffer_load_dwordx4 v14, s[40:43], s50 offen offset:2048  lds
    buffer_load_dwordx4 v15, s[40:43], s50 offen offset:3072  lds
    s_add_u32 m0, s68, 86016
    s_nop 0
    buffer_load_dwordx4 v16, s[40:43], s50 offen offset:0  lds
    buffer_load_dwordx4 v17, s[40:43], s50 offen offset:1024  lds
    buffer_load_dwordx4 v18, s[40:43], s50 offen offset:2048  lds
    buffer_load_dwordx4 v19, s[40:43], s50 offen offset:3072  lds
    s_add_u32 s50, s60, 884736
    s_cmp_ge_u32 s50, s61
    s_cselect_b32 s48, 2359296, 0
    s_sub_u32 s50, s50, s48
    s_add_u32 m0, s68, 0
    s_nop 0
    buffer_load_dwordx4 v12, s[40:43], s50 offen offset:0  lds
    buffer_load_dwordx4 v13, s[40:43], s50 offen offset:1024  lds
    buffer_load_dwordx4 v14, s[40:43], s50 offen offset:2048  lds
    buffer_load_dwordx4 v15, s[40:43], s50 offen offset:3072  lds
    s_add_u32 m0, s68, 4096
    s_nop 0
    buffer_load_dwordx4 v16, s[40:43], s50 offen offset:0  lds
    buffer_load_dwordx4 v17, s[40:43], s50 offen offset:1024  lds
    buffer_load_dwordx4 v18, s[40:43], s50 offen offset:2048  lds
    buffer_load_dwordx4 v19, s[40:43], s50 offen offset:3072  lds
    s_add_u32 s50, s60, 958464
    s_cmp_ge_u32 s50, s61
    s_cselect_b32 s48, 2359296, 0
    s_sub_u32 s50, s50, s48
    s_add_u32 m0, s68, 16384
    s_nop 0
    buffer_load_dwordx4 v12, s[40:43], s50 offen offset:0  lds
    buffer_load_dwordx4 v13, s[40:43], s50 offen offset:1024  lds
    buffer_load_dwordx4 v14, s[40:43], s50 offen offset:2048  lds
    buffer_load_dwordx4 v15, s[40:43], s50 offen offset:3072  lds
    s_add_u32 m0, s68, 20480
    s_nop 0
    buffer_load_dwordx4 v16, s[40:43], s50 offen offset:0  lds
    buffer_load_dwordx4 v17, s[40:43], s50 offen offset:1024  lds
    buffer_load_dwordx4 v18, s[40:43], s50 offen offset:2048  lds
    buffer_load_dwordx4 v19, s[40:43], s50 offen offset:3072  lds
    s_waitcnt vmcnt(40)
    s_barrier
    s_waitcnt vmcnt(32)
    s_barrier
    s_add_u32 s50, s60, 1032192
    s_cmp_ge_u32 s50, s61
    s_cselect_b32 s48, 2359296, 0
    s_sub_u32 s50, s50, s48
    s_add_u32 m0, s68, 32768
    s_nop 0
    buffer_load_dwordx4 v12, s[40:43], s50 offen offset:0  lds
    buffer_load_dwordx4 v13, s[40:43], s50 offen offset:1024  lds
    buffer_load_dwordx4 v14, s[40:43], s50 offen offset:2048  lds
    buffer_load_dwordx4 v15, s[40:43], s50 offen offset:3072  lds
    s_add_u32 m0, s68, 36864
    s_nop 0
    buffer_load_dwordx4 v16, s[40:43], s50 offen offset:0  lds
    s_waitcnt vmcnt(29)
    s_barrier
    buffer_load_dwordx4 v17, s[40:43], s50 offen offset:1024  lds
    buffer_load_dwordx4 v18, s[40:43], s50 offen offset:2048  lds
    buffer_load_dwordx4 v19, s[40:43], s50 offen offset:3072  lds
    s_add_u32 s50, s60, 1105920
    s_cmp_ge_u32 s50, s61
    s_cselect_b32 s48, 2359296, 0
    s_sub_u32 s50, s50, s48
    s_add_u32 m0, s68, 49152
    s_nop 0
    buffer_load_dwordx4 v12, s[40:43], s50 offen offset:0  lds
    buffer_load_dwordx4 v13, s[40:43], s50 offen offset:1024  lds
    s_waitcnt vmcnt(26)
    s_barrier
    buffer_load_dwordx4 v14, s[40:43], s50 offen offset:2048  lds
    buffer_load_dwordx4 v15, s[40:43], s50 offen offset:3072  lds
    s_add_u32 m0, s68, 53248
    s_nop 0
    buffer_load_dwordx4 v16, s[40:43], s50 offen offset:0  lds
    buffer_load_dwordx4 v17, s[40:43], s50 offen offset:1024  lds
    buffer_load_dwordx4 v18, s[40:43], s50 offen offset:2048  lds
    s_waitcnt vmcnt(23)
    s_barrier
    buffer_load_dwordx4 v19, s[40:43], s50 offen offset:3072  lds
    s_add_u32 s50, s60, 1179648
    s_cmp_ge_u32 s50, s61
    s_cselect_b32 s48, 2359296, 0
    s_sub_u32 s50, s50, s48
    s_add_u32 m0, s68, 65536
    s_nop 0
    buffer_load_dwordx4 v12, s[40:43], s50 offen offset:0  lds
    buffer_load_dwordx4 v13, s[40:43], s50 offen offset:1024  lds
    buffer_load_dwordx4 v14, s[40:43], s50 offen offset:2048  lds
    buffer_load_dwordx4 v15, s[40:43], s50 offen offset:3072  lds
    s_add_u32 m0, s68, 69632
    s_nop 0
    buffer_load_dwordx4 v16, s[40:43], s50 offen offset:0  lds
    s_waitcnt vmcnt(21)
    s_barrier
    buffer_load_dwordx4 v17, s[40:43], s50 offen offset:1024  lds
    buffer_load_dwordx4 v18, s[40:43], s50 offen offset:2048  lds
    buffer_load_dwordx4 v19, s[40:43], s50 offen offset:3072  lds
    s_add_u32 s50, s60, 1253376
    s_cmp_ge_u32 s50, s61
    s_cselect_b32 s48, 2359296, 0
    s_sub_u32 s50, s50, s48
    s_add_u32 m0, s68, 81920
    s_nop 0
    buffer_load_dwordx4 v12, s[40:43], s50 offen offset:0  lds
    buffer_load_dwordx4 v13, s[40:43], s50 offen offset:1024  lds
    s_barrier
    buffer_load_dwordx4 v14, s[40:43], s50 offen offset:2048  lds
    buffer_load_dwordx4 v15, s[40:43], s50 offen offset:3072  lds
    s_add_u32 m0, s68, 86016
    s_nop 0
    buffer_load_dwordx4 v16, s[40:43], s50 offen offset:0  lds
    buffer_load_dwordx4 v17, s[40:43], s50 offen offset:1024  lds
    buffer_load_dwordx4 v18, s[40:43], s50 offen offset:2048  lds
    s_waitcnt vmcnt(23)
    s_barrier
    buffer_load_dwordx4 v19, s[40:43], s50 offen offset:3072  lds
    s_add_u32 s50, s60, 1327104
    s_cmp_ge_u32 s50, s61
    s_cselect_b32 s48, 2359296, 0
    s_sub_u32 s50, s50, s48
    s_add_u32 m0, s68, 0
    s_nop 0
    buffer_load_dwordx4 v12, s[40:43], s50 offen offset:0  lds
    buffer_load_dwordx4 v13, s[40:43], s50 offen offset:1024  lds
    buffer_load_dwordx4 v14, s[40:43], s50 offen offset:2048  lds
    buffer_load_dwordx4 v15, s[40:43], s50 offen offset:3072  lds
    s_waitcnt vmcnt(20)
    s_barrier
    s_add_u32 m0, s68, 4096
    s_nop 0
    buffer_load_dwordx4 v16, s[40:43], s50 offen offset:0  lds
    buffer_load_dwordx4 v17, s[40:43], s50 offen offset:1024  lds
    buffer_load_dwordx4 v18, s[40:43], s50 offen offset:2048  lds
    buffer_load_dwordx4 v19, s[40:43], s50 offen offset:3072  lds
    s_add_u32 s50, s60, 1400832
    s_cmp_ge_u32 s50, s61
    s_cselect_b32 s48, 2359296, 0
    s_sub_u32 s50, s50, s48
    s_add_u32 m0, s68, 16384
    s_nop 0
    buffer_load_dwordx4 v12, s[40:43], s50 offen offset:0  lds
    s_barrier
    buffer_load_dwordx4 v13, s[40:43], s50 offen offset:1024  lds
    buffer_load_dwordx4 v14, s[40:43], s50 offen offset:2048  lds
    buffer_load_dwordx4 v15, s[40:43], s50 offen offset:3072  lds
    s_add_u32 m0, s68, 20480
    s_nop 0
    buffer_load_dwordx4 v16, s[40:43], s50 offen offset:0  lds
    buffer_load_dwordx4 v17, s[40:43], s50 offen offset:1024  lds
    s_waitcnt vmcnt(22)
    s_barrier
    buffer_load_dwordx4 v18, s[40:43], s50 offen offset:2048  lds
    buffer_load_dwordx4 v19, s[40:43], s50 offen offset:3072  lds
    s_add_u32 s50, s60, 1474560
    s_cmp_ge_u32 s50, s61
    s_cselect_b32 s48, 2359296, 0
    s_sub_u32 s50, s50, s48
    s_add_u32 m0, s68, 32768
    s_nop 0
    buffer_load_dwordx4 v12, s[40:43], s50 offen offset:0  lds
    buffer_load_dwordx4 v13, s[40:43], s50 offen offset:1024  lds
    buffer_load_dwordx4 v14, s[40:43], s50 offen offset:2048  lds
    s_waitcnt vmcnt(19)
    s_barrier
    buffer_load_dwordx4 v15, s[40:43], s50 offen offset:3072  lds
    s_add_u32 m0, s68, 36864
    s_nop 0
    buffer_load_dwordx4 v16, s[40:43], s50 offen offset:0  lds
    buffer_load_dwordx4 v17, s[40:43], s50 offen offset:1024  lds
    buffer_load_dwordx4 v18, s[40:43], s50 offen offset:2048  lds
    buffer_load_dwordx4 v19, s[40:43], s50 offen offset:3072  lds
    s_add_u32 s50, s60, 1548288
    s_cmp_ge_u32 s50, s61
    s_cselect_b32 s48, 2359296, 0
    s_sub_u32 s50, s50, s48
    s_add_u32 m0, s68, 49152
    s_nop 0
    buffer_load_dwordx4 v12, s[40:43], s50 offen offset:0  lds
    s_barrier
    buffer_load_dwordx4 v13, s[40:43], s50 offen offset:1024  lds
    buffer_load_dwordx4 v14, s[40:43], s50 offen offset:2048  lds
    buffer_load_dwordx4 v15, s[40:43], s50 offen offset:3072  lds
    s_add_u32 m0, s68, 53248
    s_nop 0
    buffer_load_dwordx4 v16, s[40:43], s50 offen offset:0  lds
    buffer_load_dwordx4 v17, s[40:43], s50 offen offset:1024  lds
    s_waitcnt vmcnt(22)
    s_barrier
    buffer_load_dwordx4 v18, s[40:43], s50 offen offset:2048  lds
    buffer_load_dwordx4 v19, s[40:43], s50 offen offset:3072  lds
    s_add_u32 s50, s60, 1622016
    s_cmp_ge_u32 s50, s61
    s_cselect_b32 s48, 2359296, 0
    s_sub_u32 s50, s50, s48
    s_add_u32 m0, s68, 65536
    s_nop 0
    buffer_load_dwordx4 v12, s[40:43], s50 offen offset:0  lds
    buffer_load_dwordx4 v13, s[40:43], s50 offen offset:1024  lds
    buffer_load_dwordx4 v14, s[40:43], s50 offen offset:2048  lds
    s_waitcnt vmcnt(19)
    s_barrier
    buffer_load_dwordx4 v15, s[40:43], s50 offen offset:3072  lds
    s_add_u32 m0, s68, 69632
    s_nop 0
    buffer_load_dwordx4 v16, s[40:43], s50 offen offset:0  lds
    buffer_load_dwordx4 v17, s[40:43], s50 offen offset:1024  lds
    buffer_load_dwordx4 v18, s[40:43], s50 offen offset:2048  lds
    buffer_load_dwordx4 v19, s[40:43], s50 offen offset:3072  lds
    s_barrier
    s_add_u32 s50, s60, 1695744
    s_cmp_ge_u32 s50, s61
    s_cselect_b32 s48, 2359296, 0
    s_sub_u32 s50, s50, s48
    s_add_u32 m0, s68, 81920
    s_nop 0
    buffer_load_dwordx4 v12, s[40:43], s50 offen offset:0  lds
    buffer_load_dwordx4 v13, s[40:43], s50 offen offset:1024  lds
    buffer_load_dwordx4 v14, s[40:43], s50 offen offset:2048  lds
    buffer_load_dwordx4 v15, s[40:43], s50 offen offset:3072  lds
    s_add_u32 m0, s68, 86016
    s_nop 0
    buffer_load_dwordx4 v16, s[40:43], s50 offen offset:0  lds
    s_waitcnt vmcnt(21)
    s_barrier
    buffer_load_dwordx4 v17, s[40:43], s50 offen offset:1024  lds
    buffer_load_dwordx4 v18, s[40:43], s50 offen offset:2048  lds
    buffer_load_dwordx4 v19, s[40:43], s50 offen offset:3072  lds
    s_add_u32 s50, s60, 1769472
    s_cmp_ge_u32 s50, s61
    s_cselect_b32 s48, 2359296, 0
    s_sub_u32 s50, s50, s48
    s_add_u32 m0, s68, 0
    s_nop 0
    buffer_load_dwordx4 v12, s[40:43], s50 offen offset:0  lds
    buffer_load_dwordx4 v13, s[40:43], s50 offen offset:1024  lds
    s_waitcnt vmcnt(18)
    s_barrier
    buffer_load_dwordx4 v14, s[40:43], s50 offen offset:2048  lds
    buffer_load_dwordx4 v15, s[40:43], s50 offen offset:3072  lds
    s_add_u32 m0, s68, 4096
    s_nop 0
    buffer_load_dwordx4 v16, s[40:43], s50 offen offset:0  lds
    buffer_load_dwordx4 v17, s[40:43], s50 offen offset:1024  lds
    buffer_load_dwordx4 v18, s[40:43], s50 offen offset:2048  lds
    s_barrier
    buffer_load_dwordx4 v19, s[40:43], s50 offen offset:3072  lds
    s_add_u32 s50, s60, 1843200
    s_cmp_ge_u32 s50, s61
    s_cselect_b32 s48, 2359296, 0
    s_sub_u32 s50, s50, s48
    s_add_u32 m0, s68, 16384
    s_nop 0
    buffer_load_dwordx4 v12, s[40:43], s50 offen offset:0  lds
    buffer_load_dwordx4 v13, s[40:43], s50 offen offset:1024  lds
    buffer_load_dwordx4 v14, s[40:43], s50 offen offset:2048  lds
    buffer_load_dwordx4 v15, s[40:43], s50 offen offset:3072  lds
    s_add_u32 m0, s68, 20480
    s_nop 0
    buffer_load_dwordx4 v16, s[40:43], s50 offen offset:0  lds
    s_waitcnt vmcnt(21)
    s_barrier
    buffer_load_dwordx4 v17, s[40:43], s50 offen offset:1024  lds
    buffer_load_dwordx4 v18, s[40:43], s50 offen offset:2048  lds
    buffer_load_dwordx4 v19, s[40:43], s50 offen offset:3072  lds
    s_add_u32 s50, s60, 1916928
    s_cmp_ge_u32 s50, s61
    s_cselect_b32 s48, 2359296, 0
    s_sub_u32 s50, s50, s48
    s_add_u32 m0, s68, 32768
    s_nop 0
    buffer_load_dwordx4 v12, s[40:43], s50 offen offset:0  lds
    buffer_load_dwordx4 v13, s[40:43], s50 offen offset:1024  lds
    s_waitcnt vmcnt(18)
    s_barrier
    buffer_load_dwordx4 v14, s[40:43], s50 offen offset:2048  lds
    buffer_load_dwordx4 v15, s[40:43], s50 offen offset:3072  lds
    s_add_u32 m0, s68, 36864
    s_nop 0
    buffer_load_dwordx4 v16, s[40:43], s50 offen offset:0  lds
    buffer_load_dwordx4 v17, s[40:43], s50 offen offset:1024  lds
    buffer_load_dwordx4 v18, s[40:43], s50 offen offset:2048  lds
    s_barrier
    buffer_load_dwordx4 v19, s[40:43], s50 offen offset:3072  lds
    s_add_u32 s50, s60, 1990656
    s_cmp_ge_u32 s50, s61
    s_cselect_b32 s48, 2359296, 0
    s_sub_u32 s50, s50, s48
    s_add_u32 m0, s68, 49152
    s_nop 0
    buffer_load_dwordx4 v12, s[40:43], s50 offen offset:0  lds
    buffer_load_dwordx4 v13, s[40:43], s50 offen offset:1024  lds
    buffer_load_dwordx4 v14, s[40:43], s50 offen offset:2048  lds
    buffer_load_dwordx4 v15, s[40:43], s50 offen offset:3072  lds
    s_waitcnt vmcnt(20)
    s_barrier
    s_add_u32 m0, s68, 53248
    s_nop 0
    buffer_load_dwordx4 v16, s[40:43], s50 offen offset:0  lds
    buffer_load_dwordx4 v17, s[40:43], s50 offen offset:1024  lds
    buffer_load_dwordx4 v18, s[40:43], s50 offen offset:2048  lds
    buffer_load_dwordx4 v19, s[40:43], s50 offen offset:3072  lds
    s_add_u32 s50, s60, 2064384
    s_cmp_ge_u32 s50, s61
    s_cselect_b32 s48, 2359296, 0
    s_sub_u32 s50, s50, s48
    s_add_u32 m0, s68, 65536
    s_nop 0
    buffer_load_dwordx4 v12, s[40:43], s50 offen offset:0  lds
    s_waitcnt vmcnt(17)
    s_barrier
    buffer_load_dwordx4 v13, s[40:43], s50 offen offset:1024  lds
    buffer_load_dwordx4 v14, s[40:43], s50 offen offset:2048  lds
    buffer_load_dwordx4 v15, s[40:43], s50 offen offset:3072  lds
    s_add_u32 m0, s68, 69632
    s_nop 0
    buffer_load_dwordx4 v16, s[40:43], s50 offen offset:0  lds
    buffer_load_dwordx4 v17, s[40:43], s50 offen offset:1024  lds
    s_barrier
    buffer_load_dwordx4 v18, s[40:43], s50 offen offset:2048  lds
    buffer_load_dwordx4 v19, s[40:43], s50 offen offset:3072  lds
    s_add_u32 s50, s60, 2138112
    s_cmp_ge_u32 s50, s61
    s_cselect_b32 s48, 2359296, 0
    s_sub_u32 s50, s50, s48
    s_add_u32 m0, s68, 81920
    s_nop 0
    buffer_load_dwordx4 v12, s[40:43], s50 offen offset:0  lds
    buffer_load_dwordx4 v13, s[40:43], s50 offen offset:1024  lds
    buffer_load_dwordx4 v14, s[40:43], s50 offen offset:2048  lds
    s_waitcnt vmcnt(19)
    s_barrier
    buffer_load_dwordx4 v15, s[40:43], s50 offen offset:3072  lds
    s_add_u32 m0, s68, 86016
    s_nop 0
    buffer_load_dwordx4 v16, s[40:43], s50 offen offset:0  lds
    buffer_load_dwordx4 v17, s[40:43], s50 offen offset:1024  lds
    buffer_load_dwordx4 v18, s[40:43], s50 offen offset:2048  lds
    buffer_load_dwordx4 v19, s[40:43], s50 offen offset:3072  lds
    s_add_u32 s50, s60, 2211840
    s_cmp_ge_u32 s50, s61
    s_cselect_b32 s48, 2359296, 0
    s_sub_u32 s50, s50, s48
    s_add_u32 m0, s68, 0
    s_nop 0
    buffer_load_dwordx4 v12, s[40:43], s50 offen offset:0  lds
    s_waitcnt vmcnt(17)
    s_barrier
    buffer_load_dwordx4 v13, s[40:43], s50 offen offset:1024  lds
    buffer_load_dwordx4 v14, s[40:43], s50 offen offset:2048  lds
    buffer_load_dwordx4 v15, s[40:43], s50 offen offset:3072  lds
    s_add_u32 m0, s68, 4096
    s_nop 0
    buffer_load_dwordx4 v16, s[40:43], s50 offen offset:0  lds
    buffer_load_dwordx4 v17, s[40:43], s50 offen offset:1024  lds
    s_barrier
    buffer_load_dwordx4 v18, s[40:43], s50 offen offset:2048  lds
    buffer_load_dwordx4 v19, s[40:43], s50 offen offset:3072  lds
    s_add_u32 s50, s60, 2285568
    s_cmp_ge_u32 s50, s61
    s_cselect_b32 s48, 2359296, 0
    s_sub_u32 s50, s50, s48
    s_add_u32 m0, s68, 16384
    s_nop 0
    buffer_load_dwordx4 v12, s[40:43], s50 offen offset:0  lds
    buffer_load_dwordx4 v13, s[40:43], s50 offen offset:1024  lds
    buffer_load_dwordx4 v14, s[40:43], s50 offen offset:2048  lds
    s_waitcnt vmcnt(19)
    s_barrier
    buffer_load_dwordx4 v15, s[40:43], s50 offen offset:3072  lds
    s_add_u32 m0, s68, 20480
    s_nop 0
    buffer_load_dwordx4 v16, s[40:43], s50 offen offset:0  lds
    buffer_load_dwordx4 v17, s[40:43], s50 offen offset:1024  lds
    buffer_load_dwordx4 v18, s[40:43], s50 offen offset:2048  lds
    buffer_load_dwordx4 v19, s[40:43], s50 offen offset:3072  lds
    s_waitcnt vmcnt(16)
    s_barrier
    s_add_u32 s50, s58, 0
    s_cmp_ge_u32 s50, s59
    s_cselect_b32 s48, 4718592, 0
    s_sub_u32 s50, s50, s48
    s_add_u32 m0, s68, 32768
    s_nop 0
    buffer_load_dwordx4 v56, s[44:47], s50 offen offset:0  lds
    buffer_load_dwordx4 v57, s[44:47], s50 offen offset:1024  lds
    buffer_load_dwordx4 v58, s[44:47], s50 offen offset:2048  lds
    buffer_load_dwordx4 v59, s[44:47], s50 offen offset:3072  lds
    s_add_u32 m0, s68, 36864
    s_nop 0
    buffer_load_dwordx4 v60, s[44:47], s50 offen offset:0  lds
    buffer_load_dwordx4 v61, s[44:47], s50 offen offset:1024  lds
    buffer_load_dwordx4 v62, s[44:47], s50 offen offset:2048  lds
    buffer_load_dwordx4 v63, s[44:47], s50 offen offset:3072  lds
    s_add_u32 s50, s58, 262144
    s_cmp_ge_u32 s50, s59
    s_cselect_b32 s48, 4718592, 0
    s_sub_u32 s50, s50, s48
    s_add_u32 m0, s68, 49152
    s_nop 0
    buffer_load_dwordx4 v56, s[44:47], s50 offen offset:0  lds
    buffer_load_dwordx4 v57, s[44:47], s50 offen offset:1024  lds
    s_waitcnt vmcnt(18)
    s_barrier
    buffer_load_dwordx4 v58, s[44:47], s50 offen offset:2048  lds
    buffer_load_dwordx4 v59, s[44:47], s50 offen offset:3072  lds
    s_add_u32 m0, s68, 53248
    s_nop 0
    buffer_load_dwordx4 v60, s[44:47], s50 offen offset:0  lds
    buffer_load_dwordx4 v61, s[44:47], s50 offen offset:1024  lds
    buffer_load_dwordx4 v62, s[44:47], s50 offen offset:2048  lds
    buffer_load_dwordx4 v63, s[44:47], s50 offen offset:3072  lds
    s_add_u32 s50, s58, 524288
    s_cmp_ge_u32 s50, s59
    s_cselect_b32 s48, 4718592, 0
    s_sub_u32 s50, s50, s48
    s_add_u32 m0, s68, 65536
    s_nop 0
    buffer_load_dwordx4 v56, s[44:47], s50 offen offset:0  lds
    buffer_load_dwordx4 v57, s[44:47], s50 offen offset:1024  lds
    buffer_load_dwordx4 v58, s[44:47], s50 offen offset:2048  lds
    buffer_load_dwordx4 v59, s[44:47], s50 offen offset:3072  lds
    s_add_u32 m0, s68, 69632
    s_nop 0
    buffer_load_dwordx4 v60, s[44:47], s50 offen offset:0  lds
    buffer_load_dwordx4 v61, s[44:47], s50 offen offset:1024  lds
    s_waitcnt vmcnt(22)
    s_barrier
    buffer_load_dwordx4 v62, s[44:47], s50 offen offset:2048  lds
    buffer_load_dwordx4 v63, s[44:47], s50 offen offset:3072  lds
    s_add_u32 s50, s58, 786432
    s_cmp_ge_u32 s50, s59
    s_cselect_b32 s48, 4718592, 0
    s_branch L_skip_16
L_stub_16:
    s_branch L_back_w1
L_skip_16:
    s_sub_u32 s50, s50, s48
    s_add_u32 m0, s68, 81920
    s_nop 0
    buffer_load_dwordx4 v56, s[44:47], s50 offen offset:0  lds
    buffer_load_dwordx4 v57, s[44:47], s50 offen offset:1024  lds
    buffer_load_dwordx4 v58, s[44:47], s50 offen offset:2048  lds
    buffer_load_dwordx4 v59, s[44:47], s50 offen offset:3072  lds
    s_add_u32 m0, s68, 86016
    s_nop 0
    buffer_load_dwordx4 v60, s[44:47], s50 offen offset:0  lds
    buffer_load_dwordx4 v61, s[44:47], s50 offen offset:1024  lds
    buffer_load_dwordx4 v62, s[44:47], s50 offen offset:2048  lds
    buffer_load_dwordx4 v63, s[44:47], s50 offen offset:3072  lds
    s_barrier
    s_branch L_m_102
L_m_101:
    s_sub_u32 s56, s5, 27
    s_lshl_b32 s56, s56, 1
    s_add_u32 s56, s56, s62
    s_add_u32 s56, s56, 96
    s_barrier
L_m_103:
    s_cmp_ge_u32 s56, 116
    s_cbranch_scc1 L_m_104
    s_mul_i32 s48, s56, 820
    s_lshr_b32 s48, s48, 13
    s_mul_i32 s49, s48, 10
    s_sub_u32 s49, s56, s49
    s_lshl_b32 s49, s49, 6
    v_add_u32 v22, s49, v0
    s_and_b32 s49, s4, 7
    s_mul_i32 s49, s49, 4
    s_add_u32 s48, s48, s49
    s_add_u32 s48, s48, 26
    s_and_b32 s48, s48, 31
    s_mul_i32 s48, s48, 73728
    s_mul_i32 s49, s4, 1152
    s_and_b32 s49, s49, -256
    s_add_u32 s48, s48, s49
    v_mul_u32_u24 v23, 820, v22
    v_lshrrev_b32 v23, 13, v23
    v_mul_u32_u24 v24, 10, v23
    v_sub_u32 v24, v22, v24
    v_and_b32 v22, 7, v23
    v_lshrrev_b32 v23, 3, v23
    v_lshl_add_u32 v22, v22, 8, v23
    v_mul_u32_u24 v22, 9216, v22
    v_lshl_add_u32 v22, v24, 7, v22
    buffer_load_dword v25, v22, s[40:43], s48 offen
    s_add_u32 s56, s56, 10
    s_branch L_m_103
L_m_104:
    s_barrier
    s_barrier
    s_barrier
    s_barrier
    s_barrier
    s_add_u32 s50, s58, 0
    s_cmp_ge_u32 s50, s59
    s_cselect_b32 s48, 4718592, 0
    s_sub_u32 s50, s50, s48
    s_add_u32 m0, s68, 32768
    s_nop 0
    buffer_load_dwordx4 v56, s[44:47], s50 offen offset:0  lds
    buffer_load_dwordx4 v57, s[44:47], s50 offen offset:1024  lds
    buffer_load_dwordx4 v58, s[44:47], s50 offen offset:2048  lds
    buffer_load_dwordx4 v59, s[44:47], s50 offen offset:3072  lds
    s_add_u32 m0, s68, 36864
    s_nop 0
    buffer_load_dwordx4 v60, s[44:47], s50 offen offset:0  lds
    buffer_load_dwordx4 v61, s[44:47], s50 offen offset:1024  lds
    buffer_load_dwordx4 v62, s[44:47], s50 offen offset:2048  lds
    buffer_load_dwordx4 v63, s[44:47], s50 offen offset:3072  lds
    s_add_u32 s50, s58, 262144
    s_cmp_ge_u32 s50, s59
    s_cselect_b32 s48, 4718592, 0
    s_sub_u32 s50, s50, s48
    s_add_u32 m0, s68, 49152
    s_nop 0
    buffer_load_dwordx4 v56, s[44:47], s50 offen offset:0  lds
    buffer_load_dwordx4 v57, s[44:47], s50 offen offset:1024  lds
    buffer_load_dwordx4 v58, s[44:47], s50 offen offset:2048  lds
    buffer_load_dwordx4 v59, s[44:47], s50 offen offset:3072  lds
    s_add_u32 m0, s68, 53248
    s_nop 0
    buffer_load_dwordx4 v60, s[44:47], s50 offen offset:0  lds
    buffer_load_dwordx4 v61, s[44:47], s50 offen offset:1024  lds
    buffer_load_dwordx4 v62, s[44:47], s50 offen offset:2048  lds
    buffer_load_dwordx4 v63, s[44:47], s50 offen offset:3072  lds
    s_add_u32 s50, s58, 524288
    s_cmp_ge_u32 s50, s59
    s_cselect_b32 s48, 4718592, 0
    s_sub_u32 s50, s50, s48
    s_add_u32 m0, s68, 65536
    s_nop 0
    buffer_load_dwordx4 v56, s[44:47], s50 offen offset:0  lds
    buffer_load_dwordx4 v57, s[44:47], s50 offen offset:1024  lds
    buffer_load_dwordx4 v58, s[44:47], s50 offen offset:2048  lds
    buffer_load_dwordx4 v59, s[44:47], s50 offen offset:3072  lds
    s_add_u32 m0, s68, 69632
    s_nop 0
    buffer_load_dwordx4 v60, s[44:47], s50 offen offset:0  lds
    buffer_load_dwordx4 v61, s[44:47], s50 offen offset:1024  lds
    buffer_load_dwordx4 v62, s[44:47], s50 offen offset:2048  lds
    buffer_load_dwordx4 v63, s[44:47], s50 offen offset:3072  lds
    s_add_u32 s50, s58, 786432
    s_cmp_ge_u32 s50, s59
    s_cselect_b32 s48, 4718592, 0
    s_sub_u32 s50, s50, s48
    s_add_u32 m0, s68, 81920
    s_nop 0
    buffer_load_dwordx4 v56, s[44:47], s50 offen offset:0  lds
    buffer_load_dwordx4 v57, s[44:47], s50 offen offset:1024  lds
    buffer_load_dwordx4 v58, s[44:47], s50 offen offset:2048  lds
    buffer_load_dwordx4 v59, s[44:47], s50 offen offset:3072  lds
    s_add_u32 m0, s68, 86016
    s_nop 0
    buffer_load_dwordx4 v60, s[44:47], s50 offen offset:0  lds
    buffer_load_dwordx4 v61, s[44:47], s50 offen offset:1024  lds
    buffer_load_dwordx4 v62, s[44:47], s50 offen offset:2048  lds
    buffer_load_dwordx4 v63, s[44:47], s50 offen offset:3072  lds
L_m_102:
    s_add_u32 s50, s58, 1048576
    s_cmp_ge_u32 s50, s59
    s_cselect_b32 s48, 4718592, 0
    s_sub_u32 s50, s50, s48
    s_add_u32 m0, s68, 0
    s_nop 0
    buffer_load_dwordx4 v56, s[44:47], s50 offen offset:0  lds
    buffer_load_dwordx4 v57, s[44:47], s50 offen offset:1024  lds
    buffer_load_dwordx4 v58, s[44:47], s50 offen offset:2048  lds
    buffer_load_dwordx4 v59, s[44:47], s50 offen offset:3072  lds
    s_add_u32 m0, s68, 4096
    s_nop 0
    buffer_load_dwordx4 v60, s[44:47], s50 offen offset:0  lds
    buffer_load_dwordx4 v61, s[44:47], s50 offen offset:1024  lds
    buffer_load_dwordx4 v62, s[44:47], s50 offen offset:2048  lds
    buffer_load_dwordx4 v63, s[44:47], s50 offen offset:3072  lds
    s_add_u32 s50, s58, 1310720
    s_cmp_ge_u32 s50, s59
    s_cselect_b32 s48, 4718592, 0
    s_sub_u32 s50, s50, s48
    s_add_u32 m0, s68, 16384
    s_nop 0
    buffer_load_dwordx4 v56, s[44:47], s50 offen offset:0  lds
    buffer_load_dwordx4 v57, s[44:47], s50 offen offset:1024  lds
    buffer_load_dwordx4 v58, s[44:47], s50 offen offset:2048  lds
    buffer_load_dwordx4 v59, s[44:47], s50 offen offset:3072  lds
    s_add_u32 m0, s68, 20480
    s_nop 0
    buffer_load_dwordx4 v60, s[44:47], s50 offen offset:0  lds
    buffer_load_dwordx4 v61, s[44:47], s50 offen offset:1024  lds
    buffer_load_dwordx4 v62, s[44:47], s50 offen offset:2048  lds
    buffer_load_dwordx4 v63, s[44:47], s50 offen offset:3072  lds
    s_nop 0
L_back_w2:
    s_waitcnt vmcnt(0)
    s_barrier
    s_barrier
    s_add_u32 s50, s58, 1572864
    s_cmp_ge_u32 s50, s59
    s_cselect_b32 s48, 4718592, 0
    s_sub_u32 s50, s50, s48
    s_add_u32 m0, s68, 0
    s_nop 0
    buffer_load_dwordx4 v56, s[44:47], s50 offen offset:0  lds
    buffer_load_dwordx4 v57, s[44:47], s50 offen offset:1024  lds
    buffer_load_dwordx4 v58, s[44:47], s50 offen offset:2048  lds
    buffer_load_dwordx4 v59, s[44:47], s50 offen offset:3072  lds
    s_add_u32 m0, s68, 4096
    s_nop 0
    buffer_load_dwordx4 v60, s[44:47], s50 offen offset:0  lds
    buffer_load_dwordx4 v61, s[44:47], s50 offen offset:1024  lds
    buffer_load_dwordx4 v62, s[44:47], s50 offen offset:2048  lds
    buffer_load_dwordx4 v63, s[44:47], s50 offen offset:3072  lds
    s_barrier
    s_add_u32 s50, s58, 1835008
    s_cmp_ge_u32 s50, s59
    s_cselect_b32 s48, 4718592, 0
    s_sub_u32 s50, s50, s48
    s_add_u32 m0, s68, 16384
    s_nop 0
    buffer_load_dwordx4 v56, s[44:47], s50 offen offset:0  lds
    buffer_load_dwordx4 v57, s[44:47], s50 offen offset:1024  lds
    buffer_load_dwordx4 v58, s[44:47], s50 offen offset:2048  lds
    buffer_load_dwordx4 v59, s[44:47], s50 offen offset:3072  lds
    s_add_u32 m0, s68, 20480
    s_nop 0
    buffer_load_dwordx4 v60, s[44:47], s50 offen offset:0  lds
    buffer_load_dwordx4 v61, s[44:47], s50 offen offset:1024  lds
    buffer_load_dwordx4 v62, s[44:47], s50 offen offset:2048  lds
    buffer_load_dwordx4 v63, s[44:47], s50 offen offset:3072  lds
    s_add_u32 s50, s58, 2097152
    s_cmp_ge_u32 s50, s59
    s_cselect_b32 s48, 4718592, 0
    s_sub_u32 s50, s50, s48
    s_add_u32 m0, s68, 32768
    s_nop 0
    buffer_load_dwordx4 v56, s[44:47], s50 offen offset:0  lds
    buffer_load_dwordx4 v57, s[44:47], s50 offen offset:1024  lds
    buffer_load_dwordx4 v58, s[44:47], s50 offen offset:2048  lds
    buffer_load_dwordx4 v59, s[44:47], s50 offen offset:3072  lds
    s_add_u32 m0, s68, 36864
    s_nop 0
    buffer_load_dwordx4 v60, s[44:47], s50 offen offset:0  lds
    buffer_load_dwordx4 v61, s[44:47], s50 offen offset:1024  lds
    buffer_load_dwordx4 v62, s[44:47], s50 offen offset:2048  lds
    buffer_load_dwordx4 v63, s[44:47], s50 offen offset:3072  lds
    s_add_u32 s50, s58, 2359296
    s_cmp_ge_u32 s50, s59
    s_cselect_b32 s48, 4718592, 0
    s_sub_u32 s50, s50, s48
    s_add_u32 m0, s68, 49152
    s_nop 0
    buffer_load_dwordx4 v56, s[44:47], s50 offen offset:0  lds
    buffer_load_dwordx4 v57, s[44:47], s50 offen offset:1024  lds
    buffer_load_dwordx4 v58, s[44:47], s50 offen offset:2048  lds
    buffer_load_dwordx4 v59, s[44:47], s50 offen offset:3072  lds
    s_add_u32 m0, s68, 53248
    s_nop 0
    buffer_load_dwordx4 v60, s[44:47], s50 offen offset:0  lds
    buffer_load_dwordx4 v61, s[44:47], s50 offen offset:1024  lds
    buffer_load_dwordx4 v62, s[44:47], s50 offen offset:2048  lds
    buffer_load_dwordx4 v63, s[44:47], s50 offen offset:3072  lds
    v_mov_b64 v[100:101], -1
    v_mov_b64 v[102:103], -1
    v_mov_b32 v104, v3
    v_mov_b32 v105, v3
    v_mov_b32 v106, v3
    v_mov_b32 v107, v3
    v_lshlrev_b32 v110, 4, v0
    s_lshl_b32 s48, s2, 7
    s_add_u32 s48, s48, 38797312
    v_add_u32 v108, s48, v110
    s_cmp_eq_u32 s62, 0
    s_cselect_b32 s48, 8, 0
    v_cmp_gt_u32 vcc, s48, v0
    v_mov_b32 v109, 2146435072
    s_nop 0
    v_cndmask_b32 v108, v109, v108, vcc
    v_min_u32 v109, 2, v0
    v_add_u32 v109, 1, v109
    v_lshlrev_b32 v109, 1, v109
    v_xor_b32 v109, s2, v109
    v_lshlrev_b32 v109, 7, v109
    v_add_u32 v109, 38797312, v109
    v_lshlrev_b32 v111, 4, v0
    s_mul_i32 s56, s2, 27648
    s_lshl_b32 s48, s62, 10
    s_add_u32 s56, s56, s48
    s_add_u32 s56, s56, 27262976
    s_waitcnt vmcnt(24)
    s_barrier
    s_add_u32 s50, s58, 2621440
    s_cmp_ge_u32 s50, s59
    s_cselect_b32 s48, 4718592, 0
    s_sub_u32 s50, s50, s48
    s_add_u32 m0, s68, 65536
    s_nop 0
    buffer_load_dwordx4 v56, s[44:47], s50 offen offset:0  lds
    buffer_load_dwordx4 v57, s[44:47], s50 offen offset:1024  lds
    buffer_load_dwordx4 v58, s[44:47], s50 offen offset:2048  lds
    buffer_load_dwordx4 v59, s[44:47], s50 offen offset:3072  lds
    s_waitcnt vmcnt(20)
    s_barrier
    s_add_u32 m0, s68, 69632
    s_nop 0
    buffer_load_dwordx4 v60, s[44:47], s50 offen offset:0  lds
    buffer_load_dwordx4 v61, s[44:47], s50 offen offset:1024  lds
    buffer_load_dwordx4 v62, s[44:47], s50 offen offset:2048  lds
    buffer_load_dwordx4 v63, s[44:47], s50 offen offset:3072  lds
    s_waitcnt vmcnt(16)
    s_barrier
    s_add_u32 s57, s56, 0
    buffer_store_dwordx4 v[100:103], v111, s[36:39], s57 offen sc1
    s_add_u32 s50, s58, 2883584
    s_cmp_ge_u32 s50, s59
    s_cselect_b32 s48, 4718592, 0
    s_sub_u32 s50, s50, s48
    s_add_u32 m0, s68, 0
    s_nop 0
    buffer_load_dwordx4 v56, s[44:47], s50 offen offset:0  lds
    buffer_load_dwordx4 v57, s[44:47], s50 offen offset:1024  lds
    buffer_load_dwordx4 v58, s[44:47], s50 offen offset:2048  lds
    buffer_load_dwordx4 v59, s[44:47], s50 offen offset:3072  lds
    s_waitcnt vmcnt(13)
    s_barrier
    s_add_u32 s57, s56, 2048
    buffer_store_dwordx4 v[100:103], v111, s[36:39], s57 offen sc1
    s_add_u32 s57, s56, 4096
    buffer_store_dwordx4 v[100:103], v111, s[36:39], s57 offen sc1
    s_add_u32 m0, s68, 4096
    s_nop 0
    buffer_load_dwordx4 v60, s[44:47], s50 offen offset:0  lds
    buffer_load_dwordx4 v61, s[44:47], s50 offen offset:1024  lds
    buffer_load_dwordx4 v62, s[44:47], s50 offen offset:2048  lds
    buffer_load_dwordx4 v63, s[44:47], s50 offen offset:3072  lds
    s_barrier
    s_add_u32 s57, s56, 6144
    buffer_store_dwordx4 v[100:103], v111, s[36:39], s57 offen sc1
    s_add_u32 s57, s56, 8192
    buffer_store_dwordx4 v[100:103], v111, s[36:39], s57 offen sc1
    s_add_u32 s50, s58, 3145728
    s_cmp_ge_u32 s50, s59
    s_cselect_b32 s48, 4718592, 0
    s_sub_u32 s50, s50, s48
    s_add_u32 m0, s68, 16384
    s_nop 0
    buffer_load_dwordx4 v56, s[44:47], s50 offen offset:0  lds
    buffer_load_dwordx4 v57, s[44:47], s50 offen offset:1024  lds
    buffer_load_dwordx4 v58, s[44:47], s50 offen offset:2048  lds
    buffer_load_dwordx4 v59, s[44:47], s50 offen offset:3072  lds
    s_waitcnt vmcnt(17)
    s_barrier
    s_add_u32 s57, s56, 10240
    buffer_store_dwordx4 v[100:103], v111, s[36:39], s57 offen sc1
    s_add_u32 s57, s56, 12288
    buffer_store_dwordx4 v[100:103], v111, s[36:39], s57 offen sc1
    s_add_u32 m0, s68, 20480
    s_nop 0
    buffer_load_dwordx4 v60, s[44:47], s50 offen offset:0  lds
    buffer_load_dwordx4 v61, s[44:47], s50 offen offset:1024  lds
    buffer_load_dwordx4 v62, s[44:47], s50 offen offset:2048  lds
    buffer_load_dwordx4 v63, s[44:47], s50 offen offset:3072  lds
    s_barrier
    s_add_u32 s57, s56, 14336
    buffer_store_dwordx4 v[100:103], v111, s[36:39], s57 offen sc1
    s_add_u32 s50, s58, 3407872
    s_cmp_ge_u32 s50, s59
    s_cselect_b32 s48, 4718592, 0
    s_sub_u32 s50, s50, s48
    s_add_u32 m0, s68, 32768
    s_nop 0
    buffer_load_dwordx4 v56, s[44:47], s50 offen offset:0  lds
    buffer_load_dwordx4 v57, s[44:47], s50 offen offset:1024  lds
    buffer_load_dwordx4 v58, s[44:47], s50 offen offset:2048  lds
    buffer_load_dwordx4 v59, s[44:47], s50 offen offset:3072  lds
    s_waitcnt vmcnt(17)
    s_barrier
    s_add_u32 s57, s56, 16384
    buffer_store_dwordx4 v[100:103], v111, s[36:39], s57 offen sc1
    s_add_u32 s57, s56, 18432
    buffer_store_dwordx4 v[100:103], v111, s[36:39], s57 offen sc1
    s_add_u32 m0, s68, 36864
    s_nop 0
    buffer_load_dwordx4 v60, s[44:47], s50 offen offset:0  lds
    buffer_load_dwordx4 v61, s[44:47], s50 offen offset:1024  lds
    buffer_load_dwordx4 v62, s[44:47], s50 offen offset:2048  lds
    buffer_load_dwordx4 v63, s[44:47], s50 offen offset:3072  lds
    s_barrier
    s_add_u32 s57, s56, 20480
    buffer_store_dwordx4 v[100:103], v111, s[36:39], s57 offen sc1
    s_add_u32 s57, s56, 22528
    buffer_store_dwordx4 v[100:103], v111, s[36:39], s57 offen sc1
    s_add_u32 s50, s58, 3670016
    s_cmp_ge_u32 s50, s59
    s_cselect_b32 s48, 4718592, 0
    s_sub_u32 s50, s50, s48
    s_add_u32 m0, s68, 49152
    s_nop 0
    buffer_load_dwordx4 v56, s[44:47], s50 offen offset:0  lds
    buffer_load_dwordx4 v57, s[44:47], s50 offen offset:1024  lds
    buffer_load_dwordx4 v58, s[44:47], s50 offen offset:2048  lds
    buffer_load_dwordx4 v59, s[44:47], s50 offen offset:3072  lds
    s_waitcnt vmcnt(17)
    s_barrier
    s_add_u32 s57, s56, 24576
    buffer_store_dwordx4 v[100:103], v111, s[36:39], s57 offen sc1
    s_mul_i32 s57, s62, -2048
    s_add_u32 s57, s57, 26624
    s_add_u32 s57, s57, s56
    buffer_store_dwordx4 v[100:103], v111, s[36:39], s57 offen sc1
    s_add_u32 m0, s68, 53248
    s_nop 0
    buffer_load_dwordx4 v60, s[44:47], s50 offen offset:0  lds
    buffer_load_dwordx4 v61, s[44:47], s50 offen offset:1024  lds
    buffer_load_dwordx4 v62, s[44:47], s50 offen offset:2048  lds
    buffer_load_dwordx4 v63, s[44:47], s50 offen offset:3072  lds
    s_barrier
    s_add_u32 s50, s58, 3932160
    s_cmp_ge_u32 s50, s59
    s_cselect_b32 s48, 4718592, 0
    s_sub_u32 s50, s50, s48
    s_add_u32 m0, s68, 65536
    s_nop 0
    buffer_load_dwordx4 v56, s[44:47], s50 offen offset:0  lds
    buffer_load_dwordx4 v57, s[44:47], s50 offen offset:1024  lds
    buffer_load_dwordx4 v58, s[44:47], s50 offen offset:2048  lds
    buffer_load_dwordx4 v59, s[44:47], s50 offen offset:3072  lds
    s_barrier
    s_add_u32 m0, s68, 69632
    s_nop 0
    buffer_load_dwordx4 v60, s[44:47], s50 offen offset:0  lds
    buffer_load_dwordx4 v61, s[44:47], s50 offen offset:1024  lds
    buffer_load_dwordx4 v62, s[44:47], s50 offen offset:2048  lds
    buffer_load_dwordx4 v63, s[44:47], s50 offen offset:3072  lds
    s_waitcnt vmcnt(12)
    s_barrier
    buffer_store_dwordx4 v[104:107], v108, s[36:39], 0 offen sc1
    s_add_u32 s50, s58, 4194304
    s_cmp_ge_u32 s50, s59
    s_cselect_b32 s48, 4718592, 0
    s_sub_u32 s50, s50, s48
    s_add_u32 m0, s68, 0
    s_nop 0
    buffer_load_dwordx4 v56, s[44:47], s50 offen offset:0  lds
    buffer_load_dwordx4 v57, s[44:47], s50 offen offset:1024  lds
    buffer_load_dwordx4 v58, s[44:47], s50 offen offset:2048  lds
    buffer_load_dwordx4 v59, s[44:47], s50 offen offset:3072  lds
    s_waitcnt vmcnt(25)
    s_barrier
    s_add_u32 m0, s68, 4096
    s_nop 0
    buffer_load_dwordx4 v60, s[44:47], s50 offen offset:0  lds
    buffer_load_dwordx4 v61, s[44:47], s50 offen offset:1024  lds
    buffer_load_dwordx4 v62, s[44:47], s50 offen offset:2048  lds
    buffer_load_dwordx4 v63, s[44:47], s50 offen offset:3072  lds
    s_waitcnt vmcnt(17)
    s_barrier
    s_add_u32 s50, s58, 4456448
    s_cmp_ge_u32 s50, s59
    s_cselect_b32 s48, 4718592, 0
    s_sub_u32 s50, s50, s48
    s_add_u32 m0, s68, 16384
    s_nop 0
    buffer_load_dwordx4 v56, s[44:47], s50 offen offset:0  lds
    buffer_load_dwordx4 v57, s[44:47], s50 offen offset:1024  lds
    buffer_load_dwordx4 v58, s[44:47], s50 offen offset:2048  lds
    buffer_load_dwordx4 v59, s[44:47], s50 offen offset:3072  lds
    s_waitcnt vmcnt(13)
    s_barrier
    buffer_load_dword v110, v109, s[36:39], 0 offen sc1
    s_add_u32 m0, s68, 20480
    s_nop 0
    buffer_load_dwordx4 v60, s[44:47], s50 offen offset:0  lds
    buffer_load_dwordx4 v61, s[44:47], s50 offen offset:1024  lds
    buffer_load_dwordx4 v62, s[44:47], s50 offen offset:2048  lds
    buffer_load_dwordx4 v63, s[44:47], s50 offen offset:3072  lds
    s_waitcnt vmcnt(9)
    s_barrier
    s_waitcnt vmcnt(0)
    s_waitcnt vmcnt(4)
    v_cmp_ne_u32 vcc, v3, v110
    s_nop 0
    s_cbranch_vccz L_m_105
Lp_m_106:
    buffer_load_dword v110, v109, s[36:39], 0 offen sc1
    s_waitcnt vmcnt(0)
    v_cmp_ne_u32 vcc, v3, v110
    s_nop 0
    s_cbranch_vccz Le_m_107
    s_sub_u32 s7, s7, 1
    s_cbranch_scc1 Le_m_107
    s_mov_b64 exec, vcc
    s_sleep 1
    s_branch Lp_m_106
Le_m_107:
    s_mov_b64 exec, -1
    s_max_i32 s7, s7, 0
L_m_105:
    s_barrier
    s_barrier
L_m_100:
    v_lshlrev_b32 v100, 4, v0
    v_lshlrev_b32 v101, 2, v0
    s_mul_i32 s48, s3, 2304
    s_mul_i32 s60, s2, 27648
    s_add_u32 s60, s60, s48
    s_add_u32 s60, s60, 27272192
    s_add_u32 s61, s60, 9216
    s_mul_i32 s63, s3, 4608
    s_add_u32 s63, s63, 49152
    v_add_u32 v102, s63, v100
    v_add_u32 v103, s63, v101
Lp_m_108:
    s_add_u32 m0, s63, 2304
    s_nop 0
    buffer_load_dwordx4 v100, s[36:39], s61 offen sc1 lds
    buffer_load_dwordx4 v100, s[36:39], s61 offen offset:1024 sc1 lds
    buffer_load_dword v101, s[36:39], s61 offen offset:2048 sc1 lds
    s_add_u32 m0, s63, 0
    s_nop 0
    buffer_load_dwordx4 v100, s[36:39], s60 offen sc1 lds
    buffer_load_dwordx4 v100, s[36:39], s60 offen offset:1024 sc1 lds
    buffer_load_dword v101, s[36:39], s60 offen offset:2048 sc1 lds
    s_waitcnt vmcnt(0)
    ds_read_b32 v104, v102 offset:0
    ds_read_b32 v105, v102 offset:1024
    ds_read_b32 v106, v103 offset:2048
    ds_read_b32 v107, v102 offset:2304
    ds_read_b32 v108, v102 offset:3328
    ds_read_b32 v109, v103 offset:4352
    s_waitcnt lgkmcnt(3)
    v_max3_u32 v110, v104, v105, v106
    s_waitcnt lgkmcnt(2)
    v_max_u32 v110, v110, v107
    s_waitcnt lgkmcnt(1)
    v_max_u32 v110, v110, v108
    s_waitcnt lgkmcnt(0)
    v_max_u32 v110, v110, v109
    v_cmp_eq_u32 vcc, -1, v110
    s_nop 0
    s_cbranch_vccz Le_m_109
    s_sub_u32 s7, s7, 1
    s_cbranch_scc1 Le_m_109
    s_sleep 1
    s_branch Lp_m_108
Le_m_109:
    s_max_i32 s7, s7, 0
    s_barrier
L_end:
L_exit:
    s_endpgm
L_code_end:
.section .rodata,"a"
.p2align 6
.amdhsa_kernel adaLN_cond__spectral_gfnet__mixer_token_mlp__prompt_kernel
  .amdhsa_next_free_vgpr 256
  .amdhsa_next_free_sgpr 70
  .amdhsa_accum_offset 256
  .amdhsa_group_segment_fixed_size 0
  .amdhsa_kernarg_size 104
  .amdhsa_user_sgpr_count 2
  .amdhsa_user_sgpr_kernarg_segment_ptr 1
  .amdhsa_system_sgpr_workgroup_id_x 1
.end_amdhsa_kernel
```

```asm
; @launch grid=(256,1,1) block=(512,1,1) lds=163840
.amdgcn_target "amdgcn-amd-amdhsa--gfx950"
.text
.globl adaLN_cond__spectral_gfnet__mixer_token_mlp__prompt_kernel
.p2align 8
.type adaLN_cond__spectral_gfnet__mixer_token_mlp__prompt_kernel,@function
adaLN_cond__spectral_gfnet__mixer_token_mlp__prompt_kernel:
    s_cmp_ge_u32 s2, 256
    s_cbranch_scc1 L_exit
    s_load_dwordx16 s[8:23], s[0:1], 0
    s_load_dwordx8 s[24:31], s[0:1], 64
    s_load_dwordx2 s[32:33], s[0:1], 96
    v_readfirstlane_b32 s4, v0
    s_lshr_b32 s5, s2, 3
    s_lshr_b32 s4, s4, 6
    s_cmp_lg_u32 s4, s5
    s_cbranch_scc1 L_nopf
    s_getpc_b64 s[52:53]
L_pc:
    s_sub_u32 s52, s52, L_pc-adaLN_cond__spectral_gfnet__mixer_token_mlp__prompt_kernel
    s_subb_u32 s53, s53, 0
    s_mov_b32 s54, L_code_end-adaLN_cond__spectral_gfnet__mixer_token_mlp__prompt_kernel
    s_mov_b32 s55, 0x20000
    v_lshlrev_b32 v1, 7, v0
    buffer_load_dword v255, v1, s[52:55], 0 offen
    v_add_u32 v1, 65536, v1
    buffer_load_dword v255, v1, s[52:55], 0 offen
L_nopf:
    v_lshrrev_b32 v1, 6, v0
    v_and_b32 v0, 63, v0
    v_readfirstlane_b32 s34, v1
    v_and_b32 v1, 15, v0
    v_lshrrev_b32 v2, 4, v0
    s_and_b32 s4, s2, 7
    s_lshr_b32 s5, s2, 3
    s_lshl_b32 s6, s4, 5
    s_add_u32 s6, s6, s5
    s_mov_b32 s7, 100000
    s_and_b32 s3, s34, 3
    s_cmp_ge_u32 s34, 4
    s_cbranch_scc0 L_C
L_H:
    v_lshlrev_b32 v16, 4, v0
    v_mov_b32 v30, 2146435072
    v_mov_b32 v12, 2146435072
    v_mov_b32 v18, 2146435072
    s_sub_u32 s63, 255, s2
    s_mul_i32 s62, s63, 171
    s_lshr_b32 s62, s62, 9
    s_mul_i32 s48, s62, 3
    s_sub_u32 s61, s63, s48
    s_cmp_ge_u32 s63, 54
    s_cbranch_scc1 L_m_30
    v_lshrrev_b32 v4, 3, v0
    v_and_b32 v5, 7, v0
    v_and_b32 v6, 6, v4
    v_xor_b32 v5, v5, v6
    v_mul_u32_u24 v4, 6912, v4
    v_lshl_add_u32 v12, v5, 4, v4
    s_lshl_b32 s48, s61, 2
    s_add_u32 s48, s48, s3
    s_mul_i32 s48, s48, 331776
    s_lshl_b32 s49, s62, 7
    s_add_u32 s47, s48, s49
    s_lshl_b32 s50, s3, 8
    v_lshl_add_u32 v27, v0, 2, s50
    s_mul_i32 s49, s61, 384
    v_add_u32 v9, s49, v27
    v_add_u32 v12, s47, v12
    s_waitcnt lgkmcnt(0)
    s_mov_b32 s40, s26
    s_mov_b32 s41, s27
    s_mov_b32 s42, 3981312
    s_mov_b32 s43, 0x20000
    s_mul_i32 m0, s3, 6144
    s_mov_b32 s59, 0
    buffer_load_dwordx4 v12, s[40:43], s59 offen lds
    s_add_u32 m0, m0, 1024
    s_add_u32 s59, s59, 55296
    buffer_load_dwordx4 v12, s[40:43], s59 offen lds
    s_add_u32 m0, m0, 1024
    s_add_u32 s59, s59, 55296
    buffer_load_dwordx4 v12, s[40:43], s59 offen lds
    s_add_u32 m0, m0, 1024
    s_add_u32 s59, s59, 55296
    buffer_load_dwordx4 v12, s[40:43], s59 offen lds
    s_add_u32 m0, m0, 1024
    s_add_u32 s59, s59, 55296
    buffer_load_dwordx4 v12, s[40:43], s59 offen lds
    s_add_u32 m0, m0, 1024
    s_add_u32 s59, s59, 55296
    buffer_load_dwordx4 v12, s[40:43], s59 offen lds
    s_mov_b32 s44, s24
    s_mov_b32 s45, s25
    s_mov_b32 s46, 1152
    s_mov_b32 s47, 0x20000
    buffer_load_dword v26, v9, s[44:47], 0 offen
    s_mov_b32 s36, s32
    s_mov_b32 s37, s33
    s_mov_b32 s38, 50331648
    s_mov_b32 s39, 0x20000
    v_mov_b32 v7, 32768
    buffer_load_dword v3, v7, s[36:39], 0 offen sc1
    v_lshrrev_b32 v4, 2, v0
    v_bfe_u32 v5, v4, 1, 2
    v_xor_b32 v5, s3, v5
    v_lshlrev_b32 v5, 5, v5
    v_lshlrev_b32 v4, 7, v4
    v_and_b32 v6, 3, v0
    v_lshlrev_b32 v6, 3, v6
    v_add3_u32 v28, v4, v5, v6
    v_lshlrev_b32 v29, 3, v2
    v_add_u32 v29, 90112, v29
    s_mul_i32 s48, s3, 3456
    s_mul_i32 s49, s61, 1152
    s_add_u32 s48, s48, s49
    s_lshl_b32 s49, s62, 6
    s_add_u32 s48, s48, s49
    s_add_u32 s48, s48, 15204352
    v_mul_u32_u24 v4, 13824, v2
    v_lshl_add_u32 v4, v1, 2, v4
    v_add_u32 v30, s48, v4
    v_add_u32 v31, 55296, v30
    v_mov_b32 v5, 0
    s_mov_b32 s48, 0
    buffer_store_dword v5, v30, s[36:39], s48 offen sc1
    buffer_store_dword v5, v31, s[36:39], s48 offen sc1
    s_lshr_b32 s51, s5, 2
    s_lshl_b32 s51, s51, 3
    s_add_u32 s51, s51, s4
    s_and_b32 s60, s5, 3
    s_lshl_b32 s35, s51, 2
    s_add_u32 s35, s35, s60
    s_lshl_b32 s35, s35, 14
    s_bfe_u32 s48, s6, 0x20002
    s_lshl_b32 s48, s48, 6
    s_lshr_b32 s49, s6, 4
    s_lshl_b32 s49, s49, 2
    s_add_u32 s48, s48, s49
    s_and_b32 s49, s6, 3
    s_add_u32 s48, s48, s49
    s_lshl_b32 s48, s48, 4
    s_lshl_b32 s49, s3, 16
    s_add_u32 s48, s48, s49
    s_add_u32 s48, s48, 15728640
    v_mov_b32 v17, 2146435072
    v_writelane_b32 v17, s48, 0
    s_add_u32 s48, s48, 16384
    s_add_u32 s48, s2, 160
    s_lshl_b32 s48, s48, 7
    s_add_u32 s48, s48, 557056
    s_lshl_b32 s49, s3, 8
    s_add_u32 s49, s49, s5
    s_cmp_lt_u32 s49, 12
    s_cselect_b32 s48, s48, 2146435072
    v_mov_b32 v19, 2146435072
    v_writelane_b32 v19, s48, 0
    s_or_b32 s48, s2, s3
    s_cmp_eq_u32 s48, 0
    s_cselect_b32 s48, 0, 2146435072
    s_add_u32 s48, s48, 32768
    v_writelane_b32 v19, s48, 1
    buffer_load_dword v220, v17, s[36:39], 0 offen
    s_waitcnt vmcnt(3)
    s_setprio 2
    v_lshlrev_b32 v4, 16, v26
    v_and_b32 v5, 0xffff0000, v26
    v_mul_f32 v6, 0xbfb8aa3b, v4
    v_mul_f32 v7, 0xbfb8aa3b, v5
    v_exp_f32 v6, v6
    v_exp_f32 v7, v7
    v_add_f32 v6, 1.0, v6
    v_add_f32 v7, 1.0, v7
    v_rcp_f32 v6, v6
    v_rcp_f32 v7, v7
    v_mul_f32 v4, v4, v6
    v_mul_f32 v5, v5, v7
    v_cvt_pk_bf16_f32 v26, v4, v5
    v_add_u32 v27, 90112, v27
    ds_write_b32 v27, v26
    s_mov_b32 s48, 0x9e3779b1
    v_mul_lo_u32 v3, v3, s48
    v_add_u32 v3, 0x7f4a7c15, v3
    v_or_b32 v3, 0x01010101, v3
    s_waitcnt lgkmcnt(0)
    s_barrier
    ds_read_b64_tr_b16 v[132:133], v28 offset:0
    ds_read_b64_tr_b16 v[134:135], v28 offset:2048
    ds_read2_b64 v[136:139], v29 offset0:0 offset1:4
    ds_read_b64_tr_b16 v[140:141], v28 offset:4096
    ds_read_b64_tr_b16 v[142:143], v28 offset:6144
    ds_read2_b64 v[144:147], v29 offset0:8 offset1:12
    ds_read_b64_tr_b16 v[148:149], v28 offset:8192
    ds_read_b64_tr_b16 v[150:151], v28 offset:10240
    ds_read2_b64 v[152:155], v29 offset0:16 offset1:20
    ds_read_b64_tr_b16 v[156:157], v28 offset:12288
    ds_read_b64_tr_b16 v[158:159], v28 offset:14336
    ds_read2_b64 v[160:163], v29 offset0:24 offset1:28
    ds_read_b64_tr_b16 v[164:165], v28 offset:16384
    ds_read_b64_tr_b16 v[166:167], v28 offset:18432
    ds_read2_b64 v[168:171], v29 offset0:32 offset1:36
    ds_read_b64_tr_b16 v[172:173], v28 offset:20480
    ds_read_b64_tr_b16 v[174:175], v28 offset:22528
    ds_read2_b64 v[176:179], v29 offset0:40 offset1:44
    v_and_b32 v4, 3, v1
    v_or_b32 v4, 0x07060500, v4
    s_waitcnt lgkmcnt(14)
    v_mfma_f32_16x16x32_bf16 v[36:39], v[136:139], v[132:135], 0
    s_waitcnt lgkmcnt(12)
    v_mfma_f32_16x16x32_bf16 v[36:39], v[144:147], v[140:143], v[36:39]
    s_waitcnt lgkmcnt(9)
    v_mfma_f32_16x16x32_bf16 v[36:39], v[152:155], v[148:151], v[36:39]
    s_waitcnt lgkmcnt(6)
    v_mfma_f32_16x16x32_bf16 v[36:39], v[160:163], v[156:159], v[36:39]
    s_waitcnt lgkmcnt(3)
    v_mfma_f32_16x16x32_bf16 v[36:39], v[168:171], v[164:167], v[36:39]
    s_waitcnt lgkmcnt(0)
    v_mfma_f32_16x16x32_bf16 v[36:39], v[176:179], v[172:175], v[36:39]
    s_nop 7
    v_add_u32 v40, 0x80, v36
    v_perm_b32 v40, v40, v3, v4
    s_waitcnt vmcnt(1)
    s_mov_b32 s48, 0
    buffer_store_dword v40, v30, s[36:39], s48 offen sc1
    buffer_store_dword v40, v31, s[36:39], s48 offen sc1
    s_setprio 0
    s_mov_b32 s63, 999
    s_branch L_m_34
L_C:
    v_lshrrev_b32 v18, 5, v0
    v_and_b32 v19, 31, v0
    v_mul_u32_u24 v20, 294912, v18
    v_lshl_add_u32 v20, v19, 2, v20
    s_mul_i32 s62, s3, 589824
    s_mul_i32 s48, s6, 1152
    s_add_u32 s62, s62, s48
    s_waitcnt lgkmcnt(0)
    s_mov_b32 s40, s8
    s_mov_b32 s41, s9
    s_mov_b32 s42, 2359296
    s_mov_b32 s43, 0x20000
    buffer_load_dword v9, v20, s[40:43], s62 offen offset:0
    buffer_load_dword v10, v20, s[40:43], s62 offen offset:128
    buffer_load_dword v11, v20, s[40:43], s62 offen offset:256
    buffer_load_dword v12, v20, s[40:43], s62 offen offset:384
    buffer_load_dword v13, v20, s[40:43], s62 offen offset:512
    buffer_load_dword v14, v20, s[40:43], s62 offen offset:640
    buffer_load_dword v15, v20, s[40:43], s62 offen offset:768
    buffer_load_dword v16, v20, s[40:43], s62 offen offset:896
    buffer_load_dword v17, v20, s[40:43], s62 offen offset:1024
    s_mov_b32 s36, s32
    s_mov_b32 s37, s33
    s_mov_b32 s38, 50331648
    s_mov_b32 s39, 0x20000
    v_mov_b32 v21, 32768
    buffer_load_dword v3, v21, s[36:39], 0 offen sc1
    s_mul_i32 s52, s4, 27
    s_add_u32 s52, s52, s5
    s_mul_i32 s51, s52, 171
    s_lshr_b32 s51, s51, 10
    s_mul_i32 s48, s51, 6
    s_sub_u32 s52, s52, s48
    s_lshr_b32 s53, s4, 1
    s_and_b32 s54, s4, 1
    s_lshl_b32 s54, s54, 3
    s_lshr_b32 s48, s5, 2
    s_add_u32 s54, s54, s48
    s_and_b32 s55, s5, 3
    s_mov_b32 s44, s18
    s_mov_b32 s45, s19
    s_mov_b32 s46, 9216
    s_mov_b32 s47, 0x20000
    s_mov_b32 s64, s22
    s_mov_b32 s65, s23
    s_mov_b32 s66, 4096
    s_mov_b32 s67, 0x20000
    s_lshl_b32 s48, s51, 8
    s_lshl_b32 s49, s3, 6
    s_add_u32 s48, s48, s49
    v_lshl_add_u32 v22, v2, 3, s48
    buffer_load_dwordx2 v[4:5], v22, s[44:47], 0 offen
    buffer_load_dwordx2 v[6:7], v22, s[44:47], 0 offen offset:32
    s_lshl_b32 s48, s54, 8
    s_add_u32 s48, s48, s49
    s_lshr_b32 s49, s53, 1
    s_lshl_b32 s49, s49, 5
    s_add_u32 s48, s48, s49
    v_lshl_add_u32 v23, v1, 1, s48
    buffer_load_ushort v8, v23, s[64:67], 0 offen
    s_bfe_u32 s56, s6, 0x10002
    s_lshl_b32 s56, s56, 7
    s_lshr_b32 s57, s6, 3
    s_lshl_b32 s57, s57, 2
    s_add_u32 s56, s56, s57
    s_and_b32 s57, s6, 3
    s_add_u32 s56, s56, s57
    s_lshl_b32 s48, s56, 4
    s_lshl_b32 s49, s3, 16
    s_add_u32 s48, s48, s49
    s_add_u32 s48, s48, 16252928
    v_mov_b32 v24, 2146435072
    v_writelane_b32 v24, s48, 0
    s_add_u32 s48, s48, 16384
    s_lshl_b32 s56, s52, 6
    s_add_u32 s56, s56, s51
    s_lshl_b32 s48, s56, 4
    s_lshl_b32 s49, s3, 16
    s_add_u32 s48, s48, s49
    s_add_u32 s48, s48, 16515072
    v_mov_b32 v25, 2146435072
    v_writelane_b32 v25, s48, 0
    s_add_u32 s48, s48, 16384
    s_add_u32 s48, s2, 216
    s_lshl_b32 s48, s48, 7
    s_add_u32 s48, s48, 622592
    s_lshl_b32 s49, s3, 8
    s_add_u32 s49, s49, s5
    s_cmp_lt_u32 s49, 5
    s_cselect_b32 s48, s48, 2146435072
    v_writelane_b32 v25, s48, 8
    buffer_load_dword v90, v24, s[36:39], 0 offen
    buffer_load_dword v91, v25, s[36:39], 0 offen
    s_branch L_aligned
.p2align 12
L_aligned:
    v_lshlrev_b32 v36, 4, v0
    v_mul_u32_u24 v148, 1184, v18
    v_lshl_add_u32 v148, v19, 2, v148
    s_mul_i32 s48, s3, 2368
    s_add_u32 s48, s48, 100352
    v_add_u32 v148, s48, v148
    v_lshrrev_b32 v220, 1, v1
    v_and_b32 v221, 1, v1
    v_and_b32 v222, 1, v220
    v_cvt_f32_u32 v220, v220
    v_cvt_f32_u32 v221, v221
    v_mul_f32 v220, 0x3e000000, v220
    v_mul_f32 v221, 0x3e800000, v221
    v_mul_u32_u24 v222, 0x8000, v222
    v_lshl_or_b32 v222, v222, 16, v222
    s_lshl_b32 s48, s3, 10
    s_add_u32 s48, s48, 109952
    v_add_u32 v223, s48, v36
    s_mov_b32 s63, 0x3de38e39
    s_add_u32 s48, s3, 0
    s_mul_i32 s49, s48, 43
    s_lshr_b32 s49, s49, 7
    s_mul_i32 s50, s49, 3
    s_sub_u32 s50, s48, s50
    s_lshl_b32 s50, s50, 2
    v_add_u32 v224, s50, v2
    v_cmp_gt_u32 vcc, 9, v224
    v_mul_u32_u24 v224, s49, v224
    v_cvt_f32_u32 v224, v224
    v_fma_f32 v224, v224, s63, v221
    v_add_f32 v225, v224, v220
    v_fma_f32 v226, v220, 2.0, v224
    v_add_f32 v227, v226, v220
    v_cos_f32 v224, v224
    v_cos_f32 v225, v225
    v_cos_f32 v226, v226
    v_cos_f32 v227, v227
    v_cvt_pk_bf16_f32 v232, v224, v225
    v_cvt_pk_bf16_f32 v233, v226, v227
    v_cndmask_b32 v232, 0, v232, vcc
    v_cndmask_b32 v233, 0, v233, vcc
    v_xor_b32 v234, v222, v232
    v_xor_b32 v235, v222, v233
    ds_write_b128 v223, v[232:235] offset:0
    s_add_u32 s48, s3, 4
    s_mul_i32 s49, s48, 43
    s_lshr_b32 s49, s49, 7
    s_mul_i32 s50, s49, 3
    s_sub_u32 s50, s48, s50
    s_lshl_b32 s50, s50, 2
    v_add_u32 v224, s50, v2
    v_cmp_gt_u32 vcc, 9, v224
    v_mul_u32_u24 v224, s49, v224
    v_cvt_f32_u32 v224, v224
    v_fma_f32 v224, v224, s63, v221
    v_add_f32 v225, v224, v220
    v_fma_f32 v226, v220, 2.0, v224
    v_add_f32 v227, v226, v220
    v_cos_f32 v224, v224
    v_cos_f32 v225, v225
    v_cos_f32 v226, v226
    v_cos_f32 v227, v227
    v_cvt_pk_bf16_f32 v236, v224, v225
    v_cvt_pk_bf16_f32 v237, v226, v227
    v_cndmask_b32 v236, 0, v236, vcc
    v_cndmask_b32 v237, 0, v237, vcc
    v_xor_b32 v238, v222, v236
    v_xor_b32 v239, v222, v237
    ds_write_b128 v223, v[236:239] offset:4096
    s_add_u32 s48, s3, 8
    s_mul_i32 s49, s48, 43
    s_lshr_b32 s49, s49, 7
    s_mul_i32 s50, s49, 3
    s_sub_u32 s50, s48, s50
    s_lshl_b32 s50, s50, 2
    v_add_u32 v224, s50, v2
    v_cmp_gt_u32 vcc, 9, v224
    v_mul_u32_u24 v224, s49, v224
    v_cvt_f32_u32 v224, v224
    v_fma_f32 v224, v224, s63, v221
    v_add_f32 v225, v224, v220
    v_fma_f32 v226, v220, 2.0, v224
    v_add_f32 v227, v226, v220
    v_cos_f32 v224, v224
    v_cos_f32 v225, v225
    v_cos_f32 v226, v226
    v_cos_f32 v227, v227
    v_cvt_pk_bf16_f32 v232, v224, v225
    v_cvt_pk_bf16_f32 v233, v226, v227
    v_cndmask_b32 v232, 0, v232, vcc
    v_cndmask_b32 v233, 0, v233, vcc
    v_xor_b32 v234, v222, v232
    v_xor_b32 v235, v222, v233
    ds_write_b128 v223, v[232:235] offset:8192
    s_add_u32 s48, s3, 12
    s_mul_i32 s49, s48, 43
    s_lshr_b32 s49, s49, 7
    s_mul_i32 s50, s49, 3
    s_sub_u32 s50, s48, s50
    s_lshl_b32 s50, s50, 2
    v_add_u32 v224, s50, v2
    v_cmp_gt_u32 vcc, 9, v224
    v_mul_u32_u24 v224, s49, v224
    v_cvt_f32_u32 v224, v224
    v_fma_f32 v224, v224, s63, v221
    v_add_f32 v225, v224, v220
    v_fma_f32 v226, v220, 2.0, v224
    v_add_f32 v227, v226, v220
    v_cos_f32 v224, v224
    v_cos_f32 v225, v225
    v_cos_f32 v226, v226
    v_cos_f32 v227, v227
    v_cvt_pk_bf16_f32 v236, v224, v225
    v_cvt_pk_bf16_f32 v237, v226, v227
    v_cndmask_b32 v236, 0, v236, vcc
    v_cndmask_b32 v237, 0, v237, vcc
    v_xor_b32 v238, v222, v236
    v_xor_b32 v239, v222, v237
    ds_write_b128 v223, v[236:239] offset:12288
    v_lshrrev_b32 v22, 5, v0
    v_lshlrev_b32 v22, 2, v22
    s_lshl_b32 s48, s3, 3
    s_add_u32 s48, s48, 109824
    v_add_u32 v22, s48, v22
    v_bfe_u32 v18, v0, 2, 2
    v_mul_u32_u24 v18, 1184, v18
    v_and_b32 v19, 3, v0
    v_lshl_add_u32 v18, v19, 3, v18
    s_lshl_b32 s48, s3, 5
    s_add_u32 s48, s48, 100352
    v_add_u32 v19, s48, v18
    v_lshl_add_u32 v18, v2, 7, v19
    v_mov_b32 v20, 109824
    v_add_u32 v21, 109952, v36
    s_waitcnt vmcnt(14)
    ds_write_b32 v148, v9 offset:0
    v_lshlrev_b32 v106, 16, v9
    v_and_b32 v107, 0xffff0000, v9
    s_waitcnt vmcnt(13)
    ds_write_b32 v148, v10 offset:128
    v_lshlrev_b32 v108, 16, v10
    v_and_b32 v109, 0xffff0000, v10
    s_waitcnt vmcnt(12)
    ds_write_b32 v148, v11 offset:256
    v_lshlrev_b32 v110, 16, v11
    v_and_b32 v111, 0xffff0000, v11
    s_waitcnt vmcnt(11)
    ds_write_b32 v148, v12 offset:384
    v_lshlrev_b32 v112, 16, v12
    v_and_b32 v113, 0xffff0000, v12
    s_waitcnt vmcnt(10)
    ds_write_b32 v148, v13 offset:512
    v_lshlrev_b32 v114, 16, v13
    v_and_b32 v115, 0xffff0000, v13
    s_waitcnt vmcnt(9)
    ds_write_b32 v148, v14 offset:640
    v_lshlrev_b32 v116, 16, v14
    v_and_b32 v117, 0xffff0000, v14
    s_waitcnt vmcnt(8)
    ds_write_b32 v148, v15 offset:768
    v_lshlrev_b32 v118, 16, v15
    v_and_b32 v119, 0xffff0000, v15
    s_waitcnt vmcnt(7)
    ds_write_b32 v148, v16 offset:896
    v_lshlrev_b32 v120, 16, v16
    v_and_b32 v121, 0xffff0000, v16
    s_waitcnt vmcnt(6)
    ds_write_b32 v148, v17 offset:1024
    v_lshlrev_b32 v122, 16, v17
    v_and_b32 v123, 0xffff0000, v17
    v_pk_add_f32 v[24:25], v[106:107], v[108:109]
    v_pk_mul_f32 v[26:27], v[106:107], v[106:107]
    v_pk_fma_f32 v[26:27], v[108:109], v[108:109], v[26:27]
    v_pk_add_f32 v[24:25], v[24:25], v[110:111]
    v_pk_fma_f32 v[26:27], v[110:111], v[110:111], v[26:27]
    v_pk_add_f32 v[24:25], v[24:25], v[112:113]
    v_pk_fma_f32 v[26:27], v[112:113], v[112:113], v[26:27]
    v_pk_add_f32 v[24:25], v[24:25], v[114:115]
    v_pk_fma_f32 v[26:27], v[114:115], v[114:115], v[26:27]
    v_pk_add_f32 v[24:25], v[24:25], v[116:117]
    v_pk_fma_f32 v[26:27], v[116:117], v[116:117], v[26:27]
    v_pk_add_f32 v[24:25], v[24:25], v[118:119]
    v_pk_fma_f32 v[26:27], v[118:119], v[118:119], v[26:27]
    v_pk_add_f32 v[24:25], v[24:25], v[120:121]
    v_pk_fma_f32 v[26:27], v[120:121], v[120:121], v[26:27]
    v_pk_add_f32 v[24:25], v[24:25], v[122:123]
    v_pk_fma_f32 v[26:27], v[122:123], v[122:123], v[26:27]
    v_add_f32 v24, v24, v25
    v_add_f32 v25, v26, v27
    s_nop 0
    v_add_f32_dpp v24, v24, v24 quad_perm:[1,0,3,2] row_mask:0xf bank_mask:0xf
    v_add_f32_dpp v25, v25, v25 quad_perm:[1,0,3,2] row_mask:0xf bank_mask:0xf
    s_nop 0
    v_add_f32_dpp v24, v24, v24 quad_perm:[2,3,0,1] row_mask:0xf bank_mask:0xf
    v_add_f32_dpp v25, v25, v25 quad_perm:[2,3,0,1] row_mask:0xf bank_mask:0xf
    s_nop 0
    v_add_f32_dpp v24, v24, v24 row_half_mirror row_mask:0xf bank_mask:0xf
    v_add_f32_dpp v25, v25, v25 row_half_mirror row_mask:0xf bank_mask:0xf
    s_nop 0
    v_add_f32_dpp v24, v24, v24 row_mirror row_mask:0xf bank_mask:0xf
    v_add_f32_dpp v25, v25, v25 row_mirror row_mask:0xf bank_mask:0xf
    v_mov_b32 v26, v24
    v_mov_b32 v27, v25
    s_nop 0
    v_permlane16_swap_b32 v24, v26
    v_permlane16_swap_b32 v25, v27
    v_add_f32 v24, v24, v26
    v_add_f32 v25, v25, v27
    v_mul_f32 v24, 0xbae38e39, v24
    v_mul_f32 v25, 0x3ae38e39, v25
    v_fma_f32 v25, -v24, v24, v25
    v_max_f32 v25, 0, v25
    v_add_f32 v25, 0x3727c5ac, v25
    v_rsq_f32 v26, v25
    s_nop 0
    v_mul_f32 v24, v24, v26
    ds_write_b32 v22, v26
    ds_write_b32 v22, v24 offset:32
    s_waitcnt lgkmcnt(0)
    s_barrier
    ds_read_b128 v[132:135], v20 offset:0
    ds_read_b128 v[136:139], v20 offset:16
    ds_read_b128 v[140:143], v20 offset:32
    ds_read_b128 v[144:147], v20 offset:48
    ds_read_b64_tr_b16 v[148:149], v18 offset:0
    ds_read_b64_tr_b16 v[150:151], v18 offset:4736
    ds_read_b64_tr_b16 v[152:153], v18 offset:512
    ds_read_b64_tr_b16 v[154:155], v18 offset:5248
    ds_read_b64_tr_b16 v[156:157], v19 offset:1024
    ds_read_b64_tr_b16 v[158:159], v19 offset:5760
    ds_read_b128 v[160:163], v21 offset:0
    ds_read_b128 v[164:167], v21 offset:1024
    ds_read_b128 v[168:171], v21 offset:2048
    ds_read_b128 v[172:175], v21 offset:3072
    ds_read_b128 v[176:179], v21 offset:4096
    ds_read_b128 v[180:183], v21 offset:5120
    ds_read_b128 v[184:187], v21 offset:6144
    ds_read_b128 v[188:191], v21 offset:7168
    ds_read_b128 v[192:195], v21 offset:8192
    ds_read_b128 v[196:199], v21 offset:9216
    ds_read_b128 v[200:203], v21 offset:10240
    ds_read_b128 v[204:207], v21 offset:11264
    ds_read_b128 v[208:211], v21 offset:12288
    ds_read_b128 v[212:215], v21 offset:13312
    ds_read_b128 v[216:219], v21 offset:14336
    s_lshl_b32 s48, s3, 4
    v_add_u32 v24, s48, v1
    v_cvt_f32_u32 v24, v24
    v_mul_f32 v24, 0x3c800000, v24
    v_cvt_f32_u32 v26, v2
    v_mul_f32 v26, 4.0, v26
    v_mul_f32 v25, v26, v24
    v_cos_f32 v19, v25
    v_sin_f32 v20, v25
    s_nop 0
    v_cvt_pk_bf16_f32 v40, v19, v20
    v_cvt_pk_bf16_f32 v44, -v20, v19
    v_fma_f32 v21, v24, 1.0, v25
    v_cos_f32 v22, v21
    v_sin_f32 v23, v21
    s_nop 0
    v_cvt_pk_bf16_f32 v41, v22, v23
    v_cvt_pk_bf16_f32 v45, -v23, v22
    v_fma_f32 v18, v24, 2.0, v25
    v_cos_f32 v19, v18
    v_sin_f32 v20, v18
    s_nop 0
    v_cvt_pk_bf16_f32 v42, v19, v20
    v_cvt_pk_bf16_f32 v46, -v20, v19
    v_add_f32 v21, v18, v24
    v_cos_f32 v22, v21
    v_sin_f32 v23, v21
    s_nop 0
    v_cvt_pk_bf16_f32 v43, v22, v23
    v_cvt_pk_bf16_f32 v47, -v23, v22
    v_add_f32 v26, 0x41800000, v26
    v_mul_f32 v25, v26, v24
    v_cos_f32 v19, v25
    v_sin_f32 v20, v25
    s_nop 0
    v_cvt_pk_bf16_f32 v48, v19, v20
    v_cvt_pk_bf16_f32 v52, -v20, v19
    v_fma_f32 v21, v24, 1.0, v25
    v_cos_f32 v22, v21
    v_sin_f32 v23, v21
    s_nop 0
    v_cvt_pk_bf16_f32 v49, v22, v23
    v_cvt_pk_bf16_f32 v53, -v23, v22
    v_fma_f32 v18, v24, 2.0, v25
    v_cos_f32 v19, v18
    v_sin_f32 v20, v18
    s_nop 0
    v_cvt_pk_bf16_f32 v50, v19, v20
    v_cvt_pk_bf16_f32 v54, -v20, v19
    v_add_f32 v21, v18, v24
    v_cos_f32 v22, v21
    v_sin_f32 v23, v21
    s_nop 0
    v_cvt_pk_bf16_f32 v51, v22, v23
    v_cvt_pk_bf16_f32 v55, -v23, v22
    v_add_f32 v26, 0x41800000, v26
    v_mul_f32 v25, v26, v24
    v_cos_f32 v19, v25
    v_sin_f32 v20, v25
    s_nop 0
    v_cvt_pk_bf16_f32 v56, v19, v20
    v_cvt_pk_bf16_f32 v60, -v20, v19
    v_fma_f32 v21, v24, 1.0, v25
    v_cos_f32 v22, v21
    v_sin_f32 v23, v21
    s_nop 0
    v_cvt_pk_bf16_f32 v57, v22, v23
    v_cvt_pk_bf16_f32 v61, -v23, v22
    v_fma_f32 v18, v24, 2.0, v25
    v_cos_f32 v19, v18
    v_sin_f32 v20, v18
    s_nop 0
    v_cvt_pk_bf16_f32 v58, v19, v20
    v_cvt_pk_bf16_f32 v62, -v20, v19
    v_add_f32 v21, v18, v24
    v_cos_f32 v22, v21
    v_sin_f32 v23, v21
    s_nop 0
    v_cvt_pk_bf16_f32 v59, v22, v23
    v_cvt_pk_bf16_f32 v63, -v23, v22
    v_add_f32 v26, 0x41800000, v26
    v_mul_f32 v25, v26, v24
    v_cos_f32 v19, v25
    v_sin_f32 v20, v25
    s_nop 0
    v_cvt_pk_bf16_f32 v64, v19, v20
    v_cvt_pk_bf16_f32 v68, -v20, v19
    v_fma_f32 v21, v24, 1.0, v25
    v_cos_f32 v22, v21
    v_sin_f32 v23, v21
    s_nop 0
    v_cvt_pk_bf16_f32 v65, v22, v23
    v_cvt_pk_bf16_f32 v69, -v23, v22
    v_fma_f32 v18, v24, 2.0, v25
    v_cos_f32 v19, v18
    v_sin_f32 v20, v18
    s_nop 0
    v_cvt_pk_bf16_f32 v66, v19, v20
    v_cvt_pk_bf16_f32 v70, -v20, v19
    v_add_f32 v21, v18, v24
    v_cos_f32 v22, v21
    v_sin_f32 v23, v21
    s_nop 0
    v_cvt_pk_bf16_f32 v67, v22, v23
    v_cvt_pk_bf16_f32 v71, -v23, v22
    v_mul_f32 v37, 0x3de38e39, v24
    v_mul_f32 v22, 0x3f800000, v37
    v_cos_f32 v98, v22
    v_sin_f32 v99, v22
    v_mul_f32 v22, 0x40000000, v37
    v_cos_f32 v100, v22
    v_sin_f32 v101, v22
    v_mul_f32 v22, 0x40400000, v37
    v_cos_f32 v102, v22
    v_sin_f32 v103, v22
    v_mul_f32 v22, 0x40800000, v37
    v_cos_f32 v104, v22
    v_sin_f32 v105, v22
L_m_1:
    s_waitcnt lgkmcnt(14)
    v_lshlrev_b32 v106, 16, v148
    v_and_b32 v107, 0xffff0000, v148
    v_pk_fma_f32 v[106:107], v[106:107], v[132:133], v[140:141]
    v_lshlrev_b32 v108, 16, v149
    v_and_b32 v109, 0xffff0000, v149
    v_pk_fma_f32 v[108:109], v[108:109], v[134:135], v[142:143]
    v_lshlrev_b32 v110, 16, v150
    v_and_b32 v111, 0xffff0000, v150
    v_pk_fma_f32 v[110:111], v[110:111], v[136:137], v[144:145]
    v_lshlrev_b32 v112, 16, v151
    v_and_b32 v113, 0xffff0000, v151
    v_pk_fma_f32 v[112:113], v[112:113], v[138:139], v[146:147]
    v_lshlrev_b32 v114, 16, v152
    v_and_b32 v115, 0xffff0000, v152
    v_pk_fma_f32 v[114:115], v[114:115], v[132:133], v[140:141]
    v_lshlrev_b32 v116, 16, v153
    v_and_b32 v117, 0xffff0000, v153
    v_pk_fma_f32 v[116:117], v[116:117], v[134:135], v[142:143]
    v_lshlrev_b32 v118, 16, v154
    v_and_b32 v119, 0xffff0000, v154
    v_pk_fma_f32 v[118:119], v[118:119], v[136:137], v[144:145]
    v_lshlrev_b32 v120, 16, v155
    v_and_b32 v121, 0xffff0000, v155
    v_pk_fma_f32 v[120:121], v[120:121], v[138:139], v[146:147]
    v_lshlrev_b32 v122, 16, v156
    v_and_b32 v123, 0xffff0000, v156
    v_pk_fma_f32 v[122:123], v[122:123], v[132:133], v[140:141]
    v_lshlrev_b32 v124, 16, v157
    v_and_b32 v125, 0xffff0000, v157
    v_pk_fma_f32 v[124:125], v[124:125], v[134:135], v[142:143]
    v_lshlrev_b32 v126, 16, v158
    v_and_b32 v127, 0xffff0000, v158
    v_pk_fma_f32 v[126:127], v[126:127], v[136:137], v[144:145]
    v_lshlrev_b32 v128, 16, v159
    v_and_b32 v129, 0xffff0000, v159
    v_pk_fma_f32 v[128:129], v[128:129], v[138:139], v[146:147]
    s_waitcnt lgkmcnt(0)
    s_cmp_ge_u32 s2, 202
    s_cbranch_scc1 L_m_2
    v_and_b32 v220, 7, v1
    v_cvt_f32_u32 v220, v220
    v_mul_f32 v220, 0x3e000000, v220
    v_and_b32 v221, 1, v2
    v_cvt_f32_u32 v221, v221
    v_mul_f32 v221, 4.0, v221
    v_mul_f32 v221, v221, v220
    v_lshrrev_b32 v222, 3, v1
    v_lshrrev_b32 v223, 1, v2
    s_lshl_b32 s48, s3, 10
    s_add_u32 s48, s48, 147456
    v_add_u32 v224, s48, v36
    s_add_u32 s48, s3, 0
    s_mul_i32 s49, s48, 43
    s_lshr_b32 s49, s49, 7
    s_mul_i32 s50, s49, 3
    s_sub_u32 s50, s48, s50
    s_lshl_b32 s50, s50, 1
    s_lshl_b32 s49, s49, 1
    v_add_u32 v225, s49, v222
    v_add_u32 v226, s50, v223
    v_cmp_gt_u32 vcc, 9, v225
    v_cmp_gt_u32 s[48:49], 5, v226
    v_mul_u32_u24 v225, v225, v226
    v_cvt_f32_u32 v225, v225
    s_and_b64 vcc, vcc, s[48:49]
    v_fma_f32 v225, v225, s63, v221
    v_cos_f32 v226, v225
    v_sin_f32 v227, v225
    s_nop 0
    v_cvt_pk_bf16_f32 v232, v226, -v227
    v_add_f32 v225, v225, v220
    v_cos_f32 v228, v225
    v_sin_f32 v229, v225
    s_nop 0
    v_cvt_pk_bf16_f32 v233, v228, -v229
    v_add_f32 v225, v225, v220
    v_cos_f32 v226, v225
    v_sin_f32 v227, v225
    s_nop 0
    v_cvt_pk_bf16_f32 v234, v226, -v227
    v_add_f32 v225, v225, v220
    v_cos_f32 v228, v225
    v_sin_f32 v229, v225
    s_nop 0
    v_cvt_pk_bf16_f32 v235, v228, -v229
    v_cndmask_b32 v232, 0, v232, vcc
    v_cndmask_b32 v233, 0, v233, vcc
    v_cndmask_b32 v234, 0, v234, vcc
    v_cndmask_b32 v235, 0, v235, vcc
    ds_write_b128 v224, v[232:235] offset:0
    s_add_u32 s48, s3, 4
    s_mul_i32 s49, s48, 43
    s_lshr_b32 s49, s49, 7
    s_mul_i32 s50, s49, 3
    s_sub_u32 s50, s48, s50
    s_lshl_b32 s50, s50, 1
    s_lshl_b32 s49, s49, 1
    v_add_u32 v225, s49, v222
    v_add_u32 v226, s50, v223
    v_cmp_gt_u32 vcc, 9, v225
    v_cmp_gt_u32 s[48:49], 5, v226
    v_mul_u32_u24 v225, v225, v226
    v_cvt_f32_u32 v225, v225
    s_and_b64 vcc, vcc, s[48:49]
    v_fma_f32 v225, v225, s63, v221
    v_cos_f32 v226, v225
    v_sin_f32 v227, v225
    s_nop 0
    v_cvt_pk_bf16_f32 v236, v226, -v227
    v_add_f32 v225, v225, v220
    v_cos_f32 v228, v225
    v_sin_f32 v229, v225
    s_nop 0
    v_cvt_pk_bf16_f32 v237, v228, -v229
    v_add_f32 v225, v225, v220
    v_cos_f32 v226, v225
    v_sin_f32 v227, v225
    s_nop 0
    v_cvt_pk_bf16_f32 v238, v226, -v227
    v_add_f32 v225, v225, v220
    v_cos_f32 v228, v225
    v_sin_f32 v229, v225
    s_nop 0
    v_cvt_pk_bf16_f32 v239, v228, -v229
    v_cndmask_b32 v236, 0, v236, vcc
    v_cndmask_b32 v237, 0, v237, vcc
    v_cndmask_b32 v238, 0, v238, vcc
    v_cndmask_b32 v239, 0, v239, vcc
    ds_write_b128 v224, v[236:239] offset:4096
    s_add_u32 s48, s3, 8
    s_mul_i32 s49, s48, 43
    s_lshr_b32 s49, s49, 7
    s_mul_i32 s50, s49, 3
    s_sub_u32 s50, s48, s50
    s_lshl_b32 s50, s50, 1
    s_lshl_b32 s49, s49, 1
    v_add_u32 v225, s49, v222
    v_add_u32 v226, s50, v223
    v_cmp_gt_u32 vcc, 9, v225
    v_cmp_gt_u32 s[48:49], 5, v226
    v_mul_u32_u24 v225, v225, v226
    v_cvt_f32_u32 v225, v225
    s_and_b64 vcc, vcc, s[48:49]
    v_fma_f32 v225, v225, s63, v221
    v_cos_f32 v226, v225
    v_sin_f32 v227, v225
    s_nop 0
    v_cvt_pk_bf16_f32 v232, v226, -v227
    v_add_f32 v225, v225, v220
    v_cos_f32 v228, v225
    v_sin_f32 v229, v225
    s_nop 0
    v_cvt_pk_bf16_f32 v233, v228, -v229
    v_add_f32 v225, v225, v220
    v_cos_f32 v226, v225
    v_sin_f32 v227, v225
    s_nop 0
    v_cvt_pk_bf16_f32 v234, v226, -v227
    v_add_f32 v225, v225, v220
    v_cos_f32 v228, v225
    v_sin_f32 v229, v225
    s_nop 0
    v_cvt_pk_bf16_f32 v235, v228, -v229
    v_cndmask_b32 v232, 0, v232, vcc
    v_cndmask_b32 v233, 0, v233, vcc
    v_cndmask_b32 v234, 0, v234, vcc
    v_cndmask_b32 v235, 0, v235, vcc
    ds_write_b128 v224, v[232:235] offset:8192
    s_add_u32 s48, s3, 12
    s_mul_i32 s49, s48, 43
    s_lshr_b32 s49, s49, 7
    s_mul_i32 s50, s49, 3
    s_sub_u32 s50, s48, s50
    s_lshl_b32 s50, s50, 1
    s_lshl_b32 s49, s49, 1
    v_add_u32 v225, s49, v222
    v_add_u32 v226, s50, v223
    v_cmp_gt_u32 vcc, 9, v225
    v_cmp_gt_u32 s[48:49], 5, v226
    v_mul_u32_u24 v225, v225, v226
    v_cvt_f32_u32 v225, v225
    s_and_b64 vcc, vcc, s[48:49]
    v_fma_f32 v225, v225, s63, v221
    v_cos_f32 v226, v225
    v_sin_f32 v227, v225
    s_nop 0
    v_cvt_pk_bf16_f32 v236, v226, -v227
    v_add_f32 v225, v225, v220
    v_cos_f32 v228, v225
    v_sin_f32 v229, v225
    s_nop 0
    v_cvt_pk_bf16_f32 v237, v228, -v229
    v_add_f32 v225, v225, v220
    v_cos_f32 v226, v225
    v_sin_f32 v227, v225
    s_nop 0
    v_cvt_pk_bf16_f32 v238, v226, -v227
    v_add_f32 v225, v225, v220
    v_cos_f32 v228, v225
    v_sin_f32 v229, v225
    s_nop 0
    v_cvt_pk_bf16_f32 v239, v228, -v229
    v_cndmask_b32 v236, 0, v236, vcc
    v_cndmask_b32 v237, 0, v237, vcc
    v_cndmask_b32 v238, 0, v238, vcc
    v_cndmask_b32 v239, 0, v239, vcc
    ds_write_b128 v224, v[236:239] offset:12288
L_m_2:
    v_lshrrev_b32 v22, 1, v2
    v_cvt_f32_u32 v22, v22
    v_add_f32 v23, 1.0, v22
    v_mul_f32 v23, 0x35638e39, v23
    v_mul_f32 v24, v22, v37
    v_cos_f32 v25, v24
    v_sin_f32 v26, v24
    v_mul_f32 v30, v23, v25
    v_mul_f32 v31, v23, v26
    v_add_f32 v22, 2.0, v22
    v_mul_f32 v24, v22, v37
    v_cos_f32 v25, v24
    v_sin_f32 v26, v24
    v_mul_f32 v32, 0x35e38e39, v25
    v_mul_f32 v33, 0x35e38e39, v26
    v_add_f32 v22, 2.0, v22
    v_mul_f32 v24, v22, v37
    v_cos_f32 v25, v24
    v_sin_f32 v26, v24
    v_mul_f32 v34, 0x35e38e39, v25
    v_mul_f32 v35, 0x35e38e39, v26
    s_mov_b32 s48, 0x9e3779b1
    s_waitcnt vmcnt(5)
    v_mul_lo_u32 v3, v3, s48
    v_add_u32 v3, 0x7f4a7c15, v3
    v_or_b32 v3, 0x01010101, v3
    s_lshl_b32 s48, s3, 6
    s_add_u32 s48, s48, 126336
    v_mul_u32_u24 v18, 576, v2
    v_lshl_add_u32 v18, v1, 2, v18
    v_add_u32 v18, s48, v18
    v_mul_u32_u24 v19, 288, v1
    v_lshl_add_u32 v19, v2, 4, v19
    v_add_u32 v19, 126336, v19
    v_bfe_u32 v27, v1, 1, 2
    v_xor_b32 v27, v27, v2
    v_lshl_add_u32 v27, v1, 2, v27
    s_mul_i32 s48, s3, 3072
    s_add_u32 s48, s48, 77824
    v_lshl_add_u32 v27, v27, 4, s48
    v_add_u32 v28, s48, v36
    v_lshrrev_b32 v20, 3, v0
    v_xor_b32 v20, v20, v0
    v_and_b32 v20, 3, v20
    v_lshlrev_b32 v20, 4, v20
    v_lshrrev_b32 v21, 2, v0
    v_lshl_add_u32 v20, v21, 16, v20
    s_lshl_b32 s48, s3, 14
    s_lshl_b32 s49, s6, 6
    s_add_u32 s48, s48, s49
    s_add_u32 s48, s48, 4194304
    v_add_u32 v20, s48, v20
    v_add_u32 v21, 1048576, v20
    v_add_u32 v22, 2097152, v20
    v_cmp_gt_u32 vcc, 32, v0
    v_mov_b32 v23, 2146435072
    s_nop 0
    v_cndmask_b32 v22, v23, v22, vcc
    s_lshl_b32 s58, s3, 12
    s_add_u32 s58, s58, 61440
    v_lshl_add_u32 v93, v1, 2, s58
    s_waitcnt vmcnt(1)
    v_lshl_add_u32 v90, v2, 6, v93
    v_add_u32 v93, 512, v93
    s_waitcnt vmcnt(0)
    v_add_u32 v91, 1152, v90
    v_add_u32 v92, 2304, v90
    v_add_u32 v94, 1152, v93
    v_add_u32 v95, 2304, v93
    v_cmp_gt_u32 vcc, 24, v0
    s_nop 1
    v_cndmask_b32 v96, v23, v36, vcc
    s_mul_i32 s59, s4, 13824
    s_mul_i32 s48, s3, 3456
    s_add_u32 s59, s59, s48
    s_add_u32 s59, s59, 15204352
    v_min_u32 v97, 496, v36
    s_mul_i32 s48, s3, 2560
    s_mul_i32 s60, s6, 10240
    s_add_u32 s60, s60, s48
    s_add_u32 s60, s60, 8388608
    v_mov_b64 v[144:145], -1
    v_mov_b64 v[146:147], -1
    v_and_b32 v24, 3, v1
    v_lshlrev_b32 v24, 3, v24
    v_bfe_u32 v24, v3, v24, 8
    s_mov_b32 m0, s58
    s_branch L_stub_1
L_back_c1:
    s_waitcnt vmcnt(0) lgkmcnt(0)
Lp_m_3:
    buffer_load_dwordx4 v36, s[36:39], s59 offen offset:0 sc1 lds
    buffer_load_dwordx4 v36, s[36:39], s59 offen offset:1024 sc1 lds
    buffer_load_dwordx4 v36, s[36:39], s59 offen offset:2048 sc1 lds
    buffer_load_dwordx4 v96, s[36:39], s59 offen offset:3072 sc1 lds
    s_waitcnt vmcnt(0)
    ds_read2_b32 v[72:73], v90 offset0:0 offset1:144
    ds_read2_b32 v[74:75], v90 offset0:64 offset1:208
    ds_read2_b32 v[76:77], v93 offset0:0 offset1:144
    ds_read2_b32 v[78:79], v91 offset0:0 offset1:144
    ds_read2_b32 v[80:81], v91 offset0:64 offset1:208
    ds_read2_b32 v[82:83], v94 offset0:0 offset1:144
    ds_read2_b32 v[84:85], v92 offset0:0 offset1:144
    ds_read2_b32 v[86:87], v92 offset0:64 offset1:208
    ds_read2_b32 v[88:89], v95 offset0:0 offset1:144
    s_waitcnt lgkmcnt(8)
    v_xor_b32 v72, v72, v24
    v_xor_b32 v73, v73, v24
    v_or_b32 v26, v72, v73
    s_waitcnt lgkmcnt(7)
    v_xor_b32 v74, v74, v24
    v_xor_b32 v75, v75, v24
    v_or3_b32 v26, v74, v75, v26
    s_waitcnt lgkmcnt(6)
    v_xor_b32 v76, v76, v24
    v_xor_b32 v77, v77, v24
    v_or3_b32 v26, v76, v77, v26
    s_waitcnt lgkmcnt(5)
    v_xor_b32 v78, v78, v24
    v_xor_b32 v79, v79, v24
    v_or3_b32 v26, v78, v79, v26
    s_waitcnt lgkmcnt(4)
    v_xor_b32 v80, v80, v24
    v_xor_b32 v81, v81, v24
    v_or3_b32 v26, v80, v81, v26
    s_waitcnt lgkmcnt(3)
    v_xor_b32 v82, v82, v24
    v_xor_b32 v83, v83, v24
    v_or3_b32 v26, v82, v83, v26
    s_waitcnt lgkmcnt(2)
    v_xor_b32 v84, v84, v24
    v_xor_b32 v85, v85, v24
    v_or3_b32 v26, v84, v85, v26
    s_waitcnt lgkmcnt(1)
    v_xor_b32 v86, v86, v24
    v_xor_b32 v87, v87, v24
    v_or3_b32 v26, v86, v87, v26
    s_waitcnt lgkmcnt(0)
    v_xor_b32 v88, v88, v24
    v_xor_b32 v89, v89, v24
    v_or3_b32 v26, v88, v89, v26
    v_and_b32 v26, 0xff, v26
    v_cmp_ne_u32 vcc, 0, v26
    s_nop 0
    s_cbranch_vccz Le_m_4
    s_sub_u32 s7, s7, 1
    s_cbranch_scc1 Le_m_4
    s_sleep 1
    s_branch Lp_m_3
Le_m_4:
    s_max_i32 s7, s7, 0
    buffer_store_dwordx4 v[144:147], v36, s[36:39], s60 offen offset:0 sc1
    buffer_store_dwordx4 v[144:147], v36, s[36:39], s60 offen offset:1024 sc1
    buffer_store_dwordx4 v[144:147], v97, s[36:39], s60 offen offset:2048 sc1
    v_pk_add_f32 v[72:73], v[72:73], v[78:79]
    v_pk_add_f32 v[74:75], v[74:75], v[80:81]
    v_pk_add_f32 v[76:77], v[76:77], v[82:83]
    v_pk_add_f32 v[72:73], v[72:73], v[84:85]
    v_pk_add_f32 v[74:75], v[74:75], v[86:87]
    v_pk_add_f32 v[76:77], v[76:77], v[88:89]
    v_cvt_pk_bf16_f32 v78, v72, v73
    v_and_b32 v73, 0xffff0000, v78
    v_add_f32 v73, 1.0, v73
    v_lshlrev_b32 v72, 16, v78
    v_cvt_pk_bf16_f32 v73, 0, v73
    v_pk_fma_f32 v[106:107], v[106:107], v[72:73], v[72:73] op_sel:[0,1,0] op_sel_hi:[1,1,0]
    s_branch L_skip_1
L_stub_1:
    s_branch L_stub_2
L_skip_1:
    v_pk_fma_f32 v[108:109], v[108:109], v[72:73], v[72:73] op_sel:[0,1,0] op_sel_hi:[1,1,0]
    v_pk_fma_f32 v[110:111], v[110:111], v[72:73], v[72:73] op_sel:[0,1,0] op_sel_hi:[1,1,0]
    v_pk_fma_f32 v[112:113], v[112:113], v[72:73], v[72:73] op_sel:[0,1,0] op_sel_hi:[1,1,0]
    v_cvt_pk_bf16_f32 v148, v106, v107
    v_cvt_pk_bf16_f32 v149, v108, v109
    v_cvt_pk_bf16_f32 v150, v110, v111
    v_cvt_pk_bf16_f32 v151, v112, v113
    v_cvt_pk_bf16_f32 v80, v74, v75
    v_and_b32 v75, 0xffff0000, v80
    v_add_f32 v75, 1.0, v75
    v_lshlrev_b32 v74, 16, v80
    v_cvt_pk_bf16_f32 v75, 0, v75
    v_pk_fma_f32 v[114:115], v[114:115], v[74:75], v[74:75] op_sel:[0,1,0] op_sel_hi:[1,1,0]
    v_pk_fma_f32 v[116:117], v[116:117], v[74:75], v[74:75] op_sel:[0,1,0] op_sel_hi:[1,1,0]
    v_pk_fma_f32 v[118:119], v[118:119], v[74:75], v[74:75] op_sel:[0,1,0] op_sel_hi:[1,1,0]
    v_pk_fma_f32 v[120:121], v[120:121], v[74:75], v[74:75] op_sel:[0,1,0] op_sel_hi:[1,1,0]
    v_cvt_pk_bf16_f32 v152, v114, v115
    v_cvt_pk_bf16_f32 v153, v116, v117
    v_cvt_pk_bf16_f32 v154, v118, v119
    v_cvt_pk_bf16_f32 v155, v120, v121
    v_cvt_pk_bf16_f32 v82, v76, v77
    v_and_b32 v77, 0xffff0000, v82
    v_add_f32 v77, 1.0, v77
    v_lshlrev_b32 v76, 16, v82
    v_cvt_pk_bf16_f32 v77, 0, v77
    v_pk_fma_f32 v[122:123], v[122:123], v[76:77], v[76:77] op_sel:[0,1,0] op_sel_hi:[1,1,0]
    v_pk_fma_f32 v[124:125], v[124:125], v[76:77], v[76:77] op_sel:[0,1,0] op_sel_hi:[1,1,0]
    v_pk_fma_f32 v[126:127], v[126:127], v[76:77], v[76:77] op_sel:[0,1,0] op_sel_hi:[1,1,0]
    v_pk_fma_f32 v[128:129], v[128:129], v[76:77], v[76:77] op_sel:[0,1,0] op_sel_hi:[1,1,0]
    v_cvt_pk_bf16_f32 v156, v122, v123
    v_cvt_pk_bf16_f32 v157, v124, v125
    v_cvt_pk_bf16_f32 v158, v126, v127
    v_cvt_pk_bf16_f32 v159, v128, v129
    v_mfma_f32_16x16x32_bf16 v[224:227], v[172:175], v[148:151], 0
    v_mfma_f32_16x16x32_bf16 v[224:227], v[176:179], v[152:155], v[224:227]
    v_mfma_f32_16x16x32_bf16 v[224:227], v[180:183], v[156:159], v[224:227]
    v_mfma_f32_16x16x32_bf16 v[228:231], v[184:187], v[148:151], 0
    v_mfma_f32_16x16x32_bf16 v[228:231], v[188:191], v[152:155], v[228:231]
    v_mfma_f32_16x16x32_bf16 v[228:231], v[192:195], v[156:159], v[228:231]
    v_mfma_f32_16x16x32_bf16 v[232:235], v[196:199], v[148:151], 0
    s_nop 3
    v_mul_f32 v114, v224, v98
    v_mul_f32 v115, v225, v98
    v_mfma_f32_16x16x32_bf16 v[232:235], v[200:203], v[152:155], v[232:235]
    v_fmac_f32 v114, v225, v99
    v_fma_f32 v115, -v224, v99, v115
    v_mfma_f32_16x16x32_bf16 v[232:235], v[204:207], v[156:159], v[232:235]
    v_cvt_pk_bf16_f32 v116, v114, v115
    ds_write_b32 v18, v116 offset:2304
    v_mfma_f32_16x16x32_bf16 v[236:239], v[208:211], v[148:151], 0
    v_mul_f32 v118, v226, v98
    v_mul_f32 v119, v227, v98
    v_mfma_f32_16x16x32_bf16 v[236:239], v[212:215], v[152:155], v[236:239]
    v_fmac_f32 v118, v227, v99
    v_fma_f32 v119, -v226, v99, v119
    v_mfma_f32_16x16x32_bf16 v[236:239], v[216:219], v[156:159], v[236:239]
    v_cvt_pk_bf16_f32 v120, v118, v119
    ds_write_b32 v18, v120 offset:2592
    v_mfma_f32_16x16x32_bf16 v[220:223], v[160:163], v[148:151], 0
    v_mul_f32 v106, v228, v100
    v_mul_f32 v107, v229, v100
    v_mfma_f32_16x16x32_bf16 v[220:223], v[164:167], v[152:155], v[220:223]
    v_fmac_f32 v106, v229, v101
    v_fma_f32 v107, -v228, v101, v107
    v_mfma_f32_16x16x32_bf16 v[220:223], v[168:171], v[156:159], v[220:223]
    v_cvt_pk_bf16_f32 v108, v106, v107
    ds_write_b32 v18, v108 offset:4608
    v_mul_f32 v110, v230, v100
    v_mul_f32 v111, v231, v100
    v_fmac_f32 v110, v231, v101
    v_fma_f32 v111, -v230, v101, v111
    v_cvt_pk_bf16_f32 v112, v110, v111
    ds_write_b32 v18, v112 offset:4896
    v_mul_f32 v114, v232, v102
    v_mul_f32 v115, v233, v102
    v_fmac_f32 v114, v233, v103
    v_fma_f32 v115, -v232, v103, v115
    v_cvt_pk_bf16_f32 v116, v114, v115
    ds_write_b32 v18, v116 offset:6912
    v_mul_f32 v118, v234, v102
    v_mul_f32 v119, v235, v102
    v_fmac_f32 v118, v235, v103
    v_fma_f32 v119, -v234, v103, v119
    v_cvt_pk_bf16_f32 v120, v118, v119
    ds_write_b32 v18, v120 offset:7200
    v_mul_f32 v106, v236, v104
    v_mul_f32 v107, v237, v104
    v_fmac_f32 v106, v237, v105
    v_fma_f32 v107, -v236, v105, v107
    v_cvt_pk_bf16_f32 v108, v106, v107
    ds_write_b32 v18, v108 offset:9216
    v_mul_f32 v110, v238, v104
    v_mul_f32 v111, v239, v104
    v_fmac_f32 v110, v239, v105
    v_fma_f32 v111, -v238, v105, v111
    v_cvt_pk_bf16_f32 v112, v110, v111
    ds_write_b32 v18, v112 offset:9504
    v_cvt_pk_bf16_f32 v108, v220, v221
    ds_write_b32 v18, v108 offset:0
    v_cvt_pk_bf16_f32 v112, v222, v223
    ds_write_b32 v18, v112 offset:288
    s_waitcnt lgkmcnt(0)
    s_barrier
    ds_read_b128 v[160:163], v19 offset:0
    ds_read_b128 v[164:167], v19 offset:64
    ds_read_b128 v[168:171], v19 offset:128
    ds_read_b128 v[172:175], v19 offset:192
    ds_read_b128 v[176:179], v19 offset:4608
    ds_read_b128 v[180:183], v19 offset:4672
    ds_read_b128 v[184:187], v19 offset:4736
    ds_read_b128 v[188:191], v19 offset:4800
    ds_read_b128 v[192:195], v19 offset:9216
    ds_read_b128 v[196:199], v19 offset:9280
    ds_read_b128 v[200:203], v19 offset:9344
    ds_read_b128 v[204:207], v19 offset:9408
    s_waitcnt lgkmcnt(11)
    v_mfma_f32_16x16x32_bf16 v[220:223], v[40:43], v[160:163], 0
    v_mfma_f32_16x16x32_bf16 v[224:227], v[44:47], v[160:163], 0
    s_waitcnt lgkmcnt(10)
    v_mfma_f32_16x16x32_bf16 v[220:223], v[48:51], v[164:167], v[220:223]
    v_mfma_f32_16x16x32_bf16 v[224:227], v[52:55], v[164:167], v[224:227]
    s_waitcnt lgkmcnt(9)
    v_mfma_f32_16x16x32_bf16 v[220:223], v[56:59], v[168:171], v[220:223]
    v_mfma_f32_16x16x32_bf16 v[224:227], v[60:63], v[168:171], v[224:227]
    s_waitcnt lgkmcnt(8)
    v_mfma_f32_16x16x32_bf16 v[220:223], v[64:67], v[172:175], v[220:223]
    v_mfma_f32_16x16x32_bf16 v[224:227], v[68:71], v[172:175], v[224:227]
    s_waitcnt lgkmcnt(7)
    v_mfma_f32_16x16x32_bf16 v[228:231], v[40:43], v[176:179], 0
    v_mfma_f32_16x16x32_bf16 v[232:235], v[44:47], v[176:179], 0
    s_waitcnt lgkmcnt(6)
    v_mfma_f32_16x16x32_bf16 v[228:231], v[48:51], v[180:183], v[228:231]
    v_mfma_f32_16x16x32_bf16 v[232:235], v[52:55], v[180:183], v[232:235]
    s_waitcnt lgkmcnt(5)
    v_mfma_f32_16x16x32_bf16 v[228:231], v[56:59], v[184:187], v[228:231]
    v_cvt_pk_bf16_f32 v148, v220, v224
    v_mfma_f32_16x16x32_bf16 v[232:235], v[60:63], v[184:187], v[232:235]
    v_cvt_pk_bf16_f32 v149, v221, v225
    s_waitcnt lgkmcnt(4)
    v_mfma_f32_16x16x32_bf16 v[228:231], v[64:67], v[188:191], v[228:231]
    v_cvt_pk_bf16_f32 v150, v222, v226
    v_mfma_f32_16x16x32_bf16 v[232:235], v[68:71], v[188:191], v[232:235]
    v_cvt_pk_bf16_f32 v151, v223, v227
    ds_write_b128 v27, v[148:151] offset:0
    ds_read_b128 v[132:135], v28 offset:0
    s_waitcnt lgkmcnt(5)
    v_mfma_f32_16x16x32_bf16 v[236:239], v[40:43], v[192:195], 0
    v_mfma_f32_16x16x32_bf16 v[240:243], v[44:47], v[192:195], 0
    s_waitcnt lgkmcnt(4)
    v_mfma_f32_16x16x32_bf16 v[236:239], v[48:51], v[196:199], v[236:239]
    v_mfma_f32_16x16x32_bf16 v[240:243], v[52:55], v[196:199], v[240:243]
    s_waitcnt lgkmcnt(3)
    v_mfma_f32_16x16x32_bf16 v[236:239], v[56:59], v[200:203], v[236:239]
    v_cvt_pk_bf16_f32 v152, v228, v232
    v_mfma_f32_16x16x32_bf16 v[240:243], v[60:63], v[200:203], v[240:243]
    v_cvt_pk_bf16_f32 v153, v229, v233
    s_waitcnt lgkmcnt(2)
    v_mfma_f32_16x16x32_bf16 v[236:239], v[64:67], v[204:207], v[236:239]
    v_cvt_pk_bf16_f32 v154, v230, v234
    v_mfma_f32_16x16x32_bf16 v[240:243], v[68:71], v[204:207], v[240:243]
    v_cvt_pk_bf16_f32 v155, v231, v235
    ds_write_b128 v27, v[152:155] offset:1024
    ds_read_b128 v[136:139], v28 offset:1024
    s_waitcnt lgkmcnt(2)
    buffer_store_dwordx4 v[132:135], v20, s[36:39], 0 offen sc1
    s_nop 2
    v_cvt_pk_bf16_f32 v156, v236, v240
    v_cvt_pk_bf16_f32 v157, v237, v241
    v_cvt_pk_bf16_f32 v158, v238, v242
    v_cvt_pk_bf16_f32 v159, v239, v243
    ds_write_b128 v27, v[156:159] offset:2048
    ds_read_b128 v[140:143], v28 offset:2048
    s_waitcnt lgkmcnt(2)
    buffer_store_dwordx4 v[136:139], v21, s[36:39], 0 offen sc1
    s_waitcnt lgkmcnt(0)
    buffer_store_dwordx4 v[140:143], v22, s[36:39], 0 offen sc1
    v_lshrrev_b32 v18, 2, v1
    v_and_b32 v18, 2, v18
    v_xor_b32 v18, v18, v2
    v_lshlrev_b32 v18, 4, v18
    v_lshl_add_u32 v18, v1, 8, v18
    v_add_u32 v18, 98304, v18
    v_and_b32 v19, 7, v1
    v_lshlrev_b32 v19, 8, v19
    v_lshl_add_u32 v19, v2, 4, v19
    v_add_u32 v19, 98304, v19
    v_and_b32 v23, 3, v1
    v_xor_b32 v24, 0, v23
    v_lshl_add_u32 v72, v24, 6, v18
    v_lshl_add_u32 v76, v24, 6, v19
    v_xor_b32 v24, 1, v23
    v_lshl_add_u32 v73, v24, 6, v18
    v_lshl_add_u32 v77, v24, 6, v19
    v_xor_b32 v24, 2, v23
    v_lshl_add_u32 v74, v24, 6, v18
    v_lshl_add_u32 v78, v24, 6, v19
    v_xor_b32 v24, 3, v23
    v_lshl_add_u32 v75, v24, 6, v18
    v_lshl_add_u32 v79, v24, 6, v19
    v_and_b32 v18, 7, v1
    v_mul_u32_u24 v18, 2320, v18
    v_lshl_add_u32 v18, v2, 4, v18
    s_lshl_b32 s48, s3, 6
    s_add_u32 s48, s48, 116736
    v_add_u32 v18, s48, v18
    v_lshrrev_b32 v19, 3, v1
    v_lshl_add_u32 v225, v19, 8, v18
    v_cmp_gt_u32 vcc, 8, v1
    v_mov_b32 v23, 133248
    s_nop 0
    v_cndmask_b32 v224, v23, v18, vcc
    v_lshrrev_b32 v23, 5, v0
    s_lshl_b32 s48, s3, 1
    v_add_u32 v23, s48, v23
    v_and_b32 v24, 31, v0
    v_mul_u32_u24 v18, 2320, v23
    v_lshl_add_u32 v18, v24, 3, v18
    v_add_u32 v226, 116736, v18
    v_mul_u32_u24 v18, 1184, v23
    v_lshl_add_u32 v18, v24, 2, v18
    v_add_u32 v227, 135808, v18
    v_mul_u32_u24 v18, 1152, v23
    v_lshl_add_u32 v18, v24, 2, v18
    v_add_u32 v231, 98304, v18
    v_lshlrev_b32 v18, 3, v24
    v_add_u32 v228, 108544, v18
    v_add_u32 v37, 108800, v18
    v_bfe_u32 v18, v0, 2, 2
    v_mul_u32_u24 v18, 1184, v18
    v_and_b32 v19, 3, v0
    v_lshl_add_u32 v18, v19, 3, v18
    v_lshl_add_u32 v18, v2, 5, v18
    s_lshl_b32 s48, s3, 7
    s_add_u32 s48, s48, 135808
    v_add_u32 v229, s48, v18
    v_add_u32 v230, 147456, v36
    v_min_u32 v232, 496, v36
    s_mul_i32 s48, s3, 2560
    s_mul_i32 s66, s6, 10240
    s_add_u32 s66, s66, s48
    s_add_u32 s66, s66, 8388608
    s_add_u32 s48, s48, 98304
    v_add_u32 v233, s48, v36
    v_add_u32 v234, s48, v232
    s_lshr_b32 s48, s4, 1
    s_lshl_b32 s48, s48, 12
    s_mul_i32 s49, s3, 640
    s_add_u32 s48, s48, s49
    s_add_u32 s48, s48, 294912
    v_min_u32 v235, 624, v36
    v_add_u32 v235, s48, v235
    s_waitcnt vmcnt(0)
    s_waitcnt vmcnt(0)
    s_barrier
    s_cmp_lt_u32 s2, 202
    s_cbranch_scc1 L_m_5
    v_and_b32 v188, 7, v1
    v_cvt_f32_u32 v188, v188
    v_mul_f32 v188, 0x3e000000, v188
    v_and_b32 v189, 1, v2
    v_cvt_f32_u32 v189, v189
    v_mul_f32 v189, 4.0, v189
    v_mul_f32 v189, v189, v188
    v_lshrrev_b32 v190, 3, v1
    v_lshrrev_b32 v191, 1, v2
    s_lshl_b32 s48, s3, 10
    s_add_u32 s48, s48, 147456
    v_add_u32 v192, s48, v36
    s_add_u32 s48, s3, 0
    s_mul_i32 s49, s48, 43
    s_lshr_b32 s49, s49, 7
    s_mul_i32 s50, s49, 3
    s_sub_u32 s50, s48, s50
    s_lshl_b32 s50, s50, 1
    s_lshl_b32 s49, s49, 1
    v_add_u32 v193, s49, v190
    v_add_u32 v194, s50, v191
    v_cmp_gt_u32 vcc, 9, v193
    v_cmp_gt_u32 s[48:49], 5, v194
    v_mul_u32_u24 v193, v193, v194
    v_cvt_f32_u32 v193, v193
    s_and_b64 vcc, vcc, s[48:49]
    v_fma_f32 v193, v193, s63, v189
    v_cos_f32 v194, v193
    v_sin_f32 v195, v193
    s_nop 0
    v_cvt_pk_bf16_f32 v200, v194, -v195
    v_add_f32 v193, v193, v188
    v_cos_f32 v196, v193
    v_sin_f32 v197, v193
    s_nop 0
    v_cvt_pk_bf16_f32 v201, v196, -v197
    v_add_f32 v193, v193, v188
    v_cos_f32 v194, v193
    v_sin_f32 v195, v193
    s_nop 0
    v_cvt_pk_bf16_f32 v202, v194, -v195
    v_add_f32 v193, v193, v188
    v_cos_f32 v196, v193
    v_sin_f32 v197, v193
    s_nop 0
    v_cvt_pk_bf16_f32 v203, v196, -v197
    v_cndmask_b32 v200, 0, v200, vcc
    v_cndmask_b32 v201, 0, v201, vcc
    v_cndmask_b32 v202, 0, v202, vcc
    v_cndmask_b32 v203, 0, v203, vcc
    ds_write_b128 v192, v[200:203] offset:0
    s_add_u32 s48, s3, 4
    s_mul_i32 s49, s48, 43
    s_lshr_b32 s49, s49, 7
    s_mul_i32 s50, s49, 3
    s_sub_u32 s50, s48, s50
    s_lshl_b32 s50, s50, 1
    s_lshl_b32 s49, s49, 1
    v_add_u32 v193, s49, v190
    v_add_u32 v194, s50, v191
    v_cmp_gt_u32 vcc, 9, v193
    v_cmp_gt_u32 s[48:49], 5, v194
    v_mul_u32_u24 v193, v193, v194
    v_cvt_f32_u32 v193, v193
    s_and_b64 vcc, vcc, s[48:49]
    v_fma_f32 v193, v193, s63, v189
    v_cos_f32 v194, v193
    v_sin_f32 v195, v193
    s_nop 0
    v_cvt_pk_bf16_f32 v204, v194, -v195
    v_add_f32 v193, v193, v188
    v_cos_f32 v196, v193
    v_sin_f32 v197, v193
    s_nop 0
    v_cvt_pk_bf16_f32 v205, v196, -v197
    v_add_f32 v193, v193, v188
    v_cos_f32 v194, v193
    v_sin_f32 v195, v193
    s_nop 0
    v_cvt_pk_bf16_f32 v206, v194, -v195
    v_add_f32 v193, v193, v188
    v_cos_f32 v196, v193
    v_sin_f32 v197, v193
    s_nop 0
    v_cvt_pk_bf16_f32 v207, v196, -v197
    v_cndmask_b32 v204, 0, v204, vcc
    v_cndmask_b32 v205, 0, v205, vcc
    v_cndmask_b32 v206, 0, v206, vcc
    v_cndmask_b32 v207, 0, v207, vcc
    ds_write_b128 v192, v[204:207] offset:4096
    s_add_u32 s48, s3, 8
    s_mul_i32 s49, s48, 43
    s_lshr_b32 s49, s49, 7
    s_mul_i32 s50, s49, 3
    s_sub_u32 s50, s48, s50
    s_lshl_b32 s50, s50, 1
    s_lshl_b32 s49, s49, 1
    v_add_u32 v193, s49, v190
    v_add_u32 v194, s50, v191
    v_cmp_gt_u32 vcc, 9, v193
    v_cmp_gt_u32 s[48:49], 5, v194
    v_mul_u32_u24 v193, v193, v194
    v_cvt_f32_u32 v193, v193
    s_and_b64 vcc, vcc, s[48:49]
    v_fma_f32 v193, v193, s63, v189
    v_cos_f32 v194, v193
    v_sin_f32 v195, v193
    s_nop 0
    v_cvt_pk_bf16_f32 v200, v194, -v195
    v_add_f32 v193, v193, v188
    v_cos_f32 v196, v193
    v_sin_f32 v197, v193
    s_nop 0
    v_cvt_pk_bf16_f32 v201, v196, -v197
    v_add_f32 v193, v193, v188
    v_cos_f32 v194, v193
    v_sin_f32 v195, v193
    s_nop 0
    v_cvt_pk_bf16_f32 v202, v194, -v195
    v_add_f32 v193, v193, v188
    v_cos_f32 v196, v193
    v_sin_f32 v197, v193
    s_nop 0
    v_cvt_pk_bf16_f32 v203, v196, -v197
    v_cndmask_b32 v200, 0, v200, vcc
    v_cndmask_b32 v201, 0, v201, vcc
    v_cndmask_b32 v202, 0, v202, vcc
    v_cndmask_b32 v203, 0, v203, vcc
    ds_write_b128 v192, v[200:203] offset:8192
    s_add_u32 s48, s3, 12
    s_mul_i32 s49, s48, 43
    s_lshr_b32 s49, s49, 7
    s_mul_i32 s50, s49, 3
    s_sub_u32 s50, s48, s50
    s_lshl_b32 s50, s50, 1
    s_lshl_b32 s49, s49, 1
    v_add_u32 v193, s49, v190
    v_add_u32 v194, s50, v191
    v_cmp_gt_u32 vcc, 9, v193
    v_cmp_gt_u32 s[48:49], 5, v194
    v_mul_u32_u24 v193, v193, v194
    v_cvt_f32_u32 v193, v193
    s_and_b64 vcc, vcc, s[48:49]
    v_fma_f32 v193, v193, s63, v189
    v_cos_f32 v194, v193
    v_sin_f32 v195, v193
    s_nop 0
    v_cvt_pk_bf16_f32 v204, v194, -v195
    v_add_f32 v193, v193, v188
    v_cos_f32 v196, v193
    v_sin_f32 v197, v193
    s_nop 0
    v_cvt_pk_bf16_f32 v205, v196, -v197
    v_add_f32 v193, v193, v188
    v_cos_f32 v194, v193
    v_sin_f32 v195, v193
    s_nop 0
    v_cvt_pk_bf16_f32 v206, v194, -v195
    v_add_f32 v193, v193, v188
    v_cos_f32 v196, v193
    v_sin_f32 v197, v193
    s_nop 0
    v_cvt_pk_bf16_f32 v207, v196, -v197
    v_cndmask_b32 v204, 0, v204, vcc
    v_cndmask_b32 v205, 0, v205, vcc
    v_cndmask_b32 v206, 0, v206, vcc
    v_cndmask_b32 v207, 0, v207, vcc
    ds_write_b128 v192, v[204:207] offset:12288
L_m_5:
    s_lshl_b32 s58, s3, 10
    v_add_u32 v18, s58, v36
    v_add_u32 v19, 4096, v18
    v_min_u32 v19, 6896, v19
    v_min_u32 v20, 2288, v18
    v_add_u32 v20, 6912, v20
    s_mov_b32 s56, 0x0c0c0400
    s_mov_b32 s57, 0x04000c0c
    s_mov_b32 s58, 196608
    s_mov_b32 s59, 205824
    s_mov_b32 s60, 215040
    s_waitcnt lgkmcnt(0)
    s_cmp_ge_u32 s5, 20
    s_cbranch_scc1 L_m_6
    s_barrier
L_m_6:
    buffer_load_dwordx4 v[80:83], v18, s[36:39], s58 offen sc1
    buffer_load_dwordx4 v[84:87], v18, s[36:39], s59 offen sc1
    buffer_load_dwordx4 v[92:95], v19, s[36:39], s58 offen sc1
    buffer_load_dwordx4 v[96:99], v19, s[36:39], s59 offen sc1
    s_cmp_ge_u32 s5, 20
    s_cbranch_scc1 L_m_7
    s_barrier
L_m_7:
    s_waitcnt vmcnt(0)
    v_perm_b32 v22, v81, v80, s56
    v_perm_b32 v23, v83, v82, s57
    v_or_b32 v22, v22, v23
    v_cmp_ne_u32 vcc, v3, v22
    v_perm_b32 v22, v85, v84, s56
    v_perm_b32 v23, v87, v86, s57
    v_or_b32 v22, v22, v23
    v_cmp_ne_u32 s[48:49], v3, v22
    s_nop 0
    s_or_b64 vcc, vcc, s[48:49]
    v_perm_b32 v22, v93, v92, s56
    v_perm_b32 v23, v95, v94, s57
    v_or_b32 v22, v22, v23
    v_cmp_ne_u32 s[48:49], v3, v22
    s_nop 0
    s_or_b64 vcc, vcc, s[48:49]
    v_perm_b32 v22, v97, v96, s56
    v_perm_b32 v23, v99, v98, s57
    v_or_b32 v22, v22, v23
    v_cmp_ne_u32 s[48:49], v3, v22
    s_nop 0
    s_or_b64 vcc, vcc, s[48:49]
    s_cbranch_vccz L_m_8
Lp_m_9:
    buffer_load_dwordx4 v[80:83], v18, s[36:39], s58 offen sc1
    buffer_load_dwordx4 v[84:87], v18, s[36:39], s59 offen sc1
    buffer_load_dwordx4 v[92:95], v19, s[36:39], s58 offen sc1
    buffer_load_dwordx4 v[96:99], v19, s[36:39], s59 offen sc1
    s_waitcnt vmcnt(0)
    v_perm_b32 v22, v81, v80, s56
    v_perm_b32 v23, v83, v82, s57
    v_or_b32 v22, v22, v23
    v_cmp_ne_u32 vcc, v3, v22
    v_perm_b32 v22, v85, v84, s56
    v_perm_b32 v23, v87, v86, s57
    v_or_b32 v22, v22, v23
    v_cmp_ne_u32 s[48:49], v3, v22
    s_nop 0
    s_or_b64 vcc, vcc, s[48:49]
    v_perm_b32 v22, v93, v92, s56
    v_perm_b32 v23, v95, v94, s57
    v_or_b32 v22, v22, v23
    v_cmp_ne_u32 s[48:49], v3, v22
    s_nop 0
    s_or_b64 vcc, vcc, s[48:49]
    v_perm_b32 v22, v97, v96, s56
    v_perm_b32 v23, v99, v98, s57
    v_or_b32 v22, v22, v23
    v_cmp_ne_u32 s[48:49], v3, v22
    s_nop 0
    s_or_b64 vcc, vcc, s[48:49]
    s_cbranch_vccz Le_m_10
    s_sub_u32 s7, s7, 1
    s_cbranch_scc1 Le_m_10
    s_sleep 1
    s_branch Lp_m_9
Le_m_10:
    s_max_i32 s7, s7, 0
L_m_8:
    v_cmp_le_u32 vcc, 4608, v19
    s_nop 1
    v_cndmask_b32 v22, 0, 1.0, vcc
    v_and_b32 v80, 0xffffff00, v80
    v_and_b32 v81, 0xffffff00, v81
    v_and_b32 v82, 0xffffff00, v82
    v_and_b32 v83, 0xffffff00, v83
    v_and_b32 v84, 0xffffff00, v84
    v_and_b32 v85, 0xffffff00, v85
    v_and_b32 v86, 0xffffff00, v86
    v_and_b32 v87, 0xffffff00, v87
    v_pk_add_f32 v[80:81], v[80:81], v[84:85]
    v_pk_add_f32 v[82:83], v[82:83], v[86:87]
    v_cvt_pk_bf16_f32 v80, 0, v80
    v_cvt_pk_bf16_f32 v81, 0, v81
    v_cvt_pk_bf16_f32 v82, 0, v82
    v_cvt_pk_bf16_f32 v83, 0, v83
    v_and_b32 v92, 0xffffff00, v92
    v_and_b32 v93, 0xffffff00, v93
    v_and_b32 v94, 0xffffff00, v94
    v_and_b32 v95, 0xffffff00, v95
    v_and_b32 v96, 0xffffff00, v96
    v_and_b32 v97, 0xffffff00, v97
    v_and_b32 v98, 0xffffff00, v98
    v_and_b32 v99, 0xffffff00, v99
    v_pk_add_f32 v[92:93], v[92:93], v[96:97]
    v_pk_add_f32 v[94:95], v[94:95], v[98:99]
    v_cvt_pk_bf16_f32 v92, 0, v92
    v_cvt_pk_bf16_f32 v93, 0, v93
    v_cvt_pk_bf16_f32 v94, 0, v94
    v_cvt_pk_bf16_f32 v95, 0, v95
    v_add_f32 v92, v92, v22
    v_add_f32 v93, v93, v22
    v_add_f32 v94, v94, v22
    v_add_f32 v95, v95, v22
    v_cvt_pk_bf16_f32 v92, 0, v92
    v_cvt_pk_bf16_f32 v93, 0, v93
    v_cvt_pk_bf16_f32 v94, 0, v94
    v_cvt_pk_bf16_f32 v95, 0, v95
    v_add_u32 v22, 108544, v18
    v_add_u32 v23, 108544, v19
    ds_write_b128 v22, v[80:83]
    ds_write_b128 v23, v[92:95]
    s_cmp_lg_u32 s2, 255
    s_cbranch_scc1 L_m_11
    s_mov_b32 s50, 4608
    buffer_store_dwordx4 v[80:83], v18, s[36:39], s50 offen sc1
    buffer_store_dwordx4 v[92:95], v19, s[36:39], s50 offen sc1
Lp_m_12:
    buffer_load_dwordx4 v[104:107], v20, s[36:39], s58 offen sc1
    buffer_load_dwordx4 v[108:111], v20, s[36:39], s59 offen sc1
    s_waitcnt vmcnt(0)
    v_perm_b32 v22, v105, v104, s56
    v_perm_b32 v23, v107, v106, s57
    v_or_b32 v22, v22, v23
    v_cmp_ne_u32 vcc, v3, v22
    v_perm_b32 v22, v109, v108, s56
    v_perm_b32 v23, v111, v110, s57
    v_or_b32 v22, v22, v23
    v_cmp_ne_u32 s[48:49], v3, v22
    s_nop 0
    s_or_b64 vcc, vcc, s[48:49]
    s_cbranch_vccz Le_m_13
    s_sub_u32 s7, s7, 1
    s_cbranch_scc1 Le_m_13
    s_sleep 1
    s_branch Lp_m_12
Le_m_13:
    s_max_i32 s7, s7, 0
    v_and_b32 v104, 0xffffff00, v104
    v_and_b32 v105, 0xffffff00, v105
    v_and_b32 v106, 0xffffff00, v106
    v_and_b32 v107, 0xffffff00, v107
    v_and_b32 v108, 0xffffff00, v108
    v_and_b32 v109, 0xffffff00, v109
    v_and_b32 v110, 0xffffff00, v110
    v_and_b32 v111, 0xffffff00, v111
    v_pk_add_f32 v[104:105], v[104:105], v[108:109]
    v_pk_add_f32 v[106:107], v[106:107], v[110:111]
    v_cvt_pk_bf16_f32 v104, 0, v104
    v_cvt_pk_bf16_f32 v105, 0, v105
    v_cvt_pk_bf16_f32 v106, 0, v106
    v_cvt_pk_bf16_f32 v107, 0, v107
    buffer_store_dwordx4 v[104:107], v20, s[36:39], s50 offen sc1
L_m_11:
    v_lshlrev_b32 v236, 16, v9
    v_and_b32 v237, 0xffff0000, v9
    v_lshlrev_b32 v238, 16, v10
    v_and_b32 v239, 0xffff0000, v10
    v_lshlrev_b32 v240, 16, v11
    v_and_b32 v241, 0xffff0000, v11
    v_lshlrev_b32 v242, 16, v12
    v_and_b32 v243, 0xffff0000, v12
    v_lshlrev_b32 v244, 16, v13
    v_and_b32 v245, 0xffff0000, v13
    v_lshlrev_b32 v246, 16, v14
    v_and_b32 v247, 0xffff0000, v14
    v_lshlrev_b32 v248, 16, v15
    v_and_b32 v249, 0xffff0000, v15
    v_lshlrev_b32 v250, 16, v16
    v_and_b32 v251, 0xffff0000, v16
    v_lshlrev_b32 v252, 16, v17
    v_and_b32 v253, 0xffff0000, v17
    s_cmp_ge_u32 s5, 20
    s_cbranch_scc1 L_m_14
    ds_read_b128 v[128:131], v230 offset:0
    ds_read_b128 v[132:135], v230 offset:1024
    ds_read_b128 v[136:139], v230 offset:2048
    ds_read_b128 v[140:143], v230 offset:3072
    ds_read_b128 v[144:147], v230 offset:4096
    ds_read_b128 v[148:151], v230 offset:5120
    ds_read_b128 v[152:155], v230 offset:6144
    ds_read_b128 v[156:159], v230 offset:7168
    ds_read_b128 v[160:163], v230 offset:8192
    ds_read_b128 v[164:167], v230 offset:9216
    ds_read_b128 v[168:171], v230 offset:10240
    ds_read_b128 v[172:175], v230 offset:11264
    ds_read_b128 v[176:179], v230 offset:12288
    ds_read_b128 v[180:183], v230 offset:13312
    ds_read_b128 v[184:187], v230 offset:14336
    s_waitcnt lgkmcnt(0)
    s_barrier
    s_branch L_m_15
L_m_14:
    s_waitcnt lgkmcnt(0)
    s_barrier
    ds_read_b128 v[128:131], v230 offset:0
    ds_read_b128 v[132:135], v230 offset:1024
    ds_read_b128 v[136:139], v230 offset:2048
    ds_read_b128 v[140:143], v230 offset:3072
    ds_read_b128 v[144:147], v230 offset:4096
    ds_read_b128 v[148:151], v230 offset:5120
    ds_read_b128 v[152:155], v230 offset:6144
    ds_read_b128 v[156:159], v230 offset:7168
    ds_read_b128 v[160:163], v230 offset:8192
    ds_read_b128 v[164:167], v230 offset:9216
    ds_read_b128 v[168:171], v230 offset:10240
    ds_read_b128 v[172:175], v230 offset:11264
    ds_read_b128 v[176:179], v230 offset:12288
    ds_read_b128 v[180:183], v230 offset:13312
    ds_read_b128 v[184:187], v230 offset:14336
    s_lshl_b32 s50, s2, 7
    s_add_u32 s50, s50, 557056
    v_mov_b32 v18, 0
Lp_m_16:
    buffer_load_dword v19, v18, s[36:39], s50 offen sc1
    s_waitcnt vmcnt(0)
    v_cmp_ne_u32 vcc, v3, v19
    s_nop 0
    s_cbranch_vccz Le_m_17
    s_sub_u32 s7, s7, 1
    s_cbranch_scc1 Le_m_17
    s_sleep 4
    s_branch Lp_m_16
Le_m_17:
    s_max_i32 s7, s7, 0
    s_waitcnt lgkmcnt(0)
L_m_15:
Lp_m_18:
    buffer_load_dwordx4 v[212:215], v36, s[36:39], s66 offen offset:0 sc1
    buffer_load_dwordx4 v[216:219], v36, s[36:39], s66 offen offset:1024 sc1
    buffer_load_dwordx4 v[220:223], v232, s[36:39], s66 offen offset:2048 sc1
    s_waitcnt vmcnt(0)
    v_max3_u32 v18, v212, v216, v220
    v_cmp_eq_u32 vcc, -1, v18
    s_nop 0
    s_cbranch_vccz Le_m_19
    s_sub_u32 s7, s7, 1
    s_cbranch_scc1 Le_m_19
    s_mov_b64 exec, vcc
    s_sleep 1
    s_branch Lp_m_18
Le_m_19:
    s_mov_b64 exec, -1
    s_max_i32 s7, s7, 0
    ds_write_b128 v233, v[212:215] offset:0
    s_branch L_skip_2
    s_nop 0
L_stub_2:
    s_branch L_back_c1
L_skip_2:
    ds_write_b128 v233, v[216:219] offset:1024
    ds_write_b128 v234, v[220:223] offset:2048
    s_waitcnt lgkmcnt(0)
    s_barrier
    ds_read_b128 v[80:83], v72 offset:0
    ds_read_b128 v[84:87], v73 offset:0
    ds_read_b128 v[88:91], v74 offset:0
    ds_read_b128 v[92:95], v75 offset:0
    ds_read_b128 v[96:99], v72 offset:4096
    ds_read_b128 v[100:103], v73 offset:4096
    ds_read_b128 v[104:107], v74 offset:4096
    ds_read_b128 v[108:111], v75 offset:4096
    ds_read_b128 v[112:115], v76 offset:8192
    ds_read_b128 v[116:119], v77 offset:8192
    ds_read_b128 v[120:123], v78 offset:8192
    ds_read_b128 v[124:127], v79 offset:8192
    s_waitcnt lgkmcnt(11)
    v_mfma_f32_16x16x32_bf16 v[188:191], v[80:83], v[44:47], 0
    v_mfma_f32_16x16x32_bf16 v[192:195], v[80:83], v[40:43], 0
    s_waitcnt lgkmcnt(10)
    v_mfma_f32_16x16x32_bf16 v[188:191], v[84:87], v[52:55], v[188:191]
    v_mfma_f32_16x16x32_bf16 v[192:195], v[84:87], v[48:51], v[192:195]
    s_waitcnt lgkmcnt(9)
    v_mfma_f32_16x16x32_bf16 v[188:191], v[88:91], v[60:63], v[188:191]
    v_mfma_f32_16x16x32_bf16 v[192:195], v[88:91], v[56:59], v[192:195]
    s_waitcnt lgkmcnt(8)
    v_mfma_f32_16x16x32_bf16 v[188:191], v[92:95], v[68:71], v[188:191]
    v_mfma_f32_16x16x32_bf16 v[192:195], v[92:95], v[64:67], v[192:195]
    s_waitcnt lgkmcnt(7)
    v_mfma_f32_16x16x32_bf16 v[196:199], v[96:99], v[44:47], 0
    v_mfma_f32_16x16x32_bf16 v[200:203], v[96:99], v[40:43], 0
    s_waitcnt lgkmcnt(6)
    v_mfma_f32_16x16x32_bf16 v[196:199], v[100:103], v[52:55], v[196:199]
    v_mfma_f32_16x16x32_bf16 v[200:203], v[100:103], v[48:51], v[200:203]
    s_waitcnt lgkmcnt(5)
    v_mfma_f32_16x16x32_bf16 v[196:199], v[104:107], v[60:63], v[196:199]
    v_mul_f32 v18, v188, v30
    v_mul_f32 v19, v192, v30
    v_mfma_f32_16x16x32_bf16 v[200:203], v[104:107], v[56:59], v[200:203]
    v_fma_f32 v18, -v192, v31, v18
    v_fmac_f32 v19, v188, v31
    s_waitcnt lgkmcnt(4)
    v_mfma_f32_16x16x32_bf16 v[196:199], v[108:111], v[68:71], v[196:199]
    v_cvt_pk_bf16_f32 v212, v18, v19
    v_mul_f32 v20, v189, v30
    v_mfma_f32_16x16x32_bf16 v[200:203], v[108:111], v[64:67], v[200:203]
    v_mul_f32 v21, v193, v30
    v_fma_f32 v20, -v193, v31, v20
    s_waitcnt lgkmcnt(3)
    v_mfma_f32_16x16x32_bf16 v[204:207], v[112:115], v[44:47], 0
    v_fmac_f32 v21, v189, v31
    v_cvt_pk_bf16_f32 v213, v20, v21
    v_mfma_f32_16x16x32_bf16 v[208:211], v[112:115], v[40:43], 0
    v_mul_f32 v22, v190, v30
    v_mul_f32 v23, v194, v30
    s_waitcnt lgkmcnt(2)
    v_mfma_f32_16x16x32_bf16 v[204:207], v[116:119], v[52:55], v[204:207]
    v_fma_f32 v22, -v194, v31, v22
    v_fmac_f32 v23, v190, v31
    v_mfma_f32_16x16x32_bf16 v[208:211], v[116:119], v[48:51], v[208:211]
    v_cvt_pk_bf16_f32 v214, v22, v23
    v_mul_f32 v24, v191, v30
    s_waitcnt lgkmcnt(1)
    v_mfma_f32_16x16x32_bf16 v[204:207], v[120:123], v[60:63], v[204:207]
    v_mul_f32 v25, v195, v30
    v_fma_f32 v24, -v195, v31, v24
    v_mfma_f32_16x16x32_bf16 v[208:211], v[120:123], v[56:59], v[208:211]
    v_fmac_f32 v25, v191, v31
    v_cvt_pk_bf16_f32 v215, v24, v25
    s_waitcnt lgkmcnt(0)
    v_mfma_f32_16x16x32_bf16 v[204:207], v[124:127], v[68:71], v[204:207]
    v_mul_f32 v18, v196, v32
    v_mul_f32 v19, v200, v32
    v_mfma_f32_16x16x32_bf16 v[208:211], v[124:127], v[64:67], v[208:211]
    v_fma_f32 v18, -v200, v33, v18
    v_fmac_f32 v19, v196, v33
    v_mfma_f32_16x16x32_bf16 v[80:83], v[212:215], v[128:131], 0
    v_cvt_pk_bf16_f32 v216, v18, v19
    v_mul_f32 v20, v197, v32
    v_mfma_f32_16x16x32_bf16 v[84:87], v[212:215], v[140:143], 0
    v_mul_f32 v21, v201, v32
    v_fma_f32 v20, -v201, v33, v20
    v_mfma_f32_16x16x32_bf16 v[88:91], v[212:215], v[152:155], 0
    v_fmac_f32 v21, v197, v33
    v_cvt_pk_bf16_f32 v217, v20, v21
    v_mfma_f32_16x16x32_bf16 v[92:95], v[212:215], v[164:167], 0
    v_mul_f32 v22, v198, v32
    v_mul_f32 v23, v202, v32
    v_mfma_f32_16x16x32_bf16 v[96:99], v[212:215], v[176:179], 0
    v_fma_f32 v22, -v202, v33, v22
    v_fmac_f32 v23, v198, v33
    v_cvt_pk_bf16_f32 v218, v22, v23
    v_mul_f32 v24, v199, v32
    v_mul_f32 v25, v203, v32
    v_fma_f32 v24, -v203, v33, v24
    v_fmac_f32 v25, v199, v33
    v_cvt_pk_bf16_f32 v219, v24, v25
    s_nop 1
    v_mfma_f32_16x16x32_bf16 v[80:83], v[216:219], v[132:135], v[80:83]
    v_mul_f32 v18, v204, v34
    v_mul_f32 v19, v208, v34
    v_mfma_f32_16x16x32_bf16 v[84:87], v[216:219], v[144:147], v[84:87]
    v_fma_f32 v18, -v208, v35, v18
    v_fmac_f32 v19, v204, v35
    v_mfma_f32_16x16x32_bf16 v[88:91], v[216:219], v[156:159], v[88:91]
    v_cvt_pk_bf16_f32 v220, v18, v19
    v_mul_f32 v20, v205, v34
    v_mfma_f32_16x16x32_bf16 v[92:95], v[216:219], v[168:171], v[92:95]
    v_mul_f32 v21, v209, v34
    v_fma_f32 v20, -v209, v35, v20
    v_mfma_f32_16x16x32_bf16 v[96:99], v[216:219], v[180:183], v[96:99]
    v_fmac_f32 v21, v205, v35
    v_cvt_pk_bf16_f32 v221, v20, v21
    v_mul_f32 v22, v206, v34
    v_mul_f32 v23, v210, v34
    v_fma_f32 v22, -v210, v35, v22
    v_fmac_f32 v23, v206, v35
    v_cvt_pk_bf16_f32 v222, v22, v23
    v_mul_f32 v24, v207, v34
    v_mul_f32 v25, v211, v34
    v_fma_f32 v24, -v211, v35, v24
    v_fmac_f32 v25, v207, v35
    v_cvt_pk_bf16_f32 v223, v24, v25
    s_nop 1
    v_mfma_f32_16x16x32_bf16 v[80:83], v[220:223], v[136:139], v[80:83]
    v_mfma_f32_16x16x32_bf16 v[84:87], v[220:223], v[148:151], v[84:87]
    v_mfma_f32_16x16x32_bf16 v[88:91], v[220:223], v[160:163], v[88:91]
    v_mfma_f32_16x16x32_bf16 v[92:95], v[220:223], v[172:175], v[92:95]
    v_mfma_f32_16x16x32_bf16 v[96:99], v[220:223], v[184:187], v[96:99]
    ds_read2st64_b64 v[40:43], v228 offset0:0 offset1:1
    ds_read2st64_b64 v[44:47], v37 offset0:0 offset1:1
    ds_read2st64_b64 v[48:51], v228 offset0:2 offset1:3
    ds_read2st64_b64 v[52:55], v37 offset0:2 offset1:3
    ds_read_b64 v[56:57], v228 offset:2048
    ds_write_b128 v225, v[80:83] offset:0
    ds_write_b128 v225, v[84:87] offset:512
    ds_write_b128 v225, v[88:91] offset:1024
    ds_write_b128 v225, v[92:95] offset:1536
    ds_write_b128 v224, v[96:99] offset:2048
    ds_read2st64_b64 v[188:191], v228 offset0:9 offset1:10
    ds_read2st64_b64 v[192:195], v37 offset0:9 offset1:10
    ds_read2st64_b64 v[196:199], v228 offset0:11 offset1:12
    ds_read2st64_b64 v[200:203], v37 offset0:11 offset1:12
    ds_read_b64 v[204:205], v228 offset:6656
    ds_read2st64_b64 v[128:131], v37 offset0:4 offset1:5
    ds_read2st64_b64 v[132:135], v228 offset0:5 offset1:6
    ds_read2st64_b64 v[136:139], v37 offset0:6 offset1:7
    ds_read2st64_b64 v[140:143], v228 offset0:7 offset1:8
    ds_read_b64 v[144:145], v228 offset:4352
    s_waitcnt lgkmcnt(10)
    s_barrier
    ds_read_b64 v[100:101], v226 offset:0
    ds_read_b64 v[102:103], v226 offset:256
    ds_read_b64 v[104:105], v226 offset:512
    ds_read_b64 v[106:107], v226 offset:768
    ds_read_b64 v[108:109], v226 offset:1024
    ds_read_b64 v[110:111], v226 offset:1280
    ds_read_b64 v[112:113], v226 offset:1536
    ds_read_b64 v[114:115], v226 offset:1792
    ds_read_b64 v[116:117], v226 offset:2048
    s_mul_i32 s48, s6, 9216
    s_lshl_b32 s49, s3, 10
    s_add_u32 s48, s48, s49
    s_add_u32 s48, s48, 16777216
    s_add_u32 s49, s48, 4096
    s_add_u32 s50, s48, 8192
    s_waitcnt lgkmcnt(8)
    v_pk_fma_f32 v[236:237], v[100:101], v[40:41], v[236:237]
    s_waitcnt lgkmcnt(7)
    v_pk_fma_f32 v[238:239], v[102:103], v[44:45], v[238:239]
    s_waitcnt lgkmcnt(6)
    v_pk_fma_f32 v[240:241], v[104:105], v[42:43], v[240:241]
    s_waitcnt lgkmcnt(5)
    v_pk_fma_f32 v[242:243], v[106:107], v[46:47], v[242:243]
    s_waitcnt lgkmcnt(4)
    v_pk_fma_f32 v[244:245], v[108:109], v[48:49], v[244:245]
    s_waitcnt lgkmcnt(3)
    v_pk_fma_f32 v[246:247], v[110:111], v[52:53], v[246:247]
    s_waitcnt lgkmcnt(2)
    v_pk_fma_f32 v[248:249], v[112:113], v[50:51], v[248:249]
    s_waitcnt lgkmcnt(1)
    v_pk_fma_f32 v[250:251], v[114:115], v[54:55], v[250:251]
    s_waitcnt lgkmcnt(0)
    v_pk_fma_f32 v[252:253], v[116:117], v[56:57], v[252:253]
    v_pk_add_f32 v[24:25], v[236:237], v[238:239]
    v_pk_mul_f32 v[26:27], v[236:237], v[236:237]
    v_pk_fma_f32 v[26:27], v[238:239], v[238:239], v[26:27]
    v_pk_add_f32 v[24:25], v[24:25], v[240:241]
    v_pk_fma_f32 v[26:27], v[240:241], v[240:241], v[26:27]
    v_pk_add_f32 v[24:25], v[24:25], v[242:243]
    v_pk_fma_f32 v[26:27], v[242:243], v[242:243], v[26:27]
    v_pk_add_f32 v[24:25], v[24:25], v[244:245]
    v_pk_fma_f32 v[26:27], v[244:245], v[244:245], v[26:27]
    v_pk_add_f32 v[24:25], v[24:25], v[246:247]
    v_pk_fma_f32 v[26:27], v[246:247], v[246:247], v[26:27]
    v_pk_add_f32 v[24:25], v[24:25], v[248:249]
    v_pk_fma_f32 v[26:27], v[248:249], v[248:249], v[26:27]
    v_pk_add_f32 v[24:25], v[24:25], v[250:251]
    v_pk_fma_f32 v[26:27], v[250:251], v[250:251], v[26:27]
    v_pk_add_f32 v[24:25], v[24:25], v[252:253]
    v_pk_fma_f32 v[26:27], v[252:253], v[252:253], v[26:27]
    v_add_f32 v24, v24, v25
    v_add_f32 v25, v26, v27
    s_nop 0
    v_add_f32_dpp v24, v24, v24 quad_perm:[1,0,3,2] row_mask:0xf bank_mask:0xf
    v_add_f32_dpp v25, v25, v25 quad_perm:[1,0,3,2] row_mask:0xf bank_mask:0xf
    s_nop 0
    v_add_f32_dpp v24, v24, v24 quad_perm:[2,3,0,1] row_mask:0xf bank_mask:0xf
    v_add_f32_dpp v25, v25, v25 quad_perm:[2,3,0,1] row_mask:0xf bank_mask:0xf
    s_nop 0
    v_add_f32_dpp v24, v24, v24 row_half_mirror row_mask:0xf bank_mask:0xf
    v_add_f32_dpp v25, v25, v25 row_half_mirror row_mask:0xf bank_mask:0xf
    s_nop 0
    v_add_f32_dpp v24, v24, v24 row_mirror row_mask:0xf bank_mask:0xf
    v_add_f32_dpp v25, v25, v25 row_mirror row_mask:0xf bank_mask:0xf
    v_mov_b32 v26, v24
    v_mov_b32 v27, v25
    s_nop 0
    v_permlane16_swap_b32 v24, v26
    v_permlane16_swap_b32 v25, v27
    v_add_f32 v24, v24, v26
    v_add_f32 v25, v25, v27
    v_mul_f32 v24, 0xbae38e39, v24
    v_mul_f32 v25, 0x3ae38e39, v25
    v_fma_f32 v25, -v24, v24, v25
    v_max_f32 v25, 0, v25
    v_add_f32 v25, 0x3727c5ac, v25
    v_rsq_f32 v26, v25
    s_nop 0
    v_mul_f32 v24, v24, v26
    v_pk_fma_f32 v[100:101], v[236:237], v[26:27], v[24:25] op_sel_hi:[1,0,0]
    v_pk_fma_f32 v[102:103], v[238:239], v[26:27], v[24:25] op_sel_hi:[1,0,0]
    v_pk_fma_f32 v[104:105], v[240:241], v[26:27], v[24:25] op_sel_hi:[1,0,0]
    v_pk_fma_f32 v[106:107], v[242:243], v[26:27], v[24:25] op_sel_hi:[1,0,0]
    v_pk_fma_f32 v[108:109], v[244:245], v[26:27], v[24:25] op_sel_hi:[1,0,0]
    v_pk_fma_f32 v[110:111], v[246:247], v[26:27], v[24:25] op_sel_hi:[1,0,0]
    v_pk_fma_f32 v[112:113], v[248:249], v[26:27], v[24:25] op_sel_hi:[1,0,0]
    v_pk_fma_f32 v[114:115], v[250:251], v[26:27], v[24:25] op_sel_hi:[1,0,0]
    v_pk_fma_f32 v[116:117], v[252:253], v[26:27], v[24:25] op_sel_hi:[1,0,0]
    v_pk_fma_f32 v[100:101], v[100:101], v[188:189], v[128:129]
    v_pk_fma_f32 v[102:103], v[102:103], v[192:193], v[132:133]
    v_pk_fma_f32 v[104:105], v[104:105], v[190:191], v[130:131]
    v_pk_fma_f32 v[106:107], v[106:107], v[194:195], v[134:135]
    v_pk_fma_f32 v[108:109], v[108:109], v[196:197], v[136:137]
    v_pk_fma_f32 v[110:111], v[110:111], v[200:201], v[140:141]
    v_pk_fma_f32 v[112:113], v[112:113], v[198:199], v[138:139]
    v_pk_fma_f32 v[114:115], v[114:115], v[202:203], v[142:143]
    v_pk_fma_f32 v[116:117], v[116:117], v[204:205], v[144:145]
    v_pk_add_f32 v[24:25], v[100:101], v[102:103]
    v_pk_mul_f32 v[26:27], v[100:101], v[100:101]
    v_pk_fma_f32 v[26:27], v[102:103], v[102:103], v[26:27]
    v_pk_add_f32 v[24:25], v[24:25], v[104:105]
    v_pk_fma_f32 v[26:27], v[104:105], v[104:105], v[26:27]
    v_pk_add_f32 v[24:25], v[24:25], v[106:107]
    v_pk_fma_f32 v[26:27], v[106:107], v[106:107], v[26:27]
    v_pk_add_f32 v[24:25], v[24:25], v[108:109]
    v_pk_fma_f32 v[26:27], v[108:109], v[108:109], v[26:27]
    v_pk_add_f32 v[24:25], v[24:25], v[110:111]
    v_pk_fma_f32 v[26:27], v[110:111], v[110:111], v[26:27]
    v_pk_add_f32 v[24:25], v[24:25], v[112:113]
    v_pk_fma_f32 v[26:27], v[112:113], v[112:113], v[26:27]
    v_pk_add_f32 v[24:25], v[24:25], v[114:115]
    v_pk_fma_f32 v[26:27], v[114:115], v[114:115], v[26:27]
    v_pk_add_f32 v[24:25], v[24:25], v[116:117]
    v_pk_fma_f32 v[26:27], v[116:117], v[116:117], v[26:27]
    v_add_f32 v24, v24, v25
    v_add_f32 v25, v26, v27
    s_nop 0
    v_add_f32_dpp v24, v24, v24 quad_perm:[1,0,3,2] row_mask:0xf bank_mask:0xf
    v_add_f32_dpp v25, v25, v25 quad_perm:[1,0,3,2] row_mask:0xf bank_mask:0xf
    s_nop 0
    v_add_f32_dpp v24, v24, v24 quad_perm:[2,3,0,1] row_mask:0xf bank_mask:0xf
    v_add_f32_dpp v25, v25, v25 quad_perm:[2,3,0,1] row_mask:0xf bank_mask:0xf
    s_nop 0
    v_add_f32_dpp v24, v24, v24 row_half_mirror row_mask:0xf bank_mask:0xf
    v_add_f32_dpp v25, v25, v25 row_half_mirror row_mask:0xf bank_mask:0xf
    s_nop 0
    v_add_f32_dpp v24, v24, v24 row_mirror row_mask:0xf bank_mask:0xf
    v_add_f32_dpp v25, v25, v25 row_mirror row_mask:0xf bank_mask:0xf
    v_mov_b32 v26, v24
    v_mov_b32 v27, v25
    s_nop 0
    v_permlane16_swap_b32 v24, v26
    v_permlane16_swap_b32 v25, v27
    v_add_f32 v24, v24, v26
    v_add_f32 v25, v25, v27
    v_mul_f32 v24, 0xbae38e39, v24
    v_mul_f32 v25, 0x3ae38e39, v25
    v_fma_f32 v25, -v24, v24, v25
    v_max_f32 v25, 0, v25
    v_add_f32 v25, 0x3727c5ac, v25
    v_rsq_f32 v26, v25
    s_nop 0
    v_mul_f32 v24, v24, v26
    v_pk_fma_f32 v[100:101], v[100:101], v[26:27], v[24:25] op_sel_hi:[1,0,0]
    v_cvt_pk_bf16_f32 v9, v100, v101
    v_pk_fma_f32 v[102:103], v[102:103], v[26:27], v[24:25] op_sel_hi:[1,0,0]
    v_cvt_pk_bf16_f32 v10, v102, v103
    ds_write2_b32 v227, v9, v10 offset0:0 offset1:32
    v_pk_fma_f32 v[104:105], v[104:105], v[26:27], v[24:25] op_sel_hi:[1,0,0]
    v_cvt_pk_bf16_f32 v11, v104, v105
    v_pk_fma_f32 v[106:107], v[106:107], v[26:27], v[24:25] op_sel_hi:[1,0,0]
    v_cvt_pk_bf16_f32 v12, v106, v107
    ds_write2_b32 v227, v11, v12 offset0:64 offset1:96
    v_pk_fma_f32 v[108:109], v[108:109], v[26:27], v[24:25] op_sel_hi:[1,0,0]
    v_cvt_pk_bf16_f32 v13, v108, v109
    v_pk_fma_f32 v[110:111], v[110:111], v[26:27], v[24:25] op_sel_hi:[1,0,0]
    v_cvt_pk_bf16_f32 v14, v110, v111
    ds_write2_b32 v227, v13, v14 offset0:128 offset1:160
    v_pk_fma_f32 v[112:113], v[112:113], v[26:27], v[24:25] op_sel_hi:[1,0,0]
    v_cvt_pk_bf16_f32 v15, v112, v113
    v_pk_fma_f32 v[114:115], v[114:115], v[26:27], v[24:25] op_sel_hi:[1,0,0]
    v_cvt_pk_bf16_f32 v16, v114, v115
    ds_write2_b32 v227, v15, v16 offset0:192 offset1:224
    v_pk_fma_f32 v[116:117], v[116:117], v[26:27], v[24:25] op_sel_hi:[1,0,0]
    v_cvt_pk_bf16_f32 v17, v116, v117
    ds_write_b32 v227, v17 offset:1024
    s_waitcnt lgkmcnt(0)
    s_barrier
    ds_read_b64_tr_b16 v[188:189], v229 offset:0
    ds_read_b64_tr_b16 v[190:191], v229 offset:4736
    ds_read_b64_tr_b16 v[192:193], v229 offset:512
    ds_read_b64_tr_b16 v[194:195], v229 offset:5248
    ds_read_b64_tr_b16 v[196:197], v229 offset:1024
    ds_read_b64_tr_b16 v[198:199], v229 offset:5760
    s_waitcnt lgkmcnt(4)
    buffer_store_dwordx4 v[188:191], v36, s[36:39], s48 offen sc1
    s_waitcnt lgkmcnt(2)
    buffer_store_dwordx4 v[192:195], v36, s[36:39], s49 offen sc1
    s_waitcnt lgkmcnt(0)
    s_cmp_lg_u32 s3, 0
    s_cbranch_scc1 L_m_20
    buffer_store_dwordx4 v[196:199], v36, s[36:39], s50 offen sc1
L_m_20:
    v_cvt_pk_bf16_f32 v9, v236, v237
    v_cvt_pk_bf16_f32 v10, v238, v239
    v_cvt_pk_bf16_f32 v11, v240, v241
    v_cvt_pk_bf16_f32 v12, v242, v243
    v_cvt_pk_bf16_f32 v13, v244, v245
    v_cvt_pk_bf16_f32 v14, v246, v247
    v_cvt_pk_bf16_f32 v15, v248, v249
    v_cvt_pk_bf16_f32 v16, v250, v251
    v_cvt_pk_bf16_f32 v17, v252, v253
    ds_write2_b32 v231, v9, v10 offset0:0 offset1:32
    ds_write2_b32 v231, v11, v12 offset0:64 offset1:96
    ds_write2_b32 v231, v13, v14 offset0:128 offset1:160
    ds_write2_b32 v231, v15, v16 offset0:192 offset1:224
    ds_write_b32 v231, v17 offset:1024
    s_waitcnt lgkmcnt(0)
    s_barrier
    s_cmp_ge_u32 s5, 27
    s_cbranch_scc1 L_m_21
    v_lshrrev_b32 v10, 2, v0
    v_and_b32 v11, 7, v10
    s_lshl_b32 s59, s3, 1
    s_add_u32 s59, s59, 0
    v_xor_b32 v11, s59, v11
    v_xor_b32 v12, 1, v11
    v_and_b32 v13, 3, v0
    v_lshlrev_b32 v13, 3, v13
    v_lshl_add_u32 v10, v10, 8, v13
    v_lshl_add_u32 v20, v11, 5, v10
    v_lshl_add_u32 v21, v12, 5, v10
    v_add_u32 v24, 0, v20
    v_add_u32 v25, 0, v21
    ds_read_b64_tr_b16 v[92:93], v24 offset:0
    ds_read_b64_tr_b16 v[94:95], v24 offset:4096
    ds_read_b64_tr_b16 v[96:97], v25 offset:0
    ds_read_b64_tr_b16 v[98:99], v25 offset:4096
    ds_read_b64_tr_b16 v[100:101], v24 offset:8192
    ds_read_b64_tr_b16 v[102:103], v24 offset:12288
    ds_read_b64_tr_b16 v[104:105], v25 offset:8192
    ds_read_b64_tr_b16 v[106:107], v25 offset:12288
    ds_read_b64_tr_b16 v[108:109], v24 offset:16384
    ds_read_b64_tr_b16 v[110:111], v24 offset:20480
    ds_read_b64_tr_b16 v[112:113], v25 offset:16384
    ds_read_b64_tr_b16 v[114:115], v25 offset:20480
    ds_read_b64_tr_b16 v[116:117], v24 offset:24576
    ds_read_b64_tr_b16 v[118:119], v24 offset:28672
    ds_read_b64_tr_b16 v[120:121], v25 offset:24576
    ds_read_b64_tr_b16 v[122:123], v25 offset:28672
    ds_read_b64_tr_b16 v[124:125], v24 offset:32768
    ds_read_b64_tr_b16 v[126:127], v24 offset:36864
    ds_read_b64_tr_b16 v[128:129], v25 offset:32768
    ds_read_b64_tr_b16 v[130:131], v25 offset:36864
    ds_read_b64_tr_b16 v[132:133], v24 offset:40960
    ds_read_b64_tr_b16 v[134:135], v24 offset:45056
    ds_read_b64_tr_b16 v[136:137], v25 offset:40960
    ds_read_b64_tr_b16 v[138:139], v25 offset:45056
    v_add_u32 v24, 49152, v20
    v_add_u32 v25, 49152, v21
    ds_read_b64_tr_b16 v[140:141], v24 offset:0
    ds_read_b64_tr_b16 v[142:143], v24 offset:4096
    ds_read_b64_tr_b16 v[144:145], v25 offset:0
    ds_read_b64_tr_b16 v[146:147], v25 offset:4096
    ds_read_b64_tr_b16 v[148:149], v24 offset:8192
    ds_read_b64_tr_b16 v[150:151], v24 offset:12288
    ds_read_b64_tr_b16 v[152:153], v25 offset:8192
    ds_read_b64_tr_b16 v[154:155], v25 offset:12288
    ds_read_b64_tr_b16 v[156:157], v24 offset:16384
    ds_read_b64_tr_b16 v[158:159], v24 offset:20480
    ds_read_b64_tr_b16 v[160:161], v25 offset:16384
    ds_read_b64_tr_b16 v[162:163], v25 offset:20480
    ds_read_b64_tr_b16 v[164:165], v24 offset:24576
    ds_read_b64_tr_b16 v[166:167], v24 offset:28672
    ds_read_b64_tr_b16 v[168:169], v25 offset:24576
    ds_read_b64_tr_b16 v[170:171], v25 offset:28672
    ds_read_b64_tr_b16 v[172:173], v24 offset:32768
    ds_read_b64_tr_b16 v[174:175], v24 offset:36864
    ds_read_b64_tr_b16 v[176:177], v25 offset:32768
    ds_read_b64_tr_b16 v[178:179], v25 offset:36864
    ds_read_b64_tr_b16 v[180:181], v24 offset:40960
    ds_read_b64_tr_b16 v[182:183], v24 offset:45056
    ds_read_b64_tr_b16 v[184:185], v25 offset:40960
    ds_read_b64_tr_b16 v[186:187], v25 offset:45056
    s_waitcnt vmcnt(0) lgkmcnt(0)
    s_barrier
    v_mul_u32_u24 v18, 1536, v2
    v_lshl_add_u32 v18, v1, 4, v18
    v_add_u32 v18, 98304, v18
    v_lshlrev_b32 v204, 16, v4
    v_and_b32 v205, 0xffff0000, v4
    v_lshlrev_b32 v206, 16, v5
    v_and_b32 v207, 0xffff0000, v5
    v_lshlrev_b32 v208, 16, v6
    v_and_b32 v209, 0xffff0000, v6
    v_lshlrev_b32 v210, 16, v7
    v_and_b32 v211, 0xffff0000, v7
    v_mov_b64 v[212:213], v[204:205]
    v_mov_b64 v[214:215], v[206:207]
    v_mov_b64 v[216:217], v[208:209]
    v_mov_b64 v[218:219], v[210:211]
    v_mov_b64 v[220:221], v[204:205]
    v_mov_b64 v[222:223], v[206:207]
    v_mov_b64 v[224:225], v[208:209]
    v_mov_b64 v[226:227], v[210:211]
    v_mov_b64 v[228:229], v[204:205]
    v_mov_b64 v[230:231], v[206:207]
    v_mov_b64 v[232:233], v[208:209]
    v_mov_b64 v[234:235], v[210:211]
    v_mov_b64 v[236:237], v[204:205]
    v_mov_b64 v[238:239], v[206:207]
    v_mov_b64 v[240:241], v[208:209]
    v_mov_b64 v[242:243], v[210:211]
    v_mov_b64 v[244:245], v[204:205]
    v_mov_b64 v[246:247], v[206:207]
    v_mov_b64 v[248:249], v[208:209]
    v_mov_b64 v[250:251], v[210:211]
    s_barrier
    v_add_u32 v24, 0, v20
    v_add_u32 v25, 0, v21
    ds_read_b64_tr_b16 v[188:189], v24 offset:0
    ds_read_b64_tr_b16 v[190:191], v24 offset:4096
    ds_read_b64_tr_b16 v[192:193], v25 offset:0
    ds_read_b64_tr_b16 v[194:195], v25 offset:4096
    ds_read_b64_tr_b16 v[196:197], v24 offset:8192
    ds_read_b64_tr_b16 v[198:199], v24 offset:12288
    ds_read_b64_tr_b16 v[200:201], v25 offset:8192
    ds_read_b64_tr_b16 v[202:203], v25 offset:12288
    ds_read_b64_tr_b16 v[52:53], v24 offset:16384
    ds_read_b64_tr_b16 v[54:55], v24 offset:20480
    ds_read_b64_tr_b16 v[56:57], v25 offset:16384
    ds_read_b64_tr_b16 v[58:59], v25 offset:20480
    ds_read_b64_tr_b16 v[60:61], v24 offset:24576
    ds_read_b64_tr_b16 v[62:63], v24 offset:28672
    ds_read_b64_tr_b16 v[64:65], v25 offset:24576
    ds_read_b64_tr_b16 v[66:67], v25 offset:28672
    s_waitcnt lgkmcnt(0)
    s_barrier
    s_branch L_stub_3
L_back_c2:
    v_add_u32 v24, 49152, v20
    v_add_u32 v25, 49152, v21
    s_barrier
    ds_read_b64_tr_b16 v[76:77], v20 offset:32768
    ds_read_b128 v[28:31], v18 offset:0
    ds_read_b64_tr_b16 v[78:79], v20 offset:36864
    ds_read_b128 v[32:35], v18 offset:256
    ds_read_b64_tr_b16 v[80:81], v21 offset:32768
    ds_read_b128 v[36:39], v18 offset:512
    ds_read_b64_tr_b16 v[82:83], v21 offset:36864
    ds_read_b128 v[40:43], v18 offset:768
    ds_read_b128 v[44:47], v18 offset:1024
    ds_read_b128 v[48:51], v18 offset:1280
    s_waitcnt lgkmcnt(7)
    v_mfma_f32_16x16x32_bf16 v[204:207], v[76:79], v[28:31], v[204:207]
    ds_read_b64_tr_b16 v[84:85], v20 offset:40960
    s_waitcnt lgkmcnt(4)
    v_mfma_f32_16x16x32_bf16 v[208:211], v[80:83], v[28:31], v[208:211]
    ds_read_b128 v[28:31], v18 offset:6144
    v_mfma_f32_16x16x32_bf16 v[212:215], v[76:79], v[32:35], v[212:215]
    ds_read_b64_tr_b16 v[86:87], v20 offset:45056
    v_mfma_f32_16x16x32_bf16 v[216:219], v[80:83], v[32:35], v[216:219]
    ds_read_b128 v[32:35], v18 offset:6400
    v_mfma_f32_16x16x32_bf16 v[220:223], v[76:79], v[36:39], v[220:223]
    ds_read_b64_tr_b16 v[88:89], v21 offset:40960
    v_mfma_f32_16x16x32_bf16 v[224:227], v[80:83], v[36:39], v[224:227]
    ds_read_b128 v[36:39], v18 offset:6656
    s_waitcnt lgkmcnt(8)
    v_mfma_f32_16x16x32_bf16 v[228:231], v[76:79], v[40:43], v[228:231]
    ds_read_b64_tr_b16 v[90:91], v21 offset:45056
    v_mfma_f32_16x16x32_bf16 v[232:235], v[80:83], v[40:43], v[232:235]
    ds_read_b128 v[40:43], v18 offset:6912
    s_waitcnt lgkmcnt(9)
    v_mfma_f32_16x16x32_bf16 v[236:239], v[76:79], v[44:47], v[236:239]
    v_mfma_f32_16x16x32_bf16 v[240:243], v[80:83], v[44:47], v[240:243]
    ds_read_b128 v[44:47], v18 offset:7168
    s_waitcnt lgkmcnt(9)
    v_mfma_f32_16x16x32_bf16 v[244:247], v[76:79], v[48:51], v[244:247]
    v_mfma_f32_16x16x32_bf16 v[248:251], v[80:83], v[48:51], v[248:251]
    ds_read_b128 v[48:51], v18 offset:7424
    s_waitcnt lgkmcnt(3)
    v_mfma_f32_16x16x32_bf16 v[204:207], v[84:87], v[28:31], v[204:207]
    s_barrier
    ds_read_b64_tr_b16 v[76:77], v24 offset:0
    v_mfma_f32_16x16x32_bf16 v[208:211], v[88:91], v[28:31], v[208:211]
    ds_read_b128 v[28:31], v18 offset:12288
    v_mfma_f32_16x16x32_bf16 v[212:215], v[84:87], v[32:35], v[212:215]
    ds_read_b64_tr_b16 v[78:79], v24 offset:4096
    v_mfma_f32_16x16x32_bf16 v[216:219], v[88:91], v[32:35], v[216:219]
    ds_read_b128 v[32:35], v18 offset:12544
    v_mfma_f32_16x16x32_bf16 v[220:223], v[84:87], v[36:39], v[220:223]
    ds_read_b64_tr_b16 v[80:81], v25 offset:0
    v_mfma_f32_16x16x32_bf16 v[224:227], v[88:91], v[36:39], v[224:227]
    ds_read_b128 v[36:39], v18 offset:12800
    s_waitcnt lgkmcnt(8)
    v_mfma_f32_16x16x32_bf16 v[228:231], v[84:87], v[40:43], v[228:231]
    ds_read_b64_tr_b16 v[82:83], v25 offset:4096
    v_mfma_f32_16x16x32_bf16 v[232:235], v[88:91], v[40:43], v[232:235]
    ds_read_b128 v[40:43], v18 offset:13056
    s_waitcnt lgkmcnt(9)
    v_mfma_f32_16x16x32_bf16 v[236:239], v[84:87], v[44:47], v[236:239]
    v_mfma_f32_16x16x32_bf16 v[240:243], v[88:91], v[44:47], v[240:243]
    ds_read_b128 v[44:47], v18 offset:13312
    s_waitcnt lgkmcnt(9)
    v_mfma_f32_16x16x32_bf16 v[244:247], v[84:87], v[48:51], v[244:247]
    v_mfma_f32_16x16x32_bf16 v[248:251], v[88:91], v[48:51], v[248:251]
    ds_read_b128 v[48:51], v18 offset:13568
    s_waitcnt lgkmcnt(3)
    v_mfma_f32_16x16x32_bf16 v[204:207], v[76:79], v[28:31], v[204:207]
    ds_read_b64_tr_b16 v[84:85], v24 offset:8192
    v_mfma_f32_16x16x32_bf16 v[208:211], v[80:83], v[28:31], v[208:211]
    ds_read_b128 v[28:31], v18 offset:18432
    v_mfma_f32_16x16x32_bf16 v[212:215], v[76:79], v[32:35], v[212:215]
    ds_read_b64_tr_b16 v[86:87], v24 offset:12288
    v_mfma_f32_16x16x32_bf16 v[216:219], v[80:83], v[32:35], v[216:219]
    ds_read_b128 v[32:35], v18 offset:18688
    v_mfma_f32_16x16x32_bf16 v[220:223], v[76:79], v[36:39], v[220:223]
    ds_read_b64_tr_b16 v[88:89], v25 offset:8192
    v_mfma_f32_16x16x32_bf16 v[224:227], v[80:83], v[36:39], v[224:227]
    ds_read_b128 v[36:39], v18 offset:18944
    s_waitcnt lgkmcnt(8)
    v_mfma_f32_16x16x32_bf16 v[228:231], v[76:79], v[40:43], v[228:231]
    ds_read_b64_tr_b16 v[90:91], v25 offset:12288
    v_mfma_f32_16x16x32_bf16 v[232:235], v[80:83], v[40:43], v[232:235]
    ds_read_b128 v[40:43], v18 offset:19200
    s_waitcnt lgkmcnt(9)
    v_mfma_f32_16x16x32_bf16 v[236:239], v[76:79], v[44:47], v[236:239]
    v_mfma_f32_16x16x32_bf16 v[240:243], v[80:83], v[44:47], v[240:243]
    ds_read_b128 v[44:47], v18 offset:19456
    s_waitcnt lgkmcnt(9)
    v_mfma_f32_16x16x32_bf16 v[244:247], v[76:79], v[48:51], v[244:247]
    v_mfma_f32_16x16x32_bf16 v[248:251], v[80:83], v[48:51], v[248:251]
    ds_read_b128 v[48:51], v18 offset:19712
    s_waitcnt lgkmcnt(3)
    v_mfma_f32_16x16x32_bf16 v[204:207], v[84:87], v[28:31], v[204:207]
    s_barrier
    ds_read_b64_tr_b16 v[76:77], v24 offset:16384
    v_mfma_f32_16x16x32_bf16 v[208:211], v[88:91], v[28:31], v[208:211]
    ds_read_b128 v[28:31], v18 offset:24576
    v_mfma_f32_16x16x32_bf16 v[212:215], v[84:87], v[32:35], v[212:215]
    ds_read_b64_tr_b16 v[78:79], v24 offset:20480
    v_mfma_f32_16x16x32_bf16 v[216:219], v[88:91], v[32:35], v[216:219]
    ds_read_b128 v[32:35], v18 offset:24832
    v_mfma_f32_16x16x32_bf16 v[220:223], v[84:87], v[36:39], v[220:223]
    ds_read_b64_tr_b16 v[80:81], v25 offset:16384
    v_mfma_f32_16x16x32_bf16 v[224:227], v[88:91], v[36:39], v[224:227]
    ds_read_b128 v[36:39], v18 offset:25088
    s_waitcnt lgkmcnt(8)
    v_mfma_f32_16x16x32_bf16 v[228:231], v[84:87], v[40:43], v[228:231]
    ds_read_b64_tr_b16 v[82:83], v25 offset:20480
    v_mfma_f32_16x16x32_bf16 v[232:235], v[88:91], v[40:43], v[232:235]
    ds_read_b128 v[40:43], v18 offset:25344
    s_waitcnt lgkmcnt(9)
    v_mfma_f32_16x16x32_bf16 v[236:239], v[84:87], v[44:47], v[236:239]
    v_mfma_f32_16x16x32_bf16 v[240:243], v[88:91], v[44:47], v[240:243]
    ds_read_b128 v[44:47], v18 offset:25600
    s_waitcnt lgkmcnt(9)
    v_mfma_f32_16x16x32_bf16 v[244:247], v[84:87], v[48:51], v[244:247]
    v_mfma_f32_16x16x32_bf16 v[248:251], v[88:91], v[48:51], v[248:251]
    ds_read_b128 v[48:51], v18 offset:25856
    s_waitcnt lgkmcnt(3)
    v_mfma_f32_16x16x32_bf16 v[204:207], v[76:79], v[28:31], v[204:207]
    ds_read_b64_tr_b16 v[84:85], v24 offset:24576
    v_mfma_f32_16x16x32_bf16 v[208:211], v[80:83], v[28:31], v[208:211]
    ds_read_b128 v[28:31], v18 offset:30720
    v_mfma_f32_16x16x32_bf16 v[212:215], v[76:79], v[32:35], v[212:215]
    ds_read_b64_tr_b16 v[86:87], v24 offset:28672
    v_mfma_f32_16x16x32_bf16 v[216:219], v[80:83], v[32:35], v[216:219]
    s_branch L_skip_3
    s_nop 0
L_stub_3:
    s_branch L_stub_4
L_skip_3:
    ds_read_b128 v[32:35], v18 offset:30976
    v_mfma_f32_16x16x32_bf16 v[220:223], v[76:79], v[36:39], v[220:223]
    ds_read_b64_tr_b16 v[88:89], v25 offset:24576
    v_mfma_f32_16x16x32_bf16 v[224:227], v[80:83], v[36:39], v[224:227]
    ds_read_b128 v[36:39], v18 offset:31232
    s_waitcnt lgkmcnt(8)
    v_mfma_f32_16x16x32_bf16 v[228:231], v[76:79], v[40:43], v[228:231]
    ds_read_b64_tr_b16 v[90:91], v25 offset:28672
    v_mfma_f32_16x16x32_bf16 v[232:235], v[80:83], v[40:43], v[232:235]
    ds_read_b128 v[40:43], v18 offset:31488
    s_waitcnt lgkmcnt(9)
    v_mfma_f32_16x16x32_bf16 v[236:239], v[76:79], v[44:47], v[236:239]
    v_mfma_f32_16x16x32_bf16 v[240:243], v[80:83], v[44:47], v[240:243]
    ds_read_b128 v[44:47], v18 offset:31744
    s_waitcnt lgkmcnt(9)
    v_mfma_f32_16x16x32_bf16 v[244:247], v[76:79], v[48:51], v[244:247]
    v_mfma_f32_16x16x32_bf16 v[248:251], v[80:83], v[48:51], v[248:251]
    ds_read_b128 v[48:51], v18 offset:32000
    s_waitcnt lgkmcnt(3)
    v_mfma_f32_16x16x32_bf16 v[204:207], v[84:87], v[28:31], v[204:207]
    s_barrier
    ds_read_b64_tr_b16 v[76:77], v24 offset:32768
    v_mfma_f32_16x16x32_bf16 v[208:211], v[88:91], v[28:31], v[208:211]
    ds_read_b128 v[28:31], v18 offset:36864
    v_mfma_f32_16x16x32_bf16 v[212:215], v[84:87], v[32:35], v[212:215]
    ds_read_b64_tr_b16 v[78:79], v24 offset:36864
    v_mfma_f32_16x16x32_bf16 v[216:219], v[88:91], v[32:35], v[216:219]
    ds_read_b128 v[32:35], v18 offset:37120
    v_mfma_f32_16x16x32_bf16 v[220:223], v[84:87], v[36:39], v[220:223]
    ds_read_b64_tr_b16 v[80:81], v25 offset:32768
    v_mfma_f32_16x16x32_bf16 v[224:227], v[88:91], v[36:39], v[224:227]
    ds_read_b128 v[36:39], v18 offset:37376
    s_waitcnt lgkmcnt(8)
    v_mfma_f32_16x16x32_bf16 v[228:231], v[84:87], v[40:43], v[228:231]
    ds_read_b64_tr_b16 v[82:83], v25 offset:36864
    v_mfma_f32_16x16x32_bf16 v[232:235], v[88:91], v[40:43], v[232:235]
    ds_read_b128 v[40:43], v18 offset:37632
    s_waitcnt lgkmcnt(9)
    v_mfma_f32_16x16x32_bf16 v[236:239], v[84:87], v[44:47], v[236:239]
    v_mfma_f32_16x16x32_bf16 v[240:243], v[88:91], v[44:47], v[240:243]
    ds_read_b128 v[44:47], v18 offset:37888
    s_waitcnt lgkmcnt(9)
    v_mfma_f32_16x16x32_bf16 v[244:247], v[84:87], v[48:51], v[244:247]
    v_mfma_f32_16x16x32_bf16 v[248:251], v[88:91], v[48:51], v[248:251]
    ds_read_b128 v[48:51], v18 offset:38144
    s_waitcnt lgkmcnt(3)
    v_mfma_f32_16x16x32_bf16 v[204:207], v[76:79], v[28:31], v[204:207]
    ds_read_b64_tr_b16 v[84:85], v24 offset:40960
    v_mfma_f32_16x16x32_bf16 v[208:211], v[80:83], v[28:31], v[208:211]
    ds_read_b128 v[28:31], v18 offset:43008
    v_mfma_f32_16x16x32_bf16 v[212:215], v[76:79], v[32:35], v[212:215]
    ds_read_b64_tr_b16 v[86:87], v24 offset:45056
    v_mfma_f32_16x16x32_bf16 v[216:219], v[80:83], v[32:35], v[216:219]
    ds_read_b128 v[32:35], v18 offset:43264
    v_mfma_f32_16x16x32_bf16 v[220:223], v[76:79], v[36:39], v[220:223]
    ds_read_b64_tr_b16 v[88:89], v25 offset:40960
    v_mfma_f32_16x16x32_bf16 v[224:227], v[80:83], v[36:39], v[224:227]
    ds_read_b128 v[36:39], v18 offset:43520
    s_waitcnt lgkmcnt(8)
    v_mfma_f32_16x16x32_bf16 v[228:231], v[76:79], v[40:43], v[228:231]
    ds_read_b64_tr_b16 v[90:91], v25 offset:45056
    v_mfma_f32_16x16x32_bf16 v[232:235], v[80:83], v[40:43], v[232:235]
    ds_read_b128 v[40:43], v18 offset:43776
    s_waitcnt lgkmcnt(9)
    v_mfma_f32_16x16x32_bf16 v[236:239], v[76:79], v[44:47], v[236:239]
    v_mfma_f32_16x16x32_bf16 v[240:243], v[80:83], v[44:47], v[240:243]
    ds_read_b128 v[44:47], v18 offset:44032
    s_waitcnt lgkmcnt(9)
    v_mfma_f32_16x16x32_bf16 v[244:247], v[76:79], v[48:51], v[244:247]
    v_mfma_f32_16x16x32_bf16 v[248:251], v[80:83], v[48:51], v[248:251]
    ds_read_b128 v[48:51], v18 offset:44288
    s_waitcnt lgkmcnt(3)
    v_mfma_f32_16x16x32_bf16 v[204:207], v[84:87], v[28:31], v[204:207]
    s_barrier
    ds_read_b64_tr_b16 v[76:77], v20 offset:0
    v_mfma_f32_16x16x32_bf16 v[208:211], v[88:91], v[28:31], v[208:211]
    ds_read_b128 v[28:31], v18 offset:49152
    v_mfma_f32_16x16x32_bf16 v[212:215], v[84:87], v[32:35], v[212:215]
    ds_read_b64_tr_b16 v[78:79], v20 offset:4096
    v_mfma_f32_16x16x32_bf16 v[216:219], v[88:91], v[32:35], v[216:219]
    ds_read_b128 v[32:35], v18 offset:49408
    v_mfma_f32_16x16x32_bf16 v[220:223], v[84:87], v[36:39], v[220:223]
    ds_read_b64_tr_b16 v[80:81], v21 offset:0
    v_mfma_f32_16x16x32_bf16 v[224:227], v[88:91], v[36:39], v[224:227]
    ds_read_b128 v[36:39], v18 offset:49664
    s_waitcnt lgkmcnt(8)
    v_mfma_f32_16x16x32_bf16 v[228:231], v[84:87], v[40:43], v[228:231]
    ds_read_b64_tr_b16 v[82:83], v21 offset:4096
    v_mfma_f32_16x16x32_bf16 v[232:235], v[88:91], v[40:43], v[232:235]
    ds_read_b128 v[40:43], v18 offset:49920
    s_waitcnt lgkmcnt(9)
    v_mfma_f32_16x16x32_bf16 v[236:239], v[84:87], v[44:47], v[236:239]
    v_mfma_f32_16x16x32_bf16 v[240:243], v[88:91], v[44:47], v[240:243]
    ds_read_b128 v[44:47], v18 offset:50176
    s_waitcnt lgkmcnt(9)
    v_mfma_f32_16x16x32_bf16 v[244:247], v[84:87], v[48:51], v[244:247]
    v_mfma_f32_16x16x32_bf16 v[248:251], v[88:91], v[48:51], v[248:251]
    ds_read_b128 v[48:51], v18 offset:50432
    s_waitcnt lgkmcnt(3)
    v_mfma_f32_16x16x32_bf16 v[204:207], v[76:79], v[28:31], v[204:207]
    ds_read_b64_tr_b16 v[84:85], v20 offset:8192
    v_mfma_f32_16x16x32_bf16 v[208:211], v[80:83], v[28:31], v[208:211]
    ds_read_b128 v[28:31], v18 offset:55296
    v_mfma_f32_16x16x32_bf16 v[212:215], v[76:79], v[32:35], v[212:215]
    ds_read_b64_tr_b16 v[86:87], v20 offset:12288
    v_mfma_f32_16x16x32_bf16 v[216:219], v[80:83], v[32:35], v[216:219]
    ds_read_b128 v[32:35], v18 offset:55552
    v_mfma_f32_16x16x32_bf16 v[220:223], v[76:79], v[36:39], v[220:223]
    ds_read_b64_tr_b16 v[88:89], v21 offset:8192
    v_mfma_f32_16x16x32_bf16 v[224:227], v[80:83], v[36:39], v[224:227]
    ds_read_b128 v[36:39], v18 offset:55808
    s_waitcnt lgkmcnt(8)
    v_mfma_f32_16x16x32_bf16 v[228:231], v[76:79], v[40:43], v[228:231]
    ds_read_b64_tr_b16 v[90:91], v21 offset:12288
    v_mfma_f32_16x16x32_bf16 v[232:235], v[80:83], v[40:43], v[232:235]
    ds_read_b128 v[40:43], v18 offset:56064
    s_waitcnt lgkmcnt(9)
    v_mfma_f32_16x16x32_bf16 v[236:239], v[76:79], v[44:47], v[236:239]
    v_mfma_f32_16x16x32_bf16 v[240:243], v[80:83], v[44:47], v[240:243]
    ds_read_b128 v[44:47], v18 offset:56320
    s_waitcnt lgkmcnt(9)
    v_mfma_f32_16x16x32_bf16 v[244:247], v[76:79], v[48:51], v[244:247]
    v_mfma_f32_16x16x32_bf16 v[248:251], v[80:83], v[48:51], v[248:251]
    ds_read_b128 v[48:51], v18 offset:56576
    s_waitcnt lgkmcnt(3)
    v_mfma_f32_16x16x32_bf16 v[204:207], v[84:87], v[28:31], v[204:207]
    s_barrier
    ds_read_b64_tr_b16 v[76:77], v20 offset:16384
    v_mfma_f32_16x16x32_bf16 v[208:211], v[88:91], v[28:31], v[208:211]
    ds_read_b128 v[28:31], v18 offset:0
    v_mfma_f32_16x16x32_bf16 v[212:215], v[84:87], v[32:35], v[212:215]
    ds_read_b64_tr_b16 v[78:79], v20 offset:20480
    v_mfma_f32_16x16x32_bf16 v[216:219], v[88:91], v[32:35], v[216:219]
    ds_read_b128 v[32:35], v18 offset:256
    v_mfma_f32_16x16x32_bf16 v[220:223], v[84:87], v[36:39], v[220:223]
    ds_read_b64_tr_b16 v[80:81], v21 offset:16384
    v_mfma_f32_16x16x32_bf16 v[224:227], v[88:91], v[36:39], v[224:227]
    ds_read_b128 v[36:39], v18 offset:512
    s_waitcnt lgkmcnt(8)
    v_mfma_f32_16x16x32_bf16 v[228:231], v[84:87], v[40:43], v[228:231]
    ds_read_b64_tr_b16 v[82:83], v21 offset:20480
    v_mfma_f32_16x16x32_bf16 v[232:235], v[88:91], v[40:43], v[232:235]
    ds_read_b128 v[40:43], v18 offset:768
    s_waitcnt lgkmcnt(9)
    v_mfma_f32_16x16x32_bf16 v[236:239], v[84:87], v[44:47], v[236:239]
    v_mfma_f32_16x16x32_bf16 v[240:243], v[88:91], v[44:47], v[240:243]
    ds_read_b128 v[44:47], v18 offset:1024
    s_waitcnt lgkmcnt(9)
    v_mfma_f32_16x16x32_bf16 v[244:247], v[84:87], v[48:51], v[244:247]
    v_mfma_f32_16x16x32_bf16 v[248:251], v[88:91], v[48:51], v[248:251]
    ds_read_b128 v[48:51], v18 offset:1280
    s_waitcnt lgkmcnt(3)
    v_mfma_f32_16x16x32_bf16 v[204:207], v[76:79], v[28:31], v[204:207]
    ds_read_b64_tr_b16 v[84:85], v20 offset:24576
    v_mfma_f32_16x16x32_bf16 v[208:211], v[80:83], v[28:31], v[208:211]
    ds_read_b128 v[28:31], v18 offset:6144
    v_mfma_f32_16x16x32_bf16 v[212:215], v[76:79], v[32:35], v[212:215]
    ds_read_b64_tr_b16 v[86:87], v20 offset:28672
    v_mfma_f32_16x16x32_bf16 v[216:219], v[80:83], v[32:35], v[216:219]
    ds_read_b128 v[32:35], v18 offset:6400
    v_mfma_f32_16x16x32_bf16 v[220:223], v[76:79], v[36:39], v[220:223]
    ds_read_b64_tr_b16 v[88:89], v21 offset:24576
    v_mfma_f32_16x16x32_bf16 v[224:227], v[80:83], v[36:39], v[224:227]
    ds_read_b128 v[36:39], v18 offset:6656
    s_waitcnt lgkmcnt(8)
    v_mfma_f32_16x16x32_bf16 v[228:231], v[76:79], v[40:43], v[228:231]
    ds_read_b64_tr_b16 v[90:91], v21 offset:28672
    v_mfma_f32_16x16x32_bf16 v[232:235], v[80:83], v[40:43], v[232:235]
    ds_read_b128 v[40:43], v18 offset:6912
    s_waitcnt lgkmcnt(9)
    v_mfma_f32_16x16x32_bf16 v[236:239], v[76:79], v[44:47], v[236:239]
    v_mfma_f32_16x16x32_bf16 v[240:243], v[80:83], v[44:47], v[240:243]
    ds_read_b128 v[44:47], v18 offset:7168
    s_waitcnt lgkmcnt(9)
    v_mfma_f32_16x16x32_bf16 v[244:247], v[76:79], v[48:51], v[244:247]
    v_mfma_f32_16x16x32_bf16 v[248:251], v[80:83], v[48:51], v[248:251]
    ds_read_b128 v[48:51], v18 offset:7424
    s_waitcnt lgkmcnt(3)
    v_mfma_f32_16x16x32_bf16 v[204:207], v[84:87], v[28:31], v[204:207]
    s_barrier
    v_mfma_f32_16x16x32_bf16 v[208:211], v[88:91], v[28:31], v[208:211]
    ds_read_b128 v[28:31], v18 offset:12288
    v_mfma_f32_16x16x32_bf16 v[212:215], v[84:87], v[32:35], v[212:215]
    v_mfma_f32_16x16x32_bf16 v[216:219], v[88:91], v[32:35], v[216:219]
    ds_read_b128 v[32:35], v18 offset:12544
    v_mfma_f32_16x16x32_bf16 v[220:223], v[84:87], v[36:39], v[220:223]
    v_mfma_f32_16x16x32_bf16 v[224:227], v[88:91], v[36:39], v[224:227]
    ds_read_b128 v[36:39], v18 offset:12800
    s_waitcnt lgkmcnt(5)
    v_mfma_f32_16x16x32_bf16 v[228:231], v[84:87], v[40:43], v[228:231]
    v_mfma_f32_16x16x32_bf16 v[232:235], v[88:91], v[40:43], v[232:235]
    ds_read_b128 v[40:43], v18 offset:13056
    s_waitcnt lgkmcnt(5)
    v_mfma_f32_16x16x32_bf16 v[236:239], v[84:87], v[44:47], v[236:239]
    v_mfma_f32_16x16x32_bf16 v[240:243], v[88:91], v[44:47], v[240:243]
    ds_read_b128 v[44:47], v18 offset:13312
    s_waitcnt lgkmcnt(5)
    v_mfma_f32_16x16x32_bf16 v[244:247], v[84:87], v[48:51], v[244:247]
    v_mfma_f32_16x16x32_bf16 v[248:251], v[88:91], v[48:51], v[248:251]
    ds_read_b128 v[48:51], v18 offset:13568
    s_waitcnt lgkmcnt(3)
    v_mfma_f32_16x16x32_bf16 v[204:207], v[92:95], v[28:31], v[204:207]
    v_mfma_f32_16x16x32_bf16 v[208:211], v[96:99], v[28:31], v[208:211]
    ds_read_b128 v[28:31], v18 offset:18432
    v_mfma_f32_16x16x32_bf16 v[212:215], v[92:95], v[32:35], v[212:215]
    v_mfma_f32_16x16x32_bf16 v[216:219], v[96:99], v[32:35], v[216:219]
    ds_read_b128 v[32:35], v18 offset:18688
    v_mfma_f32_16x16x32_bf16 v[220:223], v[92:95], v[36:39], v[220:223]
    v_mfma_f32_16x16x32_bf16 v[224:227], v[96:99], v[36:39], v[224:227]
    ds_read_b128 v[36:39], v18 offset:18944
    s_waitcnt lgkmcnt(5)
    v_mfma_f32_16x16x32_bf16 v[228:231], v[92:95], v[40:43], v[228:231]
    v_mfma_f32_16x16x32_bf16 v[232:235], v[96:99], v[40:43], v[232:235]
    ds_read_b128 v[40:43], v18 offset:19200
    s_waitcnt lgkmcnt(5)
    v_mfma_f32_16x16x32_bf16 v[236:239], v[92:95], v[44:47], v[236:239]
    v_mfma_f32_16x16x32_bf16 v[240:243], v[96:99], v[44:47], v[240:243]
    ds_read_b128 v[44:47], v18 offset:19456
    s_waitcnt lgkmcnt(5)
    v_mfma_f32_16x16x32_bf16 v[244:247], v[92:95], v[48:51], v[244:247]
    v_mfma_f32_16x16x32_bf16 v[248:251], v[96:99], v[48:51], v[248:251]
    ds_read_b128 v[48:51], v18 offset:19712
    s_waitcnt lgkmcnt(3)
    v_mfma_f32_16x16x32_bf16 v[204:207], v[100:103], v[28:31], v[204:207]
    s_barrier
    ds_read_b64_tr_b16 v[76:77], v20 offset:32768
    v_mfma_f32_16x16x32_bf16 v[208:211], v[104:107], v[28:31], v[208:211]
    ds_read_b128 v[28:31], v18 offset:24576
    v_mfma_f32_16x16x32_bf16 v[212:215], v[100:103], v[32:35], v[212:215]
    ds_read_b64_tr_b16 v[78:79], v20 offset:36864
    v_mfma_f32_16x16x32_bf16 v[216:219], v[104:107], v[32:35], v[216:219]
    ds_read_b128 v[32:35], v18 offset:24832
    v_mfma_f32_16x16x32_bf16 v[220:223], v[100:103], v[36:39], v[220:223]
    ds_read_b64_tr_b16 v[80:81], v21 offset:32768
    v_mfma_f32_16x16x32_bf16 v[224:227], v[104:107], v[36:39], v[224:227]
    ds_read_b128 v[36:39], v18 offset:25088
    s_waitcnt lgkmcnt(8)
    v_mfma_f32_16x16x32_bf16 v[228:231], v[100:103], v[40:43], v[228:231]
    ds_read_b64_tr_b16 v[82:83], v21 offset:36864
    v_mfma_f32_16x16x32_bf16 v[232:235], v[104:107], v[40:43], v[232:235]
    ds_read_b128 v[40:43], v18 offset:25344
    s_waitcnt lgkmcnt(9)
    v_mfma_f32_16x16x32_bf16 v[236:239], v[100:103], v[44:47], v[236:239]
    v_mfma_f32_16x16x32_bf16 v[240:243], v[104:107], v[44:47], v[240:243]
    ds_read_b128 v[44:47], v18 offset:25600
    s_waitcnt lgkmcnt(9)
    v_mfma_f32_16x16x32_bf16 v[244:247], v[100:103], v[48:51], v[244:247]
    v_mfma_f32_16x16x32_bf16 v[248:251], v[104:107], v[48:51], v[248:251]
    ds_read_b128 v[48:51], v18 offset:25856
    s_waitcnt lgkmcnt(3)
    v_mfma_f32_16x16x32_bf16 v[204:207], v[76:79], v[28:31], v[204:207]
    ds_read_b64_tr_b16 v[84:85], v20 offset:40960
    v_mfma_f32_16x16x32_bf16 v[208:211], v[80:83], v[28:31], v[208:211]
    ds_read_b128 v[28:31], v18 offset:30720
    v_mfma_f32_16x16x32_bf16 v[212:215], v[76:79], v[32:35], v[212:215]
    ds_read_b64_tr_b16 v[86:87], v20 offset:45056
    v_mfma_f32_16x16x32_bf16 v[216:219], v[80:83], v[32:35], v[216:219]
    ds_read_b128 v[32:35], v18 offset:30976
    v_mfma_f32_16x16x32_bf16 v[220:223], v[76:79], v[36:39], v[220:223]
    ds_read_b64_tr_b16 v[88:89], v21 offset:40960
    v_mfma_f32_16x16x32_bf16 v[224:227], v[80:83], v[36:39], v[224:227]
    ds_read_b128 v[36:39], v18 offset:31232
    s_waitcnt lgkmcnt(8)
    v_mfma_f32_16x16x32_bf16 v[228:231], v[76:79], v[40:43], v[228:231]
    ds_read_b64_tr_b16 v[90:91], v21 offset:45056
    v_mfma_f32_16x16x32_bf16 v[232:235], v[80:83], v[40:43], v[232:235]
    ds_read_b128 v[40:43], v18 offset:31488
    s_waitcnt lgkmcnt(9)
    v_mfma_f32_16x16x32_bf16 v[236:239], v[76:79], v[44:47], v[236:239]
    v_mfma_f32_16x16x32_bf16 v[240:243], v[80:83], v[44:47], v[240:243]
    ds_read_b128 v[44:47], v18 offset:31744
    s_waitcnt lgkmcnt(9)
    v_mfma_f32_16x16x32_bf16 v[244:247], v[76:79], v[48:51], v[244:247]
    v_mfma_f32_16x16x32_bf16 v[248:251], v[80:83], v[48:51], v[248:251]
    ds_read_b128 v[48:51], v18 offset:32000
    s_waitcnt lgkmcnt(3)
    v_mfma_f32_16x16x32_bf16 v[204:207], v[84:87], v[28:31], v[204:207]
    s_barrier
    ds_read_b64_tr_b16 v[76:77], v24 offset:0
    v_mfma_f32_16x16x32_bf16 v[208:211], v[88:91], v[28:31], v[208:211]
    ds_read_b128 v[28:31], v18 offset:36864
    v_mfma_f32_16x16x32_bf16 v[212:215], v[84:87], v[32:35], v[212:215]
    ds_read_b64_tr_b16 v[78:79], v24 offset:4096
    v_mfma_f32_16x16x32_bf16 v[216:219], v[88:91], v[32:35], v[216:219]
    ds_read_b128 v[32:35], v18 offset:37120
    v_mfma_f32_16x16x32_bf16 v[220:223], v[84:87], v[36:39], v[220:223]
    ds_read_b64_tr_b16 v[80:81], v25 offset:0
    v_mfma_f32_16x16x32_bf16 v[224:227], v[88:91], v[36:39], v[224:227]
    ds_read_b128 v[36:39], v18 offset:37376
    s_waitcnt lgkmcnt(8)
    v_mfma_f32_16x16x32_bf16 v[228:231], v[84:87], v[40:43], v[228:231]
    ds_read_b64_tr_b16 v[82:83], v25 offset:4096
    v_mfma_f32_16x16x32_bf16 v[232:235], v[88:91], v[40:43], v[232:235]
    ds_read_b128 v[40:43], v18 offset:37632
    s_waitcnt lgkmcnt(9)
    v_mfma_f32_16x16x32_bf16 v[236:239], v[84:87], v[44:47], v[236:239]
    v_mfma_f32_16x16x32_bf16 v[240:243], v[88:91], v[44:47], v[240:243]
    ds_read_b128 v[44:47], v18 offset:37888
    s_waitcnt lgkmcnt(9)
    v_mfma_f32_16x16x32_bf16 v[244:247], v[84:87], v[48:51], v[244:247]
    v_mfma_f32_16x16x32_bf16 v[248:251], v[88:91], v[48:51], v[248:251]
    ds_read_b128 v[48:51], v18 offset:38144
    s_waitcnt lgkmcnt(3)
    v_mfma_f32_16x16x32_bf16 v[204:207], v[76:79], v[28:31], v[204:207]
    ds_read_b64_tr_b16 v[84:85], v24 offset:8192
    v_mfma_f32_16x16x32_bf16 v[208:211], v[80:83], v[28:31], v[208:211]
    ds_read_b128 v[28:31], v18 offset:43008
    v_mfma_f32_16x16x32_bf16 v[212:215], v[76:79], v[32:35], v[212:215]
    ds_read_b64_tr_b16 v[86:87], v24 offset:12288
    v_mfma_f32_16x16x32_bf16 v[216:219], v[80:83], v[32:35], v[216:219]
    ds_read_b128 v[32:35], v18 offset:43264
    v_mfma_f32_16x16x32_bf16 v[220:223], v[76:79], v[36:39], v[220:223]
    ds_read_b64_tr_b16 v[88:89], v25 offset:8192
    v_mfma_f32_16x16x32_bf16 v[224:227], v[80:83], v[36:39], v[224:227]
    ds_read_b128 v[36:39], v18 offset:43520
    s_waitcnt lgkmcnt(8)
    v_mfma_f32_16x16x32_bf16 v[228:231], v[76:79], v[40:43], v[228:231]
    ds_read_b64_tr_b16 v[90:91], v25 offset:12288
    v_mfma_f32_16x16x32_bf16 v[232:235], v[80:83], v[40:43], v[232:235]
    ds_read_b128 v[40:43], v18 offset:43776
    s_waitcnt lgkmcnt(9)
    v_mfma_f32_16x16x32_bf16 v[236:239], v[76:79], v[44:47], v[236:239]
    v_mfma_f32_16x16x32_bf16 v[240:243], v[80:83], v[44:47], v[240:243]
    ds_read_b128 v[44:47], v18 offset:44032
    s_waitcnt lgkmcnt(9)
    v_mfma_f32_16x16x32_bf16 v[244:247], v[76:79], v[48:51], v[244:247]
    v_mfma_f32_16x16x32_bf16 v[248:251], v[80:83], v[48:51], v[248:251]
    ds_read_b128 v[48:51], v18 offset:44288
    s_waitcnt lgkmcnt(3)
    v_mfma_f32_16x16x32_bf16 v[204:207], v[84:87], v[28:31], v[204:207]
    s_barrier
    v_mfma_f32_16x16x32_bf16 v[208:211], v[88:91], v[28:31], v[208:211]
    ds_read_b128 v[28:31], v18 offset:49152
    v_mfma_f32_16x16x32_bf16 v[212:215], v[84:87], v[32:35], v[212:215]
    v_mfma_f32_16x16x32_bf16 v[216:219], v[88:91], v[32:35], v[216:219]
    ds_read_b128 v[32:35], v18 offset:49408
    v_mfma_f32_16x16x32_bf16 v[220:223], v[84:87], v[36:39], v[220:223]
    v_mfma_f32_16x16x32_bf16 v[224:227], v[88:91], v[36:39], v[224:227]
    ds_read_b128 v[36:39], v18 offset:49664
    s_waitcnt lgkmcnt(5)
    v_mfma_f32_16x16x32_bf16 v[228:231], v[84:87], v[40:43], v[228:231]
    v_mfma_f32_16x16x32_bf16 v[232:235], v[88:91], v[40:43], v[232:235]
    ds_read_b128 v[40:43], v18 offset:49920
    s_waitcnt lgkmcnt(5)
    v_mfma_f32_16x16x32_bf16 v[236:239], v[84:87], v[44:47], v[236:239]
    v_mfma_f32_16x16x32_bf16 v[240:243], v[88:91], v[44:47], v[240:243]
    ds_read_b128 v[44:47], v18 offset:50176
    s_waitcnt lgkmcnt(5)
    v_mfma_f32_16x16x32_bf16 v[244:247], v[84:87], v[48:51], v[244:247]
    v_mfma_f32_16x16x32_bf16 v[248:251], v[88:91], v[48:51], v[248:251]
    ds_read_b128 v[48:51], v18 offset:50432
    s_waitcnt lgkmcnt(3)
    v_mfma_f32_16x16x32_bf16 v[204:207], v[108:111], v[28:31], v[204:207]
    v_mfma_f32_16x16x32_bf16 v[208:211], v[112:115], v[28:31], v[208:211]
    ds_read_b128 v[28:31], v18 offset:55296
    v_mfma_f32_16x16x32_bf16 v[212:215], v[108:111], v[32:35], v[212:215]
    v_mfma_f32_16x16x32_bf16 v[216:219], v[112:115], v[32:35], v[216:219]
    ds_read_b128 v[32:35], v18 offset:55552
    v_mfma_f32_16x16x32_bf16 v[220:223], v[108:111], v[36:39], v[220:223]
    v_mfma_f32_16x16x32_bf16 v[224:227], v[112:115], v[36:39], v[224:227]
    ds_read_b128 v[36:39], v18 offset:55808
    s_waitcnt lgkmcnt(5)
    v_mfma_f32_16x16x32_bf16 v[228:231], v[108:111], v[40:43], v[228:231]
    v_mfma_f32_16x16x32_bf16 v[232:235], v[112:115], v[40:43], v[232:235]
    ds_read_b128 v[40:43], v18 offset:56064
    s_waitcnt lgkmcnt(5)
    v_mfma_f32_16x16x32_bf16 v[236:239], v[108:111], v[44:47], v[236:239]
    v_mfma_f32_16x16x32_bf16 v[240:243], v[112:115], v[44:47], v[240:243]
    ds_read_b128 v[44:47], v18 offset:56320
    s_waitcnt lgkmcnt(5)
    v_mfma_f32_16x16x32_bf16 v[244:247], v[108:111], v[48:51], v[244:247]
    v_mfma_f32_16x16x32_bf16 v[248:251], v[112:115], v[48:51], v[248:251]
    ds_read_b128 v[48:51], v18 offset:56576
    s_waitcnt lgkmcnt(3)
    v_mfma_f32_16x16x32_bf16 v[204:207], v[116:119], v[28:31], v[204:207]
    s_barrier
    ds_read_b64_tr_b16 v[76:77], v24 offset:16384
    v_mfma_f32_16x16x32_bf16 v[208:211], v[120:123], v[28:31], v[208:211]
    ds_read_b128 v[28:31], v18 offset:0
    v_mfma_f32_16x16x32_bf16 v[212:215], v[116:119], v[32:35], v[212:215]
    ds_read_b64_tr_b16 v[78:79], v24 offset:20480
    v_mfma_f32_16x16x32_bf16 v[216:219], v[120:123], v[32:35], v[216:219]
    ds_read_b128 v[32:35], v18 offset:256
    v_mfma_f32_16x16x32_bf16 v[220:223], v[116:119], v[36:39], v[220:223]
    ds_read_b64_tr_b16 v[80:81], v25 offset:16384
    v_mfma_f32_16x16x32_bf16 v[224:227], v[120:123], v[36:39], v[224:227]
    ds_read_b128 v[36:39], v18 offset:512
    s_waitcnt lgkmcnt(8)
    v_mfma_f32_16x16x32_bf16 v[228:231], v[116:119], v[40:43], v[228:231]
    ds_read_b64_tr_b16 v[82:83], v25 offset:20480
    v_mfma_f32_16x16x32_bf16 v[232:235], v[120:123], v[40:43], v[232:235]
    ds_read_b128 v[40:43], v18 offset:768
    s_waitcnt lgkmcnt(9)
    v_mfma_f32_16x16x32_bf16 v[236:239], v[116:119], v[44:47], v[236:239]
    v_mfma_f32_16x16x32_bf16 v[240:243], v[120:123], v[44:47], v[240:243]
    ds_read_b128 v[44:47], v18 offset:1024
    s_waitcnt lgkmcnt(9)
    v_mfma_f32_16x16x32_bf16 v[244:247], v[116:119], v[48:51], v[244:247]
    v_mfma_f32_16x16x32_bf16 v[248:251], v[120:123], v[48:51], v[248:251]
    ds_read_b128 v[48:51], v18 offset:1280
    s_waitcnt lgkmcnt(3)
    v_mfma_f32_16x16x32_bf16 v[204:207], v[76:79], v[28:31], v[204:207]
    ds_read_b64_tr_b16 v[84:85], v24 offset:24576
    v_mfma_f32_16x16x32_bf16 v[208:211], v[80:83], v[28:31], v[208:211]
    ds_read_b128 v[28:31], v18 offset:6144
    v_mfma_f32_16x16x32_bf16 v[212:215], v[76:79], v[32:35], v[212:215]
    ds_read_b64_tr_b16 v[86:87], v24 offset:28672
    v_mfma_f32_16x16x32_bf16 v[216:219], v[80:83], v[32:35], v[216:219]
    ds_read_b128 v[32:35], v18 offset:6400
    v_mfma_f32_16x16x32_bf16 v[220:223], v[76:79], v[36:39], v[220:223]
    ds_read_b64_tr_b16 v[88:89], v25 offset:24576
    v_mfma_f32_16x16x32_bf16 v[224:227], v[80:83], v[36:39], v[224:227]
    ds_read_b128 v[36:39], v18 offset:6656
    s_waitcnt lgkmcnt(8)
    v_mfma_f32_16x16x32_bf16 v[228:231], v[76:79], v[40:43], v[228:231]
    ds_read_b64_tr_b16 v[90:91], v25 offset:28672
    v_mfma_f32_16x16x32_bf16 v[232:235], v[80:83], v[40:43], v[232:235]
    ds_read_b128 v[40:43], v18 offset:6912
    s_waitcnt lgkmcnt(9)
    v_mfma_f32_16x16x32_bf16 v[236:239], v[76:79], v[44:47], v[236:239]
    v_mfma_f32_16x16x32_bf16 v[240:243], v[80:83], v[44:47], v[240:243]
    ds_read_b128 v[44:47], v18 offset:7168
    s_waitcnt lgkmcnt(9)
    v_mfma_f32_16x16x32_bf16 v[244:247], v[76:79], v[48:51], v[244:247]
    v_mfma_f32_16x16x32_bf16 v[248:251], v[80:83], v[48:51], v[248:251]
    ds_read_b128 v[48:51], v18 offset:7424
    s_waitcnt lgkmcnt(3)
    v_mfma_f32_16x16x32_bf16 v[204:207], v[84:87], v[28:31], v[204:207]
    s_barrier
    ds_read_b64_tr_b16 v[76:77], v24 offset:32768
    v_mfma_f32_16x16x32_bf16 v[208:211], v[88:91], v[28:31], v[208:211]
    ds_read_b128 v[28:31], v18 offset:12288
    v_mfma_f32_16x16x32_bf16 v[212:215], v[84:87], v[32:35], v[212:215]
    ds_read_b64_tr_b16 v[78:79], v24 offset:36864
    v_mfma_f32_16x16x32_bf16 v[216:219], v[88:91], v[32:35], v[216:219]
    ds_read_b128 v[32:35], v18 offset:12544
    v_mfma_f32_16x16x32_bf16 v[220:223], v[84:87], v[36:39], v[220:223]
    ds_read_b64_tr_b16 v[80:81], v25 offset:32768
    v_mfma_f32_16x16x32_bf16 v[224:227], v[88:91], v[36:39], v[224:227]
    ds_read_b128 v[36:39], v18 offset:12800
    s_waitcnt lgkmcnt(8)
    v_mfma_f32_16x16x32_bf16 v[228:231], v[84:87], v[40:43], v[228:231]
    ds_read_b64_tr_b16 v[82:83], v25 offset:36864
    v_mfma_f32_16x16x32_bf16 v[232:235], v[88:91], v[40:43], v[232:235]
    ds_read_b128 v[40:43], v18 offset:13056
    s_waitcnt lgkmcnt(9)
    v_mfma_f32_16x16x32_bf16 v[236:239], v[84:87], v[44:47], v[236:239]
    v_mfma_f32_16x16x32_bf16 v[240:243], v[88:91], v[44:47], v[240:243]
    ds_read_b128 v[44:47], v18 offset:13312
    s_waitcnt lgkmcnt(9)
    v_mfma_f32_16x16x32_bf16 v[244:247], v[84:87], v[48:51], v[244:247]
    v_mfma_f32_16x16x32_bf16 v[248:251], v[88:91], v[48:51], v[248:251]
    ds_read_b128 v[48:51], v18 offset:13568
    s_waitcnt lgkmcnt(3)
    v_mfma_f32_16x16x32_bf16 v[204:207], v[76:79], v[28:31], v[204:207]
    ds_read_b64_tr_b16 v[84:85], v24 offset:40960
    v_mfma_f32_16x16x32_bf16 v[208:211], v[80:83], v[28:31], v[208:211]
    ds_read_b128 v[28:31], v18 offset:18432
    v_mfma_f32_16x16x32_bf16 v[212:215], v[76:79], v[32:35], v[212:215]
    ds_read_b64_tr_b16 v[86:87], v24 offset:45056
    v_mfma_f32_16x16x32_bf16 v[216:219], v[80:83], v[32:35], v[216:219]
    ds_read_b128 v[32:35], v18 offset:18688
    v_mfma_f32_16x16x32_bf16 v[220:223], v[76:79], v[36:39], v[220:223]
    ds_read_b64_tr_b16 v[88:89], v25 offset:40960
    v_mfma_f32_16x16x32_bf16 v[224:227], v[80:83], v[36:39], v[224:227]
    ds_read_b128 v[36:39], v18 offset:18944
    s_waitcnt lgkmcnt(8)
    v_mfma_f32_16x16x32_bf16 v[228:231], v[76:79], v[40:43], v[228:231]
    ds_read_b64_tr_b16 v[90:91], v25 offset:45056
    v_mfma_f32_16x16x32_bf16 v[232:235], v[80:83], v[40:43], v[232:235]
    ds_read_b128 v[40:43], v18 offset:19200
    s_waitcnt lgkmcnt(9)
    v_mfma_f32_16x16x32_bf16 v[236:239], v[76:79], v[44:47], v[236:239]
    v_mfma_f32_16x16x32_bf16 v[240:243], v[80:83], v[44:47], v[240:243]
    ds_read_b128 v[44:47], v18 offset:19456
    s_waitcnt lgkmcnt(9)
    v_mfma_f32_16x16x32_bf16 v[244:247], v[76:79], v[48:51], v[244:247]
    v_mfma_f32_16x16x32_bf16 v[248:251], v[80:83], v[48:51], v[248:251]
    ds_read_b128 v[48:51], v18 offset:19712
    s_waitcnt lgkmcnt(3)
    v_mfma_f32_16x16x32_bf16 v[204:207], v[84:87], v[28:31], v[204:207]
    s_barrier
    v_mfma_f32_16x16x32_bf16 v[208:211], v[88:91], v[28:31], v[208:211]
    ds_read_b128 v[28:31], v18 offset:24576
    v_mfma_f32_16x16x32_bf16 v[212:215], v[84:87], v[32:35], v[212:215]
    v_mfma_f32_16x16x32_bf16 v[216:219], v[88:91], v[32:35], v[216:219]
    ds_read_b128 v[32:35], v18 offset:24832
    v_mfma_f32_16x16x32_bf16 v[220:223], v[84:87], v[36:39], v[220:223]
    v_mfma_f32_16x16x32_bf16 v[224:227], v[88:91], v[36:39], v[224:227]
    ds_read_b128 v[36:39], v18 offset:25088
    s_waitcnt lgkmcnt(5)
    v_mfma_f32_16x16x32_bf16 v[228:231], v[84:87], v[40:43], v[228:231]
    v_mfma_f32_16x16x32_bf16 v[232:235], v[88:91], v[40:43], v[232:235]
    ds_read_b128 v[40:43], v18 offset:25344
    s_waitcnt lgkmcnt(5)
    v_mfma_f32_16x16x32_bf16 v[236:239], v[84:87], v[44:47], v[236:239]
    v_mfma_f32_16x16x32_bf16 v[240:243], v[88:91], v[44:47], v[240:243]
    ds_read_b128 v[44:47], v18 offset:25600
    s_waitcnt lgkmcnt(5)
    v_mfma_f32_16x16x32_bf16 v[244:247], v[84:87], v[48:51], v[244:247]
    v_mfma_f32_16x16x32_bf16 v[248:251], v[88:91], v[48:51], v[248:251]
    ds_read_b128 v[48:51], v18 offset:25856
    s_waitcnt lgkmcnt(3)
    v_mfma_f32_16x16x32_bf16 v[204:207], v[124:127], v[28:31], v[204:207]
    v_mfma_f32_16x16x32_bf16 v[208:211], v[128:131], v[28:31], v[208:211]
    ds_read_b128 v[28:31], v18 offset:30720
    v_mfma_f32_16x16x32_bf16 v[212:215], v[124:127], v[32:35], v[212:215]
    v_mfma_f32_16x16x32_bf16 v[216:219], v[128:131], v[32:35], v[216:219]
    ds_read_b128 v[32:35], v18 offset:30976
    v_mfma_f32_16x16x32_bf16 v[220:223], v[124:127], v[36:39], v[220:223]
    v_mfma_f32_16x16x32_bf16 v[224:227], v[128:131], v[36:39], v[224:227]
    ds_read_b128 v[36:39], v18 offset:31232
    s_waitcnt lgkmcnt(5)
    v_mfma_f32_16x16x32_bf16 v[228:231], v[124:127], v[40:43], v[228:231]
    v_mfma_f32_16x16x32_bf16 v[232:235], v[128:131], v[40:43], v[232:235]
    ds_read_b128 v[40:43], v18 offset:31488
    s_waitcnt lgkmcnt(5)
    v_mfma_f32_16x16x32_bf16 v[236:239], v[124:127], v[44:47], v[236:239]
    v_mfma_f32_16x16x32_bf16 v[240:243], v[128:131], v[44:47], v[240:243]
    ds_read_b128 v[44:47], v18 offset:31744
    s_waitcnt lgkmcnt(5)
    v_mfma_f32_16x16x32_bf16 v[244:247], v[124:127], v[48:51], v[244:247]
    v_mfma_f32_16x16x32_bf16 v[248:251], v[128:131], v[48:51], v[248:251]
    ds_read_b128 v[48:51], v18 offset:32000
    s_waitcnt lgkmcnt(3)
    v_mfma_f32_16x16x32_bf16 v[204:207], v[132:135], v[28:31], v[204:207]
    s_barrier
    ds_read_b64_tr_b16 v[76:77], v20 offset:0
    v_mfma_f32_16x16x32_bf16 v[208:211], v[136:139], v[28:31], v[208:211]
    ds_read_b128 v[28:31], v18 offset:36864
    v_mfma_f32_16x16x32_bf16 v[212:215], v[132:135], v[32:35], v[212:215]
    ds_read_b64_tr_b16 v[78:79], v20 offset:4096
    v_mfma_f32_16x16x32_bf16 v[216:219], v[136:139], v[32:35], v[216:219]
    ds_read_b128 v[32:35], v18 offset:37120
    v_mfma_f32_16x16x32_bf16 v[220:223], v[132:135], v[36:39], v[220:223]
    ds_read_b64_tr_b16 v[80:81], v21 offset:0
    v_mfma_f32_16x16x32_bf16 v[224:227], v[136:139], v[36:39], v[224:227]
    ds_read_b128 v[36:39], v18 offset:37376
    s_waitcnt lgkmcnt(8)
    v_mfma_f32_16x16x32_bf16 v[228:231], v[132:135], v[40:43], v[228:231]
    ds_read_b64_tr_b16 v[82:83], v21 offset:4096
    v_mfma_f32_16x16x32_bf16 v[232:235], v[136:139], v[40:43], v[232:235]
    ds_read_b128 v[40:43], v18 offset:37632
    s_waitcnt lgkmcnt(9)
    v_mfma_f32_16x16x32_bf16 v[236:239], v[132:135], v[44:47], v[236:239]
    v_mfma_f32_16x16x32_bf16 v[240:243], v[136:139], v[44:47], v[240:243]
    ds_read_b128 v[44:47], v18 offset:37888
    s_waitcnt lgkmcnt(9)
    v_mfma_f32_16x16x32_bf16 v[244:247], v[132:135], v[48:51], v[244:247]
    v_mfma_f32_16x16x32_bf16 v[248:251], v[136:139], v[48:51], v[248:251]
    ds_read_b128 v[48:51], v18 offset:38144
    s_waitcnt lgkmcnt(3)
    v_mfma_f32_16x16x32_bf16 v[204:207], v[76:79], v[28:31], v[204:207]
    ds_read_b64_tr_b16 v[84:85], v20 offset:8192
    v_mfma_f32_16x16x32_bf16 v[208:211], v[80:83], v[28:31], v[208:211]
    ds_read_b128 v[28:31], v18 offset:43008
    v_mfma_f32_16x16x32_bf16 v[212:215], v[76:79], v[32:35], v[212:215]
    ds_read_b64_tr_b16 v[86:87], v20 offset:12288
    v_mfma_f32_16x16x32_bf16 v[216:219], v[80:83], v[32:35], v[216:219]
    ds_read_b128 v[32:35], v18 offset:43264
    s_branch L_skip_4
    s_nop 0
L_stub_4:
    s_branch L_stub_5
L_skip_4:
    v_mfma_f32_16x16x32_bf16 v[220:223], v[76:79], v[36:39], v[220:223]
    ds_read_b64_tr_b16 v[88:89], v21 offset:8192
    v_mfma_f32_16x16x32_bf16 v[224:227], v[80:83], v[36:39], v[224:227]
    ds_read_b128 v[36:39], v18 offset:43520
    s_waitcnt lgkmcnt(8)
    v_mfma_f32_16x16x32_bf16 v[228:231], v[76:79], v[40:43], v[228:231]
    ds_read_b64_tr_b16 v[90:91], v21 offset:12288
    v_mfma_f32_16x16x32_bf16 v[232:235], v[80:83], v[40:43], v[232:235]
    ds_read_b128 v[40:43], v18 offset:43776
    s_waitcnt lgkmcnt(9)
    v_mfma_f32_16x16x32_bf16 v[236:239], v[76:79], v[44:47], v[236:239]
    v_mfma_f32_16x16x32_bf16 v[240:243], v[80:83], v[44:47], v[240:243]
    ds_read_b128 v[44:47], v18 offset:44032
    s_waitcnt lgkmcnt(9)
    v_mfma_f32_16x16x32_bf16 v[244:247], v[76:79], v[48:51], v[244:247]
    v_mfma_f32_16x16x32_bf16 v[248:251], v[80:83], v[48:51], v[248:251]
    ds_read_b128 v[48:51], v18 offset:44288
    s_waitcnt lgkmcnt(3)
    v_mfma_f32_16x16x32_bf16 v[204:207], v[84:87], v[28:31], v[204:207]
    s_barrier
    ds_read_b64_tr_b16 v[76:77], v20 offset:16384
    v_mfma_f32_16x16x32_bf16 v[208:211], v[88:91], v[28:31], v[208:211]
    ds_read_b128 v[28:31], v18 offset:49152
    v_mfma_f32_16x16x32_bf16 v[212:215], v[84:87], v[32:35], v[212:215]
    ds_read_b64_tr_b16 v[78:79], v20 offset:20480
    v_mfma_f32_16x16x32_bf16 v[216:219], v[88:91], v[32:35], v[216:219]
    ds_read_b128 v[32:35], v18 offset:49408
    v_mfma_f32_16x16x32_bf16 v[220:223], v[84:87], v[36:39], v[220:223]
    ds_read_b64_tr_b16 v[80:81], v21 offset:16384
    v_mfma_f32_16x16x32_bf16 v[224:227], v[88:91], v[36:39], v[224:227]
    ds_read_b128 v[36:39], v18 offset:49664
    s_waitcnt lgkmcnt(8)
    v_mfma_f32_16x16x32_bf16 v[228:231], v[84:87], v[40:43], v[228:231]
    ds_read_b64_tr_b16 v[82:83], v21 offset:20480
    v_mfma_f32_16x16x32_bf16 v[232:235], v[88:91], v[40:43], v[232:235]
    ds_read_b128 v[40:43], v18 offset:49920
    s_waitcnt lgkmcnt(9)
    v_mfma_f32_16x16x32_bf16 v[236:239], v[84:87], v[44:47], v[236:239]
    v_mfma_f32_16x16x32_bf16 v[240:243], v[88:91], v[44:47], v[240:243]
    ds_read_b128 v[44:47], v18 offset:50176
    s_waitcnt lgkmcnt(9)
    v_mfma_f32_16x16x32_bf16 v[244:247], v[84:87], v[48:51], v[244:247]
    v_mfma_f32_16x16x32_bf16 v[248:251], v[88:91], v[48:51], v[248:251]
    ds_read_b128 v[48:51], v18 offset:50432
    s_waitcnt lgkmcnt(3)
    v_mfma_f32_16x16x32_bf16 v[204:207], v[76:79], v[28:31], v[204:207]
    ds_read_b64_tr_b16 v[84:85], v20 offset:24576
    v_mfma_f32_16x16x32_bf16 v[208:211], v[80:83], v[28:31], v[208:211]
    ds_read_b128 v[28:31], v18 offset:55296
    v_mfma_f32_16x16x32_bf16 v[212:215], v[76:79], v[32:35], v[212:215]
    ds_read_b64_tr_b16 v[86:87], v20 offset:28672
    v_mfma_f32_16x16x32_bf16 v[216:219], v[80:83], v[32:35], v[216:219]
    ds_read_b128 v[32:35], v18 offset:55552
    v_mfma_f32_16x16x32_bf16 v[220:223], v[76:79], v[36:39], v[220:223]
    ds_read_b64_tr_b16 v[88:89], v21 offset:24576
    v_mfma_f32_16x16x32_bf16 v[224:227], v[80:83], v[36:39], v[224:227]
    ds_read_b128 v[36:39], v18 offset:55808
    s_waitcnt lgkmcnt(8)
    v_mfma_f32_16x16x32_bf16 v[228:231], v[76:79], v[40:43], v[228:231]
    ds_read_b64_tr_b16 v[90:91], v21 offset:28672
    v_mfma_f32_16x16x32_bf16 v[232:235], v[80:83], v[40:43], v[232:235]
    ds_read_b128 v[40:43], v18 offset:56064
    s_waitcnt lgkmcnt(9)
    v_mfma_f32_16x16x32_bf16 v[236:239], v[76:79], v[44:47], v[236:239]
    v_mfma_f32_16x16x32_bf16 v[240:243], v[80:83], v[44:47], v[240:243]
    ds_read_b128 v[44:47], v18 offset:56320
    s_waitcnt lgkmcnt(9)
    v_mfma_f32_16x16x32_bf16 v[244:247], v[76:79], v[48:51], v[244:247]
    v_mfma_f32_16x16x32_bf16 v[248:251], v[80:83], v[48:51], v[248:251]
    ds_read_b128 v[48:51], v18 offset:56576
    s_waitcnt lgkmcnt(3)
    v_mfma_f32_16x16x32_bf16 v[204:207], v[84:87], v[28:31], v[204:207]
    s_barrier
    v_mfma_f32_16x16x32_bf16 v[208:211], v[88:91], v[28:31], v[208:211]
    ds_read_b128 v[28:31], v18 offset:0
    v_mfma_f32_16x16x32_bf16 v[212:215], v[84:87], v[32:35], v[212:215]
    v_mfma_f32_16x16x32_bf16 v[216:219], v[88:91], v[32:35], v[216:219]
    ds_read_b128 v[32:35], v18 offset:256
    v_mfma_f32_16x16x32_bf16 v[220:223], v[84:87], v[36:39], v[220:223]
    v_mfma_f32_16x16x32_bf16 v[224:227], v[88:91], v[36:39], v[224:227]
    ds_read_b128 v[36:39], v18 offset:512
    s_waitcnt lgkmcnt(5)
    v_mfma_f32_16x16x32_bf16 v[228:231], v[84:87], v[40:43], v[228:231]
    v_mfma_f32_16x16x32_bf16 v[232:235], v[88:91], v[40:43], v[232:235]
    ds_read_b128 v[40:43], v18 offset:768
    s_waitcnt lgkmcnt(5)
    v_mfma_f32_16x16x32_bf16 v[236:239], v[84:87], v[44:47], v[236:239]
    v_mfma_f32_16x16x32_bf16 v[240:243], v[88:91], v[44:47], v[240:243]
    ds_read_b128 v[44:47], v18 offset:1024
    s_waitcnt lgkmcnt(5)
    v_mfma_f32_16x16x32_bf16 v[244:247], v[84:87], v[48:51], v[244:247]
    v_mfma_f32_16x16x32_bf16 v[248:251], v[88:91], v[48:51], v[248:251]
    ds_read_b128 v[48:51], v18 offset:1280
    s_waitcnt lgkmcnt(3)
    v_mfma_f32_16x16x32_bf16 v[204:207], v[140:143], v[28:31], v[204:207]
    v_mfma_f32_16x16x32_bf16 v[208:211], v[144:147], v[28:31], v[208:211]
    ds_read_b128 v[28:31], v18 offset:6144
    v_mfma_f32_16x16x32_bf16 v[212:215], v[140:143], v[32:35], v[212:215]
    v_mfma_f32_16x16x32_bf16 v[216:219], v[144:147], v[32:35], v[216:219]
    ds_read_b128 v[32:35], v18 offset:6400
    v_mfma_f32_16x16x32_bf16 v[220:223], v[140:143], v[36:39], v[220:223]
    v_mfma_f32_16x16x32_bf16 v[224:227], v[144:147], v[36:39], v[224:227]
    ds_read_b128 v[36:39], v18 offset:6656
    s_waitcnt lgkmcnt(5)
    v_mfma_f32_16x16x32_bf16 v[228:231], v[140:143], v[40:43], v[228:231]
    v_mfma_f32_16x16x32_bf16 v[232:235], v[144:147], v[40:43], v[232:235]
    ds_read_b128 v[40:43], v18 offset:6912
    s_waitcnt lgkmcnt(5)
    v_mfma_f32_16x16x32_bf16 v[236:239], v[140:143], v[44:47], v[236:239]
    v_mfma_f32_16x16x32_bf16 v[240:243], v[144:147], v[44:47], v[240:243]
    ds_read_b128 v[44:47], v18 offset:7168
    s_waitcnt lgkmcnt(5)
    v_mfma_f32_16x16x32_bf16 v[244:247], v[140:143], v[48:51], v[244:247]
    v_mfma_f32_16x16x32_bf16 v[248:251], v[144:147], v[48:51], v[248:251]
    ds_read_b128 v[48:51], v18 offset:7424
    s_waitcnt lgkmcnt(3)
    v_mfma_f32_16x16x32_bf16 v[204:207], v[148:151], v[28:31], v[204:207]
    s_barrier
    ds_read_b64_tr_b16 v[76:77], v20 offset:32768
    v_mfma_f32_16x16x32_bf16 v[208:211], v[152:155], v[28:31], v[208:211]
    ds_read_b128 v[28:31], v18 offset:12288
    v_mfma_f32_16x16x32_bf16 v[212:215], v[148:151], v[32:35], v[212:215]
    ds_read_b64_tr_b16 v[78:79], v20 offset:36864
    v_mfma_f32_16x16x32_bf16 v[216:219], v[152:155], v[32:35], v[216:219]
    ds_read_b128 v[32:35], v18 offset:12544
    v_mfma_f32_16x16x32_bf16 v[220:223], v[148:151], v[36:39], v[220:223]
    ds_read_b64_tr_b16 v[80:81], v21 offset:32768
    v_mfma_f32_16x16x32_bf16 v[224:227], v[152:155], v[36:39], v[224:227]
    ds_read_b128 v[36:39], v18 offset:12800
    s_waitcnt lgkmcnt(8)
    v_mfma_f32_16x16x32_bf16 v[228:231], v[148:151], v[40:43], v[228:231]
    ds_read_b64_tr_b16 v[82:83], v21 offset:36864
    v_mfma_f32_16x16x32_bf16 v[232:235], v[152:155], v[40:43], v[232:235]
    ds_read_b128 v[40:43], v18 offset:13056
    s_waitcnt lgkmcnt(9)
    v_mfma_f32_16x16x32_bf16 v[236:239], v[148:151], v[44:47], v[236:239]
    v_mfma_f32_16x16x32_bf16 v[240:243], v[152:155], v[44:47], v[240:243]
    ds_read_b128 v[44:47], v18 offset:13312
    s_waitcnt lgkmcnt(9)
    v_mfma_f32_16x16x32_bf16 v[244:247], v[148:151], v[48:51], v[244:247]
    v_mfma_f32_16x16x32_bf16 v[248:251], v[152:155], v[48:51], v[248:251]
    ds_read_b128 v[48:51], v18 offset:13568
    s_waitcnt lgkmcnt(3)
    v_mfma_f32_16x16x32_bf16 v[204:207], v[76:79], v[28:31], v[204:207]
    ds_read_b64_tr_b16 v[84:85], v20 offset:40960
    v_mfma_f32_16x16x32_bf16 v[208:211], v[80:83], v[28:31], v[208:211]
    ds_read_b128 v[28:31], v18 offset:18432
    v_mfma_f32_16x16x32_bf16 v[212:215], v[76:79], v[32:35], v[212:215]
    ds_read_b64_tr_b16 v[86:87], v20 offset:45056
    v_mfma_f32_16x16x32_bf16 v[216:219], v[80:83], v[32:35], v[216:219]
    ds_read_b128 v[32:35], v18 offset:18688
    v_mfma_f32_16x16x32_bf16 v[220:223], v[76:79], v[36:39], v[220:223]
    ds_read_b64_tr_b16 v[88:89], v21 offset:40960
    v_mfma_f32_16x16x32_bf16 v[224:227], v[80:83], v[36:39], v[224:227]
    ds_read_b128 v[36:39], v18 offset:18944
    s_waitcnt lgkmcnt(8)
    v_mfma_f32_16x16x32_bf16 v[228:231], v[76:79], v[40:43], v[228:231]
    ds_read_b64_tr_b16 v[90:91], v21 offset:45056
    v_mfma_f32_16x16x32_bf16 v[232:235], v[80:83], v[40:43], v[232:235]
    ds_read_b128 v[40:43], v18 offset:19200
    s_waitcnt lgkmcnt(9)
    v_mfma_f32_16x16x32_bf16 v[236:239], v[76:79], v[44:47], v[236:239]
    v_mfma_f32_16x16x32_bf16 v[240:243], v[80:83], v[44:47], v[240:243]
    ds_read_b128 v[44:47], v18 offset:19456
    s_waitcnt lgkmcnt(9)
    v_mfma_f32_16x16x32_bf16 v[244:247], v[76:79], v[48:51], v[244:247]
    v_mfma_f32_16x16x32_bf16 v[248:251], v[80:83], v[48:51], v[248:251]
    ds_read_b128 v[48:51], v18 offset:19712
    s_waitcnt lgkmcnt(3)
    v_mfma_f32_16x16x32_bf16 v[204:207], v[84:87], v[28:31], v[204:207]
    s_barrier
    ds_read_b64_tr_b16 v[76:77], v24 offset:0
    v_mfma_f32_16x16x32_bf16 v[208:211], v[88:91], v[28:31], v[208:211]
    ds_read_b128 v[28:31], v18 offset:24576
    v_mfma_f32_16x16x32_bf16 v[212:215], v[84:87], v[32:35], v[212:215]
    ds_read_b64_tr_b16 v[78:79], v24 offset:4096
    v_mfma_f32_16x16x32_bf16 v[216:219], v[88:91], v[32:35], v[216:219]
    ds_read_b128 v[32:35], v18 offset:24832
    v_mfma_f32_16x16x32_bf16 v[220:223], v[84:87], v[36:39], v[220:223]
    ds_read_b64_tr_b16 v[80:81], v25 offset:0
    v_mfma_f32_16x16x32_bf16 v[224:227], v[88:91], v[36:39], v[224:227]
    ds_read_b128 v[36:39], v18 offset:25088
    s_waitcnt lgkmcnt(8)
    v_mfma_f32_16x16x32_bf16 v[228:231], v[84:87], v[40:43], v[228:231]
    ds_read_b64_tr_b16 v[82:83], v25 offset:4096
    v_mfma_f32_16x16x32_bf16 v[232:235], v[88:91], v[40:43], v[232:235]
    ds_read_b128 v[40:43], v18 offset:25344
    s_waitcnt lgkmcnt(9)
    v_mfma_f32_16x16x32_bf16 v[236:239], v[84:87], v[44:47], v[236:239]
    v_mfma_f32_16x16x32_bf16 v[240:243], v[88:91], v[44:47], v[240:243]
    ds_read_b128 v[44:47], v18 offset:25600
    s_waitcnt lgkmcnt(9)
    v_mfma_f32_16x16x32_bf16 v[244:247], v[84:87], v[48:51], v[244:247]
    v_mfma_f32_16x16x32_bf16 v[248:251], v[88:91], v[48:51], v[248:251]
    ds_read_b128 v[48:51], v18 offset:25856
    s_waitcnt lgkmcnt(3)
    v_mfma_f32_16x16x32_bf16 v[204:207], v[76:79], v[28:31], v[204:207]
    ds_read_b64_tr_b16 v[84:85], v24 offset:8192
    v_mfma_f32_16x16x32_bf16 v[208:211], v[80:83], v[28:31], v[208:211]
    ds_read_b128 v[28:31], v18 offset:30720
    v_mfma_f32_16x16x32_bf16 v[212:215], v[76:79], v[32:35], v[212:215]
    ds_read_b64_tr_b16 v[86:87], v24 offset:12288
    v_mfma_f32_16x16x32_bf16 v[216:219], v[80:83], v[32:35], v[216:219]
    ds_read_b128 v[32:35], v18 offset:30976
    v_mfma_f32_16x16x32_bf16 v[220:223], v[76:79], v[36:39], v[220:223]
    ds_read_b64_tr_b16 v[88:89], v25 offset:8192
    v_mfma_f32_16x16x32_bf16 v[224:227], v[80:83], v[36:39], v[224:227]
    ds_read_b128 v[36:39], v18 offset:31232
    s_waitcnt lgkmcnt(8)
    v_mfma_f32_16x16x32_bf16 v[228:231], v[76:79], v[40:43], v[228:231]
    ds_read_b64_tr_b16 v[90:91], v25 offset:12288
    v_mfma_f32_16x16x32_bf16 v[232:235], v[80:83], v[40:43], v[232:235]
    ds_read_b128 v[40:43], v18 offset:31488
    s_waitcnt lgkmcnt(9)
    v_mfma_f32_16x16x32_bf16 v[236:239], v[76:79], v[44:47], v[236:239]
    v_mfma_f32_16x16x32_bf16 v[240:243], v[80:83], v[44:47], v[240:243]
    ds_read_b128 v[44:47], v18 offset:31744
    s_waitcnt lgkmcnt(9)
    v_mfma_f32_16x16x32_bf16 v[244:247], v[76:79], v[48:51], v[244:247]
    v_mfma_f32_16x16x32_bf16 v[248:251], v[80:83], v[48:51], v[248:251]
    ds_read_b128 v[48:51], v18 offset:32000
    s_waitcnt lgkmcnt(3)
    v_mfma_f32_16x16x32_bf16 v[204:207], v[84:87], v[28:31], v[204:207]
    s_barrier
    v_mfma_f32_16x16x32_bf16 v[208:211], v[88:91], v[28:31], v[208:211]
    ds_read_b128 v[28:31], v18 offset:36864
    v_mfma_f32_16x16x32_bf16 v[212:215], v[84:87], v[32:35], v[212:215]
    v_mfma_f32_16x16x32_bf16 v[216:219], v[88:91], v[32:35], v[216:219]
    ds_read_b128 v[32:35], v18 offset:37120
    v_mfma_f32_16x16x32_bf16 v[220:223], v[84:87], v[36:39], v[220:223]
    v_mfma_f32_16x16x32_bf16 v[224:227], v[88:91], v[36:39], v[224:227]
    ds_read_b128 v[36:39], v18 offset:37376
    s_waitcnt lgkmcnt(5)
    v_mfma_f32_16x16x32_bf16 v[228:231], v[84:87], v[40:43], v[228:231]
    v_mfma_f32_16x16x32_bf16 v[232:235], v[88:91], v[40:43], v[232:235]
    ds_read_b128 v[40:43], v18 offset:37632
    s_waitcnt lgkmcnt(5)
    v_mfma_f32_16x16x32_bf16 v[236:239], v[84:87], v[44:47], v[236:239]
    v_mfma_f32_16x16x32_bf16 v[240:243], v[88:91], v[44:47], v[240:243]
    ds_read_b128 v[44:47], v18 offset:37888
    s_waitcnt lgkmcnt(5)
    v_mfma_f32_16x16x32_bf16 v[244:247], v[84:87], v[48:51], v[244:247]
    v_mfma_f32_16x16x32_bf16 v[248:251], v[88:91], v[48:51], v[248:251]
    ds_read_b128 v[48:51], v18 offset:38144
    s_waitcnt lgkmcnt(3)
    v_mfma_f32_16x16x32_bf16 v[204:207], v[156:159], v[28:31], v[204:207]
    v_mfma_f32_16x16x32_bf16 v[208:211], v[160:163], v[28:31], v[208:211]
    ds_read_b128 v[28:31], v18 offset:43008
    v_mfma_f32_16x16x32_bf16 v[212:215], v[156:159], v[32:35], v[212:215]
    v_mfma_f32_16x16x32_bf16 v[216:219], v[160:163], v[32:35], v[216:219]
    ds_read_b128 v[32:35], v18 offset:43264
    v_mfma_f32_16x16x32_bf16 v[220:223], v[156:159], v[36:39], v[220:223]
    v_mfma_f32_16x16x32_bf16 v[224:227], v[160:163], v[36:39], v[224:227]
    ds_read_b128 v[36:39], v18 offset:43520
    s_waitcnt lgkmcnt(5)
    v_mfma_f32_16x16x32_bf16 v[228:231], v[156:159], v[40:43], v[228:231]
    v_mfma_f32_16x16x32_bf16 v[232:235], v[160:163], v[40:43], v[232:235]
    ds_read_b128 v[40:43], v18 offset:43776
    s_waitcnt lgkmcnt(5)
    v_mfma_f32_16x16x32_bf16 v[236:239], v[156:159], v[44:47], v[236:239]
    v_mfma_f32_16x16x32_bf16 v[240:243], v[160:163], v[44:47], v[240:243]
    ds_read_b128 v[44:47], v18 offset:44032
    s_waitcnt lgkmcnt(5)
    v_mfma_f32_16x16x32_bf16 v[244:247], v[156:159], v[48:51], v[244:247]
    v_mfma_f32_16x16x32_bf16 v[248:251], v[160:163], v[48:51], v[248:251]
    ds_read_b128 v[48:51], v18 offset:44288
    s_waitcnt lgkmcnt(3)
    v_mfma_f32_16x16x32_bf16 v[204:207], v[164:167], v[28:31], v[204:207]
    s_barrier
    ds_read_b64_tr_b16 v[76:77], v24 offset:16384
    v_mfma_f32_16x16x32_bf16 v[208:211], v[168:171], v[28:31], v[208:211]
    ds_read_b128 v[28:31], v18 offset:49152
    v_mfma_f32_16x16x32_bf16 v[212:215], v[164:167], v[32:35], v[212:215]
    ds_read_b64_tr_b16 v[78:79], v24 offset:20480
    v_mfma_f32_16x16x32_bf16 v[216:219], v[168:171], v[32:35], v[216:219]
    ds_read_b128 v[32:35], v18 offset:49408
    v_mfma_f32_16x16x32_bf16 v[220:223], v[164:167], v[36:39], v[220:223]
    ds_read_b64_tr_b16 v[80:81], v25 offset:16384
    v_mfma_f32_16x16x32_bf16 v[224:227], v[168:171], v[36:39], v[224:227]
    ds_read_b128 v[36:39], v18 offset:49664
    s_waitcnt lgkmcnt(8)
    v_mfma_f32_16x16x32_bf16 v[228:231], v[164:167], v[40:43], v[228:231]
    ds_read_b64_tr_b16 v[82:83], v25 offset:20480
    v_mfma_f32_16x16x32_bf16 v[232:235], v[168:171], v[40:43], v[232:235]
    ds_read_b128 v[40:43], v18 offset:49920
    s_waitcnt lgkmcnt(9)
    v_mfma_f32_16x16x32_bf16 v[236:239], v[164:167], v[44:47], v[236:239]
    v_mfma_f32_16x16x32_bf16 v[240:243], v[168:171], v[44:47], v[240:243]
    ds_read_b128 v[44:47], v18 offset:50176
    s_waitcnt lgkmcnt(9)
    v_mfma_f32_16x16x32_bf16 v[244:247], v[164:167], v[48:51], v[244:247]
    v_mfma_f32_16x16x32_bf16 v[248:251], v[168:171], v[48:51], v[248:251]
    ds_read_b128 v[48:51], v18 offset:50432
    s_waitcnt lgkmcnt(3)
    v_mfma_f32_16x16x32_bf16 v[204:207], v[76:79], v[28:31], v[204:207]
    ds_read_b64_tr_b16 v[84:85], v24 offset:24576
    v_mfma_f32_16x16x32_bf16 v[208:211], v[80:83], v[28:31], v[208:211]
    ds_read_b128 v[28:31], v18 offset:55296
    v_mfma_f32_16x16x32_bf16 v[212:215], v[76:79], v[32:35], v[212:215]
    ds_read_b64_tr_b16 v[86:87], v24 offset:28672
    v_mfma_f32_16x16x32_bf16 v[216:219], v[80:83], v[32:35], v[216:219]
    ds_read_b128 v[32:35], v18 offset:55552
    v_mfma_f32_16x16x32_bf16 v[220:223], v[76:79], v[36:39], v[220:223]
    ds_read_b64_tr_b16 v[88:89], v25 offset:24576
    v_mfma_f32_16x16x32_bf16 v[224:227], v[80:83], v[36:39], v[224:227]
    ds_read_b128 v[36:39], v18 offset:55808
    s_waitcnt lgkmcnt(8)
    v_mfma_f32_16x16x32_bf16 v[228:231], v[76:79], v[40:43], v[228:231]
    ds_read_b64_tr_b16 v[90:91], v25 offset:28672
    v_mfma_f32_16x16x32_bf16 v[232:235], v[80:83], v[40:43], v[232:235]
    ds_read_b128 v[40:43], v18 offset:56064
    s_waitcnt lgkmcnt(9)
    v_mfma_f32_16x16x32_bf16 v[236:239], v[76:79], v[44:47], v[236:239]
    v_mfma_f32_16x16x32_bf16 v[240:243], v[80:83], v[44:47], v[240:243]
    ds_read_b128 v[44:47], v18 offset:56320
    s_waitcnt lgkmcnt(9)
    v_mfma_f32_16x16x32_bf16 v[244:247], v[76:79], v[48:51], v[244:247]
    v_mfma_f32_16x16x32_bf16 v[248:251], v[80:83], v[48:51], v[248:251]
    ds_read_b128 v[48:51], v18 offset:56576
    s_waitcnt lgkmcnt(3)
    v_mfma_f32_16x16x32_bf16 v[204:207], v[84:87], v[28:31], v[204:207]
    s_barrier
    ds_read_b64_tr_b16 v[76:77], v24 offset:32768
    v_mfma_f32_16x16x32_bf16 v[208:211], v[88:91], v[28:31], v[208:211]
    ds_read_b128 v[28:31], v18 offset:0
    v_mfma_f32_16x16x32_bf16 v[212:215], v[84:87], v[32:35], v[212:215]
    ds_read_b64_tr_b16 v[78:79], v24 offset:36864
    v_mfma_f32_16x16x32_bf16 v[216:219], v[88:91], v[32:35], v[216:219]
    ds_read_b128 v[32:35], v18 offset:256
    v_mfma_f32_16x16x32_bf16 v[220:223], v[84:87], v[36:39], v[220:223]
    ds_read_b64_tr_b16 v[80:81], v25 offset:32768
    v_mfma_f32_16x16x32_bf16 v[224:227], v[88:91], v[36:39], v[224:227]
    ds_read_b128 v[36:39], v18 offset:512
    s_waitcnt lgkmcnt(8)
    v_mfma_f32_16x16x32_bf16 v[228:231], v[84:87], v[40:43], v[228:231]
    ds_read_b64_tr_b16 v[82:83], v25 offset:36864
    v_mfma_f32_16x16x32_bf16 v[232:235], v[88:91], v[40:43], v[232:235]
    ds_read_b128 v[40:43], v18 offset:768
    s_waitcnt lgkmcnt(9)
    v_mfma_f32_16x16x32_bf16 v[236:239], v[84:87], v[44:47], v[236:239]
    v_mfma_f32_16x16x32_bf16 v[240:243], v[88:91], v[44:47], v[240:243]
    ds_read_b128 v[44:47], v18 offset:1024
    s_waitcnt lgkmcnt(9)
    v_mfma_f32_16x16x32_bf16 v[244:247], v[84:87], v[48:51], v[244:247]
    v_mfma_f32_16x16x32_bf16 v[248:251], v[88:91], v[48:51], v[248:251]
    ds_read_b128 v[48:51], v18 offset:1280
    s_waitcnt lgkmcnt(3)
    v_mfma_f32_16x16x32_bf16 v[204:207], v[76:79], v[28:31], v[204:207]
    ds_read_b64_tr_b16 v[84:85], v24 offset:40960
    v_mfma_f32_16x16x32_bf16 v[208:211], v[80:83], v[28:31], v[208:211]
    ds_read_b128 v[28:31], v18 offset:6144
    v_mfma_f32_16x16x32_bf16 v[212:215], v[76:79], v[32:35], v[212:215]
    ds_read_b64_tr_b16 v[86:87], v24 offset:45056
    v_mfma_f32_16x16x32_bf16 v[216:219], v[80:83], v[32:35], v[216:219]
    ds_read_b128 v[32:35], v18 offset:6400
    v_mfma_f32_16x16x32_bf16 v[220:223], v[76:79], v[36:39], v[220:223]
    ds_read_b64_tr_b16 v[88:89], v25 offset:40960
    v_mfma_f32_16x16x32_bf16 v[224:227], v[80:83], v[36:39], v[224:227]
    ds_read_b128 v[36:39], v18 offset:6656
    s_waitcnt lgkmcnt(8)
    v_mfma_f32_16x16x32_bf16 v[228:231], v[76:79], v[40:43], v[228:231]
    ds_read_b64_tr_b16 v[90:91], v25 offset:45056
    v_mfma_f32_16x16x32_bf16 v[232:235], v[80:83], v[40:43], v[232:235]
    ds_read_b128 v[40:43], v18 offset:6912
    s_waitcnt lgkmcnt(9)
    v_mfma_f32_16x16x32_bf16 v[236:239], v[76:79], v[44:47], v[236:239]
    v_mfma_f32_16x16x32_bf16 v[240:243], v[80:83], v[44:47], v[240:243]
    ds_read_b128 v[44:47], v18 offset:7168
    s_waitcnt lgkmcnt(9)
    v_mfma_f32_16x16x32_bf16 v[244:247], v[76:79], v[48:51], v[244:247]
    v_mfma_f32_16x16x32_bf16 v[248:251], v[80:83], v[48:51], v[248:251]
    ds_read_b128 v[48:51], v18 offset:7424
    s_waitcnt lgkmcnt(3)
    v_mfma_f32_16x16x32_bf16 v[204:207], v[84:87], v[28:31], v[204:207]
    s_barrier
    v_mfma_f32_16x16x32_bf16 v[208:211], v[88:91], v[28:31], v[208:211]
    ds_read_b128 v[28:31], v18 offset:12288
    v_mfma_f32_16x16x32_bf16 v[212:215], v[84:87], v[32:35], v[212:215]
    v_mfma_f32_16x16x32_bf16 v[216:219], v[88:91], v[32:35], v[216:219]
    ds_read_b128 v[32:35], v18 offset:12544
    v_mfma_f32_16x16x32_bf16 v[220:223], v[84:87], v[36:39], v[220:223]
    v_mfma_f32_16x16x32_bf16 v[224:227], v[88:91], v[36:39], v[224:227]
    ds_read_b128 v[36:39], v18 offset:12800
    s_waitcnt lgkmcnt(5)
    v_mfma_f32_16x16x32_bf16 v[228:231], v[84:87], v[40:43], v[228:231]
    v_mfma_f32_16x16x32_bf16 v[232:235], v[88:91], v[40:43], v[232:235]
    ds_read_b128 v[40:43], v18 offset:13056
    s_waitcnt lgkmcnt(5)
    v_mfma_f32_16x16x32_bf16 v[236:239], v[84:87], v[44:47], v[236:239]
    v_mfma_f32_16x16x32_bf16 v[240:243], v[88:91], v[44:47], v[240:243]
    ds_read_b128 v[44:47], v18 offset:13312
    s_waitcnt lgkmcnt(5)
    v_mfma_f32_16x16x32_bf16 v[244:247], v[84:87], v[48:51], v[244:247]
    v_mfma_f32_16x16x32_bf16 v[248:251], v[88:91], v[48:51], v[248:251]
    ds_read_b128 v[48:51], v18 offset:13568
    s_waitcnt lgkmcnt(3)
    v_mfma_f32_16x16x32_bf16 v[204:207], v[172:175], v[28:31], v[204:207]
    v_mfma_f32_16x16x32_bf16 v[208:211], v[176:179], v[28:31], v[208:211]
    ds_read_b128 v[28:31], v18 offset:18432
    v_mfma_f32_16x16x32_bf16 v[212:215], v[172:175], v[32:35], v[212:215]
    v_mfma_f32_16x16x32_bf16 v[216:219], v[176:179], v[32:35], v[216:219]
    ds_read_b128 v[32:35], v18 offset:18688
    v_mfma_f32_16x16x32_bf16 v[220:223], v[172:175], v[36:39], v[220:223]
    v_mfma_f32_16x16x32_bf16 v[224:227], v[176:179], v[36:39], v[224:227]
    ds_read_b128 v[36:39], v18 offset:18944
    s_waitcnt lgkmcnt(5)
    v_mfma_f32_16x16x32_bf16 v[228:231], v[172:175], v[40:43], v[228:231]
    v_mfma_f32_16x16x32_bf16 v[232:235], v[176:179], v[40:43], v[232:235]
    ds_read_b128 v[40:43], v18 offset:19200
    s_waitcnt lgkmcnt(5)
    v_mfma_f32_16x16x32_bf16 v[236:239], v[172:175], v[44:47], v[236:239]
    v_mfma_f32_16x16x32_bf16 v[240:243], v[176:179], v[44:47], v[240:243]
    ds_read_b128 v[44:47], v18 offset:19456
    s_waitcnt lgkmcnt(5)
    v_mfma_f32_16x16x32_bf16 v[244:247], v[172:175], v[48:51], v[244:247]
    v_mfma_f32_16x16x32_bf16 v[248:251], v[176:179], v[48:51], v[248:251]
    ds_read_b128 v[48:51], v18 offset:19712
    s_waitcnt lgkmcnt(3)
    v_mfma_f32_16x16x32_bf16 v[204:207], v[180:183], v[28:31], v[204:207]
    s_barrier
    ds_read_b64_tr_b16 v[76:77], v20 offset:0
    v_mfma_f32_16x16x32_bf16 v[208:211], v[184:187], v[28:31], v[208:211]
    ds_read_b128 v[28:31], v18 offset:24576
    v_mfma_f32_16x16x32_bf16 v[212:215], v[180:183], v[32:35], v[212:215]
    ds_read_b64_tr_b16 v[78:79], v20 offset:4096
    v_mfma_f32_16x16x32_bf16 v[216:219], v[184:187], v[32:35], v[216:219]
    ds_read_b128 v[32:35], v18 offset:24832
    v_mfma_f32_16x16x32_bf16 v[220:223], v[180:183], v[36:39], v[220:223]
    ds_read_b64_tr_b16 v[80:81], v21 offset:0
    v_mfma_f32_16x16x32_bf16 v[224:227], v[184:187], v[36:39], v[224:227]
    ds_read_b128 v[36:39], v18 offset:25088
    s_waitcnt lgkmcnt(8)
    v_mfma_f32_16x16x32_bf16 v[228:231], v[180:183], v[40:43], v[228:231]
    ds_read_b64_tr_b16 v[82:83], v21 offset:4096
    v_mfma_f32_16x16x32_bf16 v[232:235], v[184:187], v[40:43], v[232:235]
    ds_read_b128 v[40:43], v18 offset:25344
    s_waitcnt lgkmcnt(9)
    v_mfma_f32_16x16x32_bf16 v[236:239], v[180:183], v[44:47], v[236:239]
    v_mfma_f32_16x16x32_bf16 v[240:243], v[184:187], v[44:47], v[240:243]
    ds_read_b128 v[44:47], v18 offset:25600
    s_waitcnt lgkmcnt(9)
    v_mfma_f32_16x16x32_bf16 v[244:247], v[180:183], v[48:51], v[244:247]
    v_mfma_f32_16x16x32_bf16 v[248:251], v[184:187], v[48:51], v[248:251]
    ds_read_b128 v[48:51], v18 offset:25856
    s_waitcnt lgkmcnt(3)
    v_mfma_f32_16x16x32_bf16 v[204:207], v[76:79], v[28:31], v[204:207]
    ds_read_b64_tr_b16 v[84:85], v20 offset:8192
    v_mfma_f32_16x16x32_bf16 v[208:211], v[80:83], v[28:31], v[208:211]
    ds_read_b128 v[28:31], v18 offset:30720
    v_mfma_f32_16x16x32_bf16 v[212:215], v[76:79], v[32:35], v[212:215]
    ds_read_b64_tr_b16 v[86:87], v20 offset:12288
    v_mfma_f32_16x16x32_bf16 v[216:219], v[80:83], v[32:35], v[216:219]
    ds_read_b128 v[32:35], v18 offset:30976
    v_mfma_f32_16x16x32_bf16 v[220:223], v[76:79], v[36:39], v[220:223]
    ds_read_b64_tr_b16 v[88:89], v21 offset:8192
    v_mfma_f32_16x16x32_bf16 v[224:227], v[80:83], v[36:39], v[224:227]
    ds_read_b128 v[36:39], v18 offset:31232
    s_waitcnt lgkmcnt(8)
    v_mfma_f32_16x16x32_bf16 v[228:231], v[76:79], v[40:43], v[228:231]
    ds_read_b64_tr_b16 v[90:91], v21 offset:12288
    v_mfma_f32_16x16x32_bf16 v[232:235], v[80:83], v[40:43], v[232:235]
    ds_read_b128 v[40:43], v18 offset:31488
    s_waitcnt lgkmcnt(9)
    v_mfma_f32_16x16x32_bf16 v[236:239], v[76:79], v[44:47], v[236:239]
    v_mfma_f32_16x16x32_bf16 v[240:243], v[80:83], v[44:47], v[240:243]
    ds_read_b128 v[44:47], v18 offset:31744
    s_waitcnt lgkmcnt(9)
    v_mfma_f32_16x16x32_bf16 v[244:247], v[76:79], v[48:51], v[244:247]
    v_mfma_f32_16x16x32_bf16 v[248:251], v[80:83], v[48:51], v[248:251]
    ds_read_b128 v[48:51], v18 offset:32000
    s_waitcnt lgkmcnt(3)
    v_mfma_f32_16x16x32_bf16 v[204:207], v[84:87], v[28:31], v[204:207]
    s_barrier
    ds_read_b64_tr_b16 v[76:77], v20 offset:16384
    v_mfma_f32_16x16x32_bf16 v[208:211], v[88:91], v[28:31], v[208:211]
    ds_read_b128 v[28:31], v18 offset:36864
    v_mfma_f32_16x16x32_bf16 v[212:215], v[84:87], v[32:35], v[212:215]
    ds_read_b64_tr_b16 v[78:79], v20 offset:20480
    v_mfma_f32_16x16x32_bf16 v[216:219], v[88:91], v[32:35], v[216:219]
    ds_read_b128 v[32:35], v18 offset:37120
    v_mfma_f32_16x16x32_bf16 v[220:223], v[84:87], v[36:39], v[220:223]
    ds_read_b64_tr_b16 v[80:81], v21 offset:16384
    v_mfma_f32_16x16x32_bf16 v[224:227], v[88:91], v[36:39], v[224:227]
    ds_read_b128 v[36:39], v18 offset:37376
    s_waitcnt lgkmcnt(8)
    v_mfma_f32_16x16x32_bf16 v[228:231], v[84:87], v[40:43], v[228:231]
    ds_read_b64_tr_b16 v[82:83], v21 offset:20480
    v_mfma_f32_16x16x32_bf16 v[232:235], v[88:91], v[40:43], v[232:235]
    ds_read_b128 v[40:43], v18 offset:37632
    s_waitcnt lgkmcnt(9)
    v_mfma_f32_16x16x32_bf16 v[236:239], v[84:87], v[44:47], v[236:239]
    v_mfma_f32_16x16x32_bf16 v[240:243], v[88:91], v[44:47], v[240:243]
    ds_read_b128 v[44:47], v18 offset:37888
    s_waitcnt lgkmcnt(9)
    v_mfma_f32_16x16x32_bf16 v[244:247], v[84:87], v[48:51], v[244:247]
    v_mfma_f32_16x16x32_bf16 v[248:251], v[88:91], v[48:51], v[248:251]
    ds_read_b128 v[48:51], v18 offset:38144
    s_waitcnt lgkmcnt(3)
    v_mfma_f32_16x16x32_bf16 v[204:207], v[76:79], v[28:31], v[204:207]
    ds_read_b64_tr_b16 v[84:85], v20 offset:24576
    v_mfma_f32_16x16x32_bf16 v[208:211], v[80:83], v[28:31], v[208:211]
    ds_read_b128 v[28:31], v18 offset:43008
    v_mfma_f32_16x16x32_bf16 v[212:215], v[76:79], v[32:35], v[212:215]
    ds_read_b64_tr_b16 v[86:87], v20 offset:28672
    v_mfma_f32_16x16x32_bf16 v[216:219], v[80:83], v[32:35], v[216:219]
    ds_read_b128 v[32:35], v18 offset:43264
    v_mfma_f32_16x16x32_bf16 v[220:223], v[76:79], v[36:39], v[220:223]
    ds_read_b64_tr_b16 v[88:89], v21 offset:24576
    v_mfma_f32_16x16x32_bf16 v[224:227], v[80:83], v[36:39], v[224:227]
    ds_read_b128 v[36:39], v18 offset:43520
    s_waitcnt lgkmcnt(8)
    v_mfma_f32_16x16x32_bf16 v[228:231], v[76:79], v[40:43], v[228:231]
    ds_read_b64_tr_b16 v[90:91], v21 offset:28672
    v_mfma_f32_16x16x32_bf16 v[232:235], v[80:83], v[40:43], v[232:235]
    ds_read_b128 v[40:43], v18 offset:43776
    s_waitcnt lgkmcnt(9)
    v_mfma_f32_16x16x32_bf16 v[236:239], v[76:79], v[44:47], v[236:239]
    v_mfma_f32_16x16x32_bf16 v[240:243], v[80:83], v[44:47], v[240:243]
    ds_read_b128 v[44:47], v18 offset:44032
    s_waitcnt lgkmcnt(9)
    v_mfma_f32_16x16x32_bf16 v[244:247], v[76:79], v[48:51], v[244:247]
    v_mfma_f32_16x16x32_bf16 v[248:251], v[80:83], v[48:51], v[248:251]
    ds_read_b128 v[48:51], v18 offset:44288
    s_waitcnt lgkmcnt(3)
    v_mfma_f32_16x16x32_bf16 v[204:207], v[84:87], v[28:31], v[204:207]
    s_barrier
    v_mfma_f32_16x16x32_bf16 v[208:211], v[88:91], v[28:31], v[208:211]
    ds_read_b128 v[28:31], v18 offset:49152
    v_mfma_f32_16x16x32_bf16 v[212:215], v[84:87], v[32:35], v[212:215]
    v_mfma_f32_16x16x32_bf16 v[216:219], v[88:91], v[32:35], v[216:219]
    ds_read_b128 v[32:35], v18 offset:49408
    v_mfma_f32_16x16x32_bf16 v[220:223], v[84:87], v[36:39], v[220:223]
    v_mfma_f32_16x16x32_bf16 v[224:227], v[88:91], v[36:39], v[224:227]
    ds_read_b128 v[36:39], v18 offset:49664
    s_waitcnt lgkmcnt(5)
    v_mfma_f32_16x16x32_bf16 v[228:231], v[84:87], v[40:43], v[228:231]
    v_mfma_f32_16x16x32_bf16 v[232:235], v[88:91], v[40:43], v[232:235]
    ds_read_b128 v[40:43], v18 offset:49920
    s_waitcnt lgkmcnt(5)
    v_mfma_f32_16x16x32_bf16 v[236:239], v[84:87], v[44:47], v[236:239]
    v_mfma_f32_16x16x32_bf16 v[240:243], v[88:91], v[44:47], v[240:243]
    ds_read_b128 v[44:47], v18 offset:50176
    s_waitcnt lgkmcnt(5)
    v_mfma_f32_16x16x32_bf16 v[244:247], v[84:87], v[48:51], v[244:247]
    v_mfma_f32_16x16x32_bf16 v[248:251], v[88:91], v[48:51], v[248:251]
    ds_read_b128 v[48:51], v18 offset:50432
    s_waitcnt lgkmcnt(3)
    v_mfma_f32_16x16x32_bf16 v[204:207], v[188:191], v[28:31], v[204:207]
    v_mfma_f32_16x16x32_bf16 v[208:211], v[192:195], v[28:31], v[208:211]
    ds_read_b128 v[28:31], v18 offset:55296
    v_mfma_f32_16x16x32_bf16 v[212:215], v[188:191], v[32:35], v[212:215]
    v_mfma_f32_16x16x32_bf16 v[216:219], v[192:195], v[32:35], v[216:219]
    ds_read_b128 v[32:35], v18 offset:55552
    v_mfma_f32_16x16x32_bf16 v[220:223], v[188:191], v[36:39], v[220:223]
    v_mfma_f32_16x16x32_bf16 v[224:227], v[192:195], v[36:39], v[224:227]
    ds_read_b128 v[36:39], v18 offset:55808
    s_waitcnt lgkmcnt(5)
    v_mfma_f32_16x16x32_bf16 v[228:231], v[188:191], v[40:43], v[228:231]
    v_mfma_f32_16x16x32_bf16 v[232:235], v[192:195], v[40:43], v[232:235]
    ds_read_b128 v[40:43], v18 offset:56064
    s_waitcnt lgkmcnt(5)
    s_branch L_skip_5
    s_nop 0
L_stub_5:
    s_branch L_stub_6
L_skip_5:
    v_mfma_f32_16x16x32_bf16 v[236:239], v[188:191], v[44:47], v[236:239]
    v_mfma_f32_16x16x32_bf16 v[240:243], v[192:195], v[44:47], v[240:243]
    ds_read_b128 v[44:47], v18 offset:56320
    s_waitcnt lgkmcnt(5)
    v_mfma_f32_16x16x32_bf16 v[244:247], v[188:191], v[48:51], v[244:247]
    v_mfma_f32_16x16x32_bf16 v[248:251], v[192:195], v[48:51], v[248:251]
    ds_read_b128 v[48:51], v18 offset:56576
    s_waitcnt lgkmcnt(3)
    v_mfma_f32_16x16x32_bf16 v[204:207], v[196:199], v[28:31], v[204:207]
    s_barrier
    ds_read_b64_tr_b16 v[76:77], v20 offset:32768
    v_mfma_f32_16x16x32_bf16 v[208:211], v[200:203], v[28:31], v[208:211]
    ds_read_b128 v[28:31], v18 offset:0
    v_mfma_f32_16x16x32_bf16 v[212:215], v[196:199], v[32:35], v[212:215]
    ds_read_b64_tr_b16 v[78:79], v20 offset:36864
    v_mfma_f32_16x16x32_bf16 v[216:219], v[200:203], v[32:35], v[216:219]
    ds_read_b128 v[32:35], v18 offset:256
    v_mfma_f32_16x16x32_bf16 v[220:223], v[196:199], v[36:39], v[220:223]
    ds_read_b64_tr_b16 v[80:81], v21 offset:32768
    v_mfma_f32_16x16x32_bf16 v[224:227], v[200:203], v[36:39], v[224:227]
    ds_read_b128 v[36:39], v18 offset:512
    s_waitcnt lgkmcnt(8)
    v_mfma_f32_16x16x32_bf16 v[228:231], v[196:199], v[40:43], v[228:231]
    ds_read_b64_tr_b16 v[82:83], v21 offset:36864
    v_mfma_f32_16x16x32_bf16 v[232:235], v[200:203], v[40:43], v[232:235]
    ds_read_b128 v[40:43], v18 offset:768
    s_waitcnt lgkmcnt(9)
    v_mfma_f32_16x16x32_bf16 v[236:239], v[196:199], v[44:47], v[236:239]
    v_mfma_f32_16x16x32_bf16 v[240:243], v[200:203], v[44:47], v[240:243]
    ds_read_b128 v[44:47], v18 offset:1024
    s_waitcnt lgkmcnt(9)
    v_mfma_f32_16x16x32_bf16 v[244:247], v[196:199], v[48:51], v[244:247]
    v_mfma_f32_16x16x32_bf16 v[248:251], v[200:203], v[48:51], v[248:251]
    ds_read_b128 v[48:51], v18 offset:1280
    s_waitcnt lgkmcnt(3)
    v_mfma_f32_16x16x32_bf16 v[204:207], v[76:79], v[28:31], v[204:207]
    ds_read_b64_tr_b16 v[84:85], v20 offset:40960
    v_mfma_f32_16x16x32_bf16 v[208:211], v[80:83], v[28:31], v[208:211]
    ds_read_b128 v[28:31], v18 offset:6144
    v_mfma_f32_16x16x32_bf16 v[212:215], v[76:79], v[32:35], v[212:215]
    ds_read_b64_tr_b16 v[86:87], v20 offset:45056
    v_mfma_f32_16x16x32_bf16 v[216:219], v[80:83], v[32:35], v[216:219]
    ds_read_b128 v[32:35], v18 offset:6400
    v_mfma_f32_16x16x32_bf16 v[220:223], v[76:79], v[36:39], v[220:223]
    ds_read_b64_tr_b16 v[88:89], v21 offset:40960
    v_mfma_f32_16x16x32_bf16 v[224:227], v[80:83], v[36:39], v[224:227]
    ds_read_b128 v[36:39], v18 offset:6656
    s_waitcnt lgkmcnt(8)
    v_mfma_f32_16x16x32_bf16 v[228:231], v[76:79], v[40:43], v[228:231]
    ds_read_b64_tr_b16 v[90:91], v21 offset:45056
    v_mfma_f32_16x16x32_bf16 v[232:235], v[80:83], v[40:43], v[232:235]
    ds_read_b128 v[40:43], v18 offset:6912
    s_waitcnt lgkmcnt(9)
    v_mfma_f32_16x16x32_bf16 v[236:239], v[76:79], v[44:47], v[236:239]
    v_mfma_f32_16x16x32_bf16 v[240:243], v[80:83], v[44:47], v[240:243]
    ds_read_b128 v[44:47], v18 offset:7168
    s_waitcnt lgkmcnt(9)
    v_mfma_f32_16x16x32_bf16 v[244:247], v[76:79], v[48:51], v[244:247]
    v_mfma_f32_16x16x32_bf16 v[248:251], v[80:83], v[48:51], v[248:251]
    ds_read_b128 v[48:51], v18 offset:7424
    s_waitcnt lgkmcnt(3)
    v_mfma_f32_16x16x32_bf16 v[204:207], v[84:87], v[28:31], v[204:207]
    s_barrier
    ds_read_b64_tr_b16 v[76:77], v24 offset:0
    v_mfma_f32_16x16x32_bf16 v[208:211], v[88:91], v[28:31], v[208:211]
    ds_read_b128 v[28:31], v18 offset:12288
    v_mfma_f32_16x16x32_bf16 v[212:215], v[84:87], v[32:35], v[212:215]
    ds_read_b64_tr_b16 v[78:79], v24 offset:4096
    v_mfma_f32_16x16x32_bf16 v[216:219], v[88:91], v[32:35], v[216:219]
    ds_read_b128 v[32:35], v18 offset:12544
    v_mfma_f32_16x16x32_bf16 v[220:223], v[84:87], v[36:39], v[220:223]
    ds_read_b64_tr_b16 v[80:81], v25 offset:0
    v_mfma_f32_16x16x32_bf16 v[224:227], v[88:91], v[36:39], v[224:227]
    ds_read_b128 v[36:39], v18 offset:12800
    s_waitcnt lgkmcnt(8)
    v_mfma_f32_16x16x32_bf16 v[228:231], v[84:87], v[40:43], v[228:231]
    ds_read_b64_tr_b16 v[82:83], v25 offset:4096
    v_mfma_f32_16x16x32_bf16 v[232:235], v[88:91], v[40:43], v[232:235]
    ds_read_b128 v[40:43], v18 offset:13056
    s_waitcnt lgkmcnt(9)
    v_mfma_f32_16x16x32_bf16 v[236:239], v[84:87], v[44:47], v[236:239]
    v_mfma_f32_16x16x32_bf16 v[240:243], v[88:91], v[44:47], v[240:243]
    ds_read_b128 v[44:47], v18 offset:13312
    s_waitcnt lgkmcnt(9)
    v_mfma_f32_16x16x32_bf16 v[244:247], v[84:87], v[48:51], v[244:247]
    v_mfma_f32_16x16x32_bf16 v[248:251], v[88:91], v[48:51], v[248:251]
    ds_read_b128 v[48:51], v18 offset:13568
    s_waitcnt lgkmcnt(3)
    v_mfma_f32_16x16x32_bf16 v[204:207], v[76:79], v[28:31], v[204:207]
    ds_read_b64_tr_b16 v[84:85], v24 offset:8192
    v_mfma_f32_16x16x32_bf16 v[208:211], v[80:83], v[28:31], v[208:211]
    ds_read_b128 v[28:31], v18 offset:18432
    v_mfma_f32_16x16x32_bf16 v[212:215], v[76:79], v[32:35], v[212:215]
    ds_read_b64_tr_b16 v[86:87], v24 offset:12288
    v_mfma_f32_16x16x32_bf16 v[216:219], v[80:83], v[32:35], v[216:219]
    ds_read_b128 v[32:35], v18 offset:18688
    v_mfma_f32_16x16x32_bf16 v[220:223], v[76:79], v[36:39], v[220:223]
    ds_read_b64_tr_b16 v[88:89], v25 offset:8192
    v_mfma_f32_16x16x32_bf16 v[224:227], v[80:83], v[36:39], v[224:227]
    ds_read_b128 v[36:39], v18 offset:18944
    s_waitcnt lgkmcnt(8)
    v_mfma_f32_16x16x32_bf16 v[228:231], v[76:79], v[40:43], v[228:231]
    ds_read_b64_tr_b16 v[90:91], v25 offset:12288
    v_mfma_f32_16x16x32_bf16 v[232:235], v[80:83], v[40:43], v[232:235]
    ds_read_b128 v[40:43], v18 offset:19200
    s_waitcnt lgkmcnt(9)
    v_mfma_f32_16x16x32_bf16 v[236:239], v[76:79], v[44:47], v[236:239]
    v_mfma_f32_16x16x32_bf16 v[240:243], v[80:83], v[44:47], v[240:243]
    ds_read_b128 v[44:47], v18 offset:19456
    s_waitcnt lgkmcnt(9)
    v_mfma_f32_16x16x32_bf16 v[244:247], v[76:79], v[48:51], v[244:247]
    v_mfma_f32_16x16x32_bf16 v[248:251], v[80:83], v[48:51], v[248:251]
    ds_read_b128 v[48:51], v18 offset:19712
    s_waitcnt lgkmcnt(3)
    v_mfma_f32_16x16x32_bf16 v[204:207], v[84:87], v[28:31], v[204:207]
    s_barrier
    v_mfma_f32_16x16x32_bf16 v[208:211], v[88:91], v[28:31], v[208:211]
    ds_read_b128 v[28:31], v18 offset:24576
    v_mfma_f32_16x16x32_bf16 v[212:215], v[84:87], v[32:35], v[212:215]
    v_mfma_f32_16x16x32_bf16 v[216:219], v[88:91], v[32:35], v[216:219]
    ds_read_b128 v[32:35], v18 offset:24832
    v_mfma_f32_16x16x32_bf16 v[220:223], v[84:87], v[36:39], v[220:223]
    v_mfma_f32_16x16x32_bf16 v[224:227], v[88:91], v[36:39], v[224:227]
    ds_read_b128 v[36:39], v18 offset:25088
    s_waitcnt lgkmcnt(5)
    v_mfma_f32_16x16x32_bf16 v[228:231], v[84:87], v[40:43], v[228:231]
    v_mfma_f32_16x16x32_bf16 v[232:235], v[88:91], v[40:43], v[232:235]
    ds_read_b128 v[40:43], v18 offset:25344
    s_waitcnt lgkmcnt(5)
    v_mfma_f32_16x16x32_bf16 v[236:239], v[84:87], v[44:47], v[236:239]
    v_mfma_f32_16x16x32_bf16 v[240:243], v[88:91], v[44:47], v[240:243]
    ds_read_b128 v[44:47], v18 offset:25600
    s_waitcnt lgkmcnt(5)
    v_mfma_f32_16x16x32_bf16 v[244:247], v[84:87], v[48:51], v[244:247]
    v_mfma_f32_16x16x32_bf16 v[248:251], v[88:91], v[48:51], v[248:251]
    ds_read_b128 v[48:51], v18 offset:25856
    s_waitcnt lgkmcnt(3)
    v_mfma_f32_16x16x32_bf16 v[204:207], v[52:55], v[28:31], v[204:207]
    v_mfma_f32_16x16x32_bf16 v[208:211], v[56:59], v[28:31], v[208:211]
    ds_read_b128 v[28:31], v18 offset:30720
    v_mfma_f32_16x16x32_bf16 v[212:215], v[52:55], v[32:35], v[212:215]
    v_mfma_f32_16x16x32_bf16 v[216:219], v[56:59], v[32:35], v[216:219]
    ds_read_b128 v[32:35], v18 offset:30976
    v_mfma_f32_16x16x32_bf16 v[220:223], v[52:55], v[36:39], v[220:223]
    v_mfma_f32_16x16x32_bf16 v[224:227], v[56:59], v[36:39], v[224:227]
    ds_read_b128 v[36:39], v18 offset:31232
    s_waitcnt lgkmcnt(5)
    v_mfma_f32_16x16x32_bf16 v[228:231], v[52:55], v[40:43], v[228:231]
    v_mfma_f32_16x16x32_bf16 v[232:235], v[56:59], v[40:43], v[232:235]
    ds_read_b128 v[40:43], v18 offset:31488
    s_waitcnt lgkmcnt(5)
    v_mfma_f32_16x16x32_bf16 v[236:239], v[52:55], v[44:47], v[236:239]
    v_mfma_f32_16x16x32_bf16 v[240:243], v[56:59], v[44:47], v[240:243]
    ds_read_b128 v[44:47], v18 offset:31744
    s_waitcnt lgkmcnt(5)
    v_mfma_f32_16x16x32_bf16 v[244:247], v[52:55], v[48:51], v[244:247]
    v_mfma_f32_16x16x32_bf16 v[248:251], v[56:59], v[48:51], v[248:251]
    ds_read_b128 v[48:51], v18 offset:32000
    s_waitcnt lgkmcnt(3)
    v_mfma_f32_16x16x32_bf16 v[204:207], v[60:63], v[28:31], v[204:207]
    s_barrier
    ds_read_b64_tr_b16 v[76:77], v24 offset:16384
    v_mfma_f32_16x16x32_bf16 v[208:211], v[64:67], v[28:31], v[208:211]
    ds_read_b128 v[28:31], v18 offset:36864
    v_mfma_f32_16x16x32_bf16 v[212:215], v[60:63], v[32:35], v[212:215]
    ds_read_b64_tr_b16 v[78:79], v24 offset:20480
    v_mfma_f32_16x16x32_bf16 v[216:219], v[64:67], v[32:35], v[216:219]
    ds_read_b128 v[32:35], v18 offset:37120
    v_mfma_f32_16x16x32_bf16 v[220:223], v[60:63], v[36:39], v[220:223]
    ds_read_b64_tr_b16 v[80:81], v25 offset:16384
    v_mfma_f32_16x16x32_bf16 v[224:227], v[64:67], v[36:39], v[224:227]
    ds_read_b128 v[36:39], v18 offset:37376
    s_waitcnt lgkmcnt(8)
    v_mfma_f32_16x16x32_bf16 v[228:231], v[60:63], v[40:43], v[228:231]
    ds_read_b64_tr_b16 v[82:83], v25 offset:20480
    v_mfma_f32_16x16x32_bf16 v[232:235], v[64:67], v[40:43], v[232:235]
    ds_read_b128 v[40:43], v18 offset:37632
    s_waitcnt lgkmcnt(9)
    v_mfma_f32_16x16x32_bf16 v[236:239], v[60:63], v[44:47], v[236:239]
    v_mfma_f32_16x16x32_bf16 v[240:243], v[64:67], v[44:47], v[240:243]
    ds_read_b128 v[44:47], v18 offset:37888
    s_waitcnt lgkmcnt(9)
    v_mfma_f32_16x16x32_bf16 v[244:247], v[60:63], v[48:51], v[244:247]
    v_mfma_f32_16x16x32_bf16 v[248:251], v[64:67], v[48:51], v[248:251]
    ds_read_b128 v[48:51], v18 offset:38144
    s_waitcnt lgkmcnt(3)
    v_mfma_f32_16x16x32_bf16 v[204:207], v[76:79], v[28:31], v[204:207]
    ds_read_b64_tr_b16 v[84:85], v24 offset:24576
    v_mfma_f32_16x16x32_bf16 v[208:211], v[80:83], v[28:31], v[208:211]
    ds_read_b128 v[28:31], v18 offset:43008
    v_mfma_f32_16x16x32_bf16 v[212:215], v[76:79], v[32:35], v[212:215]
    ds_read_b64_tr_b16 v[86:87], v24 offset:28672
    v_mfma_f32_16x16x32_bf16 v[216:219], v[80:83], v[32:35], v[216:219]
    ds_read_b128 v[32:35], v18 offset:43264
    v_mfma_f32_16x16x32_bf16 v[220:223], v[76:79], v[36:39], v[220:223]
    ds_read_b64_tr_b16 v[88:89], v25 offset:24576
    v_mfma_f32_16x16x32_bf16 v[224:227], v[80:83], v[36:39], v[224:227]
    ds_read_b128 v[36:39], v18 offset:43520
    s_waitcnt lgkmcnt(8)
    v_mfma_f32_16x16x32_bf16 v[228:231], v[76:79], v[40:43], v[228:231]
    ds_read_b64_tr_b16 v[90:91], v25 offset:28672
    v_mfma_f32_16x16x32_bf16 v[232:235], v[80:83], v[40:43], v[232:235]
    ds_read_b128 v[40:43], v18 offset:43776
    s_waitcnt lgkmcnt(9)
    v_mfma_f32_16x16x32_bf16 v[236:239], v[76:79], v[44:47], v[236:239]
    v_mfma_f32_16x16x32_bf16 v[240:243], v[80:83], v[44:47], v[240:243]
    ds_read_b128 v[44:47], v18 offset:44032
    s_waitcnt lgkmcnt(9)
    v_mfma_f32_16x16x32_bf16 v[244:247], v[76:79], v[48:51], v[244:247]
    v_mfma_f32_16x16x32_bf16 v[248:251], v[80:83], v[48:51], v[248:251]
    ds_read_b128 v[48:51], v18 offset:44288
    s_waitcnt lgkmcnt(3)
    v_mfma_f32_16x16x32_bf16 v[204:207], v[84:87], v[28:31], v[204:207]
    s_barrier
    ds_read_b64_tr_b16 v[76:77], v24 offset:32768
    v_mfma_f32_16x16x32_bf16 v[208:211], v[88:91], v[28:31], v[208:211]
    ds_read_b128 v[28:31], v18 offset:49152
    v_mfma_f32_16x16x32_bf16 v[212:215], v[84:87], v[32:35], v[212:215]
    ds_read_b64_tr_b16 v[78:79], v24 offset:36864
    v_mfma_f32_16x16x32_bf16 v[216:219], v[88:91], v[32:35], v[216:219]
    ds_read_b128 v[32:35], v18 offset:49408
    v_mfma_f32_16x16x32_bf16 v[220:223], v[84:87], v[36:39], v[220:223]
    ds_read_b64_tr_b16 v[80:81], v25 offset:32768
    v_mfma_f32_16x16x32_bf16 v[224:227], v[88:91], v[36:39], v[224:227]
    ds_read_b128 v[36:39], v18 offset:49664
    s_waitcnt lgkmcnt(8)
    v_mfma_f32_16x16x32_bf16 v[228:231], v[84:87], v[40:43], v[228:231]
    ds_read_b64_tr_b16 v[82:83], v25 offset:36864
    v_mfma_f32_16x16x32_bf16 v[232:235], v[88:91], v[40:43], v[232:235]
    ds_read_b128 v[40:43], v18 offset:49920
    s_waitcnt lgkmcnt(9)
    v_mfma_f32_16x16x32_bf16 v[236:239], v[84:87], v[44:47], v[236:239]
    v_mfma_f32_16x16x32_bf16 v[240:243], v[88:91], v[44:47], v[240:243]
    ds_read_b128 v[44:47], v18 offset:50176
    s_waitcnt lgkmcnt(9)
    v_mfma_f32_16x16x32_bf16 v[244:247], v[84:87], v[48:51], v[244:247]
    v_mfma_f32_16x16x32_bf16 v[248:251], v[88:91], v[48:51], v[248:251]
    ds_read_b128 v[48:51], v18 offset:50432
    s_waitcnt lgkmcnt(3)
    v_mfma_f32_16x16x32_bf16 v[204:207], v[76:79], v[28:31], v[204:207]
    ds_read_b64_tr_b16 v[84:85], v24 offset:40960
    v_mfma_f32_16x16x32_bf16 v[208:211], v[80:83], v[28:31], v[208:211]
    ds_read_b128 v[28:31], v18 offset:55296
    v_mfma_f32_16x16x32_bf16 v[212:215], v[76:79], v[32:35], v[212:215]
    ds_read_b64_tr_b16 v[86:87], v24 offset:45056
    v_mfma_f32_16x16x32_bf16 v[216:219], v[80:83], v[32:35], v[216:219]
    ds_read_b128 v[32:35], v18 offset:55552
    v_mfma_f32_16x16x32_bf16 v[220:223], v[76:79], v[36:39], v[220:223]
    ds_read_b64_tr_b16 v[88:89], v25 offset:40960
    v_mfma_f32_16x16x32_bf16 v[224:227], v[80:83], v[36:39], v[224:227]
    ds_read_b128 v[36:39], v18 offset:55808
    s_waitcnt lgkmcnt(8)
    v_mfma_f32_16x16x32_bf16 v[228:231], v[76:79], v[40:43], v[228:231]
    ds_read_b64_tr_b16 v[90:91], v25 offset:45056
    v_mfma_f32_16x16x32_bf16 v[232:235], v[80:83], v[40:43], v[232:235]
    ds_read_b128 v[40:43], v18 offset:56064
    s_waitcnt lgkmcnt(9)
    v_mfma_f32_16x16x32_bf16 v[236:239], v[76:79], v[44:47], v[236:239]
    v_mfma_f32_16x16x32_bf16 v[240:243], v[80:83], v[44:47], v[240:243]
    ds_read_b128 v[44:47], v18 offset:56320
    s_waitcnt lgkmcnt(9)
    v_mfma_f32_16x16x32_bf16 v[244:247], v[76:79], v[48:51], v[244:247]
    v_mfma_f32_16x16x32_bf16 v[248:251], v[80:83], v[48:51], v[248:251]
    ds_read_b128 v[48:51], v18 offset:56576
    s_waitcnt lgkmcnt(3)
    v_mfma_f32_16x16x32_bf16 v[204:207], v[84:87], v[28:31], v[204:207]
    s_barrier
    ds_read_b64_tr_b16 v[76:77], v20 offset:0
    v_mfma_f32_16x16x32_bf16 v[208:211], v[88:91], v[28:31], v[208:211]
    ds_read_b128 v[28:31], v18 offset:0
    v_mfma_f32_16x16x32_bf16 v[212:215], v[84:87], v[32:35], v[212:215]
    ds_read_b64_tr_b16 v[78:79], v20 offset:4096
    v_mfma_f32_16x16x32_bf16 v[216:219], v[88:91], v[32:35], v[216:219]
    ds_read_b128 v[32:35], v18 offset:256
    v_mfma_f32_16x16x32_bf16 v[220:223], v[84:87], v[36:39], v[220:223]
    ds_read_b64_tr_b16 v[80:81], v21 offset:0
    v_mfma_f32_16x16x32_bf16 v[224:227], v[88:91], v[36:39], v[224:227]
    ds_read_b128 v[36:39], v18 offset:512
    s_waitcnt lgkmcnt(8)
    v_mfma_f32_16x16x32_bf16 v[228:231], v[84:87], v[40:43], v[228:231]
    ds_read_b64_tr_b16 v[82:83], v21 offset:4096
    v_mfma_f32_16x16x32_bf16 v[232:235], v[88:91], v[40:43], v[232:235]
    ds_read_b128 v[40:43], v18 offset:768
    s_waitcnt lgkmcnt(9)
    v_mfma_f32_16x16x32_bf16 v[236:239], v[84:87], v[44:47], v[236:239]
    v_mfma_f32_16x16x32_bf16 v[240:243], v[88:91], v[44:47], v[240:243]
    ds_read_b128 v[44:47], v18 offset:1024
    s_waitcnt lgkmcnt(9)
    v_mfma_f32_16x16x32_bf16 v[244:247], v[84:87], v[48:51], v[244:247]
    v_mfma_f32_16x16x32_bf16 v[248:251], v[88:91], v[48:51], v[248:251]
    ds_read_b128 v[48:51], v18 offset:1280
    s_waitcnt lgkmcnt(3)
    v_mfma_f32_16x16x32_bf16 v[204:207], v[76:79], v[28:31], v[204:207]
    ds_read_b64_tr_b16 v[84:85], v20 offset:8192
    v_mfma_f32_16x16x32_bf16 v[208:211], v[80:83], v[28:31], v[208:211]
    ds_read_b128 v[28:31], v18 offset:6144
    v_mfma_f32_16x16x32_bf16 v[212:215], v[76:79], v[32:35], v[212:215]
    ds_read_b64_tr_b16 v[86:87], v20 offset:12288
    v_mfma_f32_16x16x32_bf16 v[216:219], v[80:83], v[32:35], v[216:219]
    ds_read_b128 v[32:35], v18 offset:6400
    v_mfma_f32_16x16x32_bf16 v[220:223], v[76:79], v[36:39], v[220:223]
    ds_read_b64_tr_b16 v[88:89], v21 offset:8192
    v_mfma_f32_16x16x32_bf16 v[224:227], v[80:83], v[36:39], v[224:227]
    ds_read_b128 v[36:39], v18 offset:6656
    s_waitcnt lgkmcnt(8)
    v_mfma_f32_16x16x32_bf16 v[228:231], v[76:79], v[40:43], v[228:231]
    ds_read_b64_tr_b16 v[90:91], v21 offset:12288
    v_mfma_f32_16x16x32_bf16 v[232:235], v[80:83], v[40:43], v[232:235]
    ds_read_b128 v[40:43], v18 offset:6912
    s_waitcnt lgkmcnt(9)
    v_mfma_f32_16x16x32_bf16 v[236:239], v[76:79], v[44:47], v[236:239]
    v_mfma_f32_16x16x32_bf16 v[240:243], v[80:83], v[44:47], v[240:243]
    ds_read_b128 v[44:47], v18 offset:7168
    s_waitcnt lgkmcnt(9)
    v_mfma_f32_16x16x32_bf16 v[244:247], v[76:79], v[48:51], v[244:247]
    v_mfma_f32_16x16x32_bf16 v[248:251], v[80:83], v[48:51], v[248:251]
    ds_read_b128 v[48:51], v18 offset:7424
    s_waitcnt lgkmcnt(3)
    v_mfma_f32_16x16x32_bf16 v[204:207], v[84:87], v[28:31], v[204:207]
    s_barrier
    ds_read_b64_tr_b16 v[76:77], v20 offset:16384
    v_mfma_f32_16x16x32_bf16 v[208:211], v[88:91], v[28:31], v[208:211]
    ds_read_b128 v[28:31], v18 offset:12288
    v_mfma_f32_16x16x32_bf16 v[212:215], v[84:87], v[32:35], v[212:215]
    ds_read_b64_tr_b16 v[78:79], v20 offset:20480
    v_mfma_f32_16x16x32_bf16 v[216:219], v[88:91], v[32:35], v[216:219]
    ds_read_b128 v[32:35], v18 offset:12544
    v_mfma_f32_16x16x32_bf16 v[220:223], v[84:87], v[36:39], v[220:223]
    ds_read_b64_tr_b16 v[80:81], v21 offset:16384
    v_mfma_f32_16x16x32_bf16 v[224:227], v[88:91], v[36:39], v[224:227]
    ds_read_b128 v[36:39], v18 offset:12800
    s_waitcnt lgkmcnt(8)
    v_mfma_f32_16x16x32_bf16 v[228:231], v[84:87], v[40:43], v[228:231]
    ds_read_b64_tr_b16 v[82:83], v21 offset:20480
    v_mfma_f32_16x16x32_bf16 v[232:235], v[88:91], v[40:43], v[232:235]
    ds_read_b128 v[40:43], v18 offset:13056
    s_waitcnt lgkmcnt(9)
    v_mfma_f32_16x16x32_bf16 v[236:239], v[84:87], v[44:47], v[236:239]
    v_mfma_f32_16x16x32_bf16 v[240:243], v[88:91], v[44:47], v[240:243]
    ds_read_b128 v[44:47], v18 offset:13312
    s_waitcnt lgkmcnt(9)
    v_mfma_f32_16x16x32_bf16 v[244:247], v[84:87], v[48:51], v[244:247]
    v_mfma_f32_16x16x32_bf16 v[248:251], v[88:91], v[48:51], v[248:251]
    ds_read_b128 v[48:51], v18 offset:13568
    s_waitcnt lgkmcnt(3)
    v_mfma_f32_16x16x32_bf16 v[204:207], v[76:79], v[28:31], v[204:207]
    ds_read_b64_tr_b16 v[84:85], v20 offset:24576
    v_mfma_f32_16x16x32_bf16 v[208:211], v[80:83], v[28:31], v[208:211]
    ds_read_b128 v[28:31], v18 offset:18432
    v_mfma_f32_16x16x32_bf16 v[212:215], v[76:79], v[32:35], v[212:215]
    ds_read_b64_tr_b16 v[86:87], v20 offset:28672
    v_mfma_f32_16x16x32_bf16 v[216:219], v[80:83], v[32:35], v[216:219]
    ds_read_b128 v[32:35], v18 offset:18688
    v_mfma_f32_16x16x32_bf16 v[220:223], v[76:79], v[36:39], v[220:223]
    ds_read_b64_tr_b16 v[88:89], v21 offset:24576
    v_mfma_f32_16x16x32_bf16 v[224:227], v[80:83], v[36:39], v[224:227]
    ds_read_b128 v[36:39], v18 offset:18944
    s_waitcnt lgkmcnt(8)
    v_mfma_f32_16x16x32_bf16 v[228:231], v[76:79], v[40:43], v[228:231]
    ds_read_b64_tr_b16 v[90:91], v21 offset:28672
    v_mfma_f32_16x16x32_bf16 v[232:235], v[80:83], v[40:43], v[232:235]
    ds_read_b128 v[40:43], v18 offset:19200
    s_waitcnt lgkmcnt(9)
    v_mfma_f32_16x16x32_bf16 v[236:239], v[76:79], v[44:47], v[236:239]
    v_mfma_f32_16x16x32_bf16 v[240:243], v[80:83], v[44:47], v[240:243]
    ds_read_b128 v[44:47], v18 offset:19456
    s_waitcnt lgkmcnt(9)
    v_mfma_f32_16x16x32_bf16 v[244:247], v[76:79], v[48:51], v[244:247]
    v_mfma_f32_16x16x32_bf16 v[248:251], v[80:83], v[48:51], v[248:251]
    ds_read_b128 v[48:51], v18 offset:19712
    s_waitcnt lgkmcnt(0)
    s_lshl_b32 s48, s51, 2
    s_add_u32 s48, s48, s3
    s_mul_i32 s48, s48, 36864
    s_mul_i32 s49, s52, 1536
    s_add_u32 s48, s48, s49
    s_add_u32 s48, s48, 20971520
    v_mul_u32_u24 v22, 9216, v2
    v_lshl_add_u32 v22, v1, 4, v22
    s_mov_b32 s60, 0xbdd2d3e8
    v_mov_b32 v4, 0xc0135761
    s_barrier
    v_mfma_f32_16x16x32_bf16 v[204:207], v[84:87], v[28:31], v[204:207]
    v_mfma_f32_16x16x32_bf16 v[208:211], v[88:91], v[28:31], v[208:211]
    v_mfma_f32_16x16x32_bf16 v[212:215], v[84:87], v[32:35], v[212:215]
    v_mfma_f32_16x16x32_bf16 v[216:219], v[88:91], v[32:35], v[216:219]
    s_nop 4
    v_pk_mul_f32 v[92:93], v[204:205], v[204:205]
    v_pk_mul_f32 v[94:95], v[206:207], v[206:207]
    v_pk_mul_f32 v[96:97], v[208:209], v[208:209]
    s_nop 0
    v_mfma_f32_16x16x32_bf16 v[220:223], v[84:87], v[36:39], v[220:223]
    v_pk_mul_f32 v[98:99], v[210:211], v[210:211]
    v_pk_fma_f32 v[92:93], v[92:93], s[60:61], v[4:5] op_sel_hi:[1,0,0]
    v_pk_fma_f32 v[94:95], v[94:95], s[60:61], v[4:5] op_sel_hi:[1,0,0]
    s_nop 0
    v_mfma_f32_16x16x32_bf16 v[224:227], v[88:91], v[36:39], v[224:227]
    v_pk_fma_f32 v[96:97], v[96:97], s[60:61], v[4:5] op_sel_hi:[1,0,0]
    v_pk_fma_f32 v[98:99], v[98:99], s[60:61], v[4:5] op_sel_hi:[1,0,0]
    v_pk_mul_f32 v[92:93], v[92:93], v[204:205]
    s_nop 0
    v_mfma_f32_16x16x32_bf16 v[228:231], v[84:87], v[40:43], v[228:231]
    v_pk_mul_f32 v[94:95], v[94:95], v[206:207]
    v_pk_mul_f32 v[96:97], v[96:97], v[208:209]
    v_pk_mul_f32 v[98:99], v[98:99], v[210:211]
    s_nop 0
    v_mfma_f32_16x16x32_bf16 v[232:235], v[88:91], v[40:43], v[232:235]
    v_exp_f32 v92, v92
    v_exp_f32 v93, v93
    v_exp_f32 v94, v94
    s_nop 0
    v_mfma_f32_16x16x32_bf16 v[236:239], v[84:87], v[44:47], v[236:239]
    v_exp_f32 v95, v95
    v_exp_f32 v96, v96
    v_exp_f32 v97, v97
    s_nop 0
    v_mfma_f32_16x16x32_bf16 v[240:243], v[88:91], v[44:47], v[240:243]
    v_exp_f32 v98, v98
    v_exp_f32 v99, v99
    v_pk_add_f32 v[92:93], v[92:93], 1.0 op_sel_hi:[1,0]
    s_nop 0
    v_mfma_f32_16x16x32_bf16 v[244:247], v[84:87], v[48:51], v[244:247]
    v_pk_add_f32 v[94:95], v[94:95], 1.0 op_sel_hi:[1,0]
    v_pk_add_f32 v[96:97], v[96:97], 1.0 op_sel_hi:[1,0]
    v_pk_add_f32 v[98:99], v[98:99], 1.0 op_sel_hi:[1,0]
    s_nop 0
    v_mfma_f32_16x16x32_bf16 v[248:251], v[88:91], v[48:51], v[248:251]
    v_rcp_f32 v92, v92
    v_rcp_f32 v93, v93
    v_rcp_f32 v94, v94
    v_rcp_f32 v95, v95
    v_rcp_f32 v96, v96
    v_rcp_f32 v97, v97
    v_rcp_f32 v98, v98
    v_rcp_f32 v99, v99
    v_pk_mul_f32 v[92:93], v[92:93], v[204:205]
    v_pk_mul_f32 v[94:95], v[94:95], v[206:207]
    v_pk_mul_f32 v[96:97], v[96:97], v[208:209]
    v_pk_mul_f32 v[98:99], v[98:99], v[210:211]
    v_cvt_pk_bf16_f32 v76, v92, v93
    v_cvt_pk_bf16_f32 v77, v94, v95
    v_cvt_pk_bf16_f32 v78, v96, v97
    v_cvt_pk_bf16_f32 v79, v98, v99
    buffer_store_dwordx4 v[76:79], v22, s[36:39], s48 offen offset:0 sc1
    v_pk_mul_f32 v[100:101], v[212:213], v[212:213]
    v_pk_mul_f32 v[102:103], v[214:215], v[214:215]
    v_pk_mul_f32 v[104:105], v[216:217], v[216:217]
    v_pk_mul_f32 v[106:107], v[218:219], v[218:219]
    v_pk_fma_f32 v[100:101], v[100:101], s[60:61], v[4:5] op_sel_hi:[1,0,0]
    v_pk_fma_f32 v[102:103], v[102:103], s[60:61], v[4:5] op_sel_hi:[1,0,0]
    v_pk_fma_f32 v[104:105], v[104:105], s[60:61], v[4:5] op_sel_hi:[1,0,0]
    v_pk_fma_f32 v[106:107], v[106:107], s[60:61], v[4:5] op_sel_hi:[1,0,0]
    v_pk_mul_f32 v[100:101], v[100:101], v[212:213]
    v_pk_mul_f32 v[102:103], v[102:103], v[214:215]
    v_pk_mul_f32 v[104:105], v[104:105], v[216:217]
    v_pk_mul_f32 v[106:107], v[106:107], v[218:219]
    v_exp_f32 v100, v100
    v_exp_f32 v101, v101
    v_exp_f32 v102, v102
    v_exp_f32 v103, v103
    v_exp_f32 v104, v104
    v_exp_f32 v105, v105
    v_exp_f32 v106, v106
    v_exp_f32 v107, v107
    v_pk_add_f32 v[100:101], v[100:101], 1.0 op_sel_hi:[1,0]
    v_pk_add_f32 v[102:103], v[102:103], 1.0 op_sel_hi:[1,0]
    v_pk_add_f32 v[104:105], v[104:105], 1.0 op_sel_hi:[1,0]
    v_pk_add_f32 v[106:107], v[106:107], 1.0 op_sel_hi:[1,0]
    v_rcp_f32 v100, v100
    v_rcp_f32 v101, v101
    v_rcp_f32 v102, v102
    v_rcp_f32 v103, v103
    v_rcp_f32 v104, v104
    v_rcp_f32 v105, v105
    v_rcp_f32 v106, v106
    v_rcp_f32 v107, v107
    v_pk_mul_f32 v[100:101], v[100:101], v[212:213]
    v_pk_mul_f32 v[102:103], v[102:103], v[214:215]
    v_pk_mul_f32 v[104:105], v[104:105], v[216:217]
    v_pk_mul_f32 v[106:107], v[106:107], v[218:219]
    v_cvt_pk_bf16_f32 v80, v100, v101
    v_cvt_pk_bf16_f32 v81, v102, v103
    v_cvt_pk_bf16_f32 v82, v104, v105
    v_cvt_pk_bf16_f32 v83, v106, v107
    buffer_store_dwordx4 v[80:83], v22, s[36:39], s48 offen offset:256 sc1
    v_pk_mul_f32 v[92:93], v[220:221], v[220:221]
    v_pk_mul_f32 v[94:95], v[222:223], v[222:223]
    v_pk_mul_f32 v[96:97], v[224:225], v[224:225]
    v_pk_mul_f32 v[98:99], v[226:227], v[226:227]
    v_pk_fma_f32 v[92:93], v[92:93], s[60:61], v[4:5] op_sel_hi:[1,0,0]
    v_pk_fma_f32 v[94:95], v[94:95], s[60:61], v[4:5] op_sel_hi:[1,0,0]
    v_pk_fma_f32 v[96:97], v[96:97], s[60:61], v[4:5] op_sel_hi:[1,0,0]
    v_pk_fma_f32 v[98:99], v[98:99], s[60:61], v[4:5] op_sel_hi:[1,0,0]
    v_pk_mul_f32 v[92:93], v[92:93], v[220:221]
    v_pk_mul_f32 v[94:95], v[94:95], v[222:223]
    v_pk_mul_f32 v[96:97], v[96:97], v[224:225]
    v_pk_mul_f32 v[98:99], v[98:99], v[226:227]
    v_exp_f32 v92, v92
    v_exp_f32 v93, v93
    v_exp_f32 v94, v94
    v_exp_f32 v95, v95
    v_exp_f32 v96, v96
    v_exp_f32 v97, v97
    v_exp_f32 v98, v98
    v_exp_f32 v99, v99
    v_pk_add_f32 v[92:93], v[92:93], 1.0 op_sel_hi:[1,0]
    v_pk_add_f32 v[94:95], v[94:95], 1.0 op_sel_hi:[1,0]
    v_pk_add_f32 v[96:97], v[96:97], 1.0 op_sel_hi:[1,0]
    v_pk_add_f32 v[98:99], v[98:99], 1.0 op_sel_hi:[1,0]
    v_rcp_f32 v92, v92
    v_rcp_f32 v93, v93
    v_rcp_f32 v94, v94
    v_rcp_f32 v95, v95
    v_rcp_f32 v96, v96
    v_rcp_f32 v97, v97
    v_rcp_f32 v98, v98
    v_rcp_f32 v99, v99
    v_pk_mul_f32 v[92:93], v[92:93], v[220:221]
    v_pk_mul_f32 v[94:95], v[94:95], v[222:223]
    v_pk_mul_f32 v[96:97], v[96:97], v[224:225]
    v_pk_mul_f32 v[98:99], v[98:99], v[226:227]
    v_cvt_pk_bf16_f32 v76, v92, v93
    v_cvt_pk_bf16_f32 v77, v94, v95
    v_cvt_pk_bf16_f32 v78, v96, v97
    v_cvt_pk_bf16_f32 v79, v98, v99
    buffer_store_dwordx4 v[76:79], v22, s[36:39], s48 offen offset:512 sc1
    v_pk_mul_f32 v[100:101], v[228:229], v[228:229]
    v_pk_mul_f32 v[102:103], v[230:231], v[230:231]
    v_pk_mul_f32 v[104:105], v[232:233], v[232:233]
    v_pk_mul_f32 v[106:107], v[234:235], v[234:235]
    v_pk_fma_f32 v[100:101], v[100:101], s[60:61], v[4:5] op_sel_hi:[1,0,0]
    v_pk_fma_f32 v[102:103], v[102:103], s[60:61], v[4:5] op_sel_hi:[1,0,0]
    v_pk_fma_f32 v[104:105], v[104:105], s[60:61], v[4:5] op_sel_hi:[1,0,0]
    v_pk_fma_f32 v[106:107], v[106:107], s[60:61], v[4:5] op_sel_hi:[1,0,0]
    v_pk_mul_f32 v[100:101], v[100:101], v[228:229]
    v_pk_mul_f32 v[102:103], v[102:103], v[230:231]
    v_pk_mul_f32 v[104:105], v[104:105], v[232:233]
    v_pk_mul_f32 v[106:107], v[106:107], v[234:235]
    v_exp_f32 v100, v100
    v_exp_f32 v101, v101
    v_exp_f32 v102, v102
    v_exp_f32 v103, v103
    v_exp_f32 v104, v104
    v_exp_f32 v105, v105
    v_exp_f32 v106, v106
    v_exp_f32 v107, v107
    v_pk_add_f32 v[100:101], v[100:101], 1.0 op_sel_hi:[1,0]
    v_pk_add_f32 v[102:103], v[102:103], 1.0 op_sel_hi:[1,0]
    v_pk_add_f32 v[104:105], v[104:105], 1.0 op_sel_hi:[1,0]
    v_pk_add_f32 v[106:107], v[106:107], 1.0 op_sel_hi:[1,0]
    v_rcp_f32 v100, v100
    v_rcp_f32 v101, v101
    v_rcp_f32 v102, v102
    v_rcp_f32 v103, v103
    v_rcp_f32 v104, v104
    v_rcp_f32 v105, v105
    v_rcp_f32 v106, v106
    v_rcp_f32 v107, v107
    v_pk_mul_f32 v[100:101], v[100:101], v[228:229]
    v_pk_mul_f32 v[102:103], v[102:103], v[230:231]
    v_pk_mul_f32 v[104:105], v[104:105], v[232:233]
    v_pk_mul_f32 v[106:107], v[106:107], v[234:235]
    v_cvt_pk_bf16_f32 v80, v100, v101
    v_cvt_pk_bf16_f32 v81, v102, v103
    v_cvt_pk_bf16_f32 v82, v104, v105
    v_cvt_pk_bf16_f32 v83, v106, v107
    buffer_store_dwordx4 v[80:83], v22, s[36:39], s48 offen offset:768 sc1
    v_pk_mul_f32 v[92:93], v[236:237], v[236:237]
    v_pk_mul_f32 v[94:95], v[238:239], v[238:239]
    v_pk_mul_f32 v[96:97], v[240:241], v[240:241]
    v_pk_mul_f32 v[98:99], v[242:243], v[242:243]
    v_pk_fma_f32 v[92:93], v[92:93], s[60:61], v[4:5] op_sel_hi:[1,0,0]
    v_pk_fma_f32 v[94:95], v[94:95], s[60:61], v[4:5] op_sel_hi:[1,0,0]
    v_pk_fma_f32 v[96:97], v[96:97], s[60:61], v[4:5] op_sel_hi:[1,0,0]
    v_pk_fma_f32 v[98:99], v[98:99], s[60:61], v[4:5] op_sel_hi:[1,0,0]
    v_pk_mul_f32 v[92:93], v[92:93], v[236:237]
    v_pk_mul_f32 v[94:95], v[94:95], v[238:239]
    v_pk_mul_f32 v[96:97], v[96:97], v[240:241]
    v_pk_mul_f32 v[98:99], v[98:99], v[242:243]
    v_exp_f32 v92, v92
    v_exp_f32 v93, v93
    v_exp_f32 v94, v94
    v_exp_f32 v95, v95
    v_exp_f32 v96, v96
    v_exp_f32 v97, v97
    s_branch L_skip_6
L_stub_6:
    s_branch L_stub_7
L_skip_6:
    v_exp_f32 v98, v98
    v_exp_f32 v99, v99
    v_pk_add_f32 v[92:93], v[92:93], 1.0 op_sel_hi:[1,0]
    v_pk_add_f32 v[94:95], v[94:95], 1.0 op_sel_hi:[1,0]
    v_pk_add_f32 v[96:97], v[96:97], 1.0 op_sel_hi:[1,0]
    v_pk_add_f32 v[98:99], v[98:99], 1.0 op_sel_hi:[1,0]
    v_rcp_f32 v92, v92
    v_rcp_f32 v93, v93
    v_rcp_f32 v94, v94
    v_rcp_f32 v95, v95
    v_rcp_f32 v96, v96
    v_rcp_f32 v97, v97
    v_rcp_f32 v98, v98
    v_rcp_f32 v99, v99
    v_pk_mul_f32 v[92:93], v[92:93], v[236:237]
    v_pk_mul_f32 v[94:95], v[94:95], v[238:239]
    v_pk_mul_f32 v[96:97], v[96:97], v[240:241]
    v_pk_mul_f32 v[98:99], v[98:99], v[242:243]
    v_cvt_pk_bf16_f32 v76, v92, v93
    v_cvt_pk_bf16_f32 v77, v94, v95
    v_cvt_pk_bf16_f32 v78, v96, v97
    v_cvt_pk_bf16_f32 v79, v98, v99
    buffer_store_dwordx4 v[76:79], v22, s[36:39], s48 offen offset:1024 sc1
    v_pk_mul_f32 v[100:101], v[244:245], v[244:245]
    v_pk_mul_f32 v[102:103], v[246:247], v[246:247]
    v_pk_mul_f32 v[104:105], v[248:249], v[248:249]
    v_pk_mul_f32 v[106:107], v[250:251], v[250:251]
    v_pk_fma_f32 v[100:101], v[100:101], s[60:61], v[4:5] op_sel_hi:[1,0,0]
    v_pk_fma_f32 v[102:103], v[102:103], s[60:61], v[4:5] op_sel_hi:[1,0,0]
    v_pk_fma_f32 v[104:105], v[104:105], s[60:61], v[4:5] op_sel_hi:[1,0,0]
    v_pk_fma_f32 v[106:107], v[106:107], s[60:61], v[4:5] op_sel_hi:[1,0,0]
    v_pk_mul_f32 v[100:101], v[100:101], v[244:245]
    v_pk_mul_f32 v[102:103], v[102:103], v[246:247]
    v_pk_mul_f32 v[104:105], v[104:105], v[248:249]
    v_pk_mul_f32 v[106:107], v[106:107], v[250:251]
    v_exp_f32 v100, v100
    v_exp_f32 v101, v101
    v_exp_f32 v102, v102
    v_exp_f32 v103, v103
    v_exp_f32 v104, v104
    v_exp_f32 v105, v105
    v_exp_f32 v106, v106
    v_exp_f32 v107, v107
    v_pk_add_f32 v[100:101], v[100:101], 1.0 op_sel_hi:[1,0]
    v_pk_add_f32 v[102:103], v[102:103], 1.0 op_sel_hi:[1,0]
    v_pk_add_f32 v[104:105], v[104:105], 1.0 op_sel_hi:[1,0]
    v_pk_add_f32 v[106:107], v[106:107], 1.0 op_sel_hi:[1,0]
    v_rcp_f32 v100, v100
    v_rcp_f32 v101, v101
    v_rcp_f32 v102, v102
    v_rcp_f32 v103, v103
    v_rcp_f32 v104, v104
    v_rcp_f32 v105, v105
    v_rcp_f32 v106, v106
    v_rcp_f32 v107, v107
    v_pk_mul_f32 v[100:101], v[100:101], v[244:245]
    v_pk_mul_f32 v[102:103], v[102:103], v[246:247]
    v_pk_mul_f32 v[104:105], v[104:105], v[248:249]
    v_pk_mul_f32 v[106:107], v[106:107], v[250:251]
    v_cvt_pk_bf16_f32 v80, v100, v101
    v_cvt_pk_bf16_f32 v81, v102, v103
    v_cvt_pk_bf16_f32 v82, v104, v105
    v_cvt_pk_bf16_f32 v83, v106, v107
    buffer_store_dwordx4 v[80:83], v22, s[36:39], s48 offen offset:1280 sc1
    s_branch L_m_22
L_m_21:
    s_waitcnt vmcnt(0)
    s_barrier
    s_mov_b32 s40, s16
    s_mov_b32 s41, s17
    s_mov_b32 s42, 18874368
    s_mov_b32 s43, 0x20000
    s_mov_b32 s44, s20
    s_mov_b32 s45, s21
    s_mov_b32 s46, 18874368
    s_mov_b32 s47, 0x20000
    s_mul_i32 s56, s3, 5
    s_add_u32 s56, s56, s5
    s_sub_u32 s56, s56, 27
    s_add_u32 s57, s56, 116
    s_add_u32 s56, s56, 0
L_m_23:
    s_cmp_ge_u32 s57, 320
    s_cbranch_scc1 L_m_24
    s_mul_i32 s48, s57, 820
    s_lshr_b32 s48, s48, 13
    s_mul_i32 s49, s48, 10
    s_sub_u32 s49, s57, s49
    s_lshl_b32 s49, s49, 6
    v_add_u32 v10, s49, v0
    s_and_b32 s49, s4, 7
    s_mul_i32 s49, s49, 4
    s_add_u32 s48, s48, s49
    s_add_u32 s48, s48, 26
    s_and_b32 s48, s48, 31
    s_mul_i32 s48, s48, 73728
    s_mul_i32 s49, s4, 1152
    s_and_b32 s49, s49, -256
    s_add_u32 s48, s48, s49
    v_mul_u32_u24 v11, 820, v10
    v_lshrrev_b32 v11, 13, v11
    v_mul_u32_u24 v12, 10, v11
    v_sub_u32 v12, v10, v12
    v_and_b32 v10, 7, v11
    v_lshrrev_b32 v11, 3, v11
    v_lshl_add_u32 v10, v10, 8, v11
    v_mul_u32_u24 v10, 9216, v10
    v_lshl_add_u32 v10, v12, 7, v10
    buffer_load_dword v13, v10, s[40:43], s48 offen
    s_add_u32 s57, s57, 20
    s_branch L_m_23
L_m_24:
    v_lshrrev_b32 v14, 4, v0
    v_and_b32 v15, 15, v0
    v_lshlrev_b32 v14, 12, v14
    v_lshl_add_u32 v14, v15, 7, v14
    s_lshr_b32 s48, s4, 1
    s_mul_i32 s48, s48, 4718592
    s_and_b32 s49, s4, 1
    s_lshl_b32 s49, s49, 11
    s_add_u32 s48, s48, s49
    v_add_u32 v14, s48, v14
    s_mov_b32 s50, 0
L_m_25:
    s_cmp_ge_u32 s56, 84
    s_cbranch_scc1 L_m_26
    s_add_u32 s48, s56, s50
    s_cmp_ge_u32 s48, 288
    s_cselect_b32 s49, 288, 0
    s_sub_u32 s48, s48, s49
    s_lshl_b32 s48, s48, 14
    buffer_load_dword v17, v14, s[44:47], s48 offen
    s_add_u32 s56, s56, 20
    s_branch L_m_25
L_m_26:
    s_waitcnt vmcnt(0)
    s_waitcnt vmcnt(0)
    s_barrier
    s_branch L_skip_7
L_stub_7:
    s_branch L_back_c2
L_skip_7:
L_m_22:
    s_lshr_b32 s58, s53, 1
    v_lshrrev_b32 v10, 2, v0
    v_and_b32 v11, 7, v10
    s_lshl_b32 s59, s3, 1
    s_add_u32 s59, s59, s58
    v_xor_b32 v11, s59, v11
    v_xor_b32 v12, 1, v11
    v_and_b32 v13, 3, v0
    v_lshlrev_b32 v13, 3, v13
    v_lshl_add_u32 v10, v10, 8, v13
    v_lshl_add_u32 v20, v11, 5, v10
    v_lshl_add_u32 v21, v12, 5, v10
    s_barrier
    v_add_u32 v24, 0, v20
    v_add_u32 v25, 0, v21
    ds_read_b64_tr_b16 v[92:93], v24 offset:32768
    ds_read_b64_tr_b16 v[94:95], v24 offset:36864
    ds_read_b64_tr_b16 v[96:97], v25 offset:32768
    ds_read_b64_tr_b16 v[98:99], v25 offset:36864
    ds_read_b64_tr_b16 v[100:101], v24 offset:40960
    ds_read_b64_tr_b16 v[102:103], v24 offset:45056
    ds_read_b64_tr_b16 v[104:105], v25 offset:40960
    ds_read_b64_tr_b16 v[106:107], v25 offset:45056
    ds_read_b64_tr_b16 v[156:157], v24 offset:0
    ds_read_b64_tr_b16 v[158:159], v24 offset:4096
    ds_read_b64_tr_b16 v[160:161], v25 offset:0
    ds_read_b64_tr_b16 v[162:163], v25 offset:4096
    ds_read_b64_tr_b16 v[164:165], v24 offset:8192
    ds_read_b64_tr_b16 v[166:167], v24 offset:12288
    ds_read_b64_tr_b16 v[168:169], v25 offset:8192
    ds_read_b64_tr_b16 v[170:171], v25 offset:12288
    ds_read_b64_tr_b16 v[172:173], v24 offset:16384
    ds_read_b64_tr_b16 v[174:175], v24 offset:20480
    ds_read_b64_tr_b16 v[176:177], v25 offset:16384
    ds_read_b64_tr_b16 v[178:179], v25 offset:20480
    ds_read_b64_tr_b16 v[180:181], v24 offset:24576
    ds_read_b64_tr_b16 v[182:183], v24 offset:28672
    ds_read_b64_tr_b16 v[184:185], v25 offset:24576
    ds_read_b64_tr_b16 v[186:187], v25 offset:28672
    v_add_u32 v24, 49152, v20
    v_add_u32 v25, 49152, v21
    ds_read_b64_tr_b16 v[108:109], v24 offset:0
    ds_read_b64_tr_b16 v[110:111], v24 offset:4096
    ds_read_b64_tr_b16 v[112:113], v25 offset:0
    ds_read_b64_tr_b16 v[114:115], v25 offset:4096
    ds_read_b64_tr_b16 v[116:117], v24 offset:8192
    ds_read_b64_tr_b16 v[118:119], v24 offset:12288
    ds_read_b64_tr_b16 v[120:121], v25 offset:8192
    ds_read_b64_tr_b16 v[122:123], v25 offset:12288
    ds_read_b64_tr_b16 v[124:125], v24 offset:16384
    ds_read_b64_tr_b16 v[126:127], v24 offset:20480
    ds_read_b64_tr_b16 v[128:129], v25 offset:16384
    ds_read_b64_tr_b16 v[130:131], v25 offset:20480
    ds_read_b64_tr_b16 v[132:133], v24 offset:24576
    ds_read_b64_tr_b16 v[134:135], v24 offset:28672
    ds_read_b64_tr_b16 v[136:137], v25 offset:24576
    ds_read_b64_tr_b16 v[138:139], v25 offset:28672
    ds_read_b64_tr_b16 v[140:141], v24 offset:32768
    ds_read_b64_tr_b16 v[142:143], v24 offset:36864
    ds_read_b64_tr_b16 v[144:145], v25 offset:32768
    ds_read_b64_tr_b16 v[146:147], v25 offset:36864
    ds_read_b64_tr_b16 v[148:149], v24 offset:40960
    ds_read_b64_tr_b16 v[150:151], v24 offset:45056
    ds_read_b64_tr_b16 v[152:153], v25 offset:40960
    ds_read_b64_tr_b16 v[154:155], v25 offset:45056
    s_waitcnt lgkmcnt(0)
    s_barrier
    s_waitcnt vmcnt(0)
    s_barrier
    s_and_b32 s58, s53, 1
    s_mul_i32 s48, s58, 1280
    s_sub_u32 s49, 1280, s48
    v_mul_u32_u24 v10, 2304, v2
    v_add_u32 v10, 90112, v10
    v_lshl_add_u32 v12, v1, 4, v10
    v_add_u32 v18, s48, v12
    v_add_u32 v22, s49, v12
    s_lshl_b32 s48, s58, 3
    v_xor_b32 v11, s48, v1
    v_lshl_add_u32 v19, v11, 4, v10
    v_add_u32 v19, 1024, v19
    v_lshlrev_b32 v9, 4, v0
    v_lshlrev_b32 v8, 16, v8
    v_cmp_gt_u32 vcc, 32, v0
    s_nop 1
    v_cndmask_b32 v10, 0, v8, vcc
    v_mov_b32 v188, v8
    v_mov_b32 v189, v8
    v_mov_b32 v190, v8
    v_mov_b32 v191, v8
    v_mov_b64 v[192:193], 0
    v_mov_b64 v[194:195], 0
    v_mov_b32 v196, v8
    v_mov_b32 v197, v8
    v_mov_b32 v198, v8
    v_mov_b32 v199, v8
    v_mov_b64 v[200:201], 0
    v_mov_b64 v[202:203], 0
    v_mov_b32 v204, v8
    v_mov_b32 v205, v8
    v_mov_b32 v206, v8
    v_mov_b32 v207, v8
    v_mov_b64 v[208:209], 0
    v_mov_b64 v[210:211], 0
    v_mov_b32 v212, v8
    v_mov_b32 v213, v8
    v_mov_b32 v214, v8
    v_mov_b32 v215, v8
    v_mov_b64 v[216:217], 0
    v_mov_b64 v[218:219], 0
    v_mov_b32 v220, v10
    v_mov_b32 v221, v10
    v_mov_b32 v222, v10
    v_mov_b32 v223, v10
    v_mov_b64 v[224:225], 0
    v_mov_b64 v[226:227], 0
    v_mov_b64 v[228:229], 0
    v_mov_b64 v[230:231], 0
    v_mov_b64 v[232:233], 0
    v_mov_b64 v[234:235], 0
    v_mov_b64 v[236:237], 0
    v_mov_b64 v[238:239], 0
    v_mov_b64 v[240:241], 0
    v_mov_b64 v[242:243], 0
    v_mov_b64 v[244:245], 0
    v_mov_b64 v[246:247], 0
    v_mov_b64 v[248:249], 0
    v_mov_b64 v[250:251], 0
    v_mov_b64 v[252:253], 0
    v_mov_b64 v[254:255], 0
    v_mov_b64 v[64:65], 0
    v_mov_b64 v[66:67], 0
    s_mov_b32 s44, s28
    s_mov_b32 s45, s29
    s_mov_b32 s46, 2359296
    s_mov_b32 s47, 0x20000
    s_mul_i32 s48, s3, 2304
    s_add_u32 s48, s48, 32768
    v_mul_u32_u24 v10, 144, v1
    v_lshl_add_u32 v10, v2, 3, v10
    v_add_u32 v10, s48, v10
    v_add_u32 v7, s48, v9
    s_lshl_b32 s49, s58, 4
    v_add_u32 v4, s49, v10
    s_lshl_b32 s49, s58, 7
    s_sub_u32 s49, 128, s49
    v_add_u32 v10, s49, v10
    v_cmp_gt_u32 vcc, 32, v0
    v_mov_b32 v11, 82432
    s_nop 0
    v_cndmask_b32 v5, v11, v10, vcc
    v_lshlrev_b32 v10, 4, v2
    v_add_u32 v10, 81920, v10
    s_lshl_b32 s49, s58, 5
    v_add_u32 v6, s49, v10
    s_lshl_b32 s49, s58, 8
    s_sub_u32 s49, 256, s49
    v_add_u32 v23, s49, v10
    s_lshl_b32 s48, s59, 4
    s_lshl_b32 s49, s54, 7
    s_add_u32 s48, s48, s49
    s_mul_i32 s48, s48, 1152
    s_mul_i32 s49, s55, 288
    s_add_u32 s62, s48, s49
    s_mul_i32 s49, s58, 144
    s_add_u32 s62, s62, s49
    v_add_u32 v10, 0, v0
    v_mul_u32_u24 v11, 911, v10
    v_lshrrev_b32 v11, 13, v11
    v_mul_u32_u24 v11, 1008, v11
    v_lshl_add_u32 v68, v10, 4, v11
    v_add_u32 v10, 64, v0
    v_mul_u32_u24 v11, 911, v10
    v_lshrrev_b32 v11, 13, v11
    v_mul_u32_u24 v11, 1008, v11
    v_lshl_add_u32 v69, v10, 4, v11
    v_add_u32 v10, 128, v0
    v_mul_u32_u24 v11, 911, v10
    v_lshrrev_b32 v11, 13, v11
    v_mul_u32_u24 v11, 1008, v11
    v_lshl_add_u32 v70, v10, 4, v11
    v_cmp_gt_u32 vcc, 16, v0
    v_mov_b32 v11, 2146435072
    s_nop 0
    v_cndmask_b32 v70, v11, v70, vcc
    s_mul_i32 s48, s3, 2304
    s_add_u32 s48, s48, 27262976
    s_mul_i32 s64, s2, 27648
    s_add_u32 s64, s64, s48
    v_and_b32 v10, 3, v0
    v_cmp_eq_u32 vcc, 0, v10
    v_lshlrev_b32 v27, 2, v0
    s_nop 0
    v_cndmask_b32 v26, v11, v27, vcc
    s_mul_i32 s49, s3, 4608
    s_add_u32 s49, s49, 49152
    v_add_u32 v71, s49, v9
    v_add_u32 v72, 73728, v18
    v_add_u32 v75, 73728, v19
    v_add_u32 v74, 73728, v22
    s_xor_b32 s65, s2, 2
    s_mul_i32 s65, s65, 27648
    s_add_u32 s65, s65, s48
    s_add_u32 s65, s65, 0
    s_xor_b32 s66, s2, 4
    s_mul_i32 s66, s66, 27648
    s_add_u32 s66, s66, s48
    s_add_u32 s66, s66, 9216
    s_xor_b32 s67, s2, 6
    s_mul_i32 s67, s67, 27648
    s_add_u32 s67, s67, s48
    s_add_u32 s67, s67, 18432
    s_branch L_stub_8
L_back_c3:
    v_add_u32 v24, 49152, v20
    v_add_u32 v25, 49152, v21
    s_barrier
    ds_read_b64_tr_b16 v[80:81], v21 offset:0
    ds_read_b64_tr_b16 v[82:83], v21 offset:4096
    ds_read_b64_tr_b16 v[76:77], v20 offset:0
    ds_read_b64_tr_b16 v[78:79], v20 offset:4096
    ds_read_b128 v[28:31], v18 offset:0
    ds_read_b128 v[32:35], v18 offset:256
    ds_read_b128 v[36:39], v18 offset:512
    ds_read_b128 v[40:43], v18 offset:768
    ds_read_b128 v[44:47], v19 offset:0
    ds_read_b128 v[48:51], v22 offset:0
    ds_read_b128 v[52:55], v22 offset:256
    ds_read_b128 v[56:59], v22 offset:512
    ds_read_b128 v[60:63], v22 offset:768
    s_waitcnt lgkmcnt(6)
    v_mfma_f32_16x16x32_bf16 v[192:195], v[28:31], v[80:83], v[192:195]
    ds_read_b64_tr_b16 v[88:89], v21 offset:8192
    v_mfma_f32_16x16x32_bf16 v[188:191], v[28:31], v[76:79], v[188:191]
    ds_read_b128 v[28:31], v18 offset:9216
    v_mfma_f32_16x16x32_bf16 v[200:203], v[32:35], v[80:83], v[200:203]
    ds_read_b64_tr_b16 v[90:91], v21 offset:12288
    v_mfma_f32_16x16x32_bf16 v[196:199], v[32:35], v[76:79], v[196:199]
    ds_read_b128 v[32:35], v18 offset:9472
    v_mfma_f32_16x16x32_bf16 v[208:211], v[36:39], v[80:83], v[208:211]
    ds_read_b64_tr_b16 v[84:85], v20 offset:8192
    v_mfma_f32_16x16x32_bf16 v[204:207], v[36:39], v[76:79], v[204:207]
    ds_read_b128 v[36:39], v18 offset:9728
    s_waitcnt lgkmcnt(9)
    v_mfma_f32_16x16x32_bf16 v[216:219], v[40:43], v[80:83], v[216:219]
    ds_read_b64_tr_b16 v[86:87], v20 offset:12288
    v_mfma_f32_16x16x32_bf16 v[212:215], v[40:43], v[76:79], v[212:215]
    ds_read_b128 v[40:43], v18 offset:9984
    v_mfma_f32_16x16x32_bf16 v[224:227], v[44:47], v[80:83], v[224:227]
    v_mfma_f32_16x16x32_bf16 v[220:223], v[44:47], v[76:79], v[220:223]
    ds_read_b128 v[44:47], v19 offset:9216
    v_mfma_f32_16x16x32_bf16 v[232:235], v[48:51], v[80:83], v[232:235]
    v_mfma_f32_16x16x32_bf16 v[228:231], v[48:51], v[76:79], v[228:231]
    ds_read_b128 v[48:51], v22 offset:9216
    s_waitcnt lgkmcnt(10)
    v_mfma_f32_16x16x32_bf16 v[240:243], v[52:55], v[80:83], v[240:243]
    v_mfma_f32_16x16x32_bf16 v[236:239], v[52:55], v[76:79], v[236:239]
    ds_read_b128 v[52:55], v22 offset:9472
    v_mfma_f32_16x16x32_bf16 v[248:251], v[56:59], v[80:83], v[248:251]
    v_mfma_f32_16x16x32_bf16 v[244:247], v[56:59], v[76:79], v[244:247]
    ds_read_b128 v[56:59], v22 offset:9728
    v_mfma_f32_16x16x32_bf16 v[64:67], v[60:63], v[80:83], v[64:67]
    v_mfma_f32_16x16x32_bf16 v[252:255], v[60:63], v[76:79], v[252:255]
    ds_read_b128 v[60:63], v22 offset:9984
    s_waitcnt lgkmcnt(6)
    v_mfma_f32_16x16x32_bf16 v[192:195], v[28:31], v[88:91], v[192:195]
    s_barrier
    ds_read_b64_tr_b16 v[80:81], v21 offset:16384
    v_mfma_f32_16x16x32_bf16 v[188:191], v[28:31], v[84:87], v[188:191]
    ds_read_b128 v[28:31], v18 offset:18432
    v_mfma_f32_16x16x32_bf16 v[200:203], v[32:35], v[88:91], v[200:203]
    ds_read_b64_tr_b16 v[82:83], v21 offset:20480
    v_mfma_f32_16x16x32_bf16 v[196:199], v[32:35], v[84:87], v[196:199]
    ds_read_b128 v[32:35], v18 offset:18688
    v_mfma_f32_16x16x32_bf16 v[208:211], v[36:39], v[88:91], v[208:211]
    ds_read_b64_tr_b16 v[76:77], v20 offset:16384
    v_mfma_f32_16x16x32_bf16 v[204:207], v[36:39], v[84:87], v[204:207]
    ds_read_b128 v[36:39], v18 offset:18944
    s_waitcnt lgkmcnt(9)
    v_mfma_f32_16x16x32_bf16 v[216:219], v[40:43], v[88:91], v[216:219]
    ds_read_b64_tr_b16 v[78:79], v20 offset:20480
    v_mfma_f32_16x16x32_bf16 v[212:215], v[40:43], v[84:87], v[212:215]
    ds_read_b128 v[40:43], v18 offset:19200
    v_mfma_f32_16x16x32_bf16 v[224:227], v[44:47], v[88:91], v[224:227]
    v_mfma_f32_16x16x32_bf16 v[220:223], v[44:47], v[84:87], v[220:223]
    ds_read_b128 v[44:47], v19 offset:18432
    v_mfma_f32_16x16x32_bf16 v[232:235], v[48:51], v[88:91], v[232:235]
    v_mfma_f32_16x16x32_bf16 v[228:231], v[48:51], v[84:87], v[228:231]
    ds_read_b128 v[48:51], v22 offset:18432
    s_waitcnt lgkmcnt(10)
    v_mfma_f32_16x16x32_bf16 v[240:243], v[52:55], v[88:91], v[240:243]
    v_mfma_f32_16x16x32_bf16 v[236:239], v[52:55], v[84:87], v[236:239]
    ds_read_b128 v[52:55], v22 offset:18688
    v_mfma_f32_16x16x32_bf16 v[248:251], v[56:59], v[88:91], v[248:251]
    v_mfma_f32_16x16x32_bf16 v[244:247], v[56:59], v[84:87], v[244:247]
    ds_read_b128 v[56:59], v22 offset:18944
    v_mfma_f32_16x16x32_bf16 v[64:67], v[60:63], v[88:91], v[64:67]
    v_mfma_f32_16x16x32_bf16 v[252:255], v[60:63], v[84:87], v[252:255]
    ds_read_b128 v[60:63], v22 offset:19200
    s_waitcnt lgkmcnt(6)
    v_mfma_f32_16x16x32_bf16 v[192:195], v[28:31], v[80:83], v[192:195]
    ds_read_b64_tr_b16 v[88:89], v21 offset:24576
    v_mfma_f32_16x16x32_bf16 v[188:191], v[28:31], v[76:79], v[188:191]
    ds_read_b128 v[28:31], v18 offset:27648
    v_mfma_f32_16x16x32_bf16 v[200:203], v[32:35], v[80:83], v[200:203]
    ds_read_b64_tr_b16 v[90:91], v21 offset:28672
    v_mfma_f32_16x16x32_bf16 v[196:199], v[32:35], v[76:79], v[196:199]
    ds_read_b128 v[32:35], v18 offset:27904
    v_mfma_f32_16x16x32_bf16 v[208:211], v[36:39], v[80:83], v[208:211]
    ds_read_b64_tr_b16 v[84:85], v20 offset:24576
    v_mfma_f32_16x16x32_bf16 v[204:207], v[36:39], v[76:79], v[204:207]
    ds_read_b128 v[36:39], v18 offset:28160
    s_waitcnt lgkmcnt(9)
    v_mfma_f32_16x16x32_bf16 v[216:219], v[40:43], v[80:83], v[216:219]
    ds_read_b64_tr_b16 v[86:87], v20 offset:28672
    v_mfma_f32_16x16x32_bf16 v[212:215], v[40:43], v[76:79], v[212:215]
    ds_read_b128 v[40:43], v18 offset:28416
    v_mfma_f32_16x16x32_bf16 v[224:227], v[44:47], v[80:83], v[224:227]
    v_mfma_f32_16x16x32_bf16 v[220:223], v[44:47], v[76:79], v[220:223]
    ds_read_b128 v[44:47], v19 offset:27648
    v_mfma_f32_16x16x32_bf16 v[232:235], v[48:51], v[80:83], v[232:235]
    v_mfma_f32_16x16x32_bf16 v[228:231], v[48:51], v[76:79], v[228:231]
    ds_read_b128 v[48:51], v22 offset:27648
    s_waitcnt lgkmcnt(10)
    v_mfma_f32_16x16x32_bf16 v[240:243], v[52:55], v[80:83], v[240:243]
    v_mfma_f32_16x16x32_bf16 v[236:239], v[52:55], v[76:79], v[236:239]
    ds_read_b128 v[52:55], v22 offset:27904
    v_mfma_f32_16x16x32_bf16 v[248:251], v[56:59], v[80:83], v[248:251]
    v_mfma_f32_16x16x32_bf16 v[244:247], v[56:59], v[76:79], v[244:247]
    ds_read_b128 v[56:59], v22 offset:28160
    v_mfma_f32_16x16x32_bf16 v[64:67], v[60:63], v[80:83], v[64:67]
    v_mfma_f32_16x16x32_bf16 v[252:255], v[60:63], v[76:79], v[252:255]
    ds_read_b128 v[60:63], v22 offset:28416
    s_waitcnt lgkmcnt(6)
    v_mfma_f32_16x16x32_bf16 v[192:195], v[28:31], v[88:91], v[192:195]
    s_barrier
    ds_read_b64_tr_b16 v[80:81], v21 offset:32768
    v_mfma_f32_16x16x32_bf16 v[188:191], v[28:31], v[84:87], v[188:191]
    ds_read_b128 v[28:31], v18 offset:36864
    v_mfma_f32_16x16x32_bf16 v[200:203], v[32:35], v[88:91], v[200:203]
    ds_read_b64_tr_b16 v[82:83], v21 offset:36864
    v_mfma_f32_16x16x32_bf16 v[196:199], v[32:35], v[84:87], v[196:199]
    ds_read_b128 v[32:35], v18 offset:37120
    v_mfma_f32_16x16x32_bf16 v[208:211], v[36:39], v[88:91], v[208:211]
    ds_read_b64_tr_b16 v[76:77], v20 offset:32768
    v_mfma_f32_16x16x32_bf16 v[204:207], v[36:39], v[84:87], v[204:207]
    ds_read_b128 v[36:39], v18 offset:37376
    s_waitcnt lgkmcnt(9)
    v_mfma_f32_16x16x32_bf16 v[216:219], v[40:43], v[88:91], v[216:219]
    ds_read_b64_tr_b16 v[78:79], v20 offset:36864
    v_mfma_f32_16x16x32_bf16 v[212:215], v[40:43], v[84:87], v[212:215]
    ds_read_b128 v[40:43], v18 offset:37632
    v_mfma_f32_16x16x32_bf16 v[224:227], v[44:47], v[88:91], v[224:227]
    v_mfma_f32_16x16x32_bf16 v[220:223], v[44:47], v[84:87], v[220:223]
    ds_read_b128 v[44:47], v19 offset:36864
    v_mfma_f32_16x16x32_bf16 v[232:235], v[48:51], v[88:91], v[232:235]
    v_mfma_f32_16x16x32_bf16 v[228:231], v[48:51], v[84:87], v[228:231]
    ds_read_b128 v[48:51], v22 offset:36864
    s_waitcnt lgkmcnt(10)
    v_mfma_f32_16x16x32_bf16 v[240:243], v[52:55], v[88:91], v[240:243]
    v_mfma_f32_16x16x32_bf16 v[236:239], v[52:55], v[84:87], v[236:239]
    ds_read_b128 v[52:55], v22 offset:37120
    v_mfma_f32_16x16x32_bf16 v[248:251], v[56:59], v[88:91], v[248:251]
    v_mfma_f32_16x16x32_bf16 v[244:247], v[56:59], v[84:87], v[244:247]
    ds_read_b128 v[56:59], v22 offset:37376
    v_mfma_f32_16x16x32_bf16 v[64:67], v[60:63], v[88:91], v[64:67]
    v_mfma_f32_16x16x32_bf16 v[252:255], v[60:63], v[84:87], v[252:255]
    ds_read_b128 v[60:63], v22 offset:37632
    s_waitcnt lgkmcnt(6)
    v_mfma_f32_16x16x32_bf16 v[192:195], v[28:31], v[80:83], v[192:195]
    ds_read_b64_tr_b16 v[88:89], v21 offset:40960
    v_mfma_f32_16x16x32_bf16 v[188:191], v[28:31], v[76:79], v[188:191]
    ds_read_b128 v[28:31], v18 offset:46080
    v_mfma_f32_16x16x32_bf16 v[200:203], v[32:35], v[80:83], v[200:203]
    ds_read_b64_tr_b16 v[90:91], v21 offset:45056
    v_mfma_f32_16x16x32_bf16 v[196:199], v[32:35], v[76:79], v[196:199]
    ds_read_b128 v[32:35], v18 offset:46336
    v_mfma_f32_16x16x32_bf16 v[208:211], v[36:39], v[80:83], v[208:211]
    ds_read_b64_tr_b16 v[84:85], v20 offset:40960
    v_mfma_f32_16x16x32_bf16 v[204:207], v[36:39], v[76:79], v[204:207]
    ds_read_b128 v[36:39], v18 offset:46592
    s_waitcnt lgkmcnt(9)
    v_mfma_f32_16x16x32_bf16 v[216:219], v[40:43], v[80:83], v[216:219]
    ds_read_b64_tr_b16 v[86:87], v20 offset:45056
    v_mfma_f32_16x16x32_bf16 v[212:215], v[40:43], v[76:79], v[212:215]
    ds_read_b128 v[40:43], v18 offset:46848
    v_mfma_f32_16x16x32_bf16 v[224:227], v[44:47], v[80:83], v[224:227]
    v_mfma_f32_16x16x32_bf16 v[220:223], v[44:47], v[76:79], v[220:223]
    ds_read_b128 v[44:47], v19 offset:46080
    v_mfma_f32_16x16x32_bf16 v[232:235], v[48:51], v[80:83], v[232:235]
    v_mfma_f32_16x16x32_bf16 v[228:231], v[48:51], v[76:79], v[228:231]
    ds_read_b128 v[48:51], v22 offset:46080
    s_waitcnt lgkmcnt(10)
    v_mfma_f32_16x16x32_bf16 v[240:243], v[52:55], v[80:83], v[240:243]
    v_mfma_f32_16x16x32_bf16 v[236:239], v[52:55], v[76:79], v[236:239]
    ds_read_b128 v[52:55], v22 offset:46336
    v_mfma_f32_16x16x32_bf16 v[248:251], v[56:59], v[80:83], v[248:251]
    v_mfma_f32_16x16x32_bf16 v[244:247], v[56:59], v[76:79], v[244:247]
    ds_read_b128 v[56:59], v22 offset:46592
    v_mfma_f32_16x16x32_bf16 v[64:67], v[60:63], v[80:83], v[64:67]
    v_mfma_f32_16x16x32_bf16 v[252:255], v[60:63], v[76:79], v[252:255]
    ds_read_b128 v[60:63], v22 offset:46848
    s_waitcnt lgkmcnt(6)
    v_mfma_f32_16x16x32_bf16 v[192:195], v[28:31], v[88:91], v[192:195]
    s_barrier
    ds_read_b64_tr_b16 v[80:81], v25 offset:0
    v_mfma_f32_16x16x32_bf16 v[188:191], v[28:31], v[84:87], v[188:191]
    ds_read_b128 v[28:31], v18 offset:55296
    v_mfma_f32_16x16x32_bf16 v[200:203], v[32:35], v[88:91], v[200:203]
    ds_read_b64_tr_b16 v[82:83], v25 offset:4096
    v_mfma_f32_16x16x32_bf16 v[196:199], v[32:35], v[84:87], v[196:199]
    ds_read_b128 v[32:35], v18 offset:55552
    v_mfma_f32_16x16x32_bf16 v[208:211], v[36:39], v[88:91], v[208:211]
    ds_read_b64_tr_b16 v[76:77], v24 offset:0
    v_mfma_f32_16x16x32_bf16 v[204:207], v[36:39], v[84:87], v[204:207]
    ds_read_b128 v[36:39], v18 offset:55808
    s_waitcnt lgkmcnt(9)
    v_mfma_f32_16x16x32_bf16 v[216:219], v[40:43], v[88:91], v[216:219]
    ds_read_b64_tr_b16 v[78:79], v24 offset:4096
    v_mfma_f32_16x16x32_bf16 v[212:215], v[40:43], v[84:87], v[212:215]
    ds_read_b128 v[40:43], v18 offset:56064
    v_mfma_f32_16x16x32_bf16 v[224:227], v[44:47], v[88:91], v[224:227]
    v_mfma_f32_16x16x32_bf16 v[220:223], v[44:47], v[84:87], v[220:223]
    ds_read_b128 v[44:47], v19 offset:55296
    v_mfma_f32_16x16x32_bf16 v[232:235], v[48:51], v[88:91], v[232:235]
    v_mfma_f32_16x16x32_bf16 v[228:231], v[48:51], v[84:87], v[228:231]
    ds_read_b128 v[48:51], v22 offset:55296
    s_waitcnt lgkmcnt(10)
    v_mfma_f32_16x16x32_bf16 v[240:243], v[52:55], v[88:91], v[240:243]
    v_mfma_f32_16x16x32_bf16 v[236:239], v[52:55], v[84:87], v[236:239]
    ds_read_b128 v[52:55], v22 offset:55552
    v_mfma_f32_16x16x32_bf16 v[248:251], v[56:59], v[88:91], v[248:251]
    v_mfma_f32_16x16x32_bf16 v[244:247], v[56:59], v[84:87], v[244:247]
    ds_read_b128 v[56:59], v22 offset:55808
    v_mfma_f32_16x16x32_bf16 v[64:67], v[60:63], v[88:91], v[64:67]
    v_mfma_f32_16x16x32_bf16 v[252:255], v[60:63], v[84:87], v[252:255]
    ds_read_b128 v[60:63], v22 offset:56064
    s_waitcnt lgkmcnt(6)
    v_mfma_f32_16x16x32_bf16 v[192:195], v[28:31], v[80:83], v[192:195]
    ds_read_b64_tr_b16 v[88:89], v25 offset:8192
    v_mfma_f32_16x16x32_bf16 v[188:191], v[28:31], v[76:79], v[188:191]
    ds_read_b128 v[28:31], v18 offset:64512
    v_mfma_f32_16x16x32_bf16 v[200:203], v[32:35], v[80:83], v[200:203]
    ds_read_b64_tr_b16 v[90:91], v25 offset:12288
    v_mfma_f32_16x16x32_bf16 v[196:199], v[32:35], v[76:79], v[196:199]
    ds_read_b128 v[32:35], v18 offset:64768
    v_mfma_f32_16x16x32_bf16 v[208:211], v[36:39], v[80:83], v[208:211]
    ds_read_b64_tr_b16 v[84:85], v24 offset:8192
    v_mfma_f32_16x16x32_bf16 v[204:207], v[36:39], v[76:79], v[204:207]
    ds_read_b128 v[36:39], v18 offset:65024
    s_waitcnt lgkmcnt(9)
    v_mfma_f32_16x16x32_bf16 v[216:219], v[40:43], v[80:83], v[216:219]
    ds_read_b64_tr_b16 v[86:87], v24 offset:12288
    v_mfma_f32_16x16x32_bf16 v[212:215], v[40:43], v[76:79], v[212:215]
    ds_read_b128 v[40:43], v18 offset:65280
    v_mfma_f32_16x16x32_bf16 v[224:227], v[44:47], v[80:83], v[224:227]
    v_mfma_f32_16x16x32_bf16 v[220:223], v[44:47], v[76:79], v[220:223]
    ds_read_b128 v[44:47], v19 offset:64512
    v_mfma_f32_16x16x32_bf16 v[232:235], v[48:51], v[80:83], v[232:235]
    v_mfma_f32_16x16x32_bf16 v[228:231], v[48:51], v[76:79], v[228:231]
    ds_read_b128 v[48:51], v22 offset:64512
    s_waitcnt lgkmcnt(10)
    v_mfma_f32_16x16x32_bf16 v[240:243], v[52:55], v[80:83], v[240:243]
    v_mfma_f32_16x16x32_bf16 v[236:239], v[52:55], v[76:79], v[236:239]
    ds_read_b128 v[52:55], v22 offset:64768
    v_mfma_f32_16x16x32_bf16 v[248:251], v[56:59], v[80:83], v[248:251]
    v_mfma_f32_16x16x32_bf16 v[244:247], v[56:59], v[76:79], v[244:247]
    ds_read_b128 v[56:59], v22 offset:65024
    v_mfma_f32_16x16x32_bf16 v[64:67], v[60:63], v[80:83], v[64:67]
    v_mfma_f32_16x16x32_bf16 v[252:255], v[60:63], v[76:79], v[252:255]
    ds_read_b128 v[60:63], v22 offset:65280
    s_waitcnt lgkmcnt(6)
    v_mfma_f32_16x16x32_bf16 v[192:195], v[28:31], v[88:91], v[192:195]
    s_barrier
    v_mfma_f32_16x16x32_bf16 v[188:191], v[28:31], v[84:87], v[188:191]
    ds_read_b128 v[28:31], v18 offset:0
    v_mfma_f32_16x16x32_bf16 v[200:203], v[32:35], v[88:91], v[200:203]
    v_mfma_f32_16x16x32_bf16 v[196:199], v[32:35], v[84:87], v[196:199]
    ds_read_b128 v[32:35], v18 offset:256
    v_mfma_f32_16x16x32_bf16 v[208:211], v[36:39], v[88:91], v[208:211]
    v_mfma_f32_16x16x32_bf16 v[204:207], v[36:39], v[84:87], v[204:207]
    ds_read_b128 v[36:39], v18 offset:512
    s_waitcnt lgkmcnt(6)
    v_mfma_f32_16x16x32_bf16 v[216:219], v[40:43], v[88:91], v[216:219]
    v_mfma_f32_16x16x32_bf16 v[212:215], v[40:43], v[84:87], v[212:215]
    ds_read_b128 v[40:43], v18 offset:768
    v_mfma_f32_16x16x32_bf16 v[224:227], v[44:47], v[88:91], v[224:227]
    s_branch L_skip_8
L_stub_8:
    s_branch L_stub_9
L_skip_8:
    v_mfma_f32_16x16x32_bf16 v[220:223], v[44:47], v[84:87], v[220:223]
    ds_read_b128 v[44:47], v19 offset:0
    v_mfma_f32_16x16x32_bf16 v[232:235], v[48:51], v[88:91], v[232:235]
    v_mfma_f32_16x16x32_bf16 v[228:231], v[48:51], v[84:87], v[228:231]
    ds_read_b128 v[48:51], v22 offset:0
    s_waitcnt lgkmcnt(6)
    v_mfma_f32_16x16x32_bf16 v[240:243], v[52:55], v[88:91], v[240:243]
    v_mfma_f32_16x16x32_bf16 v[236:239], v[52:55], v[84:87], v[236:239]
    ds_read_b128 v[52:55], v22 offset:256
    v_mfma_f32_16x16x32_bf16 v[248:251], v[56:59], v[88:91], v[248:251]
    v_mfma_f32_16x16x32_bf16 v[244:247], v[56:59], v[84:87], v[244:247]
    ds_read_b128 v[56:59], v22 offset:512
    v_mfma_f32_16x16x32_bf16 v[64:67], v[60:63], v[88:91], v[64:67]
    v_mfma_f32_16x16x32_bf16 v[252:255], v[60:63], v[84:87], v[252:255]
    ds_read_b128 v[60:63], v22 offset:768
    s_waitcnt lgkmcnt(6)
    v_mfma_f32_16x16x32_bf16 v[192:195], v[28:31], v[96:99], v[192:195]
    v_mfma_f32_16x16x32_bf16 v[188:191], v[28:31], v[92:95], v[188:191]
    ds_read_b128 v[28:31], v18 offset:9216
    v_mfma_f32_16x16x32_bf16 v[200:203], v[32:35], v[96:99], v[200:203]
    v_mfma_f32_16x16x32_bf16 v[196:199], v[32:35], v[92:95], v[196:199]
    ds_read_b128 v[32:35], v18 offset:9472
    v_mfma_f32_16x16x32_bf16 v[208:211], v[36:39], v[96:99], v[208:211]
    v_mfma_f32_16x16x32_bf16 v[204:207], v[36:39], v[92:95], v[204:207]
    ds_read_b128 v[36:39], v18 offset:9728
    s_waitcnt lgkmcnt(6)
    v_mfma_f32_16x16x32_bf16 v[216:219], v[40:43], v[96:99], v[216:219]
    v_mfma_f32_16x16x32_bf16 v[212:215], v[40:43], v[92:95], v[212:215]
    ds_read_b128 v[40:43], v18 offset:9984
    v_mfma_f32_16x16x32_bf16 v[224:227], v[44:47], v[96:99], v[224:227]
    v_mfma_f32_16x16x32_bf16 v[220:223], v[44:47], v[92:95], v[220:223]
    ds_read_b128 v[44:47], v19 offset:9216
    v_mfma_f32_16x16x32_bf16 v[232:235], v[48:51], v[96:99], v[232:235]
    v_mfma_f32_16x16x32_bf16 v[228:231], v[48:51], v[92:95], v[228:231]
    ds_read_b128 v[48:51], v22 offset:9216
    s_waitcnt lgkmcnt(6)
    v_mfma_f32_16x16x32_bf16 v[240:243], v[52:55], v[96:99], v[240:243]
    v_mfma_f32_16x16x32_bf16 v[236:239], v[52:55], v[92:95], v[236:239]
    ds_read_b128 v[52:55], v22 offset:9472
    v_mfma_f32_16x16x32_bf16 v[248:251], v[56:59], v[96:99], v[248:251]
    v_mfma_f32_16x16x32_bf16 v[244:247], v[56:59], v[92:95], v[244:247]
    ds_read_b128 v[56:59], v22 offset:9728
    v_mfma_f32_16x16x32_bf16 v[64:67], v[60:63], v[96:99], v[64:67]
    v_mfma_f32_16x16x32_bf16 v[252:255], v[60:63], v[92:95], v[252:255]
    ds_read_b128 v[60:63], v22 offset:9984
    s_waitcnt lgkmcnt(6)
    v_mfma_f32_16x16x32_bf16 v[192:195], v[28:31], v[104:107], v[192:195]
    s_barrier
    ds_read_b64_tr_b16 v[80:81], v25 offset:16384
    v_mfma_f32_16x16x32_bf16 v[188:191], v[28:31], v[100:103], v[188:191]
    ds_read_b128 v[28:31], v18 offset:18432
    v_mfma_f32_16x16x32_bf16 v[200:203], v[32:35], v[104:107], v[200:203]
    ds_read_b64_tr_b16 v[82:83], v25 offset:20480
    v_mfma_f32_16x16x32_bf16 v[196:199], v[32:35], v[100:103], v[196:199]
    ds_read_b128 v[32:35], v18 offset:18688
    v_mfma_f32_16x16x32_bf16 v[208:211], v[36:39], v[104:107], v[208:211]
    ds_read_b64_tr_b16 v[76:77], v24 offset:16384
    v_mfma_f32_16x16x32_bf16 v[204:207], v[36:39], v[100:103], v[204:207]
    ds_read_b128 v[36:39], v18 offset:18944
    s_waitcnt lgkmcnt(9)
    v_mfma_f32_16x16x32_bf16 v[216:219], v[40:43], v[104:107], v[216:219]
    ds_read_b64_tr_b16 v[78:79], v24 offset:20480
    v_mfma_f32_16x16x32_bf16 v[212:215], v[40:43], v[100:103], v[212:215]
    ds_read_b128 v[40:43], v18 offset:19200
    v_mfma_f32_16x16x32_bf16 v[224:227], v[44:47], v[104:107], v[224:227]
    v_mfma_f32_16x16x32_bf16 v[220:223], v[44:47], v[100:103], v[220:223]
    ds_read_b128 v[44:47], v19 offset:18432
    v_mfma_f32_16x16x32_bf16 v[232:235], v[48:51], v[104:107], v[232:235]
    v_mfma_f32_16x16x32_bf16 v[228:231], v[48:51], v[100:103], v[228:231]
    ds_read_b128 v[48:51], v22 offset:18432
    s_waitcnt lgkmcnt(10)
    v_mfma_f32_16x16x32_bf16 v[240:243], v[52:55], v[104:107], v[240:243]
    v_mfma_f32_16x16x32_bf16 v[236:239], v[52:55], v[100:103], v[236:239]
    ds_read_b128 v[52:55], v22 offset:18688
    v_mfma_f32_16x16x32_bf16 v[248:251], v[56:59], v[104:107], v[248:251]
    v_mfma_f32_16x16x32_bf16 v[244:247], v[56:59], v[100:103], v[244:247]
    ds_read_b128 v[56:59], v22 offset:18944
    v_mfma_f32_16x16x32_bf16 v[64:67], v[60:63], v[104:107], v[64:67]
    v_mfma_f32_16x16x32_bf16 v[252:255], v[60:63], v[100:103], v[252:255]
    ds_read_b128 v[60:63], v22 offset:19200
    s_waitcnt lgkmcnt(6)
    v_mfma_f32_16x16x32_bf16 v[192:195], v[28:31], v[80:83], v[192:195]
    ds_read_b64_tr_b16 v[88:89], v25 offset:24576
    v_mfma_f32_16x16x32_bf16 v[188:191], v[28:31], v[76:79], v[188:191]
    ds_read_b128 v[28:31], v18 offset:27648
    v_mfma_f32_16x16x32_bf16 v[200:203], v[32:35], v[80:83], v[200:203]
    ds_read_b64_tr_b16 v[90:91], v25 offset:28672
    v_mfma_f32_16x16x32_bf16 v[196:199], v[32:35], v[76:79], v[196:199]
    ds_read_b128 v[32:35], v18 offset:27904
    v_mfma_f32_16x16x32_bf16 v[208:211], v[36:39], v[80:83], v[208:211]
    ds_read_b64_tr_b16 v[84:85], v24 offset:24576
    v_mfma_f32_16x16x32_bf16 v[204:207], v[36:39], v[76:79], v[204:207]
    ds_read_b128 v[36:39], v18 offset:28160
    s_waitcnt lgkmcnt(9)
    v_mfma_f32_16x16x32_bf16 v[216:219], v[40:43], v[80:83], v[216:219]
    ds_read_b64_tr_b16 v[86:87], v24 offset:28672
    v_mfma_f32_16x16x32_bf16 v[212:215], v[40:43], v[76:79], v[212:215]
    ds_read_b128 v[40:43], v18 offset:28416
    v_mfma_f32_16x16x32_bf16 v[224:227], v[44:47], v[80:83], v[224:227]
    v_mfma_f32_16x16x32_bf16 v[220:223], v[44:47], v[76:79], v[220:223]
    ds_read_b128 v[44:47], v19 offset:27648
    v_mfma_f32_16x16x32_bf16 v[232:235], v[48:51], v[80:83], v[232:235]
    v_mfma_f32_16x16x32_bf16 v[228:231], v[48:51], v[76:79], v[228:231]
    ds_read_b128 v[48:51], v22 offset:27648
    s_waitcnt lgkmcnt(10)
    v_mfma_f32_16x16x32_bf16 v[240:243], v[52:55], v[80:83], v[240:243]
    v_mfma_f32_16x16x32_bf16 v[236:239], v[52:55], v[76:79], v[236:239]
    ds_read_b128 v[52:55], v22 offset:27904
    v_mfma_f32_16x16x32_bf16 v[248:251], v[56:59], v[80:83], v[248:251]
    v_mfma_f32_16x16x32_bf16 v[244:247], v[56:59], v[76:79], v[244:247]
    ds_read_b128 v[56:59], v22 offset:28160
    v_mfma_f32_16x16x32_bf16 v[64:67], v[60:63], v[80:83], v[64:67]
    v_mfma_f32_16x16x32_bf16 v[252:255], v[60:63], v[76:79], v[252:255]
    ds_read_b128 v[60:63], v22 offset:28416
    s_waitcnt lgkmcnt(6)
    v_mfma_f32_16x16x32_bf16 v[192:195], v[28:31], v[88:91], v[192:195]
    s_barrier
    v_mfma_f32_16x16x32_bf16 v[188:191], v[28:31], v[84:87], v[188:191]
    ds_read_b128 v[28:31], v18 offset:36864
    v_mfma_f32_16x16x32_bf16 v[200:203], v[32:35], v[88:91], v[200:203]
    v_mfma_f32_16x16x32_bf16 v[196:199], v[32:35], v[84:87], v[196:199]
    ds_read_b128 v[32:35], v18 offset:37120
    v_mfma_f32_16x16x32_bf16 v[208:211], v[36:39], v[88:91], v[208:211]
    v_mfma_f32_16x16x32_bf16 v[204:207], v[36:39], v[84:87], v[204:207]
    ds_read_b128 v[36:39], v18 offset:37376
    s_waitcnt lgkmcnt(6)
    v_mfma_f32_16x16x32_bf16 v[216:219], v[40:43], v[88:91], v[216:219]
    v_mfma_f32_16x16x32_bf16 v[212:215], v[40:43], v[84:87], v[212:215]
    ds_read_b128 v[40:43], v18 offset:37632
    v_mfma_f32_16x16x32_bf16 v[224:227], v[44:47], v[88:91], v[224:227]
    v_mfma_f32_16x16x32_bf16 v[220:223], v[44:47], v[84:87], v[220:223]
    ds_read_b128 v[44:47], v19 offset:36864
    v_mfma_f32_16x16x32_bf16 v[232:235], v[48:51], v[88:91], v[232:235]
    v_mfma_f32_16x16x32_bf16 v[228:231], v[48:51], v[84:87], v[228:231]
    ds_read_b128 v[48:51], v22 offset:36864
    s_waitcnt lgkmcnt(6)
    v_mfma_f32_16x16x32_bf16 v[240:243], v[52:55], v[88:91], v[240:243]
    v_mfma_f32_16x16x32_bf16 v[236:239], v[52:55], v[84:87], v[236:239]
    ds_read_b128 v[52:55], v22 offset:37120
    v_mfma_f32_16x16x32_bf16 v[248:251], v[56:59], v[88:91], v[248:251]
    v_mfma_f32_16x16x32_bf16 v[244:247], v[56:59], v[84:87], v[244:247]
    ds_read_b128 v[56:59], v22 offset:37376
    v_mfma_f32_16x16x32_bf16 v[64:67], v[60:63], v[88:91], v[64:67]
    v_mfma_f32_16x16x32_bf16 v[252:255], v[60:63], v[84:87], v[252:255]
    ds_read_b128 v[60:63], v22 offset:37632
    s_waitcnt lgkmcnt(6)
    v_mfma_f32_16x16x32_bf16 v[192:195], v[28:31], v[112:115], v[192:195]
    v_mfma_f32_16x16x32_bf16 v[188:191], v[28:31], v[108:111], v[188:191]
    ds_read_b128 v[28:31], v18 offset:46080
    v_mfma_f32_16x16x32_bf16 v[200:203], v[32:35], v[112:115], v[200:203]
    v_mfma_f32_16x16x32_bf16 v[196:199], v[32:35], v[108:111], v[196:199]
    ds_read_b128 v[32:35], v18 offset:46336
    v_mfma_f32_16x16x32_bf16 v[208:211], v[36:39], v[112:115], v[208:211]
    v_mfma_f32_16x16x32_bf16 v[204:207], v[36:39], v[108:111], v[204:207]
    ds_read_b128 v[36:39], v18 offset:46592
    s_waitcnt lgkmcnt(6)
    v_mfma_f32_16x16x32_bf16 v[216:219], v[40:43], v[112:115], v[216:219]
    v_mfma_f32_16x16x32_bf16 v[212:215], v[40:43], v[108:111], v[212:215]
    ds_read_b128 v[40:43], v18 offset:46848
    v_mfma_f32_16x16x32_bf16 v[224:227], v[44:47], v[112:115], v[224:227]
    v_mfma_f32_16x16x32_bf16 v[220:223], v[44:47], v[108:111], v[220:223]
    ds_read_b128 v[44:47], v19 offset:46080
    v_mfma_f32_16x16x32_bf16 v[232:235], v[48:51], v[112:115], v[232:235]
    v_mfma_f32_16x16x32_bf16 v[228:231], v[48:51], v[108:111], v[228:231]
    ds_read_b128 v[48:51], v22 offset:46080
    s_waitcnt lgkmcnt(6)
    v_mfma_f32_16x16x32_bf16 v[240:243], v[52:55], v[112:115], v[240:243]
    v_mfma_f32_16x16x32_bf16 v[236:239], v[52:55], v[108:111], v[236:239]
    ds_read_b128 v[52:55], v22 offset:46336
    v_mfma_f32_16x16x32_bf16 v[248:251], v[56:59], v[112:115], v[248:251]
    v_mfma_f32_16x16x32_bf16 v[244:247], v[56:59], v[108:111], v[244:247]
    ds_read_b128 v[56:59], v22 offset:46592
    v_mfma_f32_16x16x32_bf16 v[64:67], v[60:63], v[112:115], v[64:67]
    v_mfma_f32_16x16x32_bf16 v[252:255], v[60:63], v[108:111], v[252:255]
    ds_read_b128 v[60:63], v22 offset:46848
    s_waitcnt lgkmcnt(6)
    v_mfma_f32_16x16x32_bf16 v[192:195], v[28:31], v[120:123], v[192:195]
    s_barrier
    ds_read_b64_tr_b16 v[80:81], v21 offset:0
    v_mfma_f32_16x16x32_bf16 v[188:191], v[28:31], v[116:119], v[188:191]
    ds_read_b128 v[28:31], v18 offset:55296
    v_mfma_f32_16x16x32_bf16 v[200:203], v[32:35], v[120:123], v[200:203]
    ds_read_b64_tr_b16 v[82:83], v21 offset:4096
    v_mfma_f32_16x16x32_bf16 v[196:199], v[32:35], v[116:119], v[196:199]
    ds_read_b128 v[32:35], v18 offset:55552
    v_mfma_f32_16x16x32_bf16 v[208:211], v[36:39], v[120:123], v[208:211]
    ds_read_b64_tr_b16 v[76:77], v20 offset:0
    v_mfma_f32_16x16x32_bf16 v[204:207], v[36:39], v[116:119], v[204:207]
    ds_read_b128 v[36:39], v18 offset:55808
    s_waitcnt lgkmcnt(9)
    v_mfma_f32_16x16x32_bf16 v[216:219], v[40:43], v[120:123], v[216:219]
    ds_read_b64_tr_b16 v[78:79], v20 offset:4096
    v_mfma_f32_16x16x32_bf16 v[212:215], v[40:43], v[116:119], v[212:215]
    ds_read_b128 v[40:43], v18 offset:56064
    v_mfma_f32_16x16x32_bf16 v[224:227], v[44:47], v[120:123], v[224:227]
    v_mfma_f32_16x16x32_bf16 v[220:223], v[44:47], v[116:119], v[220:223]
    ds_read_b128 v[44:47], v19 offset:55296
    v_mfma_f32_16x16x32_bf16 v[232:235], v[48:51], v[120:123], v[232:235]
    v_mfma_f32_16x16x32_bf16 v[228:231], v[48:51], v[116:119], v[228:231]
    ds_read_b128 v[48:51], v22 offset:55296
    s_waitcnt lgkmcnt(10)
    v_mfma_f32_16x16x32_bf16 v[240:243], v[52:55], v[120:123], v[240:243]
    v_mfma_f32_16x16x32_bf16 v[236:239], v[52:55], v[116:119], v[236:239]
    ds_read_b128 v[52:55], v22 offset:55552
    v_mfma_f32_16x16x32_bf16 v[248:251], v[56:59], v[120:123], v[248:251]
    v_mfma_f32_16x16x32_bf16 v[244:247], v[56:59], v[116:119], v[244:247]
    ds_read_b128 v[56:59], v22 offset:55808
    v_mfma_f32_16x16x32_bf16 v[64:67], v[60:63], v[120:123], v[64:67]
    v_mfma_f32_16x16x32_bf16 v[252:255], v[60:63], v[116:119], v[252:255]
    ds_read_b128 v[60:63], v22 offset:56064
    s_waitcnt lgkmcnt(6)
    v_mfma_f32_16x16x32_bf16 v[192:195], v[28:31], v[80:83], v[192:195]
    ds_read_b64_tr_b16 v[88:89], v21 offset:8192
    v_mfma_f32_16x16x32_bf16 v[188:191], v[28:31], v[76:79], v[188:191]
    ds_read_b128 v[28:31], v18 offset:64512
    v_mfma_f32_16x16x32_bf16 v[200:203], v[32:35], v[80:83], v[200:203]
    ds_read_b64_tr_b16 v[90:91], v21 offset:12288
    v_mfma_f32_16x16x32_bf16 v[196:199], v[32:35], v[76:79], v[196:199]
    ds_read_b128 v[32:35], v18 offset:64768
    v_mfma_f32_16x16x32_bf16 v[208:211], v[36:39], v[80:83], v[208:211]
    ds_read_b64_tr_b16 v[84:85], v20 offset:8192
    v_mfma_f32_16x16x32_bf16 v[204:207], v[36:39], v[76:79], v[204:207]
    ds_read_b128 v[36:39], v18 offset:65024
    s_waitcnt lgkmcnt(9)
    v_mfma_f32_16x16x32_bf16 v[216:219], v[40:43], v[80:83], v[216:219]
    ds_read_b64_tr_b16 v[86:87], v20 offset:12288
    v_mfma_f32_16x16x32_bf16 v[212:215], v[40:43], v[76:79], v[212:215]
    ds_read_b128 v[40:43], v18 offset:65280
    v_mfma_f32_16x16x32_bf16 v[224:227], v[44:47], v[80:83], v[224:227]
    v_mfma_f32_16x16x32_bf16 v[220:223], v[44:47], v[76:79], v[220:223]
    ds_read_b128 v[44:47], v19 offset:64512
    v_mfma_f32_16x16x32_bf16 v[232:235], v[48:51], v[80:83], v[232:235]
    v_mfma_f32_16x16x32_bf16 v[228:231], v[48:51], v[76:79], v[228:231]
    ds_read_b128 v[48:51], v22 offset:64512
    s_waitcnt lgkmcnt(10)
    v_mfma_f32_16x16x32_bf16 v[240:243], v[52:55], v[80:83], v[240:243]
    v_mfma_f32_16x16x32_bf16 v[236:239], v[52:55], v[76:79], v[236:239]
    ds_read_b128 v[52:55], v22 offset:64768
    v_mfma_f32_16x16x32_bf16 v[248:251], v[56:59], v[80:83], v[248:251]
    v_mfma_f32_16x16x32_bf16 v[244:247], v[56:59], v[76:79], v[244:247]
    ds_read_b128 v[56:59], v22 offset:65024
    v_mfma_f32_16x16x32_bf16 v[64:67], v[60:63], v[80:83], v[64:67]
    v_mfma_f32_16x16x32_bf16 v[252:255], v[60:63], v[76:79], v[252:255]
    ds_read_b128 v[60:63], v22 offset:65280
    s_waitcnt lgkmcnt(6)
    v_mfma_f32_16x16x32_bf16 v[192:195], v[28:31], v[88:91], v[192:195]
    s_barrier
    v_mfma_f32_16x16x32_bf16 v[188:191], v[28:31], v[84:87], v[188:191]
    ds_read_b128 v[28:31], v18 offset:0
    v_mfma_f32_16x16x32_bf16 v[200:203], v[32:35], v[88:91], v[200:203]
    v_mfma_f32_16x16x32_bf16 v[196:199], v[32:35], v[84:87], v[196:199]
    ds_read_b128 v[32:35], v18 offset:256
    v_mfma_f32_16x16x32_bf16 v[208:211], v[36:39], v[88:91], v[208:211]
    v_mfma_f32_16x16x32_bf16 v[204:207], v[36:39], v[84:87], v[204:207]
    ds_read_b128 v[36:39], v18 offset:512
    s_waitcnt lgkmcnt(6)
    v_mfma_f32_16x16x32_bf16 v[216:219], v[40:43], v[88:91], v[216:219]
    v_mfma_f32_16x16x32_bf16 v[212:215], v[40:43], v[84:87], v[212:215]
    ds_read_b128 v[40:43], v18 offset:768
    v_mfma_f32_16x16x32_bf16 v[224:227], v[44:47], v[88:91], v[224:227]
    v_mfma_f32_16x16x32_bf16 v[220:223], v[44:47], v[84:87], v[220:223]
    ds_read_b128 v[44:47], v19 offset:0
    v_mfma_f32_16x16x32_bf16 v[232:235], v[48:51], v[88:91], v[232:235]
    v_mfma_f32_16x16x32_bf16 v[228:231], v[48:51], v[84:87], v[228:231]
    ds_read_b128 v[48:51], v22 offset:0
    s_waitcnt lgkmcnt(6)
    v_mfma_f32_16x16x32_bf16 v[240:243], v[52:55], v[88:91], v[240:243]
    v_mfma_f32_16x16x32_bf16 v[236:239], v[52:55], v[84:87], v[236:239]
    ds_read_b128 v[52:55], v22 offset:256
    v_mfma_f32_16x16x32_bf16 v[248:251], v[56:59], v[88:91], v[248:251]
    v_mfma_f32_16x16x32_bf16 v[244:247], v[56:59], v[84:87], v[244:247]
    ds_read_b128 v[56:59], v22 offset:512
    v_mfma_f32_16x16x32_bf16 v[64:67], v[60:63], v[88:91], v[64:67]
    v_mfma_f32_16x16x32_bf16 v[252:255], v[60:63], v[84:87], v[252:255]
    ds_read_b128 v[60:63], v22 offset:768
    s_waitcnt lgkmcnt(6)
    v_mfma_f32_16x16x32_bf16 v[192:195], v[28:31], v[128:131], v[192:195]
    v_mfma_f32_16x16x32_bf16 v[188:191], v[28:31], v[124:127], v[188:191]
    ds_read_b128 v[28:31], v18 offset:9216
    v_mfma_f32_16x16x32_bf16 v[200:203], v[32:35], v[128:131], v[200:203]
    v_mfma_f32_16x16x32_bf16 v[196:199], v[32:35], v[124:127], v[196:199]
    ds_read_b128 v[32:35], v18 offset:9472
    v_mfma_f32_16x16x32_bf16 v[208:211], v[36:39], v[128:131], v[208:211]
    v_mfma_f32_16x16x32_bf16 v[204:207], v[36:39], v[124:127], v[204:207]
    ds_read_b128 v[36:39], v18 offset:9728
    s_waitcnt lgkmcnt(6)
    v_mfma_f32_16x16x32_bf16 v[216:219], v[40:43], v[128:131], v[216:219]
    v_mfma_f32_16x16x32_bf16 v[212:215], v[40:43], v[124:127], v[212:215]
    ds_read_b128 v[40:43], v18 offset:9984
    v_mfma_f32_16x16x32_bf16 v[224:227], v[44:47], v[128:131], v[224:227]
    v_mfma_f32_16x16x32_bf16 v[220:223], v[44:47], v[124:127], v[220:223]
    ds_read_b128 v[44:47], v19 offset:9216
    v_mfma_f32_16x16x32_bf16 v[232:235], v[48:51], v[128:131], v[232:235]
    v_mfma_f32_16x16x32_bf16 v[228:231], v[48:51], v[124:127], v[228:231]
    ds_read_b128 v[48:51], v22 offset:9216
    s_waitcnt lgkmcnt(6)
    v_mfma_f32_16x16x32_bf16 v[240:243], v[52:55], v[128:131], v[240:243]
    v_mfma_f32_16x16x32_bf16 v[236:239], v[52:55], v[124:127], v[236:239]
    ds_read_b128 v[52:55], v22 offset:9472
    v_mfma_f32_16x16x32_bf16 v[248:251], v[56:59], v[128:131], v[248:251]
    v_mfma_f32_16x16x32_bf16 v[244:247], v[56:59], v[124:127], v[244:247]
    ds_read_b128 v[56:59], v22 offset:9728
    v_mfma_f32_16x16x32_bf16 v[64:67], v[60:63], v[128:131], v[64:67]
    v_mfma_f32_16x16x32_bf16 v[252:255], v[60:63], v[124:127], v[252:255]
    ds_read_b128 v[60:63], v22 offset:9984
    s_waitcnt lgkmcnt(6)
    v_mfma_f32_16x16x32_bf16 v[192:195], v[28:31], v[136:139], v[192:195]
    s_barrier
    ds_read_b64_tr_b16 v[80:81], v21 offset:16384
    v_mfma_f32_16x16x32_bf16 v[188:191], v[28:31], v[132:135], v[188:191]
    ds_read_b128 v[28:31], v18 offset:18432
    v_mfma_f32_16x16x32_bf16 v[200:203], v[32:35], v[136:139], v[200:203]
    ds_read_b64_tr_b16 v[82:83], v21 offset:20480
    v_mfma_f32_16x16x32_bf16 v[196:199], v[32:35], v[132:135], v[196:199]
    ds_read_b128 v[32:35], v18 offset:18688
    v_mfma_f32_16x16x32_bf16 v[208:211], v[36:39], v[136:139], v[208:211]
    ds_read_b64_tr_b16 v[76:77], v20 offset:16384
    v_mfma_f32_16x16x32_bf16 v[204:207], v[36:39], v[132:135], v[204:207]
    ds_read_b128 v[36:39], v18 offset:18944
    s_waitcnt lgkmcnt(9)
    v_mfma_f32_16x16x32_bf16 v[216:219], v[40:43], v[136:139], v[216:219]
    ds_read_b64_tr_b16 v[78:79], v20 offset:20480
    v_mfma_f32_16x16x32_bf16 v[212:215], v[40:43], v[132:135], v[212:215]
    ds_read_b128 v[40:43], v18 offset:19200
    v_mfma_f32_16x16x32_bf16 v[224:227], v[44:47], v[136:139], v[224:227]
    v_mfma_f32_16x16x32_bf16 v[220:223], v[44:47], v[132:135], v[220:223]
    ds_read_b128 v[44:47], v19 offset:18432
    v_mfma_f32_16x16x32_bf16 v[232:235], v[48:51], v[136:139], v[232:235]
    v_mfma_f32_16x16x32_bf16 v[228:231], v[48:51], v[132:135], v[228:231]
    ds_read_b128 v[48:51], v22 offset:18432
    s_waitcnt lgkmcnt(10)
    v_mfma_f32_16x16x32_bf16 v[240:243], v[52:55], v[136:139], v[240:243]
    v_mfma_f32_16x16x32_bf16 v[236:239], v[52:55], v[132:135], v[236:239]
    ds_read_b128 v[52:55], v22 offset:18688
    v_mfma_f32_16x16x32_bf16 v[248:251], v[56:59], v[136:139], v[248:251]
    v_mfma_f32_16x16x32_bf16 v[244:247], v[56:59], v[132:135], v[244:247]
    ds_read_b128 v[56:59], v22 offset:18944
    v_mfma_f32_16x16x32_bf16 v[64:67], v[60:63], v[136:139], v[64:67]
    v_mfma_f32_16x16x32_bf16 v[252:255], v[60:63], v[132:135], v[252:255]
    ds_read_b128 v[60:63], v22 offset:19200
    s_waitcnt lgkmcnt(6)
    v_mfma_f32_16x16x32_bf16 v[192:195], v[28:31], v[80:83], v[192:195]
    ds_read_b64_tr_b16 v[88:89], v21 offset:24576
    v_mfma_f32_16x16x32_bf16 v[188:191], v[28:31], v[76:79], v[188:191]
    ds_read_b128 v[28:31], v18 offset:27648
    v_mfma_f32_16x16x32_bf16 v[200:203], v[32:35], v[80:83], v[200:203]
    ds_read_b64_tr_b16 v[90:91], v21 offset:28672
    v_mfma_f32_16x16x32_bf16 v[196:199], v[32:35], v[76:79], v[196:199]
    ds_read_b128 v[32:35], v18 offset:27904
    v_mfma_f32_16x16x32_bf16 v[208:211], v[36:39], v[80:83], v[208:211]
    ds_read_b64_tr_b16 v[84:85], v20 offset:24576
    v_mfma_f32_16x16x32_bf16 v[204:207], v[36:39], v[76:79], v[204:207]
    ds_read_b128 v[36:39], v18 offset:28160
    s_waitcnt lgkmcnt(9)
    v_mfma_f32_16x16x32_bf16 v[216:219], v[40:43], v[80:83], v[216:219]
    ds_read_b64_tr_b16 v[86:87], v20 offset:28672
    v_mfma_f32_16x16x32_bf16 v[212:215], v[40:43], v[76:79], v[212:215]
    ds_read_b128 v[40:43], v18 offset:28416
    v_mfma_f32_16x16x32_bf16 v[224:227], v[44:47], v[80:83], v[224:227]
    v_mfma_f32_16x16x32_bf16 v[220:223], v[44:47], v[76:79], v[220:223]
    ds_read_b128 v[44:47], v19 offset:27648
    v_mfma_f32_16x16x32_bf16 v[232:235], v[48:51], v[80:83], v[232:235]
    v_mfma_f32_16x16x32_bf16 v[228:231], v[48:51], v[76:79], v[228:231]
    ds_read_b128 v[48:51], v22 offset:27648
    s_waitcnt lgkmcnt(10)
    v_mfma_f32_16x16x32_bf16 v[240:243], v[52:55], v[80:83], v[240:243]
    v_mfma_f32_16x16x32_bf16 v[236:239], v[52:55], v[76:79], v[236:239]
    ds_read_b128 v[52:55], v22 offset:27904
    v_mfma_f32_16x16x32_bf16 v[248:251], v[56:59], v[80:83], v[248:251]
    v_mfma_f32_16x16x32_bf16 v[244:247], v[56:59], v[76:79], v[244:247]
    ds_read_b128 v[56:59], v22 offset:28160
    v_mfma_f32_16x16x32_bf16 v[64:67], v[60:63], v[80:83], v[64:67]
    v_mfma_f32_16x16x32_bf16 v[252:255], v[60:63], v[76:79], v[252:255]
    ds_read_b128 v[60:63], v22 offset:28416
    s_waitcnt lgkmcnt(6)
    v_mfma_f32_16x16x32_bf16 v[192:195], v[28:31], v[88:91], v[192:195]
    s_barrier
    v_mfma_f32_16x16x32_bf16 v[188:191], v[28:31], v[84:87], v[188:191]
    ds_read_b128 v[28:31], v18 offset:36864
    v_mfma_f32_16x16x32_bf16 v[200:203], v[32:35], v[88:91], v[200:203]
    v_mfma_f32_16x16x32_bf16 v[196:199], v[32:35], v[84:87], v[196:199]
    ds_read_b128 v[32:35], v18 offset:37120
    v_mfma_f32_16x16x32_bf16 v[208:211], v[36:39], v[88:91], v[208:211]
    v_mfma_f32_16x16x32_bf16 v[204:207], v[36:39], v[84:87], v[204:207]
    ds_read_b128 v[36:39], v18 offset:37376
    s_waitcnt lgkmcnt(6)
    v_mfma_f32_16x16x32_bf16 v[216:219], v[40:43], v[88:91], v[216:219]
    v_mfma_f32_16x16x32_bf16 v[212:215], v[40:43], v[84:87], v[212:215]
    ds_read_b128 v[40:43], v18 offset:37632
    v_mfma_f32_16x16x32_bf16 v[224:227], v[44:47], v[88:91], v[224:227]
    v_mfma_f32_16x16x32_bf16 v[220:223], v[44:47], v[84:87], v[220:223]
    ds_read_b128 v[44:47], v19 offset:36864
    v_mfma_f32_16x16x32_bf16 v[232:235], v[48:51], v[88:91], v[232:235]
    v_mfma_f32_16x16x32_bf16 v[228:231], v[48:51], v[84:87], v[228:231]
    ds_read_b128 v[48:51], v22 offset:36864
    s_waitcnt lgkmcnt(6)
    v_mfma_f32_16x16x32_bf16 v[240:243], v[52:55], v[88:91], v[240:243]
    v_mfma_f32_16x16x32_bf16 v[236:239], v[52:55], v[84:87], v[236:239]
    ds_read_b128 v[52:55], v22 offset:37120
    v_mfma_f32_16x16x32_bf16 v[248:251], v[56:59], v[88:91], v[248:251]
    v_mfma_f32_16x16x32_bf16 v[244:247], v[56:59], v[84:87], v[244:247]
    ds_read_b128 v[56:59], v22 offset:37376
    v_mfma_f32_16x16x32_bf16 v[64:67], v[60:63], v[88:91], v[64:67]
    v_mfma_f32_16x16x32_bf16 v[252:255], v[60:63], v[84:87], v[252:255]
    ds_read_b128 v[60:63], v22 offset:37632
    s_waitcnt lgkmcnt(6)
    v_mfma_f32_16x16x32_bf16 v[192:195], v[28:31], v[144:147], v[192:195]
    v_mfma_f32_16x16x32_bf16 v[188:191], v[28:31], v[140:143], v[188:191]
    ds_read_b128 v[28:31], v18 offset:46080
    v_mfma_f32_16x16x32_bf16 v[200:203], v[32:35], v[144:147], v[200:203]
    v_mfma_f32_16x16x32_bf16 v[196:199], v[32:35], v[140:143], v[196:199]
    ds_read_b128 v[32:35], v18 offset:46336
    v_mfma_f32_16x16x32_bf16 v[208:211], v[36:39], v[144:147], v[208:211]
    v_mfma_f32_16x16x32_bf16 v[204:207], v[36:39], v[140:143], v[204:207]
    ds_read_b128 v[36:39], v18 offset:46592
    s_waitcnt lgkmcnt(6)
    v_mfma_f32_16x16x32_bf16 v[216:219], v[40:43], v[144:147], v[216:219]
    v_mfma_f32_16x16x32_bf16 v[212:215], v[40:43], v[140:143], v[212:215]
    ds_read_b128 v[40:43], v18 offset:46848
    v_mfma_f32_16x16x32_bf16 v[224:227], v[44:47], v[144:147], v[224:227]
    v_mfma_f32_16x16x32_bf16 v[220:223], v[44:47], v[140:143], v[220:223]
    ds_read_b128 v[44:47], v19 offset:46080
    v_mfma_f32_16x16x32_bf16 v[232:235], v[48:51], v[144:147], v[232:235]
    v_mfma_f32_16x16x32_bf16 v[228:231], v[48:51], v[140:143], v[228:231]
    ds_read_b128 v[48:51], v22 offset:46080
    s_waitcnt lgkmcnt(6)
    v_mfma_f32_16x16x32_bf16 v[240:243], v[52:55], v[144:147], v[240:243]
    v_mfma_f32_16x16x32_bf16 v[236:239], v[52:55], v[140:143], v[236:239]
    ds_read_b128 v[52:55], v22 offset:46336
    v_mfma_f32_16x16x32_bf16 v[248:251], v[56:59], v[144:147], v[248:251]
    v_mfma_f32_16x16x32_bf16 v[244:247], v[56:59], v[140:143], v[244:247]
    ds_read_b128 v[56:59], v22 offset:46592
    v_mfma_f32_16x16x32_bf16 v[64:67], v[60:63], v[144:147], v[64:67]
    v_mfma_f32_16x16x32_bf16 v[252:255], v[60:63], v[140:143], v[252:255]
    ds_read_b128 v[60:63], v22 offset:46848
    s_waitcnt lgkmcnt(6)
    v_mfma_f32_16x16x32_bf16 v[192:195], v[28:31], v[152:155], v[192:195]
    s_barrier
    v_mfma_f32_16x16x32_bf16 v[188:191], v[28:31], v[148:151], v[188:191]
    ds_read_b128 v[28:31], v18 offset:55296
    v_mfma_f32_16x16x32_bf16 v[200:203], v[32:35], v[152:155], v[200:203]
    v_mfma_f32_16x16x32_bf16 v[196:199], v[32:35], v[148:151], v[196:199]
    ds_read_b128 v[32:35], v18 offset:55552
    v_mfma_f32_16x16x32_bf16 v[208:211], v[36:39], v[152:155], v[208:211]
    v_mfma_f32_16x16x32_bf16 v[204:207], v[36:39], v[148:151], v[204:207]
    ds_read_b128 v[36:39], v18 offset:55808
    s_waitcnt lgkmcnt(6)
    v_mfma_f32_16x16x32_bf16 v[216:219], v[40:43], v[152:155], v[216:219]
    v_mfma_f32_16x16x32_bf16 v[212:215], v[40:43], v[148:151], v[212:215]
    ds_read_b128 v[40:43], v18 offset:56064
    v_mfma_f32_16x16x32_bf16 v[224:227], v[44:47], v[152:155], v[224:227]
    v_mfma_f32_16x16x32_bf16 v[220:223], v[44:47], v[148:151], v[220:223]
    ds_read_b128 v[44:47], v19 offset:55296
    v_mfma_f32_16x16x32_bf16 v[232:235], v[48:51], v[152:155], v[232:235]
    v_mfma_f32_16x16x32_bf16 v[228:231], v[48:51], v[148:151], v[228:231]
    ds_read_b128 v[48:51], v22 offset:55296
    s_waitcnt lgkmcnt(6)
    v_mfma_f32_16x16x32_bf16 v[240:243], v[52:55], v[152:155], v[240:243]
    v_mfma_f32_16x16x32_bf16 v[236:239], v[52:55], v[148:151], v[236:239]
    ds_read_b128 v[52:55], v22 offset:55552
    v_mfma_f32_16x16x32_bf16 v[248:251], v[56:59], v[152:155], v[248:251]
    v_mfma_f32_16x16x32_bf16 v[244:247], v[56:59], v[148:151], v[244:247]
    ds_read_b128 v[56:59], v22 offset:55808
    v_mfma_f32_16x16x32_bf16 v[64:67], v[60:63], v[152:155], v[64:67]
    v_mfma_f32_16x16x32_bf16 v[252:255], v[60:63], v[148:151], v[252:255]
    ds_read_b128 v[60:63], v22 offset:56064
    s_waitcnt lgkmcnt(6)
    v_mfma_f32_16x16x32_bf16 v[192:195], v[28:31], v[160:163], v[192:195]
    v_mfma_f32_16x16x32_bf16 v[188:191], v[28:31], v[156:159], v[188:191]
    ds_read_b128 v[28:31], v18 offset:64512
    v_mfma_f32_16x16x32_bf16 v[200:203], v[32:35], v[160:163], v[200:203]
    v_mfma_f32_16x16x32_bf16 v[196:199], v[32:35], v[156:159], v[196:199]
    ds_read_b128 v[32:35], v18 offset:64768
    v_mfma_f32_16x16x32_bf16 v[208:211], v[36:39], v[160:163], v[208:211]
    v_mfma_f32_16x16x32_bf16 v[204:207], v[36:39], v[156:159], v[204:207]
    ds_read_b128 v[36:39], v18 offset:65024
    s_waitcnt lgkmcnt(6)
    v_mfma_f32_16x16x32_bf16 v[216:219], v[40:43], v[160:163], v[216:219]
    v_mfma_f32_16x16x32_bf16 v[212:215], v[40:43], v[156:159], v[212:215]
    ds_read_b128 v[40:43], v18 offset:65280
    v_mfma_f32_16x16x32_bf16 v[224:227], v[44:47], v[160:163], v[224:227]
    v_mfma_f32_16x16x32_bf16 v[220:223], v[44:47], v[156:159], v[220:223]
    ds_read_b128 v[44:47], v19 offset:64512
    v_mfma_f32_16x16x32_bf16 v[232:235], v[48:51], v[160:163], v[232:235]
    v_mfma_f32_16x16x32_bf16 v[228:231], v[48:51], v[156:159], v[228:231]
    ds_read_b128 v[48:51], v22 offset:64512
    s_waitcnt lgkmcnt(6)
    v_mfma_f32_16x16x32_bf16 v[240:243], v[52:55], v[160:163], v[240:243]
    v_mfma_f32_16x16x32_bf16 v[236:239], v[52:55], v[156:159], v[236:239]
    ds_read_b128 v[52:55], v22 offset:64768
    v_mfma_f32_16x16x32_bf16 v[248:251], v[56:59], v[160:163], v[248:251]
    v_mfma_f32_16x16x32_bf16 v[244:247], v[56:59], v[156:159], v[244:247]
    ds_read_b128 v[56:59], v22 offset:65024
    v_mfma_f32_16x16x32_bf16 v[64:67], v[60:63], v[160:163], v[64:67]
    v_mfma_f32_16x16x32_bf16 v[252:255], v[60:63], v[156:159], v[252:255]
    ds_read_b128 v[60:63], v22 offset:65280
    s_waitcnt lgkmcnt(6)
    v_mfma_f32_16x16x32_bf16 v[192:195], v[28:31], v[168:171], v[192:195]
    s_barrier
    v_mfma_f32_16x16x32_bf16 v[188:191], v[28:31], v[164:167], v[188:191]
    ds_read_b128 v[28:31], v18 offset:0
    v_mfma_f32_16x16x32_bf16 v[200:203], v[32:35], v[168:171], v[200:203]
    v_mfma_f32_16x16x32_bf16 v[196:199], v[32:35], v[164:167], v[196:199]
    ds_read_b128 v[32:35], v18 offset:256
    v_mfma_f32_16x16x32_bf16 v[208:211], v[36:39], v[168:171], v[208:211]
    v_mfma_f32_16x16x32_bf16 v[204:207], v[36:39], v[164:167], v[204:207]
    ds_read_b128 v[36:39], v18 offset:512
    s_waitcnt lgkmcnt(6)
    v_mfma_f32_16x16x32_bf16 v[216:219], v[40:43], v[168:171], v[216:219]
    v_mfma_f32_16x16x32_bf16 v[212:215], v[40:43], v[164:167], v[212:215]
    ds_read_b128 v[40:43], v18 offset:768
    v_mfma_f32_16x16x32_bf16 v[224:227], v[44:47], v[168:171], v[224:227]
    v_mfma_f32_16x16x32_bf16 v[220:223], v[44:47], v[164:167], v[220:223]
    ds_read_b128 v[44:47], v19 offset:0
    v_mfma_f32_16x16x32_bf16 v[232:235], v[48:51], v[168:171], v[232:235]
    v_mfma_f32_16x16x32_bf16 v[228:231], v[48:51], v[164:167], v[228:231]
    ds_read_b128 v[48:51], v22 offset:0
    s_waitcnt lgkmcnt(6)
    v_mfma_f32_16x16x32_bf16 v[240:243], v[52:55], v[168:171], v[240:243]
    v_mfma_f32_16x16x32_bf16 v[236:239], v[52:55], v[164:167], v[236:239]
    ds_read_b128 v[52:55], v22 offset:256
    v_mfma_f32_16x16x32_bf16 v[248:251], v[56:59], v[168:171], v[248:251]
    v_mfma_f32_16x16x32_bf16 v[244:247], v[56:59], v[164:167], v[244:247]
    ds_read_b128 v[56:59], v22 offset:512
    v_mfma_f32_16x16x32_bf16 v[64:67], v[60:63], v[168:171], v[64:67]
    v_mfma_f32_16x16x32_bf16 v[252:255], v[60:63], v[164:167], v[252:255]
    ds_read_b128 v[60:63], v22 offset:768
    s_waitcnt lgkmcnt(6)
    v_mfma_f32_16x16x32_bf16 v[192:195], v[28:31], v[176:179], v[192:195]
    v_mfma_f32_16x16x32_bf16 v[188:191], v[28:31], v[172:175], v[188:191]
    ds_read_b128 v[28:31], v18 offset:9216
    v_mfma_f32_16x16x32_bf16 v[200:203], v[32:35], v[176:179], v[200:203]
    v_mfma_f32_16x16x32_bf16 v[196:199], v[32:35], v[172:175], v[196:199]
    ds_read_b128 v[32:35], v18 offset:9472
    v_mfma_f32_16x16x32_bf16 v[208:211], v[36:39], v[176:179], v[208:211]
    v_mfma_f32_16x16x32_bf16 v[204:207], v[36:39], v[172:175], v[204:207]
    ds_read_b128 v[36:39], v18 offset:9728
    s_waitcnt lgkmcnt(6)
    v_mfma_f32_16x16x32_bf16 v[216:219], v[40:43], v[176:179], v[216:219]
    v_mfma_f32_16x16x32_bf16 v[212:215], v[40:43], v[172:175], v[212:215]
    s_branch L_skip_9
    s_nop 0
L_stub_9:
    s_branch L_stub_10
L_skip_9:
    ds_read_b128 v[40:43], v18 offset:9984
    v_mfma_f32_16x16x32_bf16 v[224:227], v[44:47], v[176:179], v[224:227]
    v_mfma_f32_16x16x32_bf16 v[220:223], v[44:47], v[172:175], v[220:223]
    ds_read_b128 v[44:47], v19 offset:9216
    v_mfma_f32_16x16x32_bf16 v[232:235], v[48:51], v[176:179], v[232:235]
    v_mfma_f32_16x16x32_bf16 v[228:231], v[48:51], v[172:175], v[228:231]
    ds_read_b128 v[48:51], v22 offset:9216
    s_waitcnt lgkmcnt(6)
    v_mfma_f32_16x16x32_bf16 v[240:243], v[52:55], v[176:179], v[240:243]
    v_mfma_f32_16x16x32_bf16 v[236:239], v[52:55], v[172:175], v[236:239]
    ds_read_b128 v[52:55], v22 offset:9472
    v_mfma_f32_16x16x32_bf16 v[248:251], v[56:59], v[176:179], v[248:251]
    v_mfma_f32_16x16x32_bf16 v[244:247], v[56:59], v[172:175], v[244:247]
    ds_read_b128 v[56:59], v22 offset:9728
    v_mfma_f32_16x16x32_bf16 v[64:67], v[60:63], v[176:179], v[64:67]
    v_mfma_f32_16x16x32_bf16 v[252:255], v[60:63], v[172:175], v[252:255]
    ds_read_b128 v[60:63], v22 offset:9984
    s_waitcnt lgkmcnt(6)
    v_mfma_f32_16x16x32_bf16 v[192:195], v[28:31], v[184:187], v[192:195]
    s_barrier
    ds_read_b64_tr_b16 v[80:81], v21 offset:32768
    v_mfma_f32_16x16x32_bf16 v[188:191], v[28:31], v[180:183], v[188:191]
    ds_read_b128 v[28:31], v18 offset:18432
    v_mfma_f32_16x16x32_bf16 v[200:203], v[32:35], v[184:187], v[200:203]
    ds_read_b64_tr_b16 v[82:83], v21 offset:36864
    v_mfma_f32_16x16x32_bf16 v[196:199], v[32:35], v[180:183], v[196:199]
    ds_read_b128 v[32:35], v18 offset:18688
    v_mfma_f32_16x16x32_bf16 v[208:211], v[36:39], v[184:187], v[208:211]
    ds_read_b64_tr_b16 v[76:77], v20 offset:32768
    v_mfma_f32_16x16x32_bf16 v[204:207], v[36:39], v[180:183], v[204:207]
    ds_read_b128 v[36:39], v18 offset:18944
    s_waitcnt lgkmcnt(9)
    v_mfma_f32_16x16x32_bf16 v[216:219], v[40:43], v[184:187], v[216:219]
    ds_read_b64_tr_b16 v[78:79], v20 offset:36864
    v_mfma_f32_16x16x32_bf16 v[212:215], v[40:43], v[180:183], v[212:215]
    ds_read_b128 v[40:43], v18 offset:19200
    v_mfma_f32_16x16x32_bf16 v[224:227], v[44:47], v[184:187], v[224:227]
    v_mfma_f32_16x16x32_bf16 v[220:223], v[44:47], v[180:183], v[220:223]
    ds_read_b128 v[44:47], v19 offset:18432
    v_mfma_f32_16x16x32_bf16 v[232:235], v[48:51], v[184:187], v[232:235]
    v_mfma_f32_16x16x32_bf16 v[228:231], v[48:51], v[180:183], v[228:231]
    ds_read_b128 v[48:51], v22 offset:18432
    s_waitcnt lgkmcnt(10)
    v_mfma_f32_16x16x32_bf16 v[240:243], v[52:55], v[184:187], v[240:243]
    v_mfma_f32_16x16x32_bf16 v[236:239], v[52:55], v[180:183], v[236:239]
    ds_read_b128 v[52:55], v22 offset:18688
    v_mfma_f32_16x16x32_bf16 v[248:251], v[56:59], v[184:187], v[248:251]
    v_mfma_f32_16x16x32_bf16 v[244:247], v[56:59], v[180:183], v[244:247]
    ds_read_b128 v[56:59], v22 offset:18944
    v_mfma_f32_16x16x32_bf16 v[64:67], v[60:63], v[184:187], v[64:67]
    v_mfma_f32_16x16x32_bf16 v[252:255], v[60:63], v[180:183], v[252:255]
    ds_read_b128 v[60:63], v22 offset:19200
    s_waitcnt lgkmcnt(6)
    v_mfma_f32_16x16x32_bf16 v[192:195], v[28:31], v[80:83], v[192:195]
    ds_read_b64_tr_b16 v[88:89], v21 offset:40960
    v_mfma_f32_16x16x32_bf16 v[188:191], v[28:31], v[76:79], v[188:191]
    ds_read_b128 v[28:31], v18 offset:27648
    v_mfma_f32_16x16x32_bf16 v[200:203], v[32:35], v[80:83], v[200:203]
    ds_read_b64_tr_b16 v[90:91], v21 offset:45056
    v_mfma_f32_16x16x32_bf16 v[196:199], v[32:35], v[76:79], v[196:199]
    ds_read_b128 v[32:35], v18 offset:27904
    v_mfma_f32_16x16x32_bf16 v[208:211], v[36:39], v[80:83], v[208:211]
    ds_read_b64_tr_b16 v[84:85], v20 offset:40960
    v_mfma_f32_16x16x32_bf16 v[204:207], v[36:39], v[76:79], v[204:207]
    ds_read_b128 v[36:39], v18 offset:28160
    s_waitcnt lgkmcnt(9)
    v_mfma_f32_16x16x32_bf16 v[216:219], v[40:43], v[80:83], v[216:219]
    ds_read_b64_tr_b16 v[86:87], v20 offset:45056
    v_mfma_f32_16x16x32_bf16 v[212:215], v[40:43], v[76:79], v[212:215]
    ds_read_b128 v[40:43], v18 offset:28416
    v_mfma_f32_16x16x32_bf16 v[224:227], v[44:47], v[80:83], v[224:227]
    v_mfma_f32_16x16x32_bf16 v[220:223], v[44:47], v[76:79], v[220:223]
    ds_read_b128 v[44:47], v19 offset:27648
    v_mfma_f32_16x16x32_bf16 v[232:235], v[48:51], v[80:83], v[232:235]
    v_mfma_f32_16x16x32_bf16 v[228:231], v[48:51], v[76:79], v[228:231]
    ds_read_b128 v[48:51], v22 offset:27648
    s_waitcnt lgkmcnt(10)
    v_mfma_f32_16x16x32_bf16 v[240:243], v[52:55], v[80:83], v[240:243]
    v_mfma_f32_16x16x32_bf16 v[236:239], v[52:55], v[76:79], v[236:239]
    ds_read_b128 v[52:55], v22 offset:27904
    v_mfma_f32_16x16x32_bf16 v[248:251], v[56:59], v[80:83], v[248:251]
    v_mfma_f32_16x16x32_bf16 v[244:247], v[56:59], v[76:79], v[244:247]
    ds_read_b128 v[56:59], v22 offset:28160
    v_mfma_f32_16x16x32_bf16 v[64:67], v[60:63], v[80:83], v[64:67]
    v_mfma_f32_16x16x32_bf16 v[252:255], v[60:63], v[76:79], v[252:255]
    ds_read_b128 v[60:63], v22 offset:28416
    s_waitcnt lgkmcnt(6)
    v_mfma_f32_16x16x32_bf16 v[192:195], v[28:31], v[88:91], v[192:195]
    s_barrier
    ds_read_b64_tr_b16 v[80:81], v25 offset:0
    v_mfma_f32_16x16x32_bf16 v[188:191], v[28:31], v[84:87], v[188:191]
    ds_read_b128 v[28:31], v18 offset:36864
    v_mfma_f32_16x16x32_bf16 v[200:203], v[32:35], v[88:91], v[200:203]
    ds_read_b64_tr_b16 v[82:83], v25 offset:4096
    v_mfma_f32_16x16x32_bf16 v[196:199], v[32:35], v[84:87], v[196:199]
    ds_read_b128 v[32:35], v18 offset:37120
    v_mfma_f32_16x16x32_bf16 v[208:211], v[36:39], v[88:91], v[208:211]
    ds_read_b64_tr_b16 v[92:93], v24 offset:0
    v_mfma_f32_16x16x32_bf16 v[204:207], v[36:39], v[84:87], v[204:207]
    ds_read_b128 v[36:39], v18 offset:37376
    s_waitcnt lgkmcnt(9)
    v_mfma_f32_16x16x32_bf16 v[216:219], v[40:43], v[88:91], v[216:219]
    ds_read_b64_tr_b16 v[94:95], v24 offset:4096
    v_mfma_f32_16x16x32_bf16 v[212:215], v[40:43], v[84:87], v[212:215]
    ds_read_b128 v[40:43], v18 offset:37632
    v_mfma_f32_16x16x32_bf16 v[224:227], v[44:47], v[88:91], v[224:227]
    v_mfma_f32_16x16x32_bf16 v[220:223], v[44:47], v[84:87], v[220:223]
    ds_read_b128 v[44:47], v19 offset:36864
    v_mfma_f32_16x16x32_bf16 v[232:235], v[48:51], v[88:91], v[232:235]
    v_mfma_f32_16x16x32_bf16 v[228:231], v[48:51], v[84:87], v[228:231]
    ds_read_b128 v[48:51], v22 offset:36864
    s_waitcnt lgkmcnt(10)
    v_mfma_f32_16x16x32_bf16 v[240:243], v[52:55], v[88:91], v[240:243]
    v_mfma_f32_16x16x32_bf16 v[236:239], v[52:55], v[84:87], v[236:239]
    ds_read_b128 v[52:55], v22 offset:37120
    v_mfma_f32_16x16x32_bf16 v[248:251], v[56:59], v[88:91], v[248:251]
    v_mfma_f32_16x16x32_bf16 v[244:247], v[56:59], v[84:87], v[244:247]
    ds_read_b128 v[56:59], v22 offset:37376
    v_mfma_f32_16x16x32_bf16 v[64:67], v[60:63], v[88:91], v[64:67]
    v_mfma_f32_16x16x32_bf16 v[252:255], v[60:63], v[84:87], v[252:255]
    ds_read_b128 v[60:63], v22 offset:37632
    s_waitcnt lgkmcnt(7)
    v_mfma_f32_16x16x32_bf16 v[192:195], v[28:31], v[80:83], v[192:195]
    ds_read_b128 v[28:31], v18 offset:46080
    ds_read_b64_tr_b16 v[88:89], v25 offset:8192
    v_mfma_f32_16x16x32_bf16 v[200:203], v[32:35], v[80:83], v[200:203]
    ds_read_b128 v[32:35], v18 offset:46336
    ds_read_b64_tr_b16 v[90:91], v25 offset:12288
    v_mfma_f32_16x16x32_bf16 v[208:211], v[36:39], v[80:83], v[208:211]
    ds_read_b128 v[36:39], v18 offset:46592
    s_waitcnt lgkmcnt(8)
    v_mfma_f32_16x16x32_bf16 v[216:219], v[40:43], v[80:83], v[216:219]
    ds_read_b128 v[40:43], v18 offset:46848
    v_mfma_f32_16x16x32_bf16 v[224:227], v[44:47], v[80:83], v[224:227]
    ds_read_b128 v[44:47], v19 offset:46080
    v_mfma_f32_16x16x32_bf16 v[232:235], v[48:51], v[80:83], v[232:235]
    ds_read_b128 v[48:51], v22 offset:46080
    ds_read_b64_tr_b16 v[96:97], v24 offset:8192
    s_waitcnt lgkmcnt(9)
    v_mfma_f32_16x16x32_bf16 v[240:243], v[52:55], v[80:83], v[240:243]
    ds_read_b128 v[52:55], v22 offset:46336
    ds_read_b64_tr_b16 v[98:99], v24 offset:12288
    v_mfma_f32_16x16x32_bf16 v[248:251], v[56:59], v[80:83], v[248:251]
    ds_read_b128 v[56:59], v22 offset:46592
    v_mfma_f32_16x16x32_bf16 v[64:67], v[60:63], v[80:83], v[64:67]
    ds_read_b128 v[60:63], v22 offset:46848
    s_waitcnt lgkmcnt(8)
    v_mfma_f32_16x16x32_bf16 v[192:195], v[28:31], v[88:91], v[192:195]
    s_barrier
    ds_read_b128 v[28:31], v18 offset:55296
    ds_read_b64_tr_b16 v[80:81], v25 offset:16384
    v_mfma_f32_16x16x32_bf16 v[200:203], v[32:35], v[88:91], v[200:203]
    ds_read_b128 v[32:35], v18 offset:55552
    ds_read_b64_tr_b16 v[82:83], v25 offset:20480
    v_mfma_f32_16x16x32_bf16 v[208:211], v[36:39], v[88:91], v[208:211]
    ds_read_b128 v[36:39], v18 offset:55808
    s_waitcnt lgkmcnt(10)
    v_mfma_f32_16x16x32_bf16 v[216:219], v[40:43], v[88:91], v[216:219]
    ds_read_b128 v[40:43], v18 offset:56064
    v_mfma_f32_16x16x32_bf16 v[224:227], v[44:47], v[88:91], v[224:227]
    ds_read_b128 v[44:47], v19 offset:55296
    v_mfma_f32_16x16x32_bf16 v[232:235], v[48:51], v[88:91], v[232:235]
    ds_read_b128 v[48:51], v22 offset:55296
    ds_read_b64_tr_b16 v[100:101], v24 offset:16384
    s_waitcnt lgkmcnt(9)
    v_mfma_f32_16x16x32_bf16 v[240:243], v[52:55], v[88:91], v[240:243]
    ds_read_b128 v[52:55], v22 offset:55552
    ds_read_b64_tr_b16 v[102:103], v24 offset:20480
    v_mfma_f32_16x16x32_bf16 v[248:251], v[56:59], v[88:91], v[248:251]
    ds_read_b128 v[56:59], v22 offset:55808
    v_mfma_f32_16x16x32_bf16 v[64:67], v[60:63], v[88:91], v[64:67]
    ds_read_b128 v[60:63], v22 offset:56064
    s_waitcnt lgkmcnt(8)
    v_mfma_f32_16x16x32_bf16 v[192:195], v[28:31], v[80:83], v[192:195]
    ds_read_b128 v[28:31], v18 offset:64512
    ds_read_b64_tr_b16 v[88:89], v25 offset:24576
    v_mfma_f32_16x16x32_bf16 v[200:203], v[32:35], v[80:83], v[200:203]
    ds_read_b128 v[32:35], v18 offset:64768
    ds_read_b64_tr_b16 v[90:91], v25 offset:28672
    v_mfma_f32_16x16x32_bf16 v[208:211], v[36:39], v[80:83], v[208:211]
    ds_read_b128 v[36:39], v18 offset:65024
    s_waitcnt lgkmcnt(10)
    v_mfma_f32_16x16x32_bf16 v[216:219], v[40:43], v[80:83], v[216:219]
    ds_read_b128 v[40:43], v18 offset:65280
    v_mfma_f32_16x16x32_bf16 v[224:227], v[44:47], v[80:83], v[224:227]
    ds_read_b128 v[44:47], v19 offset:64512
    v_mfma_f32_16x16x32_bf16 v[232:235], v[48:51], v[80:83], v[232:235]
    ds_read_b128 v[48:51], v22 offset:64512
    ds_read_b64_tr_b16 v[104:105], v24 offset:24576
    s_waitcnt lgkmcnt(9)
    v_mfma_f32_16x16x32_bf16 v[240:243], v[52:55], v[80:83], v[240:243]
    ds_read_b128 v[52:55], v22 offset:64768
    ds_read_b64_tr_b16 v[106:107], v24 offset:28672
    v_mfma_f32_16x16x32_bf16 v[248:251], v[56:59], v[80:83], v[248:251]
    ds_read_b128 v[56:59], v22 offset:65024
    v_mfma_f32_16x16x32_bf16 v[64:67], v[60:63], v[80:83], v[64:67]
    ds_read_b128 v[60:63], v22 offset:65280
    s_waitcnt lgkmcnt(8)
    v_mfma_f32_16x16x32_bf16 v[192:195], v[28:31], v[88:91], v[192:195]
    s_barrier
    ds_read_b128 v[28:31], v18 offset:0
    ds_read_b64_tr_b16 v[80:81], v21 offset:0
    v_mfma_f32_16x16x32_bf16 v[200:203], v[32:35], v[88:91], v[200:203]
    ds_read_b128 v[32:35], v18 offset:256
    ds_read_b64_tr_b16 v[82:83], v21 offset:4096
    v_mfma_f32_16x16x32_bf16 v[208:211], v[36:39], v[88:91], v[208:211]
    ds_read_b128 v[36:39], v18 offset:512
    s_waitcnt lgkmcnt(10)
    v_mfma_f32_16x16x32_bf16 v[216:219], v[40:43], v[88:91], v[216:219]
    ds_read_b128 v[40:43], v18 offset:768
    v_mfma_f32_16x16x32_bf16 v[224:227], v[44:47], v[88:91], v[224:227]
    ds_read_b128 v[44:47], v19 offset:0
    v_mfma_f32_16x16x32_bf16 v[232:235], v[48:51], v[88:91], v[232:235]
    ds_read_b128 v[48:51], v22 offset:0
    ds_read_b64_tr_b16 v[108:109], v20 offset:0
    s_waitcnt lgkmcnt(9)
    v_mfma_f32_16x16x32_bf16 v[240:243], v[52:55], v[88:91], v[240:243]
    ds_read_b128 v[52:55], v22 offset:256
    ds_read_b64_tr_b16 v[110:111], v20 offset:4096
    v_mfma_f32_16x16x32_bf16 v[248:251], v[56:59], v[88:91], v[248:251]
    ds_read_b128 v[56:59], v22 offset:512
    v_mfma_f32_16x16x32_bf16 v[64:67], v[60:63], v[88:91], v[64:67]
    ds_read_b128 v[60:63], v22 offset:768
    s_waitcnt lgkmcnt(8)
    v_mfma_f32_16x16x32_bf16 v[192:195], v[28:31], v[80:83], v[192:195]
    ds_read_b128 v[28:31], v18 offset:9216
    ds_read_b64_tr_b16 v[88:89], v21 offset:8192
    v_mfma_f32_16x16x32_bf16 v[200:203], v[32:35], v[80:83], v[200:203]
    ds_read_b128 v[32:35], v18 offset:9472
    ds_read_b64_tr_b16 v[90:91], v21 offset:12288
    v_mfma_f32_16x16x32_bf16 v[208:211], v[36:39], v[80:83], v[208:211]
    ds_read_b128 v[36:39], v18 offset:9728
    s_waitcnt lgkmcnt(10)
    v_mfma_f32_16x16x32_bf16 v[216:219], v[40:43], v[80:83], v[216:219]
    ds_read_b128 v[40:43], v18 offset:9984
    v_mfma_f32_16x16x32_bf16 v[224:227], v[44:47], v[80:83], v[224:227]
    ds_read_b128 v[44:47], v19 offset:9216
    v_mfma_f32_16x16x32_bf16 v[232:235], v[48:51], v[80:83], v[232:235]
    ds_read_b128 v[48:51], v22 offset:9216
    ds_read_b64_tr_b16 v[112:113], v20 offset:8192
    s_waitcnt lgkmcnt(9)
    v_mfma_f32_16x16x32_bf16 v[240:243], v[52:55], v[80:83], v[240:243]
    ds_read_b128 v[52:55], v22 offset:9472
    ds_read_b64_tr_b16 v[114:115], v20 offset:12288
    v_mfma_f32_16x16x32_bf16 v[248:251], v[56:59], v[80:83], v[248:251]
    ds_read_b128 v[56:59], v22 offset:9728
    v_mfma_f32_16x16x32_bf16 v[64:67], v[60:63], v[80:83], v[64:67]
    ds_read_b128 v[60:63], v22 offset:9984
    s_waitcnt lgkmcnt(8)
    v_mfma_f32_16x16x32_bf16 v[192:195], v[28:31], v[88:91], v[192:195]
    s_barrier
    ds_read_b128 v[28:31], v18 offset:18432
    ds_read_b64_tr_b16 v[80:81], v21 offset:16384
    v_mfma_f32_16x16x32_bf16 v[200:203], v[32:35], v[88:91], v[200:203]
    ds_read_b128 v[32:35], v18 offset:18688
    ds_read_b64_tr_b16 v[82:83], v21 offset:20480
    v_mfma_f32_16x16x32_bf16 v[208:211], v[36:39], v[88:91], v[208:211]
    ds_read_b128 v[36:39], v18 offset:18944
    s_waitcnt lgkmcnt(10)
    v_mfma_f32_16x16x32_bf16 v[216:219], v[40:43], v[88:91], v[216:219]
    ds_read_b128 v[40:43], v18 offset:19200
    v_mfma_f32_16x16x32_bf16 v[224:227], v[44:47], v[88:91], v[224:227]
    ds_read_b128 v[44:47], v19 offset:18432
    v_mfma_f32_16x16x32_bf16 v[232:235], v[48:51], v[88:91], v[232:235]
    ds_read_b128 v[48:51], v22 offset:18432
    ds_read_b64_tr_b16 v[116:117], v20 offset:16384
    s_waitcnt lgkmcnt(9)
    v_mfma_f32_16x16x32_bf16 v[240:243], v[52:55], v[88:91], v[240:243]
    ds_read_b128 v[52:55], v22 offset:18688
    ds_read_b64_tr_b16 v[118:119], v20 offset:20480
    v_mfma_f32_16x16x32_bf16 v[248:251], v[56:59], v[88:91], v[248:251]
    ds_read_b128 v[56:59], v22 offset:18944
    v_mfma_f32_16x16x32_bf16 v[64:67], v[60:63], v[88:91], v[64:67]
    ds_read_b128 v[60:63], v22 offset:19200
    s_waitcnt lgkmcnt(8)
    v_mfma_f32_16x16x32_bf16 v[192:195], v[28:31], v[80:83], v[192:195]
    ds_read_b128 v[28:31], v18 offset:27648
    ds_read_b64_tr_b16 v[88:89], v21 offset:24576
    v_mfma_f32_16x16x32_bf16 v[200:203], v[32:35], v[80:83], v[200:203]
    ds_read_b128 v[32:35], v18 offset:27904
    ds_read_b64_tr_b16 v[90:91], v21 offset:28672
    v_mfma_f32_16x16x32_bf16 v[208:211], v[36:39], v[80:83], v[208:211]
    ds_read_b128 v[36:39], v18 offset:28160
    s_waitcnt lgkmcnt(10)
    v_mfma_f32_16x16x32_bf16 v[216:219], v[40:43], v[80:83], v[216:219]
    ds_read_b128 v[40:43], v18 offset:28416
    v_mfma_f32_16x16x32_bf16 v[224:227], v[44:47], v[80:83], v[224:227]
    ds_read_b128 v[44:47], v19 offset:27648
    v_mfma_f32_16x16x32_bf16 v[232:235], v[48:51], v[80:83], v[232:235]
    ds_read_b128 v[48:51], v22 offset:27648
    ds_read_b64_tr_b16 v[120:121], v20 offset:24576
    s_waitcnt lgkmcnt(9)
    v_mfma_f32_16x16x32_bf16 v[240:243], v[52:55], v[80:83], v[240:243]
    ds_read_b128 v[52:55], v22 offset:27904
    ds_read_b64_tr_b16 v[122:123], v20 offset:28672
    v_mfma_f32_16x16x32_bf16 v[248:251], v[56:59], v[80:83], v[248:251]
    ds_read_b128 v[56:59], v22 offset:28160
    v_mfma_f32_16x16x32_bf16 v[64:67], v[60:63], v[80:83], v[64:67]
    ds_read_b128 v[60:63], v22 offset:28416
    s_waitcnt lgkmcnt(8)
    v_mfma_f32_16x16x32_bf16 v[192:195], v[28:31], v[88:91], v[192:195]
    v_mfma_f32_16x16x32_bf16 v[200:203], v[32:35], v[88:91], v[200:203]
    v_mfma_f32_16x16x32_bf16 v[208:211], v[36:39], v[88:91], v[208:211]
    s_waitcnt lgkmcnt(5)
    v_mfma_f32_16x16x32_bf16 v[216:219], v[40:43], v[88:91], v[216:219]
    v_mfma_f32_16x16x32_bf16 v[224:227], v[44:47], v[88:91], v[224:227]
    v_mfma_f32_16x16x32_bf16 v[232:235], v[48:51], v[88:91], v[232:235]
    s_waitcnt lgkmcnt(0)
    v_mfma_f32_16x16x32_bf16 v[240:243], v[52:55], v[88:91], v[240:243]
    v_mfma_f32_16x16x32_bf16 v[248:251], v[56:59], v[88:91], v[248:251]
    v_mfma_f32_16x16x32_bf16 v[64:67], v[60:63], v[88:91], v[64:67]
    v_mfma_f32_16x16x32_bf16 v[220:223], v[44:47], v[120:123], v[220:223]
    ds_read_b128 v[44:47], v19 offset:36864
    v_mfma_f32_16x16x32_bf16 v[228:231], v[48:51], v[120:123], v[228:231]
    ds_read_b128 v[48:51], v22 offset:36864
    v_mfma_f32_16x16x32_bf16 v[236:239], v[52:55], v[120:123], v[236:239]
    ds_read_b128 v[52:55], v22 offset:37120
    v_mfma_f32_16x16x32_bf16 v[244:247], v[56:59], v[120:123], v[244:247]
    ds_read_b128 v[56:59], v22 offset:37376
    v_mfma_f32_16x16x32_bf16 v[252:255], v[60:63], v[120:123], v[252:255]
    ds_read_b128 v[60:63], v22 offset:37632
    v_mfma_f32_16x16x32_bf16 v[188:191], v[28:31], v[120:123], v[188:191]
    ds_read_b128 v[28:31], v18 offset:36864
    v_mfma_f32_16x16x32_bf16 v[196:199], v[32:35], v[120:123], v[196:199]
    ds_read_b128 v[32:35], v18 offset:37120
    v_mfma_f32_16x16x32_bf16 v[204:207], v[36:39], v[120:123], v[204:207]
    ds_read_b128 v[36:39], v18 offset:37376
    v_mfma_f32_16x16x32_bf16 v[212:215], v[40:43], v[120:123], v[212:215]
    ds_read_b128 v[40:43], v18 offset:37632
    s_waitcnt lgkmcnt(4)
    v_mfma_f32_16x16x32_bf16 v[220:223], v[44:47], v[92:95], v[220:223]
    ds_read_b128 v[44:47], v19 offset:46080
    v_cvt_pk_bf16_f32 v144, v224, v225
    v_cvt_pk_bf16_f32 v156, v226, v227
    v_mfma_f32_16x16x32_bf16 v[228:231], v[48:51], v[92:95], v[228:231]
    ds_read_b128 v[48:51], v22 offset:46080
    v_permlane32_swap_b32 v144, v156
    s_nop 1
    v_mov_b32_dpp v157, v156 quad_perm:[1,1,1,1] row_mask:0xf bank_mask:0xf
    v_mfma_f32_16x16x32_bf16 v[236:239], v[52:55], v[92:95], v[236:239]
    ds_read_b128 v[52:55], v22 offset:46336
    v_mov_b32_dpp v158, v156 quad_perm:[2,2,2,2] row_mask:0xf bank_mask:0xf
    v_mov_b32_dpp v159, v156 quad_perm:[3,3,3,3] row_mask:0xf bank_mask:0xf
    v_mfma_f32_16x16x32_bf16 v[244:247], v[56:59], v[92:95], v[244:247]
    ds_read_b128 v[56:59], v22 offset:46592
    v_cvt_pk_bf16_f32 v148, v232, v233
    v_cvt_pk_bf16_f32 v149, v234, v235
    v_mfma_f32_16x16x32_bf16 v[252:255], v[60:63], v[92:95], v[252:255]
    ds_read_b128 v[60:63], v22 offset:46848
    v_cvt_pk_bf16_f32 v150, v240, v241
    v_cvt_pk_bf16_f32 v151, v242, v243
    s_waitcnt lgkmcnt(0)
    v_mfma_f32_16x16x32_bf16 v[220:223], v[44:47], v[96:99], v[220:223]
    ds_read_b128 v[44:47], v19 offset:55296
    buffer_store_dwordx4 v[148:151], v9, s[36:39], s67 offen offset:0 sc1
    v_cvt_pk_bf16_f32 v152, v248, v249
    v_mfma_f32_16x16x32_bf16 v[228:231], v[48:51], v[96:99], v[228:231]
    ds_read_b128 v[48:51], v22 offset:55296
    v_cvt_pk_bf16_f32 v153, v250, v251
    v_cvt_pk_bf16_f32 v154, v64, v65
    v_mfma_f32_16x16x32_bf16 v[236:239], v[52:55], v[96:99], v[236:239]
    ds_read_b128 v[52:55], v22 offset:55552
    v_cvt_pk_bf16_f32 v155, v66, v67
    buffer_store_dwordx4 v[152:155], v9, s[36:39], s67 offen offset:1024 sc1
    v_mfma_f32_16x16x32_bf16 v[244:247], v[56:59], v[96:99], v[244:247]
    ds_read_b128 v[56:59], v22 offset:55808
    buffer_store_dwordx4 v[156:159], v26, s[36:39], s67 offen offset:2048 sc1
    v_mov_b32_dpp v145, v144 quad_perm:[1,1,1,1] row_mask:0xf bank_mask:0xf
    v_mfma_f32_16x16x32_bf16 v[252:255], v[60:63], v[96:99], v[252:255]
    ds_read_b128 v[60:63], v22 offset:56064
    v_mov_b32_dpp v146, v144 quad_perm:[2,2,2,2] row_mask:0xf bank_mask:0xf
    v_mov_b32_dpp v147, v144 quad_perm:[3,3,3,3] row_mask:0xf bank_mask:0xf
    s_waitcnt lgkmcnt(0)
    v_mfma_f32_16x16x32_bf16 v[220:223], v[44:47], v[100:103], v[220:223]
    ds_read_b128 v[44:47], v19 offset:64512
    v_cvt_pk_bf16_f32 v136, v192, v193
    v_cvt_pk_bf16_f32 v137, v194, v195
    v_mfma_f32_16x16x32_bf16 v[228:231], v[48:51], v[100:103], v[228:231]
    ds_read_b128 v[48:51], v22 offset:64512
    v_cvt_pk_bf16_f32 v138, v200, v201
    v_cvt_pk_bf16_f32 v139, v202, v203
    v_mfma_f32_16x16x32_bf16 v[236:239], v[52:55], v[100:103], v[236:239]
    ds_read_b128 v[52:55], v22 offset:64768
    buffer_store_dwordx4 v[136:139], v9, s[36:39], s66 offen offset:0 sc1
    v_cvt_pk_bf16_f32 v140, v208, v209
    v_mfma_f32_16x16x32_bf16 v[244:247], v[56:59], v[100:103], v[244:247]
    ds_read_b128 v[56:59], v22 offset:65024
    v_cvt_pk_bf16_f32 v141, v210, v211
    v_cvt_pk_bf16_f32 v142, v216, v217
    v_mfma_f32_16x16x32_bf16 v[252:255], v[60:63], v[100:103], v[252:255]
    ds_read_b128 v[60:63], v22 offset:65280
    v_cvt_pk_bf16_f32 v143, v218, v219
    buffer_store_dwordx4 v[140:143], v9, s[36:39], s66 offen offset:1024 sc1
    s_waitcnt lgkmcnt(0)
    v_mfma_f32_16x16x32_bf16 v[220:223], v[44:47], v[104:107], v[220:223]
    ds_read_b128 v[44:47], v19 offset:0
    buffer_store_dwordx4 v[144:147], v26, s[36:39], s66 offen offset:2048 sc1
    v_mfma_f32_16x16x32_bf16 v[228:231], v[48:51], v[104:107], v[228:231]
    ds_read_b128 v[48:51], v22 offset:0
    v_mfma_f32_16x16x32_bf16 v[236:239], v[52:55], v[104:107], v[236:239]
    ds_read_b128 v[52:55], v22 offset:256
    v_mfma_f32_16x16x32_bf16 v[244:247], v[56:59], v[104:107], v[244:247]
    ds_read_b128 v[56:59], v22 offset:512
    v_mfma_f32_16x16x32_bf16 v[252:255], v[60:63], v[104:107], v[252:255]
    ds_read_b128 v[60:63], v22 offset:768
    s_waitcnt lgkmcnt(0)
    v_mfma_f32_16x16x32_bf16 v[220:223], v[44:47], v[108:111], v[220:223]
    ds_read_b128 v[44:47], v19 offset:9216
    v_mfma_f32_16x16x32_bf16 v[228:231], v[48:51], v[108:111], v[228:231]
    ds_read_b128 v[48:51], v22 offset:9216
    v_mfma_f32_16x16x32_bf16 v[236:239], v[52:55], v[108:111], v[236:239]
    ds_read_b128 v[52:55], v22 offset:9472
    v_mfma_f32_16x16x32_bf16 v[244:247], v[56:59], v[108:111], v[244:247]
    ds_read_b128 v[56:59], v22 offset:9728
    v_mfma_f32_16x16x32_bf16 v[252:255], v[60:63], v[108:111], v[252:255]
    ds_read_b128 v[60:63], v22 offset:9984
    s_waitcnt lgkmcnt(0)
    v_mfma_f32_16x16x32_bf16 v[220:223], v[44:47], v[112:115], v[220:223]
    ds_read_b128 v[44:47], v19 offset:18432
    v_mfma_f32_16x16x32_bf16 v[228:231], v[48:51], v[112:115], v[228:231]
    ds_read_b128 v[48:51], v22 offset:18432
    v_mfma_f32_16x16x32_bf16 v[236:239], v[52:55], v[112:115], v[236:239]
    ds_read_b128 v[52:55], v22 offset:18688
    v_mfma_f32_16x16x32_bf16 v[244:247], v[56:59], v[112:115], v[244:247]
    ds_read_b128 v[56:59], v22 offset:18944
    v_mfma_f32_16x16x32_bf16 v[252:255], v[60:63], v[112:115], v[252:255]
    ds_read_b128 v[60:63], v22 offset:19200
    s_waitcnt lgkmcnt(0)
    v_mfma_f32_16x16x32_bf16 v[220:223], v[44:47], v[116:119], v[220:223]
    v_mfma_f32_16x16x32_bf16 v[228:231], v[48:51], v[116:119], v[228:231]
    v_mfma_f32_16x16x32_bf16 v[236:239], v[52:55], v[116:119], v[236:239]
    v_mfma_f32_16x16x32_bf16 v[244:247], v[56:59], v[116:119], v[244:247]
    v_mfma_f32_16x16x32_bf16 v[252:255], v[60:63], v[116:119], v[252:255]
    v_mfma_f32_16x16x32_bf16 v[188:191], v[28:31], v[92:95], v[188:191]
    ds_read_b128 v[28:31], v18 offset:46080
    v_mfma_f32_16x16x32_bf16 v[196:199], v[32:35], v[92:95], v[196:199]
    ds_read_b128 v[32:35], v18 offset:46336
    v_mfma_f32_16x16x32_bf16 v[204:207], v[36:39], v[92:95], v[204:207]
    ds_read_b128 v[36:39], v18 offset:46592
    v_mfma_f32_16x16x32_bf16 v[212:215], v[40:43], v[92:95], v[212:215]
    ds_read_b128 v[40:43], v18 offset:46848
    s_waitcnt lgkmcnt(0)
    v_mfma_f32_16x16x32_bf16 v[188:191], v[28:31], v[96:99], v[188:191]
    ds_read_b128 v[28:31], v18 offset:55296
    v_cvt_pk_bf16_f32 v13, v220, v221
    v_cvt_pk_bf16_f32 v132, v222, v223
    v_mfma_f32_16x16x32_bf16 v[196:199], v[32:35], v[96:99], v[196:199]
    ds_read_b128 v[32:35], v18 offset:55552
    v_permlane32_swap_b32 v13, v132
    s_nop 1
    v_mov_b32_dpp v133, v132 quad_perm:[1,1,1,1] row_mask:0xf bank_mask:0xf
    v_mfma_f32_16x16x32_bf16 v[204:207], v[36:39], v[96:99], v[204:207]
    ds_read_b128 v[36:39], v18 offset:55808
    v_mov_b32_dpp v134, v132 quad_perm:[2,2,2,2] row_mask:0xf bank_mask:0xf
    v_mov_b32_dpp v135, v132 quad_perm:[3,3,3,3] row_mask:0xf bank_mask:0xf
    v_mfma_f32_16x16x32_bf16 v[212:215], v[40:43], v[96:99], v[212:215]
    ds_read_b128 v[40:43], v18 offset:56064
    v_cvt_pk_bf16_f32 v124, v228, v229
    v_cvt_pk_bf16_f32 v125, v230, v231
    s_waitcnt lgkmcnt(0)
    v_mfma_f32_16x16x32_bf16 v[188:191], v[28:31], v[100:103], v[188:191]
    ds_read_b128 v[28:31], v18 offset:64512
    v_cvt_pk_bf16_f32 v126, v236, v237
    v_cvt_pk_bf16_f32 v127, v238, v239
    v_mfma_f32_16x16x32_bf16 v[196:199], v[32:35], v[100:103], v[196:199]
    ds_read_b128 v[32:35], v18 offset:64768
    buffer_store_dwordx4 v[124:127], v9, s[36:39], s65 offen offset:0 sc1
    v_cvt_pk_bf16_f32 v128, v244, v245
    v_mfma_f32_16x16x32_bf16 v[204:207], v[36:39], v[100:103], v[204:207]
    ds_read_b128 v[36:39], v18 offset:65024
    v_cvt_pk_bf16_f32 v129, v246, v247
    v_cvt_pk_bf16_f32 v130, v252, v253
    v_mfma_f32_16x16x32_bf16 v[212:215], v[40:43], v[100:103], v[212:215]
    ds_read_b128 v[40:43], v18 offset:65280
    v_cvt_pk_bf16_f32 v131, v254, v255
    buffer_store_dwordx4 v[128:131], v9, s[36:39], s65 offen offset:1024 sc1
    s_waitcnt lgkmcnt(0)
    v_mfma_f32_16x16x32_bf16 v[188:191], v[28:31], v[104:107], v[188:191]
    ds_read_b128 v[28:31], v18 offset:0
    buffer_store_dwordx4 v[132:135], v26, s[36:39], s65 offen offset:2048 sc1
    v_lshrrev_b32 v10, 2, v1
    v_mfma_f32_16x16x32_bf16 v[196:199], v[32:35], v[104:107], v[196:199]
    ds_read_b128 v[32:35], v18 offset:256
    v_and_b32 v11, 1, v1
    v_lshlrev_b32 v11, 4, v11
    v_mfma_f32_16x16x32_bf16 v[204:207], v[36:39], v[104:107], v[204:207]
    ds_read_b128 v[36:39], v18 offset:512
    v_mov_b32 v12, 0x3f80
    v_lshlrev_b32 v11, v11, v12
    v_mfma_f32_16x16x32_bf16 v[212:215], v[40:43], v[104:107], v[212:215]
    ds_read_b128 v[40:43], v18 offset:768
    v_and_b32 v12, 2, v1
    v_add_u32 v13, v10, v12
    s_waitcnt lgkmcnt(0)
    v_mfma_f32_16x16x32_bf16 v[188:191], v[28:31], v[108:111], v[188:191]
    ds_read_b128 v[28:31], v18 offset:9216
    v_cmp_eq_u32 vcc, v10, v2
    s_nop 1
    v_cndmask_b32 v80, 0, v11, vcc
    v_mfma_f32_16x16x32_bf16 v[196:199], v[32:35], v[108:111], v[196:199]
    ds_read_b128 v[32:35], v18 offset:9472
    v_cmp_eq_u32 vcc, v13, v2
    s_nop 1
    v_cndmask_b32 v76, 0, v11, vcc
    v_mfma_f32_16x16x32_bf16 v[204:207], v[36:39], v[108:111], v[204:207]
    ds_read_b128 v[36:39], v18 offset:9728
    v_cmp_gt_u32 vcc, 8, v1
    s_nop 1
    v_cndmask_b32 v76, 0, v76, vcc
    v_mfma_f32_16x16x32_bf16 v[212:215], v[40:43], v[108:111], v[212:215]
    ds_read_b128 v[40:43], v18 offset:9984
    v_cmp_eq_u32 vcc, 0, v12
    s_nop 1
    v_cndmask_b32 v81, v80, 0, vcc
    s_waitcnt lgkmcnt(0)
    v_mfma_f32_16x16x32_bf16 v[188:191], v[28:31], v[112:115], v[188:191]
    ds_read_b128 v[28:31], v18 offset:18432
    v_cndmask_b32 v80, 0, v80, vcc
    v_mov_b32 v77, v76
    v_mfma_f32_16x16x32_bf16 v[196:199], v[32:35], v[112:115], v[196:199]
    ds_read_b128 v[32:35], v18 offset:18688
    v_mov_b64 v[78:79], 0
    v_mov_b64 v[82:83], 0
    s_nop 0
    v_mfma_f32_16x16x32_bf16 v[204:207], v[36:39], v[112:115], v[204:207]
    ds_read_b128 v[36:39], v18 offset:18944
    v_mfma_f32_16x16x32_bf16 v[212:215], v[40:43], v[112:115], v[212:215]
    ds_read_b128 v[40:43], v18 offset:19200
    s_waitcnt lgkmcnt(0)
    v_mfma_f32_16x16x32_bf16 v[188:191], v[28:31], v[116:119], v[188:191]
    v_mfma_f32_16x16x32_bf16 v[196:199], v[32:35], v[116:119], v[196:199]
    v_mfma_f32_16x16x32_bf16 v[204:207], v[36:39], v[116:119], v[204:207]
    v_mfma_f32_16x16x32_bf16 v[212:215], v[40:43], v[116:119], v[212:215]
    s_barrier
    ds_read_b64 v[28:29], v4 offset:0
    ds_read_b128 v[160:163], v6 offset:0
    ds_read_b64 v[30:31], v4 offset:32
    ds_read_b128 v[164:167], v6 offset:64
    ds_read_b64 v[32:33], v4 offset:64
    ds_read_b128 v[168:171], v6 offset:128
    ds_read_b64 v[34:35], v4 offset:96
    ds_read_b128 v[172:175], v6 offset:192
    ds_read_b64 v[36:37], v5
    ds_read_b128 v[176:179], v23
    s_mul_i32 s49, s3, 4608
    s_add_u32 s49, s49, 49152
    v_add_u32 v73, s49, v27
    s_waitcnt lgkmcnt(9)
    v_lshlrev_b32 v44, 16, v28
    v_and_b32 v45, 0xffff0000, v28
    v_lshlrev_b32 v46, 16, v29
    v_and_b32 v47, 0xffff0000, v29
    s_waitcnt lgkmcnt(7)
    s_branch L_skip_10
L_stub_10:
    s_branch L_back_c3
L_skip_10:
    v_lshlrev_b32 v48, 16, v30
    v_and_b32 v49, 0xffff0000, v30
    v_lshlrev_b32 v50, 16, v31
    v_and_b32 v51, 0xffff0000, v31
    s_waitcnt lgkmcnt(5)
    v_lshlrev_b32 v52, 16, v32
    v_and_b32 v53, 0xffff0000, v32
    v_lshlrev_b32 v54, 16, v33
    v_and_b32 v55, 0xffff0000, v33
    s_waitcnt lgkmcnt(3)
    v_lshlrev_b32 v56, 16, v34
    v_and_b32 v57, 0xffff0000, v34
    v_lshlrev_b32 v58, 16, v35
    v_and_b32 v59, 0xffff0000, v35
    s_waitcnt lgkmcnt(1)
    v_lshlrev_b32 v60, 16, v36
    v_and_b32 v61, 0xffff0000, v36
    v_lshlrev_b32 v62, 16, v37
    v_and_b32 v63, 0xffff0000, v37
    s_waitcnt vmcnt(0)
    v_mov_b32 v133, 0
    v_mov_b64 v[134:135], 0
    v_mov_b64 v[146:147], 0
    buffer_load_dwordx4 v[124:127], v9, s[36:39], s64 offen offset:0 sc1
    buffer_load_dwordx4 v[128:131], v9, s[36:39], s64 offen offset:1024 sc1
    buffer_load_dword v132, v27, s[36:39], s64 offen offset:2048 sc1
    s_barrier
    ds_read_b128 v[136:139], v71 offset:0
    ds_read_b128 v[140:143], v71 offset:1024
    ds_read_b128 v[148:151], v71 offset:2304
    ds_read_b128 v[152:155], v71 offset:3328
    ds_read_b32 v144, v73 offset:2048
    ds_read_b32 v145, v73 offset:4352
    s_waitcnt lgkmcnt(5)
    v_mfma_f32_16x16x32_bf16 v[188:191], v[80:83], v[136:139], v[188:191]
    v_mfma_f32_16x16x32_bf16 v[196:199], v[78:81], v[136:139], v[196:199]
    s_waitcnt lgkmcnt(4)
    v_mfma_f32_16x16x32_bf16 v[204:207], v[80:83], v[140:143], v[204:207]
    v_mfma_f32_16x16x32_bf16 v[212:215], v[78:81], v[140:143], v[212:215]
    s_waitcnt lgkmcnt(3)
    v_mfma_f32_16x16x32_bf16 v[188:191], v[80:83], v[148:151], v[188:191]
    v_mfma_f32_16x16x32_bf16 v[196:199], v[78:81], v[148:151], v[196:199]
    s_waitcnt lgkmcnt(2)
    v_mfma_f32_16x16x32_bf16 v[204:207], v[80:83], v[152:155], v[204:207]
    v_mfma_f32_16x16x32_bf16 v[212:215], v[78:81], v[152:155], v[212:215]
    s_waitcnt lgkmcnt(0)
    v_mfma_f32_16x16x32_bf16 v[220:223], v[76:79], v[144:147], v[220:223]
    s_waitcnt vmcnt(0)
    v_max3_u32 v10, v124, v128, v132
    v_cmp_eq_u32 vcc, -1, v10
    s_nop 0
    s_cbranch_vccz L_m_27
Lp_m_28:
    buffer_load_dwordx4 v[124:127], v9, s[36:39], s64 offen offset:0 sc1
    buffer_load_dwordx4 v[128:131], v9, s[36:39], s64 offen offset:1024 sc1
    buffer_load_dword v132, v27, s[36:39], s64 offen offset:2048 sc1
    s_waitcnt vmcnt(0)
    v_max3_u32 v10, v124, v128, v132
    v_cmp_eq_u32 vcc, -1, v10
    s_nop 0
    s_cbranch_vccz Le_m_29
    s_sub_u32 s7, s7, 1
    s_cbranch_scc1 Le_m_29
    s_mov_b64 exec, vcc
    s_sleep 1
    s_branch Lp_m_28
Le_m_29:
    s_mov_b64 exec, -1
    s_max_i32 s7, s7, 0
L_m_27:
    v_mfma_f32_16x16x32_bf16 v[188:191], v[80:83], v[124:127], v[188:191]
    v_mfma_f32_16x16x32_bf16 v[196:199], v[78:81], v[124:127], v[196:199]
    v_mfma_f32_16x16x32_bf16 v[204:207], v[80:83], v[128:131], v[204:207]
    v_mfma_f32_16x16x32_bf16 v[212:215], v[78:81], v[128:131], v[212:215]
    v_mfma_f32_16x16x32_bf16 v[220:223], v[76:79], v[132:135], v[220:223]
    s_nop 3
    v_pk_fma_f32 v[44:45], v[188:189], v[160:161], v[44:45]
    v_pk_fma_f32 v[46:47], v[190:191], v[162:163], v[46:47]
    v_cvt_pk_bf16_f32 v28, v44, v45
    v_cvt_pk_bf16_f32 v29, v46, v47
    ds_write_b64 v4, v[28:29] offset:0
    v_pk_fma_f32 v[48:49], v[196:197], v[164:165], v[48:49]
    v_pk_fma_f32 v[50:51], v[198:199], v[166:167], v[50:51]
    v_cvt_pk_bf16_f32 v30, v48, v49
    v_cvt_pk_bf16_f32 v31, v50, v51
    ds_write_b64 v4, v[30:31] offset:32
    v_pk_fma_f32 v[52:53], v[204:205], v[168:169], v[52:53]
    v_pk_fma_f32 v[54:55], v[206:207], v[170:171], v[54:55]
    v_cvt_pk_bf16_f32 v32, v52, v53
    v_cvt_pk_bf16_f32 v33, v54, v55
    ds_write_b64 v4, v[32:33] offset:64
    v_pk_fma_f32 v[56:57], v[212:213], v[172:173], v[56:57]
    v_pk_fma_f32 v[58:59], v[214:215], v[174:175], v[58:59]
    v_cvt_pk_bf16_f32 v34, v56, v57
    v_cvt_pk_bf16_f32 v35, v58, v59
    ds_write_b64 v4, v[34:35] offset:96
    v_pk_fma_f32 v[60:61], v[220:221], v[176:177], v[60:61]
    v_pk_fma_f32 v[62:63], v[222:223], v[178:179], v[62:63]
    v_cvt_pk_bf16_f32 v36, v60, v61
    v_cvt_pk_bf16_f32 v37, v62, v63
    ds_write_b64 v5, v[36:37]
    ds_read_b128 v[160:163], v7 offset:0
    ds_read_b128 v[164:167], v7 offset:1024
    ds_read_b128 v[168:171], v7 offset:2048
    s_waitcnt lgkmcnt(2)
    buffer_store_dwordx4 v[160:163], v68, s[44:47], s62 offen sc1
    s_waitcnt lgkmcnt(1)
    buffer_store_dwordx4 v[164:167], v69, s[44:47], s62 offen sc1
    s_waitcnt lgkmcnt(0)
    buffer_store_dwordx4 v[168:171], v70, s[44:47], s62 offen sc1
    s_branch L_end
L_m_30:
    s_sub_u32 s61, s63, 54
    s_lshr_b32 s62, s61, 1
    s_add_u32 s62, s62, 18
    s_and_b32 s61, s61, 1
    s_cmp_ge_u32 s5, 16
    s_cbranch_scc1 L_m_35
    s_lshl_b32 s67, s4, 4
    s_add_u32 s67, s67, s5
    s_and_b32 s67, s67, 127
    s_lshl_b32 s48, s3, 9
    s_add_u32 s48, s48, s67
    s_mul_i32 s69, s3, 6144
    s_add_u32 s69, s69, 36864
    s_cmp_eq_u32 s67, 0
    s_cselect_b32 s68, 38, 0
    s_add_u32 s68, s68, 152
    v_mov_b32 v8, 2146435072
    v_add_u32 v4, 0, v0
    v_mul_u32_u24 v5, 1725, v4
    v_lshrrev_b32 v5, 16, v5
    v_mul_u32_u24 v6, 38, v5
    v_sub_u32 v6, v4, v6
    v_cmp_gt_u32 vcc, s68, v4
    v_lshl_add_u32 v5, v5, 7, s48
    v_and_b32 v5, 2047, v5
    v_mul_u32_u24 v5, 578, v5
    v_and_b32 v5, 0xfffffff0, v5
    v_lshl_add_u32 v5, v6, 4, v5
    v_cndmask_b32 v20, v8, v5, vcc
    v_add_u32 v4, 64, v0
    v_mul_u32_u24 v5, 1725, v4
    v_lshrrev_b32 v5, 16, v5
    v_mul_u32_u24 v6, 38, v5
    v_sub_u32 v6, v4, v6
    v_cmp_gt_u32 vcc, s68, v4
    v_lshl_add_u32 v5, v5, 7, s48
    v_and_b32 v5, 2047, v5
    v_mul_u32_u24 v5, 578, v5
    v_and_b32 v5, 0xfffffff0, v5
    v_lshl_add_u32 v5, v6, 4, v5
    v_cndmask_b32 v21, v8, v5, vcc
    v_add_u32 v4, 128, v0
    v_mul_u32_u24 v5, 1725, v4
    v_lshrrev_b32 v5, 16, v5
    v_mul_u32_u24 v6, 38, v5
    v_sub_u32 v6, v4, v6
    v_cmp_gt_u32 vcc, s68, v4
    v_lshl_add_u32 v5, v5, 7, s48
    v_and_b32 v5, 2047, v5
    v_mul_u32_u24 v5, 578, v5
    v_and_b32 v5, 0xfffffff0, v5
    v_lshl_add_u32 v5, v6, 4, v5
    v_cndmask_b32 v22, v8, v5, vcc
    s_waitcnt lgkmcnt(0)
    s_mov_b32 s36, s32
    s_mov_b32 s37, s33
    s_mov_b32 s38, 50331648
    s_mov_b32 s39, 0x20000
    s_mov_b32 s40, s26
    s_mov_b32 s41, s27
    s_mov_b32 s42, 3981312
    s_mov_b32 s43, 0x20000
    v_mov_b32 v4, 32768
    buffer_load_dword v3, v4, s[36:39], 0 offen sc1
    s_lshr_b32 s51, s5, 2
    s_lshl_b32 s51, s51, 3
    s_add_u32 s51, s51, s4
    s_and_b32 s60, s5, 3
    s_lshl_b32 s35, s51, 2
    s_add_u32 s35, s35, s60
    s_lshl_b32 s35, s35, 14
    s_bfe_u32 s48, s6, 0x20002
    s_lshl_b32 s48, s48, 6
    s_lshr_b32 s49, s6, 4
    s_lshl_b32 s49, s49, 2
    s_add_u32 s48, s48, s49
    s_and_b32 s49, s6, 3
    s_add_u32 s48, s48, s49
    s_lshl_b32 s48, s48, 4
    s_lshl_b32 s49, s3, 16
    s_add_u32 s48, s48, s49
    s_add_u32 s48, s48, 15728640
    v_mov_b32 v17, 2146435072
    v_writelane_b32 v17, s48, 0
    s_add_u32 s48, s48, 16384
    s_add_u32 s48, s2, 160
    s_lshl_b32 s48, s48, 7
    s_add_u32 s48, s48, 557056
    s_lshl_b32 s49, s3, 8
    s_add_u32 s49, s49, s5
    s_cmp_lt_u32 s49, 12
    s_cselect_b32 s48, s48, 2146435072
    v_mov_b32 v19, 2146435072
    v_writelane_b32 v19, s48, 0
    s_or_b32 s48, s2, s3
    s_cmp_eq_u32 s48, 0
    s_cselect_b32 s48, 0, 2146435072
    s_add_u32 s48, s48, 32768
    v_writelane_b32 v19, s48, 1
    buffer_load_dword v220, v17, s[36:39], 0 offen
    buffer_load_dword v221, v19, s[36:39], 0 offen
    v_cvt_f32_u32 v218, v2
    v_mul_f32 v218, 4.0, v218
    v_cvt_f32_u32 v219, v1
    v_cvt_f32_u32 v13, s4
    v_mul_f32 v10, 0x3d800000, v219
    v_fmac_f32 v10, 0x3c000000, v13
    v_mul_f32 v11, v218, v10
    v_cos_f32 v5, v11
    v_sin_f32 v6, v11
    s_nop 0
    v_cvt_pk_bf16_f32 v52, v5, v6
    v_cvt_pk_bf16_f32 v56, -v6, v5
    v_fma_f32 v7, v10, 1.0, v11
    v_cos_f32 v8, v7
    v_sin_f32 v9, v7
    s_nop 0
    v_cvt_pk_bf16_f32 v53, v8, v9
    v_cvt_pk_bf16_f32 v57, -v9, v8
    v_fma_f32 v4, v10, 2.0, v11
    v_cos_f32 v5, v4
    v_sin_f32 v6, v4
    s_nop 0
    v_cvt_pk_bf16_f32 v54, v5, v6
    v_cvt_pk_bf16_f32 v58, -v6, v5
    v_add_f32 v7, v4, v10
    v_cos_f32 v8, v7
    v_sin_f32 v9, v7
    s_nop 0
    v_cvt_pk_bf16_f32 v55, v8, v9
    v_cvt_pk_bf16_f32 v59, -v9, v8
    s_lshl_b32 s48, s3, 5
    s_add_u32 s48, s48, s4
    v_cvt_f32_u32 v14, s48
    v_mul_f32 v14, 0x3a000000, v14
    v_mul_f32 v10, 0x3d800000, v219
    v_add_f32 v10, v10, v14
    v_mul_f32 v11, v218, v10
    v_cos_f32 v5, v11
    v_sin_f32 v6, v11
    s_nop 0
    v_cvt_pk_bf16_f32 v68, v5, v6
    v_cvt_pk_bf16_f32 v72, -v6, v5
    v_fma_f32 v7, v10, 1.0, v11
    v_cos_f32 v8, v7
    v_sin_f32 v9, v7
    s_nop 0
    v_cvt_pk_bf16_f32 v69, v8, v9
    v_cvt_pk_bf16_f32 v73, -v9, v8
    v_fma_f32 v4, v10, 2.0, v11
    v_cos_f32 v5, v4
    v_sin_f32 v6, v4
    s_nop 0
    v_cvt_pk_bf16_f32 v70, v5, v6
    v_cvt_pk_bf16_f32 v74, -v6, v5
    v_add_f32 v7, v4, v10
    v_cos_f32 v8, v7
    v_sin_f32 v9, v7
    s_nop 0
    v_cvt_pk_bf16_f32 v71, v8, v9
    v_cvt_pk_bf16_f32 v75, -v9, v8
    v_add_f32 v10, 0x3b800000, v10
    v_mul_f32 v11, v218, v10
    v_cos_f32 v5, v11
    v_sin_f32 v6, v11
    s_nop 0
    v_cvt_pk_bf16_f32 v76, v5, v6
    v_cvt_pk_bf16_f32 v80, -v6, v5
    v_fma_f32 v7, v10, 1.0, v11
    v_cos_f32 v8, v7
    v_sin_f32 v9, v7
    s_nop 0
    v_cvt_pk_bf16_f32 v77, v8, v9
    v_cvt_pk_bf16_f32 v81, -v9, v8
    v_fma_f32 v4, v10, 2.0, v11
    v_cos_f32 v5, v4
    v_sin_f32 v6, v4
    s_nop 0
    v_cvt_pk_bf16_f32 v78, v5, v6
    v_cvt_pk_bf16_f32 v82, -v6, v5
    v_add_f32 v7, v4, v10
    v_cos_f32 v8, v7
    v_sin_f32 v9, v7
    s_nop 0
    v_cvt_pk_bf16_f32 v79, v8, v9
    v_cvt_pk_bf16_f32 v83, -v9, v8
    v_add_f32 v10, 0x3b800000, v10
    v_mul_f32 v11, v218, v10
    v_cos_f32 v5, v11
    v_sin_f32 v6, v11
    s_nop 0
    v_cvt_pk_bf16_f32 v84, v5, v6
    v_cvt_pk_bf16_f32 v88, -v6, v5
    v_fma_f32 v7, v10, 1.0, v11
    v_cos_f32 v8, v7
    v_sin_f32 v9, v7
    s_nop 0
    v_cvt_pk_bf16_f32 v85, v8, v9
    v_cvt_pk_bf16_f32 v89, -v9, v8
    v_fma_f32 v4, v10, 2.0, v11
    v_cos_f32 v5, v4
    v_sin_f32 v6, v4
    s_nop 0
    v_cvt_pk_bf16_f32 v86, v5, v6
    v_cvt_pk_bf16_f32 v90, -v6, v5
    v_add_f32 v7, v4, v10
    v_cos_f32 v8, v7
    v_sin_f32 v9, v7
    s_nop 0
    v_cvt_pk_bf16_f32 v87, v8, v9
    v_cvt_pk_bf16_f32 v91, -v9, v8
    v_add_f32 v10, 0x3b800000, v10
    v_mul_f32 v11, v218, v10
    v_cos_f32 v5, v11
    v_sin_f32 v6, v11
    s_nop 0
    v_cvt_pk_bf16_f32 v92, v5, v6
    v_cvt_pk_bf16_f32 v96, -v6, v5
    v_fma_f32 v7, v10, 1.0, v11
    v_cos_f32 v8, v7
    v_sin_f32 v9, v7
    s_nop 0
    v_cvt_pk_bf16_f32 v93, v8, v9
    v_cvt_pk_bf16_f32 v97, -v9, v8
    v_fma_f32 v4, v10, 2.0, v11
    v_cos_f32 v5, v4
    v_sin_f32 v6, v4
    s_nop 0
    v_cvt_pk_bf16_f32 v94, v5, v6
    v_cvt_pk_bf16_f32 v98, -v6, v5
    v_add_f32 v7, v4, v10
    v_cos_f32 v8, v7
    v_sin_f32 v9, v7
    s_nop 0
    v_cvt_pk_bf16_f32 v95, v8, v9
    v_cvt_pk_bf16_f32 v99, -v9, v8
    s_barrier
    s_mov_b32 s52, s10
    s_mov_b32 s53, s11
    s_mov_b32 s54, 1183744
    s_mov_b32 s55, 0x20000
    s_mov_b32 s56, s12
    s_mov_b32 s57, s13
    s_mov_b32 s58, 1183744
    s_mov_b32 s59, 0x20000
    s_add_u32 m0, s69, 0
    s_nop 0
    buffer_load_dwordx4 v20, s[52:55], 0 offen lds
    s_add_u32 m0, s69, 1024
    s_nop 0
    buffer_load_dwordx4 v21, s[52:55], 0 offen lds
    s_add_u32 m0, s69, 2048
    s_nop 0
    buffer_load_dwordx4 v22, s[52:55], 0 offen lds
    s_add_u32 m0, s69, 3072
    s_nop 0
    buffer_load_dwordx4 v20, s[56:59], 0 offen lds
    s_add_u32 m0, s69, 4096
    s_nop 0
    buffer_load_dwordx4 v21, s[56:59], 0 offen lds
    s_add_u32 m0, s69, 5120
    s_nop 0
    buffer_load_dwordx4 v22, s[56:59], 0 offen lds
    s_lshl_b32 s48, s67, 1
    s_and_b32 s48, s48, 15
    s_add_u32 s48, s48, s69
    v_and_b32 v4, 1, v2
    v_lshrrev_b32 v5, 1, v2
    v_mul_u32_u24 v6, 144, v4
    v_mad_u32_u24 v6, v1, 9, v6
    v_add_lshl_u32 v6, v6, v5, 1
    v_add_u32 v20, s48, v6
    s_cmp_eq_u32 s67, 0
    s_cselect_b32 s49, 608, 0
    s_add_u32 s48, s48, s49
    s_add_u32 s48, s48, 568
    v_sub_u32 v21, s48, v6
    v_lshl_add_u32 v4, v5, 5, v4
    v_lshlrev_b32 v4, 14, v4
    v_lshl_add_u32 v23, v1, 4, v4
    v_add_u32 v24, 1048576, v23
    v_add_u32 v25, 2097152, v23
    v_cmp_gt_u32 vcc, 32, v0
    v_mov_b32 v8, 2146435072
    s_nop 0
    v_cndmask_b32 v25, v8, v25, vcc
    s_lshl_b32 s48, s67, 2
    s_add_u32 s48, s48, s3
    s_lshl_b32 s48, s48, 4
    s_add_u32 s48, s48, 262144
    v_writelane_b32 v18, s48, 0
    buffer_load_dword v222, v18, s[36:39], 0 offen
    s_mov_b32 s48, s67
    s_mov_b32 s49, s3
    s_and_b32 s50, s48, 7
    s_lshr_b32 s48, s48, 3
    s_lshl_b32 s58, s50, 16
    s_lshl_b32 s59, s48, 10
    s_add_u32 s58, s58, s59
    s_lshl_b32 s59, s49, 8
    s_add_u32 s58, s58, s59
    s_add_u32 s56, s58, 1048576
    s_sub_u32 s48, 128, s67
    s_and_b32 s48, s48, 127
    s_sub_u32 s49, 3, s3
    s_and_b32 s50, s48, 7
    s_lshr_b32 s48, s48, 3
    s_lshl_b32 s58, s50, 16
    s_lshl_b32 s59, s48, 10
    s_add_u32 s58, s58, s59
    s_lshl_b32 s59, s49, 8
    s_add_u32 s58, s58, s59
    s_add_u32 s57, s58, 1081344
    s_waitcnt vmcnt(0)
    s_mov_b32 s48, 0x9e3779b1
    v_mul_lo_u32 v3, v3, s48
    v_add_u32 v3, 0x7f4a7c15, v3
    v_or_b32 v3, 0x01010101, v3
    ds_read_u16 v132, v20 offset:0
    ds_read_u16 v136, v20 offset:3072
    ds_read_u16 v133, v20 offset:608
    ds_read_u16 v137, v20 offset:3680
    ds_read_u16 v134, v20 offset:1216
    ds_read_u16 v138, v20 offset:4288
    ds_read_u16 v135, v20 offset:1824
    ds_read_u16 v139, v20 offset:4896
    ds_read_u16 v140, v20 offset:4
    ds_read_u16 v144, v20 offset:3076
    ds_read_u16 v141, v20 offset:612
    ds_read_u16 v145, v20 offset:3684
    ds_read_u16 v142, v20 offset:1220
    ds_read_u16 v146, v20 offset:4292
    ds_read_u16 v143, v20 offset:1828
    ds_read_u16 v147, v20 offset:4900
    ds_read_u16 v148, v20 offset:8
    ds_read_u16 v152, v20 offset:3080
    ds_read_u16 v149, v20 offset:616
    ds_read_u16 v153, v20 offset:3688
    ds_read_u16 v150, v20 offset:1224
    ds_read_u16 v154, v20 offset:4296
    ds_read_u16 v151, v20 offset:1832
    ds_read_u16 v155, v20 offset:4904
    ds_read_u16 v156, v21 offset:1832
    ds_read_u16 v160, v21 offset:4904
    ds_read_u16 v157, v21 offset:1224
    ds_read_u16 v161, v21 offset:4296
    ds_read_u16 v158, v21 offset:616
    ds_read_u16 v162, v21 offset:3688
    ds_read_u16 v159, v21 offset:8
    ds_read_u16 v163, v21 offset:3080
    ds_read_u16 v164, v21 offset:1828
    ds_read_u16 v168, v21 offset:4900
    ds_read_u16 v165, v21 offset:1220
    ds_read_u16 v169, v21 offset:4292
    ds_read_u16 v166, v21 offset:612
    ds_read_u16 v170, v21 offset:3684
    ds_read_u16 v167, v21 offset:4
    ds_read_u16 v171, v21 offset:3076
    ds_read_u16 v172, v21 offset:1824
    ds_read_u16 v176, v21 offset:4896
    ds_read_u16 v173, v21 offset:1216
    ds_read_u16 v177, v21 offset:4288
    ds_read_u16 v174, v21 offset:608
    ds_read_u16 v178, v21 offset:3680
    ds_read_u16 v175, v21 offset:0
    ds_read_u16 v179, v21 offset:3072
    s_waitcnt lgkmcnt(14)
    v_lshl_or_b32 v132, v136, 16, v132
    v_lshl_or_b32 v133, v137, 16, v133
    v_lshl_or_b32 v134, v138, 16, v134
    v_lshl_or_b32 v135, v139, 16, v135
    buffer_store_dwordx4 v[132:135], v23, s[36:39], s56 offen sc1
    v_lshl_or_b32 v140, v144, 16, v140
    v_lshl_or_b32 v141, v145, 16, v141
    v_lshl_or_b32 v142, v146, 16, v142
    v_lshl_or_b32 v143, v147, 16, v143
    buffer_store_dwordx4 v[140:143], v24, s[36:39], s56 offen sc1
    v_lshl_or_b32 v148, v152, 16, v148
    v_lshl_or_b32 v149, v153, 16, v149
    v_lshl_or_b32 v150, v154, 16, v150
    v_lshl_or_b32 v151, v155, 16, v151
    buffer_store_dwordx4 v[148:151], v25, s[36:39], s56 offen sc1
    v_lshl_or_b32 v156, v160, 16, v156
    v_lshl_or_b32 v157, v161, 16, v157
    v_lshl_or_b32 v158, v162, 16, v158
    v_lshl_or_b32 v159, v163, 16, v159
    v_xor_b32 v156, 0x80000000, v156
    v_xor_b32 v157, 0x80000000, v157
    v_xor_b32 v158, 0x80000000, v158
    v_xor_b32 v159, 0x80000000, v159
    buffer_store_dwordx4 v[156:159], v23, s[36:39], s57 offen sc1
    v_lshl_or_b32 v164, v168, 16, v164
    s_waitcnt lgkmcnt(12)
    v_lshl_or_b32 v165, v169, 16, v165
    s_waitcnt lgkmcnt(10)
    v_lshl_or_b32 v166, v170, 16, v166
    s_waitcnt lgkmcnt(8)
    v_lshl_or_b32 v167, v171, 16, v167
    v_xor_b32 v164, 0x80000000, v164
    v_xor_b32 v165, 0x80000000, v165
    v_xor_b32 v166, 0x80000000, v166
    v_xor_b32 v167, 0x80000000, v167
    buffer_store_dwordx4 v[164:167], v24, s[36:39], s57 offen sc1
    s_waitcnt lgkmcnt(6)
    v_lshl_or_b32 v172, v176, 16, v172
    s_waitcnt lgkmcnt(4)
    v_lshl_or_b32 v173, v177, 16, v173
    s_waitcnt lgkmcnt(2)
    v_lshl_or_b32 v174, v178, 16, v174
    s_waitcnt lgkmcnt(0)
    v_lshl_or_b32 v175, v179, 16, v175
    v_xor_b32 v172, 0x80000000, v172
    v_xor_b32 v173, 0x80000000, v173
    v_xor_b32 v174, 0x80000000, v174
    v_xor_b32 v175, 0x80000000, v175
    buffer_store_dwordx4 v[172:175], v25, s[36:39], s57 offen sc1
    s_branch L_m_34
L_m_35:
    v_lshrrev_b32 v4, 3, v0
    v_and_b32 v5, 7, v0
    v_and_b32 v6, 6, v4
    v_xor_b32 v5, v5, v6
    v_mul_u32_u24 v4, 6912, v4
    v_lshl_add_u32 v12, v5, 4, v4
    s_lshl_b32 s48, s61, 2
    s_add_u32 s48, s48, s3
    s_mul_i32 s48, s48, 497664
    s_lshl_b32 s49, s62, 7
    s_add_u32 s47, s48, s49
    s_lshl_b32 s50, s3, 8
    v_lshl_add_u32 v27, v0, 2, s50
    s_mul_i32 s49, s61, 576
    v_add_u32 v9, s49, v27
    v_add_u32 v12, s47, v12
    v_lshrrev_b32 v4, 2, v0
    v_bfe_u32 v5, v4, 1, 2
    v_xor_b32 v5, s3, v5
    v_lshlrev_b32 v5, 5, v5
    v_lshlrev_b32 v4, 7, v4
    v_and_b32 v6, 3, v0
    v_lshlrev_b32 v6, 3, v6
    v_add3_u32 v28, v4, v5, v6
    v_lshlrev_b32 v29, 3, v2
    v_add_u32 v29, 90112, v29
    s_mul_i32 s49, s61, 9216
    s_lshl_b32 s50, s62, 8
    s_add_u32 s49, s49, s50
    s_lshl_b32 s50, s3, 6
    s_add_u32 s49, s49, s50
    s_add_u32 s49, s49, 192000
    v_lshl_add_u32 v4, v1, 2, s49
    v_cmp_gt_u32 vcc, 16, v0
    v_mov_b32 v5, 2146435072
    s_nop 0
    v_cndmask_b32 v30, v5, v4, vcc
    s_waitcnt lgkmcnt(0)
    s_mov_b32 s36, s32
    s_mov_b32 s37, s33
    s_mov_b32 s38, 50331648
    s_mov_b32 s39, 0x20000
    s_mov_b32 s40, s26
    s_mov_b32 s41, s27
    s_mov_b32 s42, 3981312
    s_mov_b32 s43, 0x20000
    v_mov_b32 v4, 32768
    buffer_load_dword v3, v4, s[36:39], 0 offen sc1
    s_mov_b32 s44, s24
    s_mov_b32 s45, s25
    s_mov_b32 s46, 1152
    s_mov_b32 s47, 0x20000
    buffer_load_dword v26, v9, s[44:47], 0 offen
    s_lshr_b32 s51, s5, 2
    s_lshl_b32 s51, s51, 3
    s_add_u32 s51, s51, s4
    s_and_b32 s60, s5, 3
    s_lshl_b32 s35, s51, 2
    s_add_u32 s35, s35, s60
    s_lshl_b32 s35, s35, 14
    s_bfe_u32 s48, s6, 0x20002
    s_lshl_b32 s48, s48, 6
    s_lshr_b32 s49, s6, 4
    s_lshl_b32 s49, s49, 2
    s_add_u32 s48, s48, s49
    s_and_b32 s49, s6, 3
    s_add_u32 s48, s48, s49
    s_lshl_b32 s48, s48, 4
    s_lshl_b32 s49, s3, 16
    s_add_u32 s48, s48, s49
    s_add_u32 s48, s48, 15728640
    v_mov_b32 v17, 2146435072
    v_writelane_b32 v17, s48, 0
    s_add_u32 s48, s48, 16384
    s_add_u32 s48, s2, 160
    s_lshl_b32 s48, s48, 7
    s_add_u32 s48, s48, 557056
    s_lshl_b32 s49, s3, 8
    s_add_u32 s49, s49, s5
    s_cmp_lt_u32 s49, 12
    s_cselect_b32 s48, s48, 2146435072
    v_mov_b32 v19, 2146435072
    v_writelane_b32 v19, s48, 0
    s_or_b32 s48, s2, s3
    s_cmp_eq_u32 s48, 0
    s_cselect_b32 s48, 0, 2146435072
    s_add_u32 s48, s48, 32768
    v_writelane_b32 v19, s48, 1
    buffer_load_dword v220, v17, s[36:39], 0 offen
    buffer_load_dword v221, v19, s[36:39], 0 offen
    buffer_load_dword v222, v30, s[36:39], 0 offen
    s_cmp_ge_u32 s63, 126
    s_cbranch_scc1 L_m_37
    s_mul_i32 m0, s3, 9216
    s_mov_b32 s59, 0
    buffer_load_dwordx4 v12, s[40:43], s59 offen lds
    s_add_u32 m0, m0, 1024
    s_add_u32 s59, s59, 55296
    buffer_load_dwordx4 v12, s[40:43], s59 offen lds
    s_add_u32 m0, m0, 1024
    s_add_u32 s59, s59, 55296
L_m_37:
    s_barrier
    s_waitcnt vmcnt(0)
    s_cmp_ge_u32 s63, 126
    s_cbranch_scc1 L_m_38
    buffer_load_dwordx4 v12, s[40:43], s59 offen lds
    s_add_u32 m0, m0, 1024
    s_add_u32 s59, s59, 55296
    buffer_load_dwordx4 v12, s[40:43], s59 offen lds
    s_add_u32 m0, m0, 1024
    s_add_u32 s59, s59, 55296
    buffer_load_dwordx4 v12, s[40:43], s59 offen lds
    s_add_u32 m0, m0, 1024
    s_add_u32 s59, s59, 55296
    buffer_load_dwordx4 v12, s[40:43], s59 offen lds
    s_add_u32 m0, m0, 1024
    s_add_u32 s59, s59, 55296
    buffer_load_dwordx4 v12, s[40:43], s59 offen lds
    s_add_u32 m0, m0, 1024
    s_add_u32 s59, s59, 55296
    buffer_load_dwordx4 v12, s[40:43], s59 offen lds
    s_add_u32 m0, m0, 1024
    s_add_u32 s59, s59, 55296
    buffer_load_dwordx4 v12, s[40:43], s59 offen lds
L_m_38:
    s_mov_b32 s48, 0x9e3779b1
    v_mul_lo_u32 v3, v3, s48
    v_add_u32 v3, 0x7f4a7c15, v3
    v_or_b32 v3, 0x01010101, v3
    v_lshlrev_b32 v4, 16, v26
    v_and_b32 v5, 0xffff0000, v26
    v_mul_f32 v6, 0xbfb8aa3b, v4
    v_mul_f32 v7, 0xbfb8aa3b, v5
    v_exp_f32 v6, v6
    v_exp_f32 v7, v7
    v_add_f32 v6, 1.0, v6
    v_add_f32 v7, 1.0, v7
    v_rcp_f32 v6, v6
    v_rcp_f32 v7, v7
    v_mul_f32 v4, v4, v6
    v_mul_f32 v5, v5, v7
    v_cvt_pk_bf16_f32 v26, v4, v5
    v_add_u32 v27, 90112, v27
    ds_write_b32 v27, v26
    s_cmp_ge_u32 s5, 20
    s_cbranch_scc1 L_m_39
    v_cvt_f32_u32 v218, v2
    v_mul_f32 v218, 4.0, v218
    v_cvt_f32_u32 v219, v1
    v_cvt_f32_u32 v13, s4
    v_mul_f32 v10, 0x3d800000, v219
    v_fmac_f32 v10, 0x3c000000, v13
    v_mul_f32 v11, v218, v10
    v_cos_f32 v5, v11
    v_sin_f32 v6, v11
    s_nop 0
    v_cvt_pk_bf16_f32 v52, v5, v6
    v_cvt_pk_bf16_f32 v56, -v6, v5
    v_fma_f32 v7, v10, 1.0, v11
    v_cos_f32 v8, v7
    v_sin_f32 v9, v7
    s_nop 0
    v_cvt_pk_bf16_f32 v53, v8, v9
    v_cvt_pk_bf16_f32 v57, -v9, v8
    v_fma_f32 v4, v10, 2.0, v11
    v_cos_f32 v5, v4
    v_sin_f32 v6, v4
    s_nop 0
    v_cvt_pk_bf16_f32 v54, v5, v6
    v_cvt_pk_bf16_f32 v58, -v6, v5
    v_add_f32 v7, v4, v10
    v_cos_f32 v8, v7
    v_sin_f32 v9, v7
    s_nop 0
    v_cvt_pk_bf16_f32 v55, v8, v9
    v_cvt_pk_bf16_f32 v59, -v9, v8
    s_lshl_b32 s48, s3, 5
    s_add_u32 s48, s48, s4
    v_cvt_f32_u32 v14, s48
    v_mul_f32 v14, 0x3a000000, v14
    v_mul_f32 v10, 0x3d800000, v219
    v_add_f32 v10, v10, v14
    v_mul_f32 v11, v218, v10
    v_cos_f32 v5, v11
    v_sin_f32 v6, v11
    s_nop 0
    v_cvt_pk_bf16_f32 v68, v5, v6
    v_cvt_pk_bf16_f32 v72, -v6, v5
    v_fma_f32 v7, v10, 1.0, v11
    v_cos_f32 v8, v7
    v_sin_f32 v9, v7
    s_nop 0
    v_cvt_pk_bf16_f32 v69, v8, v9
    v_cvt_pk_bf16_f32 v73, -v9, v8
    v_fma_f32 v4, v10, 2.0, v11
    v_cos_f32 v5, v4
    v_sin_f32 v6, v4
    s_nop 0
    v_cvt_pk_bf16_f32 v70, v5, v6
    v_cvt_pk_bf16_f32 v74, -v6, v5
    v_add_f32 v7, v4, v10
    v_cos_f32 v8, v7
    v_sin_f32 v9, v7
    s_nop 0
    v_cvt_pk_bf16_f32 v71, v8, v9
    v_cvt_pk_bf16_f32 v75, -v9, v8
    v_add_f32 v10, 0x3b800000, v10
    v_mul_f32 v11, v218, v10
    v_cos_f32 v5, v11
    v_sin_f32 v6, v11
    s_nop 0
    v_cvt_pk_bf16_f32 v76, v5, v6
    v_cvt_pk_bf16_f32 v80, -v6, v5
    v_fma_f32 v7, v10, 1.0, v11
    v_cos_f32 v8, v7
    v_sin_f32 v9, v7
    s_nop 0
    v_cvt_pk_bf16_f32 v77, v8, v9
    v_cvt_pk_bf16_f32 v81, -v9, v8
    v_fma_f32 v4, v10, 2.0, v11
    v_cos_f32 v5, v4
    v_sin_f32 v6, v4
    s_nop 0
    v_cvt_pk_bf16_f32 v78, v5, v6
    v_cvt_pk_bf16_f32 v82, -v6, v5
    v_add_f32 v7, v4, v10
    v_cos_f32 v8, v7
    v_sin_f32 v9, v7
    s_nop 0
    v_cvt_pk_bf16_f32 v79, v8, v9
    v_cvt_pk_bf16_f32 v83, -v9, v8
    v_add_f32 v10, 0x3b800000, v10
    v_mul_f32 v11, v218, v10
    v_cos_f32 v5, v11
    v_sin_f32 v6, v11
    s_nop 0
    v_cvt_pk_bf16_f32 v84, v5, v6
    v_cvt_pk_bf16_f32 v88, -v6, v5
    v_fma_f32 v7, v10, 1.0, v11
    v_cos_f32 v8, v7
    v_sin_f32 v9, v7
    s_nop 0
    v_cvt_pk_bf16_f32 v85, v8, v9
    v_cvt_pk_bf16_f32 v89, -v9, v8
    v_fma_f32 v4, v10, 2.0, v11
    v_cos_f32 v5, v4
    v_sin_f32 v6, v4
    s_nop 0
    v_cvt_pk_bf16_f32 v86, v5, v6
    v_cvt_pk_bf16_f32 v90, -v6, v5
    v_add_f32 v7, v4, v10
    v_cos_f32 v8, v7
    v_sin_f32 v9, v7
    s_nop 0
    v_cvt_pk_bf16_f32 v87, v8, v9
    v_cvt_pk_bf16_f32 v91, -v9, v8
    v_add_f32 v10, 0x3b800000, v10
    v_mul_f32 v11, v218, v10
    v_cos_f32 v5, v11
    v_sin_f32 v6, v11
    s_nop 0
    v_cvt_pk_bf16_f32 v92, v5, v6
    v_cvt_pk_bf16_f32 v96, -v6, v5
    v_fma_f32 v7, v10, 1.0, v11
    v_cos_f32 v8, v7
    v_sin_f32 v9, v7
    s_nop 0
    v_cvt_pk_bf16_f32 v93, v8, v9
    v_cvt_pk_bf16_f32 v97, -v9, v8
    v_fma_f32 v4, v10, 2.0, v11
    v_cos_f32 v5, v4
    v_sin_f32 v6, v4
    s_nop 0
    v_cvt_pk_bf16_f32 v94, v5, v6
    v_cvt_pk_bf16_f32 v98, -v6, v5
    v_add_f32 v7, v4, v10
    v_cos_f32 v8, v7
    v_sin_f32 v9, v7
    s_nop 0
    v_cvt_pk_bf16_f32 v95, v8, v9
    v_cvt_pk_bf16_f32 v99, -v9, v8
L_m_39:
L_m_34:
    s_waitcnt lgkmcnt(0)
    s_barrier
    s_cmp_ge_u32 s5, 20
    s_cbranch_scc1 L_m_40
    s_waitcnt vmcnt(0)
    buffer_store_dword v3, v18, s[36:39], 0 offen sc1
    v_mul_f32 v10, 0x3d800000, v219
    v_fmac_f32 v14, 0x3d800000, v218
    v_mul_f32 v11, v219, v14
    v_cos_f32 v5, v11
    v_sin_f32 v6, v11
    s_nop 0
    v_cvt_pk_bf16_f32 v100, v5, -v6
    v_cvt_pk_bf16_f32 v104, v6, v5
    v_fma_f32 v7, v10, 1.0, v11
    v_cos_f32 v8, v7
    v_sin_f32 v9, v7
    s_nop 0
    v_cvt_pk_bf16_f32 v101, v8, -v9
    v_cvt_pk_bf16_f32 v105, v9, v8
    v_fma_f32 v4, v10, 2.0, v11
    v_cos_f32 v5, v4
    v_sin_f32 v6, v4
    s_nop 0
    v_cvt_pk_bf16_f32 v102, v5, -v6
    v_cvt_pk_bf16_f32 v106, v6, v5
    v_add_f32 v7, v4, v10
    v_cos_f32 v8, v7
    v_sin_f32 v9, v7
    s_nop 0
    v_cvt_pk_bf16_f32 v103, v8, -v9
    v_cvt_pk_bf16_f32 v107, v9, v8
    v_add_f32 v14, 0x3b800000, v14
    v_mul_f32 v11, v219, v14
    v_cos_f32 v5, v11
    v_sin_f32 v6, v11
    s_nop 0
    v_cvt_pk_bf16_f32 v108, v5, -v6
    v_cvt_pk_bf16_f32 v112, v6, v5
    v_fma_f32 v7, v10, 1.0, v11
    v_cos_f32 v8, v7
    v_sin_f32 v9, v7
    s_nop 0
    v_cvt_pk_bf16_f32 v109, v8, -v9
    v_cvt_pk_bf16_f32 v113, v9, v8
    v_fma_f32 v4, v10, 2.0, v11
    v_cos_f32 v5, v4
    v_sin_f32 v6, v4
    s_nop 0
    v_cvt_pk_bf16_f32 v110, v5, -v6
    v_cvt_pk_bf16_f32 v114, v6, v5
    v_add_f32 v7, v4, v10
    v_cos_f32 v8, v7
    v_sin_f32 v9, v7
    s_nop 0
    v_cvt_pk_bf16_f32 v111, v8, -v9
    v_cvt_pk_bf16_f32 v115, v9, v8
    v_add_f32 v14, 0x3b800000, v14
    v_mul_f32 v11, v219, v14
    v_cos_f32 v5, v11
    v_sin_f32 v6, v11
    s_nop 0
    v_cvt_pk_bf16_f32 v116, v5, -v6
    v_cvt_pk_bf16_f32 v120, v6, v5
    v_fma_f32 v7, v10, 1.0, v11
    v_cos_f32 v8, v7
    v_sin_f32 v9, v7
    s_nop 0
    v_cvt_pk_bf16_f32 v117, v8, -v9
    v_cvt_pk_bf16_f32 v121, v9, v8
    v_fma_f32 v4, v10, 2.0, v11
    v_cos_f32 v5, v4
    v_sin_f32 v6, v4
    s_nop 0
    v_cvt_pk_bf16_f32 v118, v5, -v6
    v_cvt_pk_bf16_f32 v122, v6, v5
    v_add_f32 v7, v4, v10
    v_cos_f32 v8, v7
    v_sin_f32 v9, v7
    s_nop 0
    v_cvt_pk_bf16_f32 v119, v8, -v9
    v_cvt_pk_bf16_f32 v123, v9, v8
    v_add_f32 v14, 0x3b800000, v14
    v_mul_f32 v11, v219, v14
    v_cos_f32 v5, v11
    v_sin_f32 v6, v11
    s_nop 0
    v_cvt_pk_bf16_f32 v124, v5, -v6
    v_cvt_pk_bf16_f32 v128, v6, v5
    v_fma_f32 v7, v10, 1.0, v11
    v_cos_f32 v8, v7
    v_sin_f32 v9, v7
    s_nop 0
    v_cvt_pk_bf16_f32 v125, v8, -v9
    v_cvt_pk_bf16_f32 v129, v9, v8
    v_fma_f32 v4, v10, 2.0, v11
    v_cos_f32 v5, v4
    v_sin_f32 v6, v4
    s_nop 0
    v_cvt_pk_bf16_f32 v126, v5, -v6
    v_cvt_pk_bf16_f32 v130, v6, v5
    v_add_f32 v7, v4, v10
    v_cos_f32 v8, v7
    v_sin_f32 v9, v7
    s_nop 0
    v_cvt_pk_bf16_f32 v127, v8, -v9
    v_cvt_pk_bf16_f32 v131, v9, v8
    v_mul_f32 v13, 0x3c000000, v13
    v_fmac_f32 v13, 0x3d800000, v218
    v_mul_f32 v11, v219, v13
    v_cos_f32 v5, v11
    v_sin_f32 v6, v11
    s_nop 0
    v_cvt_pk_bf16_f32 v60, v5, -v6
    v_cvt_pk_bf16_f32 v64, v6, v5
    v_fma_f32 v7, v10, 1.0, v11
    v_cos_f32 v8, v7
    v_sin_f32 v9, v7
    s_nop 0
    v_cvt_pk_bf16_f32 v61, v8, -v9
    v_cvt_pk_bf16_f32 v65, v9, v8
    v_fma_f32 v4, v10, 2.0, v11
    v_cos_f32 v5, v4
    v_sin_f32 v6, v4
    s_nop 0
    v_cvt_pk_bf16_f32 v62, v5, -v6
    v_cvt_pk_bf16_f32 v66, v6, v5
    v_add_f32 v7, v4, v10
    v_cos_f32 v8, v7
    v_sin_f32 v9, v7
    s_nop 0
    v_cvt_pk_bf16_f32 v63, v8, -v9
    v_cvt_pk_bf16_f32 v67, v9, v8
L_m_40:
    s_branch L_stub_11
L_back_h1:
    s_waitcnt vmcnt(0)
    s_lshl_b32 s48, s3, 5
    s_add_u32 s48, s48, s4
    v_lshrrev_b32 v8, 2, v1
    v_lshl_add_u32 v8, v8, 3, s48
    s_cmp_lt_u32 s60, 2
    s_cselect_b32 s48, 1, -1
    v_mul_i32_i24 v8, s48, v8
    v_and_b32 v8, 127, v8
    v_and_b32 v7, 3, v1
    v_lshl_add_u32 v8, v8, 2, v7
    v_lshlrev_b32 v15, 4, v8
    s_mov_b32 s64, 262144
    s_cmp_ge_u32 s5, 20
    s_cbranch_scc1 L_m_41
    buffer_load_dword v18, v15, s[36:39], s64 offen sc1
L_m_41:
    s_barrier
    buffer_store_dword v3, v17, s[36:39], 0 offen sc1
    s_cmp_ge_u32 s63, 126
    s_cbranch_scc1 L_m_42
    ds_read_b64_tr_b16 v[132:133], v28 offset:0
    ds_read_b64_tr_b16 v[134:135], v28 offset:2048
    ds_read2_b64 v[136:139], v29 offset0:0 offset1:4
    ds_read_b64_tr_b16 v[140:141], v28 offset:4096
    ds_read_b64_tr_b16 v[142:143], v28 offset:6144
    ds_read2_b64 v[144:147], v29 offset0:8 offset1:12
    ds_read_b64_tr_b16 v[148:149], v28 offset:8192
    ds_read_b64_tr_b16 v[150:151], v28 offset:10240
    ds_read2_b64 v[152:155], v29 offset0:16 offset1:20
    ds_read_b64_tr_b16 v[156:157], v28 offset:12288
    ds_read_b64_tr_b16 v[158:159], v28 offset:14336
    ds_read2_b64 v[160:163], v29 offset0:24 offset1:28
    ds_read_b64_tr_b16 v[164:165], v28 offset:16384
    ds_read_b64_tr_b16 v[166:167], v28 offset:18432
    ds_read2_b64 v[168:171], v29 offset0:32 offset1:36
    ds_read_b64_tr_b16 v[172:173], v28 offset:20480
    ds_read_b64_tr_b16 v[174:175], v28 offset:22528
    ds_read2_b64 v[176:179], v29 offset0:40 offset1:44
    ds_read_b64_tr_b16 v[180:181], v28 offset:24576
    ds_read_b64_tr_b16 v[182:183], v28 offset:26624
    ds_read2_b64 v[184:187], v29 offset0:48 offset1:52
    ds_read_b64_tr_b16 v[188:189], v28 offset:28672
    ds_read_b64_tr_b16 v[190:191], v28 offset:30720
    ds_read2_b64 v[192:195], v29 offset0:56 offset1:60
    ds_read_b64_tr_b16 v[196:197], v28 offset:32768
    ds_read_b64_tr_b16 v[198:199], v28 offset:34816
    ds_read2_b64 v[200:203], v29 offset0:64 offset1:68
    v_and_b32 v4, 3, v1
    v_or_b32 v4, 0x07060500, v4
    s_waitcnt lgkmcnt(14)
    v_mfma_f32_16x16x32_bf16 v[36:39], v[136:139], v[132:135], 0
    v_mfma_f32_16x16x32_bf16 v[36:39], v[144:147], v[140:143], v[36:39]
    v_mfma_f32_16x16x32_bf16 v[36:39], v[152:155], v[148:151], v[36:39]
    v_mfma_f32_16x16x32_bf16 v[36:39], v[160:163], v[156:159], v[36:39]
    s_waitcnt lgkmcnt(12)
    v_mfma_f32_16x16x32_bf16 v[36:39], v[168:171], v[164:167], v[36:39]
    s_waitcnt lgkmcnt(9)
    v_mfma_f32_16x16x32_bf16 v[36:39], v[176:179], v[172:175], v[36:39]
    s_waitcnt lgkmcnt(6)
    v_mfma_f32_16x16x32_bf16 v[36:39], v[184:187], v[180:183], v[36:39]
    s_waitcnt lgkmcnt(3)
    v_mfma_f32_16x16x32_bf16 v[36:39], v[192:195], v[188:191], v[36:39]
    s_waitcnt lgkmcnt(0)
    v_mfma_f32_16x16x32_bf16 v[36:39], v[200:203], v[196:199], v[36:39]
    s_nop 7
    v_add_u32 v40, 0x80, v36
    v_perm_b32 v40, v40, v3, v4
    s_mov_b32 s48, 0
    buffer_store_dword v40, v30, s[36:39], s48 offen sc1
L_m_42:
    s_cmp_lt_u32 s5, 20
    s_cbranch_scc1 L_m_32
    s_mov_b32 s52, s16
    s_mov_b32 s53, s17
    s_mov_b32 s54, 18874368
    s_mov_b32 s55, 0x20000
    s_mul_i32 s58, s3, 12
    s_add_u32 s58, s58, s5
    s_add_u32 s58, s58, -20
L_m_43:
    s_cmp_ge_u32 s58, 96
    s_cbranch_scc1 L_m_44
    s_mul_i32 s48, s58, 820
    s_lshr_b32 s48, s48, 13
    s_mul_i32 s49, s48, 10
    s_sub_u32 s49, s58, s49
    s_lshl_b32 s49, s49, 6
    v_add_u32 v220, s49, v0
    s_and_b32 s49, s4, 7
    s_mul_i32 s49, s49, 4
    s_add_u32 s48, s48, s49
    s_add_u32 s48, s48, 26
    s_and_b32 s48, s48, 31
    s_mul_i32 s48, s48, 73728
    s_mul_i32 s49, s4, 1152
    s_and_b32 s49, s49, -256
    s_add_u32 s48, s48, s49
    v_mul_u32_u24 v221, 820, v220
    v_lshrrev_b32 v221, 13, v221
    v_mul_u32_u24 v222, 10, v221
    v_sub_u32 v222, v220, v222
    v_and_b32 v220, 7, v221
    v_lshrrev_b32 v221, 3, v221
    v_lshl_add_u32 v220, v220, 8, v221
    v_mul_u32_u24 v220, 9216, v220
    v_lshl_add_u32 v220, v222, 7, v220
    buffer_load_dword v223, v220, s[52:55], s48 offen
    s_add_u32 s58, s58, 48
    s_branch L_m_43
L_m_44:
    s_waitcnt vmcnt(0)
    s_barrier
    s_branch L_m_33
    s_branch L_skip_11
L_stub_11:
    s_branch L_stub_12
L_skip_11:
L_m_32:
    s_setprio 1
    s_lshl_b32 s54, s3, 8
    s_add_u32 s52, s35, s54
    s_add_u32 s52, s52, 4194304
    s_lshl_b32 s53, s3, 12
    s_add_u32 s53, s53, s35
    s_add_u32 s53, s53, 1048576
    v_and_b32 v4, 3, v1
    v_lshrrev_b32 v5, 2, v1
    v_lshlrev_b32 v6, 6, v4
    v_lshl_add_u32 v6, v5, 4, v6
    v_lshl_add_u32 v217, v2, 12, v6
    v_mul_u32_u24 v212, 1040, v1
    v_lshl_add_u32 v212, v2, 6, v212
    v_add_u32 v212, s54, v212
    s_mul_i32 s48, s3, 4160
    v_add_u32 v214, s48, v16
    v_lshl_add_u32 v6, v2, 2, v4
    v_mul_u32_u24 v215, 1056, v6
    v_lshl_add_u32 v215, v5, 4, v215
    v_add_u32 v215, s54, v215
    s_mul_i32 s48, s3, 4224
    v_add_u32 v213, s48, v16
    s_and_b32 s66, s51, 3
    s_xor_b32 s66, s66, s60
    s_lshl_b32 s66, s66, 6
    s_lshl_b32 s48, s51, 8
    s_add_u32 s66, s66, s48
    s_mul_i32 s48, s3, 40960
    s_add_u32 s66, s66, s48
    s_add_u32 s66, s66, 8388608
    s_add_u32 s67, s66, 163840
    s_add_u32 s68, s66, 327680
    s_add_u32 s69, s66, 491520
    s_lshr_b32 s48, s51, 2
    s_and_b32 s48, s48, 2
    v_xor_b32 v4, s48, v4
    v_lshl_add_u32 v5, v2, 6, v5
    v_mul_u32_u24 v216, 10240, v5
    v_lshl_add_u32 v216, v4, 4, v216
    s_lshr_b32 s65, s4, 1
    s_lshl_b32 s65, s65, 16
    s_add_u32 s65, s65, 15728640
    s_lshl_b32 s48, s3, 10
    s_add_u32 s65, s65, s48
    v_lshlrev_b32 v218, 4, v0
    s_waitcnt vmcnt(1)
    v_cmp_ne_u32 vcc, v3, v18
    s_nop 0
    s_cbranch_vccz L_m_45
Lp_m_46:
    buffer_load_dword v18, v15, s[36:39], s64 offen sc1
    s_waitcnt vmcnt(0)
    v_cmp_ne_u32 vcc, v3, v18
    s_nop 0
    s_cbranch_vccz Le_m_47
    s_sub_u32 s7, s7, 1
    s_cbranch_scc1 Le_m_47
    s_sleep 1
    s_branch Lp_m_46
Le_m_47:
    s_max_i32 s7, s7, 0
L_m_45:
    buffer_load_dwordx4 v[224:227], v16, s[36:39], s53 offen offset:0 sc1
    buffer_load_dwordx4 v[228:231], v16, s[36:39], s53 offen offset:1024 sc1
    buffer_load_dwordx4 v[232:235], v16, s[36:39], s53 offen offset:2048 sc1
    buffer_load_dwordx4 v[236:239], v16, s[36:39], s53 offen offset:3072 sc1
    s_waitcnt vmcnt(0)
Lp_m_48:
    buffer_load_dword v4, v218, s[36:39], s65 offen sc1
    s_waitcnt vmcnt(0)
    v_cmp_ne_u32 vcc, v3, v4
    s_nop 0
    s_cbranch_vccz Le_m_49
    s_sub_u32 s7, s7, 1
    s_cbranch_scc1 Le_m_49
    s_mov_b64 exec, vcc
    s_sleep 1
    s_branch Lp_m_48
Le_m_49:
    s_mov_b64 exec, -1
    s_max_i32 s7, s7, 0
    buffer_load_dwordx4 v[36:39], v217, s[36:39], s52 offen offset:0 sc1
    buffer_load_dwordx4 v[40:43], v217, s[36:39], s52 offen offset:1024 sc1
    buffer_load_dwordx4 v[44:47], v217, s[36:39], s52 offen offset:2048 sc1
    buffer_load_dwordx4 v[48:51], v217, s[36:39], s52 offen offset:3072 sc1
    v_lshlrev_b32 v132, 16, v224
    v_and_b32 v136, 0xffff0000, v224
    v_lshlrev_b32 v133, 16, v225
    v_and_b32 v137, 0xffff0000, v225
    v_lshlrev_b32 v134, 16, v226
    v_and_b32 v138, 0xffff0000, v226
    v_lshlrev_b32 v135, 16, v227
    v_and_b32 v139, 0xffff0000, v227
    v_lshlrev_b32 v140, 16, v228
    v_and_b32 v144, 0xffff0000, v228
    v_lshlrev_b32 v141, 16, v229
    v_and_b32 v145, 0xffff0000, v229
    v_lshlrev_b32 v142, 16, v230
    v_and_b32 v146, 0xffff0000, v230
    v_lshlrev_b32 v143, 16, v231
    v_and_b32 v147, 0xffff0000, v231
    v_lshlrev_b32 v148, 16, v232
    v_and_b32 v152, 0xffff0000, v232
    v_lshlrev_b32 v149, 16, v233
    v_and_b32 v153, 0xffff0000, v233
    v_lshlrev_b32 v150, 16, v234
    v_and_b32 v154, 0xffff0000, v234
    v_lshlrev_b32 v151, 16, v235
    v_and_b32 v155, 0xffff0000, v235
    v_lshlrev_b32 v156, 16, v236
    v_and_b32 v160, 0xffff0000, v236
    v_lshlrev_b32 v157, 16, v237
    v_and_b32 v161, 0xffff0000, v237
    v_lshlrev_b32 v158, 16, v238
    v_and_b32 v162, 0xffff0000, v238
    v_lshlrev_b32 v159, 16, v239
    v_and_b32 v163, 0xffff0000, v239
    s_waitcnt vmcnt(2)
    v_swap_b32 v37, v40
    s_waitcnt vmcnt(1)
    v_swap_b32 v38, v44
    s_waitcnt vmcnt(0)
    v_swap_b32 v39, v48
    s_nop 1
    v_mfma_f32_16x16x32_bf16 v[164:167], v[36:39], v[52:55], 0
    v_mfma_f32_16x16x32_bf16 v[168:171], v[36:39], v[56:59], 0
    v_swap_b32 v42, v45
    v_swap_b32 v43, v49
    s_nop 1
    v_mfma_f32_16x16x32_bf16 v[172:175], v[40:43], v[52:55], 0
    v_mfma_f32_16x16x32_bf16 v[176:179], v[40:43], v[56:59], 0
    v_swap_b32 v47, v50
    s_nop 1
    v_mfma_f32_16x16x32_bf16 v[180:183], v[44:47], v[52:55], 0
    v_mfma_f32_16x16x32_bf16 v[184:187], v[44:47], v[56:59], 0
    v_mfma_f32_16x16x32_bf16 v[188:191], v[48:51], v[52:55], 0
    v_mfma_f32_16x16x32_bf16 v[192:195], v[48:51], v[56:59], 0
    v_cvt_pk_bf16_f32 v196, v164, v168
    v_cvt_pk_bf16_f32 v197, v165, v169
    v_cvt_pk_bf16_f32 v198, v166, v170
    v_cvt_pk_bf16_f32 v199, v167, v171
    ds_write_b128 v212, v[196:199] offset:36864
    v_cvt_pk_bf16_f32 v200, v172, v176
    v_cvt_pk_bf16_f32 v201, v173, v177
    v_cvt_pk_bf16_f32 v202, v174, v178
    v_cvt_pk_bf16_f32 v203, v175, v179
    ds_write_b128 v212, v[200:203] offset:36880
    v_cvt_pk_bf16_f32 v204, v180, v184
    v_cvt_pk_bf16_f32 v205, v181, v185
    v_cvt_pk_bf16_f32 v206, v182, v186
    v_cvt_pk_bf16_f32 v207, v183, v187
    ds_write_b128 v212, v[204:207] offset:36896
    v_cvt_pk_bf16_f32 v208, v188, v192
    v_cvt_pk_bf16_f32 v209, v189, v193
    v_cvt_pk_bf16_f32 v210, v190, v194
    v_cvt_pk_bf16_f32 v211, v191, v195
    ds_write_b128 v212, v[208:211] offset:36912
    s_waitcnt lgkmcnt(0)
    s_barrier
    ds_read_b128 v[36:39], v214 offset:36864
    ds_read_b128 v[40:43], v214 offset:37904
    ds_read_b128 v[44:47], v214 offset:38944
    ds_read_b128 v[48:51], v214 offset:39984
    s_waitcnt lgkmcnt(3)
    v_mfma_f32_16x16x32_bf16 v[164:167], v[68:71], v[36:39], 0
    v_mfma_f32_16x16x32_bf16 v[168:171], v[72:75], v[36:39], 0
    s_waitcnt lgkmcnt(2)
    v_mfma_f32_16x16x32_bf16 v[172:175], v[76:79], v[40:43], 0
    v_mfma_f32_16x16x32_bf16 v[176:179], v[80:83], v[40:43], 0
    s_waitcnt lgkmcnt(1)
    v_mfma_f32_16x16x32_bf16 v[180:183], v[84:87], v[44:47], 0
    v_mfma_f32_16x16x32_bf16 v[184:187], v[88:91], v[44:47], 0
    s_waitcnt lgkmcnt(0)
    v_mfma_f32_16x16x32_bf16 v[188:191], v[92:95], v[48:51], 0
    v_mfma_f32_16x16x32_bf16 v[192:195], v[96:99], v[48:51], 0
    v_pk_mul_f32 v[4:5], v[164:165], v[132:133]
    v_pk_mul_f32 v[6:7], v[168:169], v[132:133]
    v_pk_fma_f32 v[4:5], v[168:169], v[136:137], v[4:5] neg_lo:[1,0,0] neg_hi:[1,0,0]
    v_pk_fma_f32 v[6:7], v[164:165], v[136:137], v[6:7]
    v_cvt_pk_bf16_f32 v196, v4, v6
    v_cvt_pk_bf16_f32 v197, v5, v7
    v_pk_mul_f32 v[8:9], v[166:167], v[134:135]
    v_pk_mul_f32 v[10:11], v[170:171], v[134:135]
    v_pk_fma_f32 v[8:9], v[170:171], v[138:139], v[8:9] neg_lo:[1,0,0] neg_hi:[1,0,0]
    v_pk_fma_f32 v[10:11], v[166:167], v[138:139], v[10:11]
    v_cvt_pk_bf16_f32 v198, v8, v10
    v_cvt_pk_bf16_f32 v199, v9, v11
    v_pk_mul_f32 v[4:5], v[172:173], v[140:141]
    v_pk_mul_f32 v[6:7], v[176:177], v[140:141]
    v_pk_fma_f32 v[4:5], v[176:177], v[144:145], v[4:5] neg_lo:[1,0,0] neg_hi:[1,0,0]
    v_pk_fma_f32 v[6:7], v[172:173], v[144:145], v[6:7]
    v_cvt_pk_bf16_f32 v200, v4, v6
    v_cvt_pk_bf16_f32 v201, v5, v7
    v_mfma_f32_16x16x32_bf16 v[164:167], v[100:103], v[196:199], 0
    v_pk_mul_f32 v[8:9], v[174:175], v[142:143]
    v_pk_mul_f32 v[10:11], v[178:179], v[142:143]
    v_pk_fma_f32 v[8:9], v[178:179], v[146:147], v[8:9] neg_lo:[1,0,0] neg_hi:[1,0,0]
    v_pk_fma_f32 v[10:11], v[174:175], v[146:147], v[10:11]
    v_cvt_pk_bf16_f32 v202, v8, v10
    v_cvt_pk_bf16_f32 v203, v9, v11
    v_mfma_f32_16x16x32_bf16 v[168:171], v[104:107], v[196:199], 0
    v_pk_mul_f32 v[4:5], v[180:181], v[148:149]
    v_pk_mul_f32 v[6:7], v[184:185], v[148:149]
    v_pk_fma_f32 v[4:5], v[184:185], v[152:153], v[4:5] neg_lo:[1,0,0] neg_hi:[1,0,0]
    v_pk_fma_f32 v[6:7], v[180:181], v[152:153], v[6:7]
    v_cvt_pk_bf16_f32 v204, v4, v6
    v_cvt_pk_bf16_f32 v205, v5, v7
    v_mfma_f32_16x16x32_bf16 v[172:175], v[108:111], v[200:203], 0
    v_pk_mul_f32 v[8:9], v[182:183], v[150:151]
    v_pk_mul_f32 v[10:11], v[186:187], v[150:151]
    v_pk_fma_f32 v[8:9], v[186:187], v[154:155], v[8:9] neg_lo:[1,0,0] neg_hi:[1,0,0]
    v_pk_fma_f32 v[10:11], v[182:183], v[154:155], v[10:11]
    v_cvt_pk_bf16_f32 v206, v8, v10
    v_cvt_pk_bf16_f32 v207, v9, v11
    v_mfma_f32_16x16x32_bf16 v[176:179], v[112:115], v[200:203], 0
    v_pk_mul_f32 v[4:5], v[188:189], v[156:157]
    v_pk_mul_f32 v[6:7], v[192:193], v[156:157]
    v_pk_fma_f32 v[4:5], v[192:193], v[160:161], v[4:5] neg_lo:[1,0,0] neg_hi:[1,0,0]
    v_pk_fma_f32 v[6:7], v[188:189], v[160:161], v[6:7]
    v_cvt_pk_bf16_f32 v208, v4, v6
    v_cvt_pk_bf16_f32 v209, v5, v7
    v_mfma_f32_16x16x32_bf16 v[180:183], v[116:119], v[204:207], 0
    v_pk_mul_f32 v[8:9], v[190:191], v[158:159]
    v_pk_mul_f32 v[10:11], v[194:195], v[158:159]
    v_pk_fma_f32 v[8:9], v[194:195], v[162:163], v[8:9] neg_lo:[1,0,0] neg_hi:[1,0,0]
    v_pk_fma_f32 v[10:11], v[190:191], v[162:163], v[10:11]
    v_cvt_pk_bf16_f32 v210, v8, v10
    v_cvt_pk_bf16_f32 v211, v9, v11
    v_mfma_f32_16x16x32_bf16 v[184:187], v[120:123], v[204:207], 0
    v_cvt_pk_bf16_f32 v36, v164, v168
    v_cvt_pk_bf16_f32 v40, v165, v169
    v_cvt_pk_bf16_f32 v44, v166, v170
    v_cvt_pk_bf16_f32 v48, v167, v171
    v_mfma_f32_16x16x32_bf16 v[188:191], v[124:127], v[208:211], 0
    v_mfma_f32_16x16x32_bf16 v[192:195], v[128:131], v[208:211], 0
    v_cvt_pk_bf16_f32 v37, v172, v176
    v_cvt_pk_bf16_f32 v41, v173, v177
    v_cvt_pk_bf16_f32 v45, v174, v178
    v_cvt_pk_bf16_f32 v49, v175, v179
    v_cvt_pk_bf16_f32 v38, v180, v184
    v_cvt_pk_bf16_f32 v42, v181, v185
    v_cvt_pk_bf16_f32 v46, v182, v186
    v_cvt_pk_bf16_f32 v50, v183, v187
    v_cvt_pk_bf16_f32 v39, v188, v192
    ds_write_b128 v215, v[36:39] offset:53504
    v_cvt_pk_bf16_f32 v43, v189, v193
    ds_write_b128 v215, v[40:43] offset:53568
    v_cvt_pk_bf16_f32 v47, v190, v194
    ds_write_b128 v215, v[44:47] offset:53632
    v_cvt_pk_bf16_f32 v51, v191, v195
    ds_write_b128 v215, v[48:51] offset:53696
    s_waitcnt lgkmcnt(0)
    s_barrier
    ds_read_b128 v[196:199], v213 offset:53504
    ds_read_b128 v[200:203], v213 offset:54560
    ds_read_b128 v[204:207], v213 offset:55616
    ds_read_b128 v[208:211], v213 offset:56672
    s_waitcnt lgkmcnt(3)
    v_mfma_f32_16x16x32_bf16 v[164:167], v[60:63], v[196:199], 0
    v_mfma_f32_16x16x32_bf16 v[168:171], v[64:67], v[196:199], 0
    s_waitcnt lgkmcnt(2)
    v_mfma_f32_16x16x32_bf16 v[172:175], v[60:63], v[200:203], 0
    v_mfma_f32_16x16x32_bf16 v[176:179], v[64:67], v[200:203], 0
    s_waitcnt lgkmcnt(1)
    v_mfma_f32_16x16x32_bf16 v[180:183], v[60:63], v[204:207], 0
    v_mfma_f32_16x16x32_bf16 v[184:187], v[64:67], v[204:207], 0
    s_waitcnt lgkmcnt(0)
    v_mfma_f32_16x16x32_bf16 v[188:191], v[60:63], v[208:211], 0
    v_mfma_f32_16x16x32_bf16 v[192:195], v[64:67], v[208:211], 0
    v_cvt_pk_bf16_f32 v36, v168, v164
    v_cvt_pk_bf16_f32 v40, v169, v165
    v_cvt_pk_bf16_f32 v44, v170, v166
    v_cvt_pk_bf16_f32 v48, v171, v167
    v_cvt_pk_bf16_f32 v37, v176, v172
    v_cvt_pk_bf16_f32 v41, v177, v173
    v_cvt_pk_bf16_f32 v45, v178, v174
    s_branch L_skip_12
L_stub_12:
    s_branch L_back_h1
L_skip_12:
    v_cvt_pk_bf16_f32 v49, v179, v175
    v_cvt_pk_bf16_f32 v38, v184, v180
    v_cvt_pk_bf16_f32 v42, v185, v181
    v_cvt_pk_bf16_f32 v46, v186, v182
    v_cvt_pk_bf16_f32 v50, v187, v183
    v_cvt_pk_bf16_f32 v39, v192, v188
    buffer_store_dwordx4 v[36:39], v216, s[36:39], s66 offen sc1
    v_cvt_pk_bf16_f32 v43, v193, v189
    buffer_store_dwordx4 v[40:43], v216, s[36:39], s67 offen sc1
    v_cvt_pk_bf16_f32 v47, v194, v190
    buffer_store_dwordx4 v[44:47], v216, s[36:39], s68 offen sc1
    v_cvt_pk_bf16_f32 v51, v195, v191
    buffer_store_dwordx4 v[48:51], v216, s[36:39], s69 offen sc1
    buffer_store_dword v3, v19, s[36:39], 0 offen sc1
    s_setprio 0
    s_waitcnt vmcnt(0)
    s_barrier
L_m_33:
    v_lshlrev_b32 v8, 4, v0
    s_mul_i32 s52, s4, 27
    s_add_u32 s52, s52, s5
    s_mul_i32 s51, s52, 171
    s_lshr_b32 s51, s51, 10
    s_mul_i32 s48, s51, 6
    s_sub_u32 s52, s52, s48
    s_lshr_b32 s53, s4, 1
    s_and_b32 s54, s4, 1
    s_lshl_b32 s54, s54, 3
    s_lshr_b32 s48, s5, 2
    s_add_u32 s54, s54, s48
    s_and_b32 s55, s5, 3
    s_mov_b32 s40, s16
    s_mov_b32 s41, s17
    s_mov_b32 s42, 18874368
    s_mov_b32 s43, 0x20000
    s_mov_b32 s44, s20
    s_mov_b32 s45, s21
    s_mov_b32 s46, 18874368
    s_mov_b32 s47, 0x20000
    s_and_b32 s62, s3, 1
    s_and_b32 s63, s4, 7
    s_mul_i32 s63, s63, 4
    s_add_u32 s63, s63, 26
    s_mul_i32 s48, s51, 0
    s_add_u32 s63, s63, s48
    s_and_b32 s63, s63, 31
    s_mov_b32 s64, 0
    s_lshl_b32 s68, s62, 13
    s_cmp_ge_u32 s3, 2
    s_cbranch_scc1 L_m_50
    s_branch L_stub_13
L_back_a1:
    s_mul_i32 s56, s62, 27
    s_add_u32 s56, s56, s5
    s_add_u32 s56, s56, 116
    s_cmp_lt_u32 s5, 27
    s_cselect_b32 s56, s56, 999
    s_barrier
    v_mov_b64 v[28:29], -1
    v_mov_b64 v[30:31], -1
    s_lshl_b32 s56, s2, 1
    s_add_u32 s56, s56, s62
    s_add_u32 s48, s56, 0
    s_cmp_ge_u32 s48, 1152
    s_cbranch_scc1 L_m_51
    s_mov_b32 s49, s48
    s_cmp_ge_u32 s49, 288
    s_cselect_b32 s50, 1008, 0
    s_add_u32 s48, s48, s50
    s_cmp_ge_u32 s49, 576
    s_cselect_b32 s50, 1008, 0
    s_add_u32 s48, s48, s50
    s_cmp_ge_u32 s49, 864
    s_cselect_b32 s50, 1008, 0
    s_add_u32 s48, s48, s50
    s_lshl_b32 s48, s48, 10
    s_add_u32 s48, s48, 21413888
    buffer_store_dwordx4 v[28:31], v8, s[36:39], s48 offen sc1
L_m_51:
    s_add_u32 s48, s56, 512
    s_cmp_ge_u32 s48, 1152
    s_cbranch_scc1 L_m_52
    s_mov_b32 s49, s48
    s_cmp_ge_u32 s49, 288
    s_cselect_b32 s50, 1008, 0
    s_add_u32 s48, s48, s50
    s_cmp_ge_u32 s49, 576
    s_cselect_b32 s50, 1008, 0
    s_add_u32 s48, s48, s50
    s_cmp_ge_u32 s49, 864
    s_cselect_b32 s50, 1008, 0
    s_add_u32 s48, s48, s50
    s_lshl_b32 s48, s48, 10
    s_add_u32 s48, s48, 21413888
    buffer_store_dwordx4 v[28:31], v8, s[36:39], s48 offen sc1
L_m_52:
    s_add_u32 s48, s56, 1024
    s_cmp_ge_u32 s48, 1152
    s_cbranch_scc1 L_m_53
    s_mov_b32 s49, s48
    s_cmp_ge_u32 s49, 288
    s_cselect_b32 s50, 1008, 0
    s_add_u32 s48, s48, s50
    s_cmp_ge_u32 s49, 576
    s_cselect_b32 s50, 1008, 0
    s_add_u32 s48, s48, s50
    s_cmp_ge_u32 s49, 864
    s_cselect_b32 s50, 1008, 0
    s_add_u32 s48, s48, s50
    s_lshl_b32 s48, s48, 10
    s_add_u32 s48, s48, 21413888
    buffer_store_dwordx4 v[28:31], v8, s[36:39], s48 offen sc1
L_m_53:
    s_bfe_u32 s56, s6, 0x10002
    s_lshl_b32 s56, s56, 7
    s_lshr_b32 s57, s6, 3
    s_lshl_b32 s57, s57, 2
    s_add_u32 s56, s56, s57
    s_and_b32 s57, s6, 3
    s_add_u32 s56, s56, s57
    s_lshl_b32 s48, s56, 4
    s_lshl_b32 s49, s3, 16
    s_add_u32 s48, s48, s49
    s_add_u32 s48, s48, 16252928
    v_mov_b32 v10, 2146435072
    v_writelane_b32 v10, s48, 0
    s_add_u32 s48, s48, 16384
    s_lshl_b32 s56, s52, 6
    s_add_u32 s56, s56, s51
    s_lshl_b32 s48, s56, 4
    s_lshl_b32 s49, s3, 16
    s_add_u32 s48, s48, s49
    s_add_u32 s48, s48, 16515072
    v_mov_b32 v11, 2146435072
    v_writelane_b32 v11, s48, 0
    s_add_u32 s48, s48, 16384
    s_add_u32 s48, s2, 216
    s_lshl_b32 s48, s48, 7
    s_add_u32 s48, s48, 622592
    s_lshl_b32 s49, s3, 8
    s_add_u32 s49, s49, s5
    s_cmp_lt_u32 s49, 5
    s_cselect_b32 s48, s48, 2146435072
    v_writelane_b32 v11, s48, 8
    s_lshr_b32 s65, s4, 2
    s_lshl_b32 s65, s65, 16
    s_add_u32 s66, s65, 16515072
    s_lshl_b32 s48, s62, 11
    s_add_u32 s65, s65, s48
    s_add_u32 s65, s65, 16252928
    s_add_u32 s69, s65, 1024
    v_lshlrev_b32 v27, 4, v0
    s_mul_i32 s67, s52, 1536
    s_mul_i32 s48, s62, 36864
    s_add_u32 s67, s67, s48
    s_add_u32 s67, s67, 16777216
    v_add_u32 v14, 7680, v8
    v_cmp_gt_u32 vcc, 32, v0
    s_nop 1
    v_cndmask_b32 v13, v14, v8, vcc
    v_add_u32 v15, 18432, v8
    v_add_u32 v16, 18432, v13
    v_add_u32 v17, 18432, v14
    s_mul_i32 s68, s62, 6144
    s_mul_i32 s58, s63, 73728
    s_add_u32 s58, s58, s67
    s_add_u32 s59, s67, 2359296
    s_barrier
    s_mul_i32 s56, s62, 288
    s_mul_i32 s57, s6, 1152
    s_add_u32 s57, s57, 12582912
    v_add_u32 v4, 0, v0
    v_min_u32 v4, 287, v4
    v_add_u32 v4, s56, v4
    v_mul_u32_u24 v5, 911, v4
    v_lshrrev_b32 v5, 16, v5
    v_mul_u32_u24 v5, 293760, v5
    v_lshl_add_u32 v22, v4, 4, v5
    v_lshlrev_b32 v4, 4, v4
    v_add_u32 v6, 98304, v4
    v_add_u32 v4, 64, v0
    v_min_u32 v4, 287, v4
    v_add_u32 v4, s56, v4
    v_mul_u32_u24 v5, 911, v4
    v_lshrrev_b32 v5, 16, v5
    v_mul_u32_u24 v5, 293760, v5
    v_lshl_add_u32 v23, v4, 4, v5
    v_add_u32 v4, 128, v0
    v_min_u32 v4, 287, v4
    v_add_u32 v4, s56, v4
    v_mul_u32_u24 v5, 911, v4
    v_lshrrev_b32 v5, 16, v5
    v_mul_u32_u24 v5, 293760, v5
    v_lshl_add_u32 v24, v4, 4, v5
    v_add_u32 v4, 192, v0
    v_min_u32 v4, 287, v4
    v_add_u32 v4, s56, v4
    v_mul_u32_u24 v5, 911, v4
    v_lshrrev_b32 v5, 16, v5
    v_mul_u32_u24 v5, 293760, v5
    v_lshl_add_u32 v25, v4, 4, v5
    v_add_u32 v4, 256, v0
    v_min_u32 v4, 287, v4
    v_add_u32 v4, s56, v4
    v_mul_u32_u24 v5, 911, v4
    v_lshrrev_b32 v5, 16, v5
    v_mul_u32_u24 v5, 293760, v5
    v_lshl_add_u32 v26, v4, 4, v5
    v_lshlrev_b32 v4, 4, v4
    v_add_u32 v7, 98304, v4
    s_barrier
    s_barrier
    ds_read_b128 v[28:31], v6 offset:0
    ds_read_b128 v[32:35], v6 offset:1024
    ds_read_b128 v[36:39], v6 offset:2048
    ds_read_b128 v[40:43], v6 offset:3072
    ds_read_b128 v[44:47], v7 offset:0
    s_lshl_b32 s48, s62, 8
    s_add_u32 s48, s48, s6
    s_lshl_b32 s48, s48, 7
    s_add_u32 s48, s48, 15990784
    v_add_u32 v54, s48, v8
    v_cmp_gt_u32 vcc, 8, v0
    v_mov_b32 v4, 2146435072
    s_nop 0
    v_cndmask_b32 v54, v4, v54, vcc
    s_waitcnt vmcnt(0)
    v_mov_b32 v48, v3
    v_mov_b32 v49, v3
    v_mov_b32 v50, v3
    v_mov_b32 v51, v3
    s_cmp_ge_u32 s5, 27
    s_cbranch_scc1 L_m_54
    v_lshrrev_b32 v52, 4, v0
    v_and_b32 v53, 15, v0
    v_lshlrev_b32 v52, 12, v52
    v_lshl_add_u32 v52, v53, 7, v52
    s_lshr_b32 s48, s4, 1
    s_mul_i32 s48, s48, 4718592
    s_and_b32 s49, s4, 1
    s_lshl_b32 s49, s49, 11
    s_add_u32 s48, s48, s49
    v_add_u32 v52, s48, v52
    s_mov_b32 s35, 0
    s_mov_b32 s49, s35
    s_mul_i32 s48, s62, 1
    s_add_u32 s49, s49, s48
    s_bfm_b32 s48, s5, 0
    s_and_b32 s48, s48, 0
    s_bcnt1_i32_b32 s48, s48
    s_sub_u32 s12, s5, s48
    s_mul_i32 s35, s12, 4
    s_add_u32 s35, s35, 84
    s_add_u32 s35, s35, s49
    s_min_u32 s35, s35, 191
    s_lshl_b32 s8, s35, 14
    s_mul_i32 s35, s12, 4
    s_add_u32 s35, s35, 86
    s_add_u32 s35, s35, s49
    s_min_u32 s35, s35, 191
    s_lshl_b32 s9, s35, 14
    s_mul_i32 s35, s12, 132
    s_lshr_b32 s35, s35, 8
    s_add_u32 s35, s35, 0
    s_mul_i32 s48, s62, 0
    s_add_u32 s35, s35, s48
    s_mov_b32 s48, 0
    s_bitcmp1_b32 s48, s5
    s_cselect_b32 s35, 999, s35
    s_add_u32 s50, s58, 589824
    s_cmp_ge_u32 s50, s59
    s_cselect_b32 s48, 2359296, 0
    s_sub_u32 s50, s50, s48
    s_waitcnt lgkmcnt(0)
    s_barrier
    buffer_store_dword v3, v10, s[36:39], 0 offen sc1
    v_add_u32 v76, 0, v0
    v_mul_u32_u24 v77, 1821, v76
    v_lshrrev_b32 v77, 18, v77
    v_mul_u32_u24 v77, 6912, v77
    v_lshl_add_u32 v77, v76, 4, v77
    v_subrev_u32 v56, 0, v77
    v_add_u32 v76, 64, v0
    v_mul_u32_u24 v77, 1821, v76
    v_lshrrev_b32 v77, 18, v77
    v_mul_u32_u24 v77, 6912, v77
    v_lshl_add_u32 v77, v76, 4, v77
    v_subrev_u32 v57, 1024, v77
    v_add_u32 v76, 128, v0
    v_mul_u32_u24 v77, 1821, v76
    v_lshrrev_b32 v77, 18, v77
    v_mul_u32_u24 v77, 6912, v77
    v_lshl_add_u32 v77, v76, 4, v77
    v_subrev_u32 v58, 2048, v77
    v_add_u32 v76, 192, v0
    v_mul_u32_u24 v77, 1821, v76
    v_lshrrev_b32 v77, 18, v77
    v_mul_u32_u24 v77, 6912, v77
    v_lshl_add_u32 v77, v76, 4, v77
    v_subrev_u32 v59, 3072, v77
    v_add_u32 v76, 256, v0
    v_mul_u32_u24 v77, 1821, v76
    v_lshrrev_b32 v77, 18, v77
    v_mul_u32_u24 v77, 6912, v77
    v_lshl_add_u32 v77, v76, 4, v77
    v_subrev_u32 v60, 0, v77
    v_add_u32 v76, 320, v0
    v_mul_u32_u24 v77, 1821, v76
    v_lshrrev_b32 v77, 18, v77
    v_mul_u32_u24 v77, 6912, v77
    v_lshl_add_u32 v77, v76, 4, v77
    v_subrev_u32 v61, 1024, v77
    v_add_u32 v76, 384, v0
    v_mul_u32_u24 v77, 1821, v76
    v_lshrrev_b32 v77, 18, v77
    v_mul_u32_u24 v77, 6912, v77
    v_lshl_add_u32 v77, v76, 4, v77
    v_subrev_u32 v62, 2048, v77
    v_add_u32 v76, 448, v0
    v_mul_u32_u24 v77, 1821, v76
    v_lshrrev_b32 v77, 18, v77
    v_mul_u32_u24 v77, 6912, v77
    v_lshl_add_u32 v77, v76, 4, v77
    v_subrev_u32 v63, 3072, v77
    v_add_u32 v76, 512, v0
    v_mul_u32_u24 v77, 1821, v76
    v_lshrrev_b32 v77, 18, v77
    v_mul_u32_u24 v77, 6912, v77
    v_lshl_add_u32 v77, v76, 4, v77
    v_subrev_u32 v64, 0, v77
    s_mul_i32 s48, s55, 3
    s_add_u32 s49, s48, 2
    s_lshr_b32 s48, s48, 1
    s_lshr_b32 s49, s49, 1
    v_mov_b32 v76, s48
    v_mov_b32 v77, s49
    v_cmp_gt_u32 vcc, 32, v0
    s_nop 1
    v_cndmask_b32 v76, v77, v76, vcc
    v_and_b32 v77, 31, v0
    v_min_u32 v77, 8, v77
    v_lshl_add_u32 v76, v76, 6, v77
    s_mul_i32 s48, s53, 9
    v_add_u32 v76, s48, v76
    v_lshlrev_b32 v66, 4, v76
    s_lshr_b32 s48, s54, 3
    s_lshl_b32 s48, s48, 2
    s_and_b32 s49, s54, 1
    s_lshl_b32 s49, s49, 1
    s_add_u32 s48, s48, s49
    s_add_u32 s48, s48, s62
    s_lshl_b32 s48, s48, 13
    s_add_u32 s48, s48, 15990784
    v_lshl_add_u32 v67, v0, 7, s48
    v_mov_b32 v68, 0
    s_lshl_b32 s48, s54, 7
    s_lshr_b32 s49, s53, 1
    s_lshl_b32 s49, s49, 4
    s_add_u32 s48, s48, s49
    s_mul_i32 s48, s48, 1152
    s_mul_i32 s49, s55, 288
    s_add_u32 s48, s48, s49
    s_and_b32 s49, s53, 1
    s_mul_i32 s49, s49, 144
    s_add_u32 s48, s48, s49
    s_add_u32 s12, s48, 12582912
    s_lshl_b32 s13, s62, 6
    v_add_u32 v76, s13, v0
    v_mul_u32_u24 v77, 911, v76
    v_lshrrev_b32 v77, 13, v77
    v_mul_u32_u24 v78, 9, v77
    v_sub_u32 v78, v76, v78
    v_and_b32 v76, 48, v77
    v_add_u32 v77, v77, v76
    v_mul_u32_u24 v77, 1152, v77
    v_lshl_add_u32 v77, v78, 4, v77
    v_add_u32 v70, s12, v77
    s_add_u32 s13, s13, 128
    v_add_u32 v76, s13, v0
    v_mul_u32_u24 v77, 911, v76
    v_lshrrev_b32 v77, 13, v77
    v_mul_u32_u24 v78, 9, v77
    v_sub_u32 v78, v76, v78
    v_and_b32 v76, 48, v77
    v_add_u32 v77, v77, v76
    v_mul_u32_u24 v77, 1152, v77
    v_lshl_add_u32 v77, v78, 4, v77
    v_add_u32 v71, s12, v77
    s_add_u32 s13, s13, 128
    v_add_u32 v76, s13, v0
    v_mul_u32_u24 v77, 911, v76
    v_lshrrev_b32 v77, 13, v77
    v_mul_u32_u24 v78, 9, v77
    v_sub_u32 v78, v76, v78
    v_and_b32 v76, 48, v77
    v_add_u32 v77, v77, v76
    v_mul_u32_u24 v77, 1152, v77
    v_lshl_add_u32 v77, v78, 4, v77
    v_add_u32 v72, s12, v77
    s_add_u32 s13, s13, 128
    v_add_u32 v76, s13, v0
    v_mul_u32_u24 v77, 911, v76
    v_lshrrev_b32 v77, 13, v77
    v_mul_u32_u24 v78, 9, v77
    v_sub_u32 v78, v76, v78
    v_and_b32 v76, 48, v77
    v_add_u32 v77, v77, v76
    v_mul_u32_u24 v77, 1152, v77
    v_lshl_add_u32 v77, v78, 4, v77
    v_add_u32 v73, s12, v77
    s_add_u32 s13, s13, 128
    v_add_u32 v76, s13, v0
    v_mul_u32_u24 v77, 911, v76
    v_lshrrev_b32 v77, 13, v77
    v_mul_u32_u24 v78, 9, v77
    v_sub_u32 v78, v76, v78
    v_and_b32 v76, 48, v77
    v_add_u32 v77, v77, v76
    v_mul_u32_u24 v77, 1152, v77
    v_lshl_add_u32 v77, v78, 4, v77
    v_add_u32 v74, s12, v77
    s_add_u32 s13, s13, 128
    s_mul_i32 s48, s55, 576
    s_and_b32 s49, s53, 1
    s_mul_i32 s49, s49, 288
    s_add_u32 s48, s48, s49
    s_add_u32 s48, s48, 11520
    v_min_u32 v76, 272, v8
    v_add_u32 v76, s48, v76
    s_cmp_eq_u32 s62, 1
    s_cselect_b64 vcc, -1, 0
    v_cndmask_b32 v74, v74, v76, vcc
    s_waitcnt vmcnt(0)
    s_barrier
    buffer_store_dwordx4 v[28:31], v22, s[36:39], s57 offen sc1
    buffer_store_dwordx4 v[32:35], v23, s[36:39], s57 offen sc1
    buffer_store_dwordx4 v[36:39], v24, s[36:39], s57 offen sc1
    buffer_store_dwordx4 v[40:43], v25, s[36:39], s57 offen sc1
    buffer_store_dwordx4 v[44:47], v26, s[36:39], s57 offen sc1
    s_barrier
    s_waitcnt vmcnt(0)
    buffer_store_dwordx4 v[48:51], v54, s[36:39], 0 offen sc1
Lp_m_56:
    buffer_load_dword v4, v27, s[36:39], s65 offen sc1
    buffer_load_dword v5, v27, s[36:39], s69 offen sc1
    s_waitcnt vmcnt(0)
    v_cmp_ne_u32 vcc, v3, v4
    v_cmp_ne_u32 s[48:49], v3, v5
    s_nop 0
    s_or_b64 vcc, vcc, s[48:49]
    s_cbranch_vccz Le_m_57
    s_sub_u32 s7, s7, 1
    s_cbranch_scc1 Le_m_57
    s_mov_b64 exec, vcc
    s_sleep 1
    s_branch Lp_m_56
Le_m_57:
    s_mov_b64 exec, -1
    s_max_i32 s7, s7, 0
    s_add_u32 m0, s68, 98304
    s_nop 0
    buffer_load_dwordx4 v8, s[36:39], s50 offen offset:0 sc1 lds
    buffer_load_dwordx4 v13, s[36:39], s50 offen offset:1024 sc1 lds
    buffer_load_dwordx4 v14, s[36:39], s50 offen offset:2048 sc1 lds
    s_add_u32 m0, s68, 101376
    s_nop 0
    buffer_load_dwordx4 v15, s[36:39], s50 offen offset:0 sc1 lds
    buffer_load_dwordx4 v16, s[36:39], s50 offen offset:1024 sc1 lds
    buffer_load_dwordx4 v17, s[36:39], s50 offen offset:2048 sc1 lds
    s_add_u32 s50, s58, 663552
    s_cmp_ge_u32 s50, s59
    s_cselect_b32 s48, 2359296, 0
    s_sub_u32 s50, s50, s48
    s_add_u32 m0, s68, 110592
    s_nop 0
    buffer_load_dwordx4 v8, s[36:39], s50 offen offset:0 sc1 lds
    buffer_load_dwordx4 v13, s[36:39], s50 offen offset:1024 sc1 lds
    buffer_load_dwordx4 v14, s[36:39], s50 offen offset:2048 sc1 lds
    s_add_u32 m0, s68, 113664
    s_nop 0
    buffer_load_dwordx4 v15, s[36:39], s50 offen offset:0 sc1 lds
    buffer_load_dwordx4 v16, s[36:39], s50 offen offset:1024 sc1 lds
    buffer_load_dwordx4 v17, s[36:39], s50 offen offset:2048 sc1 lds
    s_add_u32 s50, s58, 737280
    s_cmp_ge_u32 s50, s59
    s_cselect_b32 s48, 2359296, 0
    s_sub_u32 s50, s50, s48
    s_waitcnt vmcnt(6)
    s_barrier
    s_add_u32 m0, s68, 122880
    s_nop 0
    buffer_load_dwordx4 v8, s[36:39], s50 offen offset:0 sc1 lds
    buffer_load_dwordx4 v13, s[36:39], s50 offen offset:1024 sc1 lds
    buffer_load_dwordx4 v14, s[36:39], s50 offen offset:2048 sc1 lds
    s_add_u32 m0, s68, 125952
    s_nop 0
    buffer_load_dwordx4 v15, s[36:39], s50 offen offset:0 sc1 lds
    buffer_load_dwordx4 v16, s[36:39], s50 offen offset:1024 sc1 lds
    buffer_load_dwordx4 v17, s[36:39], s50 offen offset:2048 sc1 lds
    s_add_u32 s50, s58, 811008
    s_cmp_ge_u32 s50, s59
    s_cselect_b32 s48, 2359296, 0
    s_sub_u32 s50, s50, s48
    s_add_u32 m0, s68, 135168
    s_nop 0
    buffer_load_dwordx4 v8, s[36:39], s50 offen offset:0 sc1 lds
    buffer_load_dwordx4 v13, s[36:39], s50 offen offset:1024 sc1 lds
    buffer_load_dwordx4 v14, s[36:39], s50 offen offset:2048 sc1 lds
    s_add_u32 m0, s68, 138240
    s_nop 0
    buffer_load_dwordx4 v15, s[36:39], s50 offen offset:0 sc1 lds
    buffer_load_dwordx4 v16, s[36:39], s50 offen offset:1024 sc1 lds
    buffer_load_dwordx4 v17, s[36:39], s50 offen offset:2048 sc1 lds
    s_add_u32 s50, s58, 884736
    s_cmp_ge_u32 s50, s59
    s_cselect_b32 s48, 2359296, 0
    s_sub_u32 s50, s50, s48
    s_cmp_lg_u32 s35, 0
    s_cbranch_scc1 L_m_58
    buffer_load_dword v53, v52, s[44:47], s8 offen
    buffer_load_dword v53, v52, s[44:47], s9 offen
L_m_58:
    s_waitcnt vmcnt(12)
    s_barrier
    s_add_u32 m0, s68, 147456
    s_nop 0
    buffer_load_dwordx4 v8, s[36:39], s50 offen offset:0 sc1 lds
    buffer_load_dwordx4 v13, s[36:39], s50 offen offset:1024 sc1 lds
    buffer_load_dwordx4 v14, s[36:39], s50 offen offset:2048 sc1 lds
    s_add_u32 m0, s68, 150528
    s_nop 0
    buffer_load_dwordx4 v15, s[36:39], s50 offen offset:0 sc1 lds
    buffer_load_dwordx4 v16, s[36:39], s50 offen offset:1024 sc1 lds
    buffer_load_dwordx4 v17, s[36:39], s50 offen offset:2048 sc1 lds
    s_add_u32 s50, s58, 958464
    s_cmp_ge_u32 s50, s59
    s_cselect_b32 s48, 2359296, 0
    s_sub_u32 s50, s50, s48
    s_cmp_lg_u32 s35, 1
    s_cbranch_scc1 L_m_59
    buffer_load_dword v53, v52, s[44:47], s8 offen
    buffer_load_dword v53, v52, s[44:47], s9 offen
L_m_59:
    s_waitcnt vmcnt(12)
    s_barrier
    s_add_u32 m0, s68, 98304
    s_nop 0
    buffer_load_dwordx4 v8, s[36:39], s50 offen offset:0 sc1 lds
    buffer_load_dwordx4 v13, s[36:39], s50 offen offset:1024 sc1 lds
    buffer_load_dwordx4 v14, s[36:39], s50 offen offset:2048 sc1 lds
    s_add_u32 m0, s68, 101376
    s_nop 0
    buffer_load_dwordx4 v15, s[36:39], s50 offen offset:0 sc1 lds
    buffer_load_dwordx4 v16, s[36:39], s50 offen offset:1024 sc1 lds
    buffer_load_dwordx4 v17, s[36:39], s50 offen offset:2048 sc1 lds
    s_add_u32 s50, s58, 0
    s_cmp_ge_u32 s50, s59
    s_cselect_b32 s48, 2359296, 0
    s_sub_u32 s50, s50, s48
    s_cmp_lg_u32 s35, 2
    s_cbranch_scc1 L_m_60
    buffer_load_dword v53, v52, s[44:47], s8 offen
    buffer_load_dword v53, v52, s[44:47], s9 offen
L_m_60:
    s_waitcnt vmcnt(12)
    s_barrier
    s_add_u32 m0, s68, 110592
    s_nop 0
    buffer_load_dwordx4 v8, s[36:39], s50 offen offset:0 sc1 lds
    buffer_load_dwordx4 v13, s[36:39], s50 offen offset:1024 sc1 lds
    buffer_load_dwordx4 v14, s[36:39], s50 offen offset:2048 sc1 lds
    s_add_u32 m0, s68, 113664
    s_nop 0
    buffer_load_dwordx4 v15, s[36:39], s50 offen offset:0 sc1 lds
    buffer_load_dwordx4 v16, s[36:39], s50 offen offset:1024 sc1 lds
    buffer_load_dwordx4 v17, s[36:39], s50 offen offset:2048 sc1 lds
    s_add_u32 s50, s58, 1032192
    s_cmp_ge_u32 s50, s59
    s_cselect_b32 s48, 2359296, 0
    s_sub_u32 s50, s50, s48
    s_cmp_lg_u32 s35, 3
    s_cbranch_scc1 L_m_61
    buffer_load_dword v53, v52, s[44:47], s8 offen
    buffer_load_dword v53, v52, s[44:47], s9 offen
L_m_61:
    s_waitcnt vmcnt(12)
    s_barrier
    s_add_u32 m0, s68, 122880
    s_nop 0
    buffer_load_dwordx4 v8, s[36:39], s50 offen offset:0 sc1 lds
    buffer_load_dwordx4 v13, s[36:39], s50 offen offset:1024 sc1 lds
    buffer_load_dwordx4 v14, s[36:39], s50 offen offset:2048 sc1 lds
    s_add_u32 m0, s68, 125952
    s_nop 0
    buffer_load_dwordx4 v15, s[36:39], s50 offen offset:0 sc1 lds
    buffer_load_dwordx4 v16, s[36:39], s50 offen offset:1024 sc1 lds
    buffer_load_dwordx4 v17, s[36:39], s50 offen offset:2048 sc1 lds
    s_add_u32 s50, s58, 1105920
    s_cmp_ge_u32 s50, s59
    s_cselect_b32 s48, 2359296, 0
    s_sub_u32 s50, s50, s48
    s_cmp_lg_u32 s35, 4
    s_cbranch_scc1 L_m_62
    buffer_load_dword v53, v52, s[44:47], s8 offen
    buffer_load_dword v53, v52, s[44:47], s9 offen
L_m_62:
    s_waitcnt vmcnt(12)
    s_barrier
    s_add_u32 m0, s68, 135168
    s_nop 0
    buffer_load_dwordx4 v8, s[36:39], s50 offen offset:0 sc1 lds
    buffer_load_dwordx4 v13, s[36:39], s50 offen offset:1024 sc1 lds
    buffer_load_dwordx4 v14, s[36:39], s50 offen offset:2048 sc1 lds
    s_add_u32 m0, s68, 138240
    s_nop 0
    buffer_load_dwordx4 v15, s[36:39], s50 offen offset:0 sc1 lds
    buffer_load_dwordx4 v16, s[36:39], s50 offen offset:1024 sc1 lds
    buffer_load_dwordx4 v17, s[36:39], s50 offen offset:2048 sc1 lds
    s_add_u32 s50, s58, 73728
    s_cmp_ge_u32 s50, s59
    s_cselect_b32 s48, 2359296, 0
    s_sub_u32 s50, s50, s48
    s_cmp_lg_u32 s35, 5
    s_cbranch_scc1 L_m_63
    buffer_load_dword v53, v52, s[44:47], s8 offen
    buffer_load_dword v53, v52, s[44:47], s9 offen
L_m_63:
    s_waitcnt vmcnt(12)
    s_barrier
    s_add_u32 m0, s68, 147456
    s_nop 0
    buffer_load_dwordx4 v8, s[36:39], s50 offen offset:0 sc1 lds
    buffer_load_dwordx4 v13, s[36:39], s50 offen offset:1024 sc1 lds
    buffer_load_dwordx4 v14, s[36:39], s50 offen offset:2048 sc1 lds
    s_add_u32 m0, s68, 150528
    s_nop 0
    buffer_load_dwordx4 v15, s[36:39], s50 offen offset:0 sc1 lds
    buffer_load_dwordx4 v16, s[36:39], s50 offen offset:1024 sc1 lds
    buffer_load_dwordx4 v17, s[36:39], s50 offen offset:2048 sc1 lds
    s_add_u32 s50, s58, 1179648
    s_cmp_ge_u32 s50, s59
    s_cselect_b32 s48, 2359296, 0
    s_sub_u32 s50, s50, s48
    s_cmp_lg_u32 s35, 6
    s_cbranch_scc1 L_m_64
    buffer_load_dword v53, v52, s[44:47], s8 offen
    buffer_load_dword v53, v52, s[44:47], s9 offen
L_m_64:
    s_waitcnt vmcnt(12)
    s_barrier
    s_add_u32 m0, s68, 98304
    s_nop 0
    buffer_load_dwordx4 v8, s[36:39], s50 offen offset:0 sc1 lds
    buffer_load_dwordx4 v13, s[36:39], s50 offen offset:1024 sc1 lds
    buffer_load_dwordx4 v14, s[36:39], s50 offen offset:2048 sc1 lds
    s_add_u32 m0, s68, 101376
    s_nop 0
    buffer_load_dwordx4 v15, s[36:39], s50 offen offset:0 sc1 lds
    buffer_load_dwordx4 v16, s[36:39], s50 offen offset:1024 sc1 lds
    buffer_load_dwordx4 v17, s[36:39], s50 offen offset:2048 sc1 lds
    s_add_u32 s50, s58, 1253376
    s_cmp_ge_u32 s50, s59
    s_cselect_b32 s48, 2359296, 0
    s_sub_u32 s50, s50, s48
    s_cmp_lg_u32 s35, 7
    s_cbranch_scc1 L_m_65
    buffer_load_dword v53, v52, s[44:47], s8 offen
    buffer_load_dword v53, v52, s[44:47], s9 offen
L_m_65:
    s_waitcnt vmcnt(12)
    s_barrier
    s_add_u32 m0, s68, 110592
    s_nop 0
    buffer_load_dwordx4 v8, s[36:39], s50 offen offset:0 sc1 lds
    buffer_load_dwordx4 v13, s[36:39], s50 offen offset:1024 sc1 lds
    buffer_load_dwordx4 v14, s[36:39], s50 offen offset:2048 sc1 lds
    s_add_u32 m0, s68, 113664
    s_nop 0
    buffer_load_dwordx4 v15, s[36:39], s50 offen offset:0 sc1 lds
    buffer_load_dwordx4 v16, s[36:39], s50 offen offset:1024 sc1 lds
    buffer_load_dwordx4 v17, s[36:39], s50 offen offset:2048 sc1 lds
    s_add_u32 s50, s58, 147456
    s_cmp_ge_u32 s50, s59
    s_cselect_b32 s48, 2359296, 0
    s_sub_u32 s50, s50, s48
    s_cmp_lg_u32 s35, 8
    s_cbranch_scc1 L_m_66
    buffer_load_dword v53, v52, s[44:47], s8 offen
    buffer_load_dword v53, v52, s[44:47], s9 offen
L_m_66:
    s_waitcnt vmcnt(12)
    s_barrier
    s_add_u32 m0, s68, 122880
    s_nop 0
    buffer_load_dwordx4 v8, s[36:39], s50 offen offset:0 sc1 lds
    buffer_load_dwordx4 v13, s[36:39], s50 offen offset:1024 sc1 lds
    s_branch L_skip_13
L_stub_13:
    s_branch L_back_a1
L_skip_13:
    buffer_load_dwordx4 v14, s[36:39], s50 offen offset:2048 sc1 lds
    s_add_u32 m0, s68, 125952
    s_nop 0
    buffer_load_dwordx4 v15, s[36:39], s50 offen offset:0 sc1 lds
    buffer_load_dwordx4 v16, s[36:39], s50 offen offset:1024 sc1 lds
    buffer_load_dwordx4 v17, s[36:39], s50 offen offset:2048 sc1 lds
    s_add_u32 s50, s58, 1327104
    s_cmp_ge_u32 s50, s59
    s_cselect_b32 s48, 2359296, 0
    s_sub_u32 s50, s50, s48
    s_cmp_lg_u32 s35, 9
    s_cbranch_scc1 L_m_67
    buffer_load_dword v53, v52, s[44:47], s8 offen
    buffer_load_dword v53, v52, s[44:47], s9 offen
L_m_67:
    s_waitcnt vmcnt(12)
    s_barrier
    s_add_u32 m0, s68, 135168
    s_nop 0
    buffer_load_dwordx4 v8, s[36:39], s50 offen offset:0 sc1 lds
    buffer_load_dwordx4 v13, s[36:39], s50 offen offset:1024 sc1 lds
    buffer_load_dwordx4 v14, s[36:39], s50 offen offset:2048 sc1 lds
    s_add_u32 m0, s68, 138240
    s_nop 0
    buffer_load_dwordx4 v15, s[36:39], s50 offen offset:0 sc1 lds
    buffer_load_dwordx4 v16, s[36:39], s50 offen offset:1024 sc1 lds
    buffer_load_dwordx4 v17, s[36:39], s50 offen offset:2048 sc1 lds
    s_add_u32 s50, s58, 1400832
    s_cmp_ge_u32 s50, s59
    s_cselect_b32 s48, 2359296, 0
    s_sub_u32 s50, s50, s48
    s_cmp_lg_u32 s35, 10
    s_cbranch_scc1 L_m_68
    buffer_load_dword v53, v52, s[44:47], s8 offen
    buffer_load_dword v53, v52, s[44:47], s9 offen
L_m_68:
    s_waitcnt vmcnt(12)
    s_barrier
    s_add_u32 m0, s68, 147456
    s_nop 0
    buffer_load_dwordx4 v8, s[36:39], s50 offen offset:0 sc1 lds
    buffer_load_dwordx4 v13, s[36:39], s50 offen offset:1024 sc1 lds
    buffer_load_dwordx4 v14, s[36:39], s50 offen offset:2048 sc1 lds
    s_add_u32 m0, s68, 150528
    s_nop 0
    buffer_load_dwordx4 v15, s[36:39], s50 offen offset:0 sc1 lds
    buffer_load_dwordx4 v16, s[36:39], s50 offen offset:1024 sc1 lds
    buffer_load_dwordx4 v17, s[36:39], s50 offen offset:2048 sc1 lds
    s_add_u32 s50, s58, 221184
    s_cmp_ge_u32 s50, s59
    s_cselect_b32 s48, 2359296, 0
    s_sub_u32 s50, s50, s48
    s_cmp_lg_u32 s35, 11
    s_cbranch_scc1 L_m_69
    buffer_load_dword v53, v52, s[44:47], s8 offen
    buffer_load_dword v53, v52, s[44:47], s9 offen
L_m_69:
    s_waitcnt vmcnt(12)
    s_barrier
    s_add_u32 m0, s68, 98304
    s_nop 0
    buffer_load_dwordx4 v8, s[36:39], s50 offen offset:0 sc1 lds
    buffer_load_dwordx4 v13, s[36:39], s50 offen offset:1024 sc1 lds
    buffer_load_dwordx4 v14, s[36:39], s50 offen offset:2048 sc1 lds
    s_add_u32 m0, s68, 101376
    s_nop 0
    buffer_load_dwordx4 v15, s[36:39], s50 offen offset:0 sc1 lds
    buffer_load_dwordx4 v16, s[36:39], s50 offen offset:1024 sc1 lds
    buffer_load_dwordx4 v17, s[36:39], s50 offen offset:2048 sc1 lds
    s_add_u32 s50, s58, 1474560
    s_cmp_ge_u32 s50, s59
    s_cselect_b32 s48, 2359296, 0
    s_sub_u32 s50, s50, s48
    s_cmp_lg_u32 s35, 12
    s_cbranch_scc1 L_m_70
    buffer_load_dword v53, v52, s[44:47], s8 offen
    buffer_load_dword v53, v52, s[44:47], s9 offen
L_m_70:
    s_waitcnt vmcnt(12)
    s_barrier
    s_add_u32 m0, s68, 110592
    s_nop 0
    buffer_load_dwordx4 v8, s[36:39], s50 offen offset:0 sc1 lds
    buffer_load_dwordx4 v13, s[36:39], s50 offen offset:1024 sc1 lds
    buffer_load_dwordx4 v14, s[36:39], s50 offen offset:2048 sc1 lds
    s_add_u32 m0, s68, 113664
    s_nop 0
    buffer_load_dwordx4 v15, s[36:39], s50 offen offset:0 sc1 lds
    buffer_load_dwordx4 v16, s[36:39], s50 offen offset:1024 sc1 lds
    buffer_load_dwordx4 v17, s[36:39], s50 offen offset:2048 sc1 lds
    s_add_u32 s50, s58, 1548288
    s_cmp_ge_u32 s50, s59
    s_cselect_b32 s48, 2359296, 0
    s_sub_u32 s50, s50, s48
    s_cmp_lg_u32 s35, 13
    s_cbranch_scc1 L_m_71
    buffer_load_dword v53, v52, s[44:47], s8 offen
    buffer_load_dword v53, v52, s[44:47], s9 offen
L_m_71:
    s_waitcnt vmcnt(12)
    s_barrier
    s_add_u32 m0, s68, 122880
    s_nop 0
    buffer_load_dwordx4 v8, s[36:39], s50 offen offset:0 sc1 lds
    buffer_load_dwordx4 v13, s[36:39], s50 offen offset:1024 sc1 lds
    buffer_load_dwordx4 v14, s[36:39], s50 offen offset:2048 sc1 lds
    s_add_u32 m0, s68, 125952
    s_nop 0
    buffer_load_dwordx4 v15, s[36:39], s50 offen offset:0 sc1 lds
    buffer_load_dwordx4 v16, s[36:39], s50 offen offset:1024 sc1 lds
    buffer_load_dwordx4 v17, s[36:39], s50 offen offset:2048 sc1 lds
    s_add_u32 s50, s58, 294912
    s_cmp_ge_u32 s50, s59
    s_cselect_b32 s48, 2359296, 0
    s_sub_u32 s50, s50, s48
    s_waitcnt vmcnt(12)
    s_barrier
    s_add_u32 m0, s68, 135168
    s_nop 0
    buffer_load_dwordx4 v8, s[36:39], s50 offen offset:0 sc1 lds
    buffer_load_dwordx4 v13, s[36:39], s50 offen offset:1024 sc1 lds
    buffer_load_dwordx4 v14, s[36:39], s50 offen offset:2048 sc1 lds
    s_add_u32 m0, s68, 138240
    s_nop 0
    buffer_load_dwordx4 v15, s[36:39], s50 offen offset:0 sc1 lds
    buffer_load_dwordx4 v16, s[36:39], s50 offen offset:1024 sc1 lds
    buffer_load_dwordx4 v17, s[36:39], s50 offen offset:2048 sc1 lds
    s_add_u32 s50, s58, 1622016
    s_cmp_ge_u32 s50, s59
    s_cselect_b32 s48, 2359296, 0
    s_sub_u32 s50, s50, s48
    s_waitcnt vmcnt(12)
    s_barrier
    s_add_u32 m0, s68, 147456
    s_nop 0
    buffer_load_dwordx4 v8, s[36:39], s50 offen offset:0 sc1 lds
    buffer_load_dwordx4 v13, s[36:39], s50 offen offset:1024 sc1 lds
    buffer_load_dwordx4 v14, s[36:39], s50 offen offset:2048 sc1 lds
    s_add_u32 m0, s68, 150528
    s_nop 0
    buffer_load_dwordx4 v15, s[36:39], s50 offen offset:0 sc1 lds
    buffer_load_dwordx4 v16, s[36:39], s50 offen offset:1024 sc1 lds
    buffer_load_dwordx4 v17, s[36:39], s50 offen offset:2048 sc1 lds
    s_add_u32 s50, s58, 1695744
    s_cmp_ge_u32 s50, s59
    s_cselect_b32 s48, 2359296, 0
    s_sub_u32 s50, s50, s48
    s_waitcnt vmcnt(12)
    s_barrier
    s_add_u32 m0, s68, 98304
    s_nop 0
    buffer_load_dwordx4 v8, s[36:39], s50 offen offset:0 sc1 lds
    buffer_load_dwordx4 v13, s[36:39], s50 offen offset:1024 sc1 lds
    buffer_load_dwordx4 v14, s[36:39], s50 offen offset:2048 sc1 lds
    s_add_u32 m0, s68, 101376
    s_nop 0
    buffer_load_dwordx4 v15, s[36:39], s50 offen offset:0 sc1 lds
    buffer_load_dwordx4 v16, s[36:39], s50 offen offset:1024 sc1 lds
    buffer_load_dwordx4 v17, s[36:39], s50 offen offset:2048 sc1 lds
    s_add_u32 s50, s58, 368640
    s_cmp_ge_u32 s50, s59
    s_cselect_b32 s48, 2359296, 0
    s_sub_u32 s50, s50, s48
    s_waitcnt vmcnt(12)
    s_barrier
    s_add_u32 m0, s68, 110592
    s_nop 0
    buffer_load_dwordx4 v8, s[36:39], s50 offen offset:0 sc1 lds
    buffer_load_dwordx4 v13, s[36:39], s50 offen offset:1024 sc1 lds
    buffer_load_dwordx4 v14, s[36:39], s50 offen offset:2048 sc1 lds
    s_add_u32 m0, s68, 113664
    s_nop 0
    buffer_load_dwordx4 v15, s[36:39], s50 offen offset:0 sc1 lds
    buffer_load_dwordx4 v16, s[36:39], s50 offen offset:1024 sc1 lds
    buffer_load_dwordx4 v17, s[36:39], s50 offen offset:2048 sc1 lds
    s_add_u32 s50, s58, 1769472
    s_cmp_ge_u32 s50, s59
    s_cselect_b32 s48, 2359296, 0
    s_sub_u32 s50, s50, s48
    s_waitcnt vmcnt(12)
    s_barrier
    s_add_u32 m0, s68, 122880
    s_nop 0
    buffer_load_dwordx4 v8, s[36:39], s50 offen offset:0 sc1 lds
    buffer_load_dwordx4 v13, s[36:39], s50 offen offset:1024 sc1 lds
    buffer_load_dwordx4 v14, s[36:39], s50 offen offset:2048 sc1 lds
    s_add_u32 m0, s68, 125952
    s_nop 0
    buffer_load_dwordx4 v15, s[36:39], s50 offen offset:0 sc1 lds
    buffer_load_dwordx4 v16, s[36:39], s50 offen offset:1024 sc1 lds
    buffer_load_dwordx4 v17, s[36:39], s50 offen offset:2048 sc1 lds
    s_add_u32 s50, s58, 1843200
    s_cmp_ge_u32 s50, s59
    s_cselect_b32 s48, 2359296, 0
    s_sub_u32 s50, s50, s48
    s_waitcnt vmcnt(12)
    s_barrier
    s_add_u32 m0, s68, 135168
    s_nop 0
    buffer_load_dwordx4 v8, s[36:39], s50 offen offset:0 sc1 lds
    buffer_load_dwordx4 v13, s[36:39], s50 offen offset:1024 sc1 lds
    buffer_load_dwordx4 v14, s[36:39], s50 offen offset:2048 sc1 lds
    s_add_u32 m0, s68, 138240
    s_nop 0
    buffer_load_dwordx4 v15, s[36:39], s50 offen offset:0 sc1 lds
    buffer_load_dwordx4 v16, s[36:39], s50 offen offset:1024 sc1 lds
    buffer_load_dwordx4 v17, s[36:39], s50 offen offset:2048 sc1 lds
    s_add_u32 s50, s58, 442368
    s_cmp_ge_u32 s50, s59
    s_cselect_b32 s48, 2359296, 0
    s_sub_u32 s50, s50, s48
    s_waitcnt vmcnt(12)
    s_barrier
    s_add_u32 m0, s68, 147456
    s_nop 0
    buffer_load_dwordx4 v8, s[36:39], s50 offen offset:0 sc1 lds
    buffer_load_dwordx4 v13, s[36:39], s50 offen offset:1024 sc1 lds
    buffer_load_dwordx4 v14, s[36:39], s50 offen offset:2048 sc1 lds
    s_add_u32 m0, s68, 150528
    s_nop 0
    buffer_load_dwordx4 v15, s[36:39], s50 offen offset:0 sc1 lds
    buffer_load_dwordx4 v16, s[36:39], s50 offen offset:1024 sc1 lds
    buffer_load_dwordx4 v17, s[36:39], s50 offen offset:2048 sc1 lds
    s_add_u32 s50, s58, 1916928
    s_cmp_ge_u32 s50, s59
    s_cselect_b32 s48, 2359296, 0
    s_sub_u32 s50, s50, s48
    s_waitcnt vmcnt(12)
    s_barrier
    s_add_u32 m0, s68, 98304
    s_nop 0
    buffer_load_dwordx4 v8, s[36:39], s50 offen offset:0 sc1 lds
    buffer_load_dwordx4 v13, s[36:39], s50 offen offset:1024 sc1 lds
    buffer_load_dwordx4 v14, s[36:39], s50 offen offset:2048 sc1 lds
    s_add_u32 m0, s68, 101376
    s_nop 0
    buffer_load_dwordx4 v15, s[36:39], s50 offen offset:0 sc1 lds
    buffer_load_dwordx4 v16, s[36:39], s50 offen offset:1024 sc1 lds
    buffer_load_dwordx4 v17, s[36:39], s50 offen offset:2048 sc1 lds
    s_add_u32 s50, s58, 1990656
    s_cmp_ge_u32 s50, s59
    s_cselect_b32 s48, 2359296, 0
    s_sub_u32 s50, s50, s48
    s_waitcnt vmcnt(12)
    s_barrier
    s_add_u32 m0, s68, 110592
    s_nop 0
    buffer_load_dwordx4 v8, s[36:39], s50 offen offset:0 sc1 lds
    buffer_load_dwordx4 v13, s[36:39], s50 offen offset:1024 sc1 lds
    buffer_load_dwordx4 v14, s[36:39], s50 offen offset:2048 sc1 lds
    s_add_u32 m0, s68, 113664
    s_nop 0
    buffer_load_dwordx4 v15, s[36:39], s50 offen offset:0 sc1 lds
    buffer_load_dwordx4 v16, s[36:39], s50 offen offset:1024 sc1 lds
    buffer_load_dwordx4 v17, s[36:39], s50 offen offset:2048 sc1 lds
    s_add_u32 s50, s58, 516096
    s_cmp_ge_u32 s50, s59
    s_cselect_b32 s48, 2359296, 0
    s_sub_u32 s50, s50, s48
    s_waitcnt vmcnt(12)
    s_barrier
    s_add_u32 m0, s68, 122880
    s_nop 0
    buffer_load_dwordx4 v8, s[36:39], s50 offen offset:0 sc1 lds
    buffer_load_dwordx4 v13, s[36:39], s50 offen offset:1024 sc1 lds
    buffer_load_dwordx4 v14, s[36:39], s50 offen offset:2048 sc1 lds
    s_add_u32 m0, s68, 125952
    s_nop 0
    buffer_load_dwordx4 v15, s[36:39], s50 offen offset:0 sc1 lds
    buffer_load_dwordx4 v16, s[36:39], s50 offen offset:1024 sc1 lds
    buffer_load_dwordx4 v17, s[36:39], s50 offen offset:2048 sc1 lds
    s_add_u32 s50, s58, 2064384
    s_cmp_ge_u32 s50, s59
    s_cselect_b32 s48, 2359296, 0
    s_sub_u32 s50, s50, s48
    s_waitcnt vmcnt(12)
    s_barrier
    s_add_u32 m0, s68, 135168
    s_nop 0
    buffer_load_dwordx4 v8, s[36:39], s50 offen offset:0 sc1 lds
    buffer_load_dwordx4 v13, s[36:39], s50 offen offset:1024 sc1 lds
    buffer_load_dwordx4 v14, s[36:39], s50 offen offset:2048 sc1 lds
    s_add_u32 m0, s68, 138240
    s_nop 0
    buffer_load_dwordx4 v15, s[36:39], s50 offen offset:0 sc1 lds
    buffer_load_dwordx4 v16, s[36:39], s50 offen offset:1024 sc1 lds
    buffer_load_dwordx4 v17, s[36:39], s50 offen offset:2048 sc1 lds
    s_add_u32 s50, s58, 2138112
    s_cmp_ge_u32 s50, s59
    s_cselect_b32 s48, 2359296, 0
    s_sub_u32 s50, s50, s48
    s_waitcnt vmcnt(12)
    s_barrier
    s_add_u32 m0, s68, 147456
    s_nop 0
    buffer_load_dwordx4 v8, s[36:39], s50 offen offset:0 sc1 lds
    buffer_load_dwordx4 v13, s[36:39], s50 offen offset:1024 sc1 lds
    buffer_load_dwordx4 v14, s[36:39], s50 offen offset:2048 sc1 lds
    s_add_u32 m0, s68, 150528
    s_nop 0
    buffer_load_dwordx4 v15, s[36:39], s50 offen offset:0 sc1 lds
    buffer_load_dwordx4 v16, s[36:39], s50 offen offset:1024 sc1 lds
    buffer_load_dwordx4 v17, s[36:39], s50 offen offset:2048 sc1 lds
    s_add_u32 s50, s58, 2211840
    s_cmp_ge_u32 s50, s59
    s_cselect_b32 s48, 2359296, 0
    s_sub_u32 s50, s50, s48
    s_waitcnt vmcnt(12)
    s_barrier
    s_add_u32 m0, s68, 98304
    s_nop 0
    buffer_load_dwordx4 v8, s[36:39], s50 offen offset:0 sc1 lds
    buffer_load_dwordx4 v13, s[36:39], s50 offen offset:1024 sc1 lds
    buffer_load_dwordx4 v14, s[36:39], s50 offen offset:2048 sc1 lds
    s_add_u32 m0, s68, 101376
    s_nop 0
    buffer_load_dwordx4 v15, s[36:39], s50 offen offset:0 sc1 lds
    buffer_load_dwordx4 v16, s[36:39], s50 offen offset:1024 sc1 lds
    buffer_load_dwordx4 v17, s[36:39], s50 offen offset:2048 sc1 lds
    s_add_u32 s50, s58, 2285568
    s_cmp_ge_u32 s50, s59
    s_cselect_b32 s48, 2359296, 0
    s_sub_u32 s50, s50, s48
    s_waitcnt vmcnt(12)
    s_barrier
    s_add_u32 m0, s68, 110592
    s_nop 0
    buffer_load_dwordx4 v8, s[36:39], s50 offen offset:0 sc1 lds
    buffer_load_dwordx4 v13, s[36:39], s50 offen offset:1024 sc1 lds
    buffer_load_dwordx4 v14, s[36:39], s50 offen offset:2048 sc1 lds
    s_add_u32 m0, s68, 113664
    s_nop 0
    buffer_load_dwordx4 v15, s[36:39], s50 offen offset:0 sc1 lds
    buffer_load_dwordx4 v16, s[36:39], s50 offen offset:1024 sc1 lds
    buffer_load_dwordx4 v17, s[36:39], s50 offen offset:2048 sc1 lds
    buffer_load_dword v68, v67, s[36:39], 0 offen sc1
    s_waitcnt vmcnt(12)
    s_barrier
    s_waitcnt vmcnt(6)
    s_barrier
    s_waitcnt vmcnt(0)
    s_barrier
    s_branch L_m_55
L_m_54:
    s_waitcnt lgkmcnt(0)
    buffer_store_dwordx4 v[28:31], v22, s[36:39], s57 offen sc1
    buffer_store_dwordx4 v[32:35], v23, s[36:39], s57 offen sc1
    buffer_store_dwordx4 v[36:39], v24, s[36:39], s57 offen sc1
    buffer_store_dwordx4 v[40:43], v25, s[36:39], s57 offen sc1
    buffer_store_dwordx4 v[44:47], v26, s[36:39], s57 offen sc1
    s_waitcnt vmcnt(0)
    s_barrier
    buffer_store_dword v3, v10, s[36:39], 0 offen sc1
    buffer_store_dwordx4 v[48:51], v54, s[36:39], 0 offen sc1
    v_add_u32 v76, 0, v0
    v_mul_u32_u24 v77, 1821, v76
    v_lshrrev_b32 v77, 18, v77
    v_mul_u32_u24 v77, 6912, v77
    v_lshl_add_u32 v77, v76, 4, v77
    v_subrev_u32 v56, 0, v77
    v_add_u32 v76, 64, v0
    v_mul_u32_u24 v77, 1821, v76
    v_lshrrev_b32 v77, 18, v77
    v_mul_u32_u24 v77, 6912, v77
    v_lshl_add_u32 v77, v76, 4, v77
    v_subrev_u32 v57, 1024, v77
    v_add_u32 v76, 128, v0
    v_mul_u32_u24 v77, 1821, v76
    v_lshrrev_b32 v77, 18, v77
    v_mul_u32_u24 v77, 6912, v77
    v_lshl_add_u32 v77, v76, 4, v77
    v_subrev_u32 v58, 2048, v77
    v_add_u32 v76, 192, v0
    v_mul_u32_u24 v77, 1821, v76
    v_lshrrev_b32 v77, 18, v77
    v_mul_u32_u24 v77, 6912, v77
    v_lshl_add_u32 v77, v76, 4, v77
    v_subrev_u32 v59, 3072, v77
    v_add_u32 v76, 256, v0
    v_mul_u32_u24 v77, 1821, v76
    v_lshrrev_b32 v77, 18, v77
    v_mul_u32_u24 v77, 6912, v77
    v_lshl_add_u32 v77, v76, 4, v77
    v_subrev_u32 v60, 0, v77
    v_add_u32 v76, 320, v0
    v_mul_u32_u24 v77, 1821, v76
    v_lshrrev_b32 v77, 18, v77
    v_mul_u32_u24 v77, 6912, v77
    v_lshl_add_u32 v77, v76, 4, v77
    v_subrev_u32 v61, 1024, v77
    v_add_u32 v76, 384, v0
    v_mul_u32_u24 v77, 1821, v76
    v_lshrrev_b32 v77, 18, v77
    v_mul_u32_u24 v77, 6912, v77
    v_lshl_add_u32 v77, v76, 4, v77
    v_subrev_u32 v62, 2048, v77
    v_add_u32 v76, 448, v0
    v_mul_u32_u24 v77, 1821, v76
    v_lshrrev_b32 v77, 18, v77
    v_mul_u32_u24 v77, 6912, v77
    v_lshl_add_u32 v77, v76, 4, v77
    v_subrev_u32 v63, 3072, v77
    v_add_u32 v76, 512, v0
    v_mul_u32_u24 v77, 1821, v76
    v_lshrrev_b32 v77, 18, v77
    v_mul_u32_u24 v77, 6912, v77
    v_lshl_add_u32 v77, v76, 4, v77
    v_subrev_u32 v64, 0, v77
    s_mul_i32 s48, s55, 3
    s_add_u32 s49, s48, 2
    s_lshr_b32 s48, s48, 1
    s_lshr_b32 s49, s49, 1
    v_mov_b32 v76, s48
    v_mov_b32 v77, s49
    v_cmp_gt_u32 vcc, 32, v0
    s_nop 1
    v_cndmask_b32 v76, v77, v76, vcc
    v_and_b32 v77, 31, v0
    v_min_u32 v77, 8, v77
    v_lshl_add_u32 v76, v76, 6, v77
    s_mul_i32 s48, s53, 9
    v_add_u32 v76, s48, v76
    v_lshlrev_b32 v66, 4, v76
    s_lshr_b32 s48, s54, 3
    s_lshl_b32 s48, s48, 2
    s_and_b32 s49, s54, 1
    s_lshl_b32 s49, s49, 1
    s_add_u32 s48, s48, s49
    s_add_u32 s48, s48, s62
    s_lshl_b32 s48, s48, 13
    s_add_u32 s48, s48, 15990784
    v_lshl_add_u32 v67, v0, 7, s48
    v_mov_b32 v68, 0
    s_lshl_b32 s48, s54, 7
    s_lshr_b32 s49, s53, 1
    s_lshl_b32 s49, s49, 4
    s_add_u32 s48, s48, s49
    s_mul_i32 s48, s48, 1152
    s_mul_i32 s49, s55, 288
    s_add_u32 s48, s48, s49
    s_and_b32 s49, s53, 1
    s_mul_i32 s49, s49, 144
    s_add_u32 s48, s48, s49
    s_add_u32 s12, s48, 12582912
    s_lshl_b32 s13, s62, 6
    v_add_u32 v76, s13, v0
    v_mul_u32_u24 v77, 911, v76
    v_lshrrev_b32 v77, 13, v77
    v_mul_u32_u24 v78, 9, v77
    v_sub_u32 v78, v76, v78
    v_and_b32 v76, 48, v77
    v_add_u32 v77, v77, v76
    v_mul_u32_u24 v77, 1152, v77
    v_lshl_add_u32 v77, v78, 4, v77
    v_add_u32 v70, s12, v77
    s_add_u32 s13, s13, 128
    v_add_u32 v76, s13, v0
    v_mul_u32_u24 v77, 911, v76
    v_lshrrev_b32 v77, 13, v77
    v_mul_u32_u24 v78, 9, v77
    v_sub_u32 v78, v76, v78
    v_and_b32 v76, 48, v77
    v_add_u32 v77, v77, v76
    v_mul_u32_u24 v77, 1152, v77
    v_lshl_add_u32 v77, v78, 4, v77
    v_add_u32 v71, s12, v77
    s_add_u32 s13, s13, 128
    v_add_u32 v76, s13, v0
    v_mul_u32_u24 v77, 911, v76
    v_lshrrev_b32 v77, 13, v77
    v_mul_u32_u24 v78, 9, v77
    v_sub_u32 v78, v76, v78
    v_and_b32 v76, 48, v77
    v_add_u32 v77, v77, v76
    v_mul_u32_u24 v77, 1152, v77
    v_lshl_add_u32 v77, v78, 4, v77
    v_add_u32 v72, s12, v77
    s_add_u32 s13, s13, 128
    v_add_u32 v76, s13, v0
    v_mul_u32_u24 v77, 911, v76
    v_lshrrev_b32 v77, 13, v77
    v_mul_u32_u24 v78, 9, v77
    v_sub_u32 v78, v76, v78
    v_and_b32 v76, 48, v77
    v_add_u32 v77, v77, v76
    v_mul_u32_u24 v77, 1152, v77
    v_lshl_add_u32 v77, v78, 4, v77
    v_add_u32 v73, s12, v77
    s_add_u32 s13, s13, 128
    v_add_u32 v76, s13, v0
    v_mul_u32_u24 v77, 911, v76
    v_lshrrev_b32 v77, 13, v77
    v_mul_u32_u24 v78, 9, v77
    v_sub_u32 v78, v76, v78
    v_and_b32 v76, 48, v77
    v_add_u32 v77, v77, v76
    v_mul_u32_u24 v77, 1152, v77
    v_lshl_add_u32 v77, v78, 4, v77
    v_add_u32 v74, s12, v77
    s_add_u32 s13, s13, 128
    s_mul_i32 s48, s55, 576
    s_and_b32 s49, s53, 1
    s_mul_i32 s49, s49, 288
    s_add_u32 s48, s48, s49
    s_add_u32 s48, s48, 11520
    v_min_u32 v76, 272, v8
    v_add_u32 v76, s48, v76
    s_cmp_eq_u32 s62, 1
    s_cselect_b64 vcc, -1, 0
    v_cndmask_b32 v74, v74, v76, vcc
    s_waitcnt vmcnt(0)
Lp_m_72:
    buffer_load_dword v4, v27, s[36:39], s65 offen sc1
    buffer_load_dword v5, v27, s[36:39], s69 offen sc1
    s_waitcnt vmcnt(0)
    v_cmp_ne_u32 vcc, v3, v4
    v_cmp_ne_u32 s[48:49], v3, v5
    s_nop 0
    s_or_b64 vcc, vcc, s[48:49]
    s_cbranch_vccz Le_m_73
    s_sub_u32 s7, s7, 1
    s_cbranch_scc1 Le_m_73
    s_mov_b64 exec, vcc
    s_sleep 1
    s_branch Lp_m_72
Le_m_73:
    s_mov_b64 exec, -1
    s_max_i32 s7, s7, 0
L_m_55:
    s_mul_i32 s67, s55, 2304
    s_mul_i32 s48, s53, 1327104
    s_add_u32 s67, s67, s48
    s_mul_i32 s48, s62, 36864
    s_add_u32 s67, s67, s48
    s_add_u32 s67, s67, 20971520
    s_mul_i32 s57, s62, 9216
    s_add_u32 s48, s57, 90112
    v_add_u32 v85, s48, v8
    v_add_u32 v90, 73728, v85
    s_mul_i32 s58, s64, 73728
    s_add_u32 s58, s58, s67
    s_add_u32 s59, s67, 1327104
    s_waitcnt vmcnt(0)
    v_cmp_ne_u32 vcc, v3, v68
    s_nop 0
    s_cbranch_vccz L_m_74
Lp_m_75:
    buffer_load_dword v68, v67, s[36:39], 0 offen sc1
    s_waitcnt vmcnt(0)
    v_cmp_ne_u32 vcc, v3, v68
    s_nop 0
    s_cbranch_vccz Le_m_76
    s_sub_u32 s7, s7, 1
    s_cbranch_scc1 Le_m_76
    s_mov_b64 exec, vcc
    s_sleep 1
    s_branch Lp_m_75
Le_m_76:
    s_mov_b64 exec, -1
    s_max_i32 s7, s7, 0
L_m_74:
    v_lshrrev_b32 v52, 4, v0
    v_and_b32 v53, 15, v0
    v_lshlrev_b32 v52, 12, v52
    v_lshl_add_u32 v52, v53, 7, v52
    s_lshr_b32 s48, s4, 1
    s_mul_i32 s48, s48, 4718592
    s_and_b32 s49, s4, 1
    s_lshl_b32 s49, s49, 11
    s_add_u32 s48, s48, s49
    v_add_u32 v52, s48, v52
    s_mov_b32 s35, 0
    s_mov_b32 s49, s35
    s_mul_i32 s48, s62, 1
    s_add_u32 s49, s49, s48
    s_bfm_b32 s48, s5, 0
    s_and_b32 s48, s48, 0
    s_bcnt1_i32_b32 s48, s48
    s_sub_u32 s12, s5, s48
    s_mul_i32 s35, s12, 3
    s_add_u32 s35, s35, 192
    s_add_u32 s35, s35, s49
    s_min_u32 s35, s35, 287
    s_lshl_b32 s8, s35, 14
    s_mul_i32 s35, s12, 3
    s_add_u32 s35, s35, 194
    s_sub_u32 s35, s35, s62
    s_sub_u32 s35, s35, s62
    s_add_u32 s35, s35, s49
    s_min_u32 s35, s35, 287
    s_lshl_b32 s9, s35, 14
    s_mul_i32 s35, s12, 64
    s_lshr_b32 s35, s35, 8
    s_add_u32 s35, s35, 0
    s_mul_i32 s48, s62, 0
    s_add_u32 s35, s35, s48
    s_mov_b32 s48, 0
    s_bitcmp1_b32 s48, s5
    s_cselect_b32 s35, 999, s35
    s_barrier
    s_branch L_stub_14
L_back_a2:
    s_barrier
    s_barrier
    s_barrier
    s_cmp_ge_u32 s5, 27
    s_cbranch_scc1 L_m_77
    buffer_store_dword v3, v11, s[36:39], 0 offen sc1
    s_branch L_m_78
L_m_77:
    s_lshl_b32 s50, s2, 7
    s_add_u32 s50, s50, 622592
    v_mov_b32 v28, 0
Lp_m_79:
    buffer_load_dword v29, v28, s[36:39], s50 offen sc1
    s_waitcnt vmcnt(0)
    v_cmp_ne_u32 vcc, v3, v29
    s_nop 0
    s_cbranch_vccz Le_m_80
    s_sub_u32 s7, s7, 1
    s_cbranch_scc1 Le_m_80
    s_sleep 4
    s_branch Lp_m_79
Le_m_80:
    s_max_i32 s7, s7, 0
L_m_78:
    s_add_u32 s50, s58, 442368
    s_cmp_ge_u32 s50, s59
    s_cselect_b32 s48, 1327104, 0
    s_sub_u32 s50, s50, s48
    s_add_u32 m0, s57, 90112
    s_nop 0
    buffer_load_dwordx4 v56, s[36:39], s50 offen offset:0 sc1 lds
    buffer_load_dwordx4 v57, s[36:39], s50 offen offset:1024 sc1 lds
    buffer_load_dwordx4 v58, s[36:39], s50 offen offset:2048 sc1 lds
    buffer_load_dwordx4 v59, s[36:39], s50 offen offset:3072 sc1 lds
    s_add_u32 m0, s57, 94208
    s_nop 0
    buffer_load_dwordx4 v60, s[36:39], s50 offen offset:0 sc1 lds
    buffer_load_dwordx4 v61, s[36:39], s50 offen offset:1024 sc1 lds
    buffer_load_dwordx4 v62, s[36:39], s50 offen offset:2048 sc1 lds
    buffer_load_dwordx4 v63, s[36:39], s50 offen offset:3072 sc1 lds
    s_add_u32 m0, s57, 98304
    s_nop 0
    buffer_load_dwordx4 v64, s[36:39], s50 offen offset:0 sc1 lds
    s_add_u32 s50, s58, 516096
    s_cmp_ge_u32 s50, s59
    s_cselect_b32 s48, 1327104, 0
    s_sub_u32 s50, s50, s48
    s_add_u32 m0, s57, 108544
    s_nop 0
    buffer_load_dwordx4 v56, s[36:39], s50 offen offset:0 sc1 lds
    buffer_load_dwordx4 v57, s[36:39], s50 offen offset:1024 sc1 lds
    buffer_load_dwordx4 v58, s[36:39], s50 offen offset:2048 sc1 lds
    buffer_load_dwordx4 v59, s[36:39], s50 offen offset:3072 sc1 lds
    s_add_u32 m0, s57, 112640
    s_nop 0
    buffer_load_dwordx4 v60, s[36:39], s50 offen offset:0 sc1 lds
    buffer_load_dwordx4 v61, s[36:39], s50 offen offset:1024 sc1 lds
    buffer_load_dwordx4 v62, s[36:39], s50 offen offset:2048 sc1 lds
    buffer_load_dwordx4 v63, s[36:39], s50 offen offset:3072 sc1 lds
    s_add_u32 m0, s57, 116736
    s_nop 0
    buffer_load_dwordx4 v64, s[36:39], s50 offen offset:0 sc1 lds
    s_add_u32 s50, s58, 589824
    s_cmp_ge_u32 s50, s59
    s_cselect_b32 s48, 1327104, 0
    s_sub_u32 s50, s50, s48
    s_add_u32 m0, s57, 126976
    s_nop 0
    buffer_load_dwordx4 v56, s[36:39], s50 offen offset:0 sc1 lds
    buffer_load_dwordx4 v57, s[36:39], s50 offen offset:1024 sc1 lds
    buffer_load_dwordx4 v58, s[36:39], s50 offen offset:2048 sc1 lds
    buffer_load_dwordx4 v59, s[36:39], s50 offen offset:3072 sc1 lds
    s_add_u32 m0, s57, 131072
    s_nop 0
    buffer_load_dwordx4 v60, s[36:39], s50 offen offset:0 sc1 lds
    buffer_load_dwordx4 v61, s[36:39], s50 offen offset:1024 sc1 lds
    buffer_load_dwordx4 v62, s[36:39], s50 offen offset:2048 sc1 lds
    buffer_load_dwordx4 v63, s[36:39], s50 offen offset:3072 sc1 lds
    s_add_u32 m0, s57, 135168
    s_nop 0
    buffer_load_dwordx4 v64, s[36:39], s50 offen offset:0 sc1 lds
    s_add_u32 s50, s58, 663552
    s_cmp_ge_u32 s50, s59
    s_cselect_b32 s48, 1327104, 0
    s_sub_u32 s50, s50, s48
    s_waitcnt vmcnt(18)
L_m_81:
    s_branch L_skip_14
L_stub_14:
    s_branch L_back_a2
L_skip_14:
    ds_read_b32 v76, v85 offset:0
    ds_read_b32 v77, v85 offset:1024
    ds_read_b32 v78, v85 offset:2048
    ds_read_b32 v79, v85 offset:3072
    ds_read_b32 v80, v85 offset:4096
    ds_read_b32 v81, v85 offset:5120
    ds_read_b32 v82, v85 offset:6144
    ds_read_b32 v83, v85 offset:7168
    ds_read_b32 v84, v85 offset:8192
    s_waitcnt lgkmcnt(6)
    v_max3_u32 v76, v76, v77, v78
    s_waitcnt lgkmcnt(4)
    v_max3_u32 v76, v76, v79, v80
    s_waitcnt lgkmcnt(2)
    v_max3_u32 v76, v76, v81, v82
    s_waitcnt lgkmcnt(0)
    v_max3_u32 v76, v76, v83, v84
    v_cmp_eq_u32 vcc, -1, v76
    s_nop 0
    s_cbranch_vccz L_m_82
    s_sub_u32 s7, s7, 1
    s_cbranch_scc1 L_m_82
    s_mov_b32 s14, m0
    s_sleep 2
    s_add_u32 s15, s58, 442368
    s_cmp_ge_u32 s15, s59
    s_cselect_b32 s48, 1327104, 0
    s_sub_u32 s15, s15, s48
    s_add_u32 m0, s57, 90112
    s_nop 0
    buffer_load_dwordx4 v56, s[36:39], s15 offen offset:0 sc1 lds
    buffer_load_dwordx4 v57, s[36:39], s15 offen offset:1024 sc1 lds
    buffer_load_dwordx4 v58, s[36:39], s15 offen offset:2048 sc1 lds
    buffer_load_dwordx4 v59, s[36:39], s15 offen offset:3072 sc1 lds
    s_add_u32 m0, s57, 94208
    s_nop 0
    buffer_load_dwordx4 v60, s[36:39], s15 offen offset:0 sc1 lds
    buffer_load_dwordx4 v61, s[36:39], s15 offen offset:1024 sc1 lds
    buffer_load_dwordx4 v62, s[36:39], s15 offen offset:2048 sc1 lds
    buffer_load_dwordx4 v63, s[36:39], s15 offen offset:3072 sc1 lds
    s_add_u32 m0, s57, 98304
    s_nop 0
    buffer_load_dwordx4 v64, s[36:39], s15 offen offset:0 sc1 lds
    s_mov_b32 m0, s14
    s_waitcnt vmcnt(0)
    s_branch L_m_81
L_m_82:
    s_max_i32 s7, s7, 0
    s_barrier
    s_add_u32 m0, s57, 145408
    s_nop 0
    buffer_load_dwordx4 v56, s[36:39], s50 offen offset:0 sc1 lds
    buffer_load_dwordx4 v57, s[36:39], s50 offen offset:1024 sc1 lds
    buffer_load_dwordx4 v58, s[36:39], s50 offen offset:2048 sc1 lds
    buffer_load_dwordx4 v59, s[36:39], s50 offen offset:3072 sc1 lds
    s_add_u32 m0, s57, 149504
    s_nop 0
    buffer_load_dwordx4 v60, s[36:39], s50 offen offset:0 sc1 lds
    buffer_load_dwordx4 v61, s[36:39], s50 offen offset:1024 sc1 lds
    buffer_load_dwordx4 v62, s[36:39], s50 offen offset:2048 sc1 lds
    buffer_load_dwordx4 v63, s[36:39], s50 offen offset:3072 sc1 lds
    s_add_u32 m0, s57, 153600
    s_nop 0
    buffer_load_dwordx4 v64, s[36:39], s50 offen offset:0 sc1 lds
    s_add_u32 s50, s58, 0
    s_cmp_ge_u32 s50, s59
    s_cselect_b32 s48, 1327104, 0
    s_sub_u32 s50, s50, s48
    s_cmp_lg_u32 s35, 0
    s_cbranch_scc1 L_m_83
    buffer_load_dword v53, v52, s[44:47], s8 offen
    s_cmp_lg_u32 s62, 0
    s_cbranch_scc1 L_m_83
    buffer_load_dword v53, v52, s[44:47], s9 offen
L_m_83:
    s_waitcnt vmcnt(18)
L_m_84:
    ds_read_b32 v76, v85 offset:18432
    ds_read_b32 v77, v85 offset:19456
    ds_read_b32 v78, v85 offset:20480
    ds_read_b32 v79, v85 offset:21504
    ds_read_b32 v80, v85 offset:22528
    ds_read_b32 v81, v85 offset:23552
    ds_read_b32 v82, v85 offset:24576
    ds_read_b32 v83, v85 offset:25600
    ds_read_b32 v84, v85 offset:26624
    s_waitcnt lgkmcnt(6)
    v_max3_u32 v76, v76, v77, v78
    s_waitcnt lgkmcnt(4)
    v_max3_u32 v76, v76, v79, v80
    s_waitcnt lgkmcnt(2)
    v_max3_u32 v76, v76, v81, v82
    s_waitcnt lgkmcnt(0)
    v_max3_u32 v76, v76, v83, v84
    v_cmp_eq_u32 vcc, -1, v76
    s_nop 0
    s_cbranch_vccz L_m_85
    s_sub_u32 s7, s7, 1
    s_cbranch_scc1 L_m_85
    s_mov_b32 s14, m0
    s_sleep 2
    s_add_u32 s15, s58, 516096
    s_cmp_ge_u32 s15, s59
    s_cselect_b32 s48, 1327104, 0
    s_sub_u32 s15, s15, s48
    s_add_u32 m0, s57, 108544
    s_nop 0
    buffer_load_dwordx4 v56, s[36:39], s15 offen offset:0 sc1 lds
    buffer_load_dwordx4 v57, s[36:39], s15 offen offset:1024 sc1 lds
    buffer_load_dwordx4 v58, s[36:39], s15 offen offset:2048 sc1 lds
    buffer_load_dwordx4 v59, s[36:39], s15 offen offset:3072 sc1 lds
    s_add_u32 m0, s57, 112640
    s_nop 0
    buffer_load_dwordx4 v60, s[36:39], s15 offen offset:0 sc1 lds
    buffer_load_dwordx4 v61, s[36:39], s15 offen offset:1024 sc1 lds
    buffer_load_dwordx4 v62, s[36:39], s15 offen offset:2048 sc1 lds
    buffer_load_dwordx4 v63, s[36:39], s15 offen offset:3072 sc1 lds
    s_add_u32 m0, s57, 116736
    s_nop 0
    buffer_load_dwordx4 v64, s[36:39], s15 offen offset:0 sc1 lds
    s_mov_b32 m0, s14
    s_waitcnt vmcnt(0)
    s_branch L_m_84
L_m_85:
    s_max_i32 s7, s7, 0
    s_barrier
    buffer_load_dword v28, v66, s[36:39], s66 offen sc1
    s_cmp_lg_u32 s35, 1
    s_cbranch_scc1 L_m_86
    buffer_load_dword v53, v52, s[44:47], s8 offen
    s_cmp_lg_u32 s62, 0
    s_cbranch_scc1 L_m_86
    buffer_load_dword v53, v52, s[44:47], s9 offen
L_m_86:
    s_waitcnt vmcnt(10)
L_m_87:
    ds_read_b32 v76, v85 offset:36864
    ds_read_b32 v77, v85 offset:37888
    ds_read_b32 v78, v85 offset:38912
    ds_read_b32 v79, v85 offset:39936
    ds_read_b32 v80, v85 offset:40960
    ds_read_b32 v81, v85 offset:41984
    ds_read_b32 v82, v85 offset:43008
    ds_read_b32 v83, v85 offset:44032
    ds_read_b32 v84, v85 offset:45056
    s_waitcnt lgkmcnt(6)
    v_max3_u32 v76, v76, v77, v78
    s_waitcnt lgkmcnt(4)
    v_max3_u32 v76, v76, v79, v80
    s_waitcnt lgkmcnt(2)
    v_max3_u32 v76, v76, v81, v82
    s_waitcnt lgkmcnt(0)
    v_max3_u32 v76, v76, v83, v84
    v_cmp_eq_u32 vcc, -1, v76
    s_nop 0
    s_cbranch_vccz L_m_88
    s_sub_u32 s7, s7, 1
    s_cbranch_scc1 L_m_88
    s_mov_b32 s14, m0
    s_sleep 2
    s_add_u32 s15, s58, 589824
    s_cmp_ge_u32 s15, s59
    s_cselect_b32 s48, 1327104, 0
    s_sub_u32 s15, s15, s48
    s_add_u32 m0, s57, 126976
    s_nop 0
    buffer_load_dwordx4 v56, s[36:39], s15 offen offset:0 sc1 lds
    buffer_load_dwordx4 v57, s[36:39], s15 offen offset:1024 sc1 lds
    buffer_load_dwordx4 v58, s[36:39], s15 offen offset:2048 sc1 lds
    buffer_load_dwordx4 v59, s[36:39], s15 offen offset:3072 sc1 lds
    s_add_u32 m0, s57, 131072
    s_nop 0
    buffer_load_dwordx4 v60, s[36:39], s15 offen offset:0 sc1 lds
    buffer_load_dwordx4 v61, s[36:39], s15 offen offset:1024 sc1 lds
    buffer_load_dwordx4 v62, s[36:39], s15 offen offset:2048 sc1 lds
    buffer_load_dwordx4 v63, s[36:39], s15 offen offset:3072 sc1 lds
    s_add_u32 m0, s57, 135168
    s_nop 0
    buffer_load_dwordx4 v64, s[36:39], s15 offen offset:0 sc1 lds
    s_mov_b32 m0, s14
    s_waitcnt vmcnt(0)
    s_branch L_m_87
L_m_88:
    s_max_i32 s7, s7, 0
    s_barrier
    s_waitcnt vmcnt(0)
    v_cmp_ne_u32 vcc, v3, v28
    s_nop 0
    s_cbranch_vccz L_m_89
Lp_m_90:
    buffer_load_dword v28, v66, s[36:39], s66 offen sc1
    s_waitcnt vmcnt(0)
    v_cmp_ne_u32 vcc, v3, v28
    s_nop 0
    s_cbranch_vccz Le_m_91
    s_sub_u32 s7, s7, 1
    s_cbranch_scc1 Le_m_91
    s_mov_b64 exec, vcc
    s_sleep 1
    s_branch Lp_m_90
Le_m_91:
    s_mov_b64 exec, -1
    s_max_i32 s7, s7, 0
L_m_89:
    s_add_u32 m0, s57, 90112
    s_nop 0
    buffer_load_dwordx4 v56, s[36:39], s50 offen offset:0 sc1 lds
    buffer_load_dwordx4 v57, s[36:39], s50 offen offset:1024 sc1 lds
    buffer_load_dwordx4 v58, s[36:39], s50 offen offset:2048 sc1 lds
    buffer_load_dwordx4 v59, s[36:39], s50 offen offset:3072 sc1 lds
    s_add_u32 m0, s57, 94208
    s_nop 0
    buffer_load_dwordx4 v60, s[36:39], s50 offen offset:0 sc1 lds
    buffer_load_dwordx4 v61, s[36:39], s50 offen offset:1024 sc1 lds
    buffer_load_dwordx4 v62, s[36:39], s50 offen offset:2048 sc1 lds
    buffer_load_dwordx4 v63, s[36:39], s50 offen offset:3072 sc1 lds
    s_add_u32 m0, s57, 98304
    s_nop 0
    buffer_load_dwordx4 v64, s[36:39], s50 offen offset:0 sc1 lds
    s_add_u32 s50, s58, 737280
    s_cmp_ge_u32 s50, s59
    s_cselect_b32 s48, 1327104, 0
    s_sub_u32 s50, s50, s48
    s_cmp_lg_u32 s35, 2
    s_cbranch_scc1 L_m_92
    buffer_load_dword v53, v52, s[44:47], s8 offen
    s_cmp_lg_u32 s62, 0
    s_cbranch_scc1 L_m_92
    buffer_load_dword v53, v52, s[44:47], s9 offen
L_m_92:
    s_waitcnt vmcnt(10)
L_m_93:
    ds_read_b32 v76, v85 offset:55296
    ds_read_b32 v77, v85 offset:56320
    ds_read_b32 v78, v85 offset:57344
    ds_read_b32 v79, v85 offset:58368
    ds_read_b32 v80, v85 offset:59392
    ds_read_b32 v81, v85 offset:60416
    ds_read_b32 v82, v85 offset:61440
    ds_read_b32 v83, v85 offset:62464
    ds_read_b32 v84, v85 offset:63488
    s_waitcnt lgkmcnt(6)
    v_max3_u32 v76, v76, v77, v78
    s_waitcnt lgkmcnt(4)
    v_max3_u32 v76, v76, v79, v80
    s_waitcnt lgkmcnt(2)
    v_max3_u32 v76, v76, v81, v82
    s_waitcnt lgkmcnt(0)
    v_max3_u32 v76, v76, v83, v84
    v_cmp_eq_u32 vcc, -1, v76
    s_nop 0
    s_cbranch_vccz L_m_94
    s_sub_u32 s7, s7, 1
    s_cbranch_scc1 L_m_94
    s_mov_b32 s14, m0
    s_sleep 2
    s_add_u32 s15, s58, 663552
    s_cmp_ge_u32 s15, s59
    s_cselect_b32 s48, 1327104, 0
    s_sub_u32 s15, s15, s48
    s_add_u32 m0, s57, 145408
    s_nop 0
    buffer_load_dwordx4 v56, s[36:39], s15 offen offset:0 sc1 lds
    buffer_load_dwordx4 v57, s[36:39], s15 offen offset:1024 sc1 lds
    buffer_load_dwordx4 v58, s[36:39], s15 offen offset:2048 sc1 lds
    buffer_load_dwordx4 v59, s[36:39], s15 offen offset:3072 sc1 lds
    s_add_u32 m0, s57, 149504
    s_nop 0
    buffer_load_dwordx4 v60, s[36:39], s15 offen offset:0 sc1 lds
    buffer_load_dwordx4 v61, s[36:39], s15 offen offset:1024 sc1 lds
    buffer_load_dwordx4 v62, s[36:39], s15 offen offset:2048 sc1 lds
    buffer_load_dwordx4 v63, s[36:39], s15 offen offset:3072 sc1 lds
    s_add_u32 m0, s57, 153600
    s_nop 0
    buffer_load_dwordx4 v64, s[36:39], s15 offen offset:0 sc1 lds
    s_mov_b32 m0, s14
    s_waitcnt vmcnt(0)
    s_branch L_m_93
L_m_94:
    s_max_i32 s7, s7, 0
    s_barrier
    s_add_u32 m0, s57, 108544
    s_nop 0
    buffer_load_dwordx4 v56, s[36:39], s50 offen offset:0 sc1 lds
    buffer_load_dwordx4 v57, s[36:39], s50 offen offset:1024 sc1 lds
    buffer_load_dwordx4 v58, s[36:39], s50 offen offset:2048 sc1 lds
    buffer_load_dwordx4 v59, s[36:39], s50 offen offset:3072 sc1 lds
    s_add_u32 m0, s57, 112640
    s_nop 0
    buffer_load_dwordx4 v60, s[36:39], s50 offen offset:0 sc1 lds
    buffer_load_dwordx4 v61, s[36:39], s50 offen offset:1024 sc1 lds
    buffer_load_dwordx4 v62, s[36:39], s50 offen offset:2048 sc1 lds
    buffer_load_dwordx4 v63, s[36:39], s50 offen offset:3072 sc1 lds
    s_add_u32 m0, s57, 116736
    s_nop 0
    buffer_load_dwordx4 v64, s[36:39], s50 offen offset:0 sc1 lds
    s_add_u32 s50, s58, 73728
    s_cmp_ge_u32 s50, s59
    s_cselect_b32 s48, 1327104, 0
    s_sub_u32 s50, s50, s48
    s_cmp_lg_u32 s35, 3
    s_cbranch_scc1 L_m_95
    buffer_load_dword v53, v52, s[44:47], s8 offen
    s_cmp_lg_u32 s62, 0
    s_cbranch_scc1 L_m_95
    buffer_load_dword v53, v52, s[44:47], s9 offen
L_m_95:
    s_waitcnt vmcnt(9)
    s_barrier
    s_add_u32 m0, s57, 126976
    s_nop 0
    buffer_load_dwordx4 v56, s[36:39], s50 offen offset:0 sc1 lds
    buffer_load_dwordx4 v57, s[36:39], s50 offen offset:1024 sc1 lds
    buffer_load_dwordx4 v58, s[36:39], s50 offen offset:2048 sc1 lds
    buffer_load_dwordx4 v59, s[36:39], s50 offen offset:3072 sc1 lds
    s_add_u32 m0, s57, 131072
    s_nop 0
    buffer_load_dwordx4 v60, s[36:39], s50 offen offset:0 sc1 lds
    buffer_load_dwordx4 v61, s[36:39], s50 offen offset:1024 sc1 lds
    buffer_load_dwordx4 v62, s[36:39], s50 offen offset:2048 sc1 lds
    buffer_load_dwordx4 v63, s[36:39], s50 offen offset:3072 sc1 lds
    s_add_u32 m0, s57, 135168
    s_nop 0
    buffer_load_dwordx4 v64, s[36:39], s50 offen offset:0 sc1 lds
    s_add_u32 s50, s58, 811008
    s_cmp_ge_u32 s50, s59
    s_cselect_b32 s48, 1327104, 0
    s_sub_u32 s50, s50, s48
    s_cmp_lg_u32 s35, 4
    s_cbranch_scc1 L_m_96
    buffer_load_dword v53, v52, s[44:47], s8 offen
    s_cmp_lg_u32 s62, 0
    s_cbranch_scc1 L_m_96
    buffer_load_dword v53, v52, s[44:47], s9 offen
L_m_96:
    s_waitcnt vmcnt(9)
    s_barrier
    s_add_u32 m0, s57, 145408
    s_nop 0
    buffer_load_dwordx4 v56, s[36:39], s50 offen offset:0 sc1 lds
    buffer_load_dwordx4 v57, s[36:39], s50 offen offset:1024 sc1 lds
    buffer_load_dwordx4 v58, s[36:39], s50 offen offset:2048 sc1 lds
    buffer_load_dwordx4 v59, s[36:39], s50 offen offset:3072 sc1 lds
    s_add_u32 m0, s57, 149504
    s_nop 0
    buffer_load_dwordx4 v60, s[36:39], s50 offen offset:0 sc1 lds
    buffer_load_dwordx4 v61, s[36:39], s50 offen offset:1024 sc1 lds
    buffer_load_dwordx4 v62, s[36:39], s50 offen offset:2048 sc1 lds
    buffer_load_dwordx4 v63, s[36:39], s50 offen offset:3072 sc1 lds
    s_add_u32 m0, s57, 153600
    s_nop 0
    buffer_load_dwordx4 v64, s[36:39], s50 offen offset:0 sc1 lds
    s_add_u32 s50, s58, 147456
    s_cmp_ge_u32 s50, s59
    s_cselect_b32 s48, 1327104, 0
    s_sub_u32 s50, s50, s48
    s_cmp_lg_u32 s35, 5
    s_cbranch_scc1 L_m_97
    buffer_load_dword v53, v52, s[44:47], s8 offen
    s_cmp_lg_u32 s62, 0
    s_cbranch_scc1 L_m_97
    buffer_load_dword v53, v52, s[44:47], s9 offen
L_m_97:
    s_waitcnt vmcnt(9)
    s_barrier
    s_add_u32 m0, s57, 90112
    s_nop 0
    buffer_load_dwordx4 v56, s[36:39], s50 offen offset:0 sc1 lds
    buffer_load_dwordx4 v57, s[36:39], s50 offen offset:1024 sc1 lds
    buffer_load_dwordx4 v58, s[36:39], s50 offen offset:2048 sc1 lds
    buffer_load_dwordx4 v59, s[36:39], s50 offen offset:3072 sc1 lds
    s_add_u32 m0, s57, 94208
    s_nop 0
    buffer_load_dwordx4 v60, s[36:39], s50 offen offset:0 sc1 lds
    buffer_load_dwordx4 v61, s[36:39], s50 offen offset:1024 sc1 lds
    buffer_load_dwordx4 v62, s[36:39], s50 offen offset:2048 sc1 lds
    buffer_load_dwordx4 v63, s[36:39], s50 offen offset:3072 sc1 lds
    s_add_u32 m0, s57, 98304
    s_nop 0
    buffer_load_dwordx4 v64, s[36:39], s50 offen offset:0 sc1 lds
    s_add_u32 s50, s58, 884736
    s_cmp_ge_u32 s50, s59
    s_cselect_b32 s48, 1327104, 0
    s_sub_u32 s50, s50, s48
    s_cmp_lg_u32 s35, 6
    s_cbranch_scc1 L_m_98
    buffer_load_dword v53, v52, s[44:47], s8 offen
    s_cmp_lg_u32 s62, 0
    s_cbranch_scc1 L_m_98
    buffer_load_dword v53, v52, s[44:47], s9 offen
L_m_98:
    s_waitcnt vmcnt(9)
    s_barrier
    s_add_u32 m0, s57, 108544
    s_nop 0
    buffer_load_dwordx4 v56, s[36:39], s50 offen offset:0 sc1 lds
    buffer_load_dwordx4 v57, s[36:39], s50 offen offset:1024 sc1 lds
    buffer_load_dwordx4 v58, s[36:39], s50 offen offset:2048 sc1 lds
    buffer_load_dwordx4 v59, s[36:39], s50 offen offset:3072 sc1 lds
    s_add_u32 m0, s57, 112640
    s_nop 0
    buffer_load_dwordx4 v60, s[36:39], s50 offen offset:0 sc1 lds
    buffer_load_dwordx4 v61, s[36:39], s50 offen offset:1024 sc1 lds
    buffer_load_dwordx4 v62, s[36:39], s50 offen offset:2048 sc1 lds
    buffer_load_dwordx4 v63, s[36:39], s50 offen offset:3072 sc1 lds
    s_add_u32 m0, s57, 116736
    s_nop 0
    buffer_load_dwordx4 v64, s[36:39], s50 offen offset:0 sc1 lds
    s_add_u32 s50, s58, 221184
    s_cmp_ge_u32 s50, s59
    s_cselect_b32 s48, 1327104, 0
    s_sub_u32 s50, s50, s48
    s_cmp_lg_u32 s35, 7
    s_cbranch_scc1 L_m_99
    buffer_load_dword v53, v52, s[44:47], s8 offen
    s_cmp_lg_u32 s62, 0
    s_cbranch_scc1 L_m_99
    buffer_load_dword v53, v52, s[44:47], s9 offen
L_m_99:
    s_waitcnt vmcnt(9)
    s_barrier
    s_add_u32 m0, s57, 126976
    s_nop 0
    buffer_load_dwordx4 v56, s[36:39], s50 offen offset:0 sc1 lds
    buffer_load_dwordx4 v57, s[36:39], s50 offen offset:1024 sc1 lds
    buffer_load_dwordx4 v58, s[36:39], s50 offen offset:2048 sc1 lds
    buffer_load_dwordx4 v59, s[36:39], s50 offen offset:3072 sc1 lds
    s_add_u32 m0, s57, 131072
    s_nop 0
    buffer_load_dwordx4 v60, s[36:39], s50 offen offset:0 sc1 lds
    buffer_load_dwordx4 v61, s[36:39], s50 offen offset:1024 sc1 lds
    buffer_load_dwordx4 v62, s[36:39], s50 offen offset:2048 sc1 lds
    buffer_load_dwordx4 v63, s[36:39], s50 offen offset:3072 sc1 lds
    s_add_u32 m0, s57, 135168
    s_nop 0
    buffer_load_dwordx4 v64, s[36:39], s50 offen offset:0 sc1 lds
    s_add_u32 s50, s58, 294912
    s_cmp_ge_u32 s50, s59
    s_cselect_b32 s48, 1327104, 0
    s_sub_u32 s50, s50, s48
    s_waitcnt vmcnt(9)
    s_barrier
    s_add_u32 m0, s57, 145408
    s_nop 0
    buffer_load_dwordx4 v56, s[36:39], s50 offen offset:0 sc1 lds
    buffer_load_dwordx4 v57, s[36:39], s50 offen offset:1024 sc1 lds
    buffer_load_dwordx4 v58, s[36:39], s50 offen offset:2048 sc1 lds
    buffer_load_dwordx4 v59, s[36:39], s50 offen offset:3072 sc1 lds
    s_add_u32 m0, s57, 149504
    s_nop 0
    buffer_load_dwordx4 v60, s[36:39], s50 offen offset:0 sc1 lds
    buffer_load_dwordx4 v61, s[36:39], s50 offen offset:1024 sc1 lds
    buffer_load_dwordx4 v62, s[36:39], s50 offen offset:2048 sc1 lds
    buffer_load_dwordx4 v63, s[36:39], s50 offen offset:3072 sc1 lds
    s_add_u32 m0, s57, 153600
    s_nop 0
    buffer_load_dwordx4 v64, s[36:39], s50 offen offset:0 sc1 lds
    s_add_u32 s50, s58, 368640
    s_cmp_ge_u32 s50, s59
    s_cselect_b32 s48, 1327104, 0
    s_sub_u32 s50, s50, s48
    s_waitcnt vmcnt(9)
    s_barrier
    s_add_u32 m0, s57, 90112
    s_nop 0
    buffer_load_dwordx4 v56, s[36:39], s50 offen offset:0 sc1 lds
    buffer_load_dwordx4 v57, s[36:39], s50 offen offset:1024 sc1 lds
    buffer_load_dwordx4 v58, s[36:39], s50 offen offset:2048 sc1 lds
    buffer_load_dwordx4 v59, s[36:39], s50 offen offset:3072 sc1 lds
    s_add_u32 m0, s57, 94208
    s_nop 0
    buffer_load_dwordx4 v60, s[36:39], s50 offen offset:0 sc1 lds
    buffer_load_dwordx4 v61, s[36:39], s50 offen offset:1024 sc1 lds
    buffer_load_dwordx4 v62, s[36:39], s50 offen offset:2048 sc1 lds
    buffer_load_dwordx4 v63, s[36:39], s50 offen offset:3072 sc1 lds
    s_add_u32 m0, s57, 98304
    s_nop 0
    buffer_load_dwordx4 v64, s[36:39], s50 offen offset:0 sc1 lds
    s_add_u32 s50, s58, 958464
    s_cmp_ge_u32 s50, s59
    s_cselect_b32 s48, 1327104, 0
    s_sub_u32 s50, s50, s48
    s_waitcnt vmcnt(9)
    s_barrier
    s_add_u32 m0, s57, 108544
    s_nop 0
    buffer_load_dwordx4 v56, s[36:39], s50 offen offset:0 sc1 lds
    buffer_load_dwordx4 v57, s[36:39], s50 offen offset:1024 sc1 lds
    buffer_load_dwordx4 v58, s[36:39], s50 offen offset:2048 sc1 lds
    buffer_load_dwordx4 v59, s[36:39], s50 offen offset:3072 sc1 lds
    s_add_u32 m0, s57, 112640
    s_nop 0
    buffer_load_dwordx4 v60, s[36:39], s50 offen offset:0 sc1 lds
    buffer_load_dwordx4 v61, s[36:39], s50 offen offset:1024 sc1 lds
    buffer_load_dwordx4 v62, s[36:39], s50 offen offset:2048 sc1 lds
    buffer_load_dwordx4 v63, s[36:39], s50 offen offset:3072 sc1 lds
    s_add_u32 m0, s57, 116736
    s_nop 0
    buffer_load_dwordx4 v64, s[36:39], s50 offen offset:0 sc1 lds
    s_add_u32 s50, s58, 1032192
    s_cmp_ge_u32 s50, s59
    s_cselect_b32 s48, 1327104, 0
    s_sub_u32 s50, s50, s48
    s_waitcnt vmcnt(9)
    s_barrier
    s_add_u32 m0, s57, 126976
    s_nop 0
    buffer_load_dwordx4 v56, s[36:39], s50 offen offset:0 sc1 lds
    buffer_load_dwordx4 v57, s[36:39], s50 offen offset:1024 sc1 lds
    buffer_load_dwordx4 v58, s[36:39], s50 offen offset:2048 sc1 lds
    buffer_load_dwordx4 v59, s[36:39], s50 offen offset:3072 sc1 lds
    s_add_u32 m0, s57, 131072
    s_nop 0
    buffer_load_dwordx4 v60, s[36:39], s50 offen offset:0 sc1 lds
    buffer_load_dwordx4 v61, s[36:39], s50 offen offset:1024 sc1 lds
    buffer_load_dwordx4 v62, s[36:39], s50 offen offset:2048 sc1 lds
    buffer_load_dwordx4 v63, s[36:39], s50 offen offset:3072 sc1 lds
    s_add_u32 m0, s57, 135168
    s_nop 0
    buffer_load_dwordx4 v64, s[36:39], s50 offen offset:0 sc1 lds
    s_add_u32 s50, s58, 1105920
    s_cmp_ge_u32 s50, s59
    s_cselect_b32 s48, 1327104, 0
    s_sub_u32 s50, s50, s48
    s_waitcnt vmcnt(9)
    s_barrier
    s_add_u32 m0, s57, 145408
    s_nop 0
    buffer_load_dwordx4 v56, s[36:39], s50 offen offset:0 sc1 lds
    buffer_load_dwordx4 v57, s[36:39], s50 offen offset:1024 sc1 lds
    buffer_load_dwordx4 v58, s[36:39], s50 offen offset:2048 sc1 lds
    buffer_load_dwordx4 v59, s[36:39], s50 offen offset:3072 sc1 lds
    s_add_u32 m0, s57, 149504
    s_nop 0
    buffer_load_dwordx4 v60, s[36:39], s50 offen offset:0 sc1 lds
    buffer_load_dwordx4 v61, s[36:39], s50 offen offset:1024 sc1 lds
    buffer_load_dwordx4 v62, s[36:39], s50 offen offset:2048 sc1 lds
    buffer_load_dwordx4 v63, s[36:39], s50 offen offset:3072 sc1 lds
    s_add_u32 m0, s57, 153600
    s_nop 0
    buffer_load_dwordx4 v64, s[36:39], s50 offen offset:0 sc1 lds
    s_add_u32 s50, s58, 1179648
    s_cmp_ge_u32 s50, s59
    s_cselect_b32 s48, 1327104, 0
    s_sub_u32 s50, s50, s48
    s_waitcnt vmcnt(9)
    s_barrier
    s_add_u32 m0, s57, 90112
    s_nop 0
    buffer_load_dwordx4 v56, s[36:39], s50 offen offset:0 sc1 lds
    buffer_load_dwordx4 v57, s[36:39], s50 offen offset:1024 sc1 lds
    buffer_load_dwordx4 v58, s[36:39], s50 offen offset:2048 sc1 lds
    buffer_load_dwordx4 v59, s[36:39], s50 offen offset:3072 sc1 lds
    s_add_u32 m0, s57, 94208
    s_nop 0
    buffer_load_dwordx4 v60, s[36:39], s50 offen offset:0 sc1 lds
    buffer_load_dwordx4 v61, s[36:39], s50 offen offset:1024 sc1 lds
    buffer_load_dwordx4 v62, s[36:39], s50 offen offset:2048 sc1 lds
    buffer_load_dwordx4 v63, s[36:39], s50 offen offset:3072 sc1 lds
    s_add_u32 m0, s57, 98304
    s_nop 0
    buffer_load_dwordx4 v64, s[36:39], s50 offen offset:0 sc1 lds
    s_add_u32 s50, s58, 1253376
    s_cmp_ge_u32 s50, s59
    s_cselect_b32 s48, 1327104, 0
    s_sub_u32 s50, s50, s48
    s_waitcnt vmcnt(9)
    s_barrier
    s_add_u32 m0, s57, 108544
    s_nop 0
    buffer_load_dwordx4 v56, s[36:39], s50 offen offset:0 sc1 lds
    buffer_load_dwordx4 v57, s[36:39], s50 offen offset:1024 sc1 lds
    buffer_load_dwordx4 v58, s[36:39], s50 offen offset:2048 sc1 lds
    buffer_load_dwordx4 v59, s[36:39], s50 offen offset:3072 sc1 lds
    s_add_u32 m0, s57, 112640
    s_nop 0
    buffer_load_dwordx4 v60, s[36:39], s50 offen offset:0 sc1 lds
    buffer_load_dwordx4 v61, s[36:39], s50 offen offset:1024 sc1 lds
    buffer_load_dwordx4 v62, s[36:39], s50 offen offset:2048 sc1 lds
    buffer_load_dwordx4 v63, s[36:39], s50 offen offset:3072 sc1 lds
    s_add_u32 m0, s57, 116736
    s_nop 0
    buffer_load_dwordx4 v64, s[36:39], s50 offen offset:0 sc1 lds
    s_lshl_b32 s48, s62, 10
    s_add_u32 m0, s48, 32768
    s_nop 0
    buffer_load_dwordx4 v70, s[36:39], 0 offen sc1 lds
    s_lshl_b32 s48, s62, 10
    s_add_u32 m0, s48, 34816
    s_nop 0
    buffer_load_dwordx4 v71, s[36:39], 0 offen sc1 lds
    s_lshl_b32 s48, s62, 10
    s_add_u32 m0, s48, 36864
    s_nop 0
    buffer_load_dwordx4 v72, s[36:39], 0 offen sc1 lds
    s_lshl_b32 s48, s62, 10
    s_add_u32 m0, s48, 38912
    s_nop 0
    buffer_load_dwordx4 v73, s[36:39], 0 offen sc1 lds
    s_mul_i32 s48, s62, 40960
    s_add_u32 m0, s48, 40960
    s_nop 0
    buffer_load_dwordx4 v74, s[36:39], 0 offen sc1 lds
    s_waitcnt vmcnt(14)
    s_barrier
    s_waitcnt vmcnt(5)
    s_barrier
    s_waitcnt vmcnt(0)
    s_barrier
    s_branch L_m_100
L_m_50:
    v_lshlrev_b32 v29, 1, v2
    v_xor_b32 v29, v29, v1
    v_xor_b32 v30, 8, v29
    v_mul_u32_u24 v28, 4096, v2
    v_lshl_add_u32 v29, v29, 4, v28
    v_lshl_add_u32 v30, v30, 4, v28
    v_add_u32 v58, 30720, v29
    v_add_u32 v59, 46080, v30
    v_add_u32 v57, 15360, v30
    v_mov_b32 v56, v29
    v_add_u32 v60, 65536, v56
    v_add_u32 v61, 65536, v57
    v_add_u32 v62, 65536, v58
    v_add_u32 v63, 65536, v59
    s_mul_i32 s49, s53, 4718592
    s_lshl_b32 s48, s62, 17
    s_add_u32 s49, s49, s48
    s_lshl_b32 s48, s54, 8
    s_add_u32 s49, s49, s48
    s_mul_i32 s58, s64, 262144
    s_add_u32 s58, s58, s49
    s_add_u32 s59, s49, 4718592
    s_cmp_ge_u32 s5, 27
    s_cbranch_scc1 L_m_101
    v_lshlrev_b32 v29, 1, v2
    v_xor_b32 v29, v29, v1
    v_xor_b32 v30, 8, v29
    v_mul_u32_u24 v28, 2359296, v2
    v_lshl_add_u32 v29, v29, 4, v28
    v_lshl_add_u32 v30, v30, 4, v28
    v_add_u32 v14, 16384, v29
    v_add_u32 v15, 24576, v30
    v_add_u32 v13, 8192, v30
    v_mov_b32 v12, v29
    v_add_u32 v16, 9437184, v12
    v_add_u32 v17, 9437184, v13
    v_add_u32 v18, 9437184, v14
    v_add_u32 v19, 9437184, v15
    s_mul_i32 s49, s62, 36864
    s_lshl_b32 s48, s51, 8
    s_add_u32 s49, s49, s48
    s_mul_i32 s60, s63, 73728
    s_add_u32 s60, s60, s49
    s_add_u32 s61, s49, 2359296
    s_branch L_stub_15
L_back_w1:
    s_add_u32 s50, s60, 0
    s_cmp_ge_u32 s50, s61
    s_cselect_b32 s48, 2359296, 0
    s_sub_u32 s50, s50, s48
    s_add_u32 m0, s68, 0
    s_nop 0
    buffer_load_dwordx4 v12, s[40:43], s50 offen offset:0  lds
    buffer_load_dwordx4 v13, s[40:43], s50 offen offset:1024  lds
    buffer_load_dwordx4 v14, s[40:43], s50 offen offset:2048  lds
    buffer_load_dwordx4 v15, s[40:43], s50 offen offset:3072  lds
    s_branch L_skip_15
L_stub_15:
    s_branch L_stub_16
L_skip_15:
    s_add_u32 m0, s68, 4096
    s_nop 0
    buffer_load_dwordx4 v16, s[40:43], s50 offen offset:0  lds
    buffer_load_dwordx4 v17, s[40:43], s50 offen offset:1024  lds
    buffer_load_dwordx4 v18, s[40:43], s50 offen offset:2048  lds
    buffer_load_dwordx4 v19, s[40:43], s50 offen offset:3072  lds
    s_add_u32 s50, s60, 73728
    s_cmp_ge_u32 s50, s61
    s_cselect_b32 s48, 2359296, 0
    s_sub_u32 s50, s50, s48
    s_add_u32 m0, s68, 16384
    s_nop 0
    buffer_load_dwordx4 v12, s[40:43], s50 offen offset:0  lds
    buffer_load_dwordx4 v13, s[40:43], s50 offen offset:1024  lds
    buffer_load_dwordx4 v14, s[40:43], s50 offen offset:2048  lds
    buffer_load_dwordx4 v15, s[40:43], s50 offen offset:3072  lds
    s_add_u32 m0, s68, 20480
    s_nop 0
    buffer_load_dwordx4 v16, s[40:43], s50 offen offset:0  lds
    buffer_load_dwordx4 v17, s[40:43], s50 offen offset:1024  lds
    buffer_load_dwordx4 v18, s[40:43], s50 offen offset:2048  lds
    buffer_load_dwordx4 v19, s[40:43], s50 offen offset:3072  lds
    s_barrier
    s_add_u32 s50, s60, 147456
    s_cmp_ge_u32 s50, s61
    s_cselect_b32 s48, 2359296, 0
    s_sub_u32 s50, s50, s48
    s_add_u32 m0, s68, 32768
    s_nop 0
    buffer_load_dwordx4 v12, s[40:43], s50 offen offset:0  lds
    buffer_load_dwordx4 v13, s[40:43], s50 offen offset:1024  lds
    buffer_load_dwordx4 v14, s[40:43], s50 offen offset:2048  lds
    buffer_load_dwordx4 v15, s[40:43], s50 offen offset:3072  lds
    s_add_u32 m0, s68, 36864
    s_nop 0
    buffer_load_dwordx4 v16, s[40:43], s50 offen offset:0  lds
    buffer_load_dwordx4 v17, s[40:43], s50 offen offset:1024  lds
    buffer_load_dwordx4 v18, s[40:43], s50 offen offset:2048  lds
    buffer_load_dwordx4 v19, s[40:43], s50 offen offset:3072  lds
    s_add_u32 s50, s60, 221184
    s_cmp_ge_u32 s50, s61
    s_cselect_b32 s48, 2359296, 0
    s_sub_u32 s50, s50, s48
    s_add_u32 m0, s68, 49152
    s_nop 0
    buffer_load_dwordx4 v12, s[40:43], s50 offen offset:0  lds
    buffer_load_dwordx4 v13, s[40:43], s50 offen offset:1024  lds
    buffer_load_dwordx4 v14, s[40:43], s50 offen offset:2048  lds
    buffer_load_dwordx4 v15, s[40:43], s50 offen offset:3072  lds
    s_add_u32 m0, s68, 53248
    s_nop 0
    buffer_load_dwordx4 v16, s[40:43], s50 offen offset:0  lds
    buffer_load_dwordx4 v17, s[40:43], s50 offen offset:1024  lds
    buffer_load_dwordx4 v18, s[40:43], s50 offen offset:2048  lds
    buffer_load_dwordx4 v19, s[40:43], s50 offen offset:3072  lds
    s_barrier
    s_add_u32 s50, s60, 294912
    s_cmp_ge_u32 s50, s61
    s_cselect_b32 s48, 2359296, 0
    s_sub_u32 s50, s50, s48
    s_add_u32 m0, s68, 65536
    s_nop 0
    buffer_load_dwordx4 v12, s[40:43], s50 offen offset:0  lds
    buffer_load_dwordx4 v13, s[40:43], s50 offen offset:1024  lds
    buffer_load_dwordx4 v14, s[40:43], s50 offen offset:2048  lds
    buffer_load_dwordx4 v15, s[40:43], s50 offen offset:3072  lds
    s_add_u32 m0, s68, 69632
    s_nop 0
    buffer_load_dwordx4 v16, s[40:43], s50 offen offset:0  lds
    buffer_load_dwordx4 v17, s[40:43], s50 offen offset:1024  lds
    buffer_load_dwordx4 v18, s[40:43], s50 offen offset:2048  lds
    buffer_load_dwordx4 v19, s[40:43], s50 offen offset:3072  lds
    s_add_u32 s50, s60, 368640
    s_cmp_ge_u32 s50, s61
    s_cselect_b32 s48, 2359296, 0
    s_sub_u32 s50, s50, s48
    s_add_u32 m0, s68, 81920
    s_nop 0
    buffer_load_dwordx4 v12, s[40:43], s50 offen offset:0  lds
    buffer_load_dwordx4 v13, s[40:43], s50 offen offset:1024  lds
    buffer_load_dwordx4 v14, s[40:43], s50 offen offset:2048  lds
    buffer_load_dwordx4 v15, s[40:43], s50 offen offset:3072  lds
    s_add_u32 m0, s68, 86016
    s_nop 0
    buffer_load_dwordx4 v16, s[40:43], s50 offen offset:0  lds
    buffer_load_dwordx4 v17, s[40:43], s50 offen offset:1024  lds
    buffer_load_dwordx4 v18, s[40:43], s50 offen offset:2048  lds
    buffer_load_dwordx4 v19, s[40:43], s50 offen offset:3072  lds
    s_barrier
    s_waitcnt vmcnt(0)
    s_barrier
    s_barrier
    s_add_u32 s50, s60, 442368
    s_cmp_ge_u32 s50, s61
    s_cselect_b32 s48, 2359296, 0
    s_sub_u32 s50, s50, s48
    s_add_u32 m0, s68, 0
    s_nop 0
    buffer_load_dwordx4 v12, s[40:43], s50 offen offset:0  lds
    buffer_load_dwordx4 v13, s[40:43], s50 offen offset:1024  lds
    buffer_load_dwordx4 v14, s[40:43], s50 offen offset:2048  lds
    buffer_load_dwordx4 v15, s[40:43], s50 offen offset:3072  lds
    s_add_u32 m0, s68, 4096
    s_nop 0
    buffer_load_dwordx4 v16, s[40:43], s50 offen offset:0  lds
    buffer_load_dwordx4 v17, s[40:43], s50 offen offset:1024  lds
    buffer_load_dwordx4 v18, s[40:43], s50 offen offset:2048  lds
    buffer_load_dwordx4 v19, s[40:43], s50 offen offset:3072  lds
    s_add_u32 s50, s60, 516096
    s_cmp_ge_u32 s50, s61
    s_cselect_b32 s48, 2359296, 0
    s_sub_u32 s50, s50, s48
    s_add_u32 m0, s68, 16384
    s_nop 0
    buffer_load_dwordx4 v12, s[40:43], s50 offen offset:0  lds
    buffer_load_dwordx4 v13, s[40:43], s50 offen offset:1024  lds
    buffer_load_dwordx4 v14, s[40:43], s50 offen offset:2048  lds
    buffer_load_dwordx4 v15, s[40:43], s50 offen offset:3072  lds
    s_add_u32 m0, s68, 20480
    s_nop 0
    buffer_load_dwordx4 v16, s[40:43], s50 offen offset:0  lds
    buffer_load_dwordx4 v17, s[40:43], s50 offen offset:1024  lds
    buffer_load_dwordx4 v18, s[40:43], s50 offen offset:2048  lds
    buffer_load_dwordx4 v19, s[40:43], s50 offen offset:3072  lds
    s_add_u32 s50, s60, 589824
    s_cmp_ge_u32 s50, s61
    s_cselect_b32 s48, 2359296, 0
    s_sub_u32 s50, s50, s48
    s_add_u32 m0, s68, 32768
    s_nop 0
    buffer_load_dwordx4 v12, s[40:43], s50 offen offset:0  lds
    buffer_load_dwordx4 v13, s[40:43], s50 offen offset:1024  lds
    buffer_load_dwordx4 v14, s[40:43], s50 offen offset:2048  lds
    buffer_load_dwordx4 v15, s[40:43], s50 offen offset:3072  lds
    s_add_u32 m0, s68, 36864
    s_nop 0
    buffer_load_dwordx4 v16, s[40:43], s50 offen offset:0  lds
    buffer_load_dwordx4 v17, s[40:43], s50 offen offset:1024  lds
    buffer_load_dwordx4 v18, s[40:43], s50 offen offset:2048  lds
    buffer_load_dwordx4 v19, s[40:43], s50 offen offset:3072  lds
    s_add_u32 s50, s60, 663552
    s_cmp_ge_u32 s50, s61
    s_cselect_b32 s48, 2359296, 0
    s_sub_u32 s50, s50, s48
    s_add_u32 m0, s68, 49152
    s_nop 0
    buffer_load_dwordx4 v12, s[40:43], s50 offen offset:0  lds
    buffer_load_dwordx4 v13, s[40:43], s50 offen offset:1024  lds
    buffer_load_dwordx4 v14, s[40:43], s50 offen offset:2048  lds
    buffer_load_dwordx4 v15, s[40:43], s50 offen offset:3072  lds
    s_waitcnt vmcnt(12)
    s_barrier
    s_add_u32 m0, s68, 53248
    s_nop 0
    buffer_load_dwordx4 v16, s[40:43], s50 offen offset:0  lds
    buffer_load_dwordx4 v17, s[40:43], s50 offen offset:1024  lds
    buffer_load_dwordx4 v18, s[40:43], s50 offen offset:2048  lds
    buffer_load_dwordx4 v19, s[40:43], s50 offen offset:3072  lds
    s_barrier
    s_add_u32 s50, s60, 737280
    s_cmp_ge_u32 s50, s61
    s_cselect_b32 s48, 2359296, 0
    s_sub_u32 s50, s50, s48
    s_add_u32 m0, s68, 65536
    s_nop 0
    buffer_load_dwordx4 v12, s[40:43], s50 offen offset:0  lds
    buffer_load_dwordx4 v13, s[40:43], s50 offen offset:1024  lds
    buffer_load_dwordx4 v14, s[40:43], s50 offen offset:2048  lds
    buffer_load_dwordx4 v15, s[40:43], s50 offen offset:3072  lds
    s_add_u32 m0, s68, 69632
    s_nop 0
    buffer_load_dwordx4 v16, s[40:43], s50 offen offset:0  lds
    buffer_load_dwordx4 v17, s[40:43], s50 offen offset:1024  lds
    buffer_load_dwordx4 v18, s[40:43], s50 offen offset:2048  lds
    buffer_load_dwordx4 v19, s[40:43], s50 offen offset:3072  lds
    s_add_u32 s50, s60, 811008
    s_cmp_ge_u32 s50, s61
    s_cselect_b32 s48, 2359296, 0
    s_sub_u32 s50, s50, s48
    s_add_u32 m0, s68, 81920
    s_nop 0
    buffer_load_dwordx4 v12, s[40:43], s50 offen offset:0  lds
    buffer_load_dwordx4 v13, s[40:43], s50 offen offset:1024  lds
    buffer_load_dwordx4 v14, s[40:43], s50 offen offset:2048  lds
    buffer_load_dwordx4 v15, s[40:43], s50 offen offset:3072  lds
    s_add_u32 m0, s68, 86016
    s_nop 0
    buffer_load_dwordx4 v16, s[40:43], s50 offen offset:0  lds
    buffer_load_dwordx4 v17, s[40:43], s50 offen offset:1024  lds
    buffer_load_dwordx4 v18, s[40:43], s50 offen offset:2048  lds
    buffer_load_dwordx4 v19, s[40:43], s50 offen offset:3072  lds
    s_add_u32 s50, s60, 884736
    s_cmp_ge_u32 s50, s61
    s_cselect_b32 s48, 2359296, 0
    s_sub_u32 s50, s50, s48
    s_add_u32 m0, s68, 0
    s_nop 0
    buffer_load_dwordx4 v12, s[40:43], s50 offen offset:0  lds
    buffer_load_dwordx4 v13, s[40:43], s50 offen offset:1024  lds
    buffer_load_dwordx4 v14, s[40:43], s50 offen offset:2048  lds
    buffer_load_dwordx4 v15, s[40:43], s50 offen offset:3072  lds
    s_add_u32 m0, s68, 4096
    s_nop 0
    buffer_load_dwordx4 v16, s[40:43], s50 offen offset:0  lds
    buffer_load_dwordx4 v17, s[40:43], s50 offen offset:1024  lds
    buffer_load_dwordx4 v18, s[40:43], s50 offen offset:2048  lds
    buffer_load_dwordx4 v19, s[40:43], s50 offen offset:3072  lds
    s_add_u32 s50, s60, 958464
    s_cmp_ge_u32 s50, s61
    s_cselect_b32 s48, 2359296, 0
    s_sub_u32 s50, s50, s48
    s_add_u32 m0, s68, 16384
    s_nop 0
    buffer_load_dwordx4 v12, s[40:43], s50 offen offset:0  lds
    buffer_load_dwordx4 v13, s[40:43], s50 offen offset:1024  lds
    buffer_load_dwordx4 v14, s[40:43], s50 offen offset:2048  lds
    buffer_load_dwordx4 v15, s[40:43], s50 offen offset:3072  lds
    s_add_u32 m0, s68, 20480
    s_nop 0
    buffer_load_dwordx4 v16, s[40:43], s50 offen offset:0  lds
    buffer_load_dwordx4 v17, s[40:43], s50 offen offset:1024  lds
    buffer_load_dwordx4 v18, s[40:43], s50 offen offset:2048  lds
    buffer_load_dwordx4 v19, s[40:43], s50 offen offset:3072  lds
    s_waitcnt vmcnt(40)
    s_barrier
    s_waitcnt vmcnt(32)
    s_barrier
    s_add_u32 s50, s60, 1032192
    s_cmp_ge_u32 s50, s61
    s_cselect_b32 s48, 2359296, 0
    s_sub_u32 s50, s50, s48
    s_add_u32 m0, s68, 32768
    s_nop 0
    buffer_load_dwordx4 v12, s[40:43], s50 offen offset:0  lds
    buffer_load_dwordx4 v13, s[40:43], s50 offen offset:1024  lds
    buffer_load_dwordx4 v14, s[40:43], s50 offen offset:2048  lds
    buffer_load_dwordx4 v15, s[40:43], s50 offen offset:3072  lds
    s_add_u32 m0, s68, 36864
    s_nop 0
    buffer_load_dwordx4 v16, s[40:43], s50 offen offset:0  lds
    s_waitcnt vmcnt(29)
    s_barrier
    buffer_load_dwordx4 v17, s[40:43], s50 offen offset:1024  lds
    buffer_load_dwordx4 v18, s[40:43], s50 offen offset:2048  lds
    buffer_load_dwordx4 v19, s[40:43], s50 offen offset:3072  lds
    s_add_u32 s50, s60, 1105920
    s_cmp_ge_u32 s50, s61
    s_cselect_b32 s48, 2359296, 0
    s_sub_u32 s50, s50, s48
    s_add_u32 m0, s68, 49152
    s_nop 0
    buffer_load_dwordx4 v12, s[40:43], s50 offen offset:0  lds
    buffer_load_dwordx4 v13, s[40:43], s50 offen offset:1024  lds
    s_waitcnt vmcnt(26)
    s_barrier
    buffer_load_dwordx4 v14, s[40:43], s50 offen offset:2048  lds
    buffer_load_dwordx4 v15, s[40:43], s50 offen offset:3072  lds
    s_add_u32 m0, s68, 53248
    s_nop 0
    buffer_load_dwordx4 v16, s[40:43], s50 offen offset:0  lds
    buffer_load_dwordx4 v17, s[40:43], s50 offen offset:1024  lds
    buffer_load_dwordx4 v18, s[40:43], s50 offen offset:2048  lds
    s_waitcnt vmcnt(23)
    s_barrier
    buffer_load_dwordx4 v19, s[40:43], s50 offen offset:3072  lds
    s_add_u32 s50, s60, 1179648
    s_cmp_ge_u32 s50, s61
    s_cselect_b32 s48, 2359296, 0
    s_sub_u32 s50, s50, s48
    s_add_u32 m0, s68, 65536
    s_nop 0
    buffer_load_dwordx4 v12, s[40:43], s50 offen offset:0  lds
    buffer_load_dwordx4 v13, s[40:43], s50 offen offset:1024  lds
    buffer_load_dwordx4 v14, s[40:43], s50 offen offset:2048  lds
    buffer_load_dwordx4 v15, s[40:43], s50 offen offset:3072  lds
    s_add_u32 m0, s68, 69632
    s_nop 0
    buffer_load_dwordx4 v16, s[40:43], s50 offen offset:0  lds
    s_waitcnt vmcnt(21)
    s_barrier
    buffer_load_dwordx4 v17, s[40:43], s50 offen offset:1024  lds
    buffer_load_dwordx4 v18, s[40:43], s50 offen offset:2048  lds
    buffer_load_dwordx4 v19, s[40:43], s50 offen offset:3072  lds
    s_add_u32 s50, s60, 1253376
    s_cmp_ge_u32 s50, s61
    s_cselect_b32 s48, 2359296, 0
    s_sub_u32 s50, s50, s48
    s_add_u32 m0, s68, 81920
    s_nop 0
    buffer_load_dwordx4 v12, s[40:43], s50 offen offset:0  lds
    buffer_load_dwordx4 v13, s[40:43], s50 offen offset:1024  lds
    s_barrier
    buffer_load_dwordx4 v14, s[40:43], s50 offen offset:2048  lds
    buffer_load_dwordx4 v15, s[40:43], s50 offen offset:3072  lds
    s_add_u32 m0, s68, 86016
    s_nop 0
    buffer_load_dwordx4 v16, s[40:43], s50 offen offset:0  lds
    buffer_load_dwordx4 v17, s[40:43], s50 offen offset:1024  lds
    buffer_load_dwordx4 v18, s[40:43], s50 offen offset:2048  lds
    s_waitcnt vmcnt(23)
    s_barrier
    buffer_load_dwordx4 v19, s[40:43], s50 offen offset:3072  lds
    s_add_u32 s50, s60, 1327104
    s_cmp_ge_u32 s50, s61
    s_cselect_b32 s48, 2359296, 0
    s_sub_u32 s50, s50, s48
    s_add_u32 m0, s68, 0
    s_nop 0
    buffer_load_dwordx4 v12, s[40:43], s50 offen offset:0  lds
    buffer_load_dwordx4 v13, s[40:43], s50 offen offset:1024  lds
    buffer_load_dwordx4 v14, s[40:43], s50 offen offset:2048  lds
    buffer_load_dwordx4 v15, s[40:43], s50 offen offset:3072  lds
    s_waitcnt vmcnt(20)
    s_barrier
    s_add_u32 m0, s68, 4096
    s_nop 0
    buffer_load_dwordx4 v16, s[40:43], s50 offen offset:0  lds
    buffer_load_dwordx4 v17, s[40:43], s50 offen offset:1024  lds
    buffer_load_dwordx4 v18, s[40:43], s50 offen offset:2048  lds
    buffer_load_dwordx4 v19, s[40:43], s50 offen offset:3072  lds
    s_add_u32 s50, s60, 1400832
    s_cmp_ge_u32 s50, s61
    s_cselect_b32 s48, 2359296, 0
    s_sub_u32 s50, s50, s48
    s_add_u32 m0, s68, 16384
    s_nop 0
    buffer_load_dwordx4 v12, s[40:43], s50 offen offset:0  lds
    s_barrier
    buffer_load_dwordx4 v13, s[40:43], s50 offen offset:1024  lds
    buffer_load_dwordx4 v14, s[40:43], s50 offen offset:2048  lds
    buffer_load_dwordx4 v15, s[40:43], s50 offen offset:3072  lds
    s_add_u32 m0, s68, 20480
    s_nop 0
    buffer_load_dwordx4 v16, s[40:43], s50 offen offset:0  lds
    buffer_load_dwordx4 v17, s[40:43], s50 offen offset:1024  lds
    s_waitcnt vmcnt(22)
    s_barrier
    buffer_load_dwordx4 v18, s[40:43], s50 offen offset:2048  lds
    buffer_load_dwordx4 v19, s[40:43], s50 offen offset:3072  lds
    s_add_u32 s50, s60, 1474560
    s_cmp_ge_u32 s50, s61
    s_cselect_b32 s48, 2359296, 0
    s_sub_u32 s50, s50, s48
    s_add_u32 m0, s68, 32768
    s_nop 0
    buffer_load_dwordx4 v12, s[40:43], s50 offen offset:0  lds
    buffer_load_dwordx4 v13, s[40:43], s50 offen offset:1024  lds
    buffer_load_dwordx4 v14, s[40:43], s50 offen offset:2048  lds
    s_waitcnt vmcnt(19)
    s_barrier
    buffer_load_dwordx4 v15, s[40:43], s50 offen offset:3072  lds
    s_add_u32 m0, s68, 36864
    s_nop 0
    buffer_load_dwordx4 v16, s[40:43], s50 offen offset:0  lds
    buffer_load_dwordx4 v17, s[40:43], s50 offen offset:1024  lds
    buffer_load_dwordx4 v18, s[40:43], s50 offen offset:2048  lds
    buffer_load_dwordx4 v19, s[40:43], s50 offen offset:3072  lds
    s_add_u32 s50, s60, 1548288
    s_cmp_ge_u32 s50, s61
    s_cselect_b32 s48, 2359296, 0
    s_sub_u32 s50, s50, s48
    s_add_u32 m0, s68, 49152
    s_nop 0
    buffer_load_dwordx4 v12, s[40:43], s50 offen offset:0  lds
    s_barrier
    buffer_load_dwordx4 v13, s[40:43], s50 offen offset:1024  lds
    buffer_load_dwordx4 v14, s[40:43], s50 offen offset:2048  lds
    buffer_load_dwordx4 v15, s[40:43], s50 offen offset:3072  lds
    s_add_u32 m0, s68, 53248
    s_nop 0
    buffer_load_dwordx4 v16, s[40:43], s50 offen offset:0  lds
    buffer_load_dwordx4 v17, s[40:43], s50 offen offset:1024  lds
    s_waitcnt vmcnt(22)
    s_barrier
    buffer_load_dwordx4 v18, s[40:43], s50 offen offset:2048  lds
    buffer_load_dwordx4 v19, s[40:43], s50 offen offset:3072  lds
    s_add_u32 s50, s60, 1622016
    s_cmp_ge_u32 s50, s61
    s_cselect_b32 s48, 2359296, 0
    s_sub_u32 s50, s50, s48
    s_add_u32 m0, s68, 65536
    s_nop 0
    buffer_load_dwordx4 v12, s[40:43], s50 offen offset:0  lds
    buffer_load_dwordx4 v13, s[40:43], s50 offen offset:1024  lds
    buffer_load_dwordx4 v14, s[40:43], s50 offen offset:2048  lds
    s_waitcnt vmcnt(19)
    s_barrier
    buffer_load_dwordx4 v15, s[40:43], s50 offen offset:3072  lds
    s_add_u32 m0, s68, 69632
    s_nop 0
    buffer_load_dwordx4 v16, s[40:43], s50 offen offset:0  lds
    buffer_load_dwordx4 v17, s[40:43], s50 offen offset:1024  lds
    buffer_load_dwordx4 v18, s[40:43], s50 offen offset:2048  lds
    buffer_load_dwordx4 v19, s[40:43], s50 offen offset:3072  lds
    s_barrier
    s_add_u32 s50, s60, 1695744
    s_cmp_ge_u32 s50, s61
    s_cselect_b32 s48, 2359296, 0
    s_sub_u32 s50, s50, s48
    s_add_u32 m0, s68, 81920
    s_nop 0
    buffer_load_dwordx4 v12, s[40:43], s50 offen offset:0  lds
    buffer_load_dwordx4 v13, s[40:43], s50 offen offset:1024  lds
    buffer_load_dwordx4 v14, s[40:43], s50 offen offset:2048  lds
    buffer_load_dwordx4 v15, s[40:43], s50 offen offset:3072  lds
    s_add_u32 m0, s68, 86016
    s_nop 0
    buffer_load_dwordx4 v16, s[40:43], s50 offen offset:0  lds
    s_waitcnt vmcnt(21)
    s_barrier
    buffer_load_dwordx4 v17, s[40:43], s50 offen offset:1024  lds
    buffer_load_dwordx4 v18, s[40:43], s50 offen offset:2048  lds
    buffer_load_dwordx4 v19, s[40:43], s50 offen offset:3072  lds
    s_add_u32 s50, s60, 1769472
    s_cmp_ge_u32 s50, s61
    s_cselect_b32 s48, 2359296, 0
    s_sub_u32 s50, s50, s48
    s_add_u32 m0, s68, 0
    s_nop 0
    buffer_load_dwordx4 v12, s[40:43], s50 offen offset:0  lds
    buffer_load_dwordx4 v13, s[40:43], s50 offen offset:1024  lds
    s_waitcnt vmcnt(18)
    s_barrier
    buffer_load_dwordx4 v14, s[40:43], s50 offen offset:2048  lds
    buffer_load_dwordx4 v15, s[40:43], s50 offen offset:3072  lds
    s_add_u32 m0, s68, 4096
    s_nop 0
    buffer_load_dwordx4 v16, s[40:43], s50 offen offset:0  lds
    buffer_load_dwordx4 v17, s[40:43], s50 offen offset:1024  lds
    buffer_load_dwordx4 v18, s[40:43], s50 offen offset:2048  lds
    s_barrier
    buffer_load_dwordx4 v19, s[40:43], s50 offen offset:3072  lds
    s_add_u32 s50, s60, 1843200
    s_cmp_ge_u32 s50, s61
    s_cselect_b32 s48, 2359296, 0
    s_sub_u32 s50, s50, s48
    s_add_u32 m0, s68, 16384
    s_nop 0
    buffer_load_dwordx4 v12, s[40:43], s50 offen offset:0  lds
    buffer_load_dwordx4 v13, s[40:43], s50 offen offset:1024  lds
    buffer_load_dwordx4 v14, s[40:43], s50 offen offset:2048  lds
    buffer_load_dwordx4 v15, s[40:43], s50 offen offset:3072  lds
    s_add_u32 m0, s68, 20480
    s_nop 0
    buffer_load_dwordx4 v16, s[40:43], s50 offen offset:0  lds
    s_waitcnt vmcnt(21)
    s_barrier
    buffer_load_dwordx4 v17, s[40:43], s50 offen offset:1024  lds
    buffer_load_dwordx4 v18, s[40:43], s50 offen offset:2048  lds
    buffer_load_dwordx4 v19, s[40:43], s50 offen offset:3072  lds
    s_add_u32 s50, s60, 1916928
    s_cmp_ge_u32 s50, s61
    s_cselect_b32 s48, 2359296, 0
    s_sub_u32 s50, s50, s48
    s_add_u32 m0, s68, 32768
    s_nop 0
    buffer_load_dwordx4 v12, s[40:43], s50 offen offset:0  lds
    buffer_load_dwordx4 v13, s[40:43], s50 offen offset:1024  lds
    s_waitcnt vmcnt(18)
    s_barrier
    buffer_load_dwordx4 v14, s[40:43], s50 offen offset:2048  lds
    buffer_load_dwordx4 v15, s[40:43], s50 offen offset:3072  lds
    s_add_u32 m0, s68, 36864
    s_nop 0
    buffer_load_dwordx4 v16, s[40:43], s50 offen offset:0  lds
    buffer_load_dwordx4 v17, s[40:43], s50 offen offset:1024  lds
    buffer_load_dwordx4 v18, s[40:43], s50 offen offset:2048  lds
    s_barrier
    buffer_load_dwordx4 v19, s[40:43], s50 offen offset:3072  lds
    s_add_u32 s50, s60, 1990656
    s_cmp_ge_u32 s50, s61
    s_cselect_b32 s48, 2359296, 0
    s_sub_u32 s50, s50, s48
    s_add_u32 m0, s68, 49152
    s_nop 0
    buffer_load_dwordx4 v12, s[40:43], s50 offen offset:0  lds
    buffer_load_dwordx4 v13, s[40:43], s50 offen offset:1024  lds
    buffer_load_dwordx4 v14, s[40:43], s50 offen offset:2048  lds
    buffer_load_dwordx4 v15, s[40:43], s50 offen offset:3072  lds
    s_waitcnt vmcnt(20)
    s_barrier
    s_add_u32 m0, s68, 53248
    s_nop 0
    buffer_load_dwordx4 v16, s[40:43], s50 offen offset:0  lds
    buffer_load_dwordx4 v17, s[40:43], s50 offen offset:1024  lds
    buffer_load_dwordx4 v18, s[40:43], s50 offen offset:2048  lds
    buffer_load_dwordx4 v19, s[40:43], s50 offen offset:3072  lds
    s_add_u32 s50, s60, 2064384
    s_cmp_ge_u32 s50, s61
    s_cselect_b32 s48, 2359296, 0
    s_sub_u32 s50, s50, s48
    s_add_u32 m0, s68, 65536
    s_nop 0
    buffer_load_dwordx4 v12, s[40:43], s50 offen offset:0  lds
    s_waitcnt vmcnt(17)
    s_barrier
    buffer_load_dwordx4 v13, s[40:43], s50 offen offset:1024  lds
    buffer_load_dwordx4 v14, s[40:43], s50 offen offset:2048  lds
    buffer_load_dwordx4 v15, s[40:43], s50 offen offset:3072  lds
    s_add_u32 m0, s68, 69632
    s_nop 0
    buffer_load_dwordx4 v16, s[40:43], s50 offen offset:0  lds
    buffer_load_dwordx4 v17, s[40:43], s50 offen offset:1024  lds
    s_barrier
    buffer_load_dwordx4 v18, s[40:43], s50 offen offset:2048  lds
    buffer_load_dwordx4 v19, s[40:43], s50 offen offset:3072  lds
    s_add_u32 s50, s60, 2138112
    s_cmp_ge_u32 s50, s61
    s_cselect_b32 s48, 2359296, 0
    s_sub_u32 s50, s50, s48
    s_add_u32 m0, s68, 81920
    s_nop 0
    buffer_load_dwordx4 v12, s[40:43], s50 offen offset:0  lds
    buffer_load_dwordx4 v13, s[40:43], s50 offen offset:1024  lds
    buffer_load_dwordx4 v14, s[40:43], s50 offen offset:2048  lds
    s_waitcnt vmcnt(19)
    s_barrier
    buffer_load_dwordx4 v15, s[40:43], s50 offen offset:3072  lds
    s_add_u32 m0, s68, 86016
    s_nop 0
    buffer_load_dwordx4 v16, s[40:43], s50 offen offset:0  lds
    buffer_load_dwordx4 v17, s[40:43], s50 offen offset:1024  lds
    buffer_load_dwordx4 v18, s[40:43], s50 offen offset:2048  lds
    buffer_load_dwordx4 v19, s[40:43], s50 offen offset:3072  lds
    s_add_u32 s50, s60, 2211840
    s_cmp_ge_u32 s50, s61
    s_cselect_b32 s48, 2359296, 0
    s_sub_u32 s50, s50, s48
    s_add_u32 m0, s68, 0
    s_nop 0
    buffer_load_dwordx4 v12, s[40:43], s50 offen offset:0  lds
    s_waitcnt vmcnt(17)
    s_barrier
    buffer_load_dwordx4 v13, s[40:43], s50 offen offset:1024  lds
    buffer_load_dwordx4 v14, s[40:43], s50 offen offset:2048  lds
    buffer_load_dwordx4 v15, s[40:43], s50 offen offset:3072  lds
    s_add_u32 m0, s68, 4096
    s_nop 0
    buffer_load_dwordx4 v16, s[40:43], s50 offen offset:0  lds
    buffer_load_dwordx4 v17, s[40:43], s50 offen offset:1024  lds
    s_barrier
    buffer_load_dwordx4 v18, s[40:43], s50 offen offset:2048  lds
    buffer_load_dwordx4 v19, s[40:43], s50 offen offset:3072  lds
    s_add_u32 s50, s60, 2285568
    s_cmp_ge_u32 s50, s61
    s_cselect_b32 s48, 2359296, 0
    s_sub_u32 s50, s50, s48
    s_add_u32 m0, s68, 16384
    s_nop 0
    buffer_load_dwordx4 v12, s[40:43], s50 offen offset:0  lds
    buffer_load_dwordx4 v13, s[40:43], s50 offen offset:1024  lds
    buffer_load_dwordx4 v14, s[40:43], s50 offen offset:2048  lds
    s_waitcnt vmcnt(19)
    s_barrier
    buffer_load_dwordx4 v15, s[40:43], s50 offen offset:3072  lds
    s_add_u32 m0, s68, 20480
    s_nop 0
    buffer_load_dwordx4 v16, s[40:43], s50 offen offset:0  lds
    buffer_load_dwordx4 v17, s[40:43], s50 offen offset:1024  lds
    buffer_load_dwordx4 v18, s[40:43], s50 offen offset:2048  lds
    buffer_load_dwordx4 v19, s[40:43], s50 offen offset:3072  lds
    s_waitcnt vmcnt(16)
    s_barrier
    s_add_u32 s50, s58, 0
    s_cmp_ge_u32 s50, s59
    s_cselect_b32 s48, 4718592, 0
    s_sub_u32 s50, s50, s48
    s_add_u32 m0, s68, 32768
    s_nop 0
    buffer_load_dwordx4 v56, s[44:47], s50 offen offset:0  lds
    buffer_load_dwordx4 v57, s[44:47], s50 offen offset:1024  lds
    buffer_load_dwordx4 v58, s[44:47], s50 offen offset:2048  lds
    buffer_load_dwordx4 v59, s[44:47], s50 offen offset:3072  lds
    s_add_u32 m0, s68, 36864
    s_nop 0
    buffer_load_dwordx4 v60, s[44:47], s50 offen offset:0  lds
    buffer_load_dwordx4 v61, s[44:47], s50 offen offset:1024  lds
    buffer_load_dwordx4 v62, s[44:47], s50 offen offset:2048  lds
    buffer_load_dwordx4 v63, s[44:47], s50 offen offset:3072  lds
    s_add_u32 s50, s58, 262144
    s_cmp_ge_u32 s50, s59
    s_cselect_b32 s48, 4718592, 0
    s_sub_u32 s50, s50, s48
    s_add_u32 m0, s68, 49152
    s_nop 0
    buffer_load_dwordx4 v56, s[44:47], s50 offen offset:0  lds
    buffer_load_dwordx4 v57, s[44:47], s50 offen offset:1024  lds
    s_waitcnt vmcnt(18)
    s_barrier
    buffer_load_dwordx4 v58, s[44:47], s50 offen offset:2048  lds
    buffer_load_dwordx4 v59, s[44:47], s50 offen offset:3072  lds
    s_add_u32 m0, s68, 53248
    s_nop 0
    buffer_load_dwordx4 v60, s[44:47], s50 offen offset:0  lds
    buffer_load_dwordx4 v61, s[44:47], s50 offen offset:1024  lds
    buffer_load_dwordx4 v62, s[44:47], s50 offen offset:2048  lds
    buffer_load_dwordx4 v63, s[44:47], s50 offen offset:3072  lds
    s_add_u32 s50, s58, 524288
    s_cmp_ge_u32 s50, s59
    s_cselect_b32 s48, 4718592, 0
    s_sub_u32 s50, s50, s48
    s_add_u32 m0, s68, 65536
    s_nop 0
    buffer_load_dwordx4 v56, s[44:47], s50 offen offset:0  lds
    buffer_load_dwordx4 v57, s[44:47], s50 offen offset:1024  lds
    buffer_load_dwordx4 v58, s[44:47], s50 offen offset:2048  lds
    buffer_load_dwordx4 v59, s[44:47], s50 offen offset:3072  lds
    s_add_u32 m0, s68, 69632
    s_nop 0
    buffer_load_dwordx4 v60, s[44:47], s50 offen offset:0  lds
    buffer_load_dwordx4 v61, s[44:47], s50 offen offset:1024  lds
    s_waitcnt vmcnt(22)
    s_barrier
    buffer_load_dwordx4 v62, s[44:47], s50 offen offset:2048  lds
    buffer_load_dwordx4 v63, s[44:47], s50 offen offset:3072  lds
    s_branch L_skip_16
L_stub_16:
    s_branch L_back_w1
L_skip_16:
    s_add_u32 s50, s58, 786432
    s_cmp_ge_u32 s50, s59
    s_cselect_b32 s48, 4718592, 0
    s_sub_u32 s50, s50, s48
    s_add_u32 m0, s68, 81920
    s_nop 0
    buffer_load_dwordx4 v56, s[44:47], s50 offen offset:0  lds
    buffer_load_dwordx4 v57, s[44:47], s50 offen offset:1024  lds
    buffer_load_dwordx4 v58, s[44:47], s50 offen offset:2048  lds
    buffer_load_dwordx4 v59, s[44:47], s50 offen offset:3072  lds
    s_add_u32 m0, s68, 86016
    s_nop 0
    buffer_load_dwordx4 v60, s[44:47], s50 offen offset:0  lds
    buffer_load_dwordx4 v61, s[44:47], s50 offen offset:1024  lds
    buffer_load_dwordx4 v62, s[44:47], s50 offen offset:2048  lds
    buffer_load_dwordx4 v63, s[44:47], s50 offen offset:3072  lds
    s_barrier
    s_branch L_m_102
L_m_101:
    s_sub_u32 s56, s5, 27
    s_lshl_b32 s56, s56, 1
    s_add_u32 s56, s56, s62
    s_add_u32 s56, s56, 96
    s_barrier
L_m_103:
    s_cmp_ge_u32 s56, 116
    s_cbranch_scc1 L_m_104
    s_mul_i32 s48, s56, 820
    s_lshr_b32 s48, s48, 13
    s_mul_i32 s49, s48, 10
    s_sub_u32 s49, s56, s49
    s_lshl_b32 s49, s49, 6
    v_add_u32 v22, s49, v0
    s_and_b32 s49, s4, 7
    s_mul_i32 s49, s49, 4
    s_add_u32 s48, s48, s49
    s_add_u32 s48, s48, 26
    s_and_b32 s48, s48, 31
    s_mul_i32 s48, s48, 73728
    s_mul_i32 s49, s4, 1152
    s_and_b32 s49, s49, -256
    s_add_u32 s48, s48, s49
    v_mul_u32_u24 v23, 820, v22
    v_lshrrev_b32 v23, 13, v23
    v_mul_u32_u24 v24, 10, v23
    v_sub_u32 v24, v22, v24
    v_and_b32 v22, 7, v23
    v_lshrrev_b32 v23, 3, v23
    v_lshl_add_u32 v22, v22, 8, v23
    v_mul_u32_u24 v22, 9216, v22
    v_lshl_add_u32 v22, v24, 7, v22
    buffer_load_dword v25, v22, s[40:43], s48 offen
    s_add_u32 s56, s56, 10
    s_branch L_m_103
L_m_104:
    s_barrier
    s_barrier
    s_barrier
    s_barrier
    s_barrier
    s_add_u32 s50, s58, 0
    s_cmp_ge_u32 s50, s59
    s_cselect_b32 s48, 4718592, 0
    s_sub_u32 s50, s50, s48
    s_add_u32 m0, s68, 32768
    s_nop 0
    buffer_load_dwordx4 v56, s[44:47], s50 offen offset:0  lds
    buffer_load_dwordx4 v57, s[44:47], s50 offen offset:1024  lds
    buffer_load_dwordx4 v58, s[44:47], s50 offen offset:2048  lds
    buffer_load_dwordx4 v59, s[44:47], s50 offen offset:3072  lds
    s_add_u32 m0, s68, 36864
    s_nop 0
    buffer_load_dwordx4 v60, s[44:47], s50 offen offset:0  lds
    buffer_load_dwordx4 v61, s[44:47], s50 offen offset:1024  lds
    buffer_load_dwordx4 v62, s[44:47], s50 offen offset:2048  lds
    buffer_load_dwordx4 v63, s[44:47], s50 offen offset:3072  lds
    s_add_u32 s50, s58, 262144
    s_cmp_ge_u32 s50, s59
    s_cselect_b32 s48, 4718592, 0
    s_sub_u32 s50, s50, s48
    s_add_u32 m0, s68, 49152
    s_nop 0
    buffer_load_dwordx4 v56, s[44:47], s50 offen offset:0  lds
    buffer_load_dwordx4 v57, s[44:47], s50 offen offset:1024  lds
    buffer_load_dwordx4 v58, s[44:47], s50 offen offset:2048  lds
    buffer_load_dwordx4 v59, s[44:47], s50 offen offset:3072  lds
    s_add_u32 m0, s68, 53248
    s_nop 0
    buffer_load_dwordx4 v60, s[44:47], s50 offen offset:0  lds
    buffer_load_dwordx4 v61, s[44:47], s50 offen offset:1024  lds
    buffer_load_dwordx4 v62, s[44:47], s50 offen offset:2048  lds
    buffer_load_dwordx4 v63, s[44:47], s50 offen offset:3072  lds
    s_add_u32 s50, s58, 524288
    s_cmp_ge_u32 s50, s59
    s_cselect_b32 s48, 4718592, 0
    s_sub_u32 s50, s50, s48
    s_add_u32 m0, s68, 65536
    s_nop 0
    buffer_load_dwordx4 v56, s[44:47], s50 offen offset:0  lds
    buffer_load_dwordx4 v57, s[44:47], s50 offen offset:1024  lds
    buffer_load_dwordx4 v58, s[44:47], s50 offen offset:2048  lds
    buffer_load_dwordx4 v59, s[44:47], s50 offen offset:3072  lds
    s_add_u32 m0, s68, 69632
    s_nop 0
    buffer_load_dwordx4 v60, s[44:47], s50 offen offset:0  lds
    buffer_load_dwordx4 v61, s[44:47], s50 offen offset:1024  lds
    buffer_load_dwordx4 v62, s[44:47], s50 offen offset:2048  lds
    buffer_load_dwordx4 v63, s[44:47], s50 offen offset:3072  lds
    s_add_u32 s50, s58, 786432
    s_cmp_ge_u32 s50, s59
    s_cselect_b32 s48, 4718592, 0
    s_sub_u32 s50, s50, s48
    s_add_u32 m0, s68, 81920
    s_nop 0
    buffer_load_dwordx4 v56, s[44:47], s50 offen offset:0  lds
    buffer_load_dwordx4 v57, s[44:47], s50 offen offset:1024  lds
    buffer_load_dwordx4 v58, s[44:47], s50 offen offset:2048  lds
    buffer_load_dwordx4 v59, s[44:47], s50 offen offset:3072  lds
    s_add_u32 m0, s68, 86016
    s_nop 0
    buffer_load_dwordx4 v60, s[44:47], s50 offen offset:0  lds
    buffer_load_dwordx4 v61, s[44:47], s50 offen offset:1024  lds
    buffer_load_dwordx4 v62, s[44:47], s50 offen offset:2048  lds
    buffer_load_dwordx4 v63, s[44:47], s50 offen offset:3072  lds
L_m_102:
    s_add_u32 s50, s58, 1048576
    s_cmp_ge_u32 s50, s59
    s_cselect_b32 s48, 4718592, 0
    s_sub_u32 s50, s50, s48
    s_add_u32 m0, s68, 0
    s_nop 0
    buffer_load_dwordx4 v56, s[44:47], s50 offen offset:0  lds
    buffer_load_dwordx4 v57, s[44:47], s50 offen offset:1024  lds
    buffer_load_dwordx4 v58, s[44:47], s50 offen offset:2048  lds
    buffer_load_dwordx4 v59, s[44:47], s50 offen offset:3072  lds
    s_add_u32 m0, s68, 4096
    s_nop 0
    buffer_load_dwordx4 v60, s[44:47], s50 offen offset:0  lds
    buffer_load_dwordx4 v61, s[44:47], s50 offen offset:1024  lds
    buffer_load_dwordx4 v62, s[44:47], s50 offen offset:2048  lds
    buffer_load_dwordx4 v63, s[44:47], s50 offen offset:3072  lds
    s_add_u32 s50, s58, 1310720
    s_cmp_ge_u32 s50, s59
    s_cselect_b32 s48, 4718592, 0
    s_sub_u32 s50, s50, s48
    s_add_u32 m0, s68, 16384
    s_nop 0
    buffer_load_dwordx4 v56, s[44:47], s50 offen offset:0  lds
    buffer_load_dwordx4 v57, s[44:47], s50 offen offset:1024  lds
    buffer_load_dwordx4 v58, s[44:47], s50 offen offset:2048  lds
    buffer_load_dwordx4 v59, s[44:47], s50 offen offset:3072  lds
    s_add_u32 m0, s68, 20480
    s_nop 0
    buffer_load_dwordx4 v60, s[44:47], s50 offen offset:0  lds
    buffer_load_dwordx4 v61, s[44:47], s50 offen offset:1024  lds
    buffer_load_dwordx4 v62, s[44:47], s50 offen offset:2048  lds
    buffer_load_dwordx4 v63, s[44:47], s50 offen offset:3072  lds
    s_nop 0
L_back_w2:
    s_waitcnt vmcnt(0)
    s_barrier
    s_barrier
    s_add_u32 s50, s58, 1572864
    s_cmp_ge_u32 s50, s59
    s_cselect_b32 s48, 4718592, 0
    s_sub_u32 s50, s50, s48
    s_add_u32 m0, s68, 0
    s_nop 0
    buffer_load_dwordx4 v56, s[44:47], s50 offen offset:0  lds
    buffer_load_dwordx4 v57, s[44:47], s50 offen offset:1024  lds
    buffer_load_dwordx4 v58, s[44:47], s50 offen offset:2048  lds
    buffer_load_dwordx4 v59, s[44:47], s50 offen offset:3072  lds
    s_add_u32 m0, s68, 4096
    s_nop 0
    buffer_load_dwordx4 v60, s[44:47], s50 offen offset:0  lds
    buffer_load_dwordx4 v61, s[44:47], s50 offen offset:1024  lds
    buffer_load_dwordx4 v62, s[44:47], s50 offen offset:2048  lds
    buffer_load_dwordx4 v63, s[44:47], s50 offen offset:3072  lds
    s_barrier
    s_add_u32 s50, s58, 1835008
    s_cmp_ge_u32 s50, s59
    s_cselect_b32 s48, 4718592, 0
    s_sub_u32 s50, s50, s48
    s_add_u32 m0, s68, 16384
    s_nop 0
    buffer_load_dwordx4 v56, s[44:47], s50 offen offset:0  lds
    buffer_load_dwordx4 v57, s[44:47], s50 offen offset:1024  lds
    buffer_load_dwordx4 v58, s[44:47], s50 offen offset:2048  lds
    buffer_load_dwordx4 v59, s[44:47], s50 offen offset:3072  lds
    s_add_u32 m0, s68, 20480
    s_nop 0
    buffer_load_dwordx4 v60, s[44:47], s50 offen offset:0  lds
    buffer_load_dwordx4 v61, s[44:47], s50 offen offset:1024  lds
    buffer_load_dwordx4 v62, s[44:47], s50 offen offset:2048  lds
    buffer_load_dwordx4 v63, s[44:47], s50 offen offset:3072  lds
    s_add_u32 s50, s58, 2097152
    s_cmp_ge_u32 s50, s59
    s_cselect_b32 s48, 4718592, 0
    s_sub_u32 s50, s50, s48
    s_add_u32 m0, s68, 32768
    s_nop 0
    buffer_load_dwordx4 v56, s[44:47], s50 offen offset:0  lds
    buffer_load_dwordx4 v57, s[44:47], s50 offen offset:1024  lds
    buffer_load_dwordx4 v58, s[44:47], s50 offen offset:2048  lds
    buffer_load_dwordx4 v59, s[44:47], s50 offen offset:3072  lds
    s_add_u32 m0, s68, 36864
    s_nop 0
    buffer_load_dwordx4 v60, s[44:47], s50 offen offset:0  lds
    buffer_load_dwordx4 v61, s[44:47], s50 offen offset:1024  lds
    buffer_load_dwordx4 v62, s[44:47], s50 offen offset:2048  lds
    buffer_load_dwordx4 v63, s[44:47], s50 offen offset:3072  lds
    s_add_u32 s50, s58, 2359296
    s_cmp_ge_u32 s50, s59
    s_cselect_b32 s48, 4718592, 0
    s_sub_u32 s50, s50, s48
    s_add_u32 m0, s68, 49152
    s_nop 0
    buffer_load_dwordx4 v56, s[44:47], s50 offen offset:0  lds
    buffer_load_dwordx4 v57, s[44:47], s50 offen offset:1024  lds
    buffer_load_dwordx4 v58, s[44:47], s50 offen offset:2048  lds
    buffer_load_dwordx4 v59, s[44:47], s50 offen offset:3072  lds
    s_add_u32 m0, s68, 53248
    s_nop 0
    buffer_load_dwordx4 v60, s[44:47], s50 offen offset:0  lds
    buffer_load_dwordx4 v61, s[44:47], s50 offen offset:1024  lds
    buffer_load_dwordx4 v62, s[44:47], s50 offen offset:2048  lds
    buffer_load_dwordx4 v63, s[44:47], s50 offen offset:3072  lds
    v_mov_b64 v[100:101], -1
    v_mov_b64 v[102:103], -1
    v_mov_b32 v104, v3
    v_mov_b32 v105, v3
    v_mov_b32 v106, v3
    v_mov_b32 v107, v3
    v_lshlrev_b32 v110, 4, v0
    s_lshl_b32 s48, s2, 7
    s_add_u32 s48, s48, 38797312
    v_add_u32 v108, s48, v110
    s_cmp_eq_u32 s62, 0
    s_cselect_b32 s48, 8, 0
    v_cmp_gt_u32 vcc, s48, v0
    v_mov_b32 v109, 2146435072
    s_nop 0
    v_cndmask_b32 v108, v109, v108, vcc
    v_min_u32 v109, 2, v0
    v_add_u32 v109, 1, v109
    v_lshlrev_b32 v109, 1, v109
    v_xor_b32 v109, s2, v109
    v_lshlrev_b32 v109, 7, v109
    v_add_u32 v109, 38797312, v109
    v_lshlrev_b32 v111, 4, v0
    s_mul_i32 s56, s2, 27648
    s_lshl_b32 s48, s62, 10
    s_add_u32 s56, s56, s48
    s_add_u32 s56, s56, 27262976
    s_waitcnt vmcnt(24)
    s_barrier
    s_add_u32 s50, s58, 2621440
    s_cmp_ge_u32 s50, s59
    s_cselect_b32 s48, 4718592, 0
    s_sub_u32 s50, s50, s48
    s_add_u32 m0, s68, 65536
    s_nop 0
    buffer_load_dwordx4 v56, s[44:47], s50 offen offset:0  lds
    buffer_load_dwordx4 v57, s[44:47], s50 offen offset:1024  lds
    buffer_load_dwordx4 v58, s[44:47], s50 offen offset:2048  lds
    buffer_load_dwordx4 v59, s[44:47], s50 offen offset:3072  lds
    s_waitcnt vmcnt(20)
    s_barrier
    s_add_u32 m0, s68, 69632
    s_nop 0
    buffer_load_dwordx4 v60, s[44:47], s50 offen offset:0  lds
    buffer_load_dwordx4 v61, s[44:47], s50 offen offset:1024  lds
    buffer_load_dwordx4 v62, s[44:47], s50 offen offset:2048  lds
    buffer_load_dwordx4 v63, s[44:47], s50 offen offset:3072  lds
    s_waitcnt vmcnt(16)
    s_barrier
    s_add_u32 s57, s56, 0
    buffer_store_dwordx4 v[100:103], v111, s[36:39], s57 offen sc1
    s_add_u32 s50, s58, 2883584
    s_cmp_ge_u32 s50, s59
    s_cselect_b32 s48, 4718592, 0
    s_sub_u32 s50, s50, s48
    s_add_u32 m0, s68, 0
    s_nop 0
    buffer_load_dwordx4 v56, s[44:47], s50 offen offset:0  lds
    buffer_load_dwordx4 v57, s[44:47], s50 offen offset:1024  lds
    buffer_load_dwordx4 v58, s[44:47], s50 offen offset:2048  lds
    buffer_load_dwordx4 v59, s[44:47], s50 offen offset:3072  lds
    s_waitcnt vmcnt(13)
    s_barrier
    s_add_u32 s57, s56, 2048
    buffer_store_dwordx4 v[100:103], v111, s[36:39], s57 offen sc1
    s_add_u32 s57, s56, 4096
    buffer_store_dwordx4 v[100:103], v111, s[36:39], s57 offen sc1
    s_add_u32 m0, s68, 4096
    s_nop 0
    buffer_load_dwordx4 v60, s[44:47], s50 offen offset:0  lds
    buffer_load_dwordx4 v61, s[44:47], s50 offen offset:1024  lds
    buffer_load_dwordx4 v62, s[44:47], s50 offen offset:2048  lds
    buffer_load_dwordx4 v63, s[44:47], s50 offen offset:3072  lds
    s_barrier
    s_add_u32 s57, s56, 6144
    buffer_store_dwordx4 v[100:103], v111, s[36:39], s57 offen sc1
    s_add_u32 s57, s56, 8192
    buffer_store_dwordx4 v[100:103], v111, s[36:39], s57 offen sc1
    s_add_u32 s50, s58, 3145728
    s_cmp_ge_u32 s50, s59
    s_cselect_b32 s48, 4718592, 0
    s_sub_u32 s50, s50, s48
    s_add_u32 m0, s68, 16384
    s_nop 0
    buffer_load_dwordx4 v56, s[44:47], s50 offen offset:0  lds
    buffer_load_dwordx4 v57, s[44:47], s50 offen offset:1024  lds
    buffer_load_dwordx4 v58, s[44:47], s50 offen offset:2048  lds
    buffer_load_dwordx4 v59, s[44:47], s50 offen offset:3072  lds
    s_waitcnt vmcnt(17)
    s_barrier
    s_add_u32 s57, s56, 10240
    buffer_store_dwordx4 v[100:103], v111, s[36:39], s57 offen sc1
    s_add_u32 s57, s56, 12288
    buffer_store_dwordx4 v[100:103], v111, s[36:39], s57 offen sc1
    s_add_u32 m0, s68, 20480
    s_nop 0
    buffer_load_dwordx4 v60, s[44:47], s50 offen offset:0  lds
    buffer_load_dwordx4 v61, s[44:47], s50 offen offset:1024  lds
    buffer_load_dwordx4 v62, s[44:47], s50 offen offset:2048  lds
    buffer_load_dwordx4 v63, s[44:47], s50 offen offset:3072  lds
    s_barrier
    s_add_u32 s57, s56, 14336
    buffer_store_dwordx4 v[100:103], v111, s[36:39], s57 offen sc1
    s_add_u32 s50, s58, 3407872
    s_cmp_ge_u32 s50, s59
    s_cselect_b32 s48, 4718592, 0
    s_sub_u32 s50, s50, s48
    s_add_u32 m0, s68, 32768
    s_nop 0
    buffer_load_dwordx4 v56, s[44:47], s50 offen offset:0  lds
    buffer_load_dwordx4 v57, s[44:47], s50 offen offset:1024  lds
    buffer_load_dwordx4 v58, s[44:47], s50 offen offset:2048  lds
    buffer_load_dwordx4 v59, s[44:47], s50 offen offset:3072  lds
    s_waitcnt vmcnt(17)
    s_barrier
    s_add_u32 s57, s56, 16384
    buffer_store_dwordx4 v[100:103], v111, s[36:39], s57 offen sc1
    s_add_u32 s57, s56, 18432
    buffer_store_dwordx4 v[100:103], v111, s[36:39], s57 offen sc1
    s_add_u32 m0, s68, 36864
    s_nop 0
    buffer_load_dwordx4 v60, s[44:47], s50 offen offset:0  lds
    buffer_load_dwordx4 v61, s[44:47], s50 offen offset:1024  lds
    buffer_load_dwordx4 v62, s[44:47], s50 offen offset:2048  lds
    buffer_load_dwordx4 v63, s[44:47], s50 offen offset:3072  lds
    s_barrier
    s_add_u32 s57, s56, 20480
    buffer_store_dwordx4 v[100:103], v111, s[36:39], s57 offen sc1
    s_add_u32 s57, s56, 22528
    buffer_store_dwordx4 v[100:103], v111, s[36:39], s57 offen sc1
    s_add_u32 s50, s58, 3670016
    s_cmp_ge_u32 s50, s59
    s_cselect_b32 s48, 4718592, 0
    s_sub_u32 s50, s50, s48
    s_add_u32 m0, s68, 49152
    s_nop 0
    buffer_load_dwordx4 v56, s[44:47], s50 offen offset:0  lds
    buffer_load_dwordx4 v57, s[44:47], s50 offen offset:1024  lds
    buffer_load_dwordx4 v58, s[44:47], s50 offen offset:2048  lds
    buffer_load_dwordx4 v59, s[44:47], s50 offen offset:3072  lds
    s_waitcnt vmcnt(17)
    s_barrier
    s_add_u32 s57, s56, 24576
    buffer_store_dwordx4 v[100:103], v111, s[36:39], s57 offen sc1
    s_mul_i32 s57, s62, -2048
    s_add_u32 s57, s57, 26624
    s_add_u32 s57, s57, s56
    buffer_store_dwordx4 v[100:103], v111, s[36:39], s57 offen sc1
    s_add_u32 m0, s68, 53248
    s_nop 0
    buffer_load_dwordx4 v60, s[44:47], s50 offen offset:0  lds
    buffer_load_dwordx4 v61, s[44:47], s50 offen offset:1024  lds
    buffer_load_dwordx4 v62, s[44:47], s50 offen offset:2048  lds
    buffer_load_dwordx4 v63, s[44:47], s50 offen offset:3072  lds
    s_barrier
    s_add_u32 s50, s58, 3932160
    s_cmp_ge_u32 s50, s59
    s_cselect_b32 s48, 4718592, 0
    s_sub_u32 s50, s50, s48
    s_add_u32 m0, s68, 65536
    s_nop 0
    buffer_load_dwordx4 v56, s[44:47], s50 offen offset:0  lds
    buffer_load_dwordx4 v57, s[44:47], s50 offen offset:1024  lds
    buffer_load_dwordx4 v58, s[44:47], s50 offen offset:2048  lds
    buffer_load_dwordx4 v59, s[44:47], s50 offen offset:3072  lds
    s_barrier
    s_add_u32 m0, s68, 69632
    s_nop 0
    buffer_load_dwordx4 v60, s[44:47], s50 offen offset:0  lds
    buffer_load_dwordx4 v61, s[44:47], s50 offen offset:1024  lds
    buffer_load_dwordx4 v62, s[44:47], s50 offen offset:2048  lds
    buffer_load_dwordx4 v63, s[44:47], s50 offen offset:3072  lds
    s_waitcnt vmcnt(12)
    s_barrier
    buffer_store_dwordx4 v[104:107], v108, s[36:39], 0 offen sc1
    s_add_u32 s50, s58, 4194304
    s_cmp_ge_u32 s50, s59
    s_cselect_b32 s48, 4718592, 0
    s_sub_u32 s50, s50, s48
    s_add_u32 m0, s68, 0
    s_nop 0
    buffer_load_dwordx4 v56, s[44:47], s50 offen offset:0  lds
    buffer_load_dwordx4 v57, s[44:47], s50 offen offset:1024  lds
    buffer_load_dwordx4 v58, s[44:47], s50 offen offset:2048  lds
    buffer_load_dwordx4 v59, s[44:47], s50 offen offset:3072  lds
    s_waitcnt vmcnt(25)
    s_barrier
    s_add_u32 m0, s68, 4096
    s_nop 0
    buffer_load_dwordx4 v60, s[44:47], s50 offen offset:0  lds
    buffer_load_dwordx4 v61, s[44:47], s50 offen offset:1024  lds
    buffer_load_dwordx4 v62, s[44:47], s50 offen offset:2048  lds
    buffer_load_dwordx4 v63, s[44:47], s50 offen offset:3072  lds
    s_waitcnt vmcnt(17)
    s_barrier
    s_add_u32 s50, s58, 4456448
    s_cmp_ge_u32 s50, s59
    s_cselect_b32 s48, 4718592, 0
    s_sub_u32 s50, s50, s48
    s_add_u32 m0, s68, 16384
    s_nop 0
    buffer_load_dwordx4 v56, s[44:47], s50 offen offset:0  lds
    buffer_load_dwordx4 v57, s[44:47], s50 offen offset:1024  lds
    buffer_load_dwordx4 v58, s[44:47], s50 offen offset:2048  lds
    buffer_load_dwordx4 v59, s[44:47], s50 offen offset:3072  lds
    s_waitcnt vmcnt(13)
    s_barrier
    buffer_load_dword v110, v109, s[36:39], 0 offen sc1
    s_add_u32 m0, s68, 20480
    s_nop 0
    buffer_load_dwordx4 v60, s[44:47], s50 offen offset:0  lds
    buffer_load_dwordx4 v61, s[44:47], s50 offen offset:1024  lds
    buffer_load_dwordx4 v62, s[44:47], s50 offen offset:2048  lds
    buffer_load_dwordx4 v63, s[44:47], s50 offen offset:3072  lds
    s_waitcnt vmcnt(9)
    s_barrier
    s_waitcnt vmcnt(0)
    s_waitcnt vmcnt(4)
    v_cmp_ne_u32 vcc, v3, v110
    s_nop 0
    s_cbranch_vccz L_m_105
Lp_m_106:
    buffer_load_dword v110, v109, s[36:39], 0 offen sc1
    s_waitcnt vmcnt(0)
    v_cmp_ne_u32 vcc, v3, v110
    s_nop 0
    s_cbranch_vccz Le_m_107
    s_sub_u32 s7, s7, 1
    s_cbranch_scc1 Le_m_107
    s_mov_b64 exec, vcc
    s_sleep 1
    s_branch Lp_m_106
Le_m_107:
    s_mov_b64 exec, -1
    s_max_i32 s7, s7, 0
L_m_105:
    s_barrier
    s_barrier
L_m_100:
    v_lshlrev_b32 v100, 4, v0
    v_lshlrev_b32 v101, 2, v0
    s_mul_i32 s48, s3, 2304
    s_mul_i32 s60, s2, 27648
    s_add_u32 s60, s60, s48
    s_add_u32 s60, s60, 27272192
    s_add_u32 s61, s60, 9216
    s_mul_i32 s63, s3, 4608
    s_add_u32 s63, s63, 49152
    v_add_u32 v102, s63, v100
    v_add_u32 v103, s63, v101
Lp_m_108:
    s_add_u32 m0, s63, 2304
    s_nop 0
    buffer_load_dwordx4 v100, s[36:39], s61 offen sc1 lds
    buffer_load_dwordx4 v100, s[36:39], s61 offen offset:1024 sc1 lds
    buffer_load_dword v101, s[36:39], s61 offen offset:2048 sc1 lds
    s_add_u32 m0, s63, 0
    s_nop 0
    buffer_load_dwordx4 v100, s[36:39], s60 offen sc1 lds
    buffer_load_dwordx4 v100, s[36:39], s60 offen offset:1024 sc1 lds
    buffer_load_dword v101, s[36:39], s60 offen offset:2048 sc1 lds
    s_waitcnt vmcnt(0)
    ds_read_b32 v104, v102 offset:0
    ds_read_b32 v105, v102 offset:1024
    ds_read_b32 v106, v103 offset:2048
    ds_read_b32 v107, v102 offset:2304
    ds_read_b32 v108, v102 offset:3328
    ds_read_b32 v109, v103 offset:4352
    s_waitcnt lgkmcnt(3)
    v_max3_u32 v110, v104, v105, v106
    s_waitcnt lgkmcnt(2)
    v_max_u32 v110, v110, v107
    s_waitcnt lgkmcnt(1)
    v_max_u32 v110, v110, v108
    s_waitcnt lgkmcnt(0)
    v_max_u32 v110, v110, v109
    v_cmp_eq_u32 vcc, -1, v110
    s_nop 0
    s_cbranch_vccz Le_m_109
    s_sub_u32 s7, s7, 1
    s_cbranch_scc1 Le_m_109
    s_sleep 1
    s_branch Lp_m_108
Le_m_109:
    s_max_i32 s7, s7, 0
    s_barrier
L_end:
L_exit:
    s_endpgm
L_code_end:
.section .rodata,"a"
.p2align 6
.amdhsa_kernel adaLN_cond__spectral_gfnet__mixer_token_mlp__prompt_kernel
  .amdhsa_next_free_vgpr 256
  .amdhsa_next_free_sgpr 70
  .amdhsa_accum_offset 256
  .amdhsa_group_segment_fixed_size 0
  .amdhsa_kernarg_size 104
  .amdhsa_user_sgpr_count 2
  .amdhsa_user_sgpr_kernarg_segment_ptr 1
  .amdhsa_system_sgpr_workgroup_id_x 1
.end_amdhsa_kernel
```

```asm
; @launch grid=(256,1,1) block=(512,1,1) lds=163840
.amdgcn_target "amdgcn-amd-amdhsa--gfx950"
.text
.globl adaLN_cond__spectral_gfnet__mixer_token_mlp__prompt_kernel
.p2align 8
.type adaLN_cond__spectral_gfnet__mixer_token_mlp__prompt_kernel,@function
adaLN_cond__spectral_gfnet__mixer_token_mlp__prompt_kernel:
    s_cmp_ge_u32 s2, 256
    s_cbranch_scc1 L_exit
    s_load_dwordx16 s[8:23], s[0:1], 0
    s_load_dwordx8 s[24:31], s[0:1], 64
    s_load_dwordx2 s[32:33], s[0:1], 96
    v_readfirstlane_b32 s4, v0
    s_lshr_b32 s5, s2, 3
    s_lshr_b32 s4, s4, 6
    s_cmp_lg_u32 s4, s5
    s_cbranch_scc1 L_nopf
    s_getpc_b64 s[52:53]
L_pc:
    s_sub_u32 s52, s52, L_pc-adaLN_cond__spectral_gfnet__mixer_token_mlp__prompt_kernel
    s_subb_u32 s53, s53, 0
    s_mov_b32 s54, L_code_end-adaLN_cond__spectral_gfnet__mixer_token_mlp__prompt_kernel
    s_mov_b32 s55, 0x20000
    v_lshlrev_b32 v1, 7, v0
    buffer_load_dword v255, v1, s[52:55], 0 offen
    v_add_u32 v1, 65536, v1
    buffer_load_dword v255, v1, s[52:55], 0 offen
L_nopf:
    v_lshrrev_b32 v1, 6, v0
    v_and_b32 v0, 63, v0
    v_readfirstlane_b32 s34, v1
    v_and_b32 v1, 15, v0
    v_lshrrev_b32 v2, 4, v0
    s_and_b32 s4, s2, 7
    s_lshr_b32 s5, s2, 3
    s_lshl_b32 s6, s4, 5
    s_add_u32 s6, s6, s5
    s_mov_b32 s7, 100000
    s_and_b32 s3, s34, 3
    s_cmp_ge_u32 s34, 4
    s_cbranch_scc0 L_C
L_H:
    v_lshlrev_b32 v16, 4, v0
    v_mov_b32 v30, 2146435072
    v_mov_b32 v12, 2146435072
    v_mov_b32 v18, 2146435072
    s_sub_u32 s63, 255, s2
    s_mul_i32 s62, s63, 171
    s_lshr_b32 s62, s62, 9
    s_mul_i32 s48, s62, 3
    s_sub_u32 s61, s63, s48
    s_cmp_ge_u32 s63, 54
    s_cbranch_scc1 L_m_30
    v_lshrrev_b32 v4, 3, v0
    v_and_b32 v5, 7, v0
    v_and_b32 v6, 6, v4
    v_xor_b32 v5, v5, v6
    v_mul_u32_u24 v4, 6912, v4
    v_lshl_add_u32 v12, v5, 4, v4
    s_lshl_b32 s48, s61, 2
    s_add_u32 s48, s48, s3
    s_mul_i32 s48, s48, 331776
    s_lshl_b32 s49, s62, 7
    s_add_u32 s47, s48, s49
    s_lshl_b32 s50, s3, 8
    v_lshl_add_u32 v27, v0, 2, s50
    s_mul_i32 s49, s61, 384
    v_add_u32 v9, s49, v27
    v_add_u32 v12, s47, v12
    s_waitcnt lgkmcnt(0)
    s_mov_b32 s40, s26
    s_mov_b32 s41, s27
    s_mov_b32 s42, 3981312
    s_mov_b32 s43, 0x20000
    s_mul_i32 m0, s3, 6144
    s_mov_b32 s59, 0
    buffer_load_dwordx4 v12, s[40:43], s59 offen lds
    s_add_u32 m0, m0, 1024
    s_add_u32 s59, s59, 55296
    buffer_load_dwordx4 v12, s[40:43], s59 offen lds
    s_add_u32 m0, m0, 1024
    s_add_u32 s59, s59, 55296
    buffer_load_dwordx4 v12, s[40:43], s59 offen lds
    s_add_u32 m0, m0, 1024
    s_add_u32 s59, s59, 55296
    buffer_load_dwordx4 v12, s[40:43], s59 offen lds
    s_add_u32 m0, m0, 1024
    s_add_u32 s59, s59, 55296
    buffer_load_dwordx4 v12, s[40:43], s59 offen lds
    s_add_u32 m0, m0, 1024
    s_add_u32 s59, s59, 55296
    buffer_load_dwordx4 v12, s[40:43], s59 offen lds
    s_mov_b32 s44, s24
    s_mov_b32 s45, s25
    s_mov_b32 s46, 1152
    s_mov_b32 s47, 0x20000
    buffer_load_dword v26, v9, s[44:47], 0 offen
    s_mov_b32 s36, s32
    s_mov_b32 s37, s33
    s_mov_b32 s38, 50331648
    s_mov_b32 s39, 0x20000
    v_mov_b32 v7, 32768
    buffer_load_dword v3, v7, s[36:39], 0 offen sc1
    v_lshrrev_b32 v4, 2, v0
    v_bfe_u32 v5, v4, 1, 2
    v_xor_b32 v5, s3, v5
    v_lshlrev_b32 v5, 5, v5
    v_lshlrev_b32 v4, 7, v4
    v_and_b32 v6, 3, v0
    v_lshlrev_b32 v6, 3, v6
    v_add3_u32 v28, v4, v5, v6
    v_lshlrev_b32 v29, 3, v2
    v_add_u32 v29, 90112, v29
    s_mul_i32 s48, s3, 3456
    s_mul_i32 s49, s61, 1152
    s_add_u32 s48, s48, s49
    s_lshl_b32 s49, s62, 6
    s_add_u32 s48, s48, s49
    s_add_u32 s48, s48, 15204352
    v_mul_u32_u24 v4, 13824, v2
    v_lshl_add_u32 v4, v1, 2, v4
    v_add_u32 v30, s48, v4
    v_add_u32 v31, 55296, v30
    v_mov_b32 v5, 0
    s_mov_b32 s48, 0
    buffer_store_dword v5, v30, s[36:39], s48 offen sc1
    buffer_store_dword v5, v31, s[36:39], s48 offen sc1
    s_lshr_b32 s51, s5, 2
    s_lshl_b32 s51, s51, 3
    s_add_u32 s51, s51, s4
    s_and_b32 s60, s5, 3
    s_lshl_b32 s35, s51, 2
    s_add_u32 s35, s35, s60
    s_lshl_b32 s35, s35, 14
    s_bfe_u32 s48, s6, 0x20002
    s_lshl_b32 s48, s48, 6
    s_lshr_b32 s49, s6, 4
    s_lshl_b32 s49, s49, 2
    s_add_u32 s48, s48, s49
    s_and_b32 s49, s6, 3
    s_add_u32 s48, s48, s49
    s_lshl_b32 s48, s48, 4
    s_lshl_b32 s49, s3, 16
    s_add_u32 s48, s48, s49
    s_add_u32 s48, s48, 15728640
    v_mov_b32 v17, 2146435072
    v_writelane_b32 v17, s48, 0
    s_add_u32 s48, s48, 16384
    s_add_u32 s48, s2, 160
    s_lshl_b32 s48, s48, 7
    s_add_u32 s48, s48, 557056
    s_lshl_b32 s49, s3, 8
    s_add_u32 s49, s49, s5
    s_cmp_lt_u32 s49, 12
    s_cselect_b32 s48, s48, 2146435072
    v_mov_b32 v19, 2146435072
    v_writelane_b32 v19, s48, 0
    s_or_b32 s48, s2, s3
    s_cmp_eq_u32 s48, 0
    s_cselect_b32 s48, 0, 2146435072
    s_add_u32 s48, s48, 32768
    v_writelane_b32 v19, s48, 1
    buffer_load_dword v220, v17, s[36:39], 0 offen
    s_waitcnt vmcnt(3)
    s_setprio 2
    v_lshlrev_b32 v4, 16, v26
    v_and_b32 v5, 0xffff0000, v26
    v_mul_f32 v6, 0xbfb8aa3b, v4
    v_mul_f32 v7, 0xbfb8aa3b, v5
    v_exp_f32 v6, v6
    v_exp_f32 v7, v7
    v_add_f32 v6, 1.0, v6
    v_add_f32 v7, 1.0, v7
    v_rcp_f32 v6, v6
    v_rcp_f32 v7, v7
    v_mul_f32 v4, v4, v6
    v_mul_f32 v5, v5, v7
    v_cvt_pk_bf16_f32 v26, v4, v5
    v_add_u32 v27, 90112, v27
    ds_write_b32 v27, v26
    s_mov_b32 s48, 0x9e3779b1
    v_mul_lo_u32 v3, v3, s48
    v_add_u32 v3, 0x7f4a7c15, v3
    v_or_b32 v3, 0x01010101, v3
    s_waitcnt lgkmcnt(0)
    s_barrier
    ds_read_b64_tr_b16 v[132:133], v28 offset:0
    ds_read_b64_tr_b16 v[134:135], v28 offset:2048
    ds_read2_b64 v[136:139], v29 offset0:0 offset1:4
    ds_read_b64_tr_b16 v[140:141], v28 offset:4096
    ds_read_b64_tr_b16 v[142:143], v28 offset:6144
    ds_read2_b64 v[144:147], v29 offset0:8 offset1:12
    ds_read_b64_tr_b16 v[148:149], v28 offset:8192
    ds_read_b64_tr_b16 v[150:151], v28 offset:10240
    ds_read2_b64 v[152:155], v29 offset0:16 offset1:20
    ds_read_b64_tr_b16 v[156:157], v28 offset:12288
    ds_read_b64_tr_b16 v[158:159], v28 offset:14336
    ds_read2_b64 v[160:163], v29 offset0:24 offset1:28
    ds_read_b64_tr_b16 v[164:165], v28 offset:16384
    ds_read_b64_tr_b16 v[166:167], v28 offset:18432
    ds_read2_b64 v[168:171], v29 offset0:32 offset1:36
    ds_read_b64_tr_b16 v[172:173], v28 offset:20480
    ds_read_b64_tr_b16 v[174:175], v28 offset:22528
    ds_read2_b64 v[176:179], v29 offset0:40 offset1:44
    v_and_b32 v4, 3, v1
    v_or_b32 v4, 0x07060500, v4
    s_waitcnt lgkmcnt(14)
    v_mfma_f32_16x16x32_bf16 v[36:39], v[136:139], v[132:135], 0
    s_waitcnt lgkmcnt(12)
    v_mfma_f32_16x16x32_bf16 v[36:39], v[144:147], v[140:143], v[36:39]
    s_waitcnt lgkmcnt(9)
    v_mfma_f32_16x16x32_bf16 v[36:39], v[152:155], v[148:151], v[36:39]
    s_waitcnt lgkmcnt(6)
    v_mfma_f32_16x16x32_bf16 v[36:39], v[160:163], v[156:159], v[36:39]
    s_waitcnt lgkmcnt(3)
    v_mfma_f32_16x16x32_bf16 v[36:39], v[168:171], v[164:167], v[36:39]
    s_waitcnt lgkmcnt(0)
    v_mfma_f32_16x16x32_bf16 v[36:39], v[176:179], v[172:175], v[36:39]
    s_nop 7
    v_add_u32 v40, 0x80, v36
    v_perm_b32 v40, v40, v3, v4
    s_waitcnt vmcnt(1)
    s_mov_b32 s48, 0
    buffer_store_dword v40, v30, s[36:39], s48 offen sc1
    buffer_store_dword v40, v31, s[36:39], s48 offen sc1
    s_setprio 0
    s_mov_b32 s63, 999
    s_branch L_m_34
L_C:
    v_lshrrev_b32 v18, 5, v0
    v_and_b32 v19, 31, v0
    v_mul_u32_u24 v20, 294912, v18
    v_lshl_add_u32 v20, v19, 2, v20
    s_mul_i32 s62, s3, 589824
    s_mul_i32 s48, s6, 1152
    s_add_u32 s62, s62, s48
    s_waitcnt lgkmcnt(0)
    s_mov_b32 s40, s8
    s_mov_b32 s41, s9
    s_mov_b32 s42, 2359296
    s_mov_b32 s43, 0x20000
    buffer_load_dword v9, v20, s[40:43], s62 offen offset:0
    buffer_load_dword v10, v20, s[40:43], s62 offen offset:128
    buffer_load_dword v11, v20, s[40:43], s62 offen offset:256
    buffer_load_dword v12, v20, s[40:43], s62 offen offset:384
    buffer_load_dword v13, v20, s[40:43], s62 offen offset:512
    buffer_load_dword v14, v20, s[40:43], s62 offen offset:640
    buffer_load_dword v15, v20, s[40:43], s62 offen offset:768
    buffer_load_dword v16, v20, s[40:43], s62 offen offset:896
    buffer_load_dword v17, v20, s[40:43], s62 offen offset:1024
    s_mov_b32 s36, s32
    s_mov_b32 s37, s33
    s_mov_b32 s38, 50331648
    s_mov_b32 s39, 0x20000
    v_mov_b32 v21, 32768
    buffer_load_dword v3, v21, s[36:39], 0 offen sc1
    s_mul_i32 s52, s4, 27
    s_add_u32 s52, s52, s5
    s_mul_i32 s51, s52, 171
    s_lshr_b32 s51, s51, 10
    s_mul_i32 s48, s51, 6
    s_sub_u32 s52, s52, s48
    s_lshr_b32 s53, s4, 1
    s_and_b32 s54, s4, 1
    s_lshl_b32 s54, s54, 3
    s_lshr_b32 s48, s5, 2
    s_add_u32 s54, s54, s48
    s_and_b32 s55, s5, 3
    s_mov_b32 s44, s18
    s_mov_b32 s45, s19
    s_mov_b32 s46, 9216
    s_mov_b32 s47, 0x20000
    s_mov_b32 s64, s22
    s_mov_b32 s65, s23
    s_mov_b32 s66, 4096
    s_mov_b32 s67, 0x20000
    s_lshl_b32 s48, s51, 8
    s_lshl_b32 s49, s3, 6
    s_add_u32 s48, s48, s49
    v_lshl_add_u32 v22, v2, 3, s48
    buffer_load_dwordx2 v[4:5], v22, s[44:47], 0 offen
    buffer_load_dwordx2 v[6:7], v22, s[44:47], 0 offen offset:32
    s_lshl_b32 s48, s54, 8
    s_add_u32 s48, s48, s49
    s_lshr_b32 s49, s53, 1
    s_lshl_b32 s49, s49, 5
    s_add_u32 s48, s48, s49
    v_lshl_add_u32 v23, v1, 1, s48
    buffer_load_ushort v8, v23, s[64:67], 0 offen
    s_bfe_u32 s56, s6, 0x10002
    s_lshl_b32 s56, s56, 7
    s_lshr_b32 s57, s6, 3
    s_lshl_b32 s57, s57, 2
    s_add_u32 s56, s56, s57
    s_and_b32 s57, s6, 3
    s_add_u32 s56, s56, s57
    s_lshl_b32 s48, s56, 4
    s_lshl_b32 s49, s3, 16
    s_add_u32 s48, s48, s49
    s_add_u32 s48, s48, 16252928
    v_mov_b32 v24, 2146435072
    v_writelane_b32 v24, s48, 0
    s_add_u32 s48, s48, 16384
    s_lshl_b32 s56, s52, 6
    s_add_u32 s56, s56, s51
    s_lshl_b32 s48, s56, 4
    s_lshl_b32 s49, s3, 16
    s_add_u32 s48, s48, s49
    s_add_u32 s48, s48, 16515072
    v_mov_b32 v25, 2146435072
    v_writelane_b32 v25, s48, 0
    s_add_u32 s48, s48, 16384
    s_add_u32 s48, s2, 216
    s_lshl_b32 s48, s48, 7
    s_add_u32 s48, s48, 622592
    s_lshl_b32 s49, s3, 8
    s_add_u32 s49, s49, s5
    s_cmp_lt_u32 s49, 5
    s_cselect_b32 s48, s48, 2146435072
    v_writelane_b32 v25, s48, 8
    buffer_load_dword v90, v24, s[36:39], 0 offen
    buffer_load_dword v91, v25, s[36:39], 0 offen
    s_branch L_aligned
.p2align 12
L_aligned:
    v_lshlrev_b32 v36, 4, v0
    v_mul_u32_u24 v148, 1184, v18
    v_lshl_add_u32 v148, v19, 2, v148
    s_mul_i32 s48, s3, 2368
    s_add_u32 s48, s48, 100352
    v_add_u32 v148, s48, v148
    v_lshrrev_b32 v220, 1, v1
    v_and_b32 v221, 1, v1
    v_and_b32 v222, 1, v220
    v_cvt_f32_u32 v220, v220
    v_cvt_f32_u32 v221, v221
    v_mul_f32 v220, 0x3e000000, v220
    v_mul_f32 v221, 0x3e800000, v221
    v_mul_u32_u24 v222, 0x8000, v222
    v_lshl_or_b32 v222, v222, 16, v222
    s_lshl_b32 s48, s3, 10
    s_add_u32 s48, s48, 109952
    v_add_u32 v223, s48, v36
    s_mov_b32 s63, 0x3de38e39
    s_add_u32 s48, s3, 0
    s_mul_i32 s49, s48, 43
    s_lshr_b32 s49, s49, 7
    s_mul_i32 s50, s49, 3
    s_sub_u32 s50, s48, s50
    s_lshl_b32 s50, s50, 2
    v_add_u32 v224, s50, v2
    v_cmp_gt_u32 vcc, 9, v224
    v_mul_u32_u24 v224, s49, v224
    v_cvt_f32_u32 v224, v224
    v_fma_f32 v224, v224, s63, v221
    v_add_f32 v225, v224, v220
    v_fma_f32 v226, v220, 2.0, v224
    v_add_f32 v227, v226, v220
    v_cos_f32 v224, v224
    v_cos_f32 v225, v225
    v_cos_f32 v226, v226
    v_cos_f32 v227, v227
    v_cvt_pk_bf16_f32 v232, v224, v225
    v_cvt_pk_bf16_f32 v233, v226, v227
    v_cndmask_b32 v232, 0, v232, vcc
    v_cndmask_b32 v233, 0, v233, vcc
    v_xor_b32 v234, v222, v232
    v_xor_b32 v235, v222, v233
    ds_write_b128 v223, v[232:235] offset:0
    s_add_u32 s48, s3, 4
    s_mul_i32 s49, s48, 43
    s_lshr_b32 s49, s49, 7
    s_mul_i32 s50, s49, 3
    s_sub_u32 s50, s48, s50
    s_lshl_b32 s50, s50, 2
    v_add_u32 v224, s50, v2
    v_cmp_gt_u32 vcc, 9, v224
    v_mul_u32_u24 v224, s49, v224
    v_cvt_f32_u32 v224, v224
    v_fma_f32 v224, v224, s63, v221
    v_add_f32 v225, v224, v220
    v_fma_f32 v226, v220, 2.0, v224
    v_add_f32 v227, v226, v220
    v_cos_f32 v224, v224
    v_cos_f32 v225, v225
    v_cos_f32 v226, v226
    v_cos_f32 v227, v227
    v_cvt_pk_bf16_f32 v236, v224, v225
    v_cvt_pk_bf16_f32 v237, v226, v227
    v_cndmask_b32 v236, 0, v236, vcc
    v_cndmask_b32 v237, 0, v237, vcc
    v_xor_b32 v238, v222, v236
    v_xor_b32 v239, v222, v237
    ds_write_b128 v223, v[236:239] offset:4096
    s_add_u32 s48, s3, 8
    s_mul_i32 s49, s48, 43
    s_lshr_b32 s49, s49, 7
    s_mul_i32 s50, s49, 3
    s_sub_u32 s50, s48, s50
    s_lshl_b32 s50, s50, 2
    v_add_u32 v224, s50, v2
    v_cmp_gt_u32 vcc, 9, v224
    v_mul_u32_u24 v224, s49, v224
    v_cvt_f32_u32 v224, v224
    v_fma_f32 v224, v224, s63, v221
    v_add_f32 v225, v224, v220
    v_fma_f32 v226, v220, 2.0, v224
    v_add_f32 v227, v226, v220
    v_cos_f32 v224, v224
    v_cos_f32 v225, v225
    v_cos_f32 v226, v226
    v_cos_f32 v227, v227
    v_cvt_pk_bf16_f32 v232, v224, v225
    v_cvt_pk_bf16_f32 v233, v226, v227
    v_cndmask_b32 v232, 0, v232, vcc
    v_cndmask_b32 v233, 0, v233, vcc
    v_xor_b32 v234, v222, v232
    v_xor_b32 v235, v222, v233
    ds_write_b128 v223, v[232:235] offset:8192
    s_add_u32 s48, s3, 12
    s_mul_i32 s49, s48, 43
    s_lshr_b32 s49, s49, 7
    s_mul_i32 s50, s49, 3
    s_sub_u32 s50, s48, s50
    s_lshl_b32 s50, s50, 2
    v_add_u32 v224, s50, v2
    v_cmp_gt_u32 vcc, 9, v224
    v_mul_u32_u24 v224, s49, v224
    v_cvt_f32_u32 v224, v224
    v_fma_f32 v224, v224, s63, v221
    v_add_f32 v225, v224, v220
    v_fma_f32 v226, v220, 2.0, v224
    v_add_f32 v227, v226, v220
    v_cos_f32 v224, v224
    v_cos_f32 v225, v225
    v_cos_f32 v226, v226
    v_cos_f32 v227, v227
    v_cvt_pk_bf16_f32 v236, v224, v225
    v_cvt_pk_bf16_f32 v237, v226, v227
    v_cndmask_b32 v236, 0, v236, vcc
    v_cndmask_b32 v237, 0, v237, vcc
    v_xor_b32 v238, v222, v236
    v_xor_b32 v239, v222, v237
    ds_write_b128 v223, v[236:239] offset:12288
    v_lshrrev_b32 v22, 5, v0
    v_lshlrev_b32 v22, 2, v22
    s_lshl_b32 s48, s3, 3
    s_add_u32 s48, s48, 109824
    v_add_u32 v22, s48, v22
    v_bfe_u32 v18, v0, 2, 2
    v_mul_u32_u24 v18, 1184, v18
    v_and_b32 v19, 3, v0
    v_lshl_add_u32 v18, v19, 3, v18
    s_lshl_b32 s48, s3, 5
    s_add_u32 s48, s48, 100352
    v_add_u32 v19, s48, v18
    v_lshl_add_u32 v18, v2, 7, v19
    v_mov_b32 v20, 109824
    v_add_u32 v21, 109952, v36
    s_waitcnt vmcnt(14)
    ds_write_b32 v148, v9 offset:0
    v_lshlrev_b32 v106, 16, v9
    v_and_b32 v107, 0xffff0000, v9
    s_waitcnt vmcnt(13)
    ds_write_b32 v148, v10 offset:128
    v_lshlrev_b32 v108, 16, v10
    v_and_b32 v109, 0xffff0000, v10
    s_waitcnt vmcnt(12)
    ds_write_b32 v148, v11 offset:256
    v_lshlrev_b32 v110, 16, v11
    v_and_b32 v111, 0xffff0000, v11
    s_waitcnt vmcnt(11)
    ds_write_b32 v148, v12 offset:384
    v_lshlrev_b32 v112, 16, v12
    v_and_b32 v113, 0xffff0000, v12
    s_waitcnt vmcnt(10)
    ds_write_b32 v148, v13 offset:512
    v_lshlrev_b32 v114, 16, v13
    v_and_b32 v115, 0xffff0000, v13
    s_waitcnt vmcnt(9)
    ds_write_b32 v148, v14 offset:640
    v_lshlrev_b32 v116, 16, v14
    v_and_b32 v117, 0xffff0000, v14
    s_waitcnt vmcnt(8)
    ds_write_b32 v148, v15 offset:768
    v_lshlrev_b32 v118, 16, v15
    v_and_b32 v119, 0xffff0000, v15
    s_waitcnt vmcnt(7)
    ds_write_b32 v148, v16 offset:896
    v_lshlrev_b32 v120, 16, v16
    v_and_b32 v121, 0xffff0000, v16
    s_waitcnt vmcnt(6)
    ds_write_b32 v148, v17 offset:1024
    v_lshlrev_b32 v122, 16, v17
    v_and_b32 v123, 0xffff0000, v17
    v_pk_add_f32 v[24:25], v[106:107], v[108:109]
    v_pk_mul_f32 v[26:27], v[106:107], v[106:107]
    v_pk_fma_f32 v[26:27], v[108:109], v[108:109], v[26:27]
    v_pk_add_f32 v[24:25], v[24:25], v[110:111]
    v_pk_fma_f32 v[26:27], v[110:111], v[110:111], v[26:27]
    v_pk_add_f32 v[24:25], v[24:25], v[112:113]
    v_pk_fma_f32 v[26:27], v[112:113], v[112:113], v[26:27]
    v_pk_add_f32 v[24:25], v[24:25], v[114:115]
    v_pk_fma_f32 v[26:27], v[114:115], v[114:115], v[26:27]
    v_pk_add_f32 v[24:25], v[24:25], v[116:117]
    v_pk_fma_f32 v[26:27], v[116:117], v[116:117], v[26:27]
    v_pk_add_f32 v[24:25], v[24:25], v[118:119]
    v_pk_fma_f32 v[26:27], v[118:119], v[118:119], v[26:27]
    v_pk_add_f32 v[24:25], v[24:25], v[120:121]
    v_pk_fma_f32 v[26:27], v[120:121], v[120:121], v[26:27]
    v_pk_add_f32 v[24:25], v[24:25], v[122:123]
    v_pk_fma_f32 v[26:27], v[122:123], v[122:123], v[26:27]
    v_add_f32 v24, v24, v25
    v_add_f32 v25, v26, v27
    s_nop 0
    v_add_f32_dpp v24, v24, v24 quad_perm:[1,0,3,2] row_mask:0xf bank_mask:0xf
    v_add_f32_dpp v25, v25, v25 quad_perm:[1,0,3,2] row_mask:0xf bank_mask:0xf
    s_nop 0
    v_add_f32_dpp v24, v24, v24 quad_perm:[2,3,0,1] row_mask:0xf bank_mask:0xf
    v_add_f32_dpp v25, v25, v25 quad_perm:[2,3,0,1] row_mask:0xf bank_mask:0xf
    s_nop 0
    v_add_f32_dpp v24, v24, v24 row_half_mirror row_mask:0xf bank_mask:0xf
    v_add_f32_dpp v25, v25, v25 row_half_mirror row_mask:0xf bank_mask:0xf
    s_nop 0
    v_add_f32_dpp v24, v24, v24 row_mirror row_mask:0xf bank_mask:0xf
    v_add_f32_dpp v25, v25, v25 row_mirror row_mask:0xf bank_mask:0xf
    v_mov_b32 v26, v24
    v_mov_b32 v27, v25
    s_nop 0
    v_permlane16_swap_b32 v24, v26
    v_permlane16_swap_b32 v25, v27
    v_add_f32 v24, v24, v26
    v_add_f32 v25, v25, v27
    v_mul_f32 v24, 0xbae38e39, v24
    v_mul_f32 v25, 0x3ae38e39, v25
    v_fma_f32 v25, -v24, v24, v25
    v_max_f32 v25, 0, v25
    v_add_f32 v25, 0x3727c5ac, v25
    v_rsq_f32 v26, v25
    s_nop 0
    v_mul_f32 v24, v24, v26
    ds_write_b32 v22, v26
    ds_write_b32 v22, v24 offset:32
    s_waitcnt lgkmcnt(0)
    s_barrier
    ds_read_b128 v[132:135], v20 offset:0
    ds_read_b128 v[136:139], v20 offset:16
    ds_read_b128 v[140:143], v20 offset:32
    ds_read_b128 v[144:147], v20 offset:48
    ds_read_b64_tr_b16 v[148:149], v18 offset:0
    ds_read_b64_tr_b16 v[150:151], v18 offset:4736
    ds_read_b64_tr_b16 v[152:153], v18 offset:512
    ds_read_b64_tr_b16 v[154:155], v18 offset:5248
    ds_read_b64_tr_b16 v[156:157], v19 offset:1024
    ds_read_b64_tr_b16 v[158:159], v19 offset:5760
    ds_read_b128 v[160:163], v21 offset:0
    ds_read_b128 v[164:167], v21 offset:1024
    ds_read_b128 v[168:171], v21 offset:2048
    ds_read_b128 v[172:175], v21 offset:3072
    ds_read_b128 v[176:179], v21 offset:4096
    ds_read_b128 v[180:183], v21 offset:5120
    ds_read_b128 v[184:187], v21 offset:6144
    ds_read_b128 v[188:191], v21 offset:7168
    ds_read_b128 v[192:195], v21 offset:8192
    ds_read_b128 v[196:199], v21 offset:9216
    ds_read_b128 v[200:203], v21 offset:10240
    ds_read_b128 v[204:207], v21 offset:11264
    ds_read_b128 v[208:211], v21 offset:12288
    ds_read_b128 v[212:215], v21 offset:13312
    ds_read_b128 v[216:219], v21 offset:14336
    s_lshl_b32 s48, s3, 4
    v_add_u32 v24, s48, v1
    v_cvt_f32_u32 v24, v24
    v_mul_f32 v24, 0x3c800000, v24
    v_cvt_f32_u32 v26, v2
    v_mul_f32 v26, 4.0, v26
    v_mul_f32 v25, v26, v24
    v_cos_f32 v19, v25
    v_sin_f32 v20, v25
    s_nop 0
    v_cvt_pk_bf16_f32 v40, v19, v20
    v_cvt_pk_bf16_f32 v44, -v20, v19
    v_fma_f32 v21, v24, 1.0, v25
    v_cos_f32 v22, v21
    v_sin_f32 v23, v21
    s_nop 0
    v_cvt_pk_bf16_f32 v41, v22, v23
    v_cvt_pk_bf16_f32 v45, -v23, v22
    v_fma_f32 v18, v24, 2.0, v25
    v_cos_f32 v19, v18
    v_sin_f32 v20, v18
    s_nop 0
    v_cvt_pk_bf16_f32 v42, v19, v20
    v_cvt_pk_bf16_f32 v46, -v20, v19
    v_add_f32 v21, v18, v24
    v_cos_f32 v22, v21
    v_sin_f32 v23, v21
    s_nop 0
    v_cvt_pk_bf16_f32 v43, v22, v23
    v_cvt_pk_bf16_f32 v47, -v23, v22
    v_add_f32 v26, 0x41800000, v26
    v_mul_f32 v25, v26, v24
    v_cos_f32 v19, v25
    v_sin_f32 v20, v25
    s_nop 0
    v_cvt_pk_bf16_f32 v48, v19, v20
    v_cvt_pk_bf16_f32 v52, -v20, v19
    v_fma_f32 v21, v24, 1.0, v25
    v_cos_f32 v22, v21
    v_sin_f32 v23, v21
    s_nop 0
    v_cvt_pk_bf16_f32 v49, v22, v23
    v_cvt_pk_bf16_f32 v53, -v23, v22
    v_fma_f32 v18, v24, 2.0, v25
    v_cos_f32 v19, v18
    v_sin_f32 v20, v18
    s_nop 0
    v_cvt_pk_bf16_f32 v50, v19, v20
    v_cvt_pk_bf16_f32 v54, -v20, v19
    v_add_f32 v21, v18, v24
    v_cos_f32 v22, v21
    v_sin_f32 v23, v21
    s_nop 0
    v_cvt_pk_bf16_f32 v51, v22, v23
    v_cvt_pk_bf16_f32 v55, -v23, v22
    v_add_f32 v26, 0x41800000, v26
    v_mul_f32 v25, v26, v24
    v_cos_f32 v19, v25
    v_sin_f32 v20, v25
    s_nop 0
    v_cvt_pk_bf16_f32 v56, v19, v20
    v_cvt_pk_bf16_f32 v60, -v20, v19
    v_fma_f32 v21, v24, 1.0, v25
    v_cos_f32 v22, v21
    v_sin_f32 v23, v21
    s_nop 0
    v_cvt_pk_bf16_f32 v57, v22, v23
    v_cvt_pk_bf16_f32 v61, -v23, v22
    v_fma_f32 v18, v24, 2.0, v25
    v_cos_f32 v19, v18
    v_sin_f32 v20, v18
    s_nop 0
    v_cvt_pk_bf16_f32 v58, v19, v20
    v_cvt_pk_bf16_f32 v62, -v20, v19
    v_add_f32 v21, v18, v24
    v_cos_f32 v22, v21
    v_sin_f32 v23, v21
    s_nop 0
    v_cvt_pk_bf16_f32 v59, v22, v23
    v_cvt_pk_bf16_f32 v63, -v23, v22
    v_add_f32 v26, 0x41800000, v26
    v_mul_f32 v25, v26, v24
    v_cos_f32 v19, v25
    v_sin_f32 v20, v25
    s_nop 0
    v_cvt_pk_bf16_f32 v64, v19, v20
    v_cvt_pk_bf16_f32 v68, -v20, v19
    v_fma_f32 v21, v24, 1.0, v25
    v_cos_f32 v22, v21
    v_sin_f32 v23, v21
    s_nop 0
    v_cvt_pk_bf16_f32 v65, v22, v23
    v_cvt_pk_bf16_f32 v69, -v23, v22
    v_fma_f32 v18, v24, 2.0, v25
    v_cos_f32 v19, v18
    v_sin_f32 v20, v18
    s_nop 0
    v_cvt_pk_bf16_f32 v66, v19, v20
    v_cvt_pk_bf16_f32 v70, -v20, v19
    v_add_f32 v21, v18, v24
    v_cos_f32 v22, v21
    v_sin_f32 v23, v21
    s_nop 0
    v_cvt_pk_bf16_f32 v67, v22, v23
    v_cvt_pk_bf16_f32 v71, -v23, v22
    v_mul_f32 v37, 0x3de38e39, v24
    v_mul_f32 v22, 0x3f800000, v37
    v_cos_f32 v98, v22
    v_sin_f32 v99, v22
    v_mul_f32 v22, 0x40000000, v37
    v_cos_f32 v100, v22
    v_sin_f32 v101, v22
    v_mul_f32 v22, 0x40400000, v37
    v_cos_f32 v102, v22
    v_sin_f32 v103, v22
    v_mul_f32 v22, 0x40800000, v37
    v_cos_f32 v104, v22
    v_sin_f32 v105, v22
L_m_1:
    s_waitcnt lgkmcnt(14)
    v_lshlrev_b32 v106, 16, v148
    v_and_b32 v107, 0xffff0000, v148
    v_pk_fma_f32 v[106:107], v[106:107], v[132:133], v[140:141]
    v_lshlrev_b32 v108, 16, v149
    v_and_b32 v109, 0xffff0000, v149
    v_pk_fma_f32 v[108:109], v[108:109], v[134:135], v[142:143]
    v_lshlrev_b32 v110, 16, v150
    v_and_b32 v111, 0xffff0000, v150
    v_pk_fma_f32 v[110:111], v[110:111], v[136:137], v[144:145]
    v_lshlrev_b32 v112, 16, v151
    v_and_b32 v113, 0xffff0000, v151
    v_pk_fma_f32 v[112:113], v[112:113], v[138:139], v[146:147]
    v_lshlrev_b32 v114, 16, v152
    v_and_b32 v115, 0xffff0000, v152
    v_pk_fma_f32 v[114:115], v[114:115], v[132:133], v[140:141]
    v_lshlrev_b32 v116, 16, v153
    v_and_b32 v117, 0xffff0000, v153
    v_pk_fma_f32 v[116:117], v[116:117], v[134:135], v[142:143]
    v_lshlrev_b32 v118, 16, v154
    v_and_b32 v119, 0xffff0000, v154
    v_pk_fma_f32 v[118:119], v[118:119], v[136:137], v[144:145]
    v_lshlrev_b32 v120, 16, v155
    v_and_b32 v121, 0xffff0000, v155
    v_pk_fma_f32 v[120:121], v[120:121], v[138:139], v[146:147]
    v_lshlrev_b32 v122, 16, v156
    v_and_b32 v123, 0xffff0000, v156
    v_pk_fma_f32 v[122:123], v[122:123], v[132:133], v[140:141]
    v_lshlrev_b32 v124, 16, v157
    v_and_b32 v125, 0xffff0000, v157
    v_pk_fma_f32 v[124:125], v[124:125], v[134:135], v[142:143]
    v_lshlrev_b32 v126, 16, v158
    v_and_b32 v127, 0xffff0000, v158
    v_pk_fma_f32 v[126:127], v[126:127], v[136:137], v[144:145]
    v_lshlrev_b32 v128, 16, v159
    v_and_b32 v129, 0xffff0000, v159
    v_pk_fma_f32 v[128:129], v[128:129], v[138:139], v[146:147]
    s_waitcnt lgkmcnt(0)
    s_cmp_ge_u32 s2, 202
    s_cbranch_scc1 L_m_2
    v_and_b32 v220, 7, v1
    v_cvt_f32_u32 v220, v220
    v_mul_f32 v220, 0x3e000000, v220
    v_and_b32 v221, 1, v2
    v_cvt_f32_u32 v221, v221
    v_mul_f32 v221, 4.0, v221
    v_mul_f32 v221, v221, v220
    v_lshrrev_b32 v222, 3, v1
    v_lshrrev_b32 v223, 1, v2
    s_lshl_b32 s48, s3, 10
    s_add_u32 s48, s48, 147456
    v_add_u32 v224, s48, v36
    s_add_u32 s48, s3, 0
    s_mul_i32 s49, s48, 43
    s_lshr_b32 s49, s49, 7
    s_mul_i32 s50, s49, 3
    s_sub_u32 s50, s48, s50
    s_lshl_b32 s50, s50, 1
    s_lshl_b32 s49, s49, 1
    v_add_u32 v225, s49, v222
    v_add_u32 v226, s50, v223
    v_cmp_gt_u32 vcc, 9, v225
    v_cmp_gt_u32 s[48:49], 5, v226
    v_mul_u32_u24 v225, v225, v226
    v_cvt_f32_u32 v225, v225
    s_and_b64 vcc, vcc, s[48:49]
    v_fma_f32 v225, v225, s63, v221
    v_cos_f32 v226, v225
    v_sin_f32 v227, v225
    s_nop 0
    v_cvt_pk_bf16_f32 v232, v226, -v227
    v_add_f32 v225, v225, v220
    v_cos_f32 v228, v225
    v_sin_f32 v229, v225
    s_nop 0
    v_cvt_pk_bf16_f32 v233, v228, -v229
    v_add_f32 v225, v225, v220
    v_cos_f32 v226, v225
    v_sin_f32 v227, v225
    s_nop 0
    v_cvt_pk_bf16_f32 v234, v226, -v227
    v_add_f32 v225, v225, v220
    v_cos_f32 v228, v225
    v_sin_f32 v229, v225
    s_nop 0
    v_cvt_pk_bf16_f32 v235, v228, -v229
    v_cndmask_b32 v232, 0, v232, vcc
    v_cndmask_b32 v233, 0, v233, vcc
    v_cndmask_b32 v234, 0, v234, vcc
    v_cndmask_b32 v235, 0, v235, vcc
    ds_write_b128 v224, v[232:235] offset:0
    s_add_u32 s48, s3, 4
    s_mul_i32 s49, s48, 43
    s_lshr_b32 s49, s49, 7
    s_mul_i32 s50, s49, 3
    s_sub_u32 s50, s48, s50
    s_lshl_b32 s50, s50, 1
    s_lshl_b32 s49, s49, 1
    v_add_u32 v225, s49, v222
    v_add_u32 v226, s50, v223
    v_cmp_gt_u32 vcc, 9, v225
    v_cmp_gt_u32 s[48:49], 5, v226
    v_mul_u32_u24 v225, v225, v226
    v_cvt_f32_u32 v225, v225
    s_and_b64 vcc, vcc, s[48:49]
    v_fma_f32 v225, v225, s63, v221
    v_cos_f32 v226, v225
    v_sin_f32 v227, v225
    s_nop 0
    v_cvt_pk_bf16_f32 v236, v226, -v227
    v_add_f32 v225, v225, v220
    v_cos_f32 v228, v225
    v_sin_f32 v229, v225
    s_nop 0
    v_cvt_pk_bf16_f32 v237, v228, -v229
    v_add_f32 v225, v225, v220
    v_cos_f32 v226, v225
    v_sin_f32 v227, v225
    s_nop 0
    v_cvt_pk_bf16_f32 v238, v226, -v227
    v_add_f32 v225, v225, v220
    v_cos_f32 v228, v225
    v_sin_f32 v229, v225
    s_nop 0
    v_cvt_pk_bf16_f32 v239, v228, -v229
    v_cndmask_b32 v236, 0, v236, vcc
    v_cndmask_b32 v237, 0, v237, vcc
    v_cndmask_b32 v238, 0, v238, vcc
    v_cndmask_b32 v239, 0, v239, vcc
    ds_write_b128 v224, v[236:239] offset:4096
    s_add_u32 s48, s3, 8
    s_mul_i32 s49, s48, 43
    s_lshr_b32 s49, s49, 7
    s_mul_i32 s50, s49, 3
    s_sub_u32 s50, s48, s50
    s_lshl_b32 s50, s50, 1
    s_lshl_b32 s49, s49, 1
    v_add_u32 v225, s49, v222
    v_add_u32 v226, s50, v223
    v_cmp_gt_u32 vcc, 9, v225
    v_cmp_gt_u32 s[48:49], 5, v226
    v_mul_u32_u24 v225, v225, v226
    v_cvt_f32_u32 v225, v225
    s_and_b64 vcc, vcc, s[48:49]
    v_fma_f32 v225, v225, s63, v221
    v_cos_f32 v226, v225
    v_sin_f32 v227, v225
    s_nop 0
    v_cvt_pk_bf16_f32 v232, v226, -v227
    v_add_f32 v225, v225, v220
    v_cos_f32 v228, v225
    v_sin_f32 v229, v225
    s_nop 0
    v_cvt_pk_bf16_f32 v233, v228, -v229
    v_add_f32 v225, v225, v220
    v_cos_f32 v226, v225
    v_sin_f32 v227, v225
    s_nop 0
    v_cvt_pk_bf16_f32 v234, v226, -v227
    v_add_f32 v225, v225, v220
    v_cos_f32 v228, v225
    v_sin_f32 v229, v225
    s_nop 0
    v_cvt_pk_bf16_f32 v235, v228, -v229
    v_cndmask_b32 v232, 0, v232, vcc
    v_cndmask_b32 v233, 0, v233, vcc
    v_cndmask_b32 v234, 0, v234, vcc
    v_cndmask_b32 v235, 0, v235, vcc
    ds_write_b128 v224, v[232:235] offset:8192
    s_add_u32 s48, s3, 12
    s_mul_i32 s49, s48, 43
    s_lshr_b32 s49, s49, 7
    s_mul_i32 s50, s49, 3
    s_sub_u32 s50, s48, s50
    s_lshl_b32 s50, s50, 1
    s_lshl_b32 s49, s49, 1
    v_add_u32 v225, s49, v222
    v_add_u32 v226, s50, v223
    v_cmp_gt_u32 vcc, 9, v225
    v_cmp_gt_u32 s[48:49], 5, v226
    v_mul_u32_u24 v225, v225, v226
    v_cvt_f32_u32 v225, v225
    s_and_b64 vcc, vcc, s[48:49]
    v_fma_f32 v225, v225, s63, v221
    v_cos_f32 v226, v225
    v_sin_f32 v227, v225
    s_nop 0
    v_cvt_pk_bf16_f32 v236, v226, -v227
    v_add_f32 v225, v225, v220
    v_cos_f32 v228, v225
    v_sin_f32 v229, v225
    s_nop 0
    v_cvt_pk_bf16_f32 v237, v228, -v229
    v_add_f32 v225, v225, v220
    v_cos_f32 v226, v225
    v_sin_f32 v227, v225
    s_nop 0
    v_cvt_pk_bf16_f32 v238, v226, -v227
    v_add_f32 v225, v225, v220
    v_cos_f32 v228, v225
    v_sin_f32 v229, v225
    s_nop 0
    v_cvt_pk_bf16_f32 v239, v228, -v229
    v_cndmask_b32 v236, 0, v236, vcc
    v_cndmask_b32 v237, 0, v237, vcc
    v_cndmask_b32 v238, 0, v238, vcc
    v_cndmask_b32 v239, 0, v239, vcc
    ds_write_b128 v224, v[236:239] offset:12288
L_m_2:
    v_lshrrev_b32 v22, 1, v2
    v_cvt_f32_u32 v22, v22
    v_add_f32 v23, 1.0, v22
    v_mul_f32 v23, 0x35638e39, v23
    v_mul_f32 v24, v22, v37
    v_cos_f32 v25, v24
    v_sin_f32 v26, v24
    v_mul_f32 v30, v23, v25
    v_mul_f32 v31, v23, v26
    v_add_f32 v22, 2.0, v22
    v_mul_f32 v24, v22, v37
    v_cos_f32 v25, v24
    v_sin_f32 v26, v24
    v_mul_f32 v32, 0x35e38e39, v25
    v_mul_f32 v33, 0x35e38e39, v26
    v_add_f32 v22, 2.0, v22
    v_mul_f32 v24, v22, v37
    v_cos_f32 v25, v24
    v_sin_f32 v26, v24
    v_mul_f32 v34, 0x35e38e39, v25
    v_mul_f32 v35, 0x35e38e39, v26
    s_mov_b32 s48, 0x9e3779b1
    s_waitcnt vmcnt(5)
    v_mul_lo_u32 v3, v3, s48
    v_add_u32 v3, 0x7f4a7c15, v3
    v_or_b32 v3, 0x01010101, v3
    s_lshl_b32 s48, s3, 6
    s_add_u32 s48, s48, 126336
    v_mul_u32_u24 v18, 576, v2
    v_lshl_add_u32 v18, v1, 2, v18
    v_add_u32 v18, s48, v18
    v_mul_u32_u24 v19, 288, v1
    v_lshl_add_u32 v19, v2, 4, v19
    v_add_u32 v19, 126336, v19
    v_bfe_u32 v27, v1, 1, 2
    v_xor_b32 v27, v27, v2
    v_lshl_add_u32 v27, v1, 2, v27
    s_mul_i32 s48, s3, 3072
    s_add_u32 s48, s48, 77824
    v_lshl_add_u32 v27, v27, 4, s48
    v_add_u32 v28, s48, v36
    v_lshrrev_b32 v20, 3, v0
    v_xor_b32 v20, v20, v0
    v_and_b32 v20, 3, v20
    v_lshlrev_b32 v20, 4, v20
    v_lshrrev_b32 v21, 2, v0
    v_lshl_add_u32 v20, v21, 16, v20
    s_lshl_b32 s48, s3, 14
    s_lshl_b32 s49, s6, 6
    s_add_u32 s48, s48, s49
    s_add_u32 s48, s48, 4194304
    v_add_u32 v20, s48, v20
    v_add_u32 v21, 1048576, v20
    v_add_u32 v22, 2097152, v20
    v_cmp_gt_u32 vcc, 32, v0
    v_mov_b32 v23, 2146435072
    s_nop 0
    v_cndmask_b32 v22, v23, v22, vcc
    s_lshl_b32 s58, s3, 12
    s_add_u32 s58, s58, 61440
    v_lshl_add_u32 v93, v1, 2, s58
    s_waitcnt vmcnt(1)
    v_lshl_add_u32 v90, v2, 6, v93
    v_add_u32 v93, 512, v93
    s_waitcnt vmcnt(0)
    v_add_u32 v91, 1152, v90
    v_add_u32 v92, 2304, v90
    v_add_u32 v94, 1152, v93
    v_add_u32 v95, 2304, v93
    v_cmp_gt_u32 vcc, 24, v0
    s_nop 1
    v_cndmask_b32 v96, v23, v36, vcc
    s_mul_i32 s59, s4, 13824
    s_mul_i32 s48, s3, 3456
    s_add_u32 s59, s59, s48
    s_add_u32 s59, s59, 15204352
    v_min_u32 v97, 496, v36
    s_mul_i32 s48, s3, 2560
    s_mul_i32 s60, s6, 10240
    s_add_u32 s60, s60, s48
    s_add_u32 s60, s60, 8388608
    v_mov_b64 v[144:145], -1
    v_mov_b64 v[146:147], -1
    v_and_b32 v24, 3, v1
    v_lshlrev_b32 v24, 3, v24
    v_bfe_u32 v24, v3, v24, 8
    s_mov_b32 m0, s58
    s_branch L_stub_1
L_back_c1:
    s_waitcnt vmcnt(0) lgkmcnt(0)
Lp_m_3:
    buffer_load_dwordx4 v36, s[36:39], s59 offen offset:0 sc1 lds
    buffer_load_dwordx4 v36, s[36:39], s59 offen offset:1024 sc1 lds
    buffer_load_dwordx4 v36, s[36:39], s59 offen offset:2048 sc1 lds
    buffer_load_dwordx4 v96, s[36:39], s59 offen offset:3072 sc1 lds
    s_waitcnt vmcnt(0)
    ds_read2_b32 v[72:73], v90 offset0:0 offset1:144
    ds_read2_b32 v[74:75], v90 offset0:64 offset1:208
    ds_read2_b32 v[76:77], v93 offset0:0 offset1:144
    ds_read2_b32 v[78:79], v91 offset0:0 offset1:144
    ds_read2_b32 v[80:81], v91 offset0:64 offset1:208
    ds_read2_b32 v[82:83], v94 offset0:0 offset1:144
    ds_read2_b32 v[84:85], v92 offset0:0 offset1:144
    ds_read2_b32 v[86:87], v92 offset0:64 offset1:208
    ds_read2_b32 v[88:89], v95 offset0:0 offset1:144
    s_waitcnt lgkmcnt(8)
    v_xor_b32 v72, v72, v24
    v_xor_b32 v73, v73, v24
    v_or_b32 v26, v72, v73
    s_waitcnt lgkmcnt(7)
    v_xor_b32 v74, v74, v24
    v_xor_b32 v75, v75, v24
    v_or3_b32 v26, v74, v75, v26
    s_waitcnt lgkmcnt(6)
    v_xor_b32 v76, v76, v24
    v_xor_b32 v77, v77, v24
    v_or3_b32 v26, v76, v77, v26
    s_waitcnt lgkmcnt(5)
    v_xor_b32 v78, v78, v24
    v_xor_b32 v79, v79, v24
    v_or3_b32 v26, v78, v79, v26
    s_waitcnt lgkmcnt(4)
    v_xor_b32 v80, v80, v24
    v_xor_b32 v81, v81, v24
    v_or3_b32 v26, v80, v81, v26
    s_waitcnt lgkmcnt(3)
    v_xor_b32 v82, v82, v24
    v_xor_b32 v83, v83, v24
    v_or3_b32 v26, v82, v83, v26
    s_waitcnt lgkmcnt(2)
    v_xor_b32 v84, v84, v24
    v_xor_b32 v85, v85, v24
    v_or3_b32 v26, v84, v85, v26
    s_waitcnt lgkmcnt(1)
    v_xor_b32 v86, v86, v24
    v_xor_b32 v87, v87, v24
    v_or3_b32 v26, v86, v87, v26
    s_waitcnt lgkmcnt(0)
    v_xor_b32 v88, v88, v24
    v_xor_b32 v89, v89, v24
    v_or3_b32 v26, v88, v89, v26
    v_and_b32 v26, 0xff, v26
    v_cmp_ne_u32 vcc, 0, v26
    s_nop 0
    s_cbranch_vccz Le_m_4
    s_sub_u32 s7, s7, 1
    s_cbranch_scc1 Le_m_4
    s_sleep 1
    s_branch Lp_m_3
Le_m_4:
    s_max_i32 s7, s7, 0
    buffer_store_dwordx4 v[144:147], v36, s[36:39], s60 offen offset:0 sc1
    buffer_store_dwordx4 v[144:147], v36, s[36:39], s60 offen offset:1024 sc1
    buffer_store_dwordx4 v[144:147], v97, s[36:39], s60 offen offset:2048 sc1
    v_pk_add_f32 v[72:73], v[72:73], v[78:79]
    v_pk_add_f32 v[74:75], v[74:75], v[80:81]
    v_pk_add_f32 v[76:77], v[76:77], v[82:83]
    v_pk_add_f32 v[72:73], v[72:73], v[84:85]
    v_pk_add_f32 v[74:75], v[74:75], v[86:87]
    v_pk_add_f32 v[76:77], v[76:77], v[88:89]
    v_cvt_pk_bf16_f32 v78, v72, v73
    v_and_b32 v73, 0xffff0000, v78
    v_add_f32 v73, 1.0, v73
    v_lshlrev_b32 v72, 16, v78
    v_cvt_pk_bf16_f32 v73, 0, v73
    v_pk_fma_f32 v[106:107], v[106:107], v[72:73], v[72:73] op_sel:[0,1,0] op_sel_hi:[1,1,0]
    s_branch L_skip_1
L_stub_1:
    s_branch L_stub_2
L_skip_1:
    v_pk_fma_f32 v[108:109], v[108:109], v[72:73], v[72:73] op_sel:[0,1,0] op_sel_hi:[1,1,0]
    v_pk_fma_f32 v[110:111], v[110:111], v[72:73], v[72:73] op_sel:[0,1,0] op_sel_hi:[1,1,0]
    v_pk_fma_f32 v[112:113], v[112:113], v[72:73], v[72:73] op_sel:[0,1,0] op_sel_hi:[1,1,0]
    v_cvt_pk_bf16_f32 v148, v106, v107
    v_cvt_pk_bf16_f32 v149, v108, v109
    v_cvt_pk_bf16_f32 v150, v110, v111
    v_cvt_pk_bf16_f32 v151, v112, v113
    v_cvt_pk_bf16_f32 v80, v74, v75
    v_and_b32 v75, 0xffff0000, v80
    v_add_f32 v75, 1.0, v75
    v_lshlrev_b32 v74, 16, v80
    v_cvt_pk_bf16_f32 v75, 0, v75
    v_pk_fma_f32 v[114:115], v[114:115], v[74:75], v[74:75] op_sel:[0,1,0] op_sel_hi:[1,1,0]
    v_pk_fma_f32 v[116:117], v[116:117], v[74:75], v[74:75] op_sel:[0,1,0] op_sel_hi:[1,1,0]
    v_pk_fma_f32 v[118:119], v[118:119], v[74:75], v[74:75] op_sel:[0,1,0] op_sel_hi:[1,1,0]
    v_pk_fma_f32 v[120:121], v[120:121], v[74:75], v[74:75] op_sel:[0,1,0] op_sel_hi:[1,1,0]
    v_cvt_pk_bf16_f32 v152, v114, v115
    v_cvt_pk_bf16_f32 v153, v116, v117
    v_cvt_pk_bf16_f32 v154, v118, v119
    v_cvt_pk_bf16_f32 v155, v120, v121
    v_cvt_pk_bf16_f32 v82, v76, v77
    v_and_b32 v77, 0xffff0000, v82
    v_add_f32 v77, 1.0, v77
    v_lshlrev_b32 v76, 16, v82
    v_cvt_pk_bf16_f32 v77, 0, v77
    v_pk_fma_f32 v[122:123], v[122:123], v[76:77], v[76:77] op_sel:[0,1,0] op_sel_hi:[1,1,0]
    v_pk_fma_f32 v[124:125], v[124:125], v[76:77], v[76:77] op_sel:[0,1,0] op_sel_hi:[1,1,0]
    v_pk_fma_f32 v[126:127], v[126:127], v[76:77], v[76:77] op_sel:[0,1,0] op_sel_hi:[1,1,0]
    v_pk_fma_f32 v[128:129], v[128:129], v[76:77], v[76:77] op_sel:[0,1,0] op_sel_hi:[1,1,0]
    v_cvt_pk_bf16_f32 v156, v122, v123
    v_cvt_pk_bf16_f32 v157, v124, v125
    v_cvt_pk_bf16_f32 v158, v126, v127
    v_cvt_pk_bf16_f32 v159, v128, v129
    v_mfma_f32_16x16x32_bf16 v[224:227], v[172:175], v[148:151], 0
    v_mfma_f32_16x16x32_bf16 v[224:227], v[176:179], v[152:155], v[224:227]
    v_mfma_f32_16x16x32_bf16 v[224:227], v[180:183], v[156:159], v[224:227]
    v_mfma_f32_16x16x32_bf16 v[228:231], v[184:187], v[148:151], 0
    v_mfma_f32_16x16x32_bf16 v[228:231], v[188:191], v[152:155], v[228:231]
    v_mfma_f32_16x16x32_bf16 v[228:231], v[192:195], v[156:159], v[228:231]
    v_mfma_f32_16x16x32_bf16 v[232:235], v[196:199], v[148:151], 0
    s_nop 3
    v_mul_f32 v114, v224, v98
    v_mul_f32 v115, v225, v98
    v_mfma_f32_16x16x32_bf16 v[232:235], v[200:203], v[152:155], v[232:235]
    v_fmac_f32 v114, v225, v99
    v_fma_f32 v115, -v224, v99, v115
    v_mfma_f32_16x16x32_bf16 v[232:235], v[204:207], v[156:159], v[232:235]
    v_cvt_pk_bf16_f32 v116, v114, v115
    ds_write_b32 v18, v116 offset:2304
    v_mfma_f32_16x16x32_bf16 v[236:239], v[208:211], v[148:151], 0
    v_mul_f32 v118, v226, v98
    v_mul_f32 v119, v227, v98
    v_mfma_f32_16x16x32_bf16 v[236:239], v[212:215], v[152:155], v[236:239]
    v_fmac_f32 v118, v227, v99
    v_fma_f32 v119, -v226, v99, v119
    v_mfma_f32_16x16x32_bf16 v[236:239], v[216:219], v[156:159], v[236:239]
    v_cvt_pk_bf16_f32 v120, v118, v119
    ds_write_b32 v18, v120 offset:2592
    v_mfma_f32_16x16x32_bf16 v[220:223], v[160:163], v[148:151], 0
    v_mul_f32 v106, v228, v100
    v_mul_f32 v107, v229, v100
    v_mfma_f32_16x16x32_bf16 v[220:223], v[164:167], v[152:155], v[220:223]
    v_fmac_f32 v106, v229, v101
    v_fma_f32 v107, -v228, v101, v107
    v_mfma_f32_16x16x32_bf16 v[220:223], v[168:171], v[156:159], v[220:223]
    v_cvt_pk_bf16_f32 v108, v106, v107
    ds_write_b32 v18, v108 offset:4608
    v_mul_f32 v110, v230, v100
    v_mul_f32 v111, v231, v100
    v_fmac_f32 v110, v231, v101
    v_fma_f32 v111, -v230, v101, v111
    v_cvt_pk_bf16_f32 v112, v110, v111
    ds_write_b32 v18, v112 offset:4896
    v_mul_f32 v114, v232, v102
    v_mul_f32 v115, v233, v102
    v_fmac_f32 v114, v233, v103
    v_fma_f32 v115, -v232, v103, v115
    v_cvt_pk_bf16_f32 v116, v114, v115
    ds_write_b32 v18, v116 offset:6912
    v_mul_f32 v118, v234, v102
    v_mul_f32 v119, v235, v102
    v_fmac_f32 v118, v235, v103
    v_fma_f32 v119, -v234, v103, v119
    v_cvt_pk_bf16_f32 v120, v118, v119
    ds_write_b32 v18, v120 offset:7200
    v_mul_f32 v106, v236, v104
    v_mul_f32 v107, v237, v104
    v_fmac_f32 v106, v237, v105
    v_fma_f32 v107, -v236, v105, v107
    v_cvt_pk_bf16_f32 v108, v106, v107
    ds_write_b32 v18, v108 offset:9216
    v_mul_f32 v110, v238, v104
    v_mul_f32 v111, v239, v104
    v_fmac_f32 v110, v239, v105
    v_fma_f32 v111, -v238, v105, v111
    v_cvt_pk_bf16_f32 v112, v110, v111
    ds_write_b32 v18, v112 offset:9504
    v_cvt_pk_bf16_f32 v108, v220, v221
    ds_write_b32 v18, v108 offset:0
    v_cvt_pk_bf16_f32 v112, v222, v223
    ds_write_b32 v18, v112 offset:288
    s_waitcnt lgkmcnt(0)
    s_barrier
    ds_read_b128 v[160:163], v19 offset:0
    ds_read_b128 v[164:167], v19 offset:64
    ds_read_b128 v[168:171], v19 offset:128
    ds_read_b128 v[172:175], v19 offset:192
    ds_read_b128 v[176:179], v19 offset:4608
    ds_read_b128 v[180:183], v19 offset:4672
    ds_read_b128 v[184:187], v19 offset:4736
    ds_read_b128 v[188:191], v19 offset:4800
    ds_read_b128 v[192:195], v19 offset:9216
    ds_read_b128 v[196:199], v19 offset:9280
    ds_read_b128 v[200:203], v19 offset:9344
    ds_read_b128 v[204:207], v19 offset:9408
    s_waitcnt lgkmcnt(11)
    v_mfma_f32_16x16x32_bf16 v[220:223], v[40:43], v[160:163], 0
    v_mfma_f32_16x16x32_bf16 v[224:227], v[44:47], v[160:163], 0
    s_waitcnt lgkmcnt(10)
    v_mfma_f32_16x16x32_bf16 v[220:223], v[48:51], v[164:167], v[220:223]
    v_mfma_f32_16x16x32_bf16 v[224:227], v[52:55], v[164:167], v[224:227]
    s_waitcnt lgkmcnt(9)
    v_mfma_f32_16x16x32_bf16 v[220:223], v[56:59], v[168:171], v[220:223]
    v_mfma_f32_16x16x32_bf16 v[224:227], v[60:63], v[168:171], v[224:227]
    s_waitcnt lgkmcnt(8)
    v_mfma_f32_16x16x32_bf16 v[220:223], v[64:67], v[172:175], v[220:223]
    v_mfma_f32_16x16x32_bf16 v[224:227], v[68:71], v[172:175], v[224:227]
    s_waitcnt lgkmcnt(7)
    v_mfma_f32_16x16x32_bf16 v[228:231], v[40:43], v[176:179], 0
    v_mfma_f32_16x16x32_bf16 v[232:235], v[44:47], v[176:179], 0
    s_waitcnt lgkmcnt(6)
    v_mfma_f32_16x16x32_bf16 v[228:231], v[48:51], v[180:183], v[228:231]
    v_mfma_f32_16x16x32_bf16 v[232:235], v[52:55], v[180:183], v[232:235]
    s_waitcnt lgkmcnt(5)
    v_mfma_f32_16x16x32_bf16 v[228:231], v[56:59], v[184:187], v[228:231]
    v_cvt_pk_bf16_f32 v148, v220, v224
    v_mfma_f32_16x16x32_bf16 v[232:235], v[60:63], v[184:187], v[232:235]
    v_cvt_pk_bf16_f32 v149, v221, v225
    s_waitcnt lgkmcnt(4)
    v_mfma_f32_16x16x32_bf16 v[228:231], v[64:67], v[188:191], v[228:231]
    v_cvt_pk_bf16_f32 v150, v222, v226
    v_mfma_f32_16x16x32_bf16 v[232:235], v[68:71], v[188:191], v[232:235]
    v_cvt_pk_bf16_f32 v151, v223, v227
    ds_write_b128 v27, v[148:151] offset:0
    ds_read_b128 v[132:135], v28 offset:0
    s_waitcnt lgkmcnt(5)
    v_mfma_f32_16x16x32_bf16 v[236:239], v[40:43], v[192:195], 0
    v_mfma_f32_16x16x32_bf16 v[240:243], v[44:47], v[192:195], 0
    s_waitcnt lgkmcnt(4)
    v_mfma_f32_16x16x32_bf16 v[236:239], v[48:51], v[196:199], v[236:239]
    v_mfma_f32_16x16x32_bf16 v[240:243], v[52:55], v[196:199], v[240:243]
    s_waitcnt lgkmcnt(3)
    v_mfma_f32_16x16x32_bf16 v[236:239], v[56:59], v[200:203], v[236:239]
    v_cvt_pk_bf16_f32 v152, v228, v232
    v_mfma_f32_16x16x32_bf16 v[240:243], v[60:63], v[200:203], v[240:243]
    v_cvt_pk_bf16_f32 v153, v229, v233
    s_waitcnt lgkmcnt(2)
    v_mfma_f32_16x16x32_bf16 v[236:239], v[64:67], v[204:207], v[236:239]
    v_cvt_pk_bf16_f32 v154, v230, v234
    v_mfma_f32_16x16x32_bf16 v[240:243], v[68:71], v[204:207], v[240:243]
    v_cvt_pk_bf16_f32 v155, v231, v235
    ds_write_b128 v27, v[152:155] offset:1024
    ds_read_b128 v[136:139], v28 offset:1024
    s_waitcnt lgkmcnt(2)
    buffer_store_dwordx4 v[132:135], v20, s[36:39], 0 offen sc1
    s_nop 2
    v_cvt_pk_bf16_f32 v156, v236, v240
    v_cvt_pk_bf16_f32 v157, v237, v241
    v_cvt_pk_bf16_f32 v158, v238, v242
    v_cvt_pk_bf16_f32 v159, v239, v243
    ds_write_b128 v27, v[156:159] offset:2048
    ds_read_b128 v[140:143], v28 offset:2048
    s_waitcnt lgkmcnt(2)
    buffer_store_dwordx4 v[136:139], v21, s[36:39], 0 offen sc1
    s_waitcnt lgkmcnt(0)
    buffer_store_dwordx4 v[140:143], v22, s[36:39], 0 offen sc1
    v_lshrrev_b32 v18, 2, v1
    v_and_b32 v18, 2, v18
    v_xor_b32 v18, v18, v2
    v_lshlrev_b32 v18, 4, v18
    v_lshl_add_u32 v18, v1, 8, v18
    v_add_u32 v18, 98304, v18
    v_and_b32 v19, 7, v1
    v_lshlrev_b32 v19, 8, v19
    v_lshl_add_u32 v19, v2, 4, v19
    v_add_u32 v19, 98304, v19
    v_and_b32 v23, 3, v1
    v_xor_b32 v24, 0, v23
    v_lshl_add_u32 v72, v24, 6, v18
    v_lshl_add_u32 v76, v24, 6, v19
    v_xor_b32 v24, 1, v23
    v_lshl_add_u32 v73, v24, 6, v18
    v_lshl_add_u32 v77, v24, 6, v19
    v_xor_b32 v24, 2, v23
    v_lshl_add_u32 v74, v24, 6, v18
    v_lshl_add_u32 v78, v24, 6, v19
    v_xor_b32 v24, 3, v23
    v_lshl_add_u32 v75, v24, 6, v18
    v_lshl_add_u32 v79, v24, 6, v19
    v_and_b32 v18, 7, v1
    v_mul_u32_u24 v18, 2320, v18
    v_lshl_add_u32 v18, v2, 4, v18
    s_lshl_b32 s48, s3, 6
    s_add_u32 s48, s48, 116736
    v_add_u32 v18, s48, v18
    v_lshrrev_b32 v19, 3, v1
    v_lshl_add_u32 v225, v19, 8, v18
    v_cmp_gt_u32 vcc, 8, v1
    v_mov_b32 v23, 133248
    s_nop 0
    v_cndmask_b32 v224, v23, v18, vcc
    v_lshrrev_b32 v23, 5, v0
    s_lshl_b32 s48, s3, 1
    v_add_u32 v23, s48, v23
    v_and_b32 v24, 31, v0
    v_mul_u32_u24 v18, 2320, v23
    v_lshl_add_u32 v18, v24, 3, v18
    v_add_u32 v226, 116736, v18
    v_mul_u32_u24 v18, 1184, v23
    v_lshl_add_u32 v18, v24, 2, v18
    v_add_u32 v227, 135808, v18
    v_mul_u32_u24 v18, 1152, v23
    v_lshl_add_u32 v18, v24, 2, v18
    v_add_u32 v231, 98304, v18
    v_lshlrev_b32 v18, 3, v24
    v_add_u32 v228, 108544, v18
    v_add_u32 v37, 108800, v18
    v_bfe_u32 v18, v0, 2, 2
    v_mul_u32_u24 v18, 1184, v18
    v_and_b32 v19, 3, v0
    v_lshl_add_u32 v18, v19, 3, v18
    v_lshl_add_u32 v18, v2, 5, v18
    s_lshl_b32 s48, s3, 7
    s_add_u32 s48, s48, 135808
    v_add_u32 v229, s48, v18
    v_add_u32 v230, 147456, v36
    v_min_u32 v232, 496, v36
    s_mul_i32 s48, s3, 2560
    s_mul_i32 s66, s6, 10240
    s_add_u32 s66, s66, s48
    s_add_u32 s66, s66, 8388608
    s_add_u32 s48, s48, 98304
    v_add_u32 v233, s48, v36
    v_add_u32 v234, s48, v232
    s_lshr_b32 s48, s4, 1
    s_lshl_b32 s48, s48, 12
    s_mul_i32 s49, s3, 640
    s_add_u32 s48, s48, s49
    s_add_u32 s48, s48, 294912
    v_min_u32 v235, 624, v36
    v_add_u32 v235, s48, v235
    s_waitcnt vmcnt(0)
    s_waitcnt vmcnt(0)
    s_barrier
    s_cmp_lt_u32 s2, 202
    s_cbranch_scc1 L_m_5
    v_and_b32 v188, 7, v1
    v_cvt_f32_u32 v188, v188
    v_mul_f32 v188, 0x3e000000, v188
    v_and_b32 v189, 1, v2
    v_cvt_f32_u32 v189, v189
    v_mul_f32 v189, 4.0, v189
    v_mul_f32 v189, v189, v188
    v_lshrrev_b32 v190, 3, v1
    v_lshrrev_b32 v191, 1, v2
    s_lshl_b32 s48, s3, 10
    s_add_u32 s48, s48, 147456
    v_add_u32 v192, s48, v36
    s_add_u32 s48, s3, 0
    s_mul_i32 s49, s48, 43
    s_lshr_b32 s49, s49, 7
    s_mul_i32 s50, s49, 3
    s_sub_u32 s50, s48, s50
    s_lshl_b32 s50, s50, 1
    s_lshl_b32 s49, s49, 1
    v_add_u32 v193, s49, v190
    v_add_u32 v194, s50, v191
    v_cmp_gt_u32 vcc, 9, v193
    v_cmp_gt_u32 s[48:49], 5, v194
    v_mul_u32_u24 v193, v193, v194
    v_cvt_f32_u32 v193, v193
    s_and_b64 vcc, vcc, s[48:49]
    v_fma_f32 v193, v193, s63, v189
    v_cos_f32 v194, v193
    v_sin_f32 v195, v193
    s_nop 0
    v_cvt_pk_bf16_f32 v200, v194, -v195
    v_add_f32 v193, v193, v188
    v_cos_f32 v196, v193
    v_sin_f32 v197, v193
    s_nop 0
    v_cvt_pk_bf16_f32 v201, v196, -v197
    v_add_f32 v193, v193, v188
    v_cos_f32 v194, v193
    v_sin_f32 v195, v193
    s_nop 0
    v_cvt_pk_bf16_f32 v202, v194, -v195
    v_add_f32 v193, v193, v188
    v_cos_f32 v196, v193
    v_sin_f32 v197, v193
    s_nop 0
    v_cvt_pk_bf16_f32 v203, v196, -v197
    v_cndmask_b32 v200, 0, v200, vcc
    v_cndmask_b32 v201, 0, v201, vcc
    v_cndmask_b32 v202, 0, v202, vcc
    v_cndmask_b32 v203, 0, v203, vcc
    ds_write_b128 v192, v[200:203] offset:0
    s_add_u32 s48, s3, 4
    s_mul_i32 s49, s48, 43
    s_lshr_b32 s49, s49, 7
    s_mul_i32 s50, s49, 3
    s_sub_u32 s50, s48, s50
    s_lshl_b32 s50, s50, 1
    s_lshl_b32 s49, s49, 1
    v_add_u32 v193, s49, v190
    v_add_u32 v194, s50, v191
    v_cmp_gt_u32 vcc, 9, v193
    v_cmp_gt_u32 s[48:49], 5, v194
    v_mul_u32_u24 v193, v193, v194
    v_cvt_f32_u32 v193, v193
    s_and_b64 vcc, vcc, s[48:49]
    v_fma_f32 v193, v193, s63, v189
    v_cos_f32 v194, v193
    v_sin_f32 v195, v193
    s_nop 0
    v_cvt_pk_bf16_f32 v204, v194, -v195
    v_add_f32 v193, v193, v188
    v_cos_f32 v196, v193
    v_sin_f32 v197, v193
    s_nop 0
    v_cvt_pk_bf16_f32 v205, v196, -v197
    v_add_f32 v193, v193, v188
    v_cos_f32 v194, v193
    v_sin_f32 v195, v193
    s_nop 0
    v_cvt_pk_bf16_f32 v206, v194, -v195
    v_add_f32 v193, v193, v188
    v_cos_f32 v196, v193
    v_sin_f32 v197, v193
    s_nop 0
    v_cvt_pk_bf16_f32 v207, v196, -v197
    v_cndmask_b32 v204, 0, v204, vcc
    v_cndmask_b32 v205, 0, v205, vcc
    v_cndmask_b32 v206, 0, v206, vcc
    v_cndmask_b32 v207, 0, v207, vcc
    ds_write_b128 v192, v[204:207] offset:4096
    s_add_u32 s48, s3, 8
    s_mul_i32 s49, s48, 43
    s_lshr_b32 s49, s49, 7
    s_mul_i32 s50, s49, 3
    s_sub_u32 s50, s48, s50
    s_lshl_b32 s50, s50, 1
    s_lshl_b32 s49, s49, 1
    v_add_u32 v193, s49, v190
    v_add_u32 v194, s50, v191
    v_cmp_gt_u32 vcc, 9, v193
    v_cmp_gt_u32 s[48:49], 5, v194
    v_mul_u32_u24 v193, v193, v194
    v_cvt_f32_u32 v193, v193
    s_and_b64 vcc, vcc, s[48:49]
    v_fma_f32 v193, v193, s63, v189
    v_cos_f32 v194, v193
    v_sin_f32 v195, v193
    s_nop 0
    v_cvt_pk_bf16_f32 v200, v194, -v195
    v_add_f32 v193, v193, v188
    v_cos_f32 v196, v193
    v_sin_f32 v197, v193
    s_nop 0
    v_cvt_pk_bf16_f32 v201, v196, -v197
    v_add_f32 v193, v193, v188
    v_cos_f32 v194, v193
    v_sin_f32 v195, v193
    s_nop 0
    v_cvt_pk_bf16_f32 v202, v194, -v195
    v_add_f32 v193, v193, v188
    v_cos_f32 v196, v193
    v_sin_f32 v197, v193
    s_nop 0
    v_cvt_pk_bf16_f32 v203, v196, -v197
    v_cndmask_b32 v200, 0, v200, vcc
    v_cndmask_b32 v201, 0, v201, vcc
    v_cndmask_b32 v202, 0, v202, vcc
    v_cndmask_b32 v203, 0, v203, vcc
    ds_write_b128 v192, v[200:203] offset:8192
    s_add_u32 s48, s3, 12
    s_mul_i32 s49, s48, 43
    s_lshr_b32 s49, s49, 7
    s_mul_i32 s50, s49, 3
    s_sub_u32 s50, s48, s50
    s_lshl_b32 s50, s50, 1
    s_lshl_b32 s49, s49, 1
    v_add_u32 v193, s49, v190
    v_add_u32 v194, s50, v191
    v_cmp_gt_u32 vcc, 9, v193
    v_cmp_gt_u32 s[48:49], 5, v194
    v_mul_u32_u24 v193, v193, v194
    v_cvt_f32_u32 v193, v193
    s_and_b64 vcc, vcc, s[48:49]
    v_fma_f32 v193, v193, s63, v189
    v_cos_f32 v194, v193
    v_sin_f32 v195, v193
    s_nop 0
    v_cvt_pk_bf16_f32 v204, v194, -v195
    v_add_f32 v193, v193, v188
    v_cos_f32 v196, v193
    v_sin_f32 v197, v193
    s_nop 0
    v_cvt_pk_bf16_f32 v205, v196, -v197
    v_add_f32 v193, v193, v188
    v_cos_f32 v194, v193
    v_sin_f32 v195, v193
    s_nop 0
    v_cvt_pk_bf16_f32 v206, v194, -v195
    v_add_f32 v193, v193, v188
    v_cos_f32 v196, v193
    v_sin_f32 v197, v193
    s_nop 0
    v_cvt_pk_bf16_f32 v207, v196, -v197
    v_cndmask_b32 v204, 0, v204, vcc
    v_cndmask_b32 v205, 0, v205, vcc
    v_cndmask_b32 v206, 0, v206, vcc
    v_cndmask_b32 v207, 0, v207, vcc
    ds_write_b128 v192, v[204:207] offset:12288
L_m_5:
    s_lshl_b32 s58, s3, 10
    v_add_u32 v18, s58, v36
    v_add_u32 v19, 4096, v18
    v_min_u32 v19, 6896, v19
    v_min_u32 v20, 2288, v18
    v_add_u32 v20, 6912, v20
    s_mov_b32 s56, 0x0c0c0400
    s_mov_b32 s57, 0x04000c0c
    s_mov_b32 s58, 196608
    s_mov_b32 s59, 205824
    s_mov_b32 s60, 215040
    s_waitcnt lgkmcnt(0)
    s_cmp_ge_u32 s5, 20
    s_cbranch_scc1 L_m_6
    s_barrier
L_m_6:
    buffer_load_dwordx4 v[80:83], v18, s[36:39], s58 offen sc1
    buffer_load_dwordx4 v[84:87], v18, s[36:39], s59 offen sc1
    buffer_load_dwordx4 v[92:95], v19, s[36:39], s58 offen sc1
    buffer_load_dwordx4 v[96:99], v19, s[36:39], s59 offen sc1
    s_cmp_ge_u32 s5, 20
    s_cbranch_scc1 L_m_7
    s_barrier
L_m_7:
    s_waitcnt vmcnt(0)
    v_perm_b32 v22, v81, v80, s56
    v_perm_b32 v23, v83, v82, s57
    v_or_b32 v22, v22, v23
    v_cmp_ne_u32 vcc, v3, v22
    v_perm_b32 v22, v85, v84, s56
    v_perm_b32 v23, v87, v86, s57
    v_or_b32 v22, v22, v23
    v_cmp_ne_u32 s[48:49], v3, v22
    s_nop 0
    s_or_b64 vcc, vcc, s[48:49]
    v_perm_b32 v22, v93, v92, s56
    v_perm_b32 v23, v95, v94, s57
    v_or_b32 v22, v22, v23
    v_cmp_ne_u32 s[48:49], v3, v22
    s_nop 0
    s_or_b64 vcc, vcc, s[48:49]
    v_perm_b32 v22, v97, v96, s56
    v_perm_b32 v23, v99, v98, s57
    v_or_b32 v22, v22, v23
    v_cmp_ne_u32 s[48:49], v3, v22
    s_nop 0
    s_or_b64 vcc, vcc, s[48:49]
    s_cbranch_vccz L_m_8
Lp_m_9:
    buffer_load_dwordx4 v[80:83], v18, s[36:39], s58 offen sc1
    buffer_load_dwordx4 v[84:87], v18, s[36:39], s59 offen sc1
    buffer_load_dwordx4 v[92:95], v19, s[36:39], s58 offen sc1
    buffer_load_dwordx4 v[96:99], v19, s[36:39], s59 offen sc1
    s_waitcnt vmcnt(0)
    v_perm_b32 v22, v81, v80, s56
    v_perm_b32 v23, v83, v82, s57
    v_or_b32 v22, v22, v23
    v_cmp_ne_u32 vcc, v3, v22
    v_perm_b32 v22, v85, v84, s56
    v_perm_b32 v23, v87, v86, s57
    v_or_b32 v22, v22, v23
    v_cmp_ne_u32 s[48:49], v3, v22
    s_nop 0
    s_or_b64 vcc, vcc, s[48:49]
    v_perm_b32 v22, v93, v92, s56
    v_perm_b32 v23, v95, v94, s57
    v_or_b32 v22, v22, v23
    v_cmp_ne_u32 s[48:49], v3, v22
    s_nop 0
    s_or_b64 vcc, vcc, s[48:49]
    v_perm_b32 v22, v97, v96, s56
    v_perm_b32 v23, v99, v98, s57
    v_or_b32 v22, v22, v23
    v_cmp_ne_u32 s[48:49], v3, v22
    s_nop 0
    s_or_b64 vcc, vcc, s[48:49]
    s_cbranch_vccz Le_m_10
    s_sub_u32 s7, s7, 1
    s_cbranch_scc1 Le_m_10
    s_sleep 1
    s_branch Lp_m_9
Le_m_10:
    s_max_i32 s7, s7, 0
L_m_8:
    v_cmp_le_u32 vcc, 4608, v19
    s_nop 1
    v_cndmask_b32 v22, 0, 1.0, vcc
    v_and_b32 v80, 0xffffff00, v80
    v_and_b32 v81, 0xffffff00, v81
    v_and_b32 v82, 0xffffff00, v82
    v_and_b32 v83, 0xffffff00, v83
    v_and_b32 v84, 0xffffff00, v84
    v_and_b32 v85, 0xffffff00, v85
    v_and_b32 v86, 0xffffff00, v86
    v_and_b32 v87, 0xffffff00, v87
    v_pk_add_f32 v[80:81], v[80:81], v[84:85]
    v_pk_add_f32 v[82:83], v[82:83], v[86:87]
    v_cvt_pk_bf16_f32 v80, 0, v80
    v_cvt_pk_bf16_f32 v81, 0, v81
    v_cvt_pk_bf16_f32 v82, 0, v82
    v_cvt_pk_bf16_f32 v83, 0, v83
    v_and_b32 v92, 0xffffff00, v92
    v_and_b32 v93, 0xffffff00, v93
    v_and_b32 v94, 0xffffff00, v94
    v_and_b32 v95, 0xffffff00, v95
    v_and_b32 v96, 0xffffff00, v96
    v_and_b32 v97, 0xffffff00, v97
    v_and_b32 v98, 0xffffff00, v98
    v_and_b32 v99, 0xffffff00, v99
    v_pk_add_f32 v[92:93], v[92:93], v[96:97]
    v_pk_add_f32 v[94:95], v[94:95], v[98:99]
    v_cvt_pk_bf16_f32 v92, 0, v92
    v_cvt_pk_bf16_f32 v93, 0, v93
    v_cvt_pk_bf16_f32 v94, 0, v94
    v_cvt_pk_bf16_f32 v95, 0, v95
    v_add_f32 v92, v92, v22
    v_add_f32 v93, v93, v22
    v_add_f32 v94, v94, v22
    v_add_f32 v95, v95, v22
    v_cvt_pk_bf16_f32 v92, 0, v92
    v_cvt_pk_bf16_f32 v93, 0, v93
    v_cvt_pk_bf16_f32 v94, 0, v94
    v_cvt_pk_bf16_f32 v95, 0, v95
    v_add_u32 v22, 108544, v18
    v_add_u32 v23, 108544, v19
    ds_write_b128 v22, v[80:83]
    ds_write_b128 v23, v[92:95]
    s_cmp_lg_u32 s2, 255
    s_cbranch_scc1 L_m_11
    s_mov_b32 s50, 4608
    buffer_store_dwordx4 v[80:83], v18, s[36:39], s50 offen sc1
    buffer_store_dwordx4 v[92:95], v19, s[36:39], s50 offen sc1
Lp_m_12:
    buffer_load_dwordx4 v[104:107], v20, s[36:39], s58 offen sc1
    buffer_load_dwordx4 v[108:111], v20, s[36:39], s59 offen sc1
    s_waitcnt vmcnt(0)
    v_perm_b32 v22, v105, v104, s56
    v_perm_b32 v23, v107, v106, s57
    v_or_b32 v22, v22, v23
    v_cmp_ne_u32 vcc, v3, v22
    v_perm_b32 v22, v109, v108, s56
    v_perm_b32 v23, v111, v110, s57
    v_or_b32 v22, v22, v23
    v_cmp_ne_u32 s[48:49], v3, v22
    s_nop 0
    s_or_b64 vcc, vcc, s[48:49]
    s_cbranch_vccz Le_m_13
    s_sub_u32 s7, s7, 1
    s_cbranch_scc1 Le_m_13
    s_sleep 1
    s_branch Lp_m_12
Le_m_13:
    s_max_i32 s7, s7, 0
    v_and_b32 v104, 0xffffff00, v104
    v_and_b32 v105, 0xffffff00, v105
    v_and_b32 v106, 0xffffff00, v106
    v_and_b32 v107, 0xffffff00, v107
    v_and_b32 v108, 0xffffff00, v108
    v_and_b32 v109, 0xffffff00, v109
    v_and_b32 v110, 0xffffff00, v110
    v_and_b32 v111, 0xffffff00, v111
    v_pk_add_f32 v[104:105], v[104:105], v[108:109]
    v_pk_add_f32 v[106:107], v[106:107], v[110:111]
    v_cvt_pk_bf16_f32 v104, 0, v104
    v_cvt_pk_bf16_f32 v105, 0, v105
    v_cvt_pk_bf16_f32 v106, 0, v106
    v_cvt_pk_bf16_f32 v107, 0, v107
    buffer_store_dwordx4 v[104:107], v20, s[36:39], s50 offen sc1
L_m_11:
    v_lshlrev_b32 v236, 16, v9
    v_and_b32 v237, 0xffff0000, v9
    v_lshlrev_b32 v238, 16, v10
    v_and_b32 v239, 0xffff0000, v10
    v_lshlrev_b32 v240, 16, v11
    v_and_b32 v241, 0xffff0000, v11
    v_lshlrev_b32 v242, 16, v12
    v_and_b32 v243, 0xffff0000, v12
    v_lshlrev_b32 v244, 16, v13
    v_and_b32 v245, 0xffff0000, v13
    v_lshlrev_b32 v246, 16, v14
    v_and_b32 v247, 0xffff0000, v14
    v_lshlrev_b32 v248, 16, v15
    v_and_b32 v249, 0xffff0000, v15
    v_lshlrev_b32 v250, 16, v16
    v_and_b32 v251, 0xffff0000, v16
    v_lshlrev_b32 v252, 16, v17
    v_and_b32 v253, 0xffff0000, v17
    s_cmp_ge_u32 s5, 20
    s_cbranch_scc1 L_m_14
    ds_read_b128 v[128:131], v230 offset:0
    ds_read_b128 v[132:135], v230 offset:1024
    ds_read_b128 v[136:139], v230 offset:2048
    ds_read_b128 v[140:143], v230 offset:3072
    ds_read_b128 v[144:147], v230 offset:4096
    ds_read_b128 v[148:151], v230 offset:5120
    ds_read_b128 v[152:155], v230 offset:6144
    ds_read_b128 v[156:159], v230 offset:7168
    ds_read_b128 v[160:163], v230 offset:8192
    ds_read_b128 v[164:167], v230 offset:9216
    ds_read_b128 v[168:171], v230 offset:10240
    ds_read_b128 v[172:175], v230 offset:11264
    ds_read_b128 v[176:179], v230 offset:12288
    ds_read_b128 v[180:183], v230 offset:13312
    ds_read_b128 v[184:187], v230 offset:14336
    s_waitcnt lgkmcnt(0)
    s_barrier
    s_branch L_m_15
L_m_14:
    s_waitcnt lgkmcnt(0)
    s_barrier
    ds_read_b128 v[128:131], v230 offset:0
    ds_read_b128 v[132:135], v230 offset:1024
    ds_read_b128 v[136:139], v230 offset:2048
    ds_read_b128 v[140:143], v230 offset:3072
    ds_read_b128 v[144:147], v230 offset:4096
    ds_read_b128 v[148:151], v230 offset:5120
    ds_read_b128 v[152:155], v230 offset:6144
    ds_read_b128 v[156:159], v230 offset:7168
    ds_read_b128 v[160:163], v230 offset:8192
    ds_read_b128 v[164:167], v230 offset:9216
    ds_read_b128 v[168:171], v230 offset:10240
    ds_read_b128 v[172:175], v230 offset:11264
    ds_read_b128 v[176:179], v230 offset:12288
    ds_read_b128 v[180:183], v230 offset:13312
    ds_read_b128 v[184:187], v230 offset:14336
    s_lshl_b32 s50, s2, 7
    s_add_u32 s50, s50, 557056
    v_mov_b32 v18, 0
Lp_m_16:
    buffer_load_dword v19, v18, s[36:39], s50 offen sc1
    s_waitcnt vmcnt(0)
    v_cmp_ne_u32 vcc, v3, v19
    s_nop 0
    s_cbranch_vccz Le_m_17
    s_sub_u32 s7, s7, 1
    s_cbranch_scc1 Le_m_17
    s_sleep 4
    s_branch Lp_m_16
Le_m_17:
    s_max_i32 s7, s7, 0
    s_waitcnt lgkmcnt(0)
L_m_15:
Lp_m_18:
    buffer_load_dwordx4 v[212:215], v36, s[36:39], s66 offen offset:0 sc1
    buffer_load_dwordx4 v[216:219], v36, s[36:39], s66 offen offset:1024 sc1
    buffer_load_dwordx4 v[220:223], v232, s[36:39], s66 offen offset:2048 sc1
    s_waitcnt vmcnt(0)
    v_max3_u32 v18, v212, v216, v220
    v_cmp_eq_u32 vcc, -1, v18
    s_nop 0
    s_cbranch_vccz Le_m_19
    s_sub_u32 s7, s7, 1
    s_cbranch_scc1 Le_m_19
    s_mov_b64 exec, vcc
    s_sleep 1
    s_branch Lp_m_18
Le_m_19:
    s_mov_b64 exec, -1
    s_max_i32 s7, s7, 0
    ds_write_b128 v233, v[212:215] offset:0
    s_branch L_skip_2
    s_nop 0
L_stub_2:
    s_branch L_back_c1
L_skip_2:
    ds_write_b128 v233, v[216:219] offset:1024
    ds_write_b128 v234, v[220:223] offset:2048
    s_waitcnt lgkmcnt(0)
    s_barrier
    ds_read_b128 v[80:83], v72 offset:0
    ds_read_b128 v[84:87], v73 offset:0
    ds_read_b128 v[88:91], v74 offset:0
    ds_read_b128 v[92:95], v75 offset:0
    ds_read_b128 v[96:99], v72 offset:4096
    ds_read_b128 v[100:103], v73 offset:4096
    ds_read_b128 v[104:107], v74 offset:4096
    ds_read_b128 v[108:111], v75 offset:4096
    ds_read_b128 v[112:115], v76 offset:8192
    ds_read_b128 v[116:119], v77 offset:8192
    ds_read_b128 v[120:123], v78 offset:8192
    ds_read_b128 v[124:127], v79 offset:8192
    s_waitcnt lgkmcnt(11)
    v_mfma_f32_16x16x32_bf16 v[188:191], v[80:83], v[44:47], 0
    v_mfma_f32_16x16x32_bf16 v[192:195], v[80:83], v[40:43], 0
    s_waitcnt lgkmcnt(10)
    v_mfma_f32_16x16x32_bf16 v[188:191], v[84:87], v[52:55], v[188:191]
    v_mfma_f32_16x16x32_bf16 v[192:195], v[84:87], v[48:51], v[192:195]
    s_waitcnt lgkmcnt(9)
    v_mfma_f32_16x16x32_bf16 v[188:191], v[88:91], v[60:63], v[188:191]
    v_mfma_f32_16x16x32_bf16 v[192:195], v[88:91], v[56:59], v[192:195]
    s_waitcnt lgkmcnt(8)
    v_mfma_f32_16x16x32_bf16 v[188:191], v[92:95], v[68:71], v[188:191]
    v_mfma_f32_16x16x32_bf16 v[192:195], v[92:95], v[64:67], v[192:195]
    s_waitcnt lgkmcnt(7)
    v_mfma_f32_16x16x32_bf16 v[196:199], v[96:99], v[44:47], 0
    v_mfma_f32_16x16x32_bf16 v[200:203], v[96:99], v[40:43], 0
    s_waitcnt lgkmcnt(6)
    v_mfma_f32_16x16x32_bf16 v[196:199], v[100:103], v[52:55], v[196:199]
    v_mfma_f32_16x16x32_bf16 v[200:203], v[100:103], v[48:51], v[200:203]
    s_waitcnt lgkmcnt(5)
    v_mfma_f32_16x16x32_bf16 v[196:199], v[104:107], v[60:63], v[196:199]
    v_mul_f32 v18, v188, v30
    v_mul_f32 v19, v192, v30
    v_mfma_f32_16x16x32_bf16 v[200:203], v[104:107], v[56:59], v[200:203]
    v_fma_f32 v18, -v192, v31, v18
    v_fmac_f32 v19, v188, v31
    s_waitcnt lgkmcnt(4)
    v_mfma_f32_16x16x32_bf16 v[196:199], v[108:111], v[68:71], v[196:199]
    v_cvt_pk_bf16_f32 v212, v18, v19
    v_mul_f32 v20, v189, v30
    v_mfma_f32_16x16x32_bf16 v[200:203], v[108:111], v[64:67], v[200:203]
    v_mul_f32 v21, v193, v30
    v_fma_f32 v20, -v193, v31, v20
    s_waitcnt lgkmcnt(3)
    v_mfma_f32_16x16x32_bf16 v[204:207], v[112:115], v[44:47], 0
    v_fmac_f32 v21, v189, v31
    v_cvt_pk_bf16_f32 v213, v20, v21
    v_mfma_f32_16x16x32_bf16 v[208:211], v[112:115], v[40:43], 0
    v_mul_f32 v22, v190, v30
    v_mul_f32 v23, v194, v30
    s_waitcnt lgkmcnt(2)
    v_mfma_f32_16x16x32_bf16 v[204:207], v[116:119], v[52:55], v[204:207]
    v_fma_f32 v22, -v194, v31, v22
    v_fmac_f32 v23, v190, v31
    v_mfma_f32_16x16x32_bf16 v[208:211], v[116:119], v[48:51], v[208:211]
    v_cvt_pk_bf16_f32 v214, v22, v23
    v_mul_f32 v24, v191, v30
    s_waitcnt lgkmcnt(1)
    v_mfma_f32_16x16x32_bf16 v[204:207], v[120:123], v[60:63], v[204:207]
    v_mul_f32 v25, v195, v30
    v_fma_f32 v24, -v195, v31, v24
    v_mfma_f32_16x16x32_bf16 v[208:211], v[120:123], v[56:59], v[208:211]
    v_fmac_f32 v25, v191, v31
    v_cvt_pk_bf16_f32 v215, v24, v25
    s_waitcnt lgkmcnt(0)
    v_mfma_f32_16x16x32_bf16 v[204:207], v[124:127], v[68:71], v[204:207]
    v_mul_f32 v18, v196, v32
    v_mul_f32 v19, v200, v32
    v_mfma_f32_16x16x32_bf16 v[208:211], v[124:127], v[64:67], v[208:211]
    v_fma_f32 v18, -v200, v33, v18
    v_fmac_f32 v19, v196, v33
    v_mfma_f32_16x16x32_bf16 v[80:83], v[212:215], v[128:131], 0
    v_cvt_pk_bf16_f32 v216, v18, v19
    v_mul_f32 v20, v197, v32
    v_mfma_f32_16x16x32_bf16 v[84:87], v[212:215], v[140:143], 0
    v_mul_f32 v21, v201, v32
    v_fma_f32 v20, -v201, v33, v20
    v_mfma_f32_16x16x32_bf16 v[88:91], v[212:215], v[152:155], 0
    v_fmac_f32 v21, v197, v33
    v_cvt_pk_bf16_f32 v217, v20, v21
    v_mfma_f32_16x16x32_bf16 v[92:95], v[212:215], v[164:167], 0
    v_mul_f32 v22, v198, v32
    v_mul_f32 v23, v202, v32
    v_mfma_f32_16x16x32_bf16 v[96:99], v[212:215], v[176:179], 0
    v_fma_f32 v22, -v202, v33, v22
    v_fmac_f32 v23, v198, v33
    v_cvt_pk_bf16_f32 v218, v22, v23
    v_mul_f32 v24, v199, v32
    v_mul_f32 v25, v203, v32
    v_fma_f32 v24, -v203, v33, v24
    v_fmac_f32 v25, v199, v33
    v_cvt_pk_bf16_f32 v219, v24, v25
    s_nop 1
    v_mfma_f32_16x16x32_bf16 v[80:83], v[216:219], v[132:135], v[80:83]
    v_mul_f32 v18, v204, v34
    v_mul_f32 v19, v208, v34
    v_mfma_f32_16x16x32_bf16 v[84:87], v[216:219], v[144:147], v[84:87]
    v_fma_f32 v18, -v208, v35, v18
    v_fmac_f32 v19, v204, v35
    v_mfma_f32_16x16x32_bf16 v[88:91], v[216:219], v[156:159], v[88:91]
    v_cvt_pk_bf16_f32 v220, v18, v19
    v_mul_f32 v20, v205, v34
    v_mfma_f32_16x16x32_bf16 v[92:95], v[216:219], v[168:171], v[92:95]
    v_mul_f32 v21, v209, v34
    v_fma_f32 v20, -v209, v35, v20
    v_mfma_f32_16x16x32_bf16 v[96:99], v[216:219], v[180:183], v[96:99]
    v_fmac_f32 v21, v205, v35
    v_cvt_pk_bf16_f32 v221, v20, v21
    v_mul_f32 v22, v206, v34
    v_mul_f32 v23, v210, v34
    v_fma_f32 v22, -v210, v35, v22
    v_fmac_f32 v23, v206, v35
    v_cvt_pk_bf16_f32 v222, v22, v23
    v_mul_f32 v24, v207, v34
    v_mul_f32 v25, v211, v34
    v_fma_f32 v24, -v211, v35, v24
    v_fmac_f32 v25, v207, v35
    v_cvt_pk_bf16_f32 v223, v24, v25
    s_nop 1
    v_mfma_f32_16x16x32_bf16 v[80:83], v[220:223], v[136:139], v[80:83]
    v_mfma_f32_16x16x32_bf16 v[84:87], v[220:223], v[148:151], v[84:87]
    v_mfma_f32_16x16x32_bf16 v[88:91], v[220:223], v[160:163], v[88:91]
    v_mfma_f32_16x16x32_bf16 v[92:95], v[220:223], v[172:175], v[92:95]
    v_mfma_f32_16x16x32_bf16 v[96:99], v[220:223], v[184:187], v[96:99]
    ds_read2st64_b64 v[40:43], v228 offset0:0 offset1:1
    ds_read2st64_b64 v[44:47], v37 offset0:0 offset1:1
    ds_read2st64_b64 v[48:51], v228 offset0:2 offset1:3
    ds_read2st64_b64 v[52:55], v37 offset0:2 offset1:3
    ds_read_b64 v[56:57], v228 offset:2048
    ds_write_b128 v225, v[80:83] offset:0
    ds_write_b128 v225, v[84:87] offset:512
    ds_write_b128 v225, v[88:91] offset:1024
    ds_write_b128 v225, v[92:95] offset:1536
    ds_write_b128 v224, v[96:99] offset:2048
    ds_read2st64_b64 v[188:191], v228 offset0:9 offset1:10
    ds_read2st64_b64 v[192:195], v37 offset0:9 offset1:10
    ds_read2st64_b64 v[196:199], v228 offset0:11 offset1:12
    ds_read2st64_b64 v[200:203], v37 offset0:11 offset1:12
    ds_read_b64 v[204:205], v228 offset:6656
    ds_read2st64_b64 v[128:131], v37 offset0:4 offset1:5
    ds_read2st64_b64 v[132:135], v228 offset0:5 offset1:6
    ds_read2st64_b64 v[136:139], v37 offset0:6 offset1:7
    ds_read2st64_b64 v[140:143], v228 offset0:7 offset1:8
    ds_read_b64 v[144:145], v228 offset:4352
    s_waitcnt lgkmcnt(10)
    s_barrier
    ds_read_b64 v[100:101], v226 offset:0
    ds_read_b64 v[102:103], v226 offset:256
    ds_read_b64 v[104:105], v226 offset:512
    ds_read_b64 v[106:107], v226 offset:768
    ds_read_b64 v[108:109], v226 offset:1024
    ds_read_b64 v[110:111], v226 offset:1280
    ds_read_b64 v[112:113], v226 offset:1536
    ds_read_b64 v[114:115], v226 offset:1792
    ds_read_b64 v[116:117], v226 offset:2048
    s_mul_i32 s48, s6, 9216
    s_lshl_b32 s49, s3, 10
    s_add_u32 s48, s48, s49
    s_add_u32 s48, s48, 16777216
    s_add_u32 s49, s48, 4096
    s_add_u32 s50, s48, 8192
    s_waitcnt lgkmcnt(8)
    v_pk_fma_f32 v[236:237], v[100:101], v[40:41], v[236:237]
    s_waitcnt lgkmcnt(7)
    v_pk_fma_f32 v[238:239], v[102:103], v[44:45], v[238:239]
    s_waitcnt lgkmcnt(6)
    v_pk_fma_f32 v[240:241], v[104:105], v[42:43], v[240:241]
    s_waitcnt lgkmcnt(5)
    v_pk_fma_f32 v[242:243], v[106:107], v[46:47], v[242:243]
    s_waitcnt lgkmcnt(4)
    v_pk_fma_f32 v[244:245], v[108:109], v[48:49], v[244:245]
    s_waitcnt lgkmcnt(3)
    v_pk_fma_f32 v[246:247], v[110:111], v[52:53], v[246:247]
    s_waitcnt lgkmcnt(2)
    v_pk_fma_f32 v[248:249], v[112:113], v[50:51], v[248:249]
    s_waitcnt lgkmcnt(1)
    v_pk_fma_f32 v[250:251], v[114:115], v[54:55], v[250:251]
    s_waitcnt lgkmcnt(0)
    v_pk_fma_f32 v[252:253], v[116:117], v[56:57], v[252:253]
    v_pk_add_f32 v[24:25], v[236:237], v[238:239]
    v_pk_mul_f32 v[26:27], v[236:237], v[236:237]
    v_pk_fma_f32 v[26:27], v[238:239], v[238:239], v[26:27]
    v_pk_add_f32 v[24:25], v[24:25], v[240:241]
    v_pk_fma_f32 v[26:27], v[240:241], v[240:241], v[26:27]
    v_pk_add_f32 v[24:25], v[24:25], v[242:243]
    v_pk_fma_f32 v[26:27], v[242:243], v[242:243], v[26:27]
    v_pk_add_f32 v[24:25], v[24:25], v[244:245]
    v_pk_fma_f32 v[26:27], v[244:245], v[244:245], v[26:27]
    v_pk_add_f32 v[24:25], v[24:25], v[246:247]
    v_pk_fma_f32 v[26:27], v[246:247], v[246:247], v[26:27]
    v_pk_add_f32 v[24:25], v[24:25], v[248:249]
    v_pk_fma_f32 v[26:27], v[248:249], v[248:249], v[26:27]
    v_pk_add_f32 v[24:25], v[24:25], v[250:251]
    v_pk_fma_f32 v[26:27], v[250:251], v[250:251], v[26:27]
    v_pk_add_f32 v[24:25], v[24:25], v[252:253]
    v_pk_fma_f32 v[26:27], v[252:253], v[252:253], v[26:27]
    v_add_f32 v24, v24, v25
    v_add_f32 v25, v26, v27
    s_nop 0
    v_add_f32_dpp v24, v24, v24 quad_perm:[1,0,3,2] row_mask:0xf bank_mask:0xf
    v_add_f32_dpp v25, v25, v25 quad_perm:[1,0,3,2] row_mask:0xf bank_mask:0xf
    s_nop 0
    v_add_f32_dpp v24, v24, v24 quad_perm:[2,3,0,1] row_mask:0xf bank_mask:0xf
    v_add_f32_dpp v25, v25, v25 quad_perm:[2,3,0,1] row_mask:0xf bank_mask:0xf
    s_nop 0
    v_add_f32_dpp v24, v24, v24 row_half_mirror row_mask:0xf bank_mask:0xf
    v_add_f32_dpp v25, v25, v25 row_half_mirror row_mask:0xf bank_mask:0xf
    s_nop 0
    v_add_f32_dpp v24, v24, v24 row_mirror row_mask:0xf bank_mask:0xf
    v_add_f32_dpp v25, v25, v25 row_mirror row_mask:0xf bank_mask:0xf
    v_mov_b32 v26, v24
    v_mov_b32 v27, v25
    s_nop 0
    v_permlane16_swap_b32 v24, v26
    v_permlane16_swap_b32 v25, v27
    v_add_f32 v24, v24, v26
    v_add_f32 v25, v25, v27
    v_mul_f32 v24, 0xbae38e39, v24
    v_mul_f32 v25, 0x3ae38e39, v25
    v_fma_f32 v25, -v24, v24, v25
    v_max_f32 v25, 0, v25
    v_add_f32 v25, 0x3727c5ac, v25
    v_rsq_f32 v26, v25
    s_nop 0
    v_mul_f32 v24, v24, v26
    v_pk_fma_f32 v[100:101], v[236:237], v[26:27], v[24:25] op_sel_hi:[1,0,0]
    v_pk_fma_f32 v[102:103], v[238:239], v[26:27], v[24:25] op_sel_hi:[1,0,0]
    v_pk_fma_f32 v[104:105], v[240:241], v[26:27], v[24:25] op_sel_hi:[1,0,0]
    v_pk_fma_f32 v[106:107], v[242:243], v[26:27], v[24:25] op_sel_hi:[1,0,0]
    v_pk_fma_f32 v[108:109], v[244:245], v[26:27], v[24:25] op_sel_hi:[1,0,0]
    v_pk_fma_f32 v[110:111], v[246:247], v[26:27], v[24:25] op_sel_hi:[1,0,0]
    v_pk_fma_f32 v[112:113], v[248:249], v[26:27], v[24:25] op_sel_hi:[1,0,0]
    v_pk_fma_f32 v[114:115], v[250:251], v[26:27], v[24:25] op_sel_hi:[1,0,0]
    v_pk_fma_f32 v[116:117], v[252:253], v[26:27], v[24:25] op_sel_hi:[1,0,0]
    v_pk_fma_f32 v[100:101], v[100:101], v[188:189], v[128:129]
    v_pk_fma_f32 v[102:103], v[102:103], v[192:193], v[132:133]
    v_pk_fma_f32 v[104:105], v[104:105], v[190:191], v[130:131]
    v_pk_fma_f32 v[106:107], v[106:107], v[194:195], v[134:135]
    v_pk_fma_f32 v[108:109], v[108:109], v[196:197], v[136:137]
    v_pk_fma_f32 v[110:111], v[110:111], v[200:201], v[140:141]
    v_pk_fma_f32 v[112:113], v[112:113], v[198:199], v[138:139]
    v_pk_fma_f32 v[114:115], v[114:115], v[202:203], v[142:143]
    v_pk_fma_f32 v[116:117], v[116:117], v[204:205], v[144:145]
    v_pk_add_f32 v[24:25], v[100:101], v[102:103]
    v_pk_mul_f32 v[26:27], v[100:101], v[100:101]
    v_pk_fma_f32 v[26:27], v[102:103], v[102:103], v[26:27]
    v_pk_add_f32 v[24:25], v[24:25], v[104:105]
    v_pk_fma_f32 v[26:27], v[104:105], v[104:105], v[26:27]
    v_pk_add_f32 v[24:25], v[24:25], v[106:107]
    v_pk_fma_f32 v[26:27], v[106:107], v[106:107], v[26:27]
    v_pk_add_f32 v[24:25], v[24:25], v[108:109]
    v_pk_fma_f32 v[26:27], v[108:109], v[108:109], v[26:27]
    v_pk_add_f32 v[24:25], v[24:25], v[110:111]
    v_pk_fma_f32 v[26:27], v[110:111], v[110:111], v[26:27]
    v_pk_add_f32 v[24:25], v[24:25], v[112:113]
    v_pk_fma_f32 v[26:27], v[112:113], v[112:113], v[26:27]
    v_pk_add_f32 v[24:25], v[24:25], v[114:115]
    v_pk_fma_f32 v[26:27], v[114:115], v[114:115], v[26:27]
    v_pk_add_f32 v[24:25], v[24:25], v[116:117]
    v_pk_fma_f32 v[26:27], v[116:117], v[116:117], v[26:27]
    v_add_f32 v24, v24, v25
    v_add_f32 v25, v26, v27
    s_nop 0
    v_add_f32_dpp v24, v24, v24 quad_perm:[1,0,3,2] row_mask:0xf bank_mask:0xf
    v_add_f32_dpp v25, v25, v25 quad_perm:[1,0,3,2] row_mask:0xf bank_mask:0xf
    s_nop 0
    v_add_f32_dpp v24, v24, v24 quad_perm:[2,3,0,1] row_mask:0xf bank_mask:0xf
    v_add_f32_dpp v25, v25, v25 quad_perm:[2,3,0,1] row_mask:0xf bank_mask:0xf
    s_nop 0
    v_add_f32_dpp v24, v24, v24 row_half_mirror row_mask:0xf bank_mask:0xf
    v_add_f32_dpp v25, v25, v25 row_half_mirror row_mask:0xf bank_mask:0xf
    s_nop 0
    v_add_f32_dpp v24, v24, v24 row_mirror row_mask:0xf bank_mask:0xf
    v_add_f32_dpp v25, v25, v25 row_mirror row_mask:0xf bank_mask:0xf
    v_mov_b32 v26, v24
    v_mov_b32 v27, v25
    s_nop 0
    v_permlane16_swap_b32 v24, v26
    v_permlane16_swap_b32 v25, v27
    v_add_f32 v24, v24, v26
    v_add_f32 v25, v25, v27
    v_mul_f32 v24, 0xbae38e39, v24
    v_mul_f32 v25, 0x3ae38e39, v25
    v_fma_f32 v25, -v24, v24, v25
    v_max_f32 v25, 0, v25
    v_add_f32 v25, 0x3727c5ac, v25
    v_rsq_f32 v26, v25
    s_nop 0
    v_mul_f32 v24, v24, v26
    v_pk_fma_f32 v[100:101], v[100:101], v[26:27], v[24:25] op_sel_hi:[1,0,0]
    v_cvt_pk_bf16_f32 v9, v100, v101
    v_pk_fma_f32 v[102:103], v[102:103], v[26:27], v[24:25] op_sel_hi:[1,0,0]
    v_cvt_pk_bf16_f32 v10, v102, v103
    ds_write2_b32 v227, v9, v10 offset0:0 offset1:32
    v_pk_fma_f32 v[104:105], v[104:105], v[26:27], v[24:25] op_sel_hi:[1,0,0]
    v_cvt_pk_bf16_f32 v11, v104, v105
    v_pk_fma_f32 v[106:107], v[106:107], v[26:27], v[24:25] op_sel_hi:[1,0,0]
    v_cvt_pk_bf16_f32 v12, v106, v107
    ds_write2_b32 v227, v11, v12 offset0:64 offset1:96
    v_pk_fma_f32 v[108:109], v[108:109], v[26:27], v[24:25] op_sel_hi:[1,0,0]
    v_cvt_pk_bf16_f32 v13, v108, v109
    v_pk_fma_f32 v[110:111], v[110:111], v[26:27], v[24:25] op_sel_hi:[1,0,0]
    v_cvt_pk_bf16_f32 v14, v110, v111
    ds_write2_b32 v227, v13, v14 offset0:128 offset1:160
    v_pk_fma_f32 v[112:113], v[112:113], v[26:27], v[24:25] op_sel_hi:[1,0,0]
    v_cvt_pk_bf16_f32 v15, v112, v113
    v_pk_fma_f32 v[114:115], v[114:115], v[26:27], v[24:25] op_sel_hi:[1,0,0]
    v_cvt_pk_bf16_f32 v16, v114, v115
    ds_write2_b32 v227, v15, v16 offset0:192 offset1:224
    v_pk_fma_f32 v[116:117], v[116:117], v[26:27], v[24:25] op_sel_hi:[1,0,0]
    v_cvt_pk_bf16_f32 v17, v116, v117
    ds_write_b32 v227, v17 offset:1024
    s_waitcnt lgkmcnt(0)
    s_barrier
    ds_read_b64_tr_b16 v[188:189], v229 offset:0
    ds_read_b64_tr_b16 v[190:191], v229 offset:4736
    ds_read_b64_tr_b16 v[192:193], v229 offset:512
    ds_read_b64_tr_b16 v[194:195], v229 offset:5248
    ds_read_b64_tr_b16 v[196:197], v229 offset:1024
    ds_read_b64_tr_b16 v[198:199], v229 offset:5760
    s_waitcnt lgkmcnt(4)
    buffer_store_dwordx4 v[188:191], v36, s[36:39], s48 offen sc1
    s_waitcnt lgkmcnt(2)
    buffer_store_dwordx4 v[192:195], v36, s[36:39], s49 offen sc1
    s_waitcnt lgkmcnt(0)
    s_cmp_lg_u32 s3, 0
    s_cbranch_scc1 L_m_20
    buffer_store_dwordx4 v[196:199], v36, s[36:39], s50 offen sc1
L_m_20:
    v_cvt_pk_bf16_f32 v9, v236, v237
    v_cvt_pk_bf16_f32 v10, v238, v239
    v_cvt_pk_bf16_f32 v11, v240, v241
    v_cvt_pk_bf16_f32 v12, v242, v243
    v_cvt_pk_bf16_f32 v13, v244, v245
    v_cvt_pk_bf16_f32 v14, v246, v247
    v_cvt_pk_bf16_f32 v15, v248, v249
    v_cvt_pk_bf16_f32 v16, v250, v251
    v_cvt_pk_bf16_f32 v17, v252, v253
    ds_write2_b32 v231, v9, v10 offset0:0 offset1:32
    ds_write2_b32 v231, v11, v12 offset0:64 offset1:96
    ds_write2_b32 v231, v13, v14 offset0:128 offset1:160
    ds_write2_b32 v231, v15, v16 offset0:192 offset1:224
    ds_write_b32 v231, v17 offset:1024
    s_waitcnt lgkmcnt(0)
    s_barrier
    s_cmp_ge_u32 s5, 27
    s_cbranch_scc1 L_m_21
    v_lshrrev_b32 v10, 2, v0
    v_and_b32 v11, 7, v10
    s_lshl_b32 s59, s3, 1
    s_add_u32 s59, s59, 0
    v_xor_b32 v11, s59, v11
    v_xor_b32 v12, 1, v11
    v_and_b32 v13, 3, v0
    v_lshlrev_b32 v13, 3, v13
    v_lshl_add_u32 v10, v10, 8, v13
    v_lshl_add_u32 v20, v11, 5, v10
    v_lshl_add_u32 v21, v12, 5, v10
    v_add_u32 v24, 0, v20
    v_add_u32 v25, 0, v21
    ds_read_b64_tr_b16 v[92:93], v24 offset:0
    ds_read_b64_tr_b16 v[94:95], v24 offset:4096
    ds_read_b64_tr_b16 v[96:97], v25 offset:0
    ds_read_b64_tr_b16 v[98:99], v25 offset:4096
    ds_read_b64_tr_b16 v[100:101], v24 offset:8192
    ds_read_b64_tr_b16 v[102:103], v24 offset:12288
    ds_read_b64_tr_b16 v[104:105], v25 offset:8192
    ds_read_b64_tr_b16 v[106:107], v25 offset:12288
    ds_read_b64_tr_b16 v[108:109], v24 offset:16384
    ds_read_b64_tr_b16 v[110:111], v24 offset:20480
    ds_read_b64_tr_b16 v[112:113], v25 offset:16384
    ds_read_b64_tr_b16 v[114:115], v25 offset:20480
    ds_read_b64_tr_b16 v[116:117], v24 offset:24576
    ds_read_b64_tr_b16 v[118:119], v24 offset:28672
    ds_read_b64_tr_b16 v[120:121], v25 offset:24576
    ds_read_b64_tr_b16 v[122:123], v25 offset:28672
    ds_read_b64_tr_b16 v[124:125], v24 offset:32768
    ds_read_b64_tr_b16 v[126:127], v24 offset:36864
    ds_read_b64_tr_b16 v[128:129], v25 offset:32768
    ds_read_b64_tr_b16 v[130:131], v25 offset:36864
    ds_read_b64_tr_b16 v[132:133], v24 offset:40960
    ds_read_b64_tr_b16 v[134:135], v24 offset:45056
    ds_read_b64_tr_b16 v[136:137], v25 offset:40960
    ds_read_b64_tr_b16 v[138:139], v25 offset:45056
    v_add_u32 v24, 49152, v20
    v_add_u32 v25, 49152, v21
    ds_read_b64_tr_b16 v[140:141], v24 offset:0
    ds_read_b64_tr_b16 v[142:143], v24 offset:4096
    ds_read_b64_tr_b16 v[144:145], v25 offset:0
    ds_read_b64_tr_b16 v[146:147], v25 offset:4096
    ds_read_b64_tr_b16 v[148:149], v24 offset:8192
    ds_read_b64_tr_b16 v[150:151], v24 offset:12288
    ds_read_b64_tr_b16 v[152:153], v25 offset:8192
    ds_read_b64_tr_b16 v[154:155], v25 offset:12288
    ds_read_b64_tr_b16 v[156:157], v24 offset:16384
    ds_read_b64_tr_b16 v[158:159], v24 offset:20480
    ds_read_b64_tr_b16 v[160:161], v25 offset:16384
    ds_read_b64_tr_b16 v[162:163], v25 offset:20480
    ds_read_b64_tr_b16 v[164:165], v24 offset:24576
    ds_read_b64_tr_b16 v[166:167], v24 offset:28672
    ds_read_b64_tr_b16 v[168:169], v25 offset:24576
    ds_read_b64_tr_b16 v[170:171], v25 offset:28672
    ds_read_b64_tr_b16 v[172:173], v24 offset:32768
    ds_read_b64_tr_b16 v[174:175], v24 offset:36864
    ds_read_b64_tr_b16 v[176:177], v25 offset:32768
    ds_read_b64_tr_b16 v[178:179], v25 offset:36864
    ds_read_b64_tr_b16 v[180:181], v24 offset:40960
    ds_read_b64_tr_b16 v[182:183], v24 offset:45056
    ds_read_b64_tr_b16 v[184:185], v25 offset:40960
    ds_read_b64_tr_b16 v[186:187], v25 offset:45056
    s_waitcnt vmcnt(0) lgkmcnt(0)
    s_barrier
    v_mul_u32_u24 v18, 1536, v2
    v_lshl_add_u32 v18, v1, 4, v18
    v_add_u32 v18, 98304, v18
    v_lshlrev_b32 v204, 16, v4
    v_and_b32 v205, 0xffff0000, v4
    v_lshlrev_b32 v206, 16, v5
    v_and_b32 v207, 0xffff0000, v5
    v_lshlrev_b32 v208, 16, v6
    v_and_b32 v209, 0xffff0000, v6
    v_lshlrev_b32 v210, 16, v7
    v_and_b32 v211, 0xffff0000, v7
    v_mov_b64 v[212:213], v[204:205]
    v_mov_b64 v[214:215], v[206:207]
    v_mov_b64 v[216:217], v[208:209]
    v_mov_b64 v[218:219], v[210:211]
    v_mov_b64 v[220:221], v[204:205]
    v_mov_b64 v[222:223], v[206:207]
    v_mov_b64 v[224:225], v[208:209]
    v_mov_b64 v[226:227], v[210:211]
    v_mov_b64 v[228:229], v[204:205]
    v_mov_b64 v[230:231], v[206:207]
    v_mov_b64 v[232:233], v[208:209]
    v_mov_b64 v[234:235], v[210:211]
    v_mov_b64 v[236:237], v[204:205]
    v_mov_b64 v[238:239], v[206:207]
    v_mov_b64 v[240:241], v[208:209]
    v_mov_b64 v[242:243], v[210:211]
    v_mov_b64 v[244:245], v[204:205]
    v_mov_b64 v[246:247], v[206:207]
    v_mov_b64 v[248:249], v[208:209]
    v_mov_b64 v[250:251], v[210:211]
    s_barrier
    v_add_u32 v24, 0, v20
    v_add_u32 v25, 0, v21
    ds_read_b64_tr_b16 v[188:189], v24 offset:0
    ds_read_b64_tr_b16 v[190:191], v24 offset:4096
    ds_read_b64_tr_b16 v[192:193], v25 offset:0
    ds_read_b64_tr_b16 v[194:195], v25 offset:4096
    ds_read_b64_tr_b16 v[196:197], v24 offset:8192
    ds_read_b64_tr_b16 v[198:199], v24 offset:12288
    ds_read_b64_tr_b16 v[200:201], v25 offset:8192
    ds_read_b64_tr_b16 v[202:203], v25 offset:12288
    ds_read_b64_tr_b16 v[52:53], v24 offset:16384
    ds_read_b64_tr_b16 v[54:55], v24 offset:20480
    ds_read_b64_tr_b16 v[56:57], v25 offset:16384
    ds_read_b64_tr_b16 v[58:59], v25 offset:20480
    ds_read_b64_tr_b16 v[60:61], v24 offset:24576
    ds_read_b64_tr_b16 v[62:63], v24 offset:28672
    ds_read_b64_tr_b16 v[64:65], v25 offset:24576
    ds_read_b64_tr_b16 v[66:67], v25 offset:28672
    s_waitcnt lgkmcnt(0)
    s_barrier
    s_branch L_stub_3
L_back_c2:
    v_add_u32 v24, 49152, v20
    v_add_u32 v25, 49152, v21
    s_barrier
    ds_read_b64_tr_b16 v[76:77], v20 offset:32768
    ds_read_b128 v[28:31], v18 offset:0
    ds_read_b64_tr_b16 v[78:79], v20 offset:36864
    ds_read_b128 v[32:35], v18 offset:256
    ds_read_b64_tr_b16 v[80:81], v21 offset:32768
    ds_read_b128 v[36:39], v18 offset:512
    ds_read_b64_tr_b16 v[82:83], v21 offset:36864
    ds_read_b128 v[40:43], v18 offset:768
    ds_read_b128 v[44:47], v18 offset:1024
    ds_read_b128 v[48:51], v18 offset:1280
    s_waitcnt lgkmcnt(7)
    v_mfma_f32_16x16x32_bf16 v[204:207], v[76:79], v[28:31], v[204:207]
    ds_read_b64_tr_b16 v[84:85], v20 offset:40960
    s_waitcnt lgkmcnt(4)
    v_mfma_f32_16x16x32_bf16 v[208:211], v[80:83], v[28:31], v[208:211]
    ds_read_b128 v[28:31], v18 offset:6144
    v_mfma_f32_16x16x32_bf16 v[212:215], v[76:79], v[32:35], v[212:215]
    ds_read_b64_tr_b16 v[86:87], v20 offset:45056
    v_mfma_f32_16x16x32_bf16 v[216:219], v[80:83], v[32:35], v[216:219]
    ds_read_b128 v[32:35], v18 offset:6400
    v_mfma_f32_16x16x32_bf16 v[220:223], v[76:79], v[36:39], v[220:223]
    ds_read_b64_tr_b16 v[88:89], v21 offset:40960
    v_mfma_f32_16x16x32_bf16 v[224:227], v[80:83], v[36:39], v[224:227]
    ds_read_b128 v[36:39], v18 offset:6656
    s_waitcnt lgkmcnt(8)
    v_mfma_f32_16x16x32_bf16 v[228:231], v[76:79], v[40:43], v[228:231]
    ds_read_b64_tr_b16 v[90:91], v21 offset:45056
    v_mfma_f32_16x16x32_bf16 v[232:235], v[80:83], v[40:43], v[232:235]
    ds_read_b128 v[40:43], v18 offset:6912
    s_waitcnt lgkmcnt(9)
    v_mfma_f32_16x16x32_bf16 v[236:239], v[76:79], v[44:47], v[236:239]
    v_mfma_f32_16x16x32_bf16 v[240:243], v[80:83], v[44:47], v[240:243]
    ds_read_b128 v[44:47], v18 offset:7168
    s_waitcnt lgkmcnt(9)
    v_mfma_f32_16x16x32_bf16 v[244:247], v[76:79], v[48:51], v[244:247]
    v_mfma_f32_16x16x32_bf16 v[248:251], v[80:83], v[48:51], v[248:251]
    ds_read_b128 v[48:51], v18 offset:7424
    s_waitcnt lgkmcnt(3)
    v_mfma_f32_16x16x32_bf16 v[204:207], v[84:87], v[28:31], v[204:207]
    s_barrier
    ds_read_b64_tr_b16 v[76:77], v24 offset:0
    v_mfma_f32_16x16x32_bf16 v[208:211], v[88:91], v[28:31], v[208:211]
    ds_read_b128 v[28:31], v18 offset:12288
    v_mfma_f32_16x16x32_bf16 v[212:215], v[84:87], v[32:35], v[212:215]
    ds_read_b64_tr_b16 v[78:79], v24 offset:4096
    v_mfma_f32_16x16x32_bf16 v[216:219], v[88:91], v[32:35], v[216:219]
    ds_read_b128 v[32:35], v18 offset:12544
    v_mfma_f32_16x16x32_bf16 v[220:223], v[84:87], v[36:39], v[220:223]
    ds_read_b64_tr_b16 v[80:81], v25 offset:0
    v_mfma_f32_16x16x32_bf16 v[224:227], v[88:91], v[36:39], v[224:227]
    ds_read_b128 v[36:39], v18 offset:12800
    s_waitcnt lgkmcnt(8)
    v_mfma_f32_16x16x32_bf16 v[228:231], v[84:87], v[40:43], v[228:231]
    ds_read_b64_tr_b16 v[82:83], v25 offset:4096
    v_mfma_f32_16x16x32_bf16 v[232:235], v[88:91], v[40:43], v[232:235]
    ds_read_b128 v[40:43], v18 offset:13056
    s_waitcnt lgkmcnt(9)
    v_mfma_f32_16x16x32_bf16 v[236:239], v[84:87], v[44:47], v[236:239]
    v_mfma_f32_16x16x32_bf16 v[240:243], v[88:91], v[44:47], v[240:243]
    ds_read_b128 v[44:47], v18 offset:13312
    s_waitcnt lgkmcnt(9)
    v_mfma_f32_16x16x32_bf16 v[244:247], v[84:87], v[48:51], v[244:247]
    v_mfma_f32_16x16x32_bf16 v[248:251], v[88:91], v[48:51], v[248:251]
    ds_read_b128 v[48:51], v18 offset:13568
    s_waitcnt lgkmcnt(3)
    v_mfma_f32_16x16x32_bf16 v[204:207], v[76:79], v[28:31], v[204:207]
    ds_read_b64_tr_b16 v[84:85], v24 offset:8192
    v_mfma_f32_16x16x32_bf16 v[208:211], v[80:83], v[28:31], v[208:211]
    ds_read_b128 v[28:31], v18 offset:18432
    v_mfma_f32_16x16x32_bf16 v[212:215], v[76:79], v[32:35], v[212:215]
    ds_read_b64_tr_b16 v[86:87], v24 offset:12288
    v_mfma_f32_16x16x32_bf16 v[216:219], v[80:83], v[32:35], v[216:219]
    ds_read_b128 v[32:35], v18 offset:18688
    v_mfma_f32_16x16x32_bf16 v[220:223], v[76:79], v[36:39], v[220:223]
    ds_read_b64_tr_b16 v[88:89], v25 offset:8192
    v_mfma_f32_16x16x32_bf16 v[224:227], v[80:83], v[36:39], v[224:227]
    ds_read_b128 v[36:39], v18 offset:18944
    s_waitcnt lgkmcnt(8)
    v_mfma_f32_16x16x32_bf16 v[228:231], v[76:79], v[40:43], v[228:231]
    ds_read_b64_tr_b16 v[90:91], v25 offset:12288
    v_mfma_f32_16x16x32_bf16 v[232:235], v[80:83], v[40:43], v[232:235]
    ds_read_b128 v[40:43], v18 offset:19200
    s_waitcnt lgkmcnt(9)
    v_mfma_f32_16x16x32_bf16 v[236:239], v[76:79], v[44:47], v[236:239]
    v_mfma_f32_16x16x32_bf16 v[240:243], v[80:83], v[44:47], v[240:243]
    ds_read_b128 v[44:47], v18 offset:19456
    s_waitcnt lgkmcnt(9)
    v_mfma_f32_16x16x32_bf16 v[244:247], v[76:79], v[48:51], v[244:247]
    v_mfma_f32_16x16x32_bf16 v[248:251], v[80:83], v[48:51], v[248:251]
    ds_read_b128 v[48:51], v18 offset:19712
    s_waitcnt lgkmcnt(3)
    v_mfma_f32_16x16x32_bf16 v[204:207], v[84:87], v[28:31], v[204:207]
    s_barrier
    ds_read_b64_tr_b16 v[76:77], v24 offset:16384
    v_mfma_f32_16x16x32_bf16 v[208:211], v[88:91], v[28:31], v[208:211]
    ds_read_b128 v[28:31], v18 offset:24576
    v_mfma_f32_16x16x32_bf16 v[212:215], v[84:87], v[32:35], v[212:215]
    ds_read_b64_tr_b16 v[78:79], v24 offset:20480
    v_mfma_f32_16x16x32_bf16 v[216:219], v[88:91], v[32:35], v[216:219]
    ds_read_b128 v[32:35], v18 offset:24832
    v_mfma_f32_16x16x32_bf16 v[220:223], v[84:87], v[36:39], v[220:223]
    ds_read_b64_tr_b16 v[80:81], v25 offset:16384
    v_mfma_f32_16x16x32_bf16 v[224:227], v[88:91], v[36:39], v[224:227]
    ds_read_b128 v[36:39], v18 offset:25088
    s_waitcnt lgkmcnt(8)
    v_mfma_f32_16x16x32_bf16 v[228:231], v[84:87], v[40:43], v[228:231]
    ds_read_b64_tr_b16 v[82:83], v25 offset:20480
    v_mfma_f32_16x16x32_bf16 v[232:235], v[88:91], v[40:43], v[232:235]
    ds_read_b128 v[40:43], v18 offset:25344
    s_waitcnt lgkmcnt(9)
    v_mfma_f32_16x16x32_bf16 v[236:239], v[84:87], v[44:47], v[236:239]
    v_mfma_f32_16x16x32_bf16 v[240:243], v[88:91], v[44:47], v[240:243]
    ds_read_b128 v[44:47], v18 offset:25600
    s_waitcnt lgkmcnt(9)
    v_mfma_f32_16x16x32_bf16 v[244:247], v[84:87], v[48:51], v[244:247]
    v_mfma_f32_16x16x32_bf16 v[248:251], v[88:91], v[48:51], v[248:251]
    ds_read_b128 v[48:51], v18 offset:25856
    s_waitcnt lgkmcnt(3)
    v_mfma_f32_16x16x32_bf16 v[204:207], v[76:79], v[28:31], v[204:207]
    ds_read_b64_tr_b16 v[84:85], v24 offset:24576
    v_mfma_f32_16x16x32_bf16 v[208:211], v[80:83], v[28:31], v[208:211]
    ds_read_b128 v[28:31], v18 offset:30720
    v_mfma_f32_16x16x32_bf16 v[212:215], v[76:79], v[32:35], v[212:215]
    ds_read_b64_tr_b16 v[86:87], v24 offset:28672
    v_mfma_f32_16x16x32_bf16 v[216:219], v[80:83], v[32:35], v[216:219]
    s_branch L_skip_3
    s_nop 0
L_stub_3:
    s_branch L_stub_4
L_skip_3:
    ds_read_b128 v[32:35], v18 offset:30976
    v_mfma_f32_16x16x32_bf16 v[220:223], v[76:79], v[36:39], v[220:223]
    ds_read_b64_tr_b16 v[88:89], v25 offset:24576
    v_mfma_f32_16x16x32_bf16 v[224:227], v[80:83], v[36:39], v[224:227]
    ds_read_b128 v[36:39], v18 offset:31232
    s_waitcnt lgkmcnt(8)
    v_mfma_f32_16x16x32_bf16 v[228:231], v[76:79], v[40:43], v[228:231]
    ds_read_b64_tr_b16 v[90:91], v25 offset:28672
    v_mfma_f32_16x16x32_bf16 v[232:235], v[80:83], v[40:43], v[232:235]
    ds_read_b128 v[40:43], v18 offset:31488
    s_waitcnt lgkmcnt(9)
    v_mfma_f32_16x16x32_bf16 v[236:239], v[76:79], v[44:47], v[236:239]
    v_mfma_f32_16x16x32_bf16 v[240:243], v[80:83], v[44:47], v[240:243]
    ds_read_b128 v[44:47], v18 offset:31744
    s_waitcnt lgkmcnt(9)
    v_mfma_f32_16x16x32_bf16 v[244:247], v[76:79], v[48:51], v[244:247]
    v_mfma_f32_16x16x32_bf16 v[248:251], v[80:83], v[48:51], v[248:251]
    ds_read_b128 v[48:51], v18 offset:32000
    s_waitcnt lgkmcnt(3)
    v_mfma_f32_16x16x32_bf16 v[204:207], v[84:87], v[28:31], v[204:207]
    s_barrier
    ds_read_b64_tr_b16 v[76:77], v24 offset:32768
    v_mfma_f32_16x16x32_bf16 v[208:211], v[88:91], v[28:31], v[208:211]
    ds_read_b128 v[28:31], v18 offset:36864
    v_mfma_f32_16x16x32_bf16 v[212:215], v[84:87], v[32:35], v[212:215]
    ds_read_b64_tr_b16 v[78:79], v24 offset:36864
    v_mfma_f32_16x16x32_bf16 v[216:219], v[88:91], v[32:35], v[216:219]
    ds_read_b128 v[32:35], v18 offset:37120
    v_mfma_f32_16x16x32_bf16 v[220:223], v[84:87], v[36:39], v[220:223]
    ds_read_b64_tr_b16 v[80:81], v25 offset:32768
    v_mfma_f32_16x16x32_bf16 v[224:227], v[88:91], v[36:39], v[224:227]
    ds_read_b128 v[36:39], v18 offset:37376
    s_waitcnt lgkmcnt(8)
    v_mfma_f32_16x16x32_bf16 v[228:231], v[84:87], v[40:43], v[228:231]
    ds_read_b64_tr_b16 v[82:83], v25 offset:36864
    v_mfma_f32_16x16x32_bf16 v[232:235], v[88:91], v[40:43], v[232:235]
    ds_read_b128 v[40:43], v18 offset:37632
    s_waitcnt lgkmcnt(9)
    v_mfma_f32_16x16x32_bf16 v[236:239], v[84:87], v[44:47], v[236:239]
    v_mfma_f32_16x16x32_bf16 v[240:243], v[88:91], v[44:47], v[240:243]
    ds_read_b128 v[44:47], v18 offset:37888
    s_waitcnt lgkmcnt(9)
    v_mfma_f32_16x16x32_bf16 v[244:247], v[84:87], v[48:51], v[244:247]
    v_mfma_f32_16x16x32_bf16 v[248:251], v[88:91], v[48:51], v[248:251]
    ds_read_b128 v[48:51], v18 offset:38144
    s_waitcnt lgkmcnt(3)
    v_mfma_f32_16x16x32_bf16 v[204:207], v[76:79], v[28:31], v[204:207]
    ds_read_b64_tr_b16 v[84:85], v24 offset:40960
    v_mfma_f32_16x16x32_bf16 v[208:211], v[80:83], v[28:31], v[208:211]
    ds_read_b128 v[28:31], v18 offset:43008
    v_mfma_f32_16x16x32_bf16 v[212:215], v[76:79], v[32:35], v[212:215]
    ds_read_b64_tr_b16 v[86:87], v24 offset:45056
    v_mfma_f32_16x16x32_bf16 v[216:219], v[80:83], v[32:35], v[216:219]
    ds_read_b128 v[32:35], v18 offset:43264
    v_mfma_f32_16x16x32_bf16 v[220:223], v[76:79], v[36:39], v[220:223]
    ds_read_b64_tr_b16 v[88:89], v25 offset:40960
    v_mfma_f32_16x16x32_bf16 v[224:227], v[80:83], v[36:39], v[224:227]
    ds_read_b128 v[36:39], v18 offset:43520
    s_waitcnt lgkmcnt(8)
    v_mfma_f32_16x16x32_bf16 v[228:231], v[76:79], v[40:43], v[228:231]
    ds_read_b64_tr_b16 v[90:91], v25 offset:45056
    v_mfma_f32_16x16x32_bf16 v[232:235], v[80:83], v[40:43], v[232:235]
    ds_read_b128 v[40:43], v18 offset:43776
    s_waitcnt lgkmcnt(9)
    v_mfma_f32_16x16x32_bf16 v[236:239], v[76:79], v[44:47], v[236:239]
    v_mfma_f32_16x16x32_bf16 v[240:243], v[80:83], v[44:47], v[240:243]
    ds_read_b128 v[44:47], v18 offset:44032
    s_waitcnt lgkmcnt(9)
    v_mfma_f32_16x16x32_bf16 v[244:247], v[76:79], v[48:51], v[244:247]
    v_mfma_f32_16x16x32_bf16 v[248:251], v[80:83], v[48:51], v[248:251]
    ds_read_b128 v[48:51], v18 offset:44288
    s_waitcnt lgkmcnt(3)
    v_mfma_f32_16x16x32_bf16 v[204:207], v[84:87], v[28:31], v[204:207]
    s_barrier
    ds_read_b64_tr_b16 v[76:77], v20 offset:0
    v_mfma_f32_16x16x32_bf16 v[208:211], v[88:91], v[28:31], v[208:211]
    ds_read_b128 v[28:31], v18 offset:49152
    v_mfma_f32_16x16x32_bf16 v[212:215], v[84:87], v[32:35], v[212:215]
    ds_read_b64_tr_b16 v[78:79], v20 offset:4096
    v_mfma_f32_16x16x32_bf16 v[216:219], v[88:91], v[32:35], v[216:219]
    ds_read_b128 v[32:35], v18 offset:49408
    v_mfma_f32_16x16x32_bf16 v[220:223], v[84:87], v[36:39], v[220:223]
    ds_read_b64_tr_b16 v[80:81], v21 offset:0
    v_mfma_f32_16x16x32_bf16 v[224:227], v[88:91], v[36:39], v[224:227]
    ds_read_b128 v[36:39], v18 offset:49664
    s_waitcnt lgkmcnt(8)
    v_mfma_f32_16x16x32_bf16 v[228:231], v[84:87], v[40:43], v[228:231]
    ds_read_b64_tr_b16 v[82:83], v21 offset:4096
    v_mfma_f32_16x16x32_bf16 v[232:235], v[88:91], v[40:43], v[232:235]
    ds_read_b128 v[40:43], v18 offset:49920
    s_waitcnt lgkmcnt(9)
    v_mfma_f32_16x16x32_bf16 v[236:239], v[84:87], v[44:47], v[236:239]
    v_mfma_f32_16x16x32_bf16 v[240:243], v[88:91], v[44:47], v[240:243]
    ds_read_b128 v[44:47], v18 offset:50176
    s_waitcnt lgkmcnt(9)
    v_mfma_f32_16x16x32_bf16 v[244:247], v[84:87], v[48:51], v[244:247]
    v_mfma_f32_16x16x32_bf16 v[248:251], v[88:91], v[48:51], v[248:251]
    ds_read_b128 v[48:51], v18 offset:50432
    s_waitcnt lgkmcnt(3)
    v_mfma_f32_16x16x32_bf16 v[204:207], v[76:79], v[28:31], v[204:207]
    ds_read_b64_tr_b16 v[84:85], v20 offset:8192
    v_mfma_f32_16x16x32_bf16 v[208:211], v[80:83], v[28:31], v[208:211]
    ds_read_b128 v[28:31], v18 offset:55296
    v_mfma_f32_16x16x32_bf16 v[212:215], v[76:79], v[32:35], v[212:215]
    ds_read_b64_tr_b16 v[86:87], v20 offset:12288
    v_mfma_f32_16x16x32_bf16 v[216:219], v[80:83], v[32:35], v[216:219]
    ds_read_b128 v[32:35], v18 offset:55552
    v_mfma_f32_16x16x32_bf16 v[220:223], v[76:79], v[36:39], v[220:223]
    ds_read_b64_tr_b16 v[88:89], v21 offset:8192
    v_mfma_f32_16x16x32_bf16 v[224:227], v[80:83], v[36:39], v[224:227]
    ds_read_b128 v[36:39], v18 offset:55808
    s_waitcnt lgkmcnt(8)
    v_mfma_f32_16x16x32_bf16 v[228:231], v[76:79], v[40:43], v[228:231]
    ds_read_b64_tr_b16 v[90:91], v21 offset:12288
    v_mfma_f32_16x16x32_bf16 v[232:235], v[80:83], v[40:43], v[232:235]
    ds_read_b128 v[40:43], v18 offset:56064
    s_waitcnt lgkmcnt(9)
    v_mfma_f32_16x16x32_bf16 v[236:239], v[76:79], v[44:47], v[236:239]
    v_mfma_f32_16x16x32_bf16 v[240:243], v[80:83], v[44:47], v[240:243]
    ds_read_b128 v[44:47], v18 offset:56320
    s_waitcnt lgkmcnt(9)
    v_mfma_f32_16x16x32_bf16 v[244:247], v[76:79], v[48:51], v[244:247]
    v_mfma_f32_16x16x32_bf16 v[248:251], v[80:83], v[48:51], v[248:251]
    ds_read_b128 v[48:51], v18 offset:56576
    s_waitcnt lgkmcnt(3)
    v_mfma_f32_16x16x32_bf16 v[204:207], v[84:87], v[28:31], v[204:207]
    s_barrier
    ds_read_b64_tr_b16 v[76:77], v20 offset:16384
    v_mfma_f32_16x16x32_bf16 v[208:211], v[88:91], v[28:31], v[208:211]
    ds_read_b128 v[28:31], v18 offset:0
    v_mfma_f32_16x16x32_bf16 v[212:215], v[84:87], v[32:35], v[212:215]
    ds_read_b64_tr_b16 v[78:79], v20 offset:20480
    v_mfma_f32_16x16x32_bf16 v[216:219], v[88:91], v[32:35], v[216:219]
    ds_read_b128 v[32:35], v18 offset:256
    v_mfma_f32_16x16x32_bf16 v[220:223], v[84:87], v[36:39], v[220:223]
    ds_read_b64_tr_b16 v[80:81], v21 offset:16384
    v_mfma_f32_16x16x32_bf16 v[224:227], v[88:91], v[36:39], v[224:227]
    ds_read_b128 v[36:39], v18 offset:512
    s_waitcnt lgkmcnt(8)
    v_mfma_f32_16x16x32_bf16 v[228:231], v[84:87], v[40:43], v[228:231]
    ds_read_b64_tr_b16 v[82:83], v21 offset:20480
    v_mfma_f32_16x16x32_bf16 v[232:235], v[88:91], v[40:43], v[232:235]
    ds_read_b128 v[40:43], v18 offset:768
    s_waitcnt lgkmcnt(9)
    v_mfma_f32_16x16x32_bf16 v[236:239], v[84:87], v[44:47], v[236:239]
    v_mfma_f32_16x16x32_bf16 v[240:243], v[88:91], v[44:47], v[240:243]
    ds_read_b128 v[44:47], v18 offset:1024
    s_waitcnt lgkmcnt(9)
    v_mfma_f32_16x16x32_bf16 v[244:247], v[84:87], v[48:51], v[244:247]
    v_mfma_f32_16x16x32_bf16 v[248:251], v[88:91], v[48:51], v[248:251]
    ds_read_b128 v[48:51], v18 offset:1280
    s_waitcnt lgkmcnt(3)
    v_mfma_f32_16x16x32_bf16 v[204:207], v[76:79], v[28:31], v[204:207]
    ds_read_b64_tr_b16 v[84:85], v20 offset:24576
    v_mfma_f32_16x16x32_bf16 v[208:211], v[80:83], v[28:31], v[208:211]
    ds_read_b128 v[28:31], v18 offset:6144
    v_mfma_f32_16x16x32_bf16 v[212:215], v[76:79], v[32:35], v[212:215]
    ds_read_b64_tr_b16 v[86:87], v20 offset:28672
    v_mfma_f32_16x16x32_bf16 v[216:219], v[80:83], v[32:35], v[216:219]
    ds_read_b128 v[32:35], v18 offset:6400
    v_mfma_f32_16x16x32_bf16 v[220:223], v[76:79], v[36:39], v[220:223]
    ds_read_b64_tr_b16 v[88:89], v21 offset:24576
    v_mfma_f32_16x16x32_bf16 v[224:227], v[80:83], v[36:39], v[224:227]
    ds_read_b128 v[36:39], v18 offset:6656
    s_waitcnt lgkmcnt(8)
    v_mfma_f32_16x16x32_bf16 v[228:231], v[76:79], v[40:43], v[228:231]
    ds_read_b64_tr_b16 v[90:91], v21 offset:28672
    v_mfma_f32_16x16x32_bf16 v[232:235], v[80:83], v[40:43], v[232:235]
    ds_read_b128 v[40:43], v18 offset:6912
    s_waitcnt lgkmcnt(9)
    v_mfma_f32_16x16x32_bf16 v[236:239], v[76:79], v[44:47], v[236:239]
    v_mfma_f32_16x16x32_bf16 v[240:243], v[80:83], v[44:47], v[240:243]
    ds_read_b128 v[44:47], v18 offset:7168
    s_waitcnt lgkmcnt(9)
    v_mfma_f32_16x16x32_bf16 v[244:247], v[76:79], v[48:51], v[244:247]
    v_mfma_f32_16x16x32_bf16 v[248:251], v[80:83], v[48:51], v[248:251]
    ds_read_b128 v[48:51], v18 offset:7424
    s_waitcnt lgkmcnt(3)
    v_mfma_f32_16x16x32_bf16 v[204:207], v[84:87], v[28:31], v[204:207]
    s_barrier
    v_mfma_f32_16x16x32_bf16 v[208:211], v[88:91], v[28:31], v[208:211]
    ds_read_b128 v[28:31], v18 offset:12288
    v_mfma_f32_16x16x32_bf16 v[212:215], v[84:87], v[32:35], v[212:215]
    v_mfma_f32_16x16x32_bf16 v[216:219], v[88:91], v[32:35], v[216:219]
    ds_read_b128 v[32:35], v18 offset:12544
    v_mfma_f32_16x16x32_bf16 v[220:223], v[84:87], v[36:39], v[220:223]
    v_mfma_f32_16x16x32_bf16 v[224:227], v[88:91], v[36:39], v[224:227]
    ds_read_b128 v[36:39], v18 offset:12800
    s_waitcnt lgkmcnt(5)
    v_mfma_f32_16x16x32_bf16 v[228:231], v[84:87], v[40:43], v[228:231]
    v_mfma_f32_16x16x32_bf16 v[232:235], v[88:91], v[40:43], v[232:235]
    ds_read_b128 v[40:43], v18 offset:13056
    s_waitcnt lgkmcnt(5)
    v_mfma_f32_16x16x32_bf16 v[236:239], v[84:87], v[44:47], v[236:239]
    v_mfma_f32_16x16x32_bf16 v[240:243], v[88:91], v[44:47], v[240:243]
    ds_read_b128 v[44:47], v18 offset:13312
    s_waitcnt lgkmcnt(5)
    v_mfma_f32_16x16x32_bf16 v[244:247], v[84:87], v[48:51], v[244:247]
    v_mfma_f32_16x16x32_bf16 v[248:251], v[88:91], v[48:51], v[248:251]
    ds_read_b128 v[48:51], v18 offset:13568
    s_waitcnt lgkmcnt(3)
    v_mfma_f32_16x16x32_bf16 v[204:207], v[92:95], v[28:31], v[204:207]
    v_mfma_f32_16x16x32_bf16 v[208:211], v[96:99], v[28:31], v[208:211]
    ds_read_b128 v[28:31], v18 offset:18432
    v_mfma_f32_16x16x32_bf16 v[212:215], v[92:95], v[32:35], v[212:215]
    v_mfma_f32_16x16x32_bf16 v[216:219], v[96:99], v[32:35], v[216:219]
    ds_read_b128 v[32:35], v18 offset:18688
    v_mfma_f32_16x16x32_bf16 v[220:223], v[92:95], v[36:39], v[220:223]
    v_mfma_f32_16x16x32_bf16 v[224:227], v[96:99], v[36:39], v[224:227]
    ds_read_b128 v[36:39], v18 offset:18944
    s_waitcnt lgkmcnt(5)
    v_mfma_f32_16x16x32_bf16 v[228:231], v[92:95], v[40:43], v[228:231]
    v_mfma_f32_16x16x32_bf16 v[232:235], v[96:99], v[40:43], v[232:235]
    ds_read_b128 v[40:43], v18 offset:19200
    s_waitcnt lgkmcnt(5)
    v_mfma_f32_16x16x32_bf16 v[236:239], v[92:95], v[44:47], v[236:239]
    v_mfma_f32_16x16x32_bf16 v[240:243], v[96:99], v[44:47], v[240:243]
    ds_read_b128 v[44:47], v18 offset:19456
    s_waitcnt lgkmcnt(5)
    v_mfma_f32_16x16x32_bf16 v[244:247], v[92:95], v[48:51], v[244:247]
    v_mfma_f32_16x16x32_bf16 v[248:251], v[96:99], v[48:51], v[248:251]
    ds_read_b128 v[48:51], v18 offset:19712
    s_waitcnt lgkmcnt(3)
    v_mfma_f32_16x16x32_bf16 v[204:207], v[100:103], v[28:31], v[204:207]
    s_barrier
    ds_read_b64_tr_b16 v[76:77], v20 offset:32768
    v_mfma_f32_16x16x32_bf16 v[208:211], v[104:107], v[28:31], v[208:211]
    ds_read_b128 v[28:31], v18 offset:24576
    v_mfma_f32_16x16x32_bf16 v[212:215], v[100:103], v[32:35], v[212:215]
    ds_read_b64_tr_b16 v[78:79], v20 offset:36864
    v_mfma_f32_16x16x32_bf16 v[216:219], v[104:107], v[32:35], v[216:219]
    ds_read_b128 v[32:35], v18 offset:24832
    v_mfma_f32_16x16x32_bf16 v[220:223], v[100:103], v[36:39], v[220:223]
    ds_read_b64_tr_b16 v[80:81], v21 offset:32768
    v_mfma_f32_16x16x32_bf16 v[224:227], v[104:107], v[36:39], v[224:227]
    ds_read_b128 v[36:39], v18 offset:25088
    s_waitcnt lgkmcnt(8)
    v_mfma_f32_16x16x32_bf16 v[228:231], v[100:103], v[40:43], v[228:231]
    ds_read_b64_tr_b16 v[82:83], v21 offset:36864
    v_mfma_f32_16x16x32_bf16 v[232:235], v[104:107], v[40:43], v[232:235]
    ds_read_b128 v[40:43], v18 offset:25344
    s_waitcnt lgkmcnt(9)
    v_mfma_f32_16x16x32_bf16 v[236:239], v[100:103], v[44:47], v[236:239]
    v_mfma_f32_16x16x32_bf16 v[240:243], v[104:107], v[44:47], v[240:243]
    ds_read_b128 v[44:47], v18 offset:25600
    s_waitcnt lgkmcnt(9)
    v_mfma_f32_16x16x32_bf16 v[244:247], v[100:103], v[48:51], v[244:247]
    v_mfma_f32_16x16x32_bf16 v[248:251], v[104:107], v[48:51], v[248:251]
    ds_read_b128 v[48:51], v18 offset:25856
    s_waitcnt lgkmcnt(3)
    v_mfma_f32_16x16x32_bf16 v[204:207], v[76:79], v[28:31], v[204:207]
    ds_read_b64_tr_b16 v[84:85], v20 offset:40960
    v_mfma_f32_16x16x32_bf16 v[208:211], v[80:83], v[28:31], v[208:211]
    ds_read_b128 v[28:31], v18 offset:30720
    v_mfma_f32_16x16x32_bf16 v[212:215], v[76:79], v[32:35], v[212:215]
    ds_read_b64_tr_b16 v[86:87], v20 offset:45056
    v_mfma_f32_16x16x32_bf16 v[216:219], v[80:83], v[32:35], v[216:219]
    ds_read_b128 v[32:35], v18 offset:30976
    v_mfma_f32_16x16x32_bf16 v[220:223], v[76:79], v[36:39], v[220:223]
    ds_read_b64_tr_b16 v[88:89], v21 offset:40960
    v_mfma_f32_16x16x32_bf16 v[224:227], v[80:83], v[36:39], v[224:227]
    ds_read_b128 v[36:39], v18 offset:31232
    s_waitcnt lgkmcnt(8)
    v_mfma_f32_16x16x32_bf16 v[228:231], v[76:79], v[40:43], v[228:231]
    ds_read_b64_tr_b16 v[90:91], v21 offset:45056
    v_mfma_f32_16x16x32_bf16 v[232:235], v[80:83], v[40:43], v[232:235]
    ds_read_b128 v[40:43], v18 offset:31488
    s_waitcnt lgkmcnt(9)
    v_mfma_f32_16x16x32_bf16 v[236:239], v[76:79], v[44:47], v[236:239]
    v_mfma_f32_16x16x32_bf16 v[240:243], v[80:83], v[44:47], v[240:243]
    ds_read_b128 v[44:47], v18 offset:31744
    s_waitcnt lgkmcnt(9)
    v_mfma_f32_16x16x32_bf16 v[244:247], v[76:79], v[48:51], v[244:247]
    v_mfma_f32_16x16x32_bf16 v[248:251], v[80:83], v[48:51], v[248:251]
    ds_read_b128 v[48:51], v18 offset:32000
    s_waitcnt lgkmcnt(3)
    v_mfma_f32_16x16x32_bf16 v[204:207], v[84:87], v[28:31], v[204:207]
    s_barrier
    ds_read_b64_tr_b16 v[76:77], v24 offset:0
    v_mfma_f32_16x16x32_bf16 v[208:211], v[88:91], v[28:31], v[208:211]
    ds_read_b128 v[28:31], v18 offset:36864
    v_mfma_f32_16x16x32_bf16 v[212:215], v[84:87], v[32:35], v[212:215]
    ds_read_b64_tr_b16 v[78:79], v24 offset:4096
    v_mfma_f32_16x16x32_bf16 v[216:219], v[88:91], v[32:35], v[216:219]
    ds_read_b128 v[32:35], v18 offset:37120
    v_mfma_f32_16x16x32_bf16 v[220:223], v[84:87], v[36:39], v[220:223]
    ds_read_b64_tr_b16 v[80:81], v25 offset:0
    v_mfma_f32_16x16x32_bf16 v[224:227], v[88:91], v[36:39], v[224:227]
    ds_read_b128 v[36:39], v18 offset:37376
    s_waitcnt lgkmcnt(8)
    v_mfma_f32_16x16x32_bf16 v[228:231], v[84:87], v[40:43], v[228:231]
    ds_read_b64_tr_b16 v[82:83], v25 offset:4096
    v_mfma_f32_16x16x32_bf16 v[232:235], v[88:91], v[40:43], v[232:235]
    ds_read_b128 v[40:43], v18 offset:37632
    s_waitcnt lgkmcnt(9)
    v_mfma_f32_16x16x32_bf16 v[236:239], v[84:87], v[44:47], v[236:239]
    v_mfma_f32_16x16x32_bf16 v[240:243], v[88:91], v[44:47], v[240:243]
    ds_read_b128 v[44:47], v18 offset:37888
    s_waitcnt lgkmcnt(9)
    v_mfma_f32_16x16x32_bf16 v[244:247], v[84:87], v[48:51], v[244:247]
    v_mfma_f32_16x16x32_bf16 v[248:251], v[88:91], v[48:51], v[248:251]
    ds_read_b128 v[48:51], v18 offset:38144
    s_waitcnt lgkmcnt(3)
    v_mfma_f32_16x16x32_bf16 v[204:207], v[76:79], v[28:31], v[204:207]
    ds_read_b64_tr_b16 v[84:85], v24 offset:8192
    v_mfma_f32_16x16x32_bf16 v[208:211], v[80:83], v[28:31], v[208:211]
    ds_read_b128 v[28:31], v18 offset:43008
    v_mfma_f32_16x16x32_bf16 v[212:215], v[76:79], v[32:35], v[212:215]
    ds_read_b64_tr_b16 v[86:87], v24 offset:12288
    v_mfma_f32_16x16x32_bf16 v[216:219], v[80:83], v[32:35], v[216:219]
    ds_read_b128 v[32:35], v18 offset:43264
    v_mfma_f32_16x16x32_bf16 v[220:223], v[76:79], v[36:39], v[220:223]
    ds_read_b64_tr_b16 v[88:89], v25 offset:8192
    v_mfma_f32_16x16x32_bf16 v[224:227], v[80:83], v[36:39], v[224:227]
    ds_read_b128 v[36:39], v18 offset:43520
    s_waitcnt lgkmcnt(8)
    v_mfma_f32_16x16x32_bf16 v[228:231], v[76:79], v[40:43], v[228:231]
    ds_read_b64_tr_b16 v[90:91], v25 offset:12288
    v_mfma_f32_16x16x32_bf16 v[232:235], v[80:83], v[40:43], v[232:235]
    ds_read_b128 v[40:43], v18 offset:43776
    s_waitcnt lgkmcnt(9)
    v_mfma_f32_16x16x32_bf16 v[236:239], v[76:79], v[44:47], v[236:239]
    v_mfma_f32_16x16x32_bf16 v[240:243], v[80:83], v[44:47], v[240:243]
    ds_read_b128 v[44:47], v18 offset:44032
    s_waitcnt lgkmcnt(9)
    v_mfma_f32_16x16x32_bf16 v[244:247], v[76:79], v[48:51], v[244:247]
    v_mfma_f32_16x16x32_bf16 v[248:251], v[80:83], v[48:51], v[248:251]
    ds_read_b128 v[48:51], v18 offset:44288
    s_waitcnt lgkmcnt(3)
    v_mfma_f32_16x16x32_bf16 v[204:207], v[84:87], v[28:31], v[204:207]
    s_barrier
    v_mfma_f32_16x16x32_bf16 v[208:211], v[88:91], v[28:31], v[208:211]
    ds_read_b128 v[28:31], v18 offset:49152
    v_mfma_f32_16x16x32_bf16 v[212:215], v[84:87], v[32:35], v[212:215]
    v_mfma_f32_16x16x32_bf16 v[216:219], v[88:91], v[32:35], v[216:219]
    ds_read_b128 v[32:35], v18 offset:49408
    v_mfma_f32_16x16x32_bf16 v[220:223], v[84:87], v[36:39], v[220:223]
    v_mfma_f32_16x16x32_bf16 v[224:227], v[88:91], v[36:39], v[224:227]
    ds_read_b128 v[36:39], v18 offset:49664
    s_waitcnt lgkmcnt(5)
    v_mfma_f32_16x16x32_bf16 v[228:231], v[84:87], v[40:43], v[228:231]
    v_mfma_f32_16x16x32_bf16 v[232:235], v[88:91], v[40:43], v[232:235]
    ds_read_b128 v[40:43], v18 offset:49920
    s_waitcnt lgkmcnt(5)
    v_mfma_f32_16x16x32_bf16 v[236:239], v[84:87], v[44:47], v[236:239]
    v_mfma_f32_16x16x32_bf16 v[240:243], v[88:91], v[44:47], v[240:243]
    ds_read_b128 v[44:47], v18 offset:50176
    s_waitcnt lgkmcnt(5)
    v_mfma_f32_16x16x32_bf16 v[244:247], v[84:87], v[48:51], v[244:247]
    v_mfma_f32_16x16x32_bf16 v[248:251], v[88:91], v[48:51], v[248:251]
    ds_read_b128 v[48:51], v18 offset:50432
    s_waitcnt lgkmcnt(3)
    v_mfma_f32_16x16x32_bf16 v[204:207], v[108:111], v[28:31], v[204:207]
    v_mfma_f32_16x16x32_bf16 v[208:211], v[112:115], v[28:31], v[208:211]
    ds_read_b128 v[28:31], v18 offset:55296
    v_mfma_f32_16x16x32_bf16 v[212:215], v[108:111], v[32:35], v[212:215]
    v_mfma_f32_16x16x32_bf16 v[216:219], v[112:115], v[32:35], v[216:219]
    ds_read_b128 v[32:35], v18 offset:55552
    v_mfma_f32_16x16x32_bf16 v[220:223], v[108:111], v[36:39], v[220:223]
    v_mfma_f32_16x16x32_bf16 v[224:227], v[112:115], v[36:39], v[224:227]
    ds_read_b128 v[36:39], v18 offset:55808
    s_waitcnt lgkmcnt(5)
    v_mfma_f32_16x16x32_bf16 v[228:231], v[108:111], v[40:43], v[228:231]
    v_mfma_f32_16x16x32_bf16 v[232:235], v[112:115], v[40:43], v[232:235]
    ds_read_b128 v[40:43], v18 offset:56064
    s_waitcnt lgkmcnt(5)
    v_mfma_f32_16x16x32_bf16 v[236:239], v[108:111], v[44:47], v[236:239]
    v_mfma_f32_16x16x32_bf16 v[240:243], v[112:115], v[44:47], v[240:243]
    ds_read_b128 v[44:47], v18 offset:56320
    s_waitcnt lgkmcnt(5)
    v_mfma_f32_16x16x32_bf16 v[244:247], v[108:111], v[48:51], v[244:247]
    v_mfma_f32_16x16x32_bf16 v[248:251], v[112:115], v[48:51], v[248:251]
    ds_read_b128 v[48:51], v18 offset:56576
    s_waitcnt lgkmcnt(3)
    v_mfma_f32_16x16x32_bf16 v[204:207], v[116:119], v[28:31], v[204:207]
    s_barrier
    ds_read_b64_tr_b16 v[76:77], v24 offset:16384
    v_mfma_f32_16x16x32_bf16 v[208:211], v[120:123], v[28:31], v[208:211]
    ds_read_b128 v[28:31], v18 offset:0
    v_mfma_f32_16x16x32_bf16 v[212:215], v[116:119], v[32:35], v[212:215]
    ds_read_b64_tr_b16 v[78:79], v24 offset:20480
    v_mfma_f32_16x16x32_bf16 v[216:219], v[120:123], v[32:35], v[216:219]
    ds_read_b128 v[32:35], v18 offset:256
    v_mfma_f32_16x16x32_bf16 v[220:223], v[116:119], v[36:39], v[220:223]
    ds_read_b64_tr_b16 v[80:81], v25 offset:16384
    v_mfma_f32_16x16x32_bf16 v[224:227], v[120:123], v[36:39], v[224:227]
    ds_read_b128 v[36:39], v18 offset:512
    s_waitcnt lgkmcnt(8)
    v_mfma_f32_16x16x32_bf16 v[228:231], v[116:119], v[40:43], v[228:231]
    ds_read_b64_tr_b16 v[82:83], v25 offset:20480
    v_mfma_f32_16x16x32_bf16 v[232:235], v[120:123], v[40:43], v[232:235]
    ds_read_b128 v[40:43], v18 offset:768
    s_waitcnt lgkmcnt(9)
    v_mfma_f32_16x16x32_bf16 v[236:239], v[116:119], v[44:47], v[236:239]
    v_mfma_f32_16x16x32_bf16 v[240:243], v[120:123], v[44:47], v[240:243]
    ds_read_b128 v[44:47], v18 offset:1024
    s_waitcnt lgkmcnt(9)
    v_mfma_f32_16x16x32_bf16 v[244:247], v[116:119], v[48:51], v[244:247]
    v_mfma_f32_16x16x32_bf16 v[248:251], v[120:123], v[48:51], v[248:251]
    ds_read_b128 v[48:51], v18 offset:1280
    s_waitcnt lgkmcnt(3)
    v_mfma_f32_16x16x32_bf16 v[204:207], v[76:79], v[28:31], v[204:207]
    ds_read_b64_tr_b16 v[84:85], v24 offset:24576
    v_mfma_f32_16x16x32_bf16 v[208:211], v[80:83], v[28:31], v[208:211]
    ds_read_b128 v[28:31], v18 offset:6144
    v_mfma_f32_16x16x32_bf16 v[212:215], v[76:79], v[32:35], v[212:215]
    ds_read_b64_tr_b16 v[86:87], v24 offset:28672
    v_mfma_f32_16x16x32_bf16 v[216:219], v[80:83], v[32:35], v[216:219]
    ds_read_b128 v[32:35], v18 offset:6400
    v_mfma_f32_16x16x32_bf16 v[220:223], v[76:79], v[36:39], v[220:223]
    ds_read_b64_tr_b16 v[88:89], v25 offset:24576
    v_mfma_f32_16x16x32_bf16 v[224:227], v[80:83], v[36:39], v[224:227]
    ds_read_b128 v[36:39], v18 offset:6656
    s_waitcnt lgkmcnt(8)
    v_mfma_f32_16x16x32_bf16 v[228:231], v[76:79], v[40:43], v[228:231]
    ds_read_b64_tr_b16 v[90:91], v25 offset:28672
    v_mfma_f32_16x16x32_bf16 v[232:235], v[80:83], v[40:43], v[232:235]
    ds_read_b128 v[40:43], v18 offset:6912
    s_waitcnt lgkmcnt(9)
    v_mfma_f32_16x16x32_bf16 v[236:239], v[76:79], v[44:47], v[236:239]
    v_mfma_f32_16x16x32_bf16 v[240:243], v[80:83], v[44:47], v[240:243]
    ds_read_b128 v[44:47], v18 offset:7168
    s_waitcnt lgkmcnt(9)
    v_mfma_f32_16x16x32_bf16 v[244:247], v[76:79], v[48:51], v[244:247]
    v_mfma_f32_16x16x32_bf16 v[248:251], v[80:83], v[48:51], v[248:251]
    ds_read_b128 v[48:51], v18 offset:7424
    s_waitcnt lgkmcnt(3)
    v_mfma_f32_16x16x32_bf16 v[204:207], v[84:87], v[28:31], v[204:207]
    s_barrier
    ds_read_b64_tr_b16 v[76:77], v24 offset:32768
    v_mfma_f32_16x16x32_bf16 v[208:211], v[88:91], v[28:31], v[208:211]
    ds_read_b128 v[28:31], v18 offset:12288
    v_mfma_f32_16x16x32_bf16 v[212:215], v[84:87], v[32:35], v[212:215]
    ds_read_b64_tr_b16 v[78:79], v24 offset:36864
    v_mfma_f32_16x16x32_bf16 v[216:219], v[88:91], v[32:35], v[216:219]
    ds_read_b128 v[32:35], v18 offset:12544
    v_mfma_f32_16x16x32_bf16 v[220:223], v[84:87], v[36:39], v[220:223]
    ds_read_b64_tr_b16 v[80:81], v25 offset:32768
    v_mfma_f32_16x16x32_bf16 v[224:227], v[88:91], v[36:39], v[224:227]
    ds_read_b128 v[36:39], v18 offset:12800
    s_waitcnt lgkmcnt(8)
    v_mfma_f32_16x16x32_bf16 v[228:231], v[84:87], v[40:43], v[228:231]
    ds_read_b64_tr_b16 v[82:83], v25 offset:36864
    v_mfma_f32_16x16x32_bf16 v[232:235], v[88:91], v[40:43], v[232:235]
    ds_read_b128 v[40:43], v18 offset:13056
    s_waitcnt lgkmcnt(9)
    v_mfma_f32_16x16x32_bf16 v[236:239], v[84:87], v[44:47], v[236:239]
    v_mfma_f32_16x16x32_bf16 v[240:243], v[88:91], v[44:47], v[240:243]
    ds_read_b128 v[44:47], v18 offset:13312
    s_waitcnt lgkmcnt(9)
    v_mfma_f32_16x16x32_bf16 v[244:247], v[84:87], v[48:51], v[244:247]
    v_mfma_f32_16x16x32_bf16 v[248:251], v[88:91], v[48:51], v[248:251]
    ds_read_b128 v[48:51], v18 offset:13568
    s_waitcnt lgkmcnt(3)
    v_mfma_f32_16x16x32_bf16 v[204:207], v[76:79], v[28:31], v[204:207]
    ds_read_b64_tr_b16 v[84:85], v24 offset:40960
    v_mfma_f32_16x16x32_bf16 v[208:211], v[80:83], v[28:31], v[208:211]
    ds_read_b128 v[28:31], v18 offset:18432
    v_mfma_f32_16x16x32_bf16 v[212:215], v[76:79], v[32:35], v[212:215]
    ds_read_b64_tr_b16 v[86:87], v24 offset:45056
    v_mfma_f32_16x16x32_bf16 v[216:219], v[80:83], v[32:35], v[216:219]
    ds_read_b128 v[32:35], v18 offset:18688
    v_mfma_f32_16x16x32_bf16 v[220:223], v[76:79], v[36:39], v[220:223]
    ds_read_b64_tr_b16 v[88:89], v25 offset:40960
    v_mfma_f32_16x16x32_bf16 v[224:227], v[80:83], v[36:39], v[224:227]
    ds_read_b128 v[36:39], v18 offset:18944
    s_waitcnt lgkmcnt(8)
    v_mfma_f32_16x16x32_bf16 v[228:231], v[76:79], v[40:43], v[228:231]
    ds_read_b64_tr_b16 v[90:91], v25 offset:45056
    v_mfma_f32_16x16x32_bf16 v[232:235], v[80:83], v[40:43], v[232:235]
    ds_read_b128 v[40:43], v18 offset:19200
    s_waitcnt lgkmcnt(9)
    v_mfma_f32_16x16x32_bf16 v[236:239], v[76:79], v[44:47], v[236:239]
    v_mfma_f32_16x16x32_bf16 v[240:243], v[80:83], v[44:47], v[240:243]
    ds_read_b128 v[44:47], v18 offset:19456
    s_waitcnt lgkmcnt(9)
    v_mfma_f32_16x16x32_bf16 v[244:247], v[76:79], v[48:51], v[244:247]
    v_mfma_f32_16x16x32_bf16 v[248:251], v[80:83], v[48:51], v[248:251]
    ds_read_b128 v[48:51], v18 offset:19712
    s_waitcnt lgkmcnt(3)
    v_mfma_f32_16x16x32_bf16 v[204:207], v[84:87], v[28:31], v[204:207]
    s_barrier
    v_mfma_f32_16x16x32_bf16 v[208:211], v[88:91], v[28:31], v[208:211]
    ds_read_b128 v[28:31], v18 offset:24576
    v_mfma_f32_16x16x32_bf16 v[212:215], v[84:87], v[32:35], v[212:215]
    v_mfma_f32_16x16x32_bf16 v[216:219], v[88:91], v[32:35], v[216:219]
    ds_read_b128 v[32:35], v18 offset:24832
    v_mfma_f32_16x16x32_bf16 v[220:223], v[84:87], v[36:39], v[220:223]
    v_mfma_f32_16x16x32_bf16 v[224:227], v[88:91], v[36:39], v[224:227]
    ds_read_b128 v[36:39], v18 offset:25088
    s_waitcnt lgkmcnt(5)
    v_mfma_f32_16x16x32_bf16 v[228:231], v[84:87], v[40:43], v[228:231]
    v_mfma_f32_16x16x32_bf16 v[232:235], v[88:91], v[40:43], v[232:235]
    ds_read_b128 v[40:43], v18 offset:25344
    s_waitcnt lgkmcnt(5)
    v_mfma_f32_16x16x32_bf16 v[236:239], v[84:87], v[44:47], v[236:239]
    v_mfma_f32_16x16x32_bf16 v[240:243], v[88:91], v[44:47], v[240:243]
    ds_read_b128 v[44:47], v18 offset:25600
    s_waitcnt lgkmcnt(5)
    v_mfma_f32_16x16x32_bf16 v[244:247], v[84:87], v[48:51], v[244:247]
    v_mfma_f32_16x16x32_bf16 v[248:251], v[88:91], v[48:51], v[248:251]
    ds_read_b128 v[48:51], v18 offset:25856
    s_waitcnt lgkmcnt(3)
    v_mfma_f32_16x16x32_bf16 v[204:207], v[124:127], v[28:31], v[204:207]
    v_mfma_f32_16x16x32_bf16 v[208:211], v[128:131], v[28:31], v[208:211]
    ds_read_b128 v[28:31], v18 offset:30720
    v_mfma_f32_16x16x32_bf16 v[212:215], v[124:127], v[32:35], v[212:215]
    v_mfma_f32_16x16x32_bf16 v[216:219], v[128:131], v[32:35], v[216:219]
    ds_read_b128 v[32:35], v18 offset:30976
    v_mfma_f32_16x16x32_bf16 v[220:223], v[124:127], v[36:39], v[220:223]
    v_mfma_f32_16x16x32_bf16 v[224:227], v[128:131], v[36:39], v[224:227]
    ds_read_b128 v[36:39], v18 offset:31232
    s_waitcnt lgkmcnt(5)
    v_mfma_f32_16x16x32_bf16 v[228:231], v[124:127], v[40:43], v[228:231]
    v_mfma_f32_16x16x32_bf16 v[232:235], v[128:131], v[40:43], v[232:235]
    ds_read_b128 v[40:43], v18 offset:31488
    s_waitcnt lgkmcnt(5)
    v_mfma_f32_16x16x32_bf16 v[236:239], v[124:127], v[44:47], v[236:239]
    v_mfma_f32_16x16x32_bf16 v[240:243], v[128:131], v[44:47], v[240:243]
    ds_read_b128 v[44:47], v18 offset:31744
    s_waitcnt lgkmcnt(5)
    v_mfma_f32_16x16x32_bf16 v[244:247], v[124:127], v[48:51], v[244:247]
    v_mfma_f32_16x16x32_bf16 v[248:251], v[128:131], v[48:51], v[248:251]
    ds_read_b128 v[48:51], v18 offset:32000
    s_waitcnt lgkmcnt(3)
    v_mfma_f32_16x16x32_bf16 v[204:207], v[132:135], v[28:31], v[204:207]
    s_barrier
    ds_read_b64_tr_b16 v[76:77], v20 offset:0
    v_mfma_f32_16x16x32_bf16 v[208:211], v[136:139], v[28:31], v[208:211]
    ds_read_b128 v[28:31], v18 offset:36864
    v_mfma_f32_16x16x32_bf16 v[212:215], v[132:135], v[32:35], v[212:215]
    ds_read_b64_tr_b16 v[78:79], v20 offset:4096
    v_mfma_f32_16x16x32_bf16 v[216:219], v[136:139], v[32:35], v[216:219]
    ds_read_b128 v[32:35], v18 offset:37120
    v_mfma_f32_16x16x32_bf16 v[220:223], v[132:135], v[36:39], v[220:223]
    ds_read_b64_tr_b16 v[80:81], v21 offset:0
    v_mfma_f32_16x16x32_bf16 v[224:227], v[136:139], v[36:39], v[224:227]
    ds_read_b128 v[36:39], v18 offset:37376
    s_waitcnt lgkmcnt(8)
    v_mfma_f32_16x16x32_bf16 v[228:231], v[132:135], v[40:43], v[228:231]
    ds_read_b64_tr_b16 v[82:83], v21 offset:4096
    v_mfma_f32_16x16x32_bf16 v[232:235], v[136:139], v[40:43], v[232:235]
    ds_read_b128 v[40:43], v18 offset:37632
    s_waitcnt lgkmcnt(9)
    v_mfma_f32_16x16x32_bf16 v[236:239], v[132:135], v[44:47], v[236:239]
    v_mfma_f32_16x16x32_bf16 v[240:243], v[136:139], v[44:47], v[240:243]
    ds_read_b128 v[44:47], v18 offset:37888
    s_waitcnt lgkmcnt(9)
    v_mfma_f32_16x16x32_bf16 v[244:247], v[132:135], v[48:51], v[244:247]
    v_mfma_f32_16x16x32_bf16 v[248:251], v[136:139], v[48:51], v[248:251]
    ds_read_b128 v[48:51], v18 offset:38144
    s_waitcnt lgkmcnt(3)
    v_mfma_f32_16x16x32_bf16 v[204:207], v[76:79], v[28:31], v[204:207]
    ds_read_b64_tr_b16 v[84:85], v20 offset:8192
    v_mfma_f32_16x16x32_bf16 v[208:211], v[80:83], v[28:31], v[208:211]
    ds_read_b128 v[28:31], v18 offset:43008
    v_mfma_f32_16x16x32_bf16 v[212:215], v[76:79], v[32:35], v[212:215]
    ds_read_b64_tr_b16 v[86:87], v20 offset:12288
    v_mfma_f32_16x16x32_bf16 v[216:219], v[80:83], v[32:35], v[216:219]
    ds_read_b128 v[32:35], v18 offset:43264
    s_branch L_skip_4
    s_nop 0
L_stub_4:
    s_branch L_stub_5
L_skip_4:
    v_mfma_f32_16x16x32_bf16 v[220:223], v[76:79], v[36:39], v[220:223]
    ds_read_b64_tr_b16 v[88:89], v21 offset:8192
    v_mfma_f32_16x16x32_bf16 v[224:227], v[80:83], v[36:39], v[224:227]
    ds_read_b128 v[36:39], v18 offset:43520
    s_waitcnt lgkmcnt(8)
    v_mfma_f32_16x16x32_bf16 v[228:231], v[76:79], v[40:43], v[228:231]
    ds_read_b64_tr_b16 v[90:91], v21 offset:12288
    v_mfma_f32_16x16x32_bf16 v[232:235], v[80:83], v[40:43], v[232:235]
    ds_read_b128 v[40:43], v18 offset:43776
    s_waitcnt lgkmcnt(9)
    v_mfma_f32_16x16x32_bf16 v[236:239], v[76:79], v[44:47], v[236:239]
    v_mfma_f32_16x16x32_bf16 v[240:243], v[80:83], v[44:47], v[240:243]
    ds_read_b128 v[44:47], v18 offset:44032
    s_waitcnt lgkmcnt(9)
    v_mfma_f32_16x16x32_bf16 v[244:247], v[76:79], v[48:51], v[244:247]
    v_mfma_f32_16x16x32_bf16 v[248:251], v[80:83], v[48:51], v[248:251]
    ds_read_b128 v[48:51], v18 offset:44288
    s_waitcnt lgkmcnt(3)
    v_mfma_f32_16x16x32_bf16 v[204:207], v[84:87], v[28:31], v[204:207]
    s_barrier
    ds_read_b64_tr_b16 v[76:77], v20 offset:16384
    v_mfma_f32_16x16x32_bf16 v[208:211], v[88:91], v[28:31], v[208:211]
    ds_read_b128 v[28:31], v18 offset:49152
    v_mfma_f32_16x16x32_bf16 v[212:215], v[84:87], v[32:35], v[212:215]
    ds_read_b64_tr_b16 v[78:79], v20 offset:20480
    v_mfma_f32_16x16x32_bf16 v[216:219], v[88:91], v[32:35], v[216:219]
    ds_read_b128 v[32:35], v18 offset:49408
    v_mfma_f32_16x16x32_bf16 v[220:223], v[84:87], v[36:39], v[220:223]
    ds_read_b64_tr_b16 v[80:81], v21 offset:16384
    v_mfma_f32_16x16x32_bf16 v[224:227], v[88:91], v[36:39], v[224:227]
    ds_read_b128 v[36:39], v18 offset:49664
    s_waitcnt lgkmcnt(8)
    v_mfma_f32_16x16x32_bf16 v[228:231], v[84:87], v[40:43], v[228:231]
    ds_read_b64_tr_b16 v[82:83], v21 offset:20480
    v_mfma_f32_16x16x32_bf16 v[232:235], v[88:91], v[40:43], v[232:235]
    ds_read_b128 v[40:43], v18 offset:49920
    s_waitcnt lgkmcnt(9)
    v_mfma_f32_16x16x32_bf16 v[236:239], v[84:87], v[44:47], v[236:239]
    v_mfma_f32_16x16x32_bf16 v[240:243], v[88:91], v[44:47], v[240:243]
    ds_read_b128 v[44:47], v18 offset:50176
    s_waitcnt lgkmcnt(9)
    v_mfma_f32_16x16x32_bf16 v[244:247], v[84:87], v[48:51], v[244:247]
    v_mfma_f32_16x16x32_bf16 v[248:251], v[88:91], v[48:51], v[248:251]
    ds_read_b128 v[48:51], v18 offset:50432
    s_waitcnt lgkmcnt(3)
    v_mfma_f32_16x16x32_bf16 v[204:207], v[76:79], v[28:31], v[204:207]
    ds_read_b64_tr_b16 v[84:85], v20 offset:24576
    v_mfma_f32_16x16x32_bf16 v[208:211], v[80:83], v[28:31], v[208:211]
    ds_read_b128 v[28:31], v18 offset:55296
    v_mfma_f32_16x16x32_bf16 v[212:215], v[76:79], v[32:35], v[212:215]
    ds_read_b64_tr_b16 v[86:87], v20 offset:28672
    v_mfma_f32_16x16x32_bf16 v[216:219], v[80:83], v[32:35], v[216:219]
    ds_read_b128 v[32:35], v18 offset:55552
    v_mfma_f32_16x16x32_bf16 v[220:223], v[76:79], v[36:39], v[220:223]
    ds_read_b64_tr_b16 v[88:89], v21 offset:24576
    v_mfma_f32_16x16x32_bf16 v[224:227], v[80:83], v[36:39], v[224:227]
    ds_read_b128 v[36:39], v18 offset:55808
    s_waitcnt lgkmcnt(8)
    v_mfma_f32_16x16x32_bf16 v[228:231], v[76:79], v[40:43], v[228:231]
    ds_read_b64_tr_b16 v[90:91], v21 offset:28672
    v_mfma_f32_16x16x32_bf16 v[232:235], v[80:83], v[40:43], v[232:235]
    ds_read_b128 v[40:43], v18 offset:56064
    s_waitcnt lgkmcnt(9)
    v_mfma_f32_16x16x32_bf16 v[236:239], v[76:79], v[44:47], v[236:239]
    v_mfma_f32_16x16x32_bf16 v[240:243], v[80:83], v[44:47], v[240:243]
    ds_read_b128 v[44:47], v18 offset:56320
    s_waitcnt lgkmcnt(9)
    v_mfma_f32_16x16x32_bf16 v[244:247], v[76:79], v[48:51], v[244:247]
    v_mfma_f32_16x16x32_bf16 v[248:251], v[80:83], v[48:51], v[248:251]
    ds_read_b128 v[48:51], v18 offset:56576
    s_waitcnt lgkmcnt(3)
    v_mfma_f32_16x16x32_bf16 v[204:207], v[84:87], v[28:31], v[204:207]
    s_barrier
    v_mfma_f32_16x16x32_bf16 v[208:211], v[88:91], v[28:31], v[208:211]
    ds_read_b128 v[28:31], v18 offset:0
    v_mfma_f32_16x16x32_bf16 v[212:215], v[84:87], v[32:35], v[212:215]
    v_mfma_f32_16x16x32_bf16 v[216:219], v[88:91], v[32:35], v[216:219]
    ds_read_b128 v[32:35], v18 offset:256
    v_mfma_f32_16x16x32_bf16 v[220:223], v[84:87], v[36:39], v[220:223]
    v_mfma_f32_16x16x32_bf16 v[224:227], v[88:91], v[36:39], v[224:227]
    ds_read_b128 v[36:39], v18 offset:512
    s_waitcnt lgkmcnt(5)
    v_mfma_f32_16x16x32_bf16 v[228:231], v[84:87], v[40:43], v[228:231]
    v_mfma_f32_16x16x32_bf16 v[232:235], v[88:91], v[40:43], v[232:235]
    ds_read_b128 v[40:43], v18 offset:768
    s_waitcnt lgkmcnt(5)
    v_mfma_f32_16x16x32_bf16 v[236:239], v[84:87], v[44:47], v[236:239]
    v_mfma_f32_16x16x32_bf16 v[240:243], v[88:91], v[44:47], v[240:243]
    ds_read_b128 v[44:47], v18 offset:1024
    s_waitcnt lgkmcnt(5)
    v_mfma_f32_16x16x32_bf16 v[244:247], v[84:87], v[48:51], v[244:247]
    v_mfma_f32_16x16x32_bf16 v[248:251], v[88:91], v[48:51], v[248:251]
    ds_read_b128 v[48:51], v18 offset:1280
    s_waitcnt lgkmcnt(3)
    v_mfma_f32_16x16x32_bf16 v[204:207], v[140:143], v[28:31], v[204:207]
    v_mfma_f32_16x16x32_bf16 v[208:211], v[144:147], v[28:31], v[208:211]
    ds_read_b128 v[28:31], v18 offset:6144
    v_mfma_f32_16x16x32_bf16 v[212:215], v[140:143], v[32:35], v[212:215]
    v_mfma_f32_16x16x32_bf16 v[216:219], v[144:147], v[32:35], v[216:219]
    ds_read_b128 v[32:35], v18 offset:6400
    v_mfma_f32_16x16x32_bf16 v[220:223], v[140:143], v[36:39], v[220:223]
    v_mfma_f32_16x16x32_bf16 v[224:227], v[144:147], v[36:39], v[224:227]
    ds_read_b128 v[36:39], v18 offset:6656
    s_waitcnt lgkmcnt(5)
    v_mfma_f32_16x16x32_bf16 v[228:231], v[140:143], v[40:43], v[228:231]
    v_mfma_f32_16x16x32_bf16 v[232:235], v[144:147], v[40:43], v[232:235]
    ds_read_b128 v[40:43], v18 offset:6912
    s_waitcnt lgkmcnt(5)
    v_mfma_f32_16x16x32_bf16 v[236:239], v[140:143], v[44:47], v[236:239]
    v_mfma_f32_16x16x32_bf16 v[240:243], v[144:147], v[44:47], v[240:243]
    ds_read_b128 v[44:47], v18 offset:7168
    s_waitcnt lgkmcnt(5)
    v_mfma_f32_16x16x32_bf16 v[244:247], v[140:143], v[48:51], v[244:247]
    v_mfma_f32_16x16x32_bf16 v[248:251], v[144:147], v[48:51], v[248:251]
    ds_read_b128 v[48:51], v18 offset:7424
    s_waitcnt lgkmcnt(3)
    v_mfma_f32_16x16x32_bf16 v[204:207], v[148:151], v[28:31], v[204:207]
    s_barrier
    ds_read_b64_tr_b16 v[76:77], v20 offset:32768
    v_mfma_f32_16x16x32_bf16 v[208:211], v[152:155], v[28:31], v[208:211]
    ds_read_b128 v[28:31], v18 offset:12288
    v_mfma_f32_16x16x32_bf16 v[212:215], v[148:151], v[32:35], v[212:215]
    ds_read_b64_tr_b16 v[78:79], v20 offset:36864
    v_mfma_f32_16x16x32_bf16 v[216:219], v[152:155], v[32:35], v[216:219]
    ds_read_b128 v[32:35], v18 offset:12544
    v_mfma_f32_16x16x32_bf16 v[220:223], v[148:151], v[36:39], v[220:223]
    ds_read_b64_tr_b16 v[80:81], v21 offset:32768
    v_mfma_f32_16x16x32_bf16 v[224:227], v[152:155], v[36:39], v[224:227]
    ds_read_b128 v[36:39], v18 offset:12800
    s_waitcnt lgkmcnt(8)
    v_mfma_f32_16x16x32_bf16 v[228:231], v[148:151], v[40:43], v[228:231]
    ds_read_b64_tr_b16 v[82:83], v21 offset:36864
    v_mfma_f32_16x16x32_bf16 v[232:235], v[152:155], v[40:43], v[232:235]
    ds_read_b128 v[40:43], v18 offset:13056
    s_waitcnt lgkmcnt(9)
    v_mfma_f32_16x16x32_bf16 v[236:239], v[148:151], v[44:47], v[236:239]
    v_mfma_f32_16x16x32_bf16 v[240:243], v[152:155], v[44:47], v[240:243]
    ds_read_b128 v[44:47], v18 offset:13312
    s_waitcnt lgkmcnt(9)
    v_mfma_f32_16x16x32_bf16 v[244:247], v[148:151], v[48:51], v[244:247]
    v_mfma_f32_16x16x32_bf16 v[248:251], v[152:155], v[48:51], v[248:251]
    ds_read_b128 v[48:51], v18 offset:13568
    s_waitcnt lgkmcnt(3)
    v_mfma_f32_16x16x32_bf16 v[204:207], v[76:79], v[28:31], v[204:207]
    ds_read_b64_tr_b16 v[84:85], v20 offset:40960
    v_mfma_f32_16x16x32_bf16 v[208:211], v[80:83], v[28:31], v[208:211]
    ds_read_b128 v[28:31], v18 offset:18432
    v_mfma_f32_16x16x32_bf16 v[212:215], v[76:79], v[32:35], v[212:215]
    ds_read_b64_tr_b16 v[86:87], v20 offset:45056
    v_mfma_f32_16x16x32_bf16 v[216:219], v[80:83], v[32:35], v[216:219]
    ds_read_b128 v[32:35], v18 offset:18688
    v_mfma_f32_16x16x32_bf16 v[220:223], v[76:79], v[36:39], v[220:223]
    ds_read_b64_tr_b16 v[88:89], v21 offset:40960
    v_mfma_f32_16x16x32_bf16 v[224:227], v[80:83], v[36:39], v[224:227]
    ds_read_b128 v[36:39], v18 offset:18944
    s_waitcnt lgkmcnt(8)
    v_mfma_f32_16x16x32_bf16 v[228:231], v[76:79], v[40:43], v[228:231]
    ds_read_b64_tr_b16 v[90:91], v21 offset:45056
    v_mfma_f32_16x16x32_bf16 v[232:235], v[80:83], v[40:43], v[232:235]
    ds_read_b128 v[40:43], v18 offset:19200
    s_waitcnt lgkmcnt(9)
    v_mfma_f32_16x16x32_bf16 v[236:239], v[76:79], v[44:47], v[236:239]
    v_mfma_f32_16x16x32_bf16 v[240:243], v[80:83], v[44:47], v[240:243]
    ds_read_b128 v[44:47], v18 offset:19456
    s_waitcnt lgkmcnt(9)
    v_mfma_f32_16x16x32_bf16 v[244:247], v[76:79], v[48:51], v[244:247]
    v_mfma_f32_16x16x32_bf16 v[248:251], v[80:83], v[48:51], v[248:251]
    ds_read_b128 v[48:51], v18 offset:19712
    s_waitcnt lgkmcnt(3)
    v_mfma_f32_16x16x32_bf16 v[204:207], v[84:87], v[28:31], v[204:207]
    s_barrier
    ds_read_b64_tr_b16 v[76:77], v24 offset:0
    v_mfma_f32_16x16x32_bf16 v[208:211], v[88:91], v[28:31], v[208:211]
    ds_read_b128 v[28:31], v18 offset:24576
    v_mfma_f32_16x16x32_bf16 v[212:215], v[84:87], v[32:35], v[212:215]
    ds_read_b64_tr_b16 v[78:79], v24 offset:4096
    v_mfma_f32_16x16x32_bf16 v[216:219], v[88:91], v[32:35], v[216:219]
    ds_read_b128 v[32:35], v18 offset:24832
    v_mfma_f32_16x16x32_bf16 v[220:223], v[84:87], v[36:39], v[220:223]
    ds_read_b64_tr_b16 v[80:81], v25 offset:0
    v_mfma_f32_16x16x32_bf16 v[224:227], v[88:91], v[36:39], v[224:227]
    ds_read_b128 v[36:39], v18 offset:25088
    s_waitcnt lgkmcnt(8)
    v_mfma_f32_16x16x32_bf16 v[228:231], v[84:87], v[40:43], v[228:231]
    ds_read_b64_tr_b16 v[82:83], v25 offset:4096
    v_mfma_f32_16x16x32_bf16 v[232:235], v[88:91], v[40:43], v[232:235]
    ds_read_b128 v[40:43], v18 offset:25344
    s_waitcnt lgkmcnt(9)
    v_mfma_f32_16x16x32_bf16 v[236:239], v[84:87], v[44:47], v[236:239]
    v_mfma_f32_16x16x32_bf16 v[240:243], v[88:91], v[44:47], v[240:243]
    ds_read_b128 v[44:47], v18 offset:25600
    s_waitcnt lgkmcnt(9)
    v_mfma_f32_16x16x32_bf16 v[244:247], v[84:87], v[48:51], v[244:247]
    v_mfma_f32_16x16x32_bf16 v[248:251], v[88:91], v[48:51], v[248:251]
    ds_read_b128 v[48:51], v18 offset:25856
    s_waitcnt lgkmcnt(3)
    v_mfma_f32_16x16x32_bf16 v[204:207], v[76:79], v[28:31], v[204:207]
    ds_read_b64_tr_b16 v[84:85], v24 offset:8192
    v_mfma_f32_16x16x32_bf16 v[208:211], v[80:83], v[28:31], v[208:211]
    ds_read_b128 v[28:31], v18 offset:30720
    v_mfma_f32_16x16x32_bf16 v[212:215], v[76:79], v[32:35], v[212:215]
    ds_read_b64_tr_b16 v[86:87], v24 offset:12288
    v_mfma_f32_16x16x32_bf16 v[216:219], v[80:83], v[32:35], v[216:219]
    ds_read_b128 v[32:35], v18 offset:30976
    v_mfma_f32_16x16x32_bf16 v[220:223], v[76:79], v[36:39], v[220:223]
    ds_read_b64_tr_b16 v[88:89], v25 offset:8192
    v_mfma_f32_16x16x32_bf16 v[224:227], v[80:83], v[36:39], v[224:227]
    ds_read_b128 v[36:39], v18 offset:31232
    s_waitcnt lgkmcnt(8)
    v_mfma_f32_16x16x32_bf16 v[228:231], v[76:79], v[40:43], v[228:231]
    ds_read_b64_tr_b16 v[90:91], v25 offset:12288
    v_mfma_f32_16x16x32_bf16 v[232:235], v[80:83], v[40:43], v[232:235]
    ds_read_b128 v[40:43], v18 offset:31488
    s_waitcnt lgkmcnt(9)
    v_mfma_f32_16x16x32_bf16 v[236:239], v[76:79], v[44:47], v[236:239]
    v_mfma_f32_16x16x32_bf16 v[240:243], v[80:83], v[44:47], v[240:243]
    ds_read_b128 v[44:47], v18 offset:31744
    s_waitcnt lgkmcnt(9)
    v_mfma_f32_16x16x32_bf16 v[244:247], v[76:79], v[48:51], v[244:247]
    v_mfma_f32_16x16x32_bf16 v[248:251], v[80:83], v[48:51], v[248:251]
    ds_read_b128 v[48:51], v18 offset:32000
    s_waitcnt lgkmcnt(3)
    v_mfma_f32_16x16x32_bf16 v[204:207], v[84:87], v[28:31], v[204:207]
    s_barrier
    v_mfma_f32_16x16x32_bf16 v[208:211], v[88:91], v[28:31], v[208:211]
    ds_read_b128 v[28:31], v18 offset:36864
    v_mfma_f32_16x16x32_bf16 v[212:215], v[84:87], v[32:35], v[212:215]
    v_mfma_f32_16x16x32_bf16 v[216:219], v[88:91], v[32:35], v[216:219]
    ds_read_b128 v[32:35], v18 offset:37120
    v_mfma_f32_16x16x32_bf16 v[220:223], v[84:87], v[36:39], v[220:223]
    v_mfma_f32_16x16x32_bf16 v[224:227], v[88:91], v[36:39], v[224:227]
    ds_read_b128 v[36:39], v18 offset:37376
    s_waitcnt lgkmcnt(5)
    v_mfma_f32_16x16x32_bf16 v[228:231], v[84:87], v[40:43], v[228:231]
    v_mfma_f32_16x16x32_bf16 v[232:235], v[88:91], v[40:43], v[232:235]
    ds_read_b128 v[40:43], v18 offset:37632
    s_waitcnt lgkmcnt(5)
    v_mfma_f32_16x16x32_bf16 v[236:239], v[84:87], v[44:47], v[236:239]
    v_mfma_f32_16x16x32_bf16 v[240:243], v[88:91], v[44:47], v[240:243]
    ds_read_b128 v[44:47], v18 offset:37888
    s_waitcnt lgkmcnt(5)
    v_mfma_f32_16x16x32_bf16 v[244:247], v[84:87], v[48:51], v[244:247]
    v_mfma_f32_16x16x32_bf16 v[248:251], v[88:91], v[48:51], v[248:251]
    ds_read_b128 v[48:51], v18 offset:38144
    s_waitcnt lgkmcnt(3)
    v_mfma_f32_16x16x32_bf16 v[204:207], v[156:159], v[28:31], v[204:207]
    v_mfma_f32_16x16x32_bf16 v[208:211], v[160:163], v[28:31], v[208:211]
    ds_read_b128 v[28:31], v18 offset:43008
    v_mfma_f32_16x16x32_bf16 v[212:215], v[156:159], v[32:35], v[212:215]
    v_mfma_f32_16x16x32_bf16 v[216:219], v[160:163], v[32:35], v[216:219]
    ds_read_b128 v[32:35], v18 offset:43264
    v_mfma_f32_16x16x32_bf16 v[220:223], v[156:159], v[36:39], v[220:223]
    v_mfma_f32_16x16x32_bf16 v[224:227], v[160:163], v[36:39], v[224:227]
    ds_read_b128 v[36:39], v18 offset:43520
    s_waitcnt lgkmcnt(5)
    v_mfma_f32_16x16x32_bf16 v[228:231], v[156:159], v[40:43], v[228:231]
    v_mfma_f32_16x16x32_bf16 v[232:235], v[160:163], v[40:43], v[232:235]
    ds_read_b128 v[40:43], v18 offset:43776
    s_waitcnt lgkmcnt(5)
    v_mfma_f32_16x16x32_bf16 v[236:239], v[156:159], v[44:47], v[236:239]
    v_mfma_f32_16x16x32_bf16 v[240:243], v[160:163], v[44:47], v[240:243]
    ds_read_b128 v[44:47], v18 offset:44032
    s_waitcnt lgkmcnt(5)
    v_mfma_f32_16x16x32_bf16 v[244:247], v[156:159], v[48:51], v[244:247]
    v_mfma_f32_16x16x32_bf16 v[248:251], v[160:163], v[48:51], v[248:251]
    ds_read_b128 v[48:51], v18 offset:44288
    s_waitcnt lgkmcnt(3)
    v_mfma_f32_16x16x32_bf16 v[204:207], v[164:167], v[28:31], v[204:207]
    s_barrier
    ds_read_b64_tr_b16 v[76:77], v24 offset:16384
    v_mfma_f32_16x16x32_bf16 v[208:211], v[168:171], v[28:31], v[208:211]
    ds_read_b128 v[28:31], v18 offset:49152
    v_mfma_f32_16x16x32_bf16 v[212:215], v[164:167], v[32:35], v[212:215]
    ds_read_b64_tr_b16 v[78:79], v24 offset:20480
    v_mfma_f32_16x16x32_bf16 v[216:219], v[168:171], v[32:35], v[216:219]
    ds_read_b128 v[32:35], v18 offset:49408
    v_mfma_f32_16x16x32_bf16 v[220:223], v[164:167], v[36:39], v[220:223]
    ds_read_b64_tr_b16 v[80:81], v25 offset:16384
    v_mfma_f32_16x16x32_bf16 v[224:227], v[168:171], v[36:39], v[224:227]
    ds_read_b128 v[36:39], v18 offset:49664
    s_waitcnt lgkmcnt(8)
    v_mfma_f32_16x16x32_bf16 v[228:231], v[164:167], v[40:43], v[228:231]
    ds_read_b64_tr_b16 v[82:83], v25 offset:20480
    v_mfma_f32_16x16x32_bf16 v[232:235], v[168:171], v[40:43], v[232:235]
    ds_read_b128 v[40:43], v18 offset:49920
    s_waitcnt lgkmcnt(9)
    v_mfma_f32_16x16x32_bf16 v[236:239], v[164:167], v[44:47], v[236:239]
    v_mfma_f32_16x16x32_bf16 v[240:243], v[168:171], v[44:47], v[240:243]
    ds_read_b128 v[44:47], v18 offset:50176
    s_waitcnt lgkmcnt(9)
    v_mfma_f32_16x16x32_bf16 v[244:247], v[164:167], v[48:51], v[244:247]
    v_mfma_f32_16x16x32_bf16 v[248:251], v[168:171], v[48:51], v[248:251]
    ds_read_b128 v[48:51], v18 offset:50432
    s_waitcnt lgkmcnt(3)
    v_mfma_f32_16x16x32_bf16 v[204:207], v[76:79], v[28:31], v[204:207]
    ds_read_b64_tr_b16 v[84:85], v24 offset:24576
    v_mfma_f32_16x16x32_bf16 v[208:211], v[80:83], v[28:31], v[208:211]
    ds_read_b128 v[28:31], v18 offset:55296
    v_mfma_f32_16x16x32_bf16 v[212:215], v[76:79], v[32:35], v[212:215]
    ds_read_b64_tr_b16 v[86:87], v24 offset:28672
    v_mfma_f32_16x16x32_bf16 v[216:219], v[80:83], v[32:35], v[216:219]
    ds_read_b128 v[32:35], v18 offset:55552
    v_mfma_f32_16x16x32_bf16 v[220:223], v[76:79], v[36:39], v[220:223]
    ds_read_b64_tr_b16 v[88:89], v25 offset:24576
    v_mfma_f32_16x16x32_bf16 v[224:227], v[80:83], v[36:39], v[224:227]
    ds_read_b128 v[36:39], v18 offset:55808
    s_waitcnt lgkmcnt(8)
    v_mfma_f32_16x16x32_bf16 v[228:231], v[76:79], v[40:43], v[228:231]
    ds_read_b64_tr_b16 v[90:91], v25 offset:28672
    v_mfma_f32_16x16x32_bf16 v[232:235], v[80:83], v[40:43], v[232:235]
    ds_read_b128 v[40:43], v18 offset:56064
    s_waitcnt lgkmcnt(9)
    v_mfma_f32_16x16x32_bf16 v[236:239], v[76:79], v[44:47], v[236:239]
    v_mfma_f32_16x16x32_bf16 v[240:243], v[80:83], v[44:47], v[240:243]
    ds_read_b128 v[44:47], v18 offset:56320
    s_waitcnt lgkmcnt(9)
    v_mfma_f32_16x16x32_bf16 v[244:247], v[76:79], v[48:51], v[244:247]
    v_mfma_f32_16x16x32_bf16 v[248:251], v[80:83], v[48:51], v[248:251]
    ds_read_b128 v[48:51], v18 offset:56576
    s_waitcnt lgkmcnt(3)
    v_mfma_f32_16x16x32_bf16 v[204:207], v[84:87], v[28:31], v[204:207]
    s_barrier
    ds_read_b64_tr_b16 v[76:77], v24 offset:32768
    v_mfma_f32_16x16x32_bf16 v[208:211], v[88:91], v[28:31], v[208:211]
    ds_read_b128 v[28:31], v18 offset:0
    v_mfma_f32_16x16x32_bf16 v[212:215], v[84:87], v[32:35], v[212:215]
    ds_read_b64_tr_b16 v[78:79], v24 offset:36864
    v_mfma_f32_16x16x32_bf16 v[216:219], v[88:91], v[32:35], v[216:219]
    ds_read_b128 v[32:35], v18 offset:256
    v_mfma_f32_16x16x32_bf16 v[220:223], v[84:87], v[36:39], v[220:223]
    ds_read_b64_tr_b16 v[80:81], v25 offset:32768
    v_mfma_f32_16x16x32_bf16 v[224:227], v[88:91], v[36:39], v[224:227]
    ds_read_b128 v[36:39], v18 offset:512
    s_waitcnt lgkmcnt(8)
    v_mfma_f32_16x16x32_bf16 v[228:231], v[84:87], v[40:43], v[228:231]
    ds_read_b64_tr_b16 v[82:83], v25 offset:36864
    v_mfma_f32_16x16x32_bf16 v[232:235], v[88:91], v[40:43], v[232:235]
    ds_read_b128 v[40:43], v18 offset:768
    s_waitcnt lgkmcnt(9)
    v_mfma_f32_16x16x32_bf16 v[236:239], v[84:87], v[44:47], v[236:239]
    v_mfma_f32_16x16x32_bf16 v[240:243], v[88:91], v[44:47], v[240:243]
    ds_read_b128 v[44:47], v18 offset:1024
    s_waitcnt lgkmcnt(9)
    v_mfma_f32_16x16x32_bf16 v[244:247], v[84:87], v[48:51], v[244:247]
    v_mfma_f32_16x16x32_bf16 v[248:251], v[88:91], v[48:51], v[248:251]
    ds_read_b128 v[48:51], v18 offset:1280
    s_waitcnt lgkmcnt(3)
    v_mfma_f32_16x16x32_bf16 v[204:207], v[76:79], v[28:31], v[204:207]
    ds_read_b64_tr_b16 v[84:85], v24 offset:40960
    v_mfma_f32_16x16x32_bf16 v[208:211], v[80:83], v[28:31], v[208:211]
    ds_read_b128 v[28:31], v18 offset:6144
    v_mfma_f32_16x16x32_bf16 v[212:215], v[76:79], v[32:35], v[212:215]
    ds_read_b64_tr_b16 v[86:87], v24 offset:45056
    v_mfma_f32_16x16x32_bf16 v[216:219], v[80:83], v[32:35], v[216:219]
    ds_read_b128 v[32:35], v18 offset:6400
    v_mfma_f32_16x16x32_bf16 v[220:223], v[76:79], v[36:39], v[220:223]
    ds_read_b64_tr_b16 v[88:89], v25 offset:40960
    v_mfma_f32_16x16x32_bf16 v[224:227], v[80:83], v[36:39], v[224:227]
    ds_read_b128 v[36:39], v18 offset:6656
    s_waitcnt lgkmcnt(8)
    v_mfma_f32_16x16x32_bf16 v[228:231], v[76:79], v[40:43], v[228:231]
    ds_read_b64_tr_b16 v[90:91], v25 offset:45056
    v_mfma_f32_16x16x32_bf16 v[232:235], v[80:83], v[40:43], v[232:235]
    ds_read_b128 v[40:43], v18 offset:6912
    s_waitcnt lgkmcnt(9)
    v_mfma_f32_16x16x32_bf16 v[236:239], v[76:79], v[44:47], v[236:239]
    v_mfma_f32_16x16x32_bf16 v[240:243], v[80:83], v[44:47], v[240:243]
    ds_read_b128 v[44:47], v18 offset:7168
    s_waitcnt lgkmcnt(9)
    v_mfma_f32_16x16x32_bf16 v[244:247], v[76:79], v[48:51], v[244:247]
    v_mfma_f32_16x16x32_bf16 v[248:251], v[80:83], v[48:51], v[248:251]
    ds_read_b128 v[48:51], v18 offset:7424
    s_waitcnt lgkmcnt(3)
    v_mfma_f32_16x16x32_bf16 v[204:207], v[84:87], v[28:31], v[204:207]
    s_barrier
    v_mfma_f32_16x16x32_bf16 v[208:211], v[88:91], v[28:31], v[208:211]
    ds_read_b128 v[28:31], v18 offset:12288
    v_mfma_f32_16x16x32_bf16 v[212:215], v[84:87], v[32:35], v[212:215]
    v_mfma_f32_16x16x32_bf16 v[216:219], v[88:91], v[32:35], v[216:219]
    ds_read_b128 v[32:35], v18 offset:12544
    v_mfma_f32_16x16x32_bf16 v[220:223], v[84:87], v[36:39], v[220:223]
    v_mfma_f32_16x16x32_bf16 v[224:227], v[88:91], v[36:39], v[224:227]
    ds_read_b128 v[36:39], v18 offset:12800
    s_waitcnt lgkmcnt(5)
    v_mfma_f32_16x16x32_bf16 v[228:231], v[84:87], v[40:43], v[228:231]
    v_mfma_f32_16x16x32_bf16 v[232:235], v[88:91], v[40:43], v[232:235]
    ds_read_b128 v[40:43], v18 offset:13056
    s_waitcnt lgkmcnt(5)
    v_mfma_f32_16x16x32_bf16 v[236:239], v[84:87], v[44:47], v[236:239]
    v_mfma_f32_16x16x32_bf16 v[240:243], v[88:91], v[44:47], v[240:243]
    ds_read_b128 v[44:47], v18 offset:13312
    s_waitcnt lgkmcnt(5)
    v_mfma_f32_16x16x32_bf16 v[244:247], v[84:87], v[48:51], v[244:247]
    v_mfma_f32_16x16x32_bf16 v[248:251], v[88:91], v[48:51], v[248:251]
    ds_read_b128 v[48:51], v18 offset:13568
    s_waitcnt lgkmcnt(3)
    v_mfma_f32_16x16x32_bf16 v[204:207], v[172:175], v[28:31], v[204:207]
    v_mfma_f32_16x16x32_bf16 v[208:211], v[176:179], v[28:31], v[208:211]
    ds_read_b128 v[28:31], v18 offset:18432
    v_mfma_f32_16x16x32_bf16 v[212:215], v[172:175], v[32:35], v[212:215]
    v_mfma_f32_16x16x32_bf16 v[216:219], v[176:179], v[32:35], v[216:219]
    ds_read_b128 v[32:35], v18 offset:18688
    v_mfma_f32_16x16x32_bf16 v[220:223], v[172:175], v[36:39], v[220:223]
    v_mfma_f32_16x16x32_bf16 v[224:227], v[176:179], v[36:39], v[224:227]
    ds_read_b128 v[36:39], v18 offset:18944
    s_waitcnt lgkmcnt(5)
    v_mfma_f32_16x16x32_bf16 v[228:231], v[172:175], v[40:43], v[228:231]
    v_mfma_f32_16x16x32_bf16 v[232:235], v[176:179], v[40:43], v[232:235]
    ds_read_b128 v[40:43], v18 offset:19200
    s_waitcnt lgkmcnt(5)
    v_mfma_f32_16x16x32_bf16 v[236:239], v[172:175], v[44:47], v[236:239]
    v_mfma_f32_16x16x32_bf16 v[240:243], v[176:179], v[44:47], v[240:243]
    ds_read_b128 v[44:47], v18 offset:19456
    s_waitcnt lgkmcnt(5)
    v_mfma_f32_16x16x32_bf16 v[244:247], v[172:175], v[48:51], v[244:247]
    v_mfma_f32_16x16x32_bf16 v[248:251], v[176:179], v[48:51], v[248:251]
    ds_read_b128 v[48:51], v18 offset:19712
    s_waitcnt lgkmcnt(3)
    v_mfma_f32_16x16x32_bf16 v[204:207], v[180:183], v[28:31], v[204:207]
    s_barrier
    ds_read_b64_tr_b16 v[76:77], v20 offset:0
    v_mfma_f32_16x16x32_bf16 v[208:211], v[184:187], v[28:31], v[208:211]
    ds_read_b128 v[28:31], v18 offset:24576
    v_mfma_f32_16x16x32_bf16 v[212:215], v[180:183], v[32:35], v[212:215]
    ds_read_b64_tr_b16 v[78:79], v20 offset:4096
    v_mfma_f32_16x16x32_bf16 v[216:219], v[184:187], v[32:35], v[216:219]
    ds_read_b128 v[32:35], v18 offset:24832
    v_mfma_f32_16x16x32_bf16 v[220:223], v[180:183], v[36:39], v[220:223]
    ds_read_b64_tr_b16 v[80:81], v21 offset:0
    v_mfma_f32_16x16x32_bf16 v[224:227], v[184:187], v[36:39], v[224:227]
    ds_read_b128 v[36:39], v18 offset:25088
    s_waitcnt lgkmcnt(8)
    v_mfma_f32_16x16x32_bf16 v[228:231], v[180:183], v[40:43], v[228:231]
    ds_read_b64_tr_b16 v[82:83], v21 offset:4096
    v_mfma_f32_16x16x32_bf16 v[232:235], v[184:187], v[40:43], v[232:235]
    ds_read_b128 v[40:43], v18 offset:25344
    s_waitcnt lgkmcnt(9)
    v_mfma_f32_16x16x32_bf16 v[236:239], v[180:183], v[44:47], v[236:239]
    v_mfma_f32_16x16x32_bf16 v[240:243], v[184:187], v[44:47], v[240:243]
    ds_read_b128 v[44:47], v18 offset:25600
    s_waitcnt lgkmcnt(9)
    v_mfma_f32_16x16x32_bf16 v[244:247], v[180:183], v[48:51], v[244:247]
    v_mfma_f32_16x16x32_bf16 v[248:251], v[184:187], v[48:51], v[248:251]
    ds_read_b128 v[48:51], v18 offset:25856
    s_waitcnt lgkmcnt(3)
    v_mfma_f32_16x16x32_bf16 v[204:207], v[76:79], v[28:31], v[204:207]
    ds_read_b64_tr_b16 v[84:85], v20 offset:8192
    v_mfma_f32_16x16x32_bf16 v[208:211], v[80:83], v[28:31], v[208:211]
    ds_read_b128 v[28:31], v18 offset:30720
    v_mfma_f32_16x16x32_bf16 v[212:215], v[76:79], v[32:35], v[212:215]
    ds_read_b64_tr_b16 v[86:87], v20 offset:12288
    v_mfma_f32_16x16x32_bf16 v[216:219], v[80:83], v[32:35], v[216:219]
    ds_read_b128 v[32:35], v18 offset:30976
    v_mfma_f32_16x16x32_bf16 v[220:223], v[76:79], v[36:39], v[220:223]
    ds_read_b64_tr_b16 v[88:89], v21 offset:8192
    v_mfma_f32_16x16x32_bf16 v[224:227], v[80:83], v[36:39], v[224:227]
    ds_read_b128 v[36:39], v18 offset:31232
    s_waitcnt lgkmcnt(8)
    v_mfma_f32_16x16x32_bf16 v[228:231], v[76:79], v[40:43], v[228:231]
    ds_read_b64_tr_b16 v[90:91], v21 offset:12288
    v_mfma_f32_16x16x32_bf16 v[232:235], v[80:83], v[40:43], v[232:235]
    ds_read_b128 v[40:43], v18 offset:31488
    s_waitcnt lgkmcnt(9)
    v_mfma_f32_16x16x32_bf16 v[236:239], v[76:79], v[44:47], v[236:239]
    v_mfma_f32_16x16x32_bf16 v[240:243], v[80:83], v[44:47], v[240:243]
    ds_read_b128 v[44:47], v18 offset:31744
    s_waitcnt lgkmcnt(9)
    v_mfma_f32_16x16x32_bf16 v[244:247], v[76:79], v[48:51], v[244:247]
    v_mfma_f32_16x16x32_bf16 v[248:251], v[80:83], v[48:51], v[248:251]
    ds_read_b128 v[48:51], v18 offset:32000
    s_waitcnt lgkmcnt(3)
    v_mfma_f32_16x16x32_bf16 v[204:207], v[84:87], v[28:31], v[204:207]
    s_barrier
    ds_read_b64_tr_b16 v[76:77], v20 offset:16384
    v_mfma_f32_16x16x32_bf16 v[208:211], v[88:91], v[28:31], v[208:211]
    ds_read_b128 v[28:31], v18 offset:36864
    v_mfma_f32_16x16x32_bf16 v[212:215], v[84:87], v[32:35], v[212:215]
    ds_read_b64_tr_b16 v[78:79], v20 offset:20480
    v_mfma_f32_16x16x32_bf16 v[216:219], v[88:91], v[32:35], v[216:219]
    ds_read_b128 v[32:35], v18 offset:37120
    v_mfma_f32_16x16x32_bf16 v[220:223], v[84:87], v[36:39], v[220:223]
    ds_read_b64_tr_b16 v[80:81], v21 offset:16384
    v_mfma_f32_16x16x32_bf16 v[224:227], v[88:91], v[36:39], v[224:227]
    ds_read_b128 v[36:39], v18 offset:37376
    s_waitcnt lgkmcnt(8)
    v_mfma_f32_16x16x32_bf16 v[228:231], v[84:87], v[40:43], v[228:231]
    ds_read_b64_tr_b16 v[82:83], v21 offset:20480
    v_mfma_f32_16x16x32_bf16 v[232:235], v[88:91], v[40:43], v[232:235]
    ds_read_b128 v[40:43], v18 offset:37632
    s_waitcnt lgkmcnt(9)
    v_mfma_f32_16x16x32_bf16 v[236:239], v[84:87], v[44:47], v[236:239]
    v_mfma_f32_16x16x32_bf16 v[240:243], v[88:91], v[44:47], v[240:243]
    ds_read_b128 v[44:47], v18 offset:37888
    s_waitcnt lgkmcnt(9)
    v_mfma_f32_16x16x32_bf16 v[244:247], v[84:87], v[48:51], v[244:247]
    v_mfma_f32_16x16x32_bf16 v[248:251], v[88:91], v[48:51], v[248:251]
    ds_read_b128 v[48:51], v18 offset:38144
    s_waitcnt lgkmcnt(3)
    v_mfma_f32_16x16x32_bf16 v[204:207], v[76:79], v[28:31], v[204:207]
    ds_read_b64_tr_b16 v[84:85], v20 offset:24576
    v_mfma_f32_16x16x32_bf16 v[208:211], v[80:83], v[28:31], v[208:211]
    ds_read_b128 v[28:31], v18 offset:43008
    v_mfma_f32_16x16x32_bf16 v[212:215], v[76:79], v[32:35], v[212:215]
    ds_read_b64_tr_b16 v[86:87], v20 offset:28672
    v_mfma_f32_16x16x32_bf16 v[216:219], v[80:83], v[32:35], v[216:219]
    ds_read_b128 v[32:35], v18 offset:43264
    v_mfma_f32_16x16x32_bf16 v[220:223], v[76:79], v[36:39], v[220:223]
    ds_read_b64_tr_b16 v[88:89], v21 offset:24576
    v_mfma_f32_16x16x32_bf16 v[224:227], v[80:83], v[36:39], v[224:227]
    ds_read_b128 v[36:39], v18 offset:43520
    s_waitcnt lgkmcnt(8)
    v_mfma_f32_16x16x32_bf16 v[228:231], v[76:79], v[40:43], v[228:231]
    ds_read_b64_tr_b16 v[90:91], v21 offset:28672
    v_mfma_f32_16x16x32_bf16 v[232:235], v[80:83], v[40:43], v[232:235]
    ds_read_b128 v[40:43], v18 offset:43776
    s_waitcnt lgkmcnt(9)
    v_mfma_f32_16x16x32_bf16 v[236:239], v[76:79], v[44:47], v[236:239]
    v_mfma_f32_16x16x32_bf16 v[240:243], v[80:83], v[44:47], v[240:243]
    ds_read_b128 v[44:47], v18 offset:44032
    s_waitcnt lgkmcnt(9)
    v_mfma_f32_16x16x32_bf16 v[244:247], v[76:79], v[48:51], v[244:247]
    v_mfma_f32_16x16x32_bf16 v[248:251], v[80:83], v[48:51], v[248:251]
    ds_read_b128 v[48:51], v18 offset:44288
    s_waitcnt lgkmcnt(3)
    v_mfma_f32_16x16x32_bf16 v[204:207], v[84:87], v[28:31], v[204:207]
    s_barrier
    v_mfma_f32_16x16x32_bf16 v[208:211], v[88:91], v[28:31], v[208:211]
    ds_read_b128 v[28:31], v18 offset:49152
    v_mfma_f32_16x16x32_bf16 v[212:215], v[84:87], v[32:35], v[212:215]
    v_mfma_f32_16x16x32_bf16 v[216:219], v[88:91], v[32:35], v[216:219]
    ds_read_b128 v[32:35], v18 offset:49408
    v_mfma_f32_16x16x32_bf16 v[220:223], v[84:87], v[36:39], v[220:223]
    v_mfma_f32_16x16x32_bf16 v[224:227], v[88:91], v[36:39], v[224:227]
    ds_read_b128 v[36:39], v18 offset:49664
    s_waitcnt lgkmcnt(5)
    v_mfma_f32_16x16x32_bf16 v[228:231], v[84:87], v[40:43], v[228:231]
    v_mfma_f32_16x16x32_bf16 v[232:235], v[88:91], v[40:43], v[232:235]
    ds_read_b128 v[40:43], v18 offset:49920
    s_waitcnt lgkmcnt(5)
    v_mfma_f32_16x16x32_bf16 v[236:239], v[84:87], v[44:47], v[236:239]
    v_mfma_f32_16x16x32_bf16 v[240:243], v[88:91], v[44:47], v[240:243]
    ds_read_b128 v[44:47], v18 offset:50176
    s_waitcnt lgkmcnt(5)
    v_mfma_f32_16x16x32_bf16 v[244:247], v[84:87], v[48:51], v[244:247]
    v_mfma_f32_16x16x32_bf16 v[248:251], v[88:91], v[48:51], v[248:251]
    ds_read_b128 v[48:51], v18 offset:50432
    s_waitcnt lgkmcnt(3)
    v_mfma_f32_16x16x32_bf16 v[204:207], v[188:191], v[28:31], v[204:207]
    v_mfma_f32_16x16x32_bf16 v[208:211], v[192:195], v[28:31], v[208:211]
    ds_read_b128 v[28:31], v18 offset:55296
    v_mfma_f32_16x16x32_bf16 v[212:215], v[188:191], v[32:35], v[212:215]
    v_mfma_f32_16x16x32_bf16 v[216:219], v[192:195], v[32:35], v[216:219]
    ds_read_b128 v[32:35], v18 offset:55552
    v_mfma_f32_16x16x32_bf16 v[220:223], v[188:191], v[36:39], v[220:223]
    v_mfma_f32_16x16x32_bf16 v[224:227], v[192:195], v[36:39], v[224:227]
    ds_read_b128 v[36:39], v18 offset:55808
    s_waitcnt lgkmcnt(5)
    v_mfma_f32_16x16x32_bf16 v[228:231], v[188:191], v[40:43], v[228:231]
    v_mfma_f32_16x16x32_bf16 v[232:235], v[192:195], v[40:43], v[232:235]
    ds_read_b128 v[40:43], v18 offset:56064
    s_waitcnt lgkmcnt(5)
    s_branch L_skip_5
    s_nop 0
L_stub_5:
    s_branch L_stub_6
L_skip_5:
    v_mfma_f32_16x16x32_bf16 v[236:239], v[188:191], v[44:47], v[236:239]
    v_mfma_f32_16x16x32_bf16 v[240:243], v[192:195], v[44:47], v[240:243]
    ds_read_b128 v[44:47], v18 offset:56320
    s_waitcnt lgkmcnt(5)
    v_mfma_f32_16x16x32_bf16 v[244:247], v[188:191], v[48:51], v[244:247]
    v_mfma_f32_16x16x32_bf16 v[248:251], v[192:195], v[48:51], v[248:251]
    ds_read_b128 v[48:51], v18 offset:56576
    s_waitcnt lgkmcnt(3)
    v_mfma_f32_16x16x32_bf16 v[204:207], v[196:199], v[28:31], v[204:207]
    s_barrier
    ds_read_b64_tr_b16 v[76:77], v20 offset:32768
    v_mfma_f32_16x16x32_bf16 v[208:211], v[200:203], v[28:31], v[208:211]
    ds_read_b128 v[28:31], v18 offset:0
    v_mfma_f32_16x16x32_bf16 v[212:215], v[196:199], v[32:35], v[212:215]
    ds_read_b64_tr_b16 v[78:79], v20 offset:36864
    v_mfma_f32_16x16x32_bf16 v[216:219], v[200:203], v[32:35], v[216:219]
    ds_read_b128 v[32:35], v18 offset:256
    v_mfma_f32_16x16x32_bf16 v[220:223], v[196:199], v[36:39], v[220:223]
    ds_read_b64_tr_b16 v[80:81], v21 offset:32768
    v_mfma_f32_16x16x32_bf16 v[224:227], v[200:203], v[36:39], v[224:227]
    ds_read_b128 v[36:39], v18 offset:512
    s_waitcnt lgkmcnt(8)
    v_mfma_f32_16x16x32_bf16 v[228:231], v[196:199], v[40:43], v[228:231]
    ds_read_b64_tr_b16 v[82:83], v21 offset:36864
    v_mfma_f32_16x16x32_bf16 v[232:235], v[200:203], v[40:43], v[232:235]
    ds_read_b128 v[40:43], v18 offset:768
    s_waitcnt lgkmcnt(9)
    v_mfma_f32_16x16x32_bf16 v[236:239], v[196:199], v[44:47], v[236:239]
    v_mfma_f32_16x16x32_bf16 v[240:243], v[200:203], v[44:47], v[240:243]
    ds_read_b128 v[44:47], v18 offset:1024
    s_waitcnt lgkmcnt(9)
    v_mfma_f32_16x16x32_bf16 v[244:247], v[196:199], v[48:51], v[244:247]
    v_mfma_f32_16x16x32_bf16 v[248:251], v[200:203], v[48:51], v[248:251]
    ds_read_b128 v[48:51], v18 offset:1280
    s_waitcnt lgkmcnt(3)
    v_mfma_f32_16x16x32_bf16 v[204:207], v[76:79], v[28:31], v[204:207]
    ds_read_b64_tr_b16 v[84:85], v20 offset:40960
    v_mfma_f32_16x16x32_bf16 v[208:211], v[80:83], v[28:31], v[208:211]
    ds_read_b128 v[28:31], v18 offset:6144
    v_mfma_f32_16x16x32_bf16 v[212:215], v[76:79], v[32:35], v[212:215]
    ds_read_b64_tr_b16 v[86:87], v20 offset:45056
    v_mfma_f32_16x16x32_bf16 v[216:219], v[80:83], v[32:35], v[216:219]
    ds_read_b128 v[32:35], v18 offset:6400
    v_mfma_f32_16x16x32_bf16 v[220:223], v[76:79], v[36:39], v[220:223]
    ds_read_b64_tr_b16 v[88:89], v21 offset:40960
    v_mfma_f32_16x16x32_bf16 v[224:227], v[80:83], v[36:39], v[224:227]
    ds_read_b128 v[36:39], v18 offset:6656
    s_waitcnt lgkmcnt(8)
    v_mfma_f32_16x16x32_bf16 v[228:231], v[76:79], v[40:43], v[228:231]
    ds_read_b64_tr_b16 v[90:91], v21 offset:45056
    v_mfma_f32_16x16x32_bf16 v[232:235], v[80:83], v[40:43], v[232:235]
    ds_read_b128 v[40:43], v18 offset:6912
    s_waitcnt lgkmcnt(9)
    v_mfma_f32_16x16x32_bf16 v[236:239], v[76:79], v[44:47], v[236:239]
    v_mfma_f32_16x16x32_bf16 v[240:243], v[80:83], v[44:47], v[240:243]
    ds_read_b128 v[44:47], v18 offset:7168
    s_waitcnt lgkmcnt(9)
    v_mfma_f32_16x16x32_bf16 v[244:247], v[76:79], v[48:51], v[244:247]
    v_mfma_f32_16x16x32_bf16 v[248:251], v[80:83], v[48:51], v[248:251]
    ds_read_b128 v[48:51], v18 offset:7424
    s_waitcnt lgkmcnt(3)
    v_mfma_f32_16x16x32_bf16 v[204:207], v[84:87], v[28:31], v[204:207]
    s_barrier
    ds_read_b64_tr_b16 v[76:77], v24 offset:0
    v_mfma_f32_16x16x32_bf16 v[208:211], v[88:91], v[28:31], v[208:211]
    ds_read_b128 v[28:31], v18 offset:12288
    v_mfma_f32_16x16x32_bf16 v[212:215], v[84:87], v[32:35], v[212:215]
    ds_read_b64_tr_b16 v[78:79], v24 offset:4096
    v_mfma_f32_16x16x32_bf16 v[216:219], v[88:91], v[32:35], v[216:219]
    ds_read_b128 v[32:35], v18 offset:12544
    v_mfma_f32_16x16x32_bf16 v[220:223], v[84:87], v[36:39], v[220:223]
    ds_read_b64_tr_b16 v[80:81], v25 offset:0
    v_mfma_f32_16x16x32_bf16 v[224:227], v[88:91], v[36:39], v[224:227]
    ds_read_b128 v[36:39], v18 offset:12800
    s_waitcnt lgkmcnt(8)
    v_mfma_f32_16x16x32_bf16 v[228:231], v[84:87], v[40:43], v[228:231]
    ds_read_b64_tr_b16 v[82:83], v25 offset:4096
    v_mfma_f32_16x16x32_bf16 v[232:235], v[88:91], v[40:43], v[232:235]
    ds_read_b128 v[40:43], v18 offset:13056
    s_waitcnt lgkmcnt(9)
    v_mfma_f32_16x16x32_bf16 v[236:239], v[84:87], v[44:47], v[236:239]
    v_mfma_f32_16x16x32_bf16 v[240:243], v[88:91], v[44:47], v[240:243]
    ds_read_b128 v[44:47], v18 offset:13312
    s_waitcnt lgkmcnt(9)
    v_mfma_f32_16x16x32_bf16 v[244:247], v[84:87], v[48:51], v[244:247]
    v_mfma_f32_16x16x32_bf16 v[248:251], v[88:91], v[48:51], v[248:251]
    ds_read_b128 v[48:51], v18 offset:13568
    s_waitcnt lgkmcnt(3)
    v_mfma_f32_16x16x32_bf16 v[204:207], v[76:79], v[28:31], v[204:207]
    ds_read_b64_tr_b16 v[84:85], v24 offset:8192
    v_mfma_f32_16x16x32_bf16 v[208:211], v[80:83], v[28:31], v[208:211]
    ds_read_b128 v[28:31], v18 offset:18432
    v_mfma_f32_16x16x32_bf16 v[212:215], v[76:79], v[32:35], v[212:215]
    ds_read_b64_tr_b16 v[86:87], v24 offset:12288
    v_mfma_f32_16x16x32_bf16 v[216:219], v[80:83], v[32:35], v[216:219]
    ds_read_b128 v[32:35], v18 offset:18688
    v_mfma_f32_16x16x32_bf16 v[220:223], v[76:79], v[36:39], v[220:223]
    ds_read_b64_tr_b16 v[88:89], v25 offset:8192
    v_mfma_f32_16x16x32_bf16 v[224:227], v[80:83], v[36:39], v[224:227]
    ds_read_b128 v[36:39], v18 offset:18944
    s_waitcnt lgkmcnt(8)
    v_mfma_f32_16x16x32_bf16 v[228:231], v[76:79], v[40:43], v[228:231]
    ds_read_b64_tr_b16 v[90:91], v25 offset:12288
    v_mfma_f32_16x16x32_bf16 v[232:235], v[80:83], v[40:43], v[232:235]
    ds_read_b128 v[40:43], v18 offset:19200
    s_waitcnt lgkmcnt(9)
    v_mfma_f32_16x16x32_bf16 v[236:239], v[76:79], v[44:47], v[236:239]
    v_mfma_f32_16x16x32_bf16 v[240:243], v[80:83], v[44:47], v[240:243]
    ds_read_b128 v[44:47], v18 offset:19456
    s_waitcnt lgkmcnt(9)
    v_mfma_f32_16x16x32_bf16 v[244:247], v[76:79], v[48:51], v[244:247]
    v_mfma_f32_16x16x32_bf16 v[248:251], v[80:83], v[48:51], v[248:251]
    ds_read_b128 v[48:51], v18 offset:19712
    s_waitcnt lgkmcnt(3)
    v_mfma_f32_16x16x32_bf16 v[204:207], v[84:87], v[28:31], v[204:207]
    s_barrier
    v_mfma_f32_16x16x32_bf16 v[208:211], v[88:91], v[28:31], v[208:211]
    ds_read_b128 v[28:31], v18 offset:24576
    v_mfma_f32_16x16x32_bf16 v[212:215], v[84:87], v[32:35], v[212:215]
    v_mfma_f32_16x16x32_bf16 v[216:219], v[88:91], v[32:35], v[216:219]
    ds_read_b128 v[32:35], v18 offset:24832
    v_mfma_f32_16x16x32_bf16 v[220:223], v[84:87], v[36:39], v[220:223]
    v_mfma_f32_16x16x32_bf16 v[224:227], v[88:91], v[36:39], v[224:227]
    ds_read_b128 v[36:39], v18 offset:25088
    s_waitcnt lgkmcnt(5)
    v_mfma_f32_16x16x32_bf16 v[228:231], v[84:87], v[40:43], v[228:231]
    v_mfma_f32_16x16x32_bf16 v[232:235], v[88:91], v[40:43], v[232:235]
    ds_read_b128 v[40:43], v18 offset:25344
    s_waitcnt lgkmcnt(5)
    v_mfma_f32_16x16x32_bf16 v[236:239], v[84:87], v[44:47], v[236:239]
    v_mfma_f32_16x16x32_bf16 v[240:243], v[88:91], v[44:47], v[240:243]
    ds_read_b128 v[44:47], v18 offset:25600
    s_waitcnt lgkmcnt(5)
    v_mfma_f32_16x16x32_bf16 v[244:247], v[84:87], v[48:51], v[244:247]
    v_mfma_f32_16x16x32_bf16 v[248:251], v[88:91], v[48:51], v[248:251]
    ds_read_b128 v[48:51], v18 offset:25856
    s_waitcnt lgkmcnt(3)
    v_mfma_f32_16x16x32_bf16 v[204:207], v[52:55], v[28:31], v[204:207]
    v_mfma_f32_16x16x32_bf16 v[208:211], v[56:59], v[28:31], v[208:211]
    ds_read_b128 v[28:31], v18 offset:30720
    v_mfma_f32_16x16x32_bf16 v[212:215], v[52:55], v[32:35], v[212:215]
    v_mfma_f32_16x16x32_bf16 v[216:219], v[56:59], v[32:35], v[216:219]
    ds_read_b128 v[32:35], v18 offset:30976
    v_mfma_f32_16x16x32_bf16 v[220:223], v[52:55], v[36:39], v[220:223]
    v_mfma_f32_16x16x32_bf16 v[224:227], v[56:59], v[36:39], v[224:227]
    ds_read_b128 v[36:39], v18 offset:31232
    s_waitcnt lgkmcnt(5)
    v_mfma_f32_16x16x32_bf16 v[228:231], v[52:55], v[40:43], v[228:231]
    v_mfma_f32_16x16x32_bf16 v[232:235], v[56:59], v[40:43], v[232:235]
    ds_read_b128 v[40:43], v18 offset:31488
    s_waitcnt lgkmcnt(5)
    v_mfma_f32_16x16x32_bf16 v[236:239], v[52:55], v[44:47], v[236:239]
    v_mfma_f32_16x16x32_bf16 v[240:243], v[56:59], v[44:47], v[240:243]
    ds_read_b128 v[44:47], v18 offset:31744
    s_waitcnt lgkmcnt(5)
    v_mfma_f32_16x16x32_bf16 v[244:247], v[52:55], v[48:51], v[244:247]
    v_mfma_f32_16x16x32_bf16 v[248:251], v[56:59], v[48:51], v[248:251]
    ds_read_b128 v[48:51], v18 offset:32000
    s_waitcnt lgkmcnt(3)
    v_mfma_f32_16x16x32_bf16 v[204:207], v[60:63], v[28:31], v[204:207]
    s_barrier
    ds_read_b64_tr_b16 v[76:77], v24 offset:16384
    v_mfma_f32_16x16x32_bf16 v[208:211], v[64:67], v[28:31], v[208:211]
    ds_read_b128 v[28:31], v18 offset:36864
    v_mfma_f32_16x16x32_bf16 v[212:215], v[60:63], v[32:35], v[212:215]
    ds_read_b64_tr_b16 v[78:79], v24 offset:20480
    v_mfma_f32_16x16x32_bf16 v[216:219], v[64:67], v[32:35], v[216:219]
    ds_read_b128 v[32:35], v18 offset:37120
    v_mfma_f32_16x16x32_bf16 v[220:223], v[60:63], v[36:39], v[220:223]
    ds_read_b64_tr_b16 v[80:81], v25 offset:16384
    v_mfma_f32_16x16x32_bf16 v[224:227], v[64:67], v[36:39], v[224:227]
    ds_read_b128 v[36:39], v18 offset:37376
    s_waitcnt lgkmcnt(8)
    v_mfma_f32_16x16x32_bf16 v[228:231], v[60:63], v[40:43], v[228:231]
    ds_read_b64_tr_b16 v[82:83], v25 offset:20480
    v_mfma_f32_16x16x32_bf16 v[232:235], v[64:67], v[40:43], v[232:235]
    ds_read_b128 v[40:43], v18 offset:37632
    s_waitcnt lgkmcnt(9)
    v_mfma_f32_16x16x32_bf16 v[236:239], v[60:63], v[44:47], v[236:239]
    v_mfma_f32_16x16x32_bf16 v[240:243], v[64:67], v[44:47], v[240:243]
    ds_read_b128 v[44:47], v18 offset:37888
    s_waitcnt lgkmcnt(9)
    v_mfma_f32_16x16x32_bf16 v[244:247], v[60:63], v[48:51], v[244:247]
    v_mfma_f32_16x16x32_bf16 v[248:251], v[64:67], v[48:51], v[248:251]
    ds_read_b128 v[48:51], v18 offset:38144
    s_waitcnt lgkmcnt(3)
    v_mfma_f32_16x16x32_bf16 v[204:207], v[76:79], v[28:31], v[204:207]
    ds_read_b64_tr_b16 v[84:85], v24 offset:24576
    v_mfma_f32_16x16x32_bf16 v[208:211], v[80:83], v[28:31], v[208:211]
    ds_read_b128 v[28:31], v18 offset:43008
    v_mfma_f32_16x16x32_bf16 v[212:215], v[76:79], v[32:35], v[212:215]
    ds_read_b64_tr_b16 v[86:87], v24 offset:28672
    v_mfma_f32_16x16x32_bf16 v[216:219], v[80:83], v[32:35], v[216:219]
    ds_read_b128 v[32:35], v18 offset:43264
    v_mfma_f32_16x16x32_bf16 v[220:223], v[76:79], v[36:39], v[220:223]
    ds_read_b64_tr_b16 v[88:89], v25 offset:24576
    v_mfma_f32_16x16x32_bf16 v[224:227], v[80:83], v[36:39], v[224:227]
    ds_read_b128 v[36:39], v18 offset:43520
    s_waitcnt lgkmcnt(8)
    v_mfma_f32_16x16x32_bf16 v[228:231], v[76:79], v[40:43], v[228:231]
    ds_read_b64_tr_b16 v[90:91], v25 offset:28672
    v_mfma_f32_16x16x32_bf16 v[232:235], v[80:83], v[40:43], v[232:235]
    ds_read_b128 v[40:43], v18 offset:43776
    s_waitcnt lgkmcnt(9)
    v_mfma_f32_16x16x32_bf16 v[236:239], v[76:79], v[44:47], v[236:239]
    v_mfma_f32_16x16x32_bf16 v[240:243], v[80:83], v[44:47], v[240:243]
    ds_read_b128 v[44:47], v18 offset:44032
    s_waitcnt lgkmcnt(9)
    v_mfma_f32_16x16x32_bf16 v[244:247], v[76:79], v[48:51], v[244:247]
    v_mfma_f32_16x16x32_bf16 v[248:251], v[80:83], v[48:51], v[248:251]
    ds_read_b128 v[48:51], v18 offset:44288
    s_waitcnt lgkmcnt(3)
    v_mfma_f32_16x16x32_bf16 v[204:207], v[84:87], v[28:31], v[204:207]
    s_barrier
    ds_read_b64_tr_b16 v[76:77], v24 offset:32768
    v_mfma_f32_16x16x32_bf16 v[208:211], v[88:91], v[28:31], v[208:211]
    ds_read_b128 v[28:31], v18 offset:49152
    v_mfma_f32_16x16x32_bf16 v[212:215], v[84:87], v[32:35], v[212:215]
    ds_read_b64_tr_b16 v[78:79], v24 offset:36864
    v_mfma_f32_16x16x32_bf16 v[216:219], v[88:91], v[32:35], v[216:219]
    ds_read_b128 v[32:35], v18 offset:49408
    v_mfma_f32_16x16x32_bf16 v[220:223], v[84:87], v[36:39], v[220:223]
    ds_read_b64_tr_b16 v[80:81], v25 offset:32768
    v_mfma_f32_16x16x32_bf16 v[224:227], v[88:91], v[36:39], v[224:227]
    ds_read_b128 v[36:39], v18 offset:49664
    s_waitcnt lgkmcnt(8)
    v_mfma_f32_16x16x32_bf16 v[228:231], v[84:87], v[40:43], v[228:231]
    ds_read_b64_tr_b16 v[82:83], v25 offset:36864
    v_mfma_f32_16x16x32_bf16 v[232:235], v[88:91], v[40:43], v[232:235]
    ds_read_b128 v[40:43], v18 offset:49920
    s_waitcnt lgkmcnt(9)
    v_mfma_f32_16x16x32_bf16 v[236:239], v[84:87], v[44:47], v[236:239]
    v_mfma_f32_16x16x32_bf16 v[240:243], v[88:91], v[44:47], v[240:243]
    ds_read_b128 v[44:47], v18 offset:50176
    s_waitcnt lgkmcnt(9)
    v_mfma_f32_16x16x32_bf16 v[244:247], v[84:87], v[48:51], v[244:247]
    v_mfma_f32_16x16x32_bf16 v[248:251], v[88:91], v[48:51], v[248:251]
    ds_read_b128 v[48:51], v18 offset:50432
    s_waitcnt lgkmcnt(3)
    v_mfma_f32_16x16x32_bf16 v[204:207], v[76:79], v[28:31], v[204:207]
    ds_read_b64_tr_b16 v[84:85], v24 offset:40960
    v_mfma_f32_16x16x32_bf16 v[208:211], v[80:83], v[28:31], v[208:211]
    ds_read_b128 v[28:31], v18 offset:55296
    v_mfma_f32_16x16x32_bf16 v[212:215], v[76:79], v[32:35], v[212:215]
    ds_read_b64_tr_b16 v[86:87], v24 offset:45056
    v_mfma_f32_16x16x32_bf16 v[216:219], v[80:83], v[32:35], v[216:219]
    ds_read_b128 v[32:35], v18 offset:55552
    v_mfma_f32_16x16x32_bf16 v[220:223], v[76:79], v[36:39], v[220:223]
    ds_read_b64_tr_b16 v[88:89], v25 offset:40960
    v_mfma_f32_16x16x32_bf16 v[224:227], v[80:83], v[36:39], v[224:227]
    ds_read_b128 v[36:39], v18 offset:55808
    s_waitcnt lgkmcnt(8)
    v_mfma_f32_16x16x32_bf16 v[228:231], v[76:79], v[40:43], v[228:231]
    ds_read_b64_tr_b16 v[90:91], v25 offset:45056
    v_mfma_f32_16x16x32_bf16 v[232:235], v[80:83], v[40:43], v[232:235]
    ds_read_b128 v[40:43], v18 offset:56064
    s_waitcnt lgkmcnt(9)
    v_mfma_f32_16x16x32_bf16 v[236:239], v[76:79], v[44:47], v[236:239]
    v_mfma_f32_16x16x32_bf16 v[240:243], v[80:83], v[44:47], v[240:243]
    ds_read_b128 v[44:47], v18 offset:56320
    s_waitcnt lgkmcnt(9)
    v_mfma_f32_16x16x32_bf16 v[244:247], v[76:79], v[48:51], v[244:247]
    v_mfma_f32_16x16x32_bf16 v[248:251], v[80:83], v[48:51], v[248:251]
    ds_read_b128 v[48:51], v18 offset:56576
    s_waitcnt lgkmcnt(3)
    v_mfma_f32_16x16x32_bf16 v[204:207], v[84:87], v[28:31], v[204:207]
    s_barrier
    ds_read_b64_tr_b16 v[76:77], v20 offset:0
    v_mfma_f32_16x16x32_bf16 v[208:211], v[88:91], v[28:31], v[208:211]
    ds_read_b128 v[28:31], v18 offset:0
    v_mfma_f32_16x16x32_bf16 v[212:215], v[84:87], v[32:35], v[212:215]
    ds_read_b64_tr_b16 v[78:79], v20 offset:4096
    v_mfma_f32_16x16x32_bf16 v[216:219], v[88:91], v[32:35], v[216:219]
    ds_read_b128 v[32:35], v18 offset:256
    v_mfma_f32_16x16x32_bf16 v[220:223], v[84:87], v[36:39], v[220:223]
    ds_read_b64_tr_b16 v[80:81], v21 offset:0
    v_mfma_f32_16x16x32_bf16 v[224:227], v[88:91], v[36:39], v[224:227]
    ds_read_b128 v[36:39], v18 offset:512
    s_waitcnt lgkmcnt(8)
    v_mfma_f32_16x16x32_bf16 v[228:231], v[84:87], v[40:43], v[228:231]
    ds_read_b64_tr_b16 v[82:83], v21 offset:4096
    v_mfma_f32_16x16x32_bf16 v[232:235], v[88:91], v[40:43], v[232:235]
    ds_read_b128 v[40:43], v18 offset:768
    s_waitcnt lgkmcnt(9)
    v_mfma_f32_16x16x32_bf16 v[236:239], v[84:87], v[44:47], v[236:239]
    v_mfma_f32_16x16x32_bf16 v[240:243], v[88:91], v[44:47], v[240:243]
    ds_read_b128 v[44:47], v18 offset:1024
    s_waitcnt lgkmcnt(9)
    v_mfma_f32_16x16x32_bf16 v[244:247], v[84:87], v[48:51], v[244:247]
    v_mfma_f32_16x16x32_bf16 v[248:251], v[88:91], v[48:51], v[248:251]
    ds_read_b128 v[48:51], v18 offset:1280
    s_waitcnt lgkmcnt(3)
    v_mfma_f32_16x16x32_bf16 v[204:207], v[76:79], v[28:31], v[204:207]
    ds_read_b64_tr_b16 v[84:85], v20 offset:8192
    v_mfma_f32_16x16x32_bf16 v[208:211], v[80:83], v[28:31], v[208:211]
    ds_read_b128 v[28:31], v18 offset:6144
    v_mfma_f32_16x16x32_bf16 v[212:215], v[76:79], v[32:35], v[212:215]
    ds_read_b64_tr_b16 v[86:87], v20 offset:12288
    v_mfma_f32_16x16x32_bf16 v[216:219], v[80:83], v[32:35], v[216:219]
    ds_read_b128 v[32:35], v18 offset:6400
    v_mfma_f32_16x16x32_bf16 v[220:223], v[76:79], v[36:39], v[220:223]
    ds_read_b64_tr_b16 v[88:89], v21 offset:8192
    v_mfma_f32_16x16x32_bf16 v[224:227], v[80:83], v[36:39], v[224:227]
    ds_read_b128 v[36:39], v18 offset:6656
    s_waitcnt lgkmcnt(8)
    v_mfma_f32_16x16x32_bf16 v[228:231], v[76:79], v[40:43], v[228:231]
    ds_read_b64_tr_b16 v[90:91], v21 offset:12288
    v_mfma_f32_16x16x32_bf16 v[232:235], v[80:83], v[40:43], v[232:235]
    ds_read_b128 v[40:43], v18 offset:6912
    s_waitcnt lgkmcnt(9)
    v_mfma_f32_16x16x32_bf16 v[236:239], v[76:79], v[44:47], v[236:239]
    v_mfma_f32_16x16x32_bf16 v[240:243], v[80:83], v[44:47], v[240:243]
    ds_read_b128 v[44:47], v18 offset:7168
    s_waitcnt lgkmcnt(9)
    v_mfma_f32_16x16x32_bf16 v[244:247], v[76:79], v[48:51], v[244:247]
    v_mfma_f32_16x16x32_bf16 v[248:251], v[80:83], v[48:51], v[248:251]
    ds_read_b128 v[48:51], v18 offset:7424
    s_waitcnt lgkmcnt(3)
    v_mfma_f32_16x16x32_bf16 v[204:207], v[84:87], v[28:31], v[204:207]
    s_barrier
    ds_read_b64_tr_b16 v[76:77], v20 offset:16384
    v_mfma_f32_16x16x32_bf16 v[208:211], v[88:91], v[28:31], v[208:211]
    ds_read_b128 v[28:31], v18 offset:12288
    v_mfma_f32_16x16x32_bf16 v[212:215], v[84:87], v[32:35], v[212:215]
    ds_read_b64_tr_b16 v[78:79], v20 offset:20480
    v_mfma_f32_16x16x32_bf16 v[216:219], v[88:91], v[32:35], v[216:219]
    ds_read_b128 v[32:35], v18 offset:12544
    v_mfma_f32_16x16x32_bf16 v[220:223], v[84:87], v[36:39], v[220:223]
    ds_read_b64_tr_b16 v[80:81], v21 offset:16384
    v_mfma_f32_16x16x32_bf16 v[224:227], v[88:91], v[36:39], v[224:227]
    ds_read_b128 v[36:39], v18 offset:12800
    s_waitcnt lgkmcnt(8)
    v_mfma_f32_16x16x32_bf16 v[228:231], v[84:87], v[40:43], v[228:231]
    ds_read_b64_tr_b16 v[82:83], v21 offset:20480
    v_mfma_f32_16x16x32_bf16 v[232:235], v[88:91], v[40:43], v[232:235]
    ds_read_b128 v[40:43], v18 offset:13056
    s_waitcnt lgkmcnt(9)
    v_mfma_f32_16x16x32_bf16 v[236:239], v[84:87], v[44:47], v[236:239]
    v_mfma_f32_16x16x32_bf16 v[240:243], v[88:91], v[44:47], v[240:243]
    ds_read_b128 v[44:47], v18 offset:13312
    s_waitcnt lgkmcnt(9)
    v_mfma_f32_16x16x32_bf16 v[244:247], v[84:87], v[48:51], v[244:247]
    v_mfma_f32_16x16x32_bf16 v[248:251], v[88:91], v[48:51], v[248:251]
    ds_read_b128 v[48:51], v18 offset:13568
    s_waitcnt lgkmcnt(3)
    v_mfma_f32_16x16x32_bf16 v[204:207], v[76:79], v[28:31], v[204:207]
    ds_read_b64_tr_b16 v[84:85], v20 offset:24576
    v_mfma_f32_16x16x32_bf16 v[208:211], v[80:83], v[28:31], v[208:211]
    ds_read_b128 v[28:31], v18 offset:18432
    v_mfma_f32_16x16x32_bf16 v[212:215], v[76:79], v[32:35], v[212:215]
    ds_read_b64_tr_b16 v[86:87], v20 offset:28672
    v_mfma_f32_16x16x32_bf16 v[216:219], v[80:83], v[32:35], v[216:219]
    ds_read_b128 v[32:35], v18 offset:18688
    v_mfma_f32_16x16x32_bf16 v[220:223], v[76:79], v[36:39], v[220:223]
    ds_read_b64_tr_b16 v[88:89], v21 offset:24576
    v_mfma_f32_16x16x32_bf16 v[224:227], v[80:83], v[36:39], v[224:227]
    ds_read_b128 v[36:39], v18 offset:18944
    s_waitcnt lgkmcnt(8)
    v_mfma_f32_16x16x32_bf16 v[228:231], v[76:79], v[40:43], v[228:231]
    ds_read_b64_tr_b16 v[90:91], v21 offset:28672
    v_mfma_f32_16x16x32_bf16 v[232:235], v[80:83], v[40:43], v[232:235]
    ds_read_b128 v[40:43], v18 offset:19200
    s_waitcnt lgkmcnt(9)
    v_mfma_f32_16x16x32_bf16 v[236:239], v[76:79], v[44:47], v[236:239]
    v_mfma_f32_16x16x32_bf16 v[240:243], v[80:83], v[44:47], v[240:243]
    ds_read_b128 v[44:47], v18 offset:19456
    s_waitcnt lgkmcnt(9)
    v_mfma_f32_16x16x32_bf16 v[244:247], v[76:79], v[48:51], v[244:247]
    v_mfma_f32_16x16x32_bf16 v[248:251], v[80:83], v[48:51], v[248:251]
    ds_read_b128 v[48:51], v18 offset:19712
    s_waitcnt lgkmcnt(0)
    s_lshl_b32 s48, s51, 2
    s_add_u32 s48, s48, s3
    s_mul_i32 s48, s48, 36864
    s_mul_i32 s49, s52, 1536
    s_add_u32 s48, s48, s49
    s_add_u32 s48, s48, 20971520
    v_mul_u32_u24 v22, 9216, v2
    v_lshl_add_u32 v22, v1, 4, v22
    s_mov_b32 s60, 0xbdd2d3e8
    v_mov_b32 v4, 0xc0135761
    s_barrier
    v_mfma_f32_16x16x32_bf16 v[204:207], v[84:87], v[28:31], v[204:207]
    v_mfma_f32_16x16x32_bf16 v[208:211], v[88:91], v[28:31], v[208:211]
    v_mfma_f32_16x16x32_bf16 v[212:215], v[84:87], v[32:35], v[212:215]
    v_mfma_f32_16x16x32_bf16 v[216:219], v[88:91], v[32:35], v[216:219]
    s_nop 4
    v_pk_mul_f32 v[92:93], v[204:205], v[204:205]
    v_pk_mul_f32 v[94:95], v[206:207], v[206:207]
    v_pk_mul_f32 v[96:97], v[208:209], v[208:209]
    s_nop 0
    v_mfma_f32_16x16x32_bf16 v[220:223], v[84:87], v[36:39], v[220:223]
    v_pk_mul_f32 v[98:99], v[210:211], v[210:211]
    v_pk_fma_f32 v[92:93], v[92:93], s[60:61], v[4:5] op_sel_hi:[1,0,0]
    v_pk_fma_f32 v[94:95], v[94:95], s[60:61], v[4:5] op_sel_hi:[1,0,0]
    s_nop 0
    v_mfma_f32_16x16x32_bf16 v[224:227], v[88:91], v[36:39], v[224:227]
    v_pk_fma_f32 v[96:97], v[96:97], s[60:61], v[4:5] op_sel_hi:[1,0,0]
    v_pk_fma_f32 v[98:99], v[98:99], s[60:61], v[4:5] op_sel_hi:[1,0,0]
    v_pk_mul_f32 v[92:93], v[92:93], v[204:205]
    s_nop 0
    v_mfma_f32_16x16x32_bf16 v[228:231], v[84:87], v[40:43], v[228:231]
    v_pk_mul_f32 v[94:95], v[94:95], v[206:207]
    v_pk_mul_f32 v[96:97], v[96:97], v[208:209]
    v_pk_mul_f32 v[98:99], v[98:99], v[210:211]
    s_nop 0
    v_mfma_f32_16x16x32_bf16 v[232:235], v[88:91], v[40:43], v[232:235]
    v_exp_f32 v92, v92
    v_exp_f32 v93, v93
    v_exp_f32 v94, v94
    s_nop 0
    v_mfma_f32_16x16x32_bf16 v[236:239], v[84:87], v[44:47], v[236:239]
    v_exp_f32 v95, v95
    v_exp_f32 v96, v96
    v_exp_f32 v97, v97
    s_nop 0
    v_mfma_f32_16x16x32_bf16 v[240:243], v[88:91], v[44:47], v[240:243]
    v_exp_f32 v98, v98
    v_exp_f32 v99, v99
    v_pk_add_f32 v[92:93], v[92:93], 1.0 op_sel_hi:[1,0]
    s_nop 0
    v_mfma_f32_16x16x32_bf16 v[244:247], v[84:87], v[48:51], v[244:247]
    v_pk_add_f32 v[94:95], v[94:95], 1.0 op_sel_hi:[1,0]
    v_pk_add_f32 v[96:97], v[96:97], 1.0 op_sel_hi:[1,0]
    v_pk_add_f32 v[98:99], v[98:99], 1.0 op_sel_hi:[1,0]
    s_nop 0
    v_mfma_f32_16x16x32_bf16 v[248:251], v[88:91], v[48:51], v[248:251]
    v_rcp_f32 v92, v92
    v_rcp_f32 v93, v93
    v_rcp_f32 v94, v94
    v_rcp_f32 v95, v95
    v_rcp_f32 v96, v96
    v_rcp_f32 v97, v97
    v_rcp_f32 v98, v98
    v_rcp_f32 v99, v99
    v_pk_mul_f32 v[92:93], v[92:93], v[204:205]
    v_pk_mul_f32 v[94:95], v[94:95], v[206:207]
    v_pk_mul_f32 v[96:97], v[96:97], v[208:209]
    v_pk_mul_f32 v[98:99], v[98:99], v[210:211]
    v_cvt_pk_bf16_f32 v76, v92, v93
    v_cvt_pk_bf16_f32 v77, v94, v95
    v_cvt_pk_bf16_f32 v78, v96, v97
    v_cvt_pk_bf16_f32 v79, v98, v99
    buffer_store_dwordx4 v[76:79], v22, s[36:39], s48 offen offset:0 sc1
    v_pk_mul_f32 v[100:101], v[212:213], v[212:213]
    v_pk_mul_f32 v[102:103], v[214:215], v[214:215]
    v_pk_mul_f32 v[104:105], v[216:217], v[216:217]
    v_pk_mul_f32 v[106:107], v[218:219], v[218:219]
    v_pk_fma_f32 v[100:101], v[100:101], s[60:61], v[4:5] op_sel_hi:[1,0,0]
    v_pk_fma_f32 v[102:103], v[102:103], s[60:61], v[4:5] op_sel_hi:[1,0,0]
    v_pk_fma_f32 v[104:105], v[104:105], s[60:61], v[4:5] op_sel_hi:[1,0,0]
    v_pk_fma_f32 v[106:107], v[106:107], s[60:61], v[4:5] op_sel_hi:[1,0,0]
    v_pk_mul_f32 v[100:101], v[100:101], v[212:213]
    v_pk_mul_f32 v[102:103], v[102:103], v[214:215]
    v_pk_mul_f32 v[104:105], v[104:105], v[216:217]
    v_pk_mul_f32 v[106:107], v[106:107], v[218:219]
    v_exp_f32 v100, v100
    v_exp_f32 v101, v101
    v_exp_f32 v102, v102
    v_exp_f32 v103, v103
    v_exp_f32 v104, v104
    v_exp_f32 v105, v105
    v_exp_f32 v106, v106
    v_exp_f32 v107, v107
    v_pk_add_f32 v[100:101], v[100:101], 1.0 op_sel_hi:[1,0]
    v_pk_add_f32 v[102:103], v[102:103], 1.0 op_sel_hi:[1,0]
    v_pk_add_f32 v[104:105], v[104:105], 1.0 op_sel_hi:[1,0]
    v_pk_add_f32 v[106:107], v[106:107], 1.0 op_sel_hi:[1,0]
    v_rcp_f32 v100, v100
    v_rcp_f32 v101, v101
    v_rcp_f32 v102, v102
    v_rcp_f32 v103, v103
    v_rcp_f32 v104, v104
    v_rcp_f32 v105, v105
    v_rcp_f32 v106, v106
    v_rcp_f32 v107, v107
    v_pk_mul_f32 v[100:101], v[100:101], v[212:213]
    v_pk_mul_f32 v[102:103], v[102:103], v[214:215]
    v_pk_mul_f32 v[104:105], v[104:105], v[216:217]
    v_pk_mul_f32 v[106:107], v[106:107], v[218:219]
    v_cvt_pk_bf16_f32 v80, v100, v101
    v_cvt_pk_bf16_f32 v81, v102, v103
    v_cvt_pk_bf16_f32 v82, v104, v105
    v_cvt_pk_bf16_f32 v83, v106, v107
    buffer_store_dwordx4 v[80:83], v22, s[36:39], s48 offen offset:256 sc1
    v_pk_mul_f32 v[92:93], v[220:221], v[220:221]
    v_pk_mul_f32 v[94:95], v[222:223], v[222:223]
    v_pk_mul_f32 v[96:97], v[224:225], v[224:225]
    v_pk_mul_f32 v[98:99], v[226:227], v[226:227]
    v_pk_fma_f32 v[92:93], v[92:93], s[60:61], v[4:5] op_sel_hi:[1,0,0]
    v_pk_fma_f32 v[94:95], v[94:95], s[60:61], v[4:5] op_sel_hi:[1,0,0]
    v_pk_fma_f32 v[96:97], v[96:97], s[60:61], v[4:5] op_sel_hi:[1,0,0]
    v_pk_fma_f32 v[98:99], v[98:99], s[60:61], v[4:5] op_sel_hi:[1,0,0]
    v_pk_mul_f32 v[92:93], v[92:93], v[220:221]
    v_pk_mul_f32 v[94:95], v[94:95], v[222:223]
    v_pk_mul_f32 v[96:97], v[96:97], v[224:225]
    v_pk_mul_f32 v[98:99], v[98:99], v[226:227]
    v_exp_f32 v92, v92
    v_exp_f32 v93, v93
    v_exp_f32 v94, v94
    v_exp_f32 v95, v95
    v_exp_f32 v96, v96
    v_exp_f32 v97, v97
    v_exp_f32 v98, v98
    v_exp_f32 v99, v99
    v_pk_add_f32 v[92:93], v[92:93], 1.0 op_sel_hi:[1,0]
    v_pk_add_f32 v[94:95], v[94:95], 1.0 op_sel_hi:[1,0]
    v_pk_add_f32 v[96:97], v[96:97], 1.0 op_sel_hi:[1,0]
    v_pk_add_f32 v[98:99], v[98:99], 1.0 op_sel_hi:[1,0]
    v_rcp_f32 v92, v92
    v_rcp_f32 v93, v93
    v_rcp_f32 v94, v94
    v_rcp_f32 v95, v95
    v_rcp_f32 v96, v96
    v_rcp_f32 v97, v97
    v_rcp_f32 v98, v98
    v_rcp_f32 v99, v99
    v_pk_mul_f32 v[92:93], v[92:93], v[220:221]
    v_pk_mul_f32 v[94:95], v[94:95], v[222:223]
    v_pk_mul_f32 v[96:97], v[96:97], v[224:225]
    v_pk_mul_f32 v[98:99], v[98:99], v[226:227]
    v_cvt_pk_bf16_f32 v76, v92, v93
    v_cvt_pk_bf16_f32 v77, v94, v95
    v_cvt_pk_bf16_f32 v78, v96, v97
    v_cvt_pk_bf16_f32 v79, v98, v99
    buffer_store_dwordx4 v[76:79], v22, s[36:39], s48 offen offset:512 sc1
    v_pk_mul_f32 v[100:101], v[228:229], v[228:229]
    v_pk_mul_f32 v[102:103], v[230:231], v[230:231]
    v_pk_mul_f32 v[104:105], v[232:233], v[232:233]
    v_pk_mul_f32 v[106:107], v[234:235], v[234:235]
    v_pk_fma_f32 v[100:101], v[100:101], s[60:61], v[4:5] op_sel_hi:[1,0,0]
    v_pk_fma_f32 v[102:103], v[102:103], s[60:61], v[4:5] op_sel_hi:[1,0,0]
    v_pk_fma_f32 v[104:105], v[104:105], s[60:61], v[4:5] op_sel_hi:[1,0,0]
    v_pk_fma_f32 v[106:107], v[106:107], s[60:61], v[4:5] op_sel_hi:[1,0,0]
    v_pk_mul_f32 v[100:101], v[100:101], v[228:229]
    v_pk_mul_f32 v[102:103], v[102:103], v[230:231]
    v_pk_mul_f32 v[104:105], v[104:105], v[232:233]
    v_pk_mul_f32 v[106:107], v[106:107], v[234:235]
    v_exp_f32 v100, v100
    v_exp_f32 v101, v101
    v_exp_f32 v102, v102
    v_exp_f32 v103, v103
    v_exp_f32 v104, v104
    v_exp_f32 v105, v105
    v_exp_f32 v106, v106
    v_exp_f32 v107, v107
    v_pk_add_f32 v[100:101], v[100:101], 1.0 op_sel_hi:[1,0]
    v_pk_add_f32 v[102:103], v[102:103], 1.0 op_sel_hi:[1,0]
    v_pk_add_f32 v[104:105], v[104:105], 1.0 op_sel_hi:[1,0]
    v_pk_add_f32 v[106:107], v[106:107], 1.0 op_sel_hi:[1,0]
    v_rcp_f32 v100, v100
    v_rcp_f32 v101, v101
    v_rcp_f32 v102, v102
    v_rcp_f32 v103, v103
    v_rcp_f32 v104, v104
    v_rcp_f32 v105, v105
    v_rcp_f32 v106, v106
    v_rcp_f32 v107, v107
    v_pk_mul_f32 v[100:101], v[100:101], v[228:229]
    v_pk_mul_f32 v[102:103], v[102:103], v[230:231]
    v_pk_mul_f32 v[104:105], v[104:105], v[232:233]
    v_pk_mul_f32 v[106:107], v[106:107], v[234:235]
    v_cvt_pk_bf16_f32 v80, v100, v101
    v_cvt_pk_bf16_f32 v81, v102, v103
    v_cvt_pk_bf16_f32 v82, v104, v105
    v_cvt_pk_bf16_f32 v83, v106, v107
    buffer_store_dwordx4 v[80:83], v22, s[36:39], s48 offen offset:768 sc1
    v_pk_mul_f32 v[92:93], v[236:237], v[236:237]
    v_pk_mul_f32 v[94:95], v[238:239], v[238:239]
    v_pk_mul_f32 v[96:97], v[240:241], v[240:241]
    v_pk_mul_f32 v[98:99], v[242:243], v[242:243]
    v_pk_fma_f32 v[92:93], v[92:93], s[60:61], v[4:5] op_sel_hi:[1,0,0]
    v_pk_fma_f32 v[94:95], v[94:95], s[60:61], v[4:5] op_sel_hi:[1,0,0]
    v_pk_fma_f32 v[96:97], v[96:97], s[60:61], v[4:5] op_sel_hi:[1,0,0]
    v_pk_fma_f32 v[98:99], v[98:99], s[60:61], v[4:5] op_sel_hi:[1,0,0]
    v_pk_mul_f32 v[92:93], v[92:93], v[236:237]
    v_pk_mul_f32 v[94:95], v[94:95], v[238:239]
    v_pk_mul_f32 v[96:97], v[96:97], v[240:241]
    v_pk_mul_f32 v[98:99], v[98:99], v[242:243]
    v_exp_f32 v92, v92
    v_exp_f32 v93, v93
    v_exp_f32 v94, v94
    v_exp_f32 v95, v95
    v_exp_f32 v96, v96
    v_exp_f32 v97, v97
    s_branch L_skip_6
L_stub_6:
    s_branch L_stub_7
L_skip_6:
    v_exp_f32 v98, v98
    v_exp_f32 v99, v99
    v_pk_add_f32 v[92:93], v[92:93], 1.0 op_sel_hi:[1,0]
    v_pk_add_f32 v[94:95], v[94:95], 1.0 op_sel_hi:[1,0]
    v_pk_add_f32 v[96:97], v[96:97], 1.0 op_sel_hi:[1,0]
    v_pk_add_f32 v[98:99], v[98:99], 1.0 op_sel_hi:[1,0]
    v_rcp_f32 v92, v92
    v_rcp_f32 v93, v93
    v_rcp_f32 v94, v94
    v_rcp_f32 v95, v95
    v_rcp_f32 v96, v96
    v_rcp_f32 v97, v97
    v_rcp_f32 v98, v98
    v_rcp_f32 v99, v99
    v_pk_mul_f32 v[92:93], v[92:93], v[236:237]
    v_pk_mul_f32 v[94:95], v[94:95], v[238:239]
    v_pk_mul_f32 v[96:97], v[96:97], v[240:241]
    v_pk_mul_f32 v[98:99], v[98:99], v[242:243]
    v_cvt_pk_bf16_f32 v76, v92, v93
    v_cvt_pk_bf16_f32 v77, v94, v95
    v_cvt_pk_bf16_f32 v78, v96, v97
    v_cvt_pk_bf16_f32 v79, v98, v99
    buffer_store_dwordx4 v[76:79], v22, s[36:39], s48 offen offset:1024 sc1
    v_pk_mul_f32 v[100:101], v[244:245], v[244:245]
    v_pk_mul_f32 v[102:103], v[246:247], v[246:247]
    v_pk_mul_f32 v[104:105], v[248:249], v[248:249]
    v_pk_mul_f32 v[106:107], v[250:251], v[250:251]
    v_pk_fma_f32 v[100:101], v[100:101], s[60:61], v[4:5] op_sel_hi:[1,0,0]
    v_pk_fma_f32 v[102:103], v[102:103], s[60:61], v[4:5] op_sel_hi:[1,0,0]
    v_pk_fma_f32 v[104:105], v[104:105], s[60:61], v[4:5] op_sel_hi:[1,0,0]
    v_pk_fma_f32 v[106:107], v[106:107], s[60:61], v[4:5] op_sel_hi:[1,0,0]
    v_pk_mul_f32 v[100:101], v[100:101], v[244:245]
    v_pk_mul_f32 v[102:103], v[102:103], v[246:247]
    v_pk_mul_f32 v[104:105], v[104:105], v[248:249]
    v_pk_mul_f32 v[106:107], v[106:107], v[250:251]
    v_exp_f32 v100, v100
    v_exp_f32 v101, v101
    v_exp_f32 v102, v102
    v_exp_f32 v103, v103
    v_exp_f32 v104, v104
    v_exp_f32 v105, v105
    v_exp_f32 v106, v106
    v_exp_f32 v107, v107
    v_pk_add_f32 v[100:101], v[100:101], 1.0 op_sel_hi:[1,0]
    v_pk_add_f32 v[102:103], v[102:103], 1.0 op_sel_hi:[1,0]
    v_pk_add_f32 v[104:105], v[104:105], 1.0 op_sel_hi:[1,0]
    v_pk_add_f32 v[106:107], v[106:107], 1.0 op_sel_hi:[1,0]
    v_rcp_f32 v100, v100
    v_rcp_f32 v101, v101
    v_rcp_f32 v102, v102
    v_rcp_f32 v103, v103
    v_rcp_f32 v104, v104
    v_rcp_f32 v105, v105
    v_rcp_f32 v106, v106
    v_rcp_f32 v107, v107
    v_pk_mul_f32 v[100:101], v[100:101], v[244:245]
    v_pk_mul_f32 v[102:103], v[102:103], v[246:247]
    v_pk_mul_f32 v[104:105], v[104:105], v[248:249]
    v_pk_mul_f32 v[106:107], v[106:107], v[250:251]
    v_cvt_pk_bf16_f32 v80, v100, v101
    v_cvt_pk_bf16_f32 v81, v102, v103
    v_cvt_pk_bf16_f32 v82, v104, v105
    v_cvt_pk_bf16_f32 v83, v106, v107
    buffer_store_dwordx4 v[80:83], v22, s[36:39], s48 offen offset:1280 sc1
    s_branch L_m_22
L_m_21:
    s_waitcnt vmcnt(0)
    s_barrier
    s_mov_b32 s40, s16
    s_mov_b32 s41, s17
    s_mov_b32 s42, 18874368
    s_mov_b32 s43, 0x20000
    s_mov_b32 s44, s20
    s_mov_b32 s45, s21
    s_mov_b32 s46, 18874368
    s_mov_b32 s47, 0x20000
    s_mul_i32 s56, s3, 5
    s_add_u32 s56, s56, s5
    s_sub_u32 s56, s56, 27
    s_add_u32 s57, s56, 116
    s_add_u32 s56, s56, 108
L_m_23:
    s_cmp_ge_u32 s57, 320
    s_cbranch_scc1 L_m_24
    s_mul_i32 s48, s57, 820
    s_lshr_b32 s48, s48, 13
    s_mul_i32 s49, s48, 10
    s_sub_u32 s49, s57, s49
    s_lshl_b32 s49, s49, 6
    v_add_u32 v10, s49, v0
    s_and_b32 s49, s4, 7
    s_mul_i32 s49, s49, 4
    s_add_u32 s48, s48, s49
    s_add_u32 s48, s48, 26
    s_and_b32 s48, s48, 31
    s_mul_i32 s48, s48, 73728
    s_mul_i32 s49, s4, 1152
    s_and_b32 s49, s49, -256
    s_add_u32 s48, s48, s49
    v_mul_u32_u24 v11, 820, v10
    v_lshrrev_b32 v11, 13, v11
    v_mul_u32_u24 v12, 10, v11
    v_sub_u32 v12, v10, v12
    v_and_b32 v10, 7, v11
    v_lshrrev_b32 v11, 3, v11
    v_lshl_add_u32 v10, v10, 8, v11
    v_mul_u32_u24 v10, 9216, v10
    v_lshl_add_u32 v10, v12, 7, v10
    buffer_load_dword v13, v10, s[40:43], s48 offen
    s_add_u32 s57, s57, 20
    s_branch L_m_23
L_m_24:
    v_lshrrev_b32 v14, 4, v0
    v_and_b32 v15, 15, v0
    v_lshlrev_b32 v14, 12, v14
    v_lshl_add_u32 v14, v15, 7, v14
    s_lshr_b32 s48, s4, 1
    s_mul_i32 s48, s48, 4718592
    s_and_b32 s49, s4, 1
    s_lshl_b32 s49, s49, 11
    s_add_u32 s48, s48, s49
    v_add_u32 v14, s48, v14
    s_mov_b32 s50, 0
L_m_25:
    s_cmp_ge_u32 s56, 192
    s_cbranch_scc1 L_m_26
    s_add_u32 s48, s56, s50
    s_cmp_ge_u32 s48, 288
    s_cselect_b32 s49, 288, 0
    s_sub_u32 s48, s48, s49
    s_lshl_b32 s48, s48, 14
    buffer_load_dword v17, v14, s[44:47], s48 offen
    s_add_u32 s56, s56, 20
    s_branch L_m_25
L_m_26:
    s_waitcnt vmcnt(0)
    s_waitcnt vmcnt(0)
    s_barrier
    s_branch L_skip_7
L_stub_7:
    s_branch L_back_c2
L_skip_7:
L_m_22:
    s_lshr_b32 s58, s53, 1
    v_lshrrev_b32 v10, 2, v0
    v_and_b32 v11, 7, v10
    s_lshl_b32 s59, s3, 1
    s_add_u32 s59, s59, s58
    v_xor_b32 v11, s59, v11
    v_xor_b32 v12, 1, v11
    v_and_b32 v13, 3, v0
    v_lshlrev_b32 v13, 3, v13
    v_lshl_add_u32 v10, v10, 8, v13
    v_lshl_add_u32 v20, v11, 5, v10
    v_lshl_add_u32 v21, v12, 5, v10
    s_barrier
    v_add_u32 v24, 0, v20
    v_add_u32 v25, 0, v21
    ds_read_b64_tr_b16 v[92:93], v24 offset:32768
    ds_read_b64_tr_b16 v[94:95], v24 offset:36864
    ds_read_b64_tr_b16 v[96:97], v25 offset:32768
    ds_read_b64_tr_b16 v[98:99], v25 offset:36864
    ds_read_b64_tr_b16 v[100:101], v24 offset:40960
    ds_read_b64_tr_b16 v[102:103], v24 offset:45056
    ds_read_b64_tr_b16 v[104:105], v25 offset:40960
    ds_read_b64_tr_b16 v[106:107], v25 offset:45056
    ds_read_b64_tr_b16 v[156:157], v24 offset:0
    ds_read_b64_tr_b16 v[158:159], v24 offset:4096
    ds_read_b64_tr_b16 v[160:161], v25 offset:0
    ds_read_b64_tr_b16 v[162:163], v25 offset:4096
    ds_read_b64_tr_b16 v[164:165], v24 offset:8192
    ds_read_b64_tr_b16 v[166:167], v24 offset:12288
    ds_read_b64_tr_b16 v[168:169], v25 offset:8192
    ds_read_b64_tr_b16 v[170:171], v25 offset:12288
    ds_read_b64_tr_b16 v[172:173], v24 offset:16384
    ds_read_b64_tr_b16 v[174:175], v24 offset:20480
    ds_read_b64_tr_b16 v[176:177], v25 offset:16384
    ds_read_b64_tr_b16 v[178:179], v25 offset:20480
    ds_read_b64_tr_b16 v[180:181], v24 offset:24576
    ds_read_b64_tr_b16 v[182:183], v24 offset:28672
    ds_read_b64_tr_b16 v[184:185], v25 offset:24576
    ds_read_b64_tr_b16 v[186:187], v25 offset:28672
    v_add_u32 v24, 49152, v20
    v_add_u32 v25, 49152, v21
    ds_read_b64_tr_b16 v[108:109], v24 offset:0
    ds_read_b64_tr_b16 v[110:111], v24 offset:4096
    ds_read_b64_tr_b16 v[112:113], v25 offset:0
    ds_read_b64_tr_b16 v[114:115], v25 offset:4096
    ds_read_b64_tr_b16 v[116:117], v24 offset:8192
    ds_read_b64_tr_b16 v[118:119], v24 offset:12288
    ds_read_b64_tr_b16 v[120:121], v25 offset:8192
    ds_read_b64_tr_b16 v[122:123], v25 offset:12288
    ds_read_b64_tr_b16 v[124:125], v24 offset:16384
    ds_read_b64_tr_b16 v[126:127], v24 offset:20480
    ds_read_b64_tr_b16 v[128:129], v25 offset:16384
    ds_read_b64_tr_b16 v[130:131], v25 offset:20480
    ds_read_b64_tr_b16 v[132:133], v24 offset:24576
    ds_read_b64_tr_b16 v[134:135], v24 offset:28672
    ds_read_b64_tr_b16 v[136:137], v25 offset:24576
    ds_read_b64_tr_b16 v[138:139], v25 offset:28672
    ds_read_b64_tr_b16 v[140:141], v24 offset:32768
    ds_read_b64_tr_b16 v[142:143], v24 offset:36864
    ds_read_b64_tr_b16 v[144:145], v25 offset:32768
    ds_read_b64_tr_b16 v[146:147], v25 offset:36864
    ds_read_b64_tr_b16 v[148:149], v24 offset:40960
    ds_read_b64_tr_b16 v[150:151], v24 offset:45056
    ds_read_b64_tr_b16 v[152:153], v25 offset:40960
    ds_read_b64_tr_b16 v[154:155], v25 offset:45056
    s_waitcnt lgkmcnt(0)
    s_barrier
    s_waitcnt vmcnt(0)
    s_barrier
    s_and_b32 s58, s53, 1
    s_mul_i32 s48, s58, 1280
    s_sub_u32 s49, 1280, s48
    v_mul_u32_u24 v10, 2304, v2
    v_add_u32 v10, 90112, v10
    v_lshl_add_u32 v12, v1, 4, v10
    v_add_u32 v18, s48, v12
    v_add_u32 v22, s49, v12
    s_lshl_b32 s48, s58, 3
    v_xor_b32 v11, s48, v1
    v_lshl_add_u32 v19, v11, 4, v10
    v_add_u32 v19, 1024, v19
    v_lshlrev_b32 v9, 4, v0
    v_lshlrev_b32 v8, 16, v8
    v_cmp_gt_u32 vcc, 32, v0
    s_nop 1
    v_cndmask_b32 v10, 0, v8, vcc
    v_mov_b32 v188, v8
    v_mov_b32 v189, v8
    v_mov_b32 v190, v8
    v_mov_b32 v191, v8
    v_mov_b64 v[192:193], 0
    v_mov_b64 v[194:195], 0
    v_mov_b32 v196, v8
    v_mov_b32 v197, v8
    v_mov_b32 v198, v8
    v_mov_b32 v199, v8
    v_mov_b64 v[200:201], 0
    v_mov_b64 v[202:203], 0
    v_mov_b32 v204, v8
    v_mov_b32 v205, v8
    v_mov_b32 v206, v8
    v_mov_b32 v207, v8
    v_mov_b64 v[208:209], 0
    v_mov_b64 v[210:211], 0
    v_mov_b32 v212, v8
    v_mov_b32 v213, v8
    v_mov_b32 v214, v8
    v_mov_b32 v215, v8
    v_mov_b64 v[216:217], 0
    v_mov_b64 v[218:219], 0
    v_mov_b32 v220, v10
    v_mov_b32 v221, v10
    v_mov_b32 v222, v10
    v_mov_b32 v223, v10
    v_mov_b64 v[224:225], 0
    v_mov_b64 v[226:227], 0
    v_mov_b64 v[228:229], 0
    v_mov_b64 v[230:231], 0
    v_mov_b64 v[232:233], 0
    v_mov_b64 v[234:235], 0
    v_mov_b64 v[236:237], 0
    v_mov_b64 v[238:239], 0
    v_mov_b64 v[240:241], 0
    v_mov_b64 v[242:243], 0
    v_mov_b64 v[244:245], 0
    v_mov_b64 v[246:247], 0
    v_mov_b64 v[248:249], 0
    v_mov_b64 v[250:251], 0
    v_mov_b64 v[252:253], 0
    v_mov_b64 v[254:255], 0
    v_mov_b64 v[64:65], 0
    v_mov_b64 v[66:67], 0
    s_mov_b32 s44, s28
    s_mov_b32 s45, s29
    s_mov_b32 s46, 2359296
    s_mov_b32 s47, 0x20000
    s_mul_i32 s48, s3, 2304
    s_add_u32 s48, s48, 32768
    v_mul_u32_u24 v10, 144, v1
    v_lshl_add_u32 v10, v2, 3, v10
    v_add_u32 v10, s48, v10
    v_add_u32 v7, s48, v9
    s_lshl_b32 s49, s58, 4
    v_add_u32 v4, s49, v10
    s_lshl_b32 s49, s58, 7
    s_sub_u32 s49, 128, s49
    v_add_u32 v10, s49, v10
    v_cmp_gt_u32 vcc, 32, v0
    v_mov_b32 v11, 82432
    s_nop 0
    v_cndmask_b32 v5, v11, v10, vcc
    v_lshlrev_b32 v10, 4, v2
    v_add_u32 v10, 81920, v10
    s_lshl_b32 s49, s58, 5
    v_add_u32 v6, s49, v10
    s_lshl_b32 s49, s58, 8
    s_sub_u32 s49, 256, s49
    v_add_u32 v23, s49, v10
    s_lshl_b32 s48, s59, 4
    s_lshl_b32 s49, s54, 7
    s_add_u32 s48, s48, s49
    s_mul_i32 s48, s48, 1152
    s_mul_i32 s49, s55, 288
    s_add_u32 s62, s48, s49
    s_mul_i32 s49, s58, 144
    s_add_u32 s62, s62, s49
    v_add_u32 v10, 0, v0
    v_mul_u32_u24 v11, 911, v10
    v_lshrrev_b32 v11, 13, v11
    v_mul_u32_u24 v11, 1008, v11
    v_lshl_add_u32 v68, v10, 4, v11
    v_add_u32 v10, 64, v0
    v_mul_u32_u24 v11, 911, v10
    v_lshrrev_b32 v11, 13, v11
    v_mul_u32_u24 v11, 1008, v11
    v_lshl_add_u32 v69, v10, 4, v11
    v_add_u32 v10, 128, v0
    v_mul_u32_u24 v11, 911, v10
    v_lshrrev_b32 v11, 13, v11
    v_mul_u32_u24 v11, 1008, v11
    v_lshl_add_u32 v70, v10, 4, v11
    v_cmp_gt_u32 vcc, 16, v0
    v_mov_b32 v11, 2146435072
    s_nop 0
    v_cndmask_b32 v70, v11, v70, vcc
    s_mul_i32 s48, s3, 2304
    s_add_u32 s48, s48, 27262976
    s_mul_i32 s64, s2, 27648
    s_add_u32 s64, s64, s48
    v_and_b32 v10, 3, v0
    v_cmp_eq_u32 vcc, 0, v10
    v_lshlrev_b32 v27, 2, v0
    s_nop 0
    v_cndmask_b32 v26, v11, v27, vcc
    s_mul_i32 s49, s3, 4608
    s_add_u32 s49, s49, 49152
    v_add_u32 v71, s49, v9
    v_add_u32 v72, 73728, v18
    v_add_u32 v75, 73728, v19
    v_add_u32 v74, 73728, v22
    s_xor_b32 s65, s2, 2
    s_mul_i32 s65, s65, 27648
    s_add_u32 s65, s65, s48
    s_add_u32 s65, s65, 0
    s_xor_b32 s66, s2, 4
    s_mul_i32 s66, s66, 27648
    s_add_u32 s66, s66, s48
    s_add_u32 s66, s66, 9216
    s_xor_b32 s67, s2, 6
    s_mul_i32 s67, s67, 27648
    s_add_u32 s67, s67, s48
    s_add_u32 s67, s67, 18432
    s_branch L_stub_8
L_back_c3:
    v_add_u32 v24, 49152, v20
    v_add_u32 v25, 49152, v21
    s_barrier
    ds_read_b64_tr_b16 v[80:81], v21 offset:0
    ds_read_b64_tr_b16 v[82:83], v21 offset:4096
    ds_read_b64_tr_b16 v[76:77], v20 offset:0
    ds_read_b64_tr_b16 v[78:79], v20 offset:4096
    ds_read_b128 v[28:31], v18 offset:0
    ds_read_b128 v[32:35], v18 offset:256
    ds_read_b128 v[36:39], v18 offset:512
    ds_read_b128 v[40:43], v18 offset:768
    ds_read_b128 v[44:47], v19 offset:0
    ds_read_b128 v[48:51], v22 offset:0
    ds_read_b128 v[52:55], v22 offset:256
    ds_read_b128 v[56:59], v22 offset:512
    ds_read_b128 v[60:63], v22 offset:768
    s_waitcnt lgkmcnt(6)
    v_mfma_f32_16x16x32_bf16 v[192:195], v[28:31], v[80:83], v[192:195]
    ds_read_b64_tr_b16 v[88:89], v21 offset:8192
    v_mfma_f32_16x16x32_bf16 v[188:191], v[28:31], v[76:79], v[188:191]
    ds_read_b128 v[28:31], v18 offset:9216
    v_mfma_f32_16x16x32_bf16 v[200:203], v[32:35], v[80:83], v[200:203]
    ds_read_b64_tr_b16 v[90:91], v21 offset:12288
    v_mfma_f32_16x16x32_bf16 v[196:199], v[32:35], v[76:79], v[196:199]
    ds_read_b128 v[32:35], v18 offset:9472
    v_mfma_f32_16x16x32_bf16 v[208:211], v[36:39], v[80:83], v[208:211]
    ds_read_b64_tr_b16 v[84:85], v20 offset:8192
    v_mfma_f32_16x16x32_bf16 v[204:207], v[36:39], v[76:79], v[204:207]
    ds_read_b128 v[36:39], v18 offset:9728
    s_waitcnt lgkmcnt(9)
    v_mfma_f32_16x16x32_bf16 v[216:219], v[40:43], v[80:83], v[216:219]
    ds_read_b64_tr_b16 v[86:87], v20 offset:12288
    v_mfma_f32_16x16x32_bf16 v[212:215], v[40:43], v[76:79], v[212:215]
    ds_read_b128 v[40:43], v18 offset:9984
    v_mfma_f32_16x16x32_bf16 v[224:227], v[44:47], v[80:83], v[224:227]
    v_mfma_f32_16x16x32_bf16 v[220:223], v[44:47], v[76:79], v[220:223]
    ds_read_b128 v[44:47], v19 offset:9216
    v_mfma_f32_16x16x32_bf16 v[232:235], v[48:51], v[80:83], v[232:235]
    v_mfma_f32_16x16x32_bf16 v[228:231], v[48:51], v[76:79], v[228:231]
    ds_read_b128 v[48:51], v22 offset:9216
    s_waitcnt lgkmcnt(10)
    v_mfma_f32_16x16x32_bf16 v[240:243], v[52:55], v[80:83], v[240:243]
    v_mfma_f32_16x16x32_bf16 v[236:239], v[52:55], v[76:79], v[236:239]
    ds_read_b128 v[52:55], v22 offset:9472
    v_mfma_f32_16x16x32_bf16 v[248:251], v[56:59], v[80:83], v[248:251]
    v_mfma_f32_16x16x32_bf16 v[244:247], v[56:59], v[76:79], v[244:247]
    ds_read_b128 v[56:59], v22 offset:9728
    v_mfma_f32_16x16x32_bf16 v[64:67], v[60:63], v[80:83], v[64:67]
    v_mfma_f32_16x16x32_bf16 v[252:255], v[60:63], v[76:79], v[252:255]
    ds_read_b128 v[60:63], v22 offset:9984
    s_waitcnt lgkmcnt(6)
    v_mfma_f32_16x16x32_bf16 v[192:195], v[28:31], v[88:91], v[192:195]
    s_barrier
    ds_read_b64_tr_b16 v[80:81], v21 offset:16384
    v_mfma_f32_16x16x32_bf16 v[188:191], v[28:31], v[84:87], v[188:191]
    ds_read_b128 v[28:31], v18 offset:18432
    v_mfma_f32_16x16x32_bf16 v[200:203], v[32:35], v[88:91], v[200:203]
    ds_read_b64_tr_b16 v[82:83], v21 offset:20480
    v_mfma_f32_16x16x32_bf16 v[196:199], v[32:35], v[84:87], v[196:199]
    ds_read_b128 v[32:35], v18 offset:18688
    v_mfma_f32_16x16x32_bf16 v[208:211], v[36:39], v[88:91], v[208:211]
    ds_read_b64_tr_b16 v[76:77], v20 offset:16384
    v_mfma_f32_16x16x32_bf16 v[204:207], v[36:39], v[84:87], v[204:207]
    ds_read_b128 v[36:39], v18 offset:18944
    s_waitcnt lgkmcnt(9)
    v_mfma_f32_16x16x32_bf16 v[216:219], v[40:43], v[88:91], v[216:219]
    ds_read_b64_tr_b16 v[78:79], v20 offset:20480
    v_mfma_f32_16x16x32_bf16 v[212:215], v[40:43], v[84:87], v[212:215]
    ds_read_b128 v[40:43], v18 offset:19200
    v_mfma_f32_16x16x32_bf16 v[224:227], v[44:47], v[88:91], v[224:227]
    v_mfma_f32_16x16x32_bf16 v[220:223], v[44:47], v[84:87], v[220:223]
    ds_read_b128 v[44:47], v19 offset:18432
    v_mfma_f32_16x16x32_bf16 v[232:235], v[48:51], v[88:91], v[232:235]
    v_mfma_f32_16x16x32_bf16 v[228:231], v[48:51], v[84:87], v[228:231]
    ds_read_b128 v[48:51], v22 offset:18432
    s_waitcnt lgkmcnt(10)
    v_mfma_f32_16x16x32_bf16 v[240:243], v[52:55], v[88:91], v[240:243]
    v_mfma_f32_16x16x32_bf16 v[236:239], v[52:55], v[84:87], v[236:239]
    ds_read_b128 v[52:55], v22 offset:18688
    v_mfma_f32_16x16x32_bf16 v[248:251], v[56:59], v[88:91], v[248:251]
    v_mfma_f32_16x16x32_bf16 v[244:247], v[56:59], v[84:87], v[244:247]
    ds_read_b128 v[56:59], v22 offset:18944
    v_mfma_f32_16x16x32_bf16 v[64:67], v[60:63], v[88:91], v[64:67]
    v_mfma_f32_16x16x32_bf16 v[252:255], v[60:63], v[84:87], v[252:255]
    ds_read_b128 v[60:63], v22 offset:19200
    s_waitcnt lgkmcnt(6)
    v_mfma_f32_16x16x32_bf16 v[192:195], v[28:31], v[80:83], v[192:195]
    ds_read_b64_tr_b16 v[88:89], v21 offset:24576
    v_mfma_f32_16x16x32_bf16 v[188:191], v[28:31], v[76:79], v[188:191]
    ds_read_b128 v[28:31], v18 offset:27648
    v_mfma_f32_16x16x32_bf16 v[200:203], v[32:35], v[80:83], v[200:203]
    ds_read_b64_tr_b16 v[90:91], v21 offset:28672
    v_mfma_f32_16x16x32_bf16 v[196:199], v[32:35], v[76:79], v[196:199]
    ds_read_b128 v[32:35], v18 offset:27904
    v_mfma_f32_16x16x32_bf16 v[208:211], v[36:39], v[80:83], v[208:211]
    ds_read_b64_tr_b16 v[84:85], v20 offset:24576
    v_mfma_f32_16x16x32_bf16 v[204:207], v[36:39], v[76:79], v[204:207]
    ds_read_b128 v[36:39], v18 offset:28160
    s_waitcnt lgkmcnt(9)
    v_mfma_f32_16x16x32_bf16 v[216:219], v[40:43], v[80:83], v[216:219]
    ds_read_b64_tr_b16 v[86:87], v20 offset:28672
    v_mfma_f32_16x16x32_bf16 v[212:215], v[40:43], v[76:79], v[212:215]
    ds_read_b128 v[40:43], v18 offset:28416
    v_mfma_f32_16x16x32_bf16 v[224:227], v[44:47], v[80:83], v[224:227]
    v_mfma_f32_16x16x32_bf16 v[220:223], v[44:47], v[76:79], v[220:223]
    ds_read_b128 v[44:47], v19 offset:27648
    v_mfma_f32_16x16x32_bf16 v[232:235], v[48:51], v[80:83], v[232:235]
    v_mfma_f32_16x16x32_bf16 v[228:231], v[48:51], v[76:79], v[228:231]
    ds_read_b128 v[48:51], v22 offset:27648
    s_waitcnt lgkmcnt(10)
    v_mfma_f32_16x16x32_bf16 v[240:243], v[52:55], v[80:83], v[240:243]
    v_mfma_f32_16x16x32_bf16 v[236:239], v[52:55], v[76:79], v[236:239]
    ds_read_b128 v[52:55], v22 offset:27904
    v_mfma_f32_16x16x32_bf16 v[248:251], v[56:59], v[80:83], v[248:251]
    v_mfma_f32_16x16x32_bf16 v[244:247], v[56:59], v[76:79], v[244:247]
    ds_read_b128 v[56:59], v22 offset:28160
    v_mfma_f32_16x16x32_bf16 v[64:67], v[60:63], v[80:83], v[64:67]
    v_mfma_f32_16x16x32_bf16 v[252:255], v[60:63], v[76:79], v[252:255]
    ds_read_b128 v[60:63], v22 offset:28416
    s_waitcnt lgkmcnt(6)
    v_mfma_f32_16x16x32_bf16 v[192:195], v[28:31], v[88:91], v[192:195]
    s_barrier
    ds_read_b64_tr_b16 v[80:81], v21 offset:32768
    v_mfma_f32_16x16x32_bf16 v[188:191], v[28:31], v[84:87], v[188:191]
    ds_read_b128 v[28:31], v18 offset:36864
    v_mfma_f32_16x16x32_bf16 v[200:203], v[32:35], v[88:91], v[200:203]
    ds_read_b64_tr_b16 v[82:83], v21 offset:36864
    v_mfma_f32_16x16x32_bf16 v[196:199], v[32:35], v[84:87], v[196:199]
    ds_read_b128 v[32:35], v18 offset:37120
    v_mfma_f32_16x16x32_bf16 v[208:211], v[36:39], v[88:91], v[208:211]
    ds_read_b64_tr_b16 v[76:77], v20 offset:32768
    v_mfma_f32_16x16x32_bf16 v[204:207], v[36:39], v[84:87], v[204:207]
    ds_read_b128 v[36:39], v18 offset:37376
    s_waitcnt lgkmcnt(9)
    v_mfma_f32_16x16x32_bf16 v[216:219], v[40:43], v[88:91], v[216:219]
    ds_read_b64_tr_b16 v[78:79], v20 offset:36864
    v_mfma_f32_16x16x32_bf16 v[212:215], v[40:43], v[84:87], v[212:215]
    ds_read_b128 v[40:43], v18 offset:37632
    v_mfma_f32_16x16x32_bf16 v[224:227], v[44:47], v[88:91], v[224:227]
    v_mfma_f32_16x16x32_bf16 v[220:223], v[44:47], v[84:87], v[220:223]
    ds_read_b128 v[44:47], v19 offset:36864
    v_mfma_f32_16x16x32_bf16 v[232:235], v[48:51], v[88:91], v[232:235]
    v_mfma_f32_16x16x32_bf16 v[228:231], v[48:51], v[84:87], v[228:231]
    ds_read_b128 v[48:51], v22 offset:36864
    s_waitcnt lgkmcnt(10)
    v_mfma_f32_16x16x32_bf16 v[240:243], v[52:55], v[88:91], v[240:243]
    v_mfma_f32_16x16x32_bf16 v[236:239], v[52:55], v[84:87], v[236:239]
    ds_read_b128 v[52:55], v22 offset:37120
    v_mfma_f32_16x16x32_bf16 v[248:251], v[56:59], v[88:91], v[248:251]
    v_mfma_f32_16x16x32_bf16 v[244:247], v[56:59], v[84:87], v[244:247]
    ds_read_b128 v[56:59], v22 offset:37376
    v_mfma_f32_16x16x32_bf16 v[64:67], v[60:63], v[88:91], v[64:67]
    v_mfma_f32_16x16x32_bf16 v[252:255], v[60:63], v[84:87], v[252:255]
    ds_read_b128 v[60:63], v22 offset:37632
    s_waitcnt lgkmcnt(6)
    v_mfma_f32_16x16x32_bf16 v[192:195], v[28:31], v[80:83], v[192:195]
    ds_read_b64_tr_b16 v[88:89], v21 offset:40960
    v_mfma_f32_16x16x32_bf16 v[188:191], v[28:31], v[76:79], v[188:191]
    ds_read_b128 v[28:31], v18 offset:46080
    v_mfma_f32_16x16x32_bf16 v[200:203], v[32:35], v[80:83], v[200:203]
    ds_read_b64_tr_b16 v[90:91], v21 offset:45056
    v_mfma_f32_16x16x32_bf16 v[196:199], v[32:35], v[76:79], v[196:199]
    ds_read_b128 v[32:35], v18 offset:46336
    v_mfma_f32_16x16x32_bf16 v[208:211], v[36:39], v[80:83], v[208:211]
    ds_read_b64_tr_b16 v[84:85], v20 offset:40960
    v_mfma_f32_16x16x32_bf16 v[204:207], v[36:39], v[76:79], v[204:207]
    ds_read_b128 v[36:39], v18 offset:46592
    s_waitcnt lgkmcnt(9)
    v_mfma_f32_16x16x32_bf16 v[216:219], v[40:43], v[80:83], v[216:219]
    ds_read_b64_tr_b16 v[86:87], v20 offset:45056
    v_mfma_f32_16x16x32_bf16 v[212:215], v[40:43], v[76:79], v[212:215]
    ds_read_b128 v[40:43], v18 offset:46848
    v_mfma_f32_16x16x32_bf16 v[224:227], v[44:47], v[80:83], v[224:227]
    v_mfma_f32_16x16x32_bf16 v[220:223], v[44:47], v[76:79], v[220:223]
    ds_read_b128 v[44:47], v19 offset:46080
    v_mfma_f32_16x16x32_bf16 v[232:235], v[48:51], v[80:83], v[232:235]
    v_mfma_f32_16x16x32_bf16 v[228:231], v[48:51], v[76:79], v[228:231]
    ds_read_b128 v[48:51], v22 offset:46080
    s_waitcnt lgkmcnt(10)
    v_mfma_f32_16x16x32_bf16 v[240:243], v[52:55], v[80:83], v[240:243]
    v_mfma_f32_16x16x32_bf16 v[236:239], v[52:55], v[76:79], v[236:239]
    ds_read_b128 v[52:55], v22 offset:46336
    v_mfma_f32_16x16x32_bf16 v[248:251], v[56:59], v[80:83], v[248:251]
    v_mfma_f32_16x16x32_bf16 v[244:247], v[56:59], v[76:79], v[244:247]
    ds_read_b128 v[56:59], v22 offset:46592
    v_mfma_f32_16x16x32_bf16 v[64:67], v[60:63], v[80:83], v[64:67]
    v_mfma_f32_16x16x32_bf16 v[252:255], v[60:63], v[76:79], v[252:255]
    ds_read_b128 v[60:63], v22 offset:46848
    s_waitcnt lgkmcnt(6)
    v_mfma_f32_16x16x32_bf16 v[192:195], v[28:31], v[88:91], v[192:195]
    s_barrier
    ds_read_b64_tr_b16 v[80:81], v25 offset:0
    v_mfma_f32_16x16x32_bf16 v[188:191], v[28:31], v[84:87], v[188:191]
    ds_read_b128 v[28:31], v18 offset:55296
    v_mfma_f32_16x16x32_bf16 v[200:203], v[32:35], v[88:91], v[200:203]
    ds_read_b64_tr_b16 v[82:83], v25 offset:4096
    v_mfma_f32_16x16x32_bf16 v[196:199], v[32:35], v[84:87], v[196:199]
    ds_read_b128 v[32:35], v18 offset:55552
    v_mfma_f32_16x16x32_bf16 v[208:211], v[36:39], v[88:91], v[208:211]
    ds_read_b64_tr_b16 v[76:77], v24 offset:0
    v_mfma_f32_16x16x32_bf16 v[204:207], v[36:39], v[84:87], v[204:207]
    ds_read_b128 v[36:39], v18 offset:55808
    s_waitcnt lgkmcnt(9)
    v_mfma_f32_16x16x32_bf16 v[216:219], v[40:43], v[88:91], v[216:219]
    ds_read_b64_tr_b16 v[78:79], v24 offset:4096
    v_mfma_f32_16x16x32_bf16 v[212:215], v[40:43], v[84:87], v[212:215]
    ds_read_b128 v[40:43], v18 offset:56064
    v_mfma_f32_16x16x32_bf16 v[224:227], v[44:47], v[88:91], v[224:227]
    v_mfma_f32_16x16x32_bf16 v[220:223], v[44:47], v[84:87], v[220:223]
    ds_read_b128 v[44:47], v19 offset:55296
    v_mfma_f32_16x16x32_bf16 v[232:235], v[48:51], v[88:91], v[232:235]
    v_mfma_f32_16x16x32_bf16 v[228:231], v[48:51], v[84:87], v[228:231]
    ds_read_b128 v[48:51], v22 offset:55296
    s_waitcnt lgkmcnt(10)
    v_mfma_f32_16x16x32_bf16 v[240:243], v[52:55], v[88:91], v[240:243]
    v_mfma_f32_16x16x32_bf16 v[236:239], v[52:55], v[84:87], v[236:239]
    ds_read_b128 v[52:55], v22 offset:55552
    v_mfma_f32_16x16x32_bf16 v[248:251], v[56:59], v[88:91], v[248:251]
    v_mfma_f32_16x16x32_bf16 v[244:247], v[56:59], v[84:87], v[244:247]
    ds_read_b128 v[56:59], v22 offset:55808
    v_mfma_f32_16x16x32_bf16 v[64:67], v[60:63], v[88:91], v[64:67]
    v_mfma_f32_16x16x32_bf16 v[252:255], v[60:63], v[84:87], v[252:255]
    ds_read_b128 v[60:63], v22 offset:56064
    s_waitcnt lgkmcnt(6)
    v_mfma_f32_16x16x32_bf16 v[192:195], v[28:31], v[80:83], v[192:195]
    ds_read_b64_tr_b16 v[88:89], v25 offset:8192
    v_mfma_f32_16x16x32_bf16 v[188:191], v[28:31], v[76:79], v[188:191]
    ds_read_b128 v[28:31], v18 offset:64512
    v_mfma_f32_16x16x32_bf16 v[200:203], v[32:35], v[80:83], v[200:203]
    ds_read_b64_tr_b16 v[90:91], v25 offset:12288
    v_mfma_f32_16x16x32_bf16 v[196:199], v[32:35], v[76:79], v[196:199]
    ds_read_b128 v[32:35], v18 offset:64768
    v_mfma_f32_16x16x32_bf16 v[208:211], v[36:39], v[80:83], v[208:211]
    ds_read_b64_tr_b16 v[84:85], v24 offset:8192
    v_mfma_f32_16x16x32_bf16 v[204:207], v[36:39], v[76:79], v[204:207]
    ds_read_b128 v[36:39], v18 offset:65024
    s_waitcnt lgkmcnt(9)
    v_mfma_f32_16x16x32_bf16 v[216:219], v[40:43], v[80:83], v[216:219]
    ds_read_b64_tr_b16 v[86:87], v24 offset:12288
    v_mfma_f32_16x16x32_bf16 v[212:215], v[40:43], v[76:79], v[212:215]
    ds_read_b128 v[40:43], v18 offset:65280
    v_mfma_f32_16x16x32_bf16 v[224:227], v[44:47], v[80:83], v[224:227]
    v_mfma_f32_16x16x32_bf16 v[220:223], v[44:47], v[76:79], v[220:223]
    ds_read_b128 v[44:47], v19 offset:64512
    v_mfma_f32_16x16x32_bf16 v[232:235], v[48:51], v[80:83], v[232:235]
    v_mfma_f32_16x16x32_bf16 v[228:231], v[48:51], v[76:79], v[228:231]
    ds_read_b128 v[48:51], v22 offset:64512
    s_waitcnt lgkmcnt(10)
    v_mfma_f32_16x16x32_bf16 v[240:243], v[52:55], v[80:83], v[240:243]
    v_mfma_f32_16x16x32_bf16 v[236:239], v[52:55], v[76:79], v[236:239]
    ds_read_b128 v[52:55], v22 offset:64768
    v_mfma_f32_16x16x32_bf16 v[248:251], v[56:59], v[80:83], v[248:251]
    v_mfma_f32_16x16x32_bf16 v[244:247], v[56:59], v[76:79], v[244:247]
    ds_read_b128 v[56:59], v22 offset:65024
    v_mfma_f32_16x16x32_bf16 v[64:67], v[60:63], v[80:83], v[64:67]
    v_mfma_f32_16x16x32_bf16 v[252:255], v[60:63], v[76:79], v[252:255]
    ds_read_b128 v[60:63], v22 offset:65280
    s_waitcnt lgkmcnt(6)
    v_mfma_f32_16x16x32_bf16 v[192:195], v[28:31], v[88:91], v[192:195]
    s_barrier
    v_mfma_f32_16x16x32_bf16 v[188:191], v[28:31], v[84:87], v[188:191]
    ds_read_b128 v[28:31], v18 offset:0
    v_mfma_f32_16x16x32_bf16 v[200:203], v[32:35], v[88:91], v[200:203]
    v_mfma_f32_16x16x32_bf16 v[196:199], v[32:35], v[84:87], v[196:199]
    ds_read_b128 v[32:35], v18 offset:256
    v_mfma_f32_16x16x32_bf16 v[208:211], v[36:39], v[88:91], v[208:211]
    v_mfma_f32_16x16x32_bf16 v[204:207], v[36:39], v[84:87], v[204:207]
    ds_read_b128 v[36:39], v18 offset:512
    s_waitcnt lgkmcnt(6)
    v_mfma_f32_16x16x32_bf16 v[216:219], v[40:43], v[88:91], v[216:219]
    v_mfma_f32_16x16x32_bf16 v[212:215], v[40:43], v[84:87], v[212:215]
    ds_read_b128 v[40:43], v18 offset:768
    s_branch L_skip_8
    s_nop 0
L_stub_8:
    s_branch L_stub_9
L_skip_8:
    v_mfma_f32_16x16x32_bf16 v[224:227], v[44:47], v[88:91], v[224:227]
    v_mfma_f32_16x16x32_bf16 v[220:223], v[44:47], v[84:87], v[220:223]
    ds_read_b128 v[44:47], v19 offset:0
    v_mfma_f32_16x16x32_bf16 v[232:235], v[48:51], v[88:91], v[232:235]
    v_mfma_f32_16x16x32_bf16 v[228:231], v[48:51], v[84:87], v[228:231]
    ds_read_b128 v[48:51], v22 offset:0
    s_waitcnt lgkmcnt(6)
    v_mfma_f32_16x16x32_bf16 v[240:243], v[52:55], v[88:91], v[240:243]
    v_mfma_f32_16x16x32_bf16 v[236:239], v[52:55], v[84:87], v[236:239]
    ds_read_b128 v[52:55], v22 offset:256
    v_mfma_f32_16x16x32_bf16 v[248:251], v[56:59], v[88:91], v[248:251]
    v_mfma_f32_16x16x32_bf16 v[244:247], v[56:59], v[84:87], v[244:247]
    ds_read_b128 v[56:59], v22 offset:512
    v_mfma_f32_16x16x32_bf16 v[64:67], v[60:63], v[88:91], v[64:67]
    v_mfma_f32_16x16x32_bf16 v[252:255], v[60:63], v[84:87], v[252:255]
    ds_read_b128 v[60:63], v22 offset:768
    s_waitcnt lgkmcnt(6)
    v_mfma_f32_16x16x32_bf16 v[192:195], v[28:31], v[96:99], v[192:195]
    v_mfma_f32_16x16x32_bf16 v[188:191], v[28:31], v[92:95], v[188:191]
    ds_read_b128 v[28:31], v18 offset:9216
    v_mfma_f32_16x16x32_bf16 v[200:203], v[32:35], v[96:99], v[200:203]
    v_mfma_f32_16x16x32_bf16 v[196:199], v[32:35], v[92:95], v[196:199]
    ds_read_b128 v[32:35], v18 offset:9472
    v_mfma_f32_16x16x32_bf16 v[208:211], v[36:39], v[96:99], v[208:211]
    v_mfma_f32_16x16x32_bf16 v[204:207], v[36:39], v[92:95], v[204:207]
    ds_read_b128 v[36:39], v18 offset:9728
    s_waitcnt lgkmcnt(6)
    v_mfma_f32_16x16x32_bf16 v[216:219], v[40:43], v[96:99], v[216:219]
    v_mfma_f32_16x16x32_bf16 v[212:215], v[40:43], v[92:95], v[212:215]
    ds_read_b128 v[40:43], v18 offset:9984
    v_mfma_f32_16x16x32_bf16 v[224:227], v[44:47], v[96:99], v[224:227]
    v_mfma_f32_16x16x32_bf16 v[220:223], v[44:47], v[92:95], v[220:223]
    ds_read_b128 v[44:47], v19 offset:9216
    v_mfma_f32_16x16x32_bf16 v[232:235], v[48:51], v[96:99], v[232:235]
    v_mfma_f32_16x16x32_bf16 v[228:231], v[48:51], v[92:95], v[228:231]
    ds_read_b128 v[48:51], v22 offset:9216
    s_waitcnt lgkmcnt(6)
    v_mfma_f32_16x16x32_bf16 v[240:243], v[52:55], v[96:99], v[240:243]
    v_mfma_f32_16x16x32_bf16 v[236:239], v[52:55], v[92:95], v[236:239]
    ds_read_b128 v[52:55], v22 offset:9472
    v_mfma_f32_16x16x32_bf16 v[248:251], v[56:59], v[96:99], v[248:251]
    v_mfma_f32_16x16x32_bf16 v[244:247], v[56:59], v[92:95], v[244:247]
    ds_read_b128 v[56:59], v22 offset:9728
    v_mfma_f32_16x16x32_bf16 v[64:67], v[60:63], v[96:99], v[64:67]
    v_mfma_f32_16x16x32_bf16 v[252:255], v[60:63], v[92:95], v[252:255]
    ds_read_b128 v[60:63], v22 offset:9984
    s_waitcnt lgkmcnt(6)
    v_mfma_f32_16x16x32_bf16 v[192:195], v[28:31], v[104:107], v[192:195]
    s_barrier
    ds_read_b64_tr_b16 v[80:81], v25 offset:16384
    v_mfma_f32_16x16x32_bf16 v[188:191], v[28:31], v[100:103], v[188:191]
    ds_read_b128 v[28:31], v18 offset:18432
    v_mfma_f32_16x16x32_bf16 v[200:203], v[32:35], v[104:107], v[200:203]
    ds_read_b64_tr_b16 v[82:83], v25 offset:20480
    v_mfma_f32_16x16x32_bf16 v[196:199], v[32:35], v[100:103], v[196:199]
    ds_read_b128 v[32:35], v18 offset:18688
    v_mfma_f32_16x16x32_bf16 v[208:211], v[36:39], v[104:107], v[208:211]
    ds_read_b64_tr_b16 v[76:77], v24 offset:16384
    v_mfma_f32_16x16x32_bf16 v[204:207], v[36:39], v[100:103], v[204:207]
    ds_read_b128 v[36:39], v18 offset:18944
    s_waitcnt lgkmcnt(9)
    v_mfma_f32_16x16x32_bf16 v[216:219], v[40:43], v[104:107], v[216:219]
    ds_read_b64_tr_b16 v[78:79], v24 offset:20480
    v_mfma_f32_16x16x32_bf16 v[212:215], v[40:43], v[100:103], v[212:215]
    ds_read_b128 v[40:43], v18 offset:19200
    v_mfma_f32_16x16x32_bf16 v[224:227], v[44:47], v[104:107], v[224:227]
    v_mfma_f32_16x16x32_bf16 v[220:223], v[44:47], v[100:103], v[220:223]
    ds_read_b128 v[44:47], v19 offset:18432
    v_mfma_f32_16x16x32_bf16 v[232:235], v[48:51], v[104:107], v[232:235]
    v_mfma_f32_16x16x32_bf16 v[228:231], v[48:51], v[100:103], v[228:231]
    ds_read_b128 v[48:51], v22 offset:18432
    s_waitcnt lgkmcnt(10)
    v_mfma_f32_16x16x32_bf16 v[240:243], v[52:55], v[104:107], v[240:243]
    v_mfma_f32_16x16x32_bf16 v[236:239], v[52:55], v[100:103], v[236:239]
    ds_read_b128 v[52:55], v22 offset:18688
    v_mfma_f32_16x16x32_bf16 v[248:251], v[56:59], v[104:107], v[248:251]
    v_mfma_f32_16x16x32_bf16 v[244:247], v[56:59], v[100:103], v[244:247]
    ds_read_b128 v[56:59], v22 offset:18944
    v_mfma_f32_16x16x32_bf16 v[64:67], v[60:63], v[104:107], v[64:67]
    v_mfma_f32_16x16x32_bf16 v[252:255], v[60:63], v[100:103], v[252:255]
    ds_read_b128 v[60:63], v22 offset:19200
    s_waitcnt lgkmcnt(6)
    v_mfma_f32_16x16x32_bf16 v[192:195], v[28:31], v[80:83], v[192:195]
    ds_read_b64_tr_b16 v[88:89], v25 offset:24576
    v_mfma_f32_16x16x32_bf16 v[188:191], v[28:31], v[76:79], v[188:191]
    ds_read_b128 v[28:31], v18 offset:27648
    v_mfma_f32_16x16x32_bf16 v[200:203], v[32:35], v[80:83], v[200:203]
    ds_read_b64_tr_b16 v[90:91], v25 offset:28672
    v_mfma_f32_16x16x32_bf16 v[196:199], v[32:35], v[76:79], v[196:199]
    ds_read_b128 v[32:35], v18 offset:27904
    v_mfma_f32_16x16x32_bf16 v[208:211], v[36:39], v[80:83], v[208:211]
    ds_read_b64_tr_b16 v[84:85], v24 offset:24576
    v_mfma_f32_16x16x32_bf16 v[204:207], v[36:39], v[76:79], v[204:207]
    ds_read_b128 v[36:39], v18 offset:28160
    s_waitcnt lgkmcnt(9)
    v_mfma_f32_16x16x32_bf16 v[216:219], v[40:43], v[80:83], v[216:219]
    ds_read_b64_tr_b16 v[86:87], v24 offset:28672
    v_mfma_f32_16x16x32_bf16 v[212:215], v[40:43], v[76:79], v[212:215]
    ds_read_b128 v[40:43], v18 offset:28416
    v_mfma_f32_16x16x32_bf16 v[224:227], v[44:47], v[80:83], v[224:227]
    v_mfma_f32_16x16x32_bf16 v[220:223], v[44:47], v[76:79], v[220:223]
    ds_read_b128 v[44:47], v19 offset:27648
    v_mfma_f32_16x16x32_bf16 v[232:235], v[48:51], v[80:83], v[232:235]
    v_mfma_f32_16x16x32_bf16 v[228:231], v[48:51], v[76:79], v[228:231]
    ds_read_b128 v[48:51], v22 offset:27648
    s_waitcnt lgkmcnt(10)
    v_mfma_f32_16x16x32_bf16 v[240:243], v[52:55], v[80:83], v[240:243]
    v_mfma_f32_16x16x32_bf16 v[236:239], v[52:55], v[76:79], v[236:239]
    ds_read_b128 v[52:55], v22 offset:27904
    v_mfma_f32_16x16x32_bf16 v[248:251], v[56:59], v[80:83], v[248:251]
    v_mfma_f32_16x16x32_bf16 v[244:247], v[56:59], v[76:79], v[244:247]
    ds_read_b128 v[56:59], v22 offset:28160
    v_mfma_f32_16x16x32_bf16 v[64:67], v[60:63], v[80:83], v[64:67]
    v_mfma_f32_16x16x32_bf16 v[252:255], v[60:63], v[76:79], v[252:255]
    ds_read_b128 v[60:63], v22 offset:28416
    s_waitcnt lgkmcnt(6)
    v_mfma_f32_16x16x32_bf16 v[192:195], v[28:31], v[88:91], v[192:195]
    s_barrier
    v_mfma_f32_16x16x32_bf16 v[188:191], v[28:31], v[84:87], v[188:191]
    ds_read_b128 v[28:31], v18 offset:36864
    v_mfma_f32_16x16x32_bf16 v[200:203], v[32:35], v[88:91], v[200:203]
    v_mfma_f32_16x16x32_bf16 v[196:199], v[32:35], v[84:87], v[196:199]
    ds_read_b128 v[32:35], v18 offset:37120
    v_mfma_f32_16x16x32_bf16 v[208:211], v[36:39], v[88:91], v[208:211]
    v_mfma_f32_16x16x32_bf16 v[204:207], v[36:39], v[84:87], v[204:207]
    ds_read_b128 v[36:39], v18 offset:37376
    s_waitcnt lgkmcnt(6)
    v_mfma_f32_16x16x32_bf16 v[216:219], v[40:43], v[88:91], v[216:219]
    v_mfma_f32_16x16x32_bf16 v[212:215], v[40:43], v[84:87], v[212:215]
    ds_read_b128 v[40:43], v18 offset:37632
    v_mfma_f32_16x16x32_bf16 v[224:227], v[44:47], v[88:91], v[224:227]
    v_mfma_f32_16x16x32_bf16 v[220:223], v[44:47], v[84:87], v[220:223]
    ds_read_b128 v[44:47], v19 offset:36864
    v_mfma_f32_16x16x32_bf16 v[232:235], v[48:51], v[88:91], v[232:235]
    v_mfma_f32_16x16x32_bf16 v[228:231], v[48:51], v[84:87], v[228:231]
    ds_read_b128 v[48:51], v22 offset:36864
    s_waitcnt lgkmcnt(6)
    v_mfma_f32_16x16x32_bf16 v[240:243], v[52:55], v[88:91], v[240:243]
    v_mfma_f32_16x16x32_bf16 v[236:239], v[52:55], v[84:87], v[236:239]
    ds_read_b128 v[52:55], v22 offset:37120
    v_mfma_f32_16x16x32_bf16 v[248:251], v[56:59], v[88:91], v[248:251]
    v_mfma_f32_16x16x32_bf16 v[244:247], v[56:59], v[84:87], v[244:247]
    ds_read_b128 v[56:59], v22 offset:37376
    v_mfma_f32_16x16x32_bf16 v[64:67], v[60:63], v[88:91], v[64:67]
    v_mfma_f32_16x16x32_bf16 v[252:255], v[60:63], v[84:87], v[252:255]
    ds_read_b128 v[60:63], v22 offset:37632
    s_waitcnt lgkmcnt(6)
    v_mfma_f32_16x16x32_bf16 v[192:195], v[28:31], v[112:115], v[192:195]
    v_mfma_f32_16x16x32_bf16 v[188:191], v[28:31], v[108:111], v[188:191]
    ds_read_b128 v[28:31], v18 offset:46080
    v_mfma_f32_16x16x32_bf16 v[200:203], v[32:35], v[112:115], v[200:203]
    v_mfma_f32_16x16x32_bf16 v[196:199], v[32:35], v[108:111], v[196:199]
    ds_read_b128 v[32:35], v18 offset:46336
    v_mfma_f32_16x16x32_bf16 v[208:211], v[36:39], v[112:115], v[208:211]
    v_mfma_f32_16x16x32_bf16 v[204:207], v[36:39], v[108:111], v[204:207]
    ds_read_b128 v[36:39], v18 offset:46592
    s_waitcnt lgkmcnt(6)
    v_mfma_f32_16x16x32_bf16 v[216:219], v[40:43], v[112:115], v[216:219]
    v_mfma_f32_16x16x32_bf16 v[212:215], v[40:43], v[108:111], v[212:215]
    ds_read_b128 v[40:43], v18 offset:46848
    v_mfma_f32_16x16x32_bf16 v[224:227], v[44:47], v[112:115], v[224:227]
    v_mfma_f32_16x16x32_bf16 v[220:223], v[44:47], v[108:111], v[220:223]
    ds_read_b128 v[44:47], v19 offset:46080
    v_mfma_f32_16x16x32_bf16 v[232:235], v[48:51], v[112:115], v[232:235]
    v_mfma_f32_16x16x32_bf16 v[228:231], v[48:51], v[108:111], v[228:231]
    ds_read_b128 v[48:51], v22 offset:46080
    s_waitcnt lgkmcnt(6)
    v_mfma_f32_16x16x32_bf16 v[240:243], v[52:55], v[112:115], v[240:243]
    v_mfma_f32_16x16x32_bf16 v[236:239], v[52:55], v[108:111], v[236:239]
    ds_read_b128 v[52:55], v22 offset:46336
    v_mfma_f32_16x16x32_bf16 v[248:251], v[56:59], v[112:115], v[248:251]
    v_mfma_f32_16x16x32_bf16 v[244:247], v[56:59], v[108:111], v[244:247]
    ds_read_b128 v[56:59], v22 offset:46592
    v_mfma_f32_16x16x32_bf16 v[64:67], v[60:63], v[112:115], v[64:67]
    v_mfma_f32_16x16x32_bf16 v[252:255], v[60:63], v[108:111], v[252:255]
    ds_read_b128 v[60:63], v22 offset:46848
    s_waitcnt lgkmcnt(6)
    v_mfma_f32_16x16x32_bf16 v[192:195], v[28:31], v[120:123], v[192:195]
    s_barrier
    ds_read_b64_tr_b16 v[80:81], v21 offset:0
    v_mfma_f32_16x16x32_bf16 v[188:191], v[28:31], v[116:119], v[188:191]
    ds_read_b128 v[28:31], v18 offset:55296
    v_mfma_f32_16x16x32_bf16 v[200:203], v[32:35], v[120:123], v[200:203]
    ds_read_b64_tr_b16 v[82:83], v21 offset:4096
    v_mfma_f32_16x16x32_bf16 v[196:199], v[32:35], v[116:119], v[196:199]
    ds_read_b128 v[32:35], v18 offset:55552
    v_mfma_f32_16x16x32_bf16 v[208:211], v[36:39], v[120:123], v[208:211]
    ds_read_b64_tr_b16 v[76:77], v20 offset:0
    v_mfma_f32_16x16x32_bf16 v[204:207], v[36:39], v[116:119], v[204:207]
    ds_read_b128 v[36:39], v18 offset:55808
    s_waitcnt lgkmcnt(9)
    v_mfma_f32_16x16x32_bf16 v[216:219], v[40:43], v[120:123], v[216:219]
    ds_read_b64_tr_b16 v[78:79], v20 offset:4096
    v_mfma_f32_16x16x32_bf16 v[212:215], v[40:43], v[116:119], v[212:215]
    ds_read_b128 v[40:43], v18 offset:56064
    v_mfma_f32_16x16x32_bf16 v[224:227], v[44:47], v[120:123], v[224:227]
    v_mfma_f32_16x16x32_bf16 v[220:223], v[44:47], v[116:119], v[220:223]
    ds_read_b128 v[44:47], v19 offset:55296
    v_mfma_f32_16x16x32_bf16 v[232:235], v[48:51], v[120:123], v[232:235]
    v_mfma_f32_16x16x32_bf16 v[228:231], v[48:51], v[116:119], v[228:231]
    ds_read_b128 v[48:51], v22 offset:55296
    s_waitcnt lgkmcnt(10)
    v_mfma_f32_16x16x32_bf16 v[240:243], v[52:55], v[120:123], v[240:243]
    v_mfma_f32_16x16x32_bf16 v[236:239], v[52:55], v[116:119], v[236:239]
    ds_read_b128 v[52:55], v22 offset:55552
    v_mfma_f32_16x16x32_bf16 v[248:251], v[56:59], v[120:123], v[248:251]
    v_mfma_f32_16x16x32_bf16 v[244:247], v[56:59], v[116:119], v[244:247]
    ds_read_b128 v[56:59], v22 offset:55808
    v_mfma_f32_16x16x32_bf16 v[64:67], v[60:63], v[120:123], v[64:67]
    v_mfma_f32_16x16x32_bf16 v[252:255], v[60:63], v[116:119], v[252:255]
    ds_read_b128 v[60:63], v22 offset:56064
    s_waitcnt lgkmcnt(6)
    v_mfma_f32_16x16x32_bf16 v[192:195], v[28:31], v[80:83], v[192:195]
    ds_read_b64_tr_b16 v[88:89], v21 offset:8192
    v_mfma_f32_16x16x32_bf16 v[188:191], v[28:31], v[76:79], v[188:191]
    ds_read_b128 v[28:31], v18 offset:64512
    v_mfma_f32_16x16x32_bf16 v[200:203], v[32:35], v[80:83], v[200:203]
    ds_read_b64_tr_b16 v[90:91], v21 offset:12288
    v_mfma_f32_16x16x32_bf16 v[196:199], v[32:35], v[76:79], v[196:199]
    ds_read_b128 v[32:35], v18 offset:64768
    v_mfma_f32_16x16x32_bf16 v[208:211], v[36:39], v[80:83], v[208:211]
    ds_read_b64_tr_b16 v[84:85], v20 offset:8192
    v_mfma_f32_16x16x32_bf16 v[204:207], v[36:39], v[76:79], v[204:207]
    ds_read_b128 v[36:39], v18 offset:65024
    s_waitcnt lgkmcnt(9)
    v_mfma_f32_16x16x32_bf16 v[216:219], v[40:43], v[80:83], v[216:219]
    ds_read_b64_tr_b16 v[86:87], v20 offset:12288
    v_mfma_f32_16x16x32_bf16 v[212:215], v[40:43], v[76:79], v[212:215]
    ds_read_b128 v[40:43], v18 offset:65280
    v_mfma_f32_16x16x32_bf16 v[224:227], v[44:47], v[80:83], v[224:227]
    v_mfma_f32_16x16x32_bf16 v[220:223], v[44:47], v[76:79], v[220:223]
    ds_read_b128 v[44:47], v19 offset:64512
    v_mfma_f32_16x16x32_bf16 v[232:235], v[48:51], v[80:83], v[232:235]
    v_mfma_f32_16x16x32_bf16 v[228:231], v[48:51], v[76:79], v[228:231]
    ds_read_b128 v[48:51], v22 offset:64512
    s_waitcnt lgkmcnt(10)
    v_mfma_f32_16x16x32_bf16 v[240:243], v[52:55], v[80:83], v[240:243]
    v_mfma_f32_16x16x32_bf16 v[236:239], v[52:55], v[76:79], v[236:239]
    ds_read_b128 v[52:55], v22 offset:64768
    v_mfma_f32_16x16x32_bf16 v[248:251], v[56:59], v[80:83], v[248:251]
    v_mfma_f32_16x16x32_bf16 v[244:247], v[56:59], v[76:79], v[244:247]
    ds_read_b128 v[56:59], v22 offset:65024
    v_mfma_f32_16x16x32_bf16 v[64:67], v[60:63], v[80:83], v[64:67]
    v_mfma_f32_16x16x32_bf16 v[252:255], v[60:63], v[76:79], v[252:255]
    ds_read_b128 v[60:63], v22 offset:65280
    s_waitcnt lgkmcnt(6)
    v_mfma_f32_16x16x32_bf16 v[192:195], v[28:31], v[88:91], v[192:195]
    s_barrier
    v_mfma_f32_16x16x32_bf16 v[188:191], v[28:31], v[84:87], v[188:191]
    ds_read_b128 v[28:31], v18 offset:0
    v_mfma_f32_16x16x32_bf16 v[200:203], v[32:35], v[88:91], v[200:203]
    v_mfma_f32_16x16x32_bf16 v[196:199], v[32:35], v[84:87], v[196:199]
    ds_read_b128 v[32:35], v18 offset:256
    v_mfma_f32_16x16x32_bf16 v[208:211], v[36:39], v[88:91], v[208:211]
    v_mfma_f32_16x16x32_bf16 v[204:207], v[36:39], v[84:87], v[204:207]
    ds_read_b128 v[36:39], v18 offset:512
    s_waitcnt lgkmcnt(6)
    v_mfma_f32_16x16x32_bf16 v[216:219], v[40:43], v[88:91], v[216:219]
    v_mfma_f32_16x16x32_bf16 v[212:215], v[40:43], v[84:87], v[212:215]
    ds_read_b128 v[40:43], v18 offset:768
    v_mfma_f32_16x16x32_bf16 v[224:227], v[44:47], v[88:91], v[224:227]
    v_mfma_f32_16x16x32_bf16 v[220:223], v[44:47], v[84:87], v[220:223]
    ds_read_b128 v[44:47], v19 offset:0
    v_mfma_f32_16x16x32_bf16 v[232:235], v[48:51], v[88:91], v[232:235]
    v_mfma_f32_16x16x32_bf16 v[228:231], v[48:51], v[84:87], v[228:231]
    ds_read_b128 v[48:51], v22 offset:0
    s_waitcnt lgkmcnt(6)
    v_mfma_f32_16x16x32_bf16 v[240:243], v[52:55], v[88:91], v[240:243]
    v_mfma_f32_16x16x32_bf16 v[236:239], v[52:55], v[84:87], v[236:239]
    ds_read_b128 v[52:55], v22 offset:256
    v_mfma_f32_16x16x32_bf16 v[248:251], v[56:59], v[88:91], v[248:251]
    v_mfma_f32_16x16x32_bf16 v[244:247], v[56:59], v[84:87], v[244:247]
    ds_read_b128 v[56:59], v22 offset:512
    v_mfma_f32_16x16x32_bf16 v[64:67], v[60:63], v[88:91], v[64:67]
    v_mfma_f32_16x16x32_bf16 v[252:255], v[60:63], v[84:87], v[252:255]
    ds_read_b128 v[60:63], v22 offset:768
    s_waitcnt lgkmcnt(6)
    v_mfma_f32_16x16x32_bf16 v[192:195], v[28:31], v[128:131], v[192:195]
    v_mfma_f32_16x16x32_bf16 v[188:191], v[28:31], v[124:127], v[188:191]
    ds_read_b128 v[28:31], v18 offset:9216
    v_mfma_f32_16x16x32_bf16 v[200:203], v[32:35], v[128:131], v[200:203]
    v_mfma_f32_16x16x32_bf16 v[196:199], v[32:35], v[124:127], v[196:199]
    ds_read_b128 v[32:35], v18 offset:9472
    v_mfma_f32_16x16x32_bf16 v[208:211], v[36:39], v[128:131], v[208:211]
    v_mfma_f32_16x16x32_bf16 v[204:207], v[36:39], v[124:127], v[204:207]
    ds_read_b128 v[36:39], v18 offset:9728
    s_waitcnt lgkmcnt(6)
    v_mfma_f32_16x16x32_bf16 v[216:219], v[40:43], v[128:131], v[216:219]
    v_mfma_f32_16x16x32_bf16 v[212:215], v[40:43], v[124:127], v[212:215]
    ds_read_b128 v[40:43], v18 offset:9984
    v_mfma_f32_16x16x32_bf16 v[224:227], v[44:47], v[128:131], v[224:227]
    v_mfma_f32_16x16x32_bf16 v[220:223], v[44:47], v[124:127], v[220:223]
    ds_read_b128 v[44:47], v19 offset:9216
    v_mfma_f32_16x16x32_bf16 v[232:235], v[48:51], v[128:131], v[232:235]
    v_mfma_f32_16x16x32_bf16 v[228:231], v[48:51], v[124:127], v[228:231]
    ds_read_b128 v[48:51], v22 offset:9216
    s_waitcnt lgkmcnt(6)
    v_mfma_f32_16x16x32_bf16 v[240:243], v[52:55], v[128:131], v[240:243]
    v_mfma_f32_16x16x32_bf16 v[236:239], v[52:55], v[124:127], v[236:239]
    ds_read_b128 v[52:55], v22 offset:9472
    v_mfma_f32_16x16x32_bf16 v[248:251], v[56:59], v[128:131], v[248:251]
    v_mfma_f32_16x16x32_bf16 v[244:247], v[56:59], v[124:127], v[244:247]
    ds_read_b128 v[56:59], v22 offset:9728
    v_mfma_f32_16x16x32_bf16 v[64:67], v[60:63], v[128:131], v[64:67]
    v_mfma_f32_16x16x32_bf16 v[252:255], v[60:63], v[124:127], v[252:255]
    ds_read_b128 v[60:63], v22 offset:9984
    s_waitcnt lgkmcnt(6)
    v_mfma_f32_16x16x32_bf16 v[192:195], v[28:31], v[136:139], v[192:195]
    s_barrier
    ds_read_b64_tr_b16 v[80:81], v21 offset:16384
    v_mfma_f32_16x16x32_bf16 v[188:191], v[28:31], v[132:135], v[188:191]
    ds_read_b128 v[28:31], v18 offset:18432
    v_mfma_f32_16x16x32_bf16 v[200:203], v[32:35], v[136:139], v[200:203]
    ds_read_b64_tr_b16 v[82:83], v21 offset:20480
    v_mfma_f32_16x16x32_bf16 v[196:199], v[32:35], v[132:135], v[196:199]
    ds_read_b128 v[32:35], v18 offset:18688
    v_mfma_f32_16x16x32_bf16 v[208:211], v[36:39], v[136:139], v[208:211]
    ds_read_b64_tr_b16 v[76:77], v20 offset:16384
    v_mfma_f32_16x16x32_bf16 v[204:207], v[36:39], v[132:135], v[204:207]
    ds_read_b128 v[36:39], v18 offset:18944
    s_waitcnt lgkmcnt(9)
    v_mfma_f32_16x16x32_bf16 v[216:219], v[40:43], v[136:139], v[216:219]
    ds_read_b64_tr_b16 v[78:79], v20 offset:20480
    v_mfma_f32_16x16x32_bf16 v[212:215], v[40:43], v[132:135], v[212:215]
    ds_read_b128 v[40:43], v18 offset:19200
    v_mfma_f32_16x16x32_bf16 v[224:227], v[44:47], v[136:139], v[224:227]
    v_mfma_f32_16x16x32_bf16 v[220:223], v[44:47], v[132:135], v[220:223]
    ds_read_b128 v[44:47], v19 offset:18432
    v_mfma_f32_16x16x32_bf16 v[232:235], v[48:51], v[136:139], v[232:235]
    v_mfma_f32_16x16x32_bf16 v[228:231], v[48:51], v[132:135], v[228:231]
    ds_read_b128 v[48:51], v22 offset:18432
    s_waitcnt lgkmcnt(10)
    v_mfma_f32_16x16x32_bf16 v[240:243], v[52:55], v[136:139], v[240:243]
    v_mfma_f32_16x16x32_bf16 v[236:239], v[52:55], v[132:135], v[236:239]
    ds_read_b128 v[52:55], v22 offset:18688
    v_mfma_f32_16x16x32_bf16 v[248:251], v[56:59], v[136:139], v[248:251]
    v_mfma_f32_16x16x32_bf16 v[244:247], v[56:59], v[132:135], v[244:247]
    ds_read_b128 v[56:59], v22 offset:18944
    v_mfma_f32_16x16x32_bf16 v[64:67], v[60:63], v[136:139], v[64:67]
    v_mfma_f32_16x16x32_bf16 v[252:255], v[60:63], v[132:135], v[252:255]
    ds_read_b128 v[60:63], v22 offset:19200
    s_waitcnt lgkmcnt(6)
    v_mfma_f32_16x16x32_bf16 v[192:195], v[28:31], v[80:83], v[192:195]
    ds_read_b64_tr_b16 v[88:89], v21 offset:24576
    v_mfma_f32_16x16x32_bf16 v[188:191], v[28:31], v[76:79], v[188:191]
    ds_read_b128 v[28:31], v18 offset:27648
    v_mfma_f32_16x16x32_bf16 v[200:203], v[32:35], v[80:83], v[200:203]
    ds_read_b64_tr_b16 v[90:91], v21 offset:28672
    v_mfma_f32_16x16x32_bf16 v[196:199], v[32:35], v[76:79], v[196:199]
    ds_read_b128 v[32:35], v18 offset:27904
    v_mfma_f32_16x16x32_bf16 v[208:211], v[36:39], v[80:83], v[208:211]
    ds_read_b64_tr_b16 v[84:85], v20 offset:24576
    v_mfma_f32_16x16x32_bf16 v[204:207], v[36:39], v[76:79], v[204:207]
    ds_read_b128 v[36:39], v18 offset:28160
    s_waitcnt lgkmcnt(9)
    v_mfma_f32_16x16x32_bf16 v[216:219], v[40:43], v[80:83], v[216:219]
    ds_read_b64_tr_b16 v[86:87], v20 offset:28672
    v_mfma_f32_16x16x32_bf16 v[212:215], v[40:43], v[76:79], v[212:215]
    ds_read_b128 v[40:43], v18 offset:28416
    v_mfma_f32_16x16x32_bf16 v[224:227], v[44:47], v[80:83], v[224:227]
    v_mfma_f32_16x16x32_bf16 v[220:223], v[44:47], v[76:79], v[220:223]
    ds_read_b128 v[44:47], v19 offset:27648
    v_mfma_f32_16x16x32_bf16 v[232:235], v[48:51], v[80:83], v[232:235]
    v_mfma_f32_16x16x32_bf16 v[228:231], v[48:51], v[76:79], v[228:231]
    ds_read_b128 v[48:51], v22 offset:27648
    s_waitcnt lgkmcnt(10)
    v_mfma_f32_16x16x32_bf16 v[240:243], v[52:55], v[80:83], v[240:243]
    v_mfma_f32_16x16x32_bf16 v[236:239], v[52:55], v[76:79], v[236:239]
    ds_read_b128 v[52:55], v22 offset:27904
    v_mfma_f32_16x16x32_bf16 v[248:251], v[56:59], v[80:83], v[248:251]
    v_mfma_f32_16x16x32_bf16 v[244:247], v[56:59], v[76:79], v[244:247]
    ds_read_b128 v[56:59], v22 offset:28160
    v_mfma_f32_16x16x32_bf16 v[64:67], v[60:63], v[80:83], v[64:67]
    v_mfma_f32_16x16x32_bf16 v[252:255], v[60:63], v[76:79], v[252:255]
    ds_read_b128 v[60:63], v22 offset:28416
    s_waitcnt lgkmcnt(6)
    v_mfma_f32_16x16x32_bf16 v[192:195], v[28:31], v[88:91], v[192:195]
    s_barrier
    v_mfma_f32_16x16x32_bf16 v[188:191], v[28:31], v[84:87], v[188:191]
    ds_read_b128 v[28:31], v18 offset:36864
    v_mfma_f32_16x16x32_bf16 v[200:203], v[32:35], v[88:91], v[200:203]
    v_mfma_f32_16x16x32_bf16 v[196:199], v[32:35], v[84:87], v[196:199]
    ds_read_b128 v[32:35], v18 offset:37120
    v_mfma_f32_16x16x32_bf16 v[208:211], v[36:39], v[88:91], v[208:211]
    v_mfma_f32_16x16x32_bf16 v[204:207], v[36:39], v[84:87], v[204:207]
    ds_read_b128 v[36:39], v18 offset:37376
    s_waitcnt lgkmcnt(6)
    v_mfma_f32_16x16x32_bf16 v[216:219], v[40:43], v[88:91], v[216:219]
    v_mfma_f32_16x16x32_bf16 v[212:215], v[40:43], v[84:87], v[212:215]
    ds_read_b128 v[40:43], v18 offset:37632
    v_mfma_f32_16x16x32_bf16 v[224:227], v[44:47], v[88:91], v[224:227]
    v_mfma_f32_16x16x32_bf16 v[220:223], v[44:47], v[84:87], v[220:223]
    ds_read_b128 v[44:47], v19 offset:36864
    v_mfma_f32_16x16x32_bf16 v[232:235], v[48:51], v[88:91], v[232:235]
    v_mfma_f32_16x16x32_bf16 v[228:231], v[48:51], v[84:87], v[228:231]
    ds_read_b128 v[48:51], v22 offset:36864
    s_waitcnt lgkmcnt(6)
    v_mfma_f32_16x16x32_bf16 v[240:243], v[52:55], v[88:91], v[240:243]
    v_mfma_f32_16x16x32_bf16 v[236:239], v[52:55], v[84:87], v[236:239]
    ds_read_b128 v[52:55], v22 offset:37120
    v_mfma_f32_16x16x32_bf16 v[248:251], v[56:59], v[88:91], v[248:251]
    v_mfma_f32_16x16x32_bf16 v[244:247], v[56:59], v[84:87], v[244:247]
    ds_read_b128 v[56:59], v22 offset:37376
    v_mfma_f32_16x16x32_bf16 v[64:67], v[60:63], v[88:91], v[64:67]
    v_mfma_f32_16x16x32_bf16 v[252:255], v[60:63], v[84:87], v[252:255]
    ds_read_b128 v[60:63], v22 offset:37632
    s_waitcnt lgkmcnt(6)
    v_mfma_f32_16x16x32_bf16 v[192:195], v[28:31], v[144:147], v[192:195]
    v_mfma_f32_16x16x32_bf16 v[188:191], v[28:31], v[140:143], v[188:191]
    ds_read_b128 v[28:31], v18 offset:46080
    v_mfma_f32_16x16x32_bf16 v[200:203], v[32:35], v[144:147], v[200:203]
    v_mfma_f32_16x16x32_bf16 v[196:199], v[32:35], v[140:143], v[196:199]
    ds_read_b128 v[32:35], v18 offset:46336
    v_mfma_f32_16x16x32_bf16 v[208:211], v[36:39], v[144:147], v[208:211]
    v_mfma_f32_16x16x32_bf16 v[204:207], v[36:39], v[140:143], v[204:207]
    ds_read_b128 v[36:39], v18 offset:46592
    s_waitcnt lgkmcnt(6)
    v_mfma_f32_16x16x32_bf16 v[216:219], v[40:43], v[144:147], v[216:219]
    v_mfma_f32_16x16x32_bf16 v[212:215], v[40:43], v[140:143], v[212:215]
    ds_read_b128 v[40:43], v18 offset:46848
    v_mfma_f32_16x16x32_bf16 v[224:227], v[44:47], v[144:147], v[224:227]
    v_mfma_f32_16x16x32_bf16 v[220:223], v[44:47], v[140:143], v[220:223]
    ds_read_b128 v[44:47], v19 offset:46080
    v_mfma_f32_16x16x32_bf16 v[232:235], v[48:51], v[144:147], v[232:235]
    v_mfma_f32_16x16x32_bf16 v[228:231], v[48:51], v[140:143], v[228:231]
    ds_read_b128 v[48:51], v22 offset:46080
    s_waitcnt lgkmcnt(6)
    v_mfma_f32_16x16x32_bf16 v[240:243], v[52:55], v[144:147], v[240:243]
    v_mfma_f32_16x16x32_bf16 v[236:239], v[52:55], v[140:143], v[236:239]
    ds_read_b128 v[52:55], v22 offset:46336
    v_mfma_f32_16x16x32_bf16 v[248:251], v[56:59], v[144:147], v[248:251]
    v_mfma_f32_16x16x32_bf16 v[244:247], v[56:59], v[140:143], v[244:247]
    ds_read_b128 v[56:59], v22 offset:46592
    v_mfma_f32_16x16x32_bf16 v[64:67], v[60:63], v[144:147], v[64:67]
    v_mfma_f32_16x16x32_bf16 v[252:255], v[60:63], v[140:143], v[252:255]
    ds_read_b128 v[60:63], v22 offset:46848
    s_waitcnt lgkmcnt(6)
    v_mfma_f32_16x16x32_bf16 v[192:195], v[28:31], v[152:155], v[192:195]
    s_barrier
    v_mfma_f32_16x16x32_bf16 v[188:191], v[28:31], v[148:151], v[188:191]
    ds_read_b128 v[28:31], v18 offset:55296
    v_mfma_f32_16x16x32_bf16 v[200:203], v[32:35], v[152:155], v[200:203]
    v_mfma_f32_16x16x32_bf16 v[196:199], v[32:35], v[148:151], v[196:199]
    ds_read_b128 v[32:35], v18 offset:55552
    v_mfma_f32_16x16x32_bf16 v[208:211], v[36:39], v[152:155], v[208:211]
    v_mfma_f32_16x16x32_bf16 v[204:207], v[36:39], v[148:151], v[204:207]
    ds_read_b128 v[36:39], v18 offset:55808
    s_waitcnt lgkmcnt(6)
    v_mfma_f32_16x16x32_bf16 v[216:219], v[40:43], v[152:155], v[216:219]
    v_mfma_f32_16x16x32_bf16 v[212:215], v[40:43], v[148:151], v[212:215]
    ds_read_b128 v[40:43], v18 offset:56064
    v_mfma_f32_16x16x32_bf16 v[224:227], v[44:47], v[152:155], v[224:227]
    v_mfma_f32_16x16x32_bf16 v[220:223], v[44:47], v[148:151], v[220:223]
    ds_read_b128 v[44:47], v19 offset:55296
    v_mfma_f32_16x16x32_bf16 v[232:235], v[48:51], v[152:155], v[232:235]
    v_mfma_f32_16x16x32_bf16 v[228:231], v[48:51], v[148:151], v[228:231]
    ds_read_b128 v[48:51], v22 offset:55296
    s_waitcnt lgkmcnt(6)
    v_mfma_f32_16x16x32_bf16 v[240:243], v[52:55], v[152:155], v[240:243]
    v_mfma_f32_16x16x32_bf16 v[236:239], v[52:55], v[148:151], v[236:239]
    ds_read_b128 v[52:55], v22 offset:55552
    v_mfma_f32_16x16x32_bf16 v[248:251], v[56:59], v[152:155], v[248:251]
    v_mfma_f32_16x16x32_bf16 v[244:247], v[56:59], v[148:151], v[244:247]
    ds_read_b128 v[56:59], v22 offset:55808
    v_mfma_f32_16x16x32_bf16 v[64:67], v[60:63], v[152:155], v[64:67]
    v_mfma_f32_16x16x32_bf16 v[252:255], v[60:63], v[148:151], v[252:255]
    ds_read_b128 v[60:63], v22 offset:56064
    s_waitcnt lgkmcnt(6)
    v_mfma_f32_16x16x32_bf16 v[192:195], v[28:31], v[160:163], v[192:195]
    v_mfma_f32_16x16x32_bf16 v[188:191], v[28:31], v[156:159], v[188:191]
    ds_read_b128 v[28:31], v18 offset:64512
    v_mfma_f32_16x16x32_bf16 v[200:203], v[32:35], v[160:163], v[200:203]
    v_mfma_f32_16x16x32_bf16 v[196:199], v[32:35], v[156:159], v[196:199]
    ds_read_b128 v[32:35], v18 offset:64768
    v_mfma_f32_16x16x32_bf16 v[208:211], v[36:39], v[160:163], v[208:211]
    v_mfma_f32_16x16x32_bf16 v[204:207], v[36:39], v[156:159], v[204:207]
    ds_read_b128 v[36:39], v18 offset:65024
    s_waitcnt lgkmcnt(6)
    v_mfma_f32_16x16x32_bf16 v[216:219], v[40:43], v[160:163], v[216:219]
    v_mfma_f32_16x16x32_bf16 v[212:215], v[40:43], v[156:159], v[212:215]
    ds_read_b128 v[40:43], v18 offset:65280
    v_mfma_f32_16x16x32_bf16 v[224:227], v[44:47], v[160:163], v[224:227]
    v_mfma_f32_16x16x32_bf16 v[220:223], v[44:47], v[156:159], v[220:223]
    ds_read_b128 v[44:47], v19 offset:64512
    v_mfma_f32_16x16x32_bf16 v[232:235], v[48:51], v[160:163], v[232:235]
    v_mfma_f32_16x16x32_bf16 v[228:231], v[48:51], v[156:159], v[228:231]
    ds_read_b128 v[48:51], v22 offset:64512
    s_waitcnt lgkmcnt(6)
    v_mfma_f32_16x16x32_bf16 v[240:243], v[52:55], v[160:163], v[240:243]
    v_mfma_f32_16x16x32_bf16 v[236:239], v[52:55], v[156:159], v[236:239]
    ds_read_b128 v[52:55], v22 offset:64768
    v_mfma_f32_16x16x32_bf16 v[248:251], v[56:59], v[160:163], v[248:251]
    v_mfma_f32_16x16x32_bf16 v[244:247], v[56:59], v[156:159], v[244:247]
    ds_read_b128 v[56:59], v22 offset:65024
    v_mfma_f32_16x16x32_bf16 v[64:67], v[60:63], v[160:163], v[64:67]
    v_mfma_f32_16x16x32_bf16 v[252:255], v[60:63], v[156:159], v[252:255]
    ds_read_b128 v[60:63], v22 offset:65280
    s_waitcnt lgkmcnt(6)
    v_mfma_f32_16x16x32_bf16 v[192:195], v[28:31], v[168:171], v[192:195]
    s_barrier
    v_mfma_f32_16x16x32_bf16 v[188:191], v[28:31], v[164:167], v[188:191]
    ds_read_b128 v[28:31], v18 offset:0
    v_mfma_f32_16x16x32_bf16 v[200:203], v[32:35], v[168:171], v[200:203]
    v_mfma_f32_16x16x32_bf16 v[196:199], v[32:35], v[164:167], v[196:199]
    ds_read_b128 v[32:35], v18 offset:256
    v_mfma_f32_16x16x32_bf16 v[208:211], v[36:39], v[168:171], v[208:211]
    v_mfma_f32_16x16x32_bf16 v[204:207], v[36:39], v[164:167], v[204:207]
    ds_read_b128 v[36:39], v18 offset:512
    s_waitcnt lgkmcnt(6)
    v_mfma_f32_16x16x32_bf16 v[216:219], v[40:43], v[168:171], v[216:219]
    v_mfma_f32_16x16x32_bf16 v[212:215], v[40:43], v[164:167], v[212:215]
    ds_read_b128 v[40:43], v18 offset:768
    v_mfma_f32_16x16x32_bf16 v[224:227], v[44:47], v[168:171], v[224:227]
    v_mfma_f32_16x16x32_bf16 v[220:223], v[44:47], v[164:167], v[220:223]
    ds_read_b128 v[44:47], v19 offset:0
    v_mfma_f32_16x16x32_bf16 v[232:235], v[48:51], v[168:171], v[232:235]
    v_mfma_f32_16x16x32_bf16 v[228:231], v[48:51], v[164:167], v[228:231]
    ds_read_b128 v[48:51], v22 offset:0
    s_waitcnt lgkmcnt(6)
    v_mfma_f32_16x16x32_bf16 v[240:243], v[52:55], v[168:171], v[240:243]
    v_mfma_f32_16x16x32_bf16 v[236:239], v[52:55], v[164:167], v[236:239]
    ds_read_b128 v[52:55], v22 offset:256
    v_mfma_f32_16x16x32_bf16 v[248:251], v[56:59], v[168:171], v[248:251]
    v_mfma_f32_16x16x32_bf16 v[244:247], v[56:59], v[164:167], v[244:247]
    ds_read_b128 v[56:59], v22 offset:512
    v_mfma_f32_16x16x32_bf16 v[64:67], v[60:63], v[168:171], v[64:67]
    v_mfma_f32_16x16x32_bf16 v[252:255], v[60:63], v[164:167], v[252:255]
    ds_read_b128 v[60:63], v22 offset:768
    s_waitcnt lgkmcnt(6)
    v_mfma_f32_16x16x32_bf16 v[192:195], v[28:31], v[176:179], v[192:195]
    v_mfma_f32_16x16x32_bf16 v[188:191], v[28:31], v[172:175], v[188:191]
    ds_read_b128 v[28:31], v18 offset:9216
    v_mfma_f32_16x16x32_bf16 v[200:203], v[32:35], v[176:179], v[200:203]
    v_mfma_f32_16x16x32_bf16 v[196:199], v[32:35], v[172:175], v[196:199]
    ds_read_b128 v[32:35], v18 offset:9472
    v_mfma_f32_16x16x32_bf16 v[208:211], v[36:39], v[176:179], v[208:211]
    v_mfma_f32_16x16x32_bf16 v[204:207], v[36:39], v[172:175], v[204:207]
    ds_read_b128 v[36:39], v18 offset:9728
    s_waitcnt lgkmcnt(6)
    v_mfma_f32_16x16x32_bf16 v[216:219], v[40:43], v[176:179], v[216:219]
    s_branch L_skip_9
    s_nop 0
L_stub_9:
    s_branch L_stub_10
L_skip_9:
    v_mfma_f32_16x16x32_bf16 v[212:215], v[40:43], v[172:175], v[212:215]
    ds_read_b128 v[40:43], v18 offset:9984
    v_mfma_f32_16x16x32_bf16 v[224:227], v[44:47], v[176:179], v[224:227]
    v_mfma_f32_16x16x32_bf16 v[220:223], v[44:47], v[172:175], v[220:223]
    ds_read_b128 v[44:47], v19 offset:9216
    v_mfma_f32_16x16x32_bf16 v[232:235], v[48:51], v[176:179], v[232:235]
    v_mfma_f32_16x16x32_bf16 v[228:231], v[48:51], v[172:175], v[228:231]
    ds_read_b128 v[48:51], v22 offset:9216
    s_waitcnt lgkmcnt(6)
    v_mfma_f32_16x16x32_bf16 v[240:243], v[52:55], v[176:179], v[240:243]
    v_mfma_f32_16x16x32_bf16 v[236:239], v[52:55], v[172:175], v[236:239]
    ds_read_b128 v[52:55], v22 offset:9472
    v_mfma_f32_16x16x32_bf16 v[248:251], v[56:59], v[176:179], v[248:251]
    v_mfma_f32_16x16x32_bf16 v[244:247], v[56:59], v[172:175], v[244:247]
    ds_read_b128 v[56:59], v22 offset:9728
    v_mfma_f32_16x16x32_bf16 v[64:67], v[60:63], v[176:179], v[64:67]
    v_mfma_f32_16x16x32_bf16 v[252:255], v[60:63], v[172:175], v[252:255]
    ds_read_b128 v[60:63], v22 offset:9984
    s_waitcnt lgkmcnt(6)
    v_mfma_f32_16x16x32_bf16 v[192:195], v[28:31], v[184:187], v[192:195]
    s_barrier
    ds_read_b64_tr_b16 v[80:81], v21 offset:32768
    v_mfma_f32_16x16x32_bf16 v[188:191], v[28:31], v[180:183], v[188:191]
    ds_read_b128 v[28:31], v18 offset:18432
    v_mfma_f32_16x16x32_bf16 v[200:203], v[32:35], v[184:187], v[200:203]
    ds_read_b64_tr_b16 v[82:83], v21 offset:36864
    v_mfma_f32_16x16x32_bf16 v[196:199], v[32:35], v[180:183], v[196:199]
    ds_read_b128 v[32:35], v18 offset:18688
    v_mfma_f32_16x16x32_bf16 v[208:211], v[36:39], v[184:187], v[208:211]
    ds_read_b64_tr_b16 v[76:77], v20 offset:32768
    v_mfma_f32_16x16x32_bf16 v[204:207], v[36:39], v[180:183], v[204:207]
    ds_read_b128 v[36:39], v18 offset:18944
    s_waitcnt lgkmcnt(9)
    v_mfma_f32_16x16x32_bf16 v[216:219], v[40:43], v[184:187], v[216:219]
    ds_read_b64_tr_b16 v[78:79], v20 offset:36864
    v_mfma_f32_16x16x32_bf16 v[212:215], v[40:43], v[180:183], v[212:215]
    ds_read_b128 v[40:43], v18 offset:19200
    v_mfma_f32_16x16x32_bf16 v[224:227], v[44:47], v[184:187], v[224:227]
    v_mfma_f32_16x16x32_bf16 v[220:223], v[44:47], v[180:183], v[220:223]
    ds_read_b128 v[44:47], v19 offset:18432
    v_mfma_f32_16x16x32_bf16 v[232:235], v[48:51], v[184:187], v[232:235]
    v_mfma_f32_16x16x32_bf16 v[228:231], v[48:51], v[180:183], v[228:231]
    ds_read_b128 v[48:51], v22 offset:18432
    s_waitcnt lgkmcnt(10)
    v_mfma_f32_16x16x32_bf16 v[240:243], v[52:55], v[184:187], v[240:243]
    v_mfma_f32_16x16x32_bf16 v[236:239], v[52:55], v[180:183], v[236:239]
    ds_read_b128 v[52:55], v22 offset:18688
    v_mfma_f32_16x16x32_bf16 v[248:251], v[56:59], v[184:187], v[248:251]
    v_mfma_f32_16x16x32_bf16 v[244:247], v[56:59], v[180:183], v[244:247]
    ds_read_b128 v[56:59], v22 offset:18944
    v_mfma_f32_16x16x32_bf16 v[64:67], v[60:63], v[184:187], v[64:67]
    v_mfma_f32_16x16x32_bf16 v[252:255], v[60:63], v[180:183], v[252:255]
    ds_read_b128 v[60:63], v22 offset:19200
    s_waitcnt lgkmcnt(6)
    v_mfma_f32_16x16x32_bf16 v[192:195], v[28:31], v[80:83], v[192:195]
    ds_read_b64_tr_b16 v[88:89], v21 offset:40960
    v_mfma_f32_16x16x32_bf16 v[188:191], v[28:31], v[76:79], v[188:191]
    ds_read_b128 v[28:31], v18 offset:27648
    v_mfma_f32_16x16x32_bf16 v[200:203], v[32:35], v[80:83], v[200:203]
    ds_read_b64_tr_b16 v[90:91], v21 offset:45056
    v_mfma_f32_16x16x32_bf16 v[196:199], v[32:35], v[76:79], v[196:199]
    ds_read_b128 v[32:35], v18 offset:27904
    v_mfma_f32_16x16x32_bf16 v[208:211], v[36:39], v[80:83], v[208:211]
    ds_read_b64_tr_b16 v[84:85], v20 offset:40960
    v_mfma_f32_16x16x32_bf16 v[204:207], v[36:39], v[76:79], v[204:207]
    ds_read_b128 v[36:39], v18 offset:28160
    s_waitcnt lgkmcnt(9)
    v_mfma_f32_16x16x32_bf16 v[216:219], v[40:43], v[80:83], v[216:219]
    ds_read_b64_tr_b16 v[86:87], v20 offset:45056
    v_mfma_f32_16x16x32_bf16 v[212:215], v[40:43], v[76:79], v[212:215]
    ds_read_b128 v[40:43], v18 offset:28416
    v_mfma_f32_16x16x32_bf16 v[224:227], v[44:47], v[80:83], v[224:227]
    v_mfma_f32_16x16x32_bf16 v[220:223], v[44:47], v[76:79], v[220:223]
    ds_read_b128 v[44:47], v19 offset:27648
    v_mfma_f32_16x16x32_bf16 v[232:235], v[48:51], v[80:83], v[232:235]
    v_mfma_f32_16x16x32_bf16 v[228:231], v[48:51], v[76:79], v[228:231]
    ds_read_b128 v[48:51], v22 offset:27648
    s_waitcnt lgkmcnt(10)
    v_mfma_f32_16x16x32_bf16 v[240:243], v[52:55], v[80:83], v[240:243]
    v_mfma_f32_16x16x32_bf16 v[236:239], v[52:55], v[76:79], v[236:239]
    ds_read_b128 v[52:55], v22 offset:27904
    v_mfma_f32_16x16x32_bf16 v[248:251], v[56:59], v[80:83], v[248:251]
    v_mfma_f32_16x16x32_bf16 v[244:247], v[56:59], v[76:79], v[244:247]
    ds_read_b128 v[56:59], v22 offset:28160
    v_mfma_f32_16x16x32_bf16 v[64:67], v[60:63], v[80:83], v[64:67]
    v_mfma_f32_16x16x32_bf16 v[252:255], v[60:63], v[76:79], v[252:255]
    ds_read_b128 v[60:63], v22 offset:28416
    s_waitcnt lgkmcnt(6)
    v_mfma_f32_16x16x32_bf16 v[192:195], v[28:31], v[88:91], v[192:195]
    s_barrier
    ds_read_b64_tr_b16 v[80:81], v25 offset:0
    v_mfma_f32_16x16x32_bf16 v[188:191], v[28:31], v[84:87], v[188:191]
    ds_read_b128 v[28:31], v18 offset:36864
    v_mfma_f32_16x16x32_bf16 v[200:203], v[32:35], v[88:91], v[200:203]
    ds_read_b64_tr_b16 v[82:83], v25 offset:4096
    v_mfma_f32_16x16x32_bf16 v[196:199], v[32:35], v[84:87], v[196:199]
    ds_read_b128 v[32:35], v18 offset:37120
    v_mfma_f32_16x16x32_bf16 v[208:211], v[36:39], v[88:91], v[208:211]
    ds_read_b64_tr_b16 v[92:93], v24 offset:0
    v_mfma_f32_16x16x32_bf16 v[204:207], v[36:39], v[84:87], v[204:207]
    ds_read_b128 v[36:39], v18 offset:37376
    s_waitcnt lgkmcnt(9)
    v_mfma_f32_16x16x32_bf16 v[216:219], v[40:43], v[88:91], v[216:219]
    ds_read_b64_tr_b16 v[94:95], v24 offset:4096
    v_mfma_f32_16x16x32_bf16 v[212:215], v[40:43], v[84:87], v[212:215]
    ds_read_b128 v[40:43], v18 offset:37632
    v_mfma_f32_16x16x32_bf16 v[224:227], v[44:47], v[88:91], v[224:227]
    v_mfma_f32_16x16x32_bf16 v[220:223], v[44:47], v[84:87], v[220:223]
    ds_read_b128 v[44:47], v19 offset:36864
    v_mfma_f32_16x16x32_bf16 v[232:235], v[48:51], v[88:91], v[232:235]
    v_mfma_f32_16x16x32_bf16 v[228:231], v[48:51], v[84:87], v[228:231]
    ds_read_b128 v[48:51], v22 offset:36864
    s_waitcnt lgkmcnt(10)
    v_mfma_f32_16x16x32_bf16 v[240:243], v[52:55], v[88:91], v[240:243]
    v_mfma_f32_16x16x32_bf16 v[236:239], v[52:55], v[84:87], v[236:239]
    ds_read_b128 v[52:55], v22 offset:37120
    v_mfma_f32_16x16x32_bf16 v[248:251], v[56:59], v[88:91], v[248:251]
    v_mfma_f32_16x16x32_bf16 v[244:247], v[56:59], v[84:87], v[244:247]
    ds_read_b128 v[56:59], v22 offset:37376
    v_mfma_f32_16x16x32_bf16 v[64:67], v[60:63], v[88:91], v[64:67]
    v_mfma_f32_16x16x32_bf16 v[252:255], v[60:63], v[84:87], v[252:255]
    ds_read_b128 v[60:63], v22 offset:37632
    s_waitcnt lgkmcnt(7)
    v_mfma_f32_16x16x32_bf16 v[192:195], v[28:31], v[80:83], v[192:195]
    ds_read_b128 v[28:31], v18 offset:46080
    ds_read_b64_tr_b16 v[88:89], v25 offset:8192
    v_mfma_f32_16x16x32_bf16 v[200:203], v[32:35], v[80:83], v[200:203]
    ds_read_b128 v[32:35], v18 offset:46336
    ds_read_b64_tr_b16 v[90:91], v25 offset:12288
    v_mfma_f32_16x16x32_bf16 v[208:211], v[36:39], v[80:83], v[208:211]
    ds_read_b128 v[36:39], v18 offset:46592
    s_waitcnt lgkmcnt(8)
    v_mfma_f32_16x16x32_bf16 v[216:219], v[40:43], v[80:83], v[216:219]
    ds_read_b128 v[40:43], v18 offset:46848
    v_mfma_f32_16x16x32_bf16 v[224:227], v[44:47], v[80:83], v[224:227]
    ds_read_b128 v[44:47], v19 offset:46080
    v_mfma_f32_16x16x32_bf16 v[232:235], v[48:51], v[80:83], v[232:235]
    ds_read_b128 v[48:51], v22 offset:46080
    ds_read_b64_tr_b16 v[96:97], v24 offset:8192
    s_waitcnt lgkmcnt(9)
    v_mfma_f32_16x16x32_bf16 v[240:243], v[52:55], v[80:83], v[240:243]
    ds_read_b128 v[52:55], v22 offset:46336
    ds_read_b64_tr_b16 v[98:99], v24 offset:12288
    v_mfma_f32_16x16x32_bf16 v[248:251], v[56:59], v[80:83], v[248:251]
    ds_read_b128 v[56:59], v22 offset:46592
    v_mfma_f32_16x16x32_bf16 v[64:67], v[60:63], v[80:83], v[64:67]
    ds_read_b128 v[60:63], v22 offset:46848
    s_waitcnt lgkmcnt(8)
    v_mfma_f32_16x16x32_bf16 v[192:195], v[28:31], v[88:91], v[192:195]
    s_barrier
    ds_read_b128 v[28:31], v18 offset:55296
    ds_read_b64_tr_b16 v[80:81], v25 offset:16384
    v_mfma_f32_16x16x32_bf16 v[200:203], v[32:35], v[88:91], v[200:203]
    ds_read_b128 v[32:35], v18 offset:55552
    ds_read_b64_tr_b16 v[82:83], v25 offset:20480
    v_mfma_f32_16x16x32_bf16 v[208:211], v[36:39], v[88:91], v[208:211]
    ds_read_b128 v[36:39], v18 offset:55808
    s_waitcnt lgkmcnt(10)
    v_mfma_f32_16x16x32_bf16 v[216:219], v[40:43], v[88:91], v[216:219]
    ds_read_b128 v[40:43], v18 offset:56064
    v_mfma_f32_16x16x32_bf16 v[224:227], v[44:47], v[88:91], v[224:227]
    ds_read_b128 v[44:47], v19 offset:55296
    v_mfma_f32_16x16x32_bf16 v[232:235], v[48:51], v[88:91], v[232:235]
    ds_read_b128 v[48:51], v22 offset:55296
    ds_read_b64_tr_b16 v[100:101], v24 offset:16384
    s_waitcnt lgkmcnt(9)
    v_mfma_f32_16x16x32_bf16 v[240:243], v[52:55], v[88:91], v[240:243]
    ds_read_b128 v[52:55], v22 offset:55552
    ds_read_b64_tr_b16 v[102:103], v24 offset:20480
    v_mfma_f32_16x16x32_bf16 v[248:251], v[56:59], v[88:91], v[248:251]
    ds_read_b128 v[56:59], v22 offset:55808
    v_mfma_f32_16x16x32_bf16 v[64:67], v[60:63], v[88:91], v[64:67]
    ds_read_b128 v[60:63], v22 offset:56064
    s_waitcnt lgkmcnt(8)
    v_mfma_f32_16x16x32_bf16 v[192:195], v[28:31], v[80:83], v[192:195]
    ds_read_b128 v[28:31], v18 offset:64512
    ds_read_b64_tr_b16 v[88:89], v25 offset:24576
    v_mfma_f32_16x16x32_bf16 v[200:203], v[32:35], v[80:83], v[200:203]
    ds_read_b128 v[32:35], v18 offset:64768
    ds_read_b64_tr_b16 v[90:91], v25 offset:28672
    v_mfma_f32_16x16x32_bf16 v[208:211], v[36:39], v[80:83], v[208:211]
    ds_read_b128 v[36:39], v18 offset:65024
    s_waitcnt lgkmcnt(10)
    v_mfma_f32_16x16x32_bf16 v[216:219], v[40:43], v[80:83], v[216:219]
    ds_read_b128 v[40:43], v18 offset:65280
    v_mfma_f32_16x16x32_bf16 v[224:227], v[44:47], v[80:83], v[224:227]
    ds_read_b128 v[44:47], v19 offset:64512
    v_mfma_f32_16x16x32_bf16 v[232:235], v[48:51], v[80:83], v[232:235]
    ds_read_b128 v[48:51], v22 offset:64512
    ds_read_b64_tr_b16 v[104:105], v24 offset:24576
    s_waitcnt lgkmcnt(9)
    v_mfma_f32_16x16x32_bf16 v[240:243], v[52:55], v[80:83], v[240:243]
    ds_read_b128 v[52:55], v22 offset:64768
    ds_read_b64_tr_b16 v[106:107], v24 offset:28672
    v_mfma_f32_16x16x32_bf16 v[248:251], v[56:59], v[80:83], v[248:251]
    ds_read_b128 v[56:59], v22 offset:65024
    v_mfma_f32_16x16x32_bf16 v[64:67], v[60:63], v[80:83], v[64:67]
    ds_read_b128 v[60:63], v22 offset:65280
    s_waitcnt lgkmcnt(8)
    v_mfma_f32_16x16x32_bf16 v[192:195], v[28:31], v[88:91], v[192:195]
    s_barrier
    ds_read_b128 v[28:31], v18 offset:0
    ds_read_b64_tr_b16 v[80:81], v21 offset:0
    v_mfma_f32_16x16x32_bf16 v[200:203], v[32:35], v[88:91], v[200:203]
    ds_read_b128 v[32:35], v18 offset:256
    ds_read_b64_tr_b16 v[82:83], v21 offset:4096
    v_mfma_f32_16x16x32_bf16 v[208:211], v[36:39], v[88:91], v[208:211]
    ds_read_b128 v[36:39], v18 offset:512
    s_waitcnt lgkmcnt(10)
    v_mfma_f32_16x16x32_bf16 v[216:219], v[40:43], v[88:91], v[216:219]
    ds_read_b128 v[40:43], v18 offset:768
    v_mfma_f32_16x16x32_bf16 v[224:227], v[44:47], v[88:91], v[224:227]
    ds_read_b128 v[44:47], v19 offset:0
    v_mfma_f32_16x16x32_bf16 v[232:235], v[48:51], v[88:91], v[232:235]
    ds_read_b128 v[48:51], v22 offset:0
    ds_read_b64_tr_b16 v[108:109], v20 offset:0
    s_waitcnt lgkmcnt(9)
    v_mfma_f32_16x16x32_bf16 v[240:243], v[52:55], v[88:91], v[240:243]
    ds_read_b128 v[52:55], v22 offset:256
    ds_read_b64_tr_b16 v[110:111], v20 offset:4096
    v_mfma_f32_16x16x32_bf16 v[248:251], v[56:59], v[88:91], v[248:251]
    ds_read_b128 v[56:59], v22 offset:512
    v_mfma_f32_16x16x32_bf16 v[64:67], v[60:63], v[88:91], v[64:67]
    ds_read_b128 v[60:63], v22 offset:768
    s_waitcnt lgkmcnt(8)
    v_mfma_f32_16x16x32_bf16 v[192:195], v[28:31], v[80:83], v[192:195]
    ds_read_b128 v[28:31], v18 offset:9216
    ds_read_b64_tr_b16 v[88:89], v21 offset:8192
    v_mfma_f32_16x16x32_bf16 v[200:203], v[32:35], v[80:83], v[200:203]
    ds_read_b128 v[32:35], v18 offset:9472
    ds_read_b64_tr_b16 v[90:91], v21 offset:12288
    v_mfma_f32_16x16x32_bf16 v[208:211], v[36:39], v[80:83], v[208:211]
    ds_read_b128 v[36:39], v18 offset:9728
    s_waitcnt lgkmcnt(10)
    v_mfma_f32_16x16x32_bf16 v[216:219], v[40:43], v[80:83], v[216:219]
    ds_read_b128 v[40:43], v18 offset:9984
    v_mfma_f32_16x16x32_bf16 v[224:227], v[44:47], v[80:83], v[224:227]
    ds_read_b128 v[44:47], v19 offset:9216
    v_mfma_f32_16x16x32_bf16 v[232:235], v[48:51], v[80:83], v[232:235]
    ds_read_b128 v[48:51], v22 offset:9216
    ds_read_b64_tr_b16 v[112:113], v20 offset:8192
    s_waitcnt lgkmcnt(9)
    v_mfma_f32_16x16x32_bf16 v[240:243], v[52:55], v[80:83], v[240:243]
    ds_read_b128 v[52:55], v22 offset:9472
    ds_read_b64_tr_b16 v[114:115], v20 offset:12288
    v_mfma_f32_16x16x32_bf16 v[248:251], v[56:59], v[80:83], v[248:251]
    ds_read_b128 v[56:59], v22 offset:9728
    v_mfma_f32_16x16x32_bf16 v[64:67], v[60:63], v[80:83], v[64:67]
    ds_read_b128 v[60:63], v22 offset:9984
    s_waitcnt lgkmcnt(8)
    v_mfma_f32_16x16x32_bf16 v[192:195], v[28:31], v[88:91], v[192:195]
    s_barrier
    ds_read_b128 v[28:31], v18 offset:18432
    ds_read_b64_tr_b16 v[80:81], v21 offset:16384
    v_mfma_f32_16x16x32_bf16 v[200:203], v[32:35], v[88:91], v[200:203]
    ds_read_b128 v[32:35], v18 offset:18688
    ds_read_b64_tr_b16 v[82:83], v21 offset:20480
    v_mfma_f32_16x16x32_bf16 v[208:211], v[36:39], v[88:91], v[208:211]
    ds_read_b128 v[36:39], v18 offset:18944
    s_waitcnt lgkmcnt(10)
    v_mfma_f32_16x16x32_bf16 v[216:219], v[40:43], v[88:91], v[216:219]
    ds_read_b128 v[40:43], v18 offset:19200
    v_mfma_f32_16x16x32_bf16 v[224:227], v[44:47], v[88:91], v[224:227]
    ds_read_b128 v[44:47], v19 offset:18432
    v_mfma_f32_16x16x32_bf16 v[232:235], v[48:51], v[88:91], v[232:235]
    ds_read_b128 v[48:51], v22 offset:18432
    ds_read_b64_tr_b16 v[116:117], v20 offset:16384
    s_waitcnt lgkmcnt(9)
    v_mfma_f32_16x16x32_bf16 v[240:243], v[52:55], v[88:91], v[240:243]
    ds_read_b128 v[52:55], v22 offset:18688
    ds_read_b64_tr_b16 v[118:119], v20 offset:20480
    v_mfma_f32_16x16x32_bf16 v[248:251], v[56:59], v[88:91], v[248:251]
    ds_read_b128 v[56:59], v22 offset:18944
    v_mfma_f32_16x16x32_bf16 v[64:67], v[60:63], v[88:91], v[64:67]
    ds_read_b128 v[60:63], v22 offset:19200
    s_waitcnt lgkmcnt(8)
    v_mfma_f32_16x16x32_bf16 v[192:195], v[28:31], v[80:83], v[192:195]
    ds_read_b128 v[28:31], v18 offset:27648
    ds_read_b64_tr_b16 v[88:89], v21 offset:24576
    v_mfma_f32_16x16x32_bf16 v[200:203], v[32:35], v[80:83], v[200:203]
    ds_read_b128 v[32:35], v18 offset:27904
    ds_read_b64_tr_b16 v[90:91], v21 offset:28672
    v_mfma_f32_16x16x32_bf16 v[208:211], v[36:39], v[80:83], v[208:211]
    ds_read_b128 v[36:39], v18 offset:28160
    s_waitcnt lgkmcnt(10)
    v_mfma_f32_16x16x32_bf16 v[216:219], v[40:43], v[80:83], v[216:219]
    ds_read_b128 v[40:43], v18 offset:28416
    v_mfma_f32_16x16x32_bf16 v[224:227], v[44:47], v[80:83], v[224:227]
    ds_read_b128 v[44:47], v19 offset:27648
    v_mfma_f32_16x16x32_bf16 v[232:235], v[48:51], v[80:83], v[232:235]
    ds_read_b128 v[48:51], v22 offset:27648
    ds_read_b64_tr_b16 v[120:121], v20 offset:24576
    s_waitcnt lgkmcnt(9)
    v_mfma_f32_16x16x32_bf16 v[240:243], v[52:55], v[80:83], v[240:243]
    ds_read_b128 v[52:55], v22 offset:27904
    ds_read_b64_tr_b16 v[122:123], v20 offset:28672
    v_mfma_f32_16x16x32_bf16 v[248:251], v[56:59], v[80:83], v[248:251]
    ds_read_b128 v[56:59], v22 offset:28160
    v_mfma_f32_16x16x32_bf16 v[64:67], v[60:63], v[80:83], v[64:67]
    ds_read_b128 v[60:63], v22 offset:28416
    s_waitcnt lgkmcnt(8)
    v_mfma_f32_16x16x32_bf16 v[192:195], v[28:31], v[88:91], v[192:195]
    v_mfma_f32_16x16x32_bf16 v[200:203], v[32:35], v[88:91], v[200:203]
    v_mfma_f32_16x16x32_bf16 v[208:211], v[36:39], v[88:91], v[208:211]
    s_waitcnt lgkmcnt(5)
    v_mfma_f32_16x16x32_bf16 v[216:219], v[40:43], v[88:91], v[216:219]
    v_mfma_f32_16x16x32_bf16 v[224:227], v[44:47], v[88:91], v[224:227]
    v_mfma_f32_16x16x32_bf16 v[232:235], v[48:51], v[88:91], v[232:235]
    s_waitcnt lgkmcnt(0)
    v_mfma_f32_16x16x32_bf16 v[240:243], v[52:55], v[88:91], v[240:243]
    v_mfma_f32_16x16x32_bf16 v[248:251], v[56:59], v[88:91], v[248:251]
    v_mfma_f32_16x16x32_bf16 v[64:67], v[60:63], v[88:91], v[64:67]
    v_mfma_f32_16x16x32_bf16 v[220:223], v[44:47], v[120:123], v[220:223]
    ds_read_b128 v[44:47], v19 offset:36864
    v_mfma_f32_16x16x32_bf16 v[228:231], v[48:51], v[120:123], v[228:231]
    ds_read_b128 v[48:51], v22 offset:36864
    v_mfma_f32_16x16x32_bf16 v[236:239], v[52:55], v[120:123], v[236:239]
    ds_read_b128 v[52:55], v22 offset:37120
    v_mfma_f32_16x16x32_bf16 v[244:247], v[56:59], v[120:123], v[244:247]
    ds_read_b128 v[56:59], v22 offset:37376
    v_mfma_f32_16x16x32_bf16 v[252:255], v[60:63], v[120:123], v[252:255]
    ds_read_b128 v[60:63], v22 offset:37632
    v_mfma_f32_16x16x32_bf16 v[188:191], v[28:31], v[120:123], v[188:191]
    ds_read_b128 v[28:31], v18 offset:36864
    v_mfma_f32_16x16x32_bf16 v[196:199], v[32:35], v[120:123], v[196:199]
    ds_read_b128 v[32:35], v18 offset:37120
    v_mfma_f32_16x16x32_bf16 v[204:207], v[36:39], v[120:123], v[204:207]
    ds_read_b128 v[36:39], v18 offset:37376
    v_mfma_f32_16x16x32_bf16 v[212:215], v[40:43], v[120:123], v[212:215]
    ds_read_b128 v[40:43], v18 offset:37632
    s_waitcnt lgkmcnt(4)
    v_mfma_f32_16x16x32_bf16 v[220:223], v[44:47], v[92:95], v[220:223]
    ds_read_b128 v[44:47], v19 offset:46080
    v_cvt_pk_bf16_f32 v144, v224, v225
    v_cvt_pk_bf16_f32 v156, v226, v227
    v_mfma_f32_16x16x32_bf16 v[228:231], v[48:51], v[92:95], v[228:231]
    ds_read_b128 v[48:51], v22 offset:46080
    v_permlane32_swap_b32 v144, v156
    s_nop 1
    v_mov_b32_dpp v157, v156 quad_perm:[1,1,1,1] row_mask:0xf bank_mask:0xf
    v_mfma_f32_16x16x32_bf16 v[236:239], v[52:55], v[92:95], v[236:239]
    ds_read_b128 v[52:55], v22 offset:46336
    v_mov_b32_dpp v158, v156 quad_perm:[2,2,2,2] row_mask:0xf bank_mask:0xf
    v_mov_b32_dpp v159, v156 quad_perm:[3,3,3,3] row_mask:0xf bank_mask:0xf
    v_mfma_f32_16x16x32_bf16 v[244:247], v[56:59], v[92:95], v[244:247]
    ds_read_b128 v[56:59], v22 offset:46592
    v_cvt_pk_bf16_f32 v148, v232, v233
    v_cvt_pk_bf16_f32 v149, v234, v235
    v_mfma_f32_16x16x32_bf16 v[252:255], v[60:63], v[92:95], v[252:255]
    ds_read_b128 v[60:63], v22 offset:46848
    v_cvt_pk_bf16_f32 v150, v240, v241
    v_cvt_pk_bf16_f32 v151, v242, v243
    s_waitcnt lgkmcnt(0)
    v_mfma_f32_16x16x32_bf16 v[220:223], v[44:47], v[96:99], v[220:223]
    ds_read_b128 v[44:47], v19 offset:55296
    buffer_store_dwordx4 v[148:151], v9, s[36:39], s67 offen offset:0 sc1
    v_cvt_pk_bf16_f32 v152, v248, v249
    v_mfma_f32_16x16x32_bf16 v[228:231], v[48:51], v[96:99], v[228:231]
    ds_read_b128 v[48:51], v22 offset:55296
    v_cvt_pk_bf16_f32 v153, v250, v251
    v_cvt_pk_bf16_f32 v154, v64, v65
    v_mfma_f32_16x16x32_bf16 v[236:239], v[52:55], v[96:99], v[236:239]
    ds_read_b128 v[52:55], v22 offset:55552
    v_cvt_pk_bf16_f32 v155, v66, v67
    buffer_store_dwordx4 v[152:155], v9, s[36:39], s67 offen offset:1024 sc1
    v_mfma_f32_16x16x32_bf16 v[244:247], v[56:59], v[96:99], v[244:247]
    ds_read_b128 v[56:59], v22 offset:55808
    buffer_store_dwordx4 v[156:159], v26, s[36:39], s67 offen offset:2048 sc1
    v_mov_b32_dpp v145, v144 quad_perm:[1,1,1,1] row_mask:0xf bank_mask:0xf
    v_mfma_f32_16x16x32_bf16 v[252:255], v[60:63], v[96:99], v[252:255]
    ds_read_b128 v[60:63], v22 offset:56064
    v_mov_b32_dpp v146, v144 quad_perm:[2,2,2,2] row_mask:0xf bank_mask:0xf
    v_mov_b32_dpp v147, v144 quad_perm:[3,3,3,3] row_mask:0xf bank_mask:0xf
    s_waitcnt lgkmcnt(0)
    v_mfma_f32_16x16x32_bf16 v[220:223], v[44:47], v[100:103], v[220:223]
    ds_read_b128 v[44:47], v19 offset:64512
    v_cvt_pk_bf16_f32 v136, v192, v193
    v_cvt_pk_bf16_f32 v137, v194, v195
    v_mfma_f32_16x16x32_bf16 v[228:231], v[48:51], v[100:103], v[228:231]
    ds_read_b128 v[48:51], v22 offset:64512
    v_cvt_pk_bf16_f32 v138, v200, v201
    v_cvt_pk_bf16_f32 v139, v202, v203
    v_mfma_f32_16x16x32_bf16 v[236:239], v[52:55], v[100:103], v[236:239]
    ds_read_b128 v[52:55], v22 offset:64768
    buffer_store_dwordx4 v[136:139], v9, s[36:39], s66 offen offset:0 sc1
    v_cvt_pk_bf16_f32 v140, v208, v209
    v_mfma_f32_16x16x32_bf16 v[244:247], v[56:59], v[100:103], v[244:247]
    ds_read_b128 v[56:59], v22 offset:65024
    v_cvt_pk_bf16_f32 v141, v210, v211
    v_cvt_pk_bf16_f32 v142, v216, v217
    v_mfma_f32_16x16x32_bf16 v[252:255], v[60:63], v[100:103], v[252:255]
    ds_read_b128 v[60:63], v22 offset:65280
    v_cvt_pk_bf16_f32 v143, v218, v219
    buffer_store_dwordx4 v[140:143], v9, s[36:39], s66 offen offset:1024 sc1
    s_waitcnt lgkmcnt(0)
    v_mfma_f32_16x16x32_bf16 v[220:223], v[44:47], v[104:107], v[220:223]
    ds_read_b128 v[44:47], v19 offset:0
    buffer_store_dwordx4 v[144:147], v26, s[36:39], s66 offen offset:2048 sc1
    v_mfma_f32_16x16x32_bf16 v[228:231], v[48:51], v[104:107], v[228:231]
    ds_read_b128 v[48:51], v22 offset:0
    v_mfma_f32_16x16x32_bf16 v[236:239], v[52:55], v[104:107], v[236:239]
    ds_read_b128 v[52:55], v22 offset:256
    v_mfma_f32_16x16x32_bf16 v[244:247], v[56:59], v[104:107], v[244:247]
    ds_read_b128 v[56:59], v22 offset:512
    v_mfma_f32_16x16x32_bf16 v[252:255], v[60:63], v[104:107], v[252:255]
    ds_read_b128 v[60:63], v22 offset:768
    s_waitcnt lgkmcnt(0)
    v_mfma_f32_16x16x32_bf16 v[220:223], v[44:47], v[108:111], v[220:223]
    ds_read_b128 v[44:47], v19 offset:9216
    v_mfma_f32_16x16x32_bf16 v[228:231], v[48:51], v[108:111], v[228:231]
    ds_read_b128 v[48:51], v22 offset:9216
    v_mfma_f32_16x16x32_bf16 v[236:239], v[52:55], v[108:111], v[236:239]
    ds_read_b128 v[52:55], v22 offset:9472
    v_mfma_f32_16x16x32_bf16 v[244:247], v[56:59], v[108:111], v[244:247]
    ds_read_b128 v[56:59], v22 offset:9728
    v_mfma_f32_16x16x32_bf16 v[252:255], v[60:63], v[108:111], v[252:255]
    ds_read_b128 v[60:63], v22 offset:9984
    s_waitcnt lgkmcnt(0)
    v_mfma_f32_16x16x32_bf16 v[220:223], v[44:47], v[112:115], v[220:223]
    ds_read_b128 v[44:47], v19 offset:18432
    v_mfma_f32_16x16x32_bf16 v[228:231], v[48:51], v[112:115], v[228:231]
    ds_read_b128 v[48:51], v22 offset:18432
    v_mfma_f32_16x16x32_bf16 v[236:239], v[52:55], v[112:115], v[236:239]
    ds_read_b128 v[52:55], v22 offset:18688
    v_mfma_f32_16x16x32_bf16 v[244:247], v[56:59], v[112:115], v[244:247]
    ds_read_b128 v[56:59], v22 offset:18944
    v_mfma_f32_16x16x32_bf16 v[252:255], v[60:63], v[112:115], v[252:255]
    ds_read_b128 v[60:63], v22 offset:19200
    s_waitcnt lgkmcnt(0)
    v_mfma_f32_16x16x32_bf16 v[220:223], v[44:47], v[116:119], v[220:223]
    v_mfma_f32_16x16x32_bf16 v[228:231], v[48:51], v[116:119], v[228:231]
    v_mfma_f32_16x16x32_bf16 v[236:239], v[52:55], v[116:119], v[236:239]
    v_mfma_f32_16x16x32_bf16 v[244:247], v[56:59], v[116:119], v[244:247]
    v_mfma_f32_16x16x32_bf16 v[252:255], v[60:63], v[116:119], v[252:255]
    v_mfma_f32_16x16x32_bf16 v[188:191], v[28:31], v[92:95], v[188:191]
    ds_read_b128 v[28:31], v18 offset:46080
    v_mfma_f32_16x16x32_bf16 v[196:199], v[32:35], v[92:95], v[196:199]
    ds_read_b128 v[32:35], v18 offset:46336
    v_mfma_f32_16x16x32_bf16 v[204:207], v[36:39], v[92:95], v[204:207]
    ds_read_b128 v[36:39], v18 offset:46592
    v_mfma_f32_16x16x32_bf16 v[212:215], v[40:43], v[92:95], v[212:215]
    ds_read_b128 v[40:43], v18 offset:46848
    s_waitcnt lgkmcnt(0)
    v_mfma_f32_16x16x32_bf16 v[188:191], v[28:31], v[96:99], v[188:191]
    ds_read_b128 v[28:31], v18 offset:55296
    v_cvt_pk_bf16_f32 v13, v220, v221
    v_cvt_pk_bf16_f32 v132, v222, v223
    v_mfma_f32_16x16x32_bf16 v[196:199], v[32:35], v[96:99], v[196:199]
    ds_read_b128 v[32:35], v18 offset:55552
    v_permlane32_swap_b32 v13, v132
    s_nop 1
    v_mov_b32_dpp v133, v132 quad_perm:[1,1,1,1] row_mask:0xf bank_mask:0xf
    v_mfma_f32_16x16x32_bf16 v[204:207], v[36:39], v[96:99], v[204:207]
    ds_read_b128 v[36:39], v18 offset:55808
    v_mov_b32_dpp v134, v132 quad_perm:[2,2,2,2] row_mask:0xf bank_mask:0xf
    v_mov_b32_dpp v135, v132 quad_perm:[3,3,3,3] row_mask:0xf bank_mask:0xf
    v_mfma_f32_16x16x32_bf16 v[212:215], v[40:43], v[96:99], v[212:215]
    ds_read_b128 v[40:43], v18 offset:56064
    v_cvt_pk_bf16_f32 v124, v228, v229
    v_cvt_pk_bf16_f32 v125, v230, v231
    s_waitcnt lgkmcnt(0)
    v_mfma_f32_16x16x32_bf16 v[188:191], v[28:31], v[100:103], v[188:191]
    ds_read_b128 v[28:31], v18 offset:64512
    v_cvt_pk_bf16_f32 v126, v236, v237
    v_cvt_pk_bf16_f32 v127, v238, v239
    v_mfma_f32_16x16x32_bf16 v[196:199], v[32:35], v[100:103], v[196:199]
    ds_read_b128 v[32:35], v18 offset:64768
    buffer_store_dwordx4 v[124:127], v9, s[36:39], s65 offen offset:0 sc1
    v_cvt_pk_bf16_f32 v128, v244, v245
    v_mfma_f32_16x16x32_bf16 v[204:207], v[36:39], v[100:103], v[204:207]
    ds_read_b128 v[36:39], v18 offset:65024
    v_cvt_pk_bf16_f32 v129, v246, v247
    v_cvt_pk_bf16_f32 v130, v252, v253
    v_mfma_f32_16x16x32_bf16 v[212:215], v[40:43], v[100:103], v[212:215]
    ds_read_b128 v[40:43], v18 offset:65280
    v_cvt_pk_bf16_f32 v131, v254, v255
    buffer_store_dwordx4 v[128:131], v9, s[36:39], s65 offen offset:1024 sc1
    s_waitcnt lgkmcnt(0)
    v_mfma_f32_16x16x32_bf16 v[188:191], v[28:31], v[104:107], v[188:191]
    ds_read_b128 v[28:31], v18 offset:0
    buffer_store_dwordx4 v[132:135], v26, s[36:39], s65 offen offset:2048 sc1
    v_lshrrev_b32 v10, 2, v1
    v_mfma_f32_16x16x32_bf16 v[196:199], v[32:35], v[104:107], v[196:199]
    ds_read_b128 v[32:35], v18 offset:256
    v_and_b32 v11, 1, v1
    v_lshlrev_b32 v11, 4, v11
    v_mfma_f32_16x16x32_bf16 v[204:207], v[36:39], v[104:107], v[204:207]
    ds_read_b128 v[36:39], v18 offset:512
    v_mov_b32 v12, 0x3f80
    v_lshlrev_b32 v11, v11, v12
    v_mfma_f32_16x16x32_bf16 v[212:215], v[40:43], v[104:107], v[212:215]
    ds_read_b128 v[40:43], v18 offset:768
    v_and_b32 v12, 2, v1
    v_add_u32 v13, v10, v12
    s_waitcnt lgkmcnt(0)
    v_mfma_f32_16x16x32_bf16 v[188:191], v[28:31], v[108:111], v[188:191]
    ds_read_b128 v[28:31], v18 offset:9216
    v_cmp_eq_u32 vcc, v10, v2
    s_nop 1
    v_cndmask_b32 v80, 0, v11, vcc
    v_mfma_f32_16x16x32_bf16 v[196:199], v[32:35], v[108:111], v[196:199]
    ds_read_b128 v[32:35], v18 offset:9472
    v_cmp_eq_u32 vcc, v13, v2
    s_nop 1
    v_cndmask_b32 v76, 0, v11, vcc
    v_mfma_f32_16x16x32_bf16 v[204:207], v[36:39], v[108:111], v[204:207]
    ds_read_b128 v[36:39], v18 offset:9728
    v_cmp_gt_u32 vcc, 8, v1
    s_nop 1
    v_cndmask_b32 v76, 0, v76, vcc
    v_mfma_f32_16x16x32_bf16 v[212:215], v[40:43], v[108:111], v[212:215]
    ds_read_b128 v[40:43], v18 offset:9984
    v_cmp_eq_u32 vcc, 0, v12
    s_nop 1
    v_cndmask_b32 v81, v80, 0, vcc
    s_waitcnt lgkmcnt(0)
    v_mfma_f32_16x16x32_bf16 v[188:191], v[28:31], v[112:115], v[188:191]
    ds_read_b128 v[28:31], v18 offset:18432
    v_cndmask_b32 v80, 0, v80, vcc
    v_mov_b32 v77, v76
    v_mfma_f32_16x16x32_bf16 v[196:199], v[32:35], v[112:115], v[196:199]
    ds_read_b128 v[32:35], v18 offset:18688
    v_mov_b64 v[78:79], 0
    v_mov_b64 v[82:83], 0
    s_nop 0
    v_mfma_f32_16x16x32_bf16 v[204:207], v[36:39], v[112:115], v[204:207]
    ds_read_b128 v[36:39], v18 offset:18944
    v_mfma_f32_16x16x32_bf16 v[212:215], v[40:43], v[112:115], v[212:215]
    ds_read_b128 v[40:43], v18 offset:19200
    s_waitcnt lgkmcnt(0)
    v_mfma_f32_16x16x32_bf16 v[188:191], v[28:31], v[116:119], v[188:191]
    v_mfma_f32_16x16x32_bf16 v[196:199], v[32:35], v[116:119], v[196:199]
    v_mfma_f32_16x16x32_bf16 v[204:207], v[36:39], v[116:119], v[204:207]
    v_mfma_f32_16x16x32_bf16 v[212:215], v[40:43], v[116:119], v[212:215]
    s_barrier
    ds_read_b64 v[28:29], v4 offset:0
    ds_read_b128 v[160:163], v6 offset:0
    ds_read_b64 v[30:31], v4 offset:32
    ds_read_b128 v[164:167], v6 offset:64
    ds_read_b64 v[32:33], v4 offset:64
    ds_read_b128 v[168:171], v6 offset:128
    ds_read_b64 v[34:35], v4 offset:96
    ds_read_b128 v[172:175], v6 offset:192
    ds_read_b64 v[36:37], v5
    ds_read_b128 v[176:179], v23
    s_mul_i32 s49, s3, 4608
    s_add_u32 s49, s49, 49152
    v_add_u32 v73, s49, v27
    s_waitcnt lgkmcnt(9)
    v_lshlrev_b32 v44, 16, v28
    v_and_b32 v45, 0xffff0000, v28
    v_lshlrev_b32 v46, 16, v29
    s_branch L_skip_10
    s_nop 0
L_stub_10:
    s_branch L_back_c3
L_skip_10:
    v_and_b32 v47, 0xffff0000, v29
    s_waitcnt lgkmcnt(7)
    v_lshlrev_b32 v48, 16, v30
    v_and_b32 v49, 0xffff0000, v30
    v_lshlrev_b32 v50, 16, v31
    v_and_b32 v51, 0xffff0000, v31
    s_waitcnt lgkmcnt(5)
    v_lshlrev_b32 v52, 16, v32
    v_and_b32 v53, 0xffff0000, v32
    v_lshlrev_b32 v54, 16, v33
    v_and_b32 v55, 0xffff0000, v33
    s_waitcnt lgkmcnt(3)
    v_lshlrev_b32 v56, 16, v34
    v_and_b32 v57, 0xffff0000, v34
    v_lshlrev_b32 v58, 16, v35
    v_and_b32 v59, 0xffff0000, v35
    s_waitcnt lgkmcnt(1)
    v_lshlrev_b32 v60, 16, v36
    v_and_b32 v61, 0xffff0000, v36
    v_lshlrev_b32 v62, 16, v37
    v_and_b32 v63, 0xffff0000, v37
    s_waitcnt vmcnt(0)
    v_mov_b32 v133, 0
    v_mov_b64 v[134:135], 0
    v_mov_b64 v[146:147], 0
    buffer_load_dwordx4 v[124:127], v9, s[36:39], s64 offen offset:0 sc1
    buffer_load_dwordx4 v[128:131], v9, s[36:39], s64 offen offset:1024 sc1
    buffer_load_dword v132, v27, s[36:39], s64 offen offset:2048 sc1
    s_barrier
    ds_read_b128 v[136:139], v71 offset:0
    ds_read_b128 v[140:143], v71 offset:1024
    ds_read_b128 v[148:151], v71 offset:2304
    ds_read_b128 v[152:155], v71 offset:3328
    ds_read_b32 v144, v73 offset:2048
    ds_read_b32 v145, v73 offset:4352
    s_waitcnt lgkmcnt(5)
    v_mfma_f32_16x16x32_bf16 v[188:191], v[80:83], v[136:139], v[188:191]
    v_mfma_f32_16x16x32_bf16 v[196:199], v[78:81], v[136:139], v[196:199]
    s_waitcnt lgkmcnt(4)
    v_mfma_f32_16x16x32_bf16 v[204:207], v[80:83], v[140:143], v[204:207]
    v_mfma_f32_16x16x32_bf16 v[212:215], v[78:81], v[140:143], v[212:215]
    s_waitcnt lgkmcnt(3)
    v_mfma_f32_16x16x32_bf16 v[188:191], v[80:83], v[148:151], v[188:191]
    v_mfma_f32_16x16x32_bf16 v[196:199], v[78:81], v[148:151], v[196:199]
    s_waitcnt lgkmcnt(2)
    v_mfma_f32_16x16x32_bf16 v[204:207], v[80:83], v[152:155], v[204:207]
    v_mfma_f32_16x16x32_bf16 v[212:215], v[78:81], v[152:155], v[212:215]
    s_waitcnt lgkmcnt(0)
    v_mfma_f32_16x16x32_bf16 v[220:223], v[76:79], v[144:147], v[220:223]
    s_waitcnt vmcnt(0)
    v_max3_u32 v10, v124, v128, v132
    v_cmp_eq_u32 vcc, -1, v10
    s_nop 0
    s_cbranch_vccz L_m_27
Lp_m_28:
    buffer_load_dwordx4 v[124:127], v9, s[36:39], s64 offen offset:0 sc1
    buffer_load_dwordx4 v[128:131], v9, s[36:39], s64 offen offset:1024 sc1
    buffer_load_dword v132, v27, s[36:39], s64 offen offset:2048 sc1
    s_waitcnt vmcnt(0)
    v_max3_u32 v10, v124, v128, v132
    v_cmp_eq_u32 vcc, -1, v10
    s_nop 0
    s_cbranch_vccz Le_m_29
    s_sub_u32 s7, s7, 1
    s_cbranch_scc1 Le_m_29
    s_mov_b64 exec, vcc
    s_sleep 1
    s_branch Lp_m_28
Le_m_29:
    s_mov_b64 exec, -1
    s_max_i32 s7, s7, 0
L_m_27:
    v_mfma_f32_16x16x32_bf16 v[188:191], v[80:83], v[124:127], v[188:191]
    v_mfma_f32_16x16x32_bf16 v[196:199], v[78:81], v[124:127], v[196:199]
    v_mfma_f32_16x16x32_bf16 v[204:207], v[80:83], v[128:131], v[204:207]
    v_mfma_f32_16x16x32_bf16 v[212:215], v[78:81], v[128:131], v[212:215]
    v_mfma_f32_16x16x32_bf16 v[220:223], v[76:79], v[132:135], v[220:223]
    s_nop 3
    v_pk_fma_f32 v[44:45], v[188:189], v[160:161], v[44:45]
    v_pk_fma_f32 v[46:47], v[190:191], v[162:163], v[46:47]
    v_cvt_pk_bf16_f32 v28, v44, v45
    v_cvt_pk_bf16_f32 v29, v46, v47
    ds_write_b64 v4, v[28:29] offset:0
    v_pk_fma_f32 v[48:49], v[196:197], v[164:165], v[48:49]
    v_pk_fma_f32 v[50:51], v[198:199], v[166:167], v[50:51]
    v_cvt_pk_bf16_f32 v30, v48, v49
    v_cvt_pk_bf16_f32 v31, v50, v51
    ds_write_b64 v4, v[30:31] offset:32
    v_pk_fma_f32 v[52:53], v[204:205], v[168:169], v[52:53]
    v_pk_fma_f32 v[54:55], v[206:207], v[170:171], v[54:55]
    v_cvt_pk_bf16_f32 v32, v52, v53
    v_cvt_pk_bf16_f32 v33, v54, v55
    ds_write_b64 v4, v[32:33] offset:64
    v_pk_fma_f32 v[56:57], v[212:213], v[172:173], v[56:57]
    v_pk_fma_f32 v[58:59], v[214:215], v[174:175], v[58:59]
    v_cvt_pk_bf16_f32 v34, v56, v57
    v_cvt_pk_bf16_f32 v35, v58, v59
    ds_write_b64 v4, v[34:35] offset:96
    v_pk_fma_f32 v[60:61], v[220:221], v[176:177], v[60:61]
    v_pk_fma_f32 v[62:63], v[222:223], v[178:179], v[62:63]
    v_cvt_pk_bf16_f32 v36, v60, v61
    v_cvt_pk_bf16_f32 v37, v62, v63
    ds_write_b64 v5, v[36:37]
    ds_read_b128 v[160:163], v7 offset:0
    ds_read_b128 v[164:167], v7 offset:1024
    ds_read_b128 v[168:171], v7 offset:2048
    s_waitcnt lgkmcnt(2)
    buffer_store_dwordx4 v[160:163], v68, s[44:47], s62 offen sc1
    s_waitcnt lgkmcnt(1)
    buffer_store_dwordx4 v[164:167], v69, s[44:47], s62 offen sc1
    s_waitcnt lgkmcnt(0)
    buffer_store_dwordx4 v[168:171], v70, s[44:47], s62 offen sc1
    s_branch L_end
L_m_30:
    s_sub_u32 s61, s63, 54
    s_lshr_b32 s62, s61, 1
    s_add_u32 s62, s62, 18
    s_and_b32 s61, s61, 1
    s_cmp_ge_u32 s5, 16
    s_cbranch_scc1 L_m_35
    s_lshl_b32 s67, s4, 4
    s_add_u32 s67, s67, s5
    s_and_b32 s67, s67, 127
    s_lshl_b32 s48, s3, 9
    s_add_u32 s48, s48, s67
    s_mul_i32 s69, s3, 6144
    s_add_u32 s69, s69, 36864
    s_cmp_eq_u32 s67, 0
    s_cselect_b32 s68, 38, 0
    s_add_u32 s68, s68, 152
    v_mov_b32 v8, 2146435072
    v_add_u32 v4, 0, v0
    v_mul_u32_u24 v5, 1725, v4
    v_lshrrev_b32 v5, 16, v5
    v_mul_u32_u24 v6, 38, v5
    v_sub_u32 v6, v4, v6
    v_cmp_gt_u32 vcc, s68, v4
    v_lshl_add_u32 v5, v5, 7, s48
    v_and_b32 v5, 2047, v5
    v_mul_u32_u24 v5, 578, v5
    v_and_b32 v5, 0xfffffff0, v5
    v_lshl_add_u32 v5, v6, 4, v5
    v_cndmask_b32 v20, v8, v5, vcc
    v_add_u32 v4, 64, v0
    v_mul_u32_u24 v5, 1725, v4
    v_lshrrev_b32 v5, 16, v5
    v_mul_u32_u24 v6, 38, v5
    v_sub_u32 v6, v4, v6
    v_cmp_gt_u32 vcc, s68, v4
    v_lshl_add_u32 v5, v5, 7, s48
    v_and_b32 v5, 2047, v5
    v_mul_u32_u24 v5, 578, v5
    v_and_b32 v5, 0xfffffff0, v5
    v_lshl_add_u32 v5, v6, 4, v5
    v_cndmask_b32 v21, v8, v5, vcc
    v_add_u32 v4, 128, v0
    v_mul_u32_u24 v5, 1725, v4
    v_lshrrev_b32 v5, 16, v5
    v_mul_u32_u24 v6, 38, v5
    v_sub_u32 v6, v4, v6
    v_cmp_gt_u32 vcc, s68, v4
    v_lshl_add_u32 v5, v5, 7, s48
    v_and_b32 v5, 2047, v5
    v_mul_u32_u24 v5, 578, v5
    v_and_b32 v5, 0xfffffff0, v5
    v_lshl_add_u32 v5, v6, 4, v5
    v_cndmask_b32 v22, v8, v5, vcc
    s_waitcnt lgkmcnt(0)
    s_mov_b32 s36, s32
    s_mov_b32 s37, s33
    s_mov_b32 s38, 50331648
    s_mov_b32 s39, 0x20000
    s_mov_b32 s40, s26
    s_mov_b32 s41, s27
    s_mov_b32 s42, 3981312
    s_mov_b32 s43, 0x20000
    v_mov_b32 v4, 32768
    buffer_load_dword v3, v4, s[36:39], 0 offen sc1
    s_lshr_b32 s51, s5, 2
    s_lshl_b32 s51, s51, 3
    s_add_u32 s51, s51, s4
    s_and_b32 s60, s5, 3
    s_lshl_b32 s35, s51, 2
    s_add_u32 s35, s35, s60
    s_lshl_b32 s35, s35, 14
    s_bfe_u32 s48, s6, 0x20002
    s_lshl_b32 s48, s48, 6
    s_lshr_b32 s49, s6, 4
    s_lshl_b32 s49, s49, 2
    s_add_u32 s48, s48, s49
    s_and_b32 s49, s6, 3
    s_add_u32 s48, s48, s49
    s_lshl_b32 s48, s48, 4
    s_lshl_b32 s49, s3, 16
    s_add_u32 s48, s48, s49
    s_add_u32 s48, s48, 15728640
    v_mov_b32 v17, 2146435072
    v_writelane_b32 v17, s48, 0
    s_add_u32 s48, s48, 16384
    s_add_u32 s48, s2, 160
    s_lshl_b32 s48, s48, 7
    s_add_u32 s48, s48, 557056
    s_lshl_b32 s49, s3, 8
    s_add_u32 s49, s49, s5
    s_cmp_lt_u32 s49, 12
    s_cselect_b32 s48, s48, 2146435072
    v_mov_b32 v19, 2146435072
    v_writelane_b32 v19, s48, 0
    s_or_b32 s48, s2, s3
    s_cmp_eq_u32 s48, 0
    s_cselect_b32 s48, 0, 2146435072
    s_add_u32 s48, s48, 32768
    v_writelane_b32 v19, s48, 1
    buffer_load_dword v220, v17, s[36:39], 0 offen
    buffer_load_dword v221, v19, s[36:39], 0 offen
    v_cvt_f32_u32 v218, v2
    v_mul_f32 v218, 4.0, v218
    v_cvt_f32_u32 v219, v1
    v_cvt_f32_u32 v13, s4
    v_mul_f32 v10, 0x3d800000, v219
    v_fmac_f32 v10, 0x3c000000, v13
    v_mul_f32 v11, v218, v10
    v_cos_f32 v5, v11
    v_sin_f32 v6, v11
    s_nop 0
    v_cvt_pk_bf16_f32 v52, v5, v6
    v_cvt_pk_bf16_f32 v56, -v6, v5
    v_fma_f32 v7, v10, 1.0, v11
    v_cos_f32 v8, v7
    v_sin_f32 v9, v7
    s_nop 0
    v_cvt_pk_bf16_f32 v53, v8, v9
    v_cvt_pk_bf16_f32 v57, -v9, v8
    v_fma_f32 v4, v10, 2.0, v11
    v_cos_f32 v5, v4
    v_sin_f32 v6, v4
    s_nop 0
    v_cvt_pk_bf16_f32 v54, v5, v6
    v_cvt_pk_bf16_f32 v58, -v6, v5
    v_add_f32 v7, v4, v10
    v_cos_f32 v8, v7
    v_sin_f32 v9, v7
    s_nop 0
    v_cvt_pk_bf16_f32 v55, v8, v9
    v_cvt_pk_bf16_f32 v59, -v9, v8
    s_lshl_b32 s48, s3, 5
    s_add_u32 s48, s48, s4
    v_cvt_f32_u32 v14, s48
    v_mul_f32 v14, 0x3a000000, v14
    v_mul_f32 v10, 0x3d800000, v219
    v_add_f32 v10, v10, v14
    v_mul_f32 v11, v218, v10
    v_cos_f32 v5, v11
    v_sin_f32 v6, v11
    s_nop 0
    v_cvt_pk_bf16_f32 v68, v5, v6
    v_cvt_pk_bf16_f32 v72, -v6, v5
    v_fma_f32 v7, v10, 1.0, v11
    v_cos_f32 v8, v7
    v_sin_f32 v9, v7
    s_nop 0
    v_cvt_pk_bf16_f32 v69, v8, v9
    v_cvt_pk_bf16_f32 v73, -v9, v8
    v_fma_f32 v4, v10, 2.0, v11
    v_cos_f32 v5, v4
    v_sin_f32 v6, v4
    s_nop 0
    v_cvt_pk_bf16_f32 v70, v5, v6
    v_cvt_pk_bf16_f32 v74, -v6, v5
    v_add_f32 v7, v4, v10
    v_cos_f32 v8, v7
    v_sin_f32 v9, v7
    s_nop 0
    v_cvt_pk_bf16_f32 v71, v8, v9
    v_cvt_pk_bf16_f32 v75, -v9, v8
    v_add_f32 v10, 0x3b800000, v10
    v_mul_f32 v11, v218, v10
    v_cos_f32 v5, v11
    v_sin_f32 v6, v11
    s_nop 0
    v_cvt_pk_bf16_f32 v76, v5, v6
    v_cvt_pk_bf16_f32 v80, -v6, v5
    v_fma_f32 v7, v10, 1.0, v11
    v_cos_f32 v8, v7
    v_sin_f32 v9, v7
    s_nop 0
    v_cvt_pk_bf16_f32 v77, v8, v9
    v_cvt_pk_bf16_f32 v81, -v9, v8
    v_fma_f32 v4, v10, 2.0, v11
    v_cos_f32 v5, v4
    v_sin_f32 v6, v4
    s_nop 0
    v_cvt_pk_bf16_f32 v78, v5, v6
    v_cvt_pk_bf16_f32 v82, -v6, v5
    v_add_f32 v7, v4, v10
    v_cos_f32 v8, v7
    v_sin_f32 v9, v7
    s_nop 0
    v_cvt_pk_bf16_f32 v79, v8, v9
    v_cvt_pk_bf16_f32 v83, -v9, v8
    v_add_f32 v10, 0x3b800000, v10
    v_mul_f32 v11, v218, v10
    v_cos_f32 v5, v11
    v_sin_f32 v6, v11
    s_nop 0
    v_cvt_pk_bf16_f32 v84, v5, v6
    v_cvt_pk_bf16_f32 v88, -v6, v5
    v_fma_f32 v7, v10, 1.0, v11
    v_cos_f32 v8, v7
    v_sin_f32 v9, v7
    s_nop 0
    v_cvt_pk_bf16_f32 v85, v8, v9
    v_cvt_pk_bf16_f32 v89, -v9, v8
    v_fma_f32 v4, v10, 2.0, v11
    v_cos_f32 v5, v4
    v_sin_f32 v6, v4
    s_nop 0
    v_cvt_pk_bf16_f32 v86, v5, v6
    v_cvt_pk_bf16_f32 v90, -v6, v5
    v_add_f32 v7, v4, v10
    v_cos_f32 v8, v7
    v_sin_f32 v9, v7
    s_nop 0
    v_cvt_pk_bf16_f32 v87, v8, v9
    v_cvt_pk_bf16_f32 v91, -v9, v8
    v_add_f32 v10, 0x3b800000, v10
    v_mul_f32 v11, v218, v10
    v_cos_f32 v5, v11
    v_sin_f32 v6, v11
    s_nop 0
    v_cvt_pk_bf16_f32 v92, v5, v6
    v_cvt_pk_bf16_f32 v96, -v6, v5
    v_fma_f32 v7, v10, 1.0, v11
    v_cos_f32 v8, v7
    v_sin_f32 v9, v7
    s_nop 0
    v_cvt_pk_bf16_f32 v93, v8, v9
    v_cvt_pk_bf16_f32 v97, -v9, v8
    v_fma_f32 v4, v10, 2.0, v11
    v_cos_f32 v5, v4
    v_sin_f32 v6, v4
    s_nop 0
    v_cvt_pk_bf16_f32 v94, v5, v6
    v_cvt_pk_bf16_f32 v98, -v6, v5
    v_add_f32 v7, v4, v10
    v_cos_f32 v8, v7
    v_sin_f32 v9, v7
    s_nop 0
    v_cvt_pk_bf16_f32 v95, v8, v9
    v_cvt_pk_bf16_f32 v99, -v9, v8
    s_barrier
    s_mov_b32 s52, s10
    s_mov_b32 s53, s11
    s_mov_b32 s54, 1183744
    s_mov_b32 s55, 0x20000
    s_mov_b32 s56, s12
    s_mov_b32 s57, s13
    s_mov_b32 s58, 1183744
    s_mov_b32 s59, 0x20000
    s_add_u32 m0, s69, 0
    s_nop 0
    buffer_load_dwordx4 v20, s[52:55], 0 offen lds
    s_add_u32 m0, s69, 1024
    s_nop 0
    buffer_load_dwordx4 v21, s[52:55], 0 offen lds
    s_add_u32 m0, s69, 2048
    s_nop 0
    buffer_load_dwordx4 v22, s[52:55], 0 offen lds
    s_add_u32 m0, s69, 3072
    s_nop 0
    buffer_load_dwordx4 v20, s[56:59], 0 offen lds
    s_add_u32 m0, s69, 4096
    s_nop 0
    buffer_load_dwordx4 v21, s[56:59], 0 offen lds
    s_add_u32 m0, s69, 5120
    s_nop 0
    buffer_load_dwordx4 v22, s[56:59], 0 offen lds
    s_lshl_b32 s48, s67, 1
    s_and_b32 s48, s48, 15
    s_add_u32 s48, s48, s69
    v_and_b32 v4, 1, v2
    v_lshrrev_b32 v5, 1, v2
    v_mul_u32_u24 v6, 144, v4
    v_mad_u32_u24 v6, v1, 9, v6
    v_add_lshl_u32 v6, v6, v5, 1
    v_add_u32 v20, s48, v6
    s_cmp_eq_u32 s67, 0
    s_cselect_b32 s49, 608, 0
    s_add_u32 s48, s48, s49
    s_add_u32 s48, s48, 568
    v_sub_u32 v21, s48, v6
    v_lshl_add_u32 v4, v5, 5, v4
    v_lshlrev_b32 v4, 14, v4
    v_lshl_add_u32 v23, v1, 4, v4
    v_add_u32 v24, 1048576, v23
    v_add_u32 v25, 2097152, v23
    v_cmp_gt_u32 vcc, 32, v0
    v_mov_b32 v8, 2146435072
    s_nop 0
    v_cndmask_b32 v25, v8, v25, vcc
    s_lshl_b32 s48, s67, 2
    s_add_u32 s48, s48, s3
    s_lshl_b32 s48, s48, 4
    s_add_u32 s48, s48, 262144
    v_writelane_b32 v18, s48, 0
    buffer_load_dword v222, v18, s[36:39], 0 offen
    s_mov_b32 s48, s67
    s_mov_b32 s49, s3
    s_and_b32 s50, s48, 7
    s_lshr_b32 s48, s48, 3
    s_lshl_b32 s58, s50, 16
    s_lshl_b32 s59, s48, 10
    s_add_u32 s58, s58, s59
    s_lshl_b32 s59, s49, 8
    s_add_u32 s58, s58, s59
    s_add_u32 s56, s58, 1048576
    s_sub_u32 s48, 128, s67
    s_and_b32 s48, s48, 127
    s_sub_u32 s49, 3, s3
    s_and_b32 s50, s48, 7
    s_lshr_b32 s48, s48, 3
    s_lshl_b32 s58, s50, 16
    s_lshl_b32 s59, s48, 10
    s_add_u32 s58, s58, s59
    s_lshl_b32 s59, s49, 8
    s_add_u32 s58, s58, s59
    s_add_u32 s57, s58, 1081344
    s_waitcnt vmcnt(0)
    s_mov_b32 s48, 0x9e3779b1
    v_mul_lo_u32 v3, v3, s48
    v_add_u32 v3, 0x7f4a7c15, v3
    v_or_b32 v3, 0x01010101, v3
    ds_read_u16 v132, v20 offset:0
    ds_read_u16 v136, v20 offset:3072
    ds_read_u16 v133, v20 offset:608
    ds_read_u16 v137, v20 offset:3680
    ds_read_u16 v134, v20 offset:1216
    ds_read_u16 v138, v20 offset:4288
    ds_read_u16 v135, v20 offset:1824
    ds_read_u16 v139, v20 offset:4896
    ds_read_u16 v140, v20 offset:4
    ds_read_u16 v144, v20 offset:3076
    ds_read_u16 v141, v20 offset:612
    ds_read_u16 v145, v20 offset:3684
    ds_read_u16 v142, v20 offset:1220
    ds_read_u16 v146, v20 offset:4292
    ds_read_u16 v143, v20 offset:1828
    ds_read_u16 v147, v20 offset:4900
    ds_read_u16 v148, v20 offset:8
    ds_read_u16 v152, v20 offset:3080
    ds_read_u16 v149, v20 offset:616
    ds_read_u16 v153, v20 offset:3688
    ds_read_u16 v150, v20 offset:1224
    ds_read_u16 v154, v20 offset:4296
    ds_read_u16 v151, v20 offset:1832
    ds_read_u16 v155, v20 offset:4904
    ds_read_u16 v156, v21 offset:1832
    ds_read_u16 v160, v21 offset:4904
    ds_read_u16 v157, v21 offset:1224
    ds_read_u16 v161, v21 offset:4296
    ds_read_u16 v158, v21 offset:616
    ds_read_u16 v162, v21 offset:3688
    ds_read_u16 v159, v21 offset:8
    ds_read_u16 v163, v21 offset:3080
    ds_read_u16 v164, v21 offset:1828
    ds_read_u16 v168, v21 offset:4900
    ds_read_u16 v165, v21 offset:1220
    ds_read_u16 v169, v21 offset:4292
    ds_read_u16 v166, v21 offset:612
    ds_read_u16 v170, v21 offset:3684
    ds_read_u16 v167, v21 offset:4
    ds_read_u16 v171, v21 offset:3076
    ds_read_u16 v172, v21 offset:1824
    ds_read_u16 v176, v21 offset:4896
    ds_read_u16 v173, v21 offset:1216
    ds_read_u16 v177, v21 offset:4288
    ds_read_u16 v174, v21 offset:608
    ds_read_u16 v178, v21 offset:3680
    ds_read_u16 v175, v21 offset:0
    ds_read_u16 v179, v21 offset:3072
    s_waitcnt lgkmcnt(14)
    v_lshl_or_b32 v132, v136, 16, v132
    v_lshl_or_b32 v133, v137, 16, v133
    v_lshl_or_b32 v134, v138, 16, v134
    v_lshl_or_b32 v135, v139, 16, v135
    buffer_store_dwordx4 v[132:135], v23, s[36:39], s56 offen sc1
    v_lshl_or_b32 v140, v144, 16, v140
    v_lshl_or_b32 v141, v145, 16, v141
    v_lshl_or_b32 v142, v146, 16, v142
    v_lshl_or_b32 v143, v147, 16, v143
    buffer_store_dwordx4 v[140:143], v24, s[36:39], s56 offen sc1
    v_lshl_or_b32 v148, v152, 16, v148
    v_lshl_or_b32 v149, v153, 16, v149
    v_lshl_or_b32 v150, v154, 16, v150
    v_lshl_or_b32 v151, v155, 16, v151
    buffer_store_dwordx4 v[148:151], v25, s[36:39], s56 offen sc1
    v_lshl_or_b32 v156, v160, 16, v156
    v_lshl_or_b32 v157, v161, 16, v157
    v_lshl_or_b32 v158, v162, 16, v158
    v_lshl_or_b32 v159, v163, 16, v159
    v_xor_b32 v156, 0x80000000, v156
    v_xor_b32 v157, 0x80000000, v157
    v_xor_b32 v158, 0x80000000, v158
    v_xor_b32 v159, 0x80000000, v159
    buffer_store_dwordx4 v[156:159], v23, s[36:39], s57 offen sc1
    v_lshl_or_b32 v164, v168, 16, v164
    s_waitcnt lgkmcnt(12)
    v_lshl_or_b32 v165, v169, 16, v165
    s_waitcnt lgkmcnt(10)
    v_lshl_or_b32 v166, v170, 16, v166
    s_waitcnt lgkmcnt(8)
    v_lshl_or_b32 v167, v171, 16, v167
    v_xor_b32 v164, 0x80000000, v164
    v_xor_b32 v165, 0x80000000, v165
    v_xor_b32 v166, 0x80000000, v166
    v_xor_b32 v167, 0x80000000, v167
    buffer_store_dwordx4 v[164:167], v24, s[36:39], s57 offen sc1
    s_waitcnt lgkmcnt(6)
    v_lshl_or_b32 v172, v176, 16, v172
    s_waitcnt lgkmcnt(4)
    v_lshl_or_b32 v173, v177, 16, v173
    s_waitcnt lgkmcnt(2)
    v_lshl_or_b32 v174, v178, 16, v174
    s_waitcnt lgkmcnt(0)
    v_lshl_or_b32 v175, v179, 16, v175
    v_xor_b32 v172, 0x80000000, v172
    v_xor_b32 v173, 0x80000000, v173
    v_xor_b32 v174, 0x80000000, v174
    v_xor_b32 v175, 0x80000000, v175
    buffer_store_dwordx4 v[172:175], v25, s[36:39], s57 offen sc1
    s_branch L_m_34
L_m_35:
    v_lshrrev_b32 v4, 3, v0
    v_and_b32 v5, 7, v0
    v_and_b32 v6, 6, v4
    v_xor_b32 v5, v5, v6
    v_mul_u32_u24 v4, 6912, v4
    v_lshl_add_u32 v12, v5, 4, v4
    s_lshl_b32 s48, s61, 2
    s_add_u32 s48, s48, s3
    s_mul_i32 s48, s48, 497664
    s_lshl_b32 s49, s62, 7
    s_add_u32 s47, s48, s49
    s_lshl_b32 s50, s3, 8
    v_lshl_add_u32 v27, v0, 2, s50
    s_mul_i32 s49, s61, 576
    v_add_u32 v9, s49, v27
    v_add_u32 v12, s47, v12
    v_lshrrev_b32 v4, 2, v0
    v_bfe_u32 v5, v4, 1, 2
    v_xor_b32 v5, s3, v5
    v_lshlrev_b32 v5, 5, v5
    v_lshlrev_b32 v4, 7, v4
    v_and_b32 v6, 3, v0
    v_lshlrev_b32 v6, 3, v6
    v_add3_u32 v28, v4, v5, v6
    v_lshlrev_b32 v29, 3, v2
    v_add_u32 v29, 90112, v29
    s_mul_i32 s49, s61, 9216
    s_lshl_b32 s50, s62, 8
    s_add_u32 s49, s49, s50
    s_lshl_b32 s50, s3, 6
    s_add_u32 s49, s49, s50
    s_add_u32 s49, s49, 192000
    v_lshl_add_u32 v4, v1, 2, s49
    v_cmp_gt_u32 vcc, 16, v0
    v_mov_b32 v5, 2146435072
    s_nop 0
    v_cndmask_b32 v30, v5, v4, vcc
    s_waitcnt lgkmcnt(0)
    s_mov_b32 s36, s32
    s_mov_b32 s37, s33
    s_mov_b32 s38, 50331648
    s_mov_b32 s39, 0x20000
    s_mov_b32 s40, s26
    s_mov_b32 s41, s27
    s_mov_b32 s42, 3981312
    s_mov_b32 s43, 0x20000
    v_mov_b32 v4, 32768
    buffer_load_dword v3, v4, s[36:39], 0 offen sc1
    s_mov_b32 s44, s24
    s_mov_b32 s45, s25
    s_mov_b32 s46, 1152
    s_mov_b32 s47, 0x20000
    buffer_load_dword v26, v9, s[44:47], 0 offen
    s_lshr_b32 s51, s5, 2
    s_lshl_b32 s51, s51, 3
    s_add_u32 s51, s51, s4
    s_and_b32 s60, s5, 3
    s_lshl_b32 s35, s51, 2
    s_add_u32 s35, s35, s60
    s_lshl_b32 s35, s35, 14
    s_bfe_u32 s48, s6, 0x20002
    s_lshl_b32 s48, s48, 6
    s_lshr_b32 s49, s6, 4
    s_lshl_b32 s49, s49, 2
    s_add_u32 s48, s48, s49
    s_and_b32 s49, s6, 3
    s_add_u32 s48, s48, s49
    s_lshl_b32 s48, s48, 4
    s_lshl_b32 s49, s3, 16
    s_add_u32 s48, s48, s49
    s_add_u32 s48, s48, 15728640
    v_mov_b32 v17, 2146435072
    v_writelane_b32 v17, s48, 0
    s_add_u32 s48, s48, 16384
    s_add_u32 s48, s2, 160
    s_lshl_b32 s48, s48, 7
    s_add_u32 s48, s48, 557056
    s_lshl_b32 s49, s3, 8
    s_add_u32 s49, s49, s5
    s_cmp_lt_u32 s49, 12
    s_cselect_b32 s48, s48, 2146435072
    v_mov_b32 v19, 2146435072
    v_writelane_b32 v19, s48, 0
    s_or_b32 s48, s2, s3
    s_cmp_eq_u32 s48, 0
    s_cselect_b32 s48, 0, 2146435072
    s_add_u32 s48, s48, 32768
    v_writelane_b32 v19, s48, 1
    buffer_load_dword v220, v17, s[36:39], 0 offen
    buffer_load_dword v221, v19, s[36:39], 0 offen
    buffer_load_dword v222, v30, s[36:39], 0 offen
    s_cmp_ge_u32 s63, 126
    s_cbranch_scc1 L_m_37
    s_mul_i32 m0, s3, 9216
    s_mov_b32 s59, 0
    buffer_load_dwordx4 v12, s[40:43], s59 offen lds
    s_add_u32 m0, m0, 1024
    s_add_u32 s59, s59, 55296
    buffer_load_dwordx4 v12, s[40:43], s59 offen lds
    s_add_u32 m0, m0, 1024
    s_add_u32 s59, s59, 55296
L_m_37:
    s_barrier
    s_waitcnt vmcnt(0)
    s_cmp_ge_u32 s63, 126
    s_cbranch_scc1 L_m_38
    buffer_load_dwordx4 v12, s[40:43], s59 offen lds
    s_add_u32 m0, m0, 1024
    s_add_u32 s59, s59, 55296
    buffer_load_dwordx4 v12, s[40:43], s59 offen lds
    s_add_u32 m0, m0, 1024
    s_add_u32 s59, s59, 55296
    buffer_load_dwordx4 v12, s[40:43], s59 offen lds
    s_add_u32 m0, m0, 1024
    s_add_u32 s59, s59, 55296
    buffer_load_dwordx4 v12, s[40:43], s59 offen lds
    s_add_u32 m0, m0, 1024
    s_add_u32 s59, s59, 55296
    buffer_load_dwordx4 v12, s[40:43], s59 offen lds
    s_add_u32 m0, m0, 1024
    s_add_u32 s59, s59, 55296
    buffer_load_dwordx4 v12, s[40:43], s59 offen lds
    s_add_u32 m0, m0, 1024
    s_add_u32 s59, s59, 55296
    buffer_load_dwordx4 v12, s[40:43], s59 offen lds
L_m_38:
    s_mov_b32 s48, 0x9e3779b1
    v_mul_lo_u32 v3, v3, s48
    v_add_u32 v3, 0x7f4a7c15, v3
    v_or_b32 v3, 0x01010101, v3
    v_lshlrev_b32 v4, 16, v26
    v_and_b32 v5, 0xffff0000, v26
    v_mul_f32 v6, 0xbfb8aa3b, v4
    v_mul_f32 v7, 0xbfb8aa3b, v5
    v_exp_f32 v6, v6
    v_exp_f32 v7, v7
    v_add_f32 v6, 1.0, v6
    v_add_f32 v7, 1.0, v7
    v_rcp_f32 v6, v6
    v_rcp_f32 v7, v7
    v_mul_f32 v4, v4, v6
    v_mul_f32 v5, v5, v7
    v_cvt_pk_bf16_f32 v26, v4, v5
    v_add_u32 v27, 90112, v27
    ds_write_b32 v27, v26
    s_cmp_ge_u32 s5, 20
    s_cbranch_scc1 L_m_39
    v_cvt_f32_u32 v218, v2
    v_mul_f32 v218, 4.0, v218
    v_cvt_f32_u32 v219, v1
    v_cvt_f32_u32 v13, s4
    v_mul_f32 v10, 0x3d800000, v219
    v_fmac_f32 v10, 0x3c000000, v13
    v_mul_f32 v11, v218, v10
    v_cos_f32 v5, v11
    v_sin_f32 v6, v11
    s_nop 0
    v_cvt_pk_bf16_f32 v52, v5, v6
    v_cvt_pk_bf16_f32 v56, -v6, v5
    v_fma_f32 v7, v10, 1.0, v11
    v_cos_f32 v8, v7
    v_sin_f32 v9, v7
    s_nop 0
    v_cvt_pk_bf16_f32 v53, v8, v9
    v_cvt_pk_bf16_f32 v57, -v9, v8
    v_fma_f32 v4, v10, 2.0, v11
    v_cos_f32 v5, v4
    v_sin_f32 v6, v4
    s_nop 0
    v_cvt_pk_bf16_f32 v54, v5, v6
    v_cvt_pk_bf16_f32 v58, -v6, v5
    v_add_f32 v7, v4, v10
    v_cos_f32 v8, v7
    v_sin_f32 v9, v7
    s_nop 0
    v_cvt_pk_bf16_f32 v55, v8, v9
    v_cvt_pk_bf16_f32 v59, -v9, v8
    s_lshl_b32 s48, s3, 5
    s_add_u32 s48, s48, s4
    v_cvt_f32_u32 v14, s48
    v_mul_f32 v14, 0x3a000000, v14
    v_mul_f32 v10, 0x3d800000, v219
    v_add_f32 v10, v10, v14
    v_mul_f32 v11, v218, v10
    v_cos_f32 v5, v11
    v_sin_f32 v6, v11
    s_nop 0
    v_cvt_pk_bf16_f32 v68, v5, v6
    v_cvt_pk_bf16_f32 v72, -v6, v5
    v_fma_f32 v7, v10, 1.0, v11
    v_cos_f32 v8, v7
    v_sin_f32 v9, v7
    s_nop 0
    v_cvt_pk_bf16_f32 v69, v8, v9
    v_cvt_pk_bf16_f32 v73, -v9, v8
    v_fma_f32 v4, v10, 2.0, v11
    v_cos_f32 v5, v4
    v_sin_f32 v6, v4
    s_nop 0
    v_cvt_pk_bf16_f32 v70, v5, v6
    v_cvt_pk_bf16_f32 v74, -v6, v5
    v_add_f32 v7, v4, v10
    v_cos_f32 v8, v7
    v_sin_f32 v9, v7
    s_nop 0
    v_cvt_pk_bf16_f32 v71, v8, v9
    v_cvt_pk_bf16_f32 v75, -v9, v8
    v_add_f32 v10, 0x3b800000, v10
    v_mul_f32 v11, v218, v10
    v_cos_f32 v5, v11
    v_sin_f32 v6, v11
    s_nop 0
    v_cvt_pk_bf16_f32 v76, v5, v6
    v_cvt_pk_bf16_f32 v80, -v6, v5
    v_fma_f32 v7, v10, 1.0, v11
    v_cos_f32 v8, v7
    v_sin_f32 v9, v7
    s_nop 0
    v_cvt_pk_bf16_f32 v77, v8, v9
    v_cvt_pk_bf16_f32 v81, -v9, v8
    v_fma_f32 v4, v10, 2.0, v11
    v_cos_f32 v5, v4
    v_sin_f32 v6, v4
    s_nop 0
    v_cvt_pk_bf16_f32 v78, v5, v6
    v_cvt_pk_bf16_f32 v82, -v6, v5
    v_add_f32 v7, v4, v10
    v_cos_f32 v8, v7
    v_sin_f32 v9, v7
    s_nop 0
    v_cvt_pk_bf16_f32 v79, v8, v9
    v_cvt_pk_bf16_f32 v83, -v9, v8
    v_add_f32 v10, 0x3b800000, v10
    v_mul_f32 v11, v218, v10
    v_cos_f32 v5, v11
    v_sin_f32 v6, v11
    s_nop 0
    v_cvt_pk_bf16_f32 v84, v5, v6
    v_cvt_pk_bf16_f32 v88, -v6, v5
    v_fma_f32 v7, v10, 1.0, v11
    v_cos_f32 v8, v7
    v_sin_f32 v9, v7
    s_nop 0
    v_cvt_pk_bf16_f32 v85, v8, v9
    v_cvt_pk_bf16_f32 v89, -v9, v8
    v_fma_f32 v4, v10, 2.0, v11
    v_cos_f32 v5, v4
    v_sin_f32 v6, v4
    s_nop 0
    v_cvt_pk_bf16_f32 v86, v5, v6
    v_cvt_pk_bf16_f32 v90, -v6, v5
    v_add_f32 v7, v4, v10
    v_cos_f32 v8, v7
    v_sin_f32 v9, v7
    s_nop 0
    v_cvt_pk_bf16_f32 v87, v8, v9
    v_cvt_pk_bf16_f32 v91, -v9, v8
    v_add_f32 v10, 0x3b800000, v10
    v_mul_f32 v11, v218, v10
    v_cos_f32 v5, v11
    v_sin_f32 v6, v11
    s_nop 0
    v_cvt_pk_bf16_f32 v92, v5, v6
    v_cvt_pk_bf16_f32 v96, -v6, v5
    v_fma_f32 v7, v10, 1.0, v11
    v_cos_f32 v8, v7
    v_sin_f32 v9, v7
    s_nop 0
    v_cvt_pk_bf16_f32 v93, v8, v9
    v_cvt_pk_bf16_f32 v97, -v9, v8
    v_fma_f32 v4, v10, 2.0, v11
    v_cos_f32 v5, v4
    v_sin_f32 v6, v4
    s_nop 0
    v_cvt_pk_bf16_f32 v94, v5, v6
    v_cvt_pk_bf16_f32 v98, -v6, v5
    v_add_f32 v7, v4, v10
    v_cos_f32 v8, v7
    v_sin_f32 v9, v7
    s_nop 0
    v_cvt_pk_bf16_f32 v95, v8, v9
    v_cvt_pk_bf16_f32 v99, -v9, v8
L_m_39:
L_m_34:
    s_waitcnt lgkmcnt(0)
    s_barrier
    s_cmp_ge_u32 s5, 20
    s_cbranch_scc1 L_m_40
    s_waitcnt vmcnt(0)
    buffer_store_dword v3, v18, s[36:39], 0 offen sc1
    v_mul_f32 v10, 0x3d800000, v219
    v_fmac_f32 v14, 0x3d800000, v218
    v_mul_f32 v11, v219, v14
    v_cos_f32 v5, v11
    v_sin_f32 v6, v11
    s_nop 0
    v_cvt_pk_bf16_f32 v100, v5, -v6
    v_cvt_pk_bf16_f32 v104, v6, v5
    v_fma_f32 v7, v10, 1.0, v11
    v_cos_f32 v8, v7
    v_sin_f32 v9, v7
    s_nop 0
    v_cvt_pk_bf16_f32 v101, v8, -v9
    v_cvt_pk_bf16_f32 v105, v9, v8
    v_fma_f32 v4, v10, 2.0, v11
    v_cos_f32 v5, v4
    v_sin_f32 v6, v4
    s_nop 0
    v_cvt_pk_bf16_f32 v102, v5, -v6
    v_cvt_pk_bf16_f32 v106, v6, v5
    v_add_f32 v7, v4, v10
    v_cos_f32 v8, v7
    v_sin_f32 v9, v7
    s_nop 0
    v_cvt_pk_bf16_f32 v103, v8, -v9
    v_cvt_pk_bf16_f32 v107, v9, v8
    v_add_f32 v14, 0x3b800000, v14
    v_mul_f32 v11, v219, v14
    v_cos_f32 v5, v11
    v_sin_f32 v6, v11
    s_nop 0
    v_cvt_pk_bf16_f32 v108, v5, -v6
    v_cvt_pk_bf16_f32 v112, v6, v5
    v_fma_f32 v7, v10, 1.0, v11
    v_cos_f32 v8, v7
    v_sin_f32 v9, v7
    s_nop 0
    v_cvt_pk_bf16_f32 v109, v8, -v9
    v_cvt_pk_bf16_f32 v113, v9, v8
    v_fma_f32 v4, v10, 2.0, v11
    v_cos_f32 v5, v4
    v_sin_f32 v6, v4
    s_nop 0
    v_cvt_pk_bf16_f32 v110, v5, -v6
    v_cvt_pk_bf16_f32 v114, v6, v5
    v_add_f32 v7, v4, v10
    v_cos_f32 v8, v7
    v_sin_f32 v9, v7
    s_nop 0
    v_cvt_pk_bf16_f32 v111, v8, -v9
    v_cvt_pk_bf16_f32 v115, v9, v8
    v_add_f32 v14, 0x3b800000, v14
    v_mul_f32 v11, v219, v14
    v_cos_f32 v5, v11
    v_sin_f32 v6, v11
    s_nop 0
    v_cvt_pk_bf16_f32 v116, v5, -v6
    v_cvt_pk_bf16_f32 v120, v6, v5
    v_fma_f32 v7, v10, 1.0, v11
    v_cos_f32 v8, v7
    v_sin_f32 v9, v7
    s_nop 0
    v_cvt_pk_bf16_f32 v117, v8, -v9
    v_cvt_pk_bf16_f32 v121, v9, v8
    v_fma_f32 v4, v10, 2.0, v11
    v_cos_f32 v5, v4
    v_sin_f32 v6, v4
    s_nop 0
    v_cvt_pk_bf16_f32 v118, v5, -v6
    v_cvt_pk_bf16_f32 v122, v6, v5
    v_add_f32 v7, v4, v10
    v_cos_f32 v8, v7
    v_sin_f32 v9, v7
    s_nop 0
    v_cvt_pk_bf16_f32 v119, v8, -v9
    v_cvt_pk_bf16_f32 v123, v9, v8
    v_add_f32 v14, 0x3b800000, v14
    v_mul_f32 v11, v219, v14
    v_cos_f32 v5, v11
    v_sin_f32 v6, v11
    s_nop 0
    v_cvt_pk_bf16_f32 v124, v5, -v6
    v_cvt_pk_bf16_f32 v128, v6, v5
    v_fma_f32 v7, v10, 1.0, v11
    v_cos_f32 v8, v7
    v_sin_f32 v9, v7
    s_nop 0
    v_cvt_pk_bf16_f32 v125, v8, -v9
    v_cvt_pk_bf16_f32 v129, v9, v8
    v_fma_f32 v4, v10, 2.0, v11
    v_cos_f32 v5, v4
    v_sin_f32 v6, v4
    s_nop 0
    v_cvt_pk_bf16_f32 v126, v5, -v6
    v_cvt_pk_bf16_f32 v130, v6, v5
    v_add_f32 v7, v4, v10
    v_cos_f32 v8, v7
    v_sin_f32 v9, v7
    s_nop 0
    v_cvt_pk_bf16_f32 v127, v8, -v9
    v_cvt_pk_bf16_f32 v131, v9, v8
    v_mul_f32 v13, 0x3c000000, v13
    v_fmac_f32 v13, 0x3d800000, v218
    v_mul_f32 v11, v219, v13
    v_cos_f32 v5, v11
    v_sin_f32 v6, v11
    s_nop 0
    v_cvt_pk_bf16_f32 v60, v5, -v6
    v_cvt_pk_bf16_f32 v64, v6, v5
    v_fma_f32 v7, v10, 1.0, v11
    v_cos_f32 v8, v7
    v_sin_f32 v9, v7
    s_nop 0
    v_cvt_pk_bf16_f32 v61, v8, -v9
    v_cvt_pk_bf16_f32 v65, v9, v8
    v_fma_f32 v4, v10, 2.0, v11
    v_cos_f32 v5, v4
    v_sin_f32 v6, v4
    s_nop 0
    v_cvt_pk_bf16_f32 v62, v5, -v6
    v_cvt_pk_bf16_f32 v66, v6, v5
    v_add_f32 v7, v4, v10
    v_cos_f32 v8, v7
    v_sin_f32 v9, v7
    s_nop 0
    v_cvt_pk_bf16_f32 v63, v8, -v9
    v_cvt_pk_bf16_f32 v67, v9, v8
L_m_40:
    s_branch L_stub_11
L_back_h1:
    s_waitcnt vmcnt(0)
    s_lshl_b32 s48, s3, 5
    s_add_u32 s48, s48, s4
    v_lshrrev_b32 v8, 2, v1
    v_lshl_add_u32 v8, v8, 3, s48
    s_cmp_lt_u32 s60, 2
    s_cselect_b32 s48, 1, -1
    v_mul_i32_i24 v8, s48, v8
    v_and_b32 v8, 127, v8
    v_and_b32 v7, 3, v1
    v_lshl_add_u32 v8, v8, 2, v7
    v_lshlrev_b32 v15, 4, v8
    s_mov_b32 s64, 262144
    s_cmp_ge_u32 s5, 20
    s_cbranch_scc1 L_m_41
    buffer_load_dword v18, v15, s[36:39], s64 offen sc1
L_m_41:
    s_barrier
    buffer_store_dword v3, v17, s[36:39], 0 offen sc1
    s_cmp_ge_u32 s63, 126
    s_cbranch_scc1 L_m_42
    ds_read_b64_tr_b16 v[132:133], v28 offset:0
    ds_read_b64_tr_b16 v[134:135], v28 offset:2048
    ds_read2_b64 v[136:139], v29 offset0:0 offset1:4
    ds_read_b64_tr_b16 v[140:141], v28 offset:4096
    ds_read_b64_tr_b16 v[142:143], v28 offset:6144
    ds_read2_b64 v[144:147], v29 offset0:8 offset1:12
    ds_read_b64_tr_b16 v[148:149], v28 offset:8192
    ds_read_b64_tr_b16 v[150:151], v28 offset:10240
    ds_read2_b64 v[152:155], v29 offset0:16 offset1:20
    ds_read_b64_tr_b16 v[156:157], v28 offset:12288
    ds_read_b64_tr_b16 v[158:159], v28 offset:14336
    ds_read2_b64 v[160:163], v29 offset0:24 offset1:28
    ds_read_b64_tr_b16 v[164:165], v28 offset:16384
    ds_read_b64_tr_b16 v[166:167], v28 offset:18432
    ds_read2_b64 v[168:171], v29 offset0:32 offset1:36
    ds_read_b64_tr_b16 v[172:173], v28 offset:20480
    ds_read_b64_tr_b16 v[174:175], v28 offset:22528
    ds_read2_b64 v[176:179], v29 offset0:40 offset1:44
    ds_read_b64_tr_b16 v[180:181], v28 offset:24576
    ds_read_b64_tr_b16 v[182:183], v28 offset:26624
    ds_read2_b64 v[184:187], v29 offset0:48 offset1:52
    ds_read_b64_tr_b16 v[188:189], v28 offset:28672
    ds_read_b64_tr_b16 v[190:191], v28 offset:30720
    ds_read2_b64 v[192:195], v29 offset0:56 offset1:60
    ds_read_b64_tr_b16 v[196:197], v28 offset:32768
    ds_read_b64_tr_b16 v[198:199], v28 offset:34816
    ds_read2_b64 v[200:203], v29 offset0:64 offset1:68
    v_and_b32 v4, 3, v1
    v_or_b32 v4, 0x07060500, v4
    s_waitcnt lgkmcnt(14)
    v_mfma_f32_16x16x32_bf16 v[36:39], v[136:139], v[132:135], 0
    v_mfma_f32_16x16x32_bf16 v[36:39], v[144:147], v[140:143], v[36:39]
    v_mfma_f32_16x16x32_bf16 v[36:39], v[152:155], v[148:151], v[36:39]
    v_mfma_f32_16x16x32_bf16 v[36:39], v[160:163], v[156:159], v[36:39]
    s_waitcnt lgkmcnt(12)
    v_mfma_f32_16x16x32_bf16 v[36:39], v[168:171], v[164:167], v[36:39]
    s_waitcnt lgkmcnt(9)
    v_mfma_f32_16x16x32_bf16 v[36:39], v[176:179], v[172:175], v[36:39]
    s_waitcnt lgkmcnt(6)
    v_mfma_f32_16x16x32_bf16 v[36:39], v[184:187], v[180:183], v[36:39]
    s_waitcnt lgkmcnt(3)
    v_mfma_f32_16x16x32_bf16 v[36:39], v[192:195], v[188:191], v[36:39]
    s_waitcnt lgkmcnt(0)
    v_mfma_f32_16x16x32_bf16 v[36:39], v[200:203], v[196:199], v[36:39]
    s_nop 7
    v_add_u32 v40, 0x80, v36
    v_perm_b32 v40, v40, v3, v4
    s_mov_b32 s48, 0
    buffer_store_dword v40, v30, s[36:39], s48 offen sc1
L_m_42:
    s_cmp_lt_u32 s5, 20
    s_cbranch_scc1 L_m_32
    s_mov_b32 s52, s16
    s_mov_b32 s53, s17
    s_mov_b32 s54, 18874368
    s_mov_b32 s55, 0x20000
    s_mul_i32 s58, s3, 12
    s_add_u32 s58, s58, s5
    s_add_u32 s58, s58, -20
L_m_43:
    s_cmp_ge_u32 s58, 96
    s_cbranch_scc1 L_m_44
    s_mul_i32 s48, s58, 820
    s_lshr_b32 s48, s48, 13
    s_mul_i32 s49, s48, 10
    s_sub_u32 s49, s58, s49
    s_lshl_b32 s49, s49, 6
    v_add_u32 v220, s49, v0
    s_and_b32 s49, s4, 7
    s_mul_i32 s49, s49, 4
    s_add_u32 s48, s48, s49
    s_add_u32 s48, s48, 26
    s_and_b32 s48, s48, 31
    s_mul_i32 s48, s48, 73728
    s_mul_i32 s49, s4, 1152
    s_and_b32 s49, s49, -256
    s_add_u32 s48, s48, s49
    v_mul_u32_u24 v221, 820, v220
    v_lshrrev_b32 v221, 13, v221
    v_mul_u32_u24 v222, 10, v221
    v_sub_u32 v222, v220, v222
    v_and_b32 v220, 7, v221
    v_lshrrev_b32 v221, 3, v221
    v_lshl_add_u32 v220, v220, 8, v221
    v_mul_u32_u24 v220, 9216, v220
    v_lshl_add_u32 v220, v222, 7, v220
    buffer_load_dword v223, v220, s[52:55], s48 offen
    s_add_u32 s58, s58, 48
    s_branch L_m_43
L_m_44:
    s_waitcnt vmcnt(0)
    s_barrier
    s_branch L_m_33
    s_branch L_skip_11
L_stub_11:
    s_branch L_stub_12
L_skip_11:
L_m_32:
    s_setprio 1
    s_lshl_b32 s54, s3, 8
    s_add_u32 s52, s35, s54
    s_add_u32 s52, s52, 4194304
    s_lshl_b32 s53, s3, 12
    s_add_u32 s53, s53, s35
    s_add_u32 s53, s53, 1048576
    v_and_b32 v4, 3, v1
    v_lshrrev_b32 v5, 2, v1
    v_lshlrev_b32 v6, 6, v4
    v_lshl_add_u32 v6, v5, 4, v6
    v_lshl_add_u32 v217, v2, 12, v6
    v_mul_u32_u24 v212, 1040, v1
    v_lshl_add_u32 v212, v2, 6, v212
    v_add_u32 v212, s54, v212
    s_mul_i32 s48, s3, 4160
    v_add_u32 v214, s48, v16
    v_lshl_add_u32 v6, v2, 2, v4
    v_mul_u32_u24 v215, 1056, v6
    v_lshl_add_u32 v215, v5, 4, v215
    v_add_u32 v215, s54, v215
    s_mul_i32 s48, s3, 4224
    v_add_u32 v213, s48, v16
    s_and_b32 s66, s51, 3
    s_xor_b32 s66, s66, s60
    s_lshl_b32 s66, s66, 6
    s_lshl_b32 s48, s51, 8
    s_add_u32 s66, s66, s48
    s_mul_i32 s48, s3, 40960
    s_add_u32 s66, s66, s48
    s_add_u32 s66, s66, 8388608
    s_add_u32 s67, s66, 163840
    s_add_u32 s68, s66, 327680
    s_add_u32 s69, s66, 491520
    s_lshr_b32 s48, s51, 2
    s_and_b32 s48, s48, 2
    v_xor_b32 v4, s48, v4
    v_lshl_add_u32 v5, v2, 6, v5
    v_mul_u32_u24 v216, 10240, v5
    v_lshl_add_u32 v216, v4, 4, v216
    s_lshr_b32 s65, s4, 1
    s_lshl_b32 s65, s65, 16
    s_add_u32 s65, s65, 15728640
    s_lshl_b32 s48, s3, 10
    s_add_u32 s65, s65, s48
    v_lshlrev_b32 v218, 4, v0
    s_waitcnt vmcnt(1)
    v_cmp_ne_u32 vcc, v3, v18
    s_nop 0
    s_cbranch_vccz L_m_45
Lp_m_46:
    buffer_load_dword v18, v15, s[36:39], s64 offen sc1
    s_waitcnt vmcnt(0)
    v_cmp_ne_u32 vcc, v3, v18
    s_nop 0
    s_cbranch_vccz Le_m_47
    s_sub_u32 s7, s7, 1
    s_cbranch_scc1 Le_m_47
    s_sleep 1
    s_branch Lp_m_46
Le_m_47:
    s_max_i32 s7, s7, 0
L_m_45:
    buffer_load_dwordx4 v[224:227], v16, s[36:39], s53 offen offset:0 sc1
    buffer_load_dwordx4 v[228:231], v16, s[36:39], s53 offen offset:1024 sc1
    buffer_load_dwordx4 v[232:235], v16, s[36:39], s53 offen offset:2048 sc1
    buffer_load_dwordx4 v[236:239], v16, s[36:39], s53 offen offset:3072 sc1
    s_waitcnt vmcnt(0)
Lp_m_48:
    buffer_load_dword v4, v218, s[36:39], s65 offen sc1
    s_waitcnt vmcnt(0)
    v_cmp_ne_u32 vcc, v3, v4
    s_nop 0
    s_cbranch_vccz Le_m_49
    s_sub_u32 s7, s7, 1
    s_cbranch_scc1 Le_m_49
    s_mov_b64 exec, vcc
    s_sleep 1
    s_branch Lp_m_48
Le_m_49:
    s_mov_b64 exec, -1
    s_max_i32 s7, s7, 0
    buffer_load_dwordx4 v[36:39], v217, s[36:39], s52 offen offset:0 sc1
    buffer_load_dwordx4 v[40:43], v217, s[36:39], s52 offen offset:1024 sc1
    buffer_load_dwordx4 v[44:47], v217, s[36:39], s52 offen offset:2048 sc1
    buffer_load_dwordx4 v[48:51], v217, s[36:39], s52 offen offset:3072 sc1
    v_lshlrev_b32 v132, 16, v224
    v_and_b32 v136, 0xffff0000, v224
    v_lshlrev_b32 v133, 16, v225
    v_and_b32 v137, 0xffff0000, v225
    v_lshlrev_b32 v134, 16, v226
    v_and_b32 v138, 0xffff0000, v226
    v_lshlrev_b32 v135, 16, v227
    v_and_b32 v139, 0xffff0000, v227
    v_lshlrev_b32 v140, 16, v228
    v_and_b32 v144, 0xffff0000, v228
    v_lshlrev_b32 v141, 16, v229
    v_and_b32 v145, 0xffff0000, v229
    v_lshlrev_b32 v142, 16, v230
    v_and_b32 v146, 0xffff0000, v230
    v_lshlrev_b32 v143, 16, v231
    v_and_b32 v147, 0xffff0000, v231
    v_lshlrev_b32 v148, 16, v232
    v_and_b32 v152, 0xffff0000, v232
    v_lshlrev_b32 v149, 16, v233
    v_and_b32 v153, 0xffff0000, v233
    v_lshlrev_b32 v150, 16, v234
    v_and_b32 v154, 0xffff0000, v234
    v_lshlrev_b32 v151, 16, v235
    v_and_b32 v155, 0xffff0000, v235
    v_lshlrev_b32 v156, 16, v236
    v_and_b32 v160, 0xffff0000, v236
    v_lshlrev_b32 v157, 16, v237
    v_and_b32 v161, 0xffff0000, v237
    v_lshlrev_b32 v158, 16, v238
    v_and_b32 v162, 0xffff0000, v238
    v_lshlrev_b32 v159, 16, v239
    v_and_b32 v163, 0xffff0000, v239
    s_waitcnt vmcnt(2)
    v_swap_b32 v37, v40
    s_waitcnt vmcnt(1)
    v_swap_b32 v38, v44
    s_waitcnt vmcnt(0)
    v_swap_b32 v39, v48
    s_nop 1
    v_mfma_f32_16x16x32_bf16 v[164:167], v[36:39], v[52:55], 0
    v_mfma_f32_16x16x32_bf16 v[168:171], v[36:39], v[56:59], 0
    v_swap_b32 v42, v45
    v_swap_b32 v43, v49
    s_nop 1
    v_mfma_f32_16x16x32_bf16 v[172:175], v[40:43], v[52:55], 0
    v_mfma_f32_16x16x32_bf16 v[176:179], v[40:43], v[56:59], 0
    v_swap_b32 v47, v50
    s_nop 1
    v_mfma_f32_16x16x32_bf16 v[180:183], v[44:47], v[52:55], 0
    v_mfma_f32_16x16x32_bf16 v[184:187], v[44:47], v[56:59], 0
    v_mfma_f32_16x16x32_bf16 v[188:191], v[48:51], v[52:55], 0
    v_mfma_f32_16x16x32_bf16 v[192:195], v[48:51], v[56:59], 0
    v_cvt_pk_bf16_f32 v196, v164, v168
    v_cvt_pk_bf16_f32 v197, v165, v169
    v_cvt_pk_bf16_f32 v198, v166, v170
    v_cvt_pk_bf16_f32 v199, v167, v171
    ds_write_b128 v212, v[196:199] offset:36864
    v_cvt_pk_bf16_f32 v200, v172, v176
    v_cvt_pk_bf16_f32 v201, v173, v177
    v_cvt_pk_bf16_f32 v202, v174, v178
    v_cvt_pk_bf16_f32 v203, v175, v179
    ds_write_b128 v212, v[200:203] offset:36880
    v_cvt_pk_bf16_f32 v204, v180, v184
    v_cvt_pk_bf16_f32 v205, v181, v185
    v_cvt_pk_bf16_f32 v206, v182, v186
    v_cvt_pk_bf16_f32 v207, v183, v187
    ds_write_b128 v212, v[204:207] offset:36896
    v_cvt_pk_bf16_f32 v208, v188, v192
    v_cvt_pk_bf16_f32 v209, v189, v193
    v_cvt_pk_bf16_f32 v210, v190, v194
    v_cvt_pk_bf16_f32 v211, v191, v195
    ds_write_b128 v212, v[208:211] offset:36912
    s_waitcnt lgkmcnt(0)
    s_barrier
    ds_read_b128 v[36:39], v214 offset:36864
    ds_read_b128 v[40:43], v214 offset:37904
    ds_read_b128 v[44:47], v214 offset:38944
    ds_read_b128 v[48:51], v214 offset:39984
    s_waitcnt lgkmcnt(3)
    v_mfma_f32_16x16x32_bf16 v[164:167], v[68:71], v[36:39], 0
    v_mfma_f32_16x16x32_bf16 v[168:171], v[72:75], v[36:39], 0
    s_waitcnt lgkmcnt(2)
    v_mfma_f32_16x16x32_bf16 v[172:175], v[76:79], v[40:43], 0
    v_mfma_f32_16x16x32_bf16 v[176:179], v[80:83], v[40:43], 0
    s_waitcnt lgkmcnt(1)
    v_mfma_f32_16x16x32_bf16 v[180:183], v[84:87], v[44:47], 0
    v_mfma_f32_16x16x32_bf16 v[184:187], v[88:91], v[44:47], 0
    s_waitcnt lgkmcnt(0)
    v_mfma_f32_16x16x32_bf16 v[188:191], v[92:95], v[48:51], 0
    v_mfma_f32_16x16x32_bf16 v[192:195], v[96:99], v[48:51], 0
    v_pk_mul_f32 v[4:5], v[164:165], v[132:133]
    v_pk_mul_f32 v[6:7], v[168:169], v[132:133]
    v_pk_fma_f32 v[4:5], v[168:169], v[136:137], v[4:5] neg_lo:[1,0,0] neg_hi:[1,0,0]
    v_pk_fma_f32 v[6:7], v[164:165], v[136:137], v[6:7]
    v_cvt_pk_bf16_f32 v196, v4, v6
    v_cvt_pk_bf16_f32 v197, v5, v7
    v_pk_mul_f32 v[8:9], v[166:167], v[134:135]
    v_pk_mul_f32 v[10:11], v[170:171], v[134:135]
    v_pk_fma_f32 v[8:9], v[170:171], v[138:139], v[8:9] neg_lo:[1,0,0] neg_hi:[1,0,0]
    v_pk_fma_f32 v[10:11], v[166:167], v[138:139], v[10:11]
    v_cvt_pk_bf16_f32 v198, v8, v10
    v_cvt_pk_bf16_f32 v199, v9, v11
    v_pk_mul_f32 v[4:5], v[172:173], v[140:141]
    v_pk_mul_f32 v[6:7], v[176:177], v[140:141]
    v_pk_fma_f32 v[4:5], v[176:177], v[144:145], v[4:5] neg_lo:[1,0,0] neg_hi:[1,0,0]
    v_pk_fma_f32 v[6:7], v[172:173], v[144:145], v[6:7]
    v_cvt_pk_bf16_f32 v200, v4, v6
    v_cvt_pk_bf16_f32 v201, v5, v7
    v_mfma_f32_16x16x32_bf16 v[164:167], v[100:103], v[196:199], 0
    v_pk_mul_f32 v[8:9], v[174:175], v[142:143]
    v_pk_mul_f32 v[10:11], v[178:179], v[142:143]
    v_pk_fma_f32 v[8:9], v[178:179], v[146:147], v[8:9] neg_lo:[1,0,0] neg_hi:[1,0,0]
    v_pk_fma_f32 v[10:11], v[174:175], v[146:147], v[10:11]
    v_cvt_pk_bf16_f32 v202, v8, v10
    v_cvt_pk_bf16_f32 v203, v9, v11
    v_mfma_f32_16x16x32_bf16 v[168:171], v[104:107], v[196:199], 0
    v_pk_mul_f32 v[4:5], v[180:181], v[148:149]
    v_pk_mul_f32 v[6:7], v[184:185], v[148:149]
    v_pk_fma_f32 v[4:5], v[184:185], v[152:153], v[4:5] neg_lo:[1,0,0] neg_hi:[1,0,0]
    v_pk_fma_f32 v[6:7], v[180:181], v[152:153], v[6:7]
    v_cvt_pk_bf16_f32 v204, v4, v6
    v_cvt_pk_bf16_f32 v205, v5, v7
    v_mfma_f32_16x16x32_bf16 v[172:175], v[108:111], v[200:203], 0
    v_pk_mul_f32 v[8:9], v[182:183], v[150:151]
    v_pk_mul_f32 v[10:11], v[186:187], v[150:151]
    v_pk_fma_f32 v[8:9], v[186:187], v[154:155], v[8:9] neg_lo:[1,0,0] neg_hi:[1,0,0]
    v_pk_fma_f32 v[10:11], v[182:183], v[154:155], v[10:11]
    v_cvt_pk_bf16_f32 v206, v8, v10
    v_cvt_pk_bf16_f32 v207, v9, v11
    v_mfma_f32_16x16x32_bf16 v[176:179], v[112:115], v[200:203], 0
    v_pk_mul_f32 v[4:5], v[188:189], v[156:157]
    v_pk_mul_f32 v[6:7], v[192:193], v[156:157]
    v_pk_fma_f32 v[4:5], v[192:193], v[160:161], v[4:5] neg_lo:[1,0,0] neg_hi:[1,0,0]
    v_pk_fma_f32 v[6:7], v[188:189], v[160:161], v[6:7]
    v_cvt_pk_bf16_f32 v208, v4, v6
    v_cvt_pk_bf16_f32 v209, v5, v7
    v_mfma_f32_16x16x32_bf16 v[180:183], v[116:119], v[204:207], 0
    v_pk_mul_f32 v[8:9], v[190:191], v[158:159]
    v_pk_mul_f32 v[10:11], v[194:195], v[158:159]
    v_pk_fma_f32 v[8:9], v[194:195], v[162:163], v[8:9] neg_lo:[1,0,0] neg_hi:[1,0,0]
    v_pk_fma_f32 v[10:11], v[190:191], v[162:163], v[10:11]
    v_cvt_pk_bf16_f32 v210, v8, v10
    v_cvt_pk_bf16_f32 v211, v9, v11
    v_mfma_f32_16x16x32_bf16 v[184:187], v[120:123], v[204:207], 0
    v_cvt_pk_bf16_f32 v36, v164, v168
    v_cvt_pk_bf16_f32 v40, v165, v169
    v_cvt_pk_bf16_f32 v44, v166, v170
    v_cvt_pk_bf16_f32 v48, v167, v171
    v_mfma_f32_16x16x32_bf16 v[188:191], v[124:127], v[208:211], 0
    v_mfma_f32_16x16x32_bf16 v[192:195], v[128:131], v[208:211], 0
    v_cvt_pk_bf16_f32 v37, v172, v176
    v_cvt_pk_bf16_f32 v41, v173, v177
    v_cvt_pk_bf16_f32 v45, v174, v178
    v_cvt_pk_bf16_f32 v49, v175, v179
    v_cvt_pk_bf16_f32 v38, v180, v184
    v_cvt_pk_bf16_f32 v42, v181, v185
    v_cvt_pk_bf16_f32 v46, v182, v186
    v_cvt_pk_bf16_f32 v50, v183, v187
    v_cvt_pk_bf16_f32 v39, v188, v192
    ds_write_b128 v215, v[36:39] offset:53504
    v_cvt_pk_bf16_f32 v43, v189, v193
    ds_write_b128 v215, v[40:43] offset:53568
    v_cvt_pk_bf16_f32 v47, v190, v194
    ds_write_b128 v215, v[44:47] offset:53632
    v_cvt_pk_bf16_f32 v51, v191, v195
    ds_write_b128 v215, v[48:51] offset:53696
    s_waitcnt lgkmcnt(0)
    s_barrier
    ds_read_b128 v[196:199], v213 offset:53504
    ds_read_b128 v[200:203], v213 offset:54560
    ds_read_b128 v[204:207], v213 offset:55616
    ds_read_b128 v[208:211], v213 offset:56672
    s_waitcnt lgkmcnt(3)
    v_mfma_f32_16x16x32_bf16 v[164:167], v[60:63], v[196:199], 0
    v_mfma_f32_16x16x32_bf16 v[168:171], v[64:67], v[196:199], 0
    s_waitcnt lgkmcnt(2)
    v_mfma_f32_16x16x32_bf16 v[172:175], v[60:63], v[200:203], 0
    v_mfma_f32_16x16x32_bf16 v[176:179], v[64:67], v[200:203], 0
    s_waitcnt lgkmcnt(1)
    v_mfma_f32_16x16x32_bf16 v[180:183], v[60:63], v[204:207], 0
    v_mfma_f32_16x16x32_bf16 v[184:187], v[64:67], v[204:207], 0
    s_waitcnt lgkmcnt(0)
    v_mfma_f32_16x16x32_bf16 v[188:191], v[60:63], v[208:211], 0
    v_mfma_f32_16x16x32_bf16 v[192:195], v[64:67], v[208:211], 0
    v_cvt_pk_bf16_f32 v36, v168, v164
    v_cvt_pk_bf16_f32 v40, v169, v165
    v_cvt_pk_bf16_f32 v44, v170, v166
    v_cvt_pk_bf16_f32 v48, v171, v167
    v_cvt_pk_bf16_f32 v37, v176, v172
    s_branch L_skip_12
    s_nop 0
L_stub_12:
    s_branch L_back_h1
L_skip_12:
    v_cvt_pk_bf16_f32 v41, v177, v173
    v_cvt_pk_bf16_f32 v45, v178, v174
    v_cvt_pk_bf16_f32 v49, v179, v175
    v_cvt_pk_bf16_f32 v38, v184, v180
    v_cvt_pk_bf16_f32 v42, v185, v181
    v_cvt_pk_bf16_f32 v46, v186, v182
    v_cvt_pk_bf16_f32 v50, v187, v183
    v_cvt_pk_bf16_f32 v39, v192, v188
    buffer_store_dwordx4 v[36:39], v216, s[36:39], s66 offen sc1
    v_cvt_pk_bf16_f32 v43, v193, v189
    buffer_store_dwordx4 v[40:43], v216, s[36:39], s67 offen sc1
    v_cvt_pk_bf16_f32 v47, v194, v190
    buffer_store_dwordx4 v[44:47], v216, s[36:39], s68 offen sc1
    v_cvt_pk_bf16_f32 v51, v195, v191
    buffer_store_dwordx4 v[48:51], v216, s[36:39], s69 offen sc1
    buffer_store_dword v3, v19, s[36:39], 0 offen sc1
    s_setprio 0
    s_waitcnt vmcnt(0)
    s_barrier
L_m_33:
    v_lshlrev_b32 v8, 4, v0
    s_mul_i32 s52, s4, 27
    s_add_u32 s52, s52, s5
    s_mul_i32 s51, s52, 171
    s_lshr_b32 s51, s51, 10
    s_mul_i32 s48, s51, 6
    s_sub_u32 s52, s52, s48
    s_lshr_b32 s53, s4, 1
    s_and_b32 s54, s4, 1
    s_lshl_b32 s54, s54, 3
    s_lshr_b32 s48, s5, 2
    s_add_u32 s54, s54, s48
    s_and_b32 s55, s5, 3
    s_mov_b32 s40, s16
    s_mov_b32 s41, s17
    s_mov_b32 s42, 18874368
    s_mov_b32 s43, 0x20000
    s_mov_b32 s44, s20
    s_mov_b32 s45, s21
    s_mov_b32 s46, 18874368
    s_mov_b32 s47, 0x20000
    s_and_b32 s62, s3, 1
    s_and_b32 s63, s4, 7
    s_mul_i32 s63, s63, 4
    s_add_u32 s63, s63, 26
    s_mul_i32 s48, s51, 0
    s_add_u32 s63, s63, s48
    s_and_b32 s63, s63, 31
    s_mov_b32 s64, 0
    s_lshl_b32 s68, s62, 13
    s_cmp_ge_u32 s3, 2
    s_cbranch_scc1 L_m_50
    s_branch L_stub_13
L_back_a1:
    s_mul_i32 s56, s62, 27
    s_add_u32 s56, s56, s5
    s_add_u32 s56, s56, 116
    s_cmp_lt_u32 s5, 27
    s_cselect_b32 s56, s56, 999
    s_barrier
    v_mov_b64 v[28:29], -1
    v_mov_b64 v[30:31], -1
    s_lshl_b32 s56, s2, 1
    s_add_u32 s56, s56, s62
    s_add_u32 s48, s56, 0
    s_cmp_ge_u32 s48, 1152
    s_cbranch_scc1 L_m_51
    s_mov_b32 s49, s48
    s_cmp_ge_u32 s49, 288
    s_cselect_b32 s50, 1008, 0
    s_add_u32 s48, s48, s50
    s_cmp_ge_u32 s49, 576
    s_cselect_b32 s50, 1008, 0
    s_add_u32 s48, s48, s50
    s_cmp_ge_u32 s49, 864
    s_cselect_b32 s50, 1008, 0
    s_add_u32 s48, s48, s50
    s_lshl_b32 s48, s48, 10
    s_add_u32 s48, s48, 21413888
    buffer_store_dwordx4 v[28:31], v8, s[36:39], s48 offen sc1
L_m_51:
    s_add_u32 s48, s56, 512
    s_cmp_ge_u32 s48, 1152
    s_cbranch_scc1 L_m_52
    s_mov_b32 s49, s48
    s_cmp_ge_u32 s49, 288
    s_cselect_b32 s50, 1008, 0
    s_add_u32 s48, s48, s50
    s_cmp_ge_u32 s49, 576
    s_cselect_b32 s50, 1008, 0
    s_add_u32 s48, s48, s50
    s_cmp_ge_u32 s49, 864
    s_cselect_b32 s50, 1008, 0
    s_add_u32 s48, s48, s50
    s_lshl_b32 s48, s48, 10
    s_add_u32 s48, s48, 21413888
    buffer_store_dwordx4 v[28:31], v8, s[36:39], s48 offen sc1
L_m_52:
    s_add_u32 s48, s56, 1024
    s_cmp_ge_u32 s48, 1152
    s_cbranch_scc1 L_m_53
    s_mov_b32 s49, s48
    s_cmp_ge_u32 s49, 288
    s_cselect_b32 s50, 1008, 0
    s_add_u32 s48, s48, s50
    s_cmp_ge_u32 s49, 576
    s_cselect_b32 s50, 1008, 0
    s_add_u32 s48, s48, s50
    s_cmp_ge_u32 s49, 864
    s_cselect_b32 s50, 1008, 0
    s_add_u32 s48, s48, s50
    s_lshl_b32 s48, s48, 10
    s_add_u32 s48, s48, 21413888
    buffer_store_dwordx4 v[28:31], v8, s[36:39], s48 offen sc1
L_m_53:
    s_bfe_u32 s56, s6, 0x10002
    s_lshl_b32 s56, s56, 7
    s_lshr_b32 s57, s6, 3
    s_lshl_b32 s57, s57, 2
    s_add_u32 s56, s56, s57
    s_and_b32 s57, s6, 3
    s_add_u32 s56, s56, s57
    s_lshl_b32 s48, s56, 4
    s_lshl_b32 s49, s3, 16
    s_add_u32 s48, s48, s49
    s_add_u32 s48, s48, 16252928
    v_mov_b32 v10, 2146435072
    v_writelane_b32 v10, s48, 0
    s_add_u32 s48, s48, 16384
    s_lshl_b32 s56, s52, 6
    s_add_u32 s56, s56, s51
    s_lshl_b32 s48, s56, 4
    s_lshl_b32 s49, s3, 16
    s_add_u32 s48, s48, s49
    s_add_u32 s48, s48, 16515072
    v_mov_b32 v11, 2146435072
    v_writelane_b32 v11, s48, 0
    s_add_u32 s48, s48, 16384
    s_add_u32 s48, s2, 216
    s_lshl_b32 s48, s48, 7
    s_add_u32 s48, s48, 622592
    s_lshl_b32 s49, s3, 8
    s_add_u32 s49, s49, s5
    s_cmp_lt_u32 s49, 5
    s_cselect_b32 s48, s48, 2146435072
    v_writelane_b32 v11, s48, 8
    s_lshr_b32 s65, s4, 2
    s_lshl_b32 s65, s65, 16
    s_add_u32 s66, s65, 16515072
    s_lshl_b32 s48, s62, 11
    s_add_u32 s65, s65, s48
    s_add_u32 s65, s65, 16252928
    s_add_u32 s69, s65, 1024
    v_lshlrev_b32 v27, 4, v0
    s_mul_i32 s67, s52, 1536
    s_mul_i32 s48, s62, 36864
    s_add_u32 s67, s67, s48
    s_add_u32 s67, s67, 16777216
    v_add_u32 v14, 7680, v8
    v_cmp_gt_u32 vcc, 32, v0
    s_nop 1
    v_cndmask_b32 v13, v14, v8, vcc
    v_add_u32 v15, 18432, v8
    v_add_u32 v16, 18432, v13
    v_add_u32 v17, 18432, v14
    s_mul_i32 s68, s62, 6144
    s_mul_i32 s58, s63, 73728
    s_add_u32 s58, s58, s67
    s_add_u32 s59, s67, 2359296
    s_barrier
    s_mul_i32 s56, s62, 288
    s_mul_i32 s57, s6, 1152
    s_add_u32 s57, s57, 12582912
    v_add_u32 v4, 0, v0
    v_min_u32 v4, 287, v4
    v_add_u32 v4, s56, v4
    v_mul_u32_u24 v5, 911, v4
    v_lshrrev_b32 v5, 16, v5
    v_mul_u32_u24 v5, 293760, v5
    v_lshl_add_u32 v22, v4, 4, v5
    v_lshlrev_b32 v4, 4, v4
    v_add_u32 v6, 98304, v4
    v_add_u32 v4, 64, v0
    v_min_u32 v4, 287, v4
    v_add_u32 v4, s56, v4
    v_mul_u32_u24 v5, 911, v4
    v_lshrrev_b32 v5, 16, v5
    v_mul_u32_u24 v5, 293760, v5
    v_lshl_add_u32 v23, v4, 4, v5
    v_add_u32 v4, 128, v0
    v_min_u32 v4, 287, v4
    v_add_u32 v4, s56, v4
    v_mul_u32_u24 v5, 911, v4
    v_lshrrev_b32 v5, 16, v5
    v_mul_u32_u24 v5, 293760, v5
    v_lshl_add_u32 v24, v4, 4, v5
    v_add_u32 v4, 192, v0
    v_min_u32 v4, 287, v4
    v_add_u32 v4, s56, v4
    v_mul_u32_u24 v5, 911, v4
    v_lshrrev_b32 v5, 16, v5
    v_mul_u32_u24 v5, 293760, v5
    v_lshl_add_u32 v25, v4, 4, v5
    v_add_u32 v4, 256, v0
    v_min_u32 v4, 287, v4
    v_add_u32 v4, s56, v4
    v_mul_u32_u24 v5, 911, v4
    v_lshrrev_b32 v5, 16, v5
    v_mul_u32_u24 v5, 293760, v5
    v_lshl_add_u32 v26, v4, 4, v5
    v_lshlrev_b32 v4, 4, v4
    v_add_u32 v7, 98304, v4
    s_barrier
    s_barrier
    ds_read_b128 v[28:31], v6 offset:0
    ds_read_b128 v[32:35], v6 offset:1024
    ds_read_b128 v[36:39], v6 offset:2048
    ds_read_b128 v[40:43], v6 offset:3072
    ds_read_b128 v[44:47], v7 offset:0
    s_lshl_b32 s48, s62, 8
    s_add_u32 s48, s48, s6
    s_lshl_b32 s48, s48, 7
    s_add_u32 s48, s48, 15990784
    v_add_u32 v54, s48, v8
    v_cmp_gt_u32 vcc, 8, v0
    v_mov_b32 v4, 2146435072
    s_nop 0
    v_cndmask_b32 v54, v4, v54, vcc
    s_waitcnt vmcnt(0)
    v_mov_b32 v48, v3
    v_mov_b32 v49, v3
    v_mov_b32 v50, v3
    v_mov_b32 v51, v3
    s_cmp_ge_u32 s5, 27
    s_cbranch_scc1 L_m_54
    v_lshrrev_b32 v52, 4, v0
    v_and_b32 v53, 15, v0
    v_lshlrev_b32 v52, 12, v52
    v_lshl_add_u32 v52, v53, 7, v52
    s_lshr_b32 s48, s4, 1
    s_mul_i32 s48, s48, 4718592
    s_and_b32 s49, s4, 1
    s_lshl_b32 s49, s49, 11
    s_add_u32 s48, s48, s49
    v_add_u32 v52, s48, v52
    s_mov_b32 s35, 0
    s_mov_b32 s49, s35
    s_mul_i32 s48, s62, 1
    s_add_u32 s49, s49, s48
    s_bfm_b32 s48, s5, 0
    s_and_b32 s48, s48, 0
    s_bcnt1_i32_b32 s48, s48
    s_sub_u32 s12, s5, s48
    s_mul_i32 s35, s12, 4
    s_add_u32 s35, s35, 0
    s_add_u32 s35, s35, s49
    s_min_u32 s35, s35, 191
    s_lshl_b32 s8, s35, 14
    s_mul_i32 s35, s12, 4
    s_add_u32 s35, s35, 2
    s_add_u32 s35, s35, s49
    s_min_u32 s35, s35, 191
    s_lshl_b32 s9, s35, 14
    s_mul_i32 s35, s12, 132
    s_lshr_b32 s35, s35, 8
    s_add_u32 s35, s35, 0
    s_mul_i32 s48, s62, 0
    s_add_u32 s35, s35, s48
    s_mov_b32 s48, 0
    s_bitcmp1_b32 s48, s5
    s_cselect_b32 s35, 999, s35
    s_add_u32 s50, s58, 589824
    s_cmp_ge_u32 s50, s59
    s_cselect_b32 s48, 2359296, 0
    s_sub_u32 s50, s50, s48
    s_waitcnt lgkmcnt(0)
    s_barrier
    buffer_store_dword v3, v10, s[36:39], 0 offen sc1
    v_add_u32 v76, 0, v0
    v_mul_u32_u24 v77, 1821, v76
    v_lshrrev_b32 v77, 18, v77
    v_mul_u32_u24 v77, 6912, v77
    v_lshl_add_u32 v77, v76, 4, v77
    v_subrev_u32 v56, 0, v77
    v_add_u32 v76, 64, v0
    v_mul_u32_u24 v77, 1821, v76
    v_lshrrev_b32 v77, 18, v77
    v_mul_u32_u24 v77, 6912, v77
    v_lshl_add_u32 v77, v76, 4, v77
    v_subrev_u32 v57, 1024, v77
    v_add_u32 v76, 128, v0
    v_mul_u32_u24 v77, 1821, v76
    v_lshrrev_b32 v77, 18, v77
    v_mul_u32_u24 v77, 6912, v77
    v_lshl_add_u32 v77, v76, 4, v77
    v_subrev_u32 v58, 2048, v77
    v_add_u32 v76, 192, v0
    v_mul_u32_u24 v77, 1821, v76
    v_lshrrev_b32 v77, 18, v77
    v_mul_u32_u24 v77, 6912, v77
    v_lshl_add_u32 v77, v76, 4, v77
    v_subrev_u32 v59, 3072, v77
    v_add_u32 v76, 256, v0
    v_mul_u32_u24 v77, 1821, v76
    v_lshrrev_b32 v77, 18, v77
    v_mul_u32_u24 v77, 6912, v77
    v_lshl_add_u32 v77, v76, 4, v77
    v_subrev_u32 v60, 0, v77
    v_add_u32 v76, 320, v0
    v_mul_u32_u24 v77, 1821, v76
    v_lshrrev_b32 v77, 18, v77
    v_mul_u32_u24 v77, 6912, v77
    v_lshl_add_u32 v77, v76, 4, v77
    v_subrev_u32 v61, 1024, v77
    v_add_u32 v76, 384, v0
    v_mul_u32_u24 v77, 1821, v76
    v_lshrrev_b32 v77, 18, v77
    v_mul_u32_u24 v77, 6912, v77
    v_lshl_add_u32 v77, v76, 4, v77
    v_subrev_u32 v62, 2048, v77
    v_add_u32 v76, 448, v0
    v_mul_u32_u24 v77, 1821, v76
    v_lshrrev_b32 v77, 18, v77
    v_mul_u32_u24 v77, 6912, v77
    v_lshl_add_u32 v77, v76, 4, v77
    v_subrev_u32 v63, 3072, v77
    v_add_u32 v76, 512, v0
    v_mul_u32_u24 v77, 1821, v76
    v_lshrrev_b32 v77, 18, v77
    v_mul_u32_u24 v77, 6912, v77
    v_lshl_add_u32 v77, v76, 4, v77
    v_subrev_u32 v64, 0, v77
    s_mul_i32 s48, s55, 3
    s_add_u32 s49, s48, 2
    s_lshr_b32 s48, s48, 1
    s_lshr_b32 s49, s49, 1
    v_mov_b32 v76, s48
    v_mov_b32 v77, s49
    v_cmp_gt_u32 vcc, 32, v0
    s_nop 1
    v_cndmask_b32 v76, v77, v76, vcc
    v_and_b32 v77, 31, v0
    v_min_u32 v77, 8, v77
    v_lshl_add_u32 v76, v76, 6, v77
    s_mul_i32 s48, s53, 9
    v_add_u32 v76, s48, v76
    v_lshlrev_b32 v66, 4, v76
    s_lshr_b32 s48, s54, 3
    s_lshl_b32 s48, s48, 2
    s_and_b32 s49, s54, 1
    s_lshl_b32 s49, s49, 1
    s_add_u32 s48, s48, s49
    s_add_u32 s48, s48, s62
    s_lshl_b32 s48, s48, 13
    s_add_u32 s48, s48, 15990784
    v_lshl_add_u32 v67, v0, 7, s48
    v_mov_b32 v68, 0
    s_lshl_b32 s48, s54, 7
    s_lshr_b32 s49, s53, 1
    s_lshl_b32 s49, s49, 4
    s_add_u32 s48, s48, s49
    s_mul_i32 s48, s48, 1152
    s_mul_i32 s49, s55, 288
    s_add_u32 s48, s48, s49
    s_and_b32 s49, s53, 1
    s_mul_i32 s49, s49, 144
    s_add_u32 s48, s48, s49
    s_add_u32 s12, s48, 12582912
    s_lshl_b32 s13, s62, 6
    v_add_u32 v76, s13, v0
    v_mul_u32_u24 v77, 911, v76
    v_lshrrev_b32 v77, 13, v77
    v_mul_u32_u24 v78, 9, v77
    v_sub_u32 v78, v76, v78
    v_and_b32 v76, 48, v77
    v_add_u32 v77, v77, v76
    v_mul_u32_u24 v77, 1152, v77
    v_lshl_add_u32 v77, v78, 4, v77
    v_add_u32 v70, s12, v77
    s_add_u32 s13, s13, 128
    v_add_u32 v76, s13, v0
    v_mul_u32_u24 v77, 911, v76
    v_lshrrev_b32 v77, 13, v77
    v_mul_u32_u24 v78, 9, v77
    v_sub_u32 v78, v76, v78
    v_and_b32 v76, 48, v77
    v_add_u32 v77, v77, v76
    v_mul_u32_u24 v77, 1152, v77
    v_lshl_add_u32 v77, v78, 4, v77
    v_add_u32 v71, s12, v77
    s_add_u32 s13, s13, 128
    v_add_u32 v76, s13, v0
    v_mul_u32_u24 v77, 911, v76
    v_lshrrev_b32 v77, 13, v77
    v_mul_u32_u24 v78, 9, v77
    v_sub_u32 v78, v76, v78
    v_and_b32 v76, 48, v77
    v_add_u32 v77, v77, v76
    v_mul_u32_u24 v77, 1152, v77
    v_lshl_add_u32 v77, v78, 4, v77
    v_add_u32 v72, s12, v77
    s_add_u32 s13, s13, 128
    v_add_u32 v76, s13, v0
    v_mul_u32_u24 v77, 911, v76
    v_lshrrev_b32 v77, 13, v77
    v_mul_u32_u24 v78, 9, v77
    v_sub_u32 v78, v76, v78
    v_and_b32 v76, 48, v77
    v_add_u32 v77, v77, v76
    v_mul_u32_u24 v77, 1152, v77
    v_lshl_add_u32 v77, v78, 4, v77
    v_add_u32 v73, s12, v77
    s_add_u32 s13, s13, 128
    v_add_u32 v76, s13, v0
    v_mul_u32_u24 v77, 911, v76
    v_lshrrev_b32 v77, 13, v77
    v_mul_u32_u24 v78, 9, v77
    v_sub_u32 v78, v76, v78
    v_and_b32 v76, 48, v77
    v_add_u32 v77, v77, v76
    v_mul_u32_u24 v77, 1152, v77
    v_lshl_add_u32 v77, v78, 4, v77
    v_add_u32 v74, s12, v77
    s_add_u32 s13, s13, 128
    s_mul_i32 s48, s55, 576
    s_and_b32 s49, s53, 1
    s_mul_i32 s49, s49, 288
    s_add_u32 s48, s48, s49
    s_add_u32 s48, s48, 11520
    v_min_u32 v76, 272, v8
    v_add_u32 v76, s48, v76
    s_cmp_eq_u32 s62, 1
    s_cselect_b64 vcc, -1, 0
    v_cndmask_b32 v74, v74, v76, vcc
    s_waitcnt vmcnt(0)
    s_barrier
    buffer_store_dwordx4 v[28:31], v22, s[36:39], s57 offen sc1
    buffer_store_dwordx4 v[32:35], v23, s[36:39], s57 offen sc1
    buffer_store_dwordx4 v[36:39], v24, s[36:39], s57 offen sc1
    buffer_store_dwordx4 v[40:43], v25, s[36:39], s57 offen sc1
    buffer_store_dwordx4 v[44:47], v26, s[36:39], s57 offen sc1
    s_barrier
    s_waitcnt vmcnt(0)
    buffer_store_dwordx4 v[48:51], v54, s[36:39], 0 offen sc1
Lp_m_56:
    buffer_load_dword v4, v27, s[36:39], s65 offen sc1
    buffer_load_dword v5, v27, s[36:39], s69 offen sc1
    s_waitcnt vmcnt(0)
    v_cmp_ne_u32 vcc, v3, v4
    v_cmp_ne_u32 s[48:49], v3, v5
    s_nop 0
    s_or_b64 vcc, vcc, s[48:49]
    s_cbranch_vccz Le_m_57
    s_sub_u32 s7, s7, 1
    s_cbranch_scc1 Le_m_57
    s_mov_b64 exec, vcc
    s_sleep 1
    s_branch Lp_m_56
Le_m_57:
    s_mov_b64 exec, -1
    s_max_i32 s7, s7, 0
    s_add_u32 m0, s68, 98304
    s_nop 0
    buffer_load_dwordx4 v8, s[36:39], s50 offen offset:0 sc1 lds
    buffer_load_dwordx4 v13, s[36:39], s50 offen offset:1024 sc1 lds
    buffer_load_dwordx4 v14, s[36:39], s50 offen offset:2048 sc1 lds
    s_add_u32 m0, s68, 101376
    s_nop 0
    buffer_load_dwordx4 v15, s[36:39], s50 offen offset:0 sc1 lds
    buffer_load_dwordx4 v16, s[36:39], s50 offen offset:1024 sc1 lds
    buffer_load_dwordx4 v17, s[36:39], s50 offen offset:2048 sc1 lds
    s_add_u32 s50, s58, 663552
    s_cmp_ge_u32 s50, s59
    s_cselect_b32 s48, 2359296, 0
    s_sub_u32 s50, s50, s48
    s_add_u32 m0, s68, 110592
    s_nop 0
    buffer_load_dwordx4 v8, s[36:39], s50 offen offset:0 sc1 lds
    buffer_load_dwordx4 v13, s[36:39], s50 offen offset:1024 sc1 lds
    buffer_load_dwordx4 v14, s[36:39], s50 offen offset:2048 sc1 lds
    s_add_u32 m0, s68, 113664
    s_nop 0
    buffer_load_dwordx4 v15, s[36:39], s50 offen offset:0 sc1 lds
    buffer_load_dwordx4 v16, s[36:39], s50 offen offset:1024 sc1 lds
    buffer_load_dwordx4 v17, s[36:39], s50 offen offset:2048 sc1 lds
    s_add_u32 s50, s58, 737280
    s_cmp_ge_u32 s50, s59
    s_cselect_b32 s48, 2359296, 0
    s_sub_u32 s50, s50, s48
    s_waitcnt vmcnt(6)
    s_barrier
    s_add_u32 m0, s68, 122880
    s_nop 0
    buffer_load_dwordx4 v8, s[36:39], s50 offen offset:0 sc1 lds
    buffer_load_dwordx4 v13, s[36:39], s50 offen offset:1024 sc1 lds
    buffer_load_dwordx4 v14, s[36:39], s50 offen offset:2048 sc1 lds
    s_add_u32 m0, s68, 125952
    s_nop 0
    buffer_load_dwordx4 v15, s[36:39], s50 offen offset:0 sc1 lds
    buffer_load_dwordx4 v16, s[36:39], s50 offen offset:1024 sc1 lds
    buffer_load_dwordx4 v17, s[36:39], s50 offen offset:2048 sc1 lds
    s_add_u32 s50, s58, 811008
    s_cmp_ge_u32 s50, s59
    s_cselect_b32 s48, 2359296, 0
    s_sub_u32 s50, s50, s48
    s_add_u32 m0, s68, 135168
    s_nop 0
    buffer_load_dwordx4 v8, s[36:39], s50 offen offset:0 sc1 lds
    buffer_load_dwordx4 v13, s[36:39], s50 offen offset:1024 sc1 lds
    buffer_load_dwordx4 v14, s[36:39], s50 offen offset:2048 sc1 lds
    s_add_u32 m0, s68, 138240
    s_nop 0
    buffer_load_dwordx4 v15, s[36:39], s50 offen offset:0 sc1 lds
    buffer_load_dwordx4 v16, s[36:39], s50 offen offset:1024 sc1 lds
    buffer_load_dwordx4 v17, s[36:39], s50 offen offset:2048 sc1 lds
    s_add_u32 s50, s58, 884736
    s_cmp_ge_u32 s50, s59
    s_cselect_b32 s48, 2359296, 0
    s_sub_u32 s50, s50, s48
    s_cmp_lg_u32 s35, 0
    s_cbranch_scc1 L_m_58
    buffer_load_dword v53, v52, s[44:47], s8 offen
    buffer_load_dword v53, v52, s[44:47], s9 offen
L_m_58:
    s_waitcnt vmcnt(12)
    s_barrier
    s_add_u32 m0, s68, 147456
    s_nop 0
    buffer_load_dwordx4 v8, s[36:39], s50 offen offset:0 sc1 lds
    buffer_load_dwordx4 v13, s[36:39], s50 offen offset:1024 sc1 lds
    buffer_load_dwordx4 v14, s[36:39], s50 offen offset:2048 sc1 lds
    s_add_u32 m0, s68, 150528
    s_nop 0
    buffer_load_dwordx4 v15, s[36:39], s50 offen offset:0 sc1 lds
    buffer_load_dwordx4 v16, s[36:39], s50 offen offset:1024 sc1 lds
    buffer_load_dwordx4 v17, s[36:39], s50 offen offset:2048 sc1 lds
    s_add_u32 s50, s58, 958464
    s_cmp_ge_u32 s50, s59
    s_cselect_b32 s48, 2359296, 0
    s_sub_u32 s50, s50, s48
    s_cmp_lg_u32 s35, 1
    s_cbranch_scc1 L_m_59
    buffer_load_dword v53, v52, s[44:47], s8 offen
    buffer_load_dword v53, v52, s[44:47], s9 offen
L_m_59:
    s_waitcnt vmcnt(12)
    s_barrier
    s_add_u32 m0, s68, 98304
    s_nop 0
    buffer_load_dwordx4 v8, s[36:39], s50 offen offset:0 sc1 lds
    buffer_load_dwordx4 v13, s[36:39], s50 offen offset:1024 sc1 lds
    buffer_load_dwordx4 v14, s[36:39], s50 offen offset:2048 sc1 lds
    s_add_u32 m0, s68, 101376
    s_nop 0
    buffer_load_dwordx4 v15, s[36:39], s50 offen offset:0 sc1 lds
    buffer_load_dwordx4 v16, s[36:39], s50 offen offset:1024 sc1 lds
    buffer_load_dwordx4 v17, s[36:39], s50 offen offset:2048 sc1 lds
    s_add_u32 s50, s58, 0
    s_cmp_ge_u32 s50, s59
    s_cselect_b32 s48, 2359296, 0
    s_sub_u32 s50, s50, s48
    s_cmp_lg_u32 s35, 2
    s_cbranch_scc1 L_m_60
    buffer_load_dword v53, v52, s[44:47], s8 offen
    buffer_load_dword v53, v52, s[44:47], s9 offen
L_m_60:
    s_waitcnt vmcnt(12)
    s_barrier
    s_add_u32 m0, s68, 110592
    s_nop 0
    buffer_load_dwordx4 v8, s[36:39], s50 offen offset:0 sc1 lds
    buffer_load_dwordx4 v13, s[36:39], s50 offen offset:1024 sc1 lds
    buffer_load_dwordx4 v14, s[36:39], s50 offen offset:2048 sc1 lds
    s_add_u32 m0, s68, 113664
    s_nop 0
    buffer_load_dwordx4 v15, s[36:39], s50 offen offset:0 sc1 lds
    buffer_load_dwordx4 v16, s[36:39], s50 offen offset:1024 sc1 lds
    buffer_load_dwordx4 v17, s[36:39], s50 offen offset:2048 sc1 lds
    s_add_u32 s50, s58, 1032192
    s_cmp_ge_u32 s50, s59
    s_cselect_b32 s48, 2359296, 0
    s_sub_u32 s50, s50, s48
    s_cmp_lg_u32 s35, 3
    s_cbranch_scc1 L_m_61
    buffer_load_dword v53, v52, s[44:47], s8 offen
    buffer_load_dword v53, v52, s[44:47], s9 offen
L_m_61:
    s_waitcnt vmcnt(12)
    s_barrier
    s_add_u32 m0, s68, 122880
    s_nop 0
    buffer_load_dwordx4 v8, s[36:39], s50 offen offset:0 sc1 lds
    buffer_load_dwordx4 v13, s[36:39], s50 offen offset:1024 sc1 lds
    buffer_load_dwordx4 v14, s[36:39], s50 offen offset:2048 sc1 lds
    s_add_u32 m0, s68, 125952
    s_nop 0
    buffer_load_dwordx4 v15, s[36:39], s50 offen offset:0 sc1 lds
    buffer_load_dwordx4 v16, s[36:39], s50 offen offset:1024 sc1 lds
    buffer_load_dwordx4 v17, s[36:39], s50 offen offset:2048 sc1 lds
    s_add_u32 s50, s58, 1105920
    s_cmp_ge_u32 s50, s59
    s_cselect_b32 s48, 2359296, 0
    s_sub_u32 s50, s50, s48
    s_cmp_lg_u32 s35, 4
    s_cbranch_scc1 L_m_62
    buffer_load_dword v53, v52, s[44:47], s8 offen
    buffer_load_dword v53, v52, s[44:47], s9 offen
L_m_62:
    s_waitcnt vmcnt(12)
    s_barrier
    s_add_u32 m0, s68, 135168
    s_nop 0
    buffer_load_dwordx4 v8, s[36:39], s50 offen offset:0 sc1 lds
    buffer_load_dwordx4 v13, s[36:39], s50 offen offset:1024 sc1 lds
    buffer_load_dwordx4 v14, s[36:39], s50 offen offset:2048 sc1 lds
    s_add_u32 m0, s68, 138240
    s_nop 0
    buffer_load_dwordx4 v15, s[36:39], s50 offen offset:0 sc1 lds
    buffer_load_dwordx4 v16, s[36:39], s50 offen offset:1024 sc1 lds
    buffer_load_dwordx4 v17, s[36:39], s50 offen offset:2048 sc1 lds
    s_add_u32 s50, s58, 73728
    s_cmp_ge_u32 s50, s59
    s_cselect_b32 s48, 2359296, 0
    s_sub_u32 s50, s50, s48
    s_cmp_lg_u32 s35, 5
    s_cbranch_scc1 L_m_63
    buffer_load_dword v53, v52, s[44:47], s8 offen
    buffer_load_dword v53, v52, s[44:47], s9 offen
L_m_63:
    s_waitcnt vmcnt(12)
    s_barrier
    s_add_u32 m0, s68, 147456
    s_nop 0
    buffer_load_dwordx4 v8, s[36:39], s50 offen offset:0 sc1 lds
    buffer_load_dwordx4 v13, s[36:39], s50 offen offset:1024 sc1 lds
    buffer_load_dwordx4 v14, s[36:39], s50 offen offset:2048 sc1 lds
    s_add_u32 m0, s68, 150528
    s_nop 0
    buffer_load_dwordx4 v15, s[36:39], s50 offen offset:0 sc1 lds
    buffer_load_dwordx4 v16, s[36:39], s50 offen offset:1024 sc1 lds
    buffer_load_dwordx4 v17, s[36:39], s50 offen offset:2048 sc1 lds
    s_add_u32 s50, s58, 1179648
    s_cmp_ge_u32 s50, s59
    s_cselect_b32 s48, 2359296, 0
    s_sub_u32 s50, s50, s48
    s_cmp_lg_u32 s35, 6
    s_cbranch_scc1 L_m_64
    buffer_load_dword v53, v52, s[44:47], s8 offen
    buffer_load_dword v53, v52, s[44:47], s9 offen
L_m_64:
    s_waitcnt vmcnt(12)
    s_barrier
    s_add_u32 m0, s68, 98304
    s_nop 0
    buffer_load_dwordx4 v8, s[36:39], s50 offen offset:0 sc1 lds
    buffer_load_dwordx4 v13, s[36:39], s50 offen offset:1024 sc1 lds
    buffer_load_dwordx4 v14, s[36:39], s50 offen offset:2048 sc1 lds
    s_add_u32 m0, s68, 101376
    s_nop 0
    buffer_load_dwordx4 v15, s[36:39], s50 offen offset:0 sc1 lds
    buffer_load_dwordx4 v16, s[36:39], s50 offen offset:1024 sc1 lds
    buffer_load_dwordx4 v17, s[36:39], s50 offen offset:2048 sc1 lds
    s_add_u32 s50, s58, 1253376
    s_cmp_ge_u32 s50, s59
    s_cselect_b32 s48, 2359296, 0
    s_sub_u32 s50, s50, s48
    s_cmp_lg_u32 s35, 7
    s_cbranch_scc1 L_m_65
    buffer_load_dword v53, v52, s[44:47], s8 offen
    buffer_load_dword v53, v52, s[44:47], s9 offen
L_m_65:
    s_waitcnt vmcnt(12)
    s_barrier
    s_add_u32 m0, s68, 110592
    s_nop 0
    buffer_load_dwordx4 v8, s[36:39], s50 offen offset:0 sc1 lds
    buffer_load_dwordx4 v13, s[36:39], s50 offen offset:1024 sc1 lds
    buffer_load_dwordx4 v14, s[36:39], s50 offen offset:2048 sc1 lds
    s_add_u32 m0, s68, 113664
    s_nop 0
    buffer_load_dwordx4 v15, s[36:39], s50 offen offset:0 sc1 lds
    buffer_load_dwordx4 v16, s[36:39], s50 offen offset:1024 sc1 lds
    buffer_load_dwordx4 v17, s[36:39], s50 offen offset:2048 sc1 lds
    s_add_u32 s50, s58, 147456
    s_cmp_ge_u32 s50, s59
    s_cselect_b32 s48, 2359296, 0
    s_sub_u32 s50, s50, s48
    s_cmp_lg_u32 s35, 8
    s_cbranch_scc1 L_m_66
    buffer_load_dword v53, v52, s[44:47], s8 offen
    buffer_load_dword v53, v52, s[44:47], s9 offen
L_m_66:
    s_waitcnt vmcnt(12)
    s_barrier
    s_add_u32 m0, s68, 122880
    s_nop 0
    buffer_load_dwordx4 v8, s[36:39], s50 offen offset:0 sc1 lds
    s_branch L_skip_13
L_stub_13:
    s_branch L_back_a1
L_skip_13:
    buffer_load_dwordx4 v13, s[36:39], s50 offen offset:1024 sc1 lds
    buffer_load_dwordx4 v14, s[36:39], s50 offen offset:2048 sc1 lds
    s_add_u32 m0, s68, 125952
    s_nop 0
    buffer_load_dwordx4 v15, s[36:39], s50 offen offset:0 sc1 lds
    buffer_load_dwordx4 v16, s[36:39], s50 offen offset:1024 sc1 lds
    buffer_load_dwordx4 v17, s[36:39], s50 offen offset:2048 sc1 lds
    s_add_u32 s50, s58, 1327104
    s_cmp_ge_u32 s50, s59
    s_cselect_b32 s48, 2359296, 0
    s_sub_u32 s50, s50, s48
    s_cmp_lg_u32 s35, 9
    s_cbranch_scc1 L_m_67
    buffer_load_dword v53, v52, s[44:47], s8 offen
    buffer_load_dword v53, v52, s[44:47], s9 offen
L_m_67:
    s_waitcnt vmcnt(12)
    s_barrier
    s_add_u32 m0, s68, 135168
    s_nop 0
    buffer_load_dwordx4 v8, s[36:39], s50 offen offset:0 sc1 lds
    buffer_load_dwordx4 v13, s[36:39], s50 offen offset:1024 sc1 lds
    buffer_load_dwordx4 v14, s[36:39], s50 offen offset:2048 sc1 lds
    s_add_u32 m0, s68, 138240
    s_nop 0
    buffer_load_dwordx4 v15, s[36:39], s50 offen offset:0 sc1 lds
    buffer_load_dwordx4 v16, s[36:39], s50 offen offset:1024 sc1 lds
    buffer_load_dwordx4 v17, s[36:39], s50 offen offset:2048 sc1 lds
    s_add_u32 s50, s58, 1400832
    s_cmp_ge_u32 s50, s59
    s_cselect_b32 s48, 2359296, 0
    s_sub_u32 s50, s50, s48
    s_cmp_lg_u32 s35, 10
    s_cbranch_scc1 L_m_68
    buffer_load_dword v53, v52, s[44:47], s8 offen
    buffer_load_dword v53, v52, s[44:47], s9 offen
L_m_68:
    s_waitcnt vmcnt(12)
    s_barrier
    s_add_u32 m0, s68, 147456
    s_nop 0
    buffer_load_dwordx4 v8, s[36:39], s50 offen offset:0 sc1 lds
    buffer_load_dwordx4 v13, s[36:39], s50 offen offset:1024 sc1 lds
    buffer_load_dwordx4 v14, s[36:39], s50 offen offset:2048 sc1 lds
    s_add_u32 m0, s68, 150528
    s_nop 0
    buffer_load_dwordx4 v15, s[36:39], s50 offen offset:0 sc1 lds
    buffer_load_dwordx4 v16, s[36:39], s50 offen offset:1024 sc1 lds
    buffer_load_dwordx4 v17, s[36:39], s50 offen offset:2048 sc1 lds
    s_add_u32 s50, s58, 221184
    s_cmp_ge_u32 s50, s59
    s_cselect_b32 s48, 2359296, 0
    s_sub_u32 s50, s50, s48
    s_cmp_lg_u32 s35, 11
    s_cbranch_scc1 L_m_69
    buffer_load_dword v53, v52, s[44:47], s8 offen
    buffer_load_dword v53, v52, s[44:47], s9 offen
L_m_69:
    s_waitcnt vmcnt(12)
    s_barrier
    s_add_u32 m0, s68, 98304
    s_nop 0
    buffer_load_dwordx4 v8, s[36:39], s50 offen offset:0 sc1 lds
    buffer_load_dwordx4 v13, s[36:39], s50 offen offset:1024 sc1 lds
    buffer_load_dwordx4 v14, s[36:39], s50 offen offset:2048 sc1 lds
    s_add_u32 m0, s68, 101376
    s_nop 0
    buffer_load_dwordx4 v15, s[36:39], s50 offen offset:0 sc1 lds
    buffer_load_dwordx4 v16, s[36:39], s50 offen offset:1024 sc1 lds
    buffer_load_dwordx4 v17, s[36:39], s50 offen offset:2048 sc1 lds
    s_add_u32 s50, s58, 1474560
    s_cmp_ge_u32 s50, s59
    s_cselect_b32 s48, 2359296, 0
    s_sub_u32 s50, s50, s48
    s_cmp_lg_u32 s35, 12
    s_cbranch_scc1 L_m_70
    buffer_load_dword v53, v52, s[44:47], s8 offen
    buffer_load_dword v53, v52, s[44:47], s9 offen
L_m_70:
    s_waitcnt vmcnt(12)
    s_barrier
    s_add_u32 m0, s68, 110592
    s_nop 0
    buffer_load_dwordx4 v8, s[36:39], s50 offen offset:0 sc1 lds
    buffer_load_dwordx4 v13, s[36:39], s50 offen offset:1024 sc1 lds
    buffer_load_dwordx4 v14, s[36:39], s50 offen offset:2048 sc1 lds
    s_add_u32 m0, s68, 113664
    s_nop 0
    buffer_load_dwordx4 v15, s[36:39], s50 offen offset:0 sc1 lds
    buffer_load_dwordx4 v16, s[36:39], s50 offen offset:1024 sc1 lds
    buffer_load_dwordx4 v17, s[36:39], s50 offen offset:2048 sc1 lds
    s_add_u32 s50, s58, 1548288
    s_cmp_ge_u32 s50, s59
    s_cselect_b32 s48, 2359296, 0
    s_sub_u32 s50, s50, s48
    s_cmp_lg_u32 s35, 13
    s_cbranch_scc1 L_m_71
    buffer_load_dword v53, v52, s[44:47], s8 offen
    buffer_load_dword v53, v52, s[44:47], s9 offen
L_m_71:
    s_waitcnt vmcnt(12)
    s_barrier
    s_add_u32 m0, s68, 122880
    s_nop 0
    buffer_load_dwordx4 v8, s[36:39], s50 offen offset:0 sc1 lds
    buffer_load_dwordx4 v13, s[36:39], s50 offen offset:1024 sc1 lds
    buffer_load_dwordx4 v14, s[36:39], s50 offen offset:2048 sc1 lds
    s_add_u32 m0, s68, 125952
    s_nop 0
    buffer_load_dwordx4 v15, s[36:39], s50 offen offset:0 sc1 lds
    buffer_load_dwordx4 v16, s[36:39], s50 offen offset:1024 sc1 lds
    buffer_load_dwordx4 v17, s[36:39], s50 offen offset:2048 sc1 lds
    s_add_u32 s50, s58, 294912
    s_cmp_ge_u32 s50, s59
    s_cselect_b32 s48, 2359296, 0
    s_sub_u32 s50, s50, s48
    s_waitcnt vmcnt(12)
    s_barrier
    s_add_u32 m0, s68, 135168
    s_nop 0
    buffer_load_dwordx4 v8, s[36:39], s50 offen offset:0 sc1 lds
    buffer_load_dwordx4 v13, s[36:39], s50 offen offset:1024 sc1 lds
    buffer_load_dwordx4 v14, s[36:39], s50 offen offset:2048 sc1 lds
    s_add_u32 m0, s68, 138240
    s_nop 0
    buffer_load_dwordx4 v15, s[36:39], s50 offen offset:0 sc1 lds
    buffer_load_dwordx4 v16, s[36:39], s50 offen offset:1024 sc1 lds
    buffer_load_dwordx4 v17, s[36:39], s50 offen offset:2048 sc1 lds
    s_add_u32 s50, s58, 1622016
    s_cmp_ge_u32 s50, s59
    s_cselect_b32 s48, 2359296, 0
    s_sub_u32 s50, s50, s48
    s_waitcnt vmcnt(12)
    s_barrier
    s_add_u32 m0, s68, 147456
    s_nop 0
    buffer_load_dwordx4 v8, s[36:39], s50 offen offset:0 sc1 lds
    buffer_load_dwordx4 v13, s[36:39], s50 offen offset:1024 sc1 lds
    buffer_load_dwordx4 v14, s[36:39], s50 offen offset:2048 sc1 lds
    s_add_u32 m0, s68, 150528
    s_nop 0
    buffer_load_dwordx4 v15, s[36:39], s50 offen offset:0 sc1 lds
    buffer_load_dwordx4 v16, s[36:39], s50 offen offset:1024 sc1 lds
    buffer_load_dwordx4 v17, s[36:39], s50 offen offset:2048 sc1 lds
    s_add_u32 s50, s58, 1695744
    s_cmp_ge_u32 s50, s59
    s_cselect_b32 s48, 2359296, 0
    s_sub_u32 s50, s50, s48
    s_waitcnt vmcnt(12)
    s_barrier
    s_add_u32 m0, s68, 98304
    s_nop 0
    buffer_load_dwordx4 v8, s[36:39], s50 offen offset:0 sc1 lds
    buffer_load_dwordx4 v13, s[36:39], s50 offen offset:1024 sc1 lds
    buffer_load_dwordx4 v14, s[36:39], s50 offen offset:2048 sc1 lds
    s_add_u32 m0, s68, 101376
    s_nop 0
    buffer_load_dwordx4 v15, s[36:39], s50 offen offset:0 sc1 lds
    buffer_load_dwordx4 v16, s[36:39], s50 offen offset:1024 sc1 lds
    buffer_load_dwordx4 v17, s[36:39], s50 offen offset:2048 sc1 lds
    s_add_u32 s50, s58, 368640
    s_cmp_ge_u32 s50, s59
    s_cselect_b32 s48, 2359296, 0
    s_sub_u32 s50, s50, s48
    s_waitcnt vmcnt(12)
    s_barrier
    s_add_u32 m0, s68, 110592
    s_nop 0
    buffer_load_dwordx4 v8, s[36:39], s50 offen offset:0 sc1 lds
    buffer_load_dwordx4 v13, s[36:39], s50 offen offset:1024 sc1 lds
    buffer_load_dwordx4 v14, s[36:39], s50 offen offset:2048 sc1 lds
    s_add_u32 m0, s68, 113664
    s_nop 0
    buffer_load_dwordx4 v15, s[36:39], s50 offen offset:0 sc1 lds
    buffer_load_dwordx4 v16, s[36:39], s50 offen offset:1024 sc1 lds
    buffer_load_dwordx4 v17, s[36:39], s50 offen offset:2048 sc1 lds
    s_add_u32 s50, s58, 1769472
    s_cmp_ge_u32 s50, s59
    s_cselect_b32 s48, 2359296, 0
    s_sub_u32 s50, s50, s48
    s_waitcnt vmcnt(12)
    s_barrier
    s_add_u32 m0, s68, 122880
    s_nop 0
    buffer_load_dwordx4 v8, s[36:39], s50 offen offset:0 sc1 lds
    buffer_load_dwordx4 v13, s[36:39], s50 offen offset:1024 sc1 lds
    buffer_load_dwordx4 v14, s[36:39], s50 offen offset:2048 sc1 lds
    s_add_u32 m0, s68, 125952
    s_nop 0
    buffer_load_dwordx4 v15, s[36:39], s50 offen offset:0 sc1 lds
    buffer_load_dwordx4 v16, s[36:39], s50 offen offset:1024 sc1 lds
    buffer_load_dwordx4 v17, s[36:39], s50 offen offset:2048 sc1 lds
    s_add_u32 s50, s58, 1843200
    s_cmp_ge_u32 s50, s59
    s_cselect_b32 s48, 2359296, 0
    s_sub_u32 s50, s50, s48
    s_waitcnt vmcnt(12)
    s_barrier
    s_add_u32 m0, s68, 135168
    s_nop 0
    buffer_load_dwordx4 v8, s[36:39], s50 offen offset:0 sc1 lds
    buffer_load_dwordx4 v13, s[36:39], s50 offen offset:1024 sc1 lds
    buffer_load_dwordx4 v14, s[36:39], s50 offen offset:2048 sc1 lds
    s_add_u32 m0, s68, 138240
    s_nop 0
    buffer_load_dwordx4 v15, s[36:39], s50 offen offset:0 sc1 lds
    buffer_load_dwordx4 v16, s[36:39], s50 offen offset:1024 sc1 lds
    buffer_load_dwordx4 v17, s[36:39], s50 offen offset:2048 sc1 lds
    s_add_u32 s50, s58, 442368
    s_cmp_ge_u32 s50, s59
    s_cselect_b32 s48, 2359296, 0
    s_sub_u32 s50, s50, s48
    s_waitcnt vmcnt(12)
    s_barrier
    s_add_u32 m0, s68, 147456
    s_nop 0
    buffer_load_dwordx4 v8, s[36:39], s50 offen offset:0 sc1 lds
    buffer_load_dwordx4 v13, s[36:39], s50 offen offset:1024 sc1 lds
    buffer_load_dwordx4 v14, s[36:39], s50 offen offset:2048 sc1 lds
    s_add_u32 m0, s68, 150528
    s_nop 0
    buffer_load_dwordx4 v15, s[36:39], s50 offen offset:0 sc1 lds
    buffer_load_dwordx4 v16, s[36:39], s50 offen offset:1024 sc1 lds
    buffer_load_dwordx4 v17, s[36:39], s50 offen offset:2048 sc1 lds
    s_add_u32 s50, s58, 1916928
    s_cmp_ge_u32 s50, s59
    s_cselect_b32 s48, 2359296, 0
    s_sub_u32 s50, s50, s48
    s_waitcnt vmcnt(12)
    s_barrier
    s_add_u32 m0, s68, 98304
    s_nop 0
    buffer_load_dwordx4 v8, s[36:39], s50 offen offset:0 sc1 lds
    buffer_load_dwordx4 v13, s[36:39], s50 offen offset:1024 sc1 lds
    buffer_load_dwordx4 v14, s[36:39], s50 offen offset:2048 sc1 lds
    s_add_u32 m0, s68, 101376
    s_nop 0
    buffer_load_dwordx4 v15, s[36:39], s50 offen offset:0 sc1 lds
    buffer_load_dwordx4 v16, s[36:39], s50 offen offset:1024 sc1 lds
    buffer_load_dwordx4 v17, s[36:39], s50 offen offset:2048 sc1 lds
    s_add_u32 s50, s58, 1990656
    s_cmp_ge_u32 s50, s59
    s_cselect_b32 s48, 2359296, 0
    s_sub_u32 s50, s50, s48
    s_waitcnt vmcnt(12)
    s_barrier
    s_add_u32 m0, s68, 110592
    s_nop 0
    buffer_load_dwordx4 v8, s[36:39], s50 offen offset:0 sc1 lds
    buffer_load_dwordx4 v13, s[36:39], s50 offen offset:1024 sc1 lds
    buffer_load_dwordx4 v14, s[36:39], s50 offen offset:2048 sc1 lds
    s_add_u32 m0, s68, 113664
    s_nop 0
    buffer_load_dwordx4 v15, s[36:39], s50 offen offset:0 sc1 lds
    buffer_load_dwordx4 v16, s[36:39], s50 offen offset:1024 sc1 lds
    buffer_load_dwordx4 v17, s[36:39], s50 offen offset:2048 sc1 lds
    s_add_u32 s50, s58, 516096
    s_cmp_ge_u32 s50, s59
    s_cselect_b32 s48, 2359296, 0
    s_sub_u32 s50, s50, s48
    s_waitcnt vmcnt(12)
    s_barrier
    s_add_u32 m0, s68, 122880
    s_nop 0
    buffer_load_dwordx4 v8, s[36:39], s50 offen offset:0 sc1 lds
    buffer_load_dwordx4 v13, s[36:39], s50 offen offset:1024 sc1 lds
    buffer_load_dwordx4 v14, s[36:39], s50 offen offset:2048 sc1 lds
    s_add_u32 m0, s68, 125952
    s_nop 0
    buffer_load_dwordx4 v15, s[36:39], s50 offen offset:0 sc1 lds
    buffer_load_dwordx4 v16, s[36:39], s50 offen offset:1024 sc1 lds
    buffer_load_dwordx4 v17, s[36:39], s50 offen offset:2048 sc1 lds
    s_add_u32 s50, s58, 2064384
    s_cmp_ge_u32 s50, s59
    s_cselect_b32 s48, 2359296, 0
    s_sub_u32 s50, s50, s48
    s_waitcnt vmcnt(12)
    s_barrier
    s_add_u32 m0, s68, 135168
    s_nop 0
    buffer_load_dwordx4 v8, s[36:39], s50 offen offset:0 sc1 lds
    buffer_load_dwordx4 v13, s[36:39], s50 offen offset:1024 sc1 lds
    buffer_load_dwordx4 v14, s[36:39], s50 offen offset:2048 sc1 lds
    s_add_u32 m0, s68, 138240
    s_nop 0
    buffer_load_dwordx4 v15, s[36:39], s50 offen offset:0 sc1 lds
    buffer_load_dwordx4 v16, s[36:39], s50 offen offset:1024 sc1 lds
    buffer_load_dwordx4 v17, s[36:39], s50 offen offset:2048 sc1 lds
    s_add_u32 s50, s58, 2138112
    s_cmp_ge_u32 s50, s59
    s_cselect_b32 s48, 2359296, 0
    s_sub_u32 s50, s50, s48
    s_waitcnt vmcnt(12)
    s_barrier
    s_add_u32 m0, s68, 147456
    s_nop 0
    buffer_load_dwordx4 v8, s[36:39], s50 offen offset:0 sc1 lds
    buffer_load_dwordx4 v13, s[36:39], s50 offen offset:1024 sc1 lds
    buffer_load_dwordx4 v14, s[36:39], s50 offen offset:2048 sc1 lds
    s_add_u32 m0, s68, 150528
    s_nop 0
    buffer_load_dwordx4 v15, s[36:39], s50 offen offset:0 sc1 lds
    buffer_load_dwordx4 v16, s[36:39], s50 offen offset:1024 sc1 lds
    buffer_load_dwordx4 v17, s[36:39], s50 offen offset:2048 sc1 lds
    s_add_u32 s50, s58, 2211840
    s_cmp_ge_u32 s50, s59
    s_cselect_b32 s48, 2359296, 0
    s_sub_u32 s50, s50, s48
    s_waitcnt vmcnt(12)
    s_barrier
    s_add_u32 m0, s68, 98304
    s_nop 0
    buffer_load_dwordx4 v8, s[36:39], s50 offen offset:0 sc1 lds
    buffer_load_dwordx4 v13, s[36:39], s50 offen offset:1024 sc1 lds
    buffer_load_dwordx4 v14, s[36:39], s50 offen offset:2048 sc1 lds
    s_add_u32 m0, s68, 101376
    s_nop 0
    buffer_load_dwordx4 v15, s[36:39], s50 offen offset:0 sc1 lds
    buffer_load_dwordx4 v16, s[36:39], s50 offen offset:1024 sc1 lds
    buffer_load_dwordx4 v17, s[36:39], s50 offen offset:2048 sc1 lds
    s_add_u32 s50, s58, 2285568
    s_cmp_ge_u32 s50, s59
    s_cselect_b32 s48, 2359296, 0
    s_sub_u32 s50, s50, s48
    s_waitcnt vmcnt(12)
    s_barrier
    s_add_u32 m0, s68, 110592
    s_nop 0
    buffer_load_dwordx4 v8, s[36:39], s50 offen offset:0 sc1 lds
    buffer_load_dwordx4 v13, s[36:39], s50 offen offset:1024 sc1 lds
    buffer_load_dwordx4 v14, s[36:39], s50 offen offset:2048 sc1 lds
    s_add_u32 m0, s68, 113664
    s_nop 0
    buffer_load_dwordx4 v15, s[36:39], s50 offen offset:0 sc1 lds
    buffer_load_dwordx4 v16, s[36:39], s50 offen offset:1024 sc1 lds
    buffer_load_dwordx4 v17, s[36:39], s50 offen offset:2048 sc1 lds
    buffer_load_dword v68, v67, s[36:39], 0 offen sc1
    s_waitcnt vmcnt(12)
    s_barrier
    s_waitcnt vmcnt(6)
    s_barrier
    s_waitcnt vmcnt(0)
    s_barrier
    s_branch L_m_55
L_m_54:
    s_waitcnt lgkmcnt(0)
    buffer_store_dwordx4 v[28:31], v22, s[36:39], s57 offen sc1
    buffer_store_dwordx4 v[32:35], v23, s[36:39], s57 offen sc1
    buffer_store_dwordx4 v[36:39], v24, s[36:39], s57 offen sc1
    buffer_store_dwordx4 v[40:43], v25, s[36:39], s57 offen sc1
    buffer_store_dwordx4 v[44:47], v26, s[36:39], s57 offen sc1
    s_waitcnt vmcnt(0)
    s_barrier
    buffer_store_dword v3, v10, s[36:39], 0 offen sc1
    buffer_store_dwordx4 v[48:51], v54, s[36:39], 0 offen sc1
    v_add_u32 v76, 0, v0
    v_mul_u32_u24 v77, 1821, v76
    v_lshrrev_b32 v77, 18, v77
    v_mul_u32_u24 v77, 6912, v77
    v_lshl_add_u32 v77, v76, 4, v77
    v_subrev_u32 v56, 0, v77
    v_add_u32 v76, 64, v0
    v_mul_u32_u24 v77, 1821, v76
    v_lshrrev_b32 v77, 18, v77
    v_mul_u32_u24 v77, 6912, v77
    v_lshl_add_u32 v77, v76, 4, v77
    v_subrev_u32 v57, 1024, v77
    v_add_u32 v76, 128, v0
    v_mul_u32_u24 v77, 1821, v76
    v_lshrrev_b32 v77, 18, v77
    v_mul_u32_u24 v77, 6912, v77
    v_lshl_add_u32 v77, v76, 4, v77
    v_subrev_u32 v58, 2048, v77
    v_add_u32 v76, 192, v0
    v_mul_u32_u24 v77, 1821, v76
    v_lshrrev_b32 v77, 18, v77
    v_mul_u32_u24 v77, 6912, v77
    v_lshl_add_u32 v77, v76, 4, v77
    v_subrev_u32 v59, 3072, v77
    v_add_u32 v76, 256, v0
    v_mul_u32_u24 v77, 1821, v76
    v_lshrrev_b32 v77, 18, v77
    v_mul_u32_u24 v77, 6912, v77
    v_lshl_add_u32 v77, v76, 4, v77
    v_subrev_u32 v60, 0, v77
    v_add_u32 v76, 320, v0
    v_mul_u32_u24 v77, 1821, v76
    v_lshrrev_b32 v77, 18, v77
    v_mul_u32_u24 v77, 6912, v77
    v_lshl_add_u32 v77, v76, 4, v77
    v_subrev_u32 v61, 1024, v77
    v_add_u32 v76, 384, v0
    v_mul_u32_u24 v77, 1821, v76
    v_lshrrev_b32 v77, 18, v77
    v_mul_u32_u24 v77, 6912, v77
    v_lshl_add_u32 v77, v76, 4, v77
    v_subrev_u32 v62, 2048, v77
    v_add_u32 v76, 448, v0
    v_mul_u32_u24 v77, 1821, v76
    v_lshrrev_b32 v77, 18, v77
    v_mul_u32_u24 v77, 6912, v77
    v_lshl_add_u32 v77, v76, 4, v77
    v_subrev_u32 v63, 3072, v77
    v_add_u32 v76, 512, v0
    v_mul_u32_u24 v77, 1821, v76
    v_lshrrev_b32 v77, 18, v77
    v_mul_u32_u24 v77, 6912, v77
    v_lshl_add_u32 v77, v76, 4, v77
    v_subrev_u32 v64, 0, v77
    s_mul_i32 s48, s55, 3
    s_add_u32 s49, s48, 2
    s_lshr_b32 s48, s48, 1
    s_lshr_b32 s49, s49, 1
    v_mov_b32 v76, s48
    v_mov_b32 v77, s49
    v_cmp_gt_u32 vcc, 32, v0
    s_nop 1
    v_cndmask_b32 v76, v77, v76, vcc
    v_and_b32 v77, 31, v0
    v_min_u32 v77, 8, v77
    v_lshl_add_u32 v76, v76, 6, v77
    s_mul_i32 s48, s53, 9
    v_add_u32 v76, s48, v76
    v_lshlrev_b32 v66, 4, v76
    s_lshr_b32 s48, s54, 3
    s_lshl_b32 s48, s48, 2
    s_and_b32 s49, s54, 1
    s_lshl_b32 s49, s49, 1
    s_add_u32 s48, s48, s49
    s_add_u32 s48, s48, s62
    s_lshl_b32 s48, s48, 13
    s_add_u32 s48, s48, 15990784
    v_lshl_add_u32 v67, v0, 7, s48
    v_mov_b32 v68, 0
    s_lshl_b32 s48, s54, 7
    s_lshr_b32 s49, s53, 1
    s_lshl_b32 s49, s49, 4
    s_add_u32 s48, s48, s49
    s_mul_i32 s48, s48, 1152
    s_mul_i32 s49, s55, 288
    s_add_u32 s48, s48, s49
    s_and_b32 s49, s53, 1
    s_mul_i32 s49, s49, 144
    s_add_u32 s48, s48, s49
    s_add_u32 s12, s48, 12582912
    s_lshl_b32 s13, s62, 6
    v_add_u32 v76, s13, v0
    v_mul_u32_u24 v77, 911, v76
    v_lshrrev_b32 v77, 13, v77
    v_mul_u32_u24 v78, 9, v77
    v_sub_u32 v78, v76, v78
    v_and_b32 v76, 48, v77
    v_add_u32 v77, v77, v76
    v_mul_u32_u24 v77, 1152, v77
    v_lshl_add_u32 v77, v78, 4, v77
    v_add_u32 v70, s12, v77
    s_add_u32 s13, s13, 128
    v_add_u32 v76, s13, v0
    v_mul_u32_u24 v77, 911, v76
    v_lshrrev_b32 v77, 13, v77
    v_mul_u32_u24 v78, 9, v77
    v_sub_u32 v78, v76, v78
    v_and_b32 v76, 48, v77
    v_add_u32 v77, v77, v76
    v_mul_u32_u24 v77, 1152, v77
    v_lshl_add_u32 v77, v78, 4, v77
    v_add_u32 v71, s12, v77
    s_add_u32 s13, s13, 128
    v_add_u32 v76, s13, v0
    v_mul_u32_u24 v77, 911, v76
    v_lshrrev_b32 v77, 13, v77
    v_mul_u32_u24 v78, 9, v77
    v_sub_u32 v78, v76, v78
    v_and_b32 v76, 48, v77
    v_add_u32 v77, v77, v76
    v_mul_u32_u24 v77, 1152, v77
    v_lshl_add_u32 v77, v78, 4, v77
    v_add_u32 v72, s12, v77
    s_add_u32 s13, s13, 128
    v_add_u32 v76, s13, v0
    v_mul_u32_u24 v77, 911, v76
    v_lshrrev_b32 v77, 13, v77
    v_mul_u32_u24 v78, 9, v77
    v_sub_u32 v78, v76, v78
    v_and_b32 v76, 48, v77
    v_add_u32 v77, v77, v76
    v_mul_u32_u24 v77, 1152, v77
    v_lshl_add_u32 v77, v78, 4, v77
    v_add_u32 v73, s12, v77
    s_add_u32 s13, s13, 128
    v_add_u32 v76, s13, v0
    v_mul_u32_u24 v77, 911, v76
    v_lshrrev_b32 v77, 13, v77
    v_mul_u32_u24 v78, 9, v77
    v_sub_u32 v78, v76, v78
    v_and_b32 v76, 48, v77
    v_add_u32 v77, v77, v76
    v_mul_u32_u24 v77, 1152, v77
    v_lshl_add_u32 v77, v78, 4, v77
    v_add_u32 v74, s12, v77
    s_add_u32 s13, s13, 128
    s_mul_i32 s48, s55, 576
    s_and_b32 s49, s53, 1
    s_mul_i32 s49, s49, 288
    s_add_u32 s48, s48, s49
    s_add_u32 s48, s48, 11520
    v_min_u32 v76, 272, v8
    v_add_u32 v76, s48, v76
    s_cmp_eq_u32 s62, 1
    s_cselect_b64 vcc, -1, 0
    v_cndmask_b32 v74, v74, v76, vcc
    s_waitcnt vmcnt(0)
Lp_m_72:
    buffer_load_dword v4, v27, s[36:39], s65 offen sc1
    buffer_load_dword v5, v27, s[36:39], s69 offen sc1
    s_waitcnt vmcnt(0)
    v_cmp_ne_u32 vcc, v3, v4
    v_cmp_ne_u32 s[48:49], v3, v5
    s_nop 0
    s_or_b64 vcc, vcc, s[48:49]
    s_cbranch_vccz Le_m_73
    s_sub_u32 s7, s7, 1
    s_cbranch_scc1 Le_m_73
    s_mov_b64 exec, vcc
    s_sleep 1
    s_branch Lp_m_72
Le_m_73:
    s_mov_b64 exec, -1
    s_max_i32 s7, s7, 0
L_m_55:
    s_mul_i32 s67, s55, 2304
    s_mul_i32 s48, s53, 1327104
    s_add_u32 s67, s67, s48
    s_mul_i32 s48, s62, 36864
    s_add_u32 s67, s67, s48
    s_add_u32 s67, s67, 20971520
    s_mul_i32 s57, s62, 9216
    s_add_u32 s48, s57, 90112
    v_add_u32 v85, s48, v8
    v_add_u32 v90, 73728, v85
    s_mul_i32 s58, s64, 73728
    s_add_u32 s58, s58, s67
    s_add_u32 s59, s67, 1327104
    s_waitcnt vmcnt(0)
    v_cmp_ne_u32 vcc, v3, v68
    s_nop 0
    s_cbranch_vccz L_m_74
Lp_m_75:
    buffer_load_dword v68, v67, s[36:39], 0 offen sc1
    s_waitcnt vmcnt(0)
    v_cmp_ne_u32 vcc, v3, v68
    s_nop 0
    s_cbranch_vccz Le_m_76
    s_sub_u32 s7, s7, 1
    s_cbranch_scc1 Le_m_76
    s_mov_b64 exec, vcc
    s_sleep 1
    s_branch Lp_m_75
Le_m_76:
    s_mov_b64 exec, -1
    s_max_i32 s7, s7, 0
L_m_74:
    v_lshrrev_b32 v52, 4, v0
    v_and_b32 v53, 15, v0
    v_lshlrev_b32 v52, 12, v52
    v_lshl_add_u32 v52, v53, 7, v52
    s_lshr_b32 s48, s4, 1
    s_mul_i32 s48, s48, 4718592
    s_and_b32 s49, s4, 1
    s_lshl_b32 s49, s49, 11
    s_add_u32 s48, s48, s49
    v_add_u32 v52, s48, v52
    s_mov_b32 s35, 0
    s_mov_b32 s49, s35
    s_mul_i32 s48, s62, 1
    s_add_u32 s49, s49, s48
    s_bfm_b32 s48, s5, 0
    s_and_b32 s48, s48, 0
    s_bcnt1_i32_b32 s48, s48
    s_sub_u32 s12, s5, s48
    s_mul_i32 s35, s12, 3
    s_add_u32 s35, s35, 192
    s_add_u32 s35, s35, s49
    s_min_u32 s35, s35, 287
    s_lshl_b32 s8, s35, 14
    s_mul_i32 s35, s12, 3
    s_add_u32 s35, s35, 194
    s_sub_u32 s35, s35, s62
    s_sub_u32 s35, s35, s62
    s_add_u32 s35, s35, s49
    s_min_u32 s35, s35, 287
    s_lshl_b32 s9, s35, 14
    s_mul_i32 s35, s12, 64
    s_lshr_b32 s35, s35, 8
    s_add_u32 s35, s35, 0
    s_mul_i32 s48, s62, 0
    s_add_u32 s35, s35, s48
    s_mov_b32 s48, 0
    s_bitcmp1_b32 s48, s5
    s_cselect_b32 s35, 999, s35
    s_barrier
    s_branch L_stub_14
L_back_a2:
    s_barrier
    s_barrier
    s_barrier
    s_cmp_ge_u32 s5, 27
    s_cbranch_scc1 L_m_77
    buffer_store_dword v3, v11, s[36:39], 0 offen sc1
    s_branch L_m_78
L_m_77:
    s_lshl_b32 s50, s2, 7
    s_add_u32 s50, s50, 622592
    v_mov_b32 v28, 0
Lp_m_79:
    buffer_load_dword v29, v28, s[36:39], s50 offen sc1
    s_waitcnt vmcnt(0)
    v_cmp_ne_u32 vcc, v3, v29
    s_nop 0
    s_cbranch_vccz Le_m_80
    s_sub_u32 s7, s7, 1
    s_cbranch_scc1 Le_m_80
    s_sleep 4
    s_branch Lp_m_79
Le_m_80:
    s_max_i32 s7, s7, 0
L_m_78:
    s_add_u32 s50, s58, 442368
    s_cmp_ge_u32 s50, s59
    s_cselect_b32 s48, 1327104, 0
    s_sub_u32 s50, s50, s48
    s_add_u32 m0, s57, 90112
    s_nop 0
    buffer_load_dwordx4 v56, s[36:39], s50 offen offset:0 sc1 lds
    buffer_load_dwordx4 v57, s[36:39], s50 offen offset:1024 sc1 lds
    buffer_load_dwordx4 v58, s[36:39], s50 offen offset:2048 sc1 lds
    buffer_load_dwordx4 v59, s[36:39], s50 offen offset:3072 sc1 lds
    s_add_u32 m0, s57, 94208
    s_nop 0
    buffer_load_dwordx4 v60, s[36:39], s50 offen offset:0 sc1 lds
    buffer_load_dwordx4 v61, s[36:39], s50 offen offset:1024 sc1 lds
    buffer_load_dwordx4 v62, s[36:39], s50 offen offset:2048 sc1 lds
    buffer_load_dwordx4 v63, s[36:39], s50 offen offset:3072 sc1 lds
    s_add_u32 m0, s57, 98304
    s_nop 0
    buffer_load_dwordx4 v64, s[36:39], s50 offen offset:0 sc1 lds
    s_add_u32 s50, s58, 516096
    s_cmp_ge_u32 s50, s59
    s_cselect_b32 s48, 1327104, 0
    s_sub_u32 s50, s50, s48
    s_add_u32 m0, s57, 108544
    s_nop 0
    buffer_load_dwordx4 v56, s[36:39], s50 offen offset:0 sc1 lds
    buffer_load_dwordx4 v57, s[36:39], s50 offen offset:1024 sc1 lds
    buffer_load_dwordx4 v58, s[36:39], s50 offen offset:2048 sc1 lds
    buffer_load_dwordx4 v59, s[36:39], s50 offen offset:3072 sc1 lds
    s_add_u32 m0, s57, 112640
    s_nop 0
    buffer_load_dwordx4 v60, s[36:39], s50 offen offset:0 sc1 lds
    buffer_load_dwordx4 v61, s[36:39], s50 offen offset:1024 sc1 lds
    buffer_load_dwordx4 v62, s[36:39], s50 offen offset:2048 sc1 lds
    buffer_load_dwordx4 v63, s[36:39], s50 offen offset:3072 sc1 lds
    s_add_u32 m0, s57, 116736
    s_nop 0
    buffer_load_dwordx4 v64, s[36:39], s50 offen offset:0 sc1 lds
    s_add_u32 s50, s58, 589824
    s_cmp_ge_u32 s50, s59
    s_cselect_b32 s48, 1327104, 0
    s_sub_u32 s50, s50, s48
    s_add_u32 m0, s57, 126976
    s_nop 0
    buffer_load_dwordx4 v56, s[36:39], s50 offen offset:0 sc1 lds
    buffer_load_dwordx4 v57, s[36:39], s50 offen offset:1024 sc1 lds
    buffer_load_dwordx4 v58, s[36:39], s50 offen offset:2048 sc1 lds
    buffer_load_dwordx4 v59, s[36:39], s50 offen offset:3072 sc1 lds
    s_add_u32 m0, s57, 131072
    s_nop 0
    buffer_load_dwordx4 v60, s[36:39], s50 offen offset:0 sc1 lds
    buffer_load_dwordx4 v61, s[36:39], s50 offen offset:1024 sc1 lds
    buffer_load_dwordx4 v62, s[36:39], s50 offen offset:2048 sc1 lds
    buffer_load_dwordx4 v63, s[36:39], s50 offen offset:3072 sc1 lds
    s_add_u32 m0, s57, 135168
    s_nop 0
    buffer_load_dwordx4 v64, s[36:39], s50 offen offset:0 sc1 lds
    s_add_u32 s50, s58, 663552
    s_cmp_ge_u32 s50, s59
    s_cselect_b32 s48, 1327104, 0
    s_branch L_skip_14
L_stub_14:
    s_branch L_back_a2
L_skip_14:
    s_sub_u32 s50, s50, s48
    s_waitcnt vmcnt(18)
L_m_81:
    ds_read_b32 v76, v85 offset:0
    ds_read_b32 v77, v85 offset:1024
    ds_read_b32 v78, v85 offset:2048
    ds_read_b32 v79, v85 offset:3072
    ds_read_b32 v80, v85 offset:4096
    ds_read_b32 v81, v85 offset:5120
    ds_read_b32 v82, v85 offset:6144
    ds_read_b32 v83, v85 offset:7168
    ds_read_b32 v84, v85 offset:8192
    s_waitcnt lgkmcnt(6)
    v_max3_u32 v76, v76, v77, v78
    s_waitcnt lgkmcnt(4)
    v_max3_u32 v76, v76, v79, v80
    s_waitcnt lgkmcnt(2)
    v_max3_u32 v76, v76, v81, v82
    s_waitcnt lgkmcnt(0)
    v_max3_u32 v76, v76, v83, v84
    v_cmp_eq_u32 vcc, -1, v76
    s_nop 0
    s_cbranch_vccz L_m_82
    s_sub_u32 s7, s7, 1
    s_cbranch_scc1 L_m_82
    s_mov_b32 s14, m0
    s_sleep 2
    s_add_u32 s15, s58, 442368
    s_cmp_ge_u32 s15, s59
    s_cselect_b32 s48, 1327104, 0
    s_sub_u32 s15, s15, s48
    s_add_u32 m0, s57, 90112
    s_nop 0
    buffer_load_dwordx4 v56, s[36:39], s15 offen offset:0 sc1 lds
    buffer_load_dwordx4 v57, s[36:39], s15 offen offset:1024 sc1 lds
    buffer_load_dwordx4 v58, s[36:39], s15 offen offset:2048 sc1 lds
    buffer_load_dwordx4 v59, s[36:39], s15 offen offset:3072 sc1 lds
    s_add_u32 m0, s57, 94208
    s_nop 0
    buffer_load_dwordx4 v60, s[36:39], s15 offen offset:0 sc1 lds
    buffer_load_dwordx4 v61, s[36:39], s15 offen offset:1024 sc1 lds
    buffer_load_dwordx4 v62, s[36:39], s15 offen offset:2048 sc1 lds
    buffer_load_dwordx4 v63, s[36:39], s15 offen offset:3072 sc1 lds
    s_add_u32 m0, s57, 98304
    s_nop 0
    buffer_load_dwordx4 v64, s[36:39], s15 offen offset:0 sc1 lds
    s_mov_b32 m0, s14
    s_waitcnt vmcnt(0)
    s_branch L_m_81
L_m_82:
    s_max_i32 s7, s7, 0
    s_barrier
    s_add_u32 m0, s57, 145408
    s_nop 0
    buffer_load_dwordx4 v56, s[36:39], s50 offen offset:0 sc1 lds
    buffer_load_dwordx4 v57, s[36:39], s50 offen offset:1024 sc1 lds
    buffer_load_dwordx4 v58, s[36:39], s50 offen offset:2048 sc1 lds
    buffer_load_dwordx4 v59, s[36:39], s50 offen offset:3072 sc1 lds
    s_add_u32 m0, s57, 149504
    s_nop 0
    buffer_load_dwordx4 v60, s[36:39], s50 offen offset:0 sc1 lds
    buffer_load_dwordx4 v61, s[36:39], s50 offen offset:1024 sc1 lds
    buffer_load_dwordx4 v62, s[36:39], s50 offen offset:2048 sc1 lds
    buffer_load_dwordx4 v63, s[36:39], s50 offen offset:3072 sc1 lds
    s_add_u32 m0, s57, 153600
    s_nop 0
    buffer_load_dwordx4 v64, s[36:39], s50 offen offset:0 sc1 lds
    s_add_u32 s50, s58, 0
    s_cmp_ge_u32 s50, s59
    s_cselect_b32 s48, 1327104, 0
    s_sub_u32 s50, s50, s48
    s_cmp_lg_u32 s35, 0
    s_cbranch_scc1 L_m_83
    buffer_load_dword v53, v52, s[44:47], s8 offen
    s_cmp_lg_u32 s62, 0
    s_cbranch_scc1 L_m_83
    buffer_load_dword v53, v52, s[44:47], s9 offen
L_m_83:
    s_waitcnt vmcnt(18)
L_m_84:
    ds_read_b32 v76, v85 offset:18432
    ds_read_b32 v77, v85 offset:19456
    ds_read_b32 v78, v85 offset:20480
    ds_read_b32 v79, v85 offset:21504
    ds_read_b32 v80, v85 offset:22528
    ds_read_b32 v81, v85 offset:23552
    ds_read_b32 v82, v85 offset:24576
    ds_read_b32 v83, v85 offset:25600
    ds_read_b32 v84, v85 offset:26624
    s_waitcnt lgkmcnt(6)
    v_max3_u32 v76, v76, v77, v78
    s_waitcnt lgkmcnt(4)
    v_max3_u32 v76, v76, v79, v80
    s_waitcnt lgkmcnt(2)
    v_max3_u32 v76, v76, v81, v82
    s_waitcnt lgkmcnt(0)
    v_max3_u32 v76, v76, v83, v84
    v_cmp_eq_u32 vcc, -1, v76
    s_nop 0
    s_cbranch_vccz L_m_85
    s_sub_u32 s7, s7, 1
    s_cbranch_scc1 L_m_85
    s_mov_b32 s14, m0
    s_sleep 2
    s_add_u32 s15, s58, 516096
    s_cmp_ge_u32 s15, s59
    s_cselect_b32 s48, 1327104, 0
    s_sub_u32 s15, s15, s48
    s_add_u32 m0, s57, 108544
    s_nop 0
    buffer_load_dwordx4 v56, s[36:39], s15 offen offset:0 sc1 lds
    buffer_load_dwordx4 v57, s[36:39], s15 offen offset:1024 sc1 lds
    buffer_load_dwordx4 v58, s[36:39], s15 offen offset:2048 sc1 lds
    buffer_load_dwordx4 v59, s[36:39], s15 offen offset:3072 sc1 lds
    s_add_u32 m0, s57, 112640
    s_nop 0
    buffer_load_dwordx4 v60, s[36:39], s15 offen offset:0 sc1 lds
    buffer_load_dwordx4 v61, s[36:39], s15 offen offset:1024 sc1 lds
    buffer_load_dwordx4 v62, s[36:39], s15 offen offset:2048 sc1 lds
    buffer_load_dwordx4 v63, s[36:39], s15 offen offset:3072 sc1 lds
    s_add_u32 m0, s57, 116736
    s_nop 0
    buffer_load_dwordx4 v64, s[36:39], s15 offen offset:0 sc1 lds
    s_mov_b32 m0, s14
    s_waitcnt vmcnt(0)
    s_branch L_m_84
L_m_85:
    s_max_i32 s7, s7, 0
    s_barrier
    buffer_load_dword v28, v66, s[36:39], s66 offen sc1
    s_cmp_lg_u32 s35, 1
    s_cbranch_scc1 L_m_86
    buffer_load_dword v53, v52, s[44:47], s8 offen
    s_cmp_lg_u32 s62, 0
    s_cbranch_scc1 L_m_86
    buffer_load_dword v53, v52, s[44:47], s9 offen
L_m_86:
    s_waitcnt vmcnt(10)
L_m_87:
    ds_read_b32 v76, v85 offset:36864
    ds_read_b32 v77, v85 offset:37888
    ds_read_b32 v78, v85 offset:38912
    ds_read_b32 v79, v85 offset:39936
    ds_read_b32 v80, v85 offset:40960
    ds_read_b32 v81, v85 offset:41984
    ds_read_b32 v82, v85 offset:43008
    ds_read_b32 v83, v85 offset:44032
    ds_read_b32 v84, v85 offset:45056
    s_waitcnt lgkmcnt(6)
    v_max3_u32 v76, v76, v77, v78
    s_waitcnt lgkmcnt(4)
    v_max3_u32 v76, v76, v79, v80
    s_waitcnt lgkmcnt(2)
    v_max3_u32 v76, v76, v81, v82
    s_waitcnt lgkmcnt(0)
    v_max3_u32 v76, v76, v83, v84
    v_cmp_eq_u32 vcc, -1, v76
    s_nop 0
    s_cbranch_vccz L_m_88
    s_sub_u32 s7, s7, 1
    s_cbranch_scc1 L_m_88
    s_mov_b32 s14, m0
    s_sleep 2
    s_add_u32 s15, s58, 589824
    s_cmp_ge_u32 s15, s59
    s_cselect_b32 s48, 1327104, 0
    s_sub_u32 s15, s15, s48
    s_add_u32 m0, s57, 126976
    s_nop 0
    buffer_load_dwordx4 v56, s[36:39], s15 offen offset:0 sc1 lds
    buffer_load_dwordx4 v57, s[36:39], s15 offen offset:1024 sc1 lds
    buffer_load_dwordx4 v58, s[36:39], s15 offen offset:2048 sc1 lds
    buffer_load_dwordx4 v59, s[36:39], s15 offen offset:3072 sc1 lds
    s_add_u32 m0, s57, 131072
    s_nop 0
    buffer_load_dwordx4 v60, s[36:39], s15 offen offset:0 sc1 lds
    buffer_load_dwordx4 v61, s[36:39], s15 offen offset:1024 sc1 lds
    buffer_load_dwordx4 v62, s[36:39], s15 offen offset:2048 sc1 lds
    buffer_load_dwordx4 v63, s[36:39], s15 offen offset:3072 sc1 lds
    s_add_u32 m0, s57, 135168
    s_nop 0
    buffer_load_dwordx4 v64, s[36:39], s15 offen offset:0 sc1 lds
    s_mov_b32 m0, s14
    s_waitcnt vmcnt(0)
    s_branch L_m_87
L_m_88:
    s_max_i32 s7, s7, 0
    s_barrier
    s_waitcnt vmcnt(0)
    v_cmp_ne_u32 vcc, v3, v28
    s_nop 0
    s_cbranch_vccz L_m_89
Lp_m_90:
    buffer_load_dword v28, v66, s[36:39], s66 offen sc1
    s_waitcnt vmcnt(0)
    v_cmp_ne_u32 vcc, v3, v28
    s_nop 0
    s_cbranch_vccz Le_m_91
    s_sub_u32 s7, s7, 1
    s_cbranch_scc1 Le_m_91
    s_mov_b64 exec, vcc
    s_sleep 1
    s_branch Lp_m_90
Le_m_91:
    s_mov_b64 exec, -1
    s_max_i32 s7, s7, 0
L_m_89:
    s_add_u32 m0, s57, 90112
    s_nop 0
    buffer_load_dwordx4 v56, s[36:39], s50 offen offset:0 sc1 lds
    buffer_load_dwordx4 v57, s[36:39], s50 offen offset:1024 sc1 lds
    buffer_load_dwordx4 v58, s[36:39], s50 offen offset:2048 sc1 lds
    buffer_load_dwordx4 v59, s[36:39], s50 offen offset:3072 sc1 lds
    s_add_u32 m0, s57, 94208
    s_nop 0
    buffer_load_dwordx4 v60, s[36:39], s50 offen offset:0 sc1 lds
    buffer_load_dwordx4 v61, s[36:39], s50 offen offset:1024 sc1 lds
    buffer_load_dwordx4 v62, s[36:39], s50 offen offset:2048 sc1 lds
    buffer_load_dwordx4 v63, s[36:39], s50 offen offset:3072 sc1 lds
    s_add_u32 m0, s57, 98304
    s_nop 0
    buffer_load_dwordx4 v64, s[36:39], s50 offen offset:0 sc1 lds
    s_add_u32 s50, s58, 737280
    s_cmp_ge_u32 s50, s59
    s_cselect_b32 s48, 1327104, 0
    s_sub_u32 s50, s50, s48
    s_cmp_lg_u32 s35, 2
    s_cbranch_scc1 L_m_92
    buffer_load_dword v53, v52, s[44:47], s8 offen
    s_cmp_lg_u32 s62, 0
    s_cbranch_scc1 L_m_92
    buffer_load_dword v53, v52, s[44:47], s9 offen
L_m_92:
    s_waitcnt vmcnt(10)
L_m_93:
    ds_read_b32 v76, v85 offset:55296
    ds_read_b32 v77, v85 offset:56320
    ds_read_b32 v78, v85 offset:57344
    ds_read_b32 v79, v85 offset:58368
    ds_read_b32 v80, v85 offset:59392
    ds_read_b32 v81, v85 offset:60416
    ds_read_b32 v82, v85 offset:61440
    ds_read_b32 v83, v85 offset:62464
    ds_read_b32 v84, v85 offset:63488
    s_waitcnt lgkmcnt(6)
    v_max3_u32 v76, v76, v77, v78
    s_waitcnt lgkmcnt(4)
    v_max3_u32 v76, v76, v79, v80
    s_waitcnt lgkmcnt(2)
    v_max3_u32 v76, v76, v81, v82
    s_waitcnt lgkmcnt(0)
    v_max3_u32 v76, v76, v83, v84
    v_cmp_eq_u32 vcc, -1, v76
    s_nop 0
    s_cbranch_vccz L_m_94
    s_sub_u32 s7, s7, 1
    s_cbranch_scc1 L_m_94
    s_mov_b32 s14, m0
    s_sleep 2
    s_add_u32 s15, s58, 663552
    s_cmp_ge_u32 s15, s59
    s_cselect_b32 s48, 1327104, 0
    s_sub_u32 s15, s15, s48
    s_add_u32 m0, s57, 145408
    s_nop 0
    buffer_load_dwordx4 v56, s[36:39], s15 offen offset:0 sc1 lds
    buffer_load_dwordx4 v57, s[36:39], s15 offen offset:1024 sc1 lds
    buffer_load_dwordx4 v58, s[36:39], s15 offen offset:2048 sc1 lds
    buffer_load_dwordx4 v59, s[36:39], s15 offen offset:3072 sc1 lds
    s_add_u32 m0, s57, 149504
    s_nop 0
    buffer_load_dwordx4 v60, s[36:39], s15 offen offset:0 sc1 lds
    buffer_load_dwordx4 v61, s[36:39], s15 offen offset:1024 sc1 lds
    buffer_load_dwordx4 v62, s[36:39], s15 offen offset:2048 sc1 lds
    buffer_load_dwordx4 v63, s[36:39], s15 offen offset:3072 sc1 lds
    s_add_u32 m0, s57, 153600
    s_nop 0
    buffer_load_dwordx4 v64, s[36:39], s15 offen offset:0 sc1 lds
    s_mov_b32 m0, s14
    s_waitcnt vmcnt(0)
    s_branch L_m_93
L_m_94:
    s_max_i32 s7, s7, 0
    s_barrier
    s_add_u32 m0, s57, 108544
    s_nop 0
    buffer_load_dwordx4 v56, s[36:39], s50 offen offset:0 sc1 lds
    buffer_load_dwordx4 v57, s[36:39], s50 offen offset:1024 sc1 lds
    buffer_load_dwordx4 v58, s[36:39], s50 offen offset:2048 sc1 lds
    buffer_load_dwordx4 v59, s[36:39], s50 offen offset:3072 sc1 lds
    s_add_u32 m0, s57, 112640
    s_nop 0
    buffer_load_dwordx4 v60, s[36:39], s50 offen offset:0 sc1 lds
    buffer_load_dwordx4 v61, s[36:39], s50 offen offset:1024 sc1 lds
    buffer_load_dwordx4 v62, s[36:39], s50 offen offset:2048 sc1 lds
    buffer_load_dwordx4 v63, s[36:39], s50 offen offset:3072 sc1 lds
    s_add_u32 m0, s57, 116736
    s_nop 0
    buffer_load_dwordx4 v64, s[36:39], s50 offen offset:0 sc1 lds
    s_add_u32 s50, s58, 73728
    s_cmp_ge_u32 s50, s59
    s_cselect_b32 s48, 1327104, 0
    s_sub_u32 s50, s50, s48
    s_cmp_lg_u32 s35, 3
    s_cbranch_scc1 L_m_95
    buffer_load_dword v53, v52, s[44:47], s8 offen
    s_cmp_lg_u32 s62, 0
    s_cbranch_scc1 L_m_95
    buffer_load_dword v53, v52, s[44:47], s9 offen
L_m_95:
    s_waitcnt vmcnt(9)
    s_barrier
    s_add_u32 m0, s57, 126976
    s_nop 0
    buffer_load_dwordx4 v56, s[36:39], s50 offen offset:0 sc1 lds
    buffer_load_dwordx4 v57, s[36:39], s50 offen offset:1024 sc1 lds
    buffer_load_dwordx4 v58, s[36:39], s50 offen offset:2048 sc1 lds
    buffer_load_dwordx4 v59, s[36:39], s50 offen offset:3072 sc1 lds
    s_add_u32 m0, s57, 131072
    s_nop 0
    buffer_load_dwordx4 v60, s[36:39], s50 offen offset:0 sc1 lds
    buffer_load_dwordx4 v61, s[36:39], s50 offen offset:1024 sc1 lds
    buffer_load_dwordx4 v62, s[36:39], s50 offen offset:2048 sc1 lds
    buffer_load_dwordx4 v63, s[36:39], s50 offen offset:3072 sc1 lds
    s_add_u32 m0, s57, 135168
    s_nop 0
    buffer_load_dwordx4 v64, s[36:39], s50 offen offset:0 sc1 lds
    s_add_u32 s50, s58, 811008
    s_cmp_ge_u32 s50, s59
    s_cselect_b32 s48, 1327104, 0
    s_sub_u32 s50, s50, s48
    s_cmp_lg_u32 s35, 4
    s_cbranch_scc1 L_m_96
    buffer_load_dword v53, v52, s[44:47], s8 offen
    s_cmp_lg_u32 s62, 0
    s_cbranch_scc1 L_m_96
    buffer_load_dword v53, v52, s[44:47], s9 offen
L_m_96:
    s_waitcnt vmcnt(9)
    s_barrier
    s_add_u32 m0, s57, 145408
    s_nop 0
    buffer_load_dwordx4 v56, s[36:39], s50 offen offset:0 sc1 lds
    buffer_load_dwordx4 v57, s[36:39], s50 offen offset:1024 sc1 lds
    buffer_load_dwordx4 v58, s[36:39], s50 offen offset:2048 sc1 lds
    buffer_load_dwordx4 v59, s[36:39], s50 offen offset:3072 sc1 lds
    s_add_u32 m0, s57, 149504
    s_nop 0
    buffer_load_dwordx4 v60, s[36:39], s50 offen offset:0 sc1 lds
    buffer_load_dwordx4 v61, s[36:39], s50 offen offset:1024 sc1 lds
    buffer_load_dwordx4 v62, s[36:39], s50 offen offset:2048 sc1 lds
    buffer_load_dwordx4 v63, s[36:39], s50 offen offset:3072 sc1 lds
    s_add_u32 m0, s57, 153600
    s_nop 0
    buffer_load_dwordx4 v64, s[36:39], s50 offen offset:0 sc1 lds
    s_add_u32 s50, s58, 147456
    s_cmp_ge_u32 s50, s59
    s_cselect_b32 s48, 1327104, 0
    s_sub_u32 s50, s50, s48
    s_cmp_lg_u32 s35, 5
    s_cbranch_scc1 L_m_97
    buffer_load_dword v53, v52, s[44:47], s8 offen
    s_cmp_lg_u32 s62, 0
    s_cbranch_scc1 L_m_97
    buffer_load_dword v53, v52, s[44:47], s9 offen
L_m_97:
    s_waitcnt vmcnt(9)
    s_barrier
    s_add_u32 m0, s57, 90112
    s_nop 0
    buffer_load_dwordx4 v56, s[36:39], s50 offen offset:0 sc1 lds
    buffer_load_dwordx4 v57, s[36:39], s50 offen offset:1024 sc1 lds
    buffer_load_dwordx4 v58, s[36:39], s50 offen offset:2048 sc1 lds
    buffer_load_dwordx4 v59, s[36:39], s50 offen offset:3072 sc1 lds
    s_add_u32 m0, s57, 94208
    s_nop 0
    buffer_load_dwordx4 v60, s[36:39], s50 offen offset:0 sc1 lds
    buffer_load_dwordx4 v61, s[36:39], s50 offen offset:1024 sc1 lds
    buffer_load_dwordx4 v62, s[36:39], s50 offen offset:2048 sc1 lds
    buffer_load_dwordx4 v63, s[36:39], s50 offen offset:3072 sc1 lds
    s_add_u32 m0, s57, 98304
    s_nop 0
    buffer_load_dwordx4 v64, s[36:39], s50 offen offset:0 sc1 lds
    s_add_u32 s50, s58, 884736
    s_cmp_ge_u32 s50, s59
    s_cselect_b32 s48, 1327104, 0
    s_sub_u32 s50, s50, s48
    s_cmp_lg_u32 s35, 6
    s_cbranch_scc1 L_m_98
    buffer_load_dword v53, v52, s[44:47], s8 offen
    s_cmp_lg_u32 s62, 0
    s_cbranch_scc1 L_m_98
    buffer_load_dword v53, v52, s[44:47], s9 offen
L_m_98:
    s_waitcnt vmcnt(9)
    s_barrier
    s_add_u32 m0, s57, 108544
    s_nop 0
    buffer_load_dwordx4 v56, s[36:39], s50 offen offset:0 sc1 lds
    buffer_load_dwordx4 v57, s[36:39], s50 offen offset:1024 sc1 lds
    buffer_load_dwordx4 v58, s[36:39], s50 offen offset:2048 sc1 lds
    buffer_load_dwordx4 v59, s[36:39], s50 offen offset:3072 sc1 lds
    s_add_u32 m0, s57, 112640
    s_nop 0
    buffer_load_dwordx4 v60, s[36:39], s50 offen offset:0 sc1 lds
    buffer_load_dwordx4 v61, s[36:39], s50 offen offset:1024 sc1 lds
    buffer_load_dwordx4 v62, s[36:39], s50 offen offset:2048 sc1 lds
    buffer_load_dwordx4 v63, s[36:39], s50 offen offset:3072 sc1 lds
    s_add_u32 m0, s57, 116736
    s_nop 0
    buffer_load_dwordx4 v64, s[36:39], s50 offen offset:0 sc1 lds
    s_add_u32 s50, s58, 221184
    s_cmp_ge_u32 s50, s59
    s_cselect_b32 s48, 1327104, 0
    s_sub_u32 s50, s50, s48
    s_cmp_lg_u32 s35, 7
    s_cbranch_scc1 L_m_99
    buffer_load_dword v53, v52, s[44:47], s8 offen
    s_cmp_lg_u32 s62, 0
    s_cbranch_scc1 L_m_99
    buffer_load_dword v53, v52, s[44:47], s9 offen
L_m_99:
    s_waitcnt vmcnt(9)
    s_barrier
    s_add_u32 m0, s57, 126976
    s_nop 0
    buffer_load_dwordx4 v56, s[36:39], s50 offen offset:0 sc1 lds
    buffer_load_dwordx4 v57, s[36:39], s50 offen offset:1024 sc1 lds
    buffer_load_dwordx4 v58, s[36:39], s50 offen offset:2048 sc1 lds
    buffer_load_dwordx4 v59, s[36:39], s50 offen offset:3072 sc1 lds
    s_add_u32 m0, s57, 131072
    s_nop 0
    buffer_load_dwordx4 v60, s[36:39], s50 offen offset:0 sc1 lds
    buffer_load_dwordx4 v61, s[36:39], s50 offen offset:1024 sc1 lds
    buffer_load_dwordx4 v62, s[36:39], s50 offen offset:2048 sc1 lds
    buffer_load_dwordx4 v63, s[36:39], s50 offen offset:3072 sc1 lds
    s_add_u32 m0, s57, 135168
    s_nop 0
    buffer_load_dwordx4 v64, s[36:39], s50 offen offset:0 sc1 lds
    s_add_u32 s50, s58, 294912
    s_cmp_ge_u32 s50, s59
    s_cselect_b32 s48, 1327104, 0
    s_sub_u32 s50, s50, s48
    s_waitcnt vmcnt(9)
    s_barrier
    s_add_u32 m0, s57, 145408
    s_nop 0
    buffer_load_dwordx4 v56, s[36:39], s50 offen offset:0 sc1 lds
    buffer_load_dwordx4 v57, s[36:39], s50 offen offset:1024 sc1 lds
    buffer_load_dwordx4 v58, s[36:39], s50 offen offset:2048 sc1 lds
    buffer_load_dwordx4 v59, s[36:39], s50 offen offset:3072 sc1 lds
    s_add_u32 m0, s57, 149504
    s_nop 0
    buffer_load_dwordx4 v60, s[36:39], s50 offen offset:0 sc1 lds
    buffer_load_dwordx4 v61, s[36:39], s50 offen offset:1024 sc1 lds
    buffer_load_dwordx4 v62, s[36:39], s50 offen offset:2048 sc1 lds
    buffer_load_dwordx4 v63, s[36:39], s50 offen offset:3072 sc1 lds
    s_add_u32 m0, s57, 153600
    s_nop 0
    buffer_load_dwordx4 v64, s[36:39], s50 offen offset:0 sc1 lds
    s_add_u32 s50, s58, 368640
    s_cmp_ge_u32 s50, s59
    s_cselect_b32 s48, 1327104, 0
    s_sub_u32 s50, s50, s48
    s_waitcnt vmcnt(9)
    s_barrier
    s_add_u32 m0, s57, 90112
    s_nop 0
    buffer_load_dwordx4 v56, s[36:39], s50 offen offset:0 sc1 lds
    buffer_load_dwordx4 v57, s[36:39], s50 offen offset:1024 sc1 lds
    buffer_load_dwordx4 v58, s[36:39], s50 offen offset:2048 sc1 lds
    buffer_load_dwordx4 v59, s[36:39], s50 offen offset:3072 sc1 lds
    s_add_u32 m0, s57, 94208
    s_nop 0
    buffer_load_dwordx4 v60, s[36:39], s50 offen offset:0 sc1 lds
    buffer_load_dwordx4 v61, s[36:39], s50 offen offset:1024 sc1 lds
    buffer_load_dwordx4 v62, s[36:39], s50 offen offset:2048 sc1 lds
    buffer_load_dwordx4 v63, s[36:39], s50 offen offset:3072 sc1 lds
    s_add_u32 m0, s57, 98304
    s_nop 0
    buffer_load_dwordx4 v64, s[36:39], s50 offen offset:0 sc1 lds
    s_add_u32 s50, s58, 958464
    s_cmp_ge_u32 s50, s59
    s_cselect_b32 s48, 1327104, 0
    s_sub_u32 s50, s50, s48
    s_waitcnt vmcnt(9)
    s_barrier
    s_add_u32 m0, s57, 108544
    s_nop 0
    buffer_load_dwordx4 v56, s[36:39], s50 offen offset:0 sc1 lds
    buffer_load_dwordx4 v57, s[36:39], s50 offen offset:1024 sc1 lds
    buffer_load_dwordx4 v58, s[36:39], s50 offen offset:2048 sc1 lds
    buffer_load_dwordx4 v59, s[36:39], s50 offen offset:3072 sc1 lds
    s_add_u32 m0, s57, 112640
    s_nop 0
    buffer_load_dwordx4 v60, s[36:39], s50 offen offset:0 sc1 lds
    buffer_load_dwordx4 v61, s[36:39], s50 offen offset:1024 sc1 lds
    buffer_load_dwordx4 v62, s[36:39], s50 offen offset:2048 sc1 lds
    buffer_load_dwordx4 v63, s[36:39], s50 offen offset:3072 sc1 lds
    s_add_u32 m0, s57, 116736
    s_nop 0
    buffer_load_dwordx4 v64, s[36:39], s50 offen offset:0 sc1 lds
    s_add_u32 s50, s58, 1032192
    s_cmp_ge_u32 s50, s59
    s_cselect_b32 s48, 1327104, 0
    s_sub_u32 s50, s50, s48
    s_waitcnt vmcnt(9)
    s_barrier
    s_add_u32 m0, s57, 126976
    s_nop 0
    buffer_load_dwordx4 v56, s[36:39], s50 offen offset:0 sc1 lds
    buffer_load_dwordx4 v57, s[36:39], s50 offen offset:1024 sc1 lds
    buffer_load_dwordx4 v58, s[36:39], s50 offen offset:2048 sc1 lds
    buffer_load_dwordx4 v59, s[36:39], s50 offen offset:3072 sc1 lds
    s_add_u32 m0, s57, 131072
    s_nop 0
    buffer_load_dwordx4 v60, s[36:39], s50 offen offset:0 sc1 lds
    buffer_load_dwordx4 v61, s[36:39], s50 offen offset:1024 sc1 lds
    buffer_load_dwordx4 v62, s[36:39], s50 offen offset:2048 sc1 lds
    buffer_load_dwordx4 v63, s[36:39], s50 offen offset:3072 sc1 lds
    s_add_u32 m0, s57, 135168
    s_nop 0
    buffer_load_dwordx4 v64, s[36:39], s50 offen offset:0 sc1 lds
    s_add_u32 s50, s58, 1105920
    s_cmp_ge_u32 s50, s59
    s_cselect_b32 s48, 1327104, 0
    s_sub_u32 s50, s50, s48
    s_waitcnt vmcnt(9)
    s_barrier
    s_add_u32 m0, s57, 145408
    s_nop 0
    buffer_load_dwordx4 v56, s[36:39], s50 offen offset:0 sc1 lds
    buffer_load_dwordx4 v57, s[36:39], s50 offen offset:1024 sc1 lds
    buffer_load_dwordx4 v58, s[36:39], s50 offen offset:2048 sc1 lds
    buffer_load_dwordx4 v59, s[36:39], s50 offen offset:3072 sc1 lds
    s_add_u32 m0, s57, 149504
    s_nop 0
    buffer_load_dwordx4 v60, s[36:39], s50 offen offset:0 sc1 lds
    buffer_load_dwordx4 v61, s[36:39], s50 offen offset:1024 sc1 lds
    buffer_load_dwordx4 v62, s[36:39], s50 offen offset:2048 sc1 lds
    buffer_load_dwordx4 v63, s[36:39], s50 offen offset:3072 sc1 lds
    s_add_u32 m0, s57, 153600
    s_nop 0
    buffer_load_dwordx4 v64, s[36:39], s50 offen offset:0 sc1 lds
    s_add_u32 s50, s58, 1179648
    s_cmp_ge_u32 s50, s59
    s_cselect_b32 s48, 1327104, 0
    s_sub_u32 s50, s50, s48
    s_waitcnt vmcnt(9)
    s_barrier
    s_add_u32 m0, s57, 90112
    s_nop 0
    buffer_load_dwordx4 v56, s[36:39], s50 offen offset:0 sc1 lds
    buffer_load_dwordx4 v57, s[36:39], s50 offen offset:1024 sc1 lds
    buffer_load_dwordx4 v58, s[36:39], s50 offen offset:2048 sc1 lds
    buffer_load_dwordx4 v59, s[36:39], s50 offen offset:3072 sc1 lds
    s_add_u32 m0, s57, 94208
    s_nop 0
    buffer_load_dwordx4 v60, s[36:39], s50 offen offset:0 sc1 lds
    buffer_load_dwordx4 v61, s[36:39], s50 offen offset:1024 sc1 lds
    buffer_load_dwordx4 v62, s[36:39], s50 offen offset:2048 sc1 lds
    buffer_load_dwordx4 v63, s[36:39], s50 offen offset:3072 sc1 lds
    s_add_u32 m0, s57, 98304
    s_nop 0
    buffer_load_dwordx4 v64, s[36:39], s50 offen offset:0 sc1 lds
    s_add_u32 s50, s58, 1253376
    s_cmp_ge_u32 s50, s59
    s_cselect_b32 s48, 1327104, 0
    s_sub_u32 s50, s50, s48
    s_waitcnt vmcnt(9)
    s_barrier
    s_add_u32 m0, s57, 108544
    s_nop 0
    buffer_load_dwordx4 v56, s[36:39], s50 offen offset:0 sc1 lds
    buffer_load_dwordx4 v57, s[36:39], s50 offen offset:1024 sc1 lds
    buffer_load_dwordx4 v58, s[36:39], s50 offen offset:2048 sc1 lds
    buffer_load_dwordx4 v59, s[36:39], s50 offen offset:3072 sc1 lds
    s_add_u32 m0, s57, 112640
    s_nop 0
    buffer_load_dwordx4 v60, s[36:39], s50 offen offset:0 sc1 lds
    buffer_load_dwordx4 v61, s[36:39], s50 offen offset:1024 sc1 lds
    buffer_load_dwordx4 v62, s[36:39], s50 offen offset:2048 sc1 lds
    buffer_load_dwordx4 v63, s[36:39], s50 offen offset:3072 sc1 lds
    s_add_u32 m0, s57, 116736
    s_nop 0
    buffer_load_dwordx4 v64, s[36:39], s50 offen offset:0 sc1 lds
    s_lshl_b32 s48, s62, 10
    s_add_u32 m0, s48, 32768
    s_nop 0
    buffer_load_dwordx4 v70, s[36:39], 0 offen sc1 lds
    s_lshl_b32 s48, s62, 10
    s_add_u32 m0, s48, 34816
    s_nop 0
    buffer_load_dwordx4 v71, s[36:39], 0 offen sc1 lds
    s_lshl_b32 s48, s62, 10
    s_add_u32 m0, s48, 36864
    s_nop 0
    buffer_load_dwordx4 v72, s[36:39], 0 offen sc1 lds
    s_lshl_b32 s48, s62, 10
    s_add_u32 m0, s48, 38912
    s_nop 0
    buffer_load_dwordx4 v73, s[36:39], 0 offen sc1 lds
    s_mul_i32 s48, s62, 40960
    s_add_u32 m0, s48, 40960
    s_nop 0
    buffer_load_dwordx4 v74, s[36:39], 0 offen sc1 lds
    s_waitcnt vmcnt(14)
    s_barrier
    s_waitcnt vmcnt(5)
    s_barrier
    s_waitcnt vmcnt(0)
    s_barrier
    s_branch L_m_100
L_m_50:
    v_lshlrev_b32 v29, 1, v2
    v_xor_b32 v29, v29, v1
    v_xor_b32 v30, 8, v29
    v_mul_u32_u24 v28, 4096, v2
    v_lshl_add_u32 v29, v29, 4, v28
    v_lshl_add_u32 v30, v30, 4, v28
    v_add_u32 v58, 30720, v29
    v_add_u32 v59, 46080, v30
    v_add_u32 v57, 15360, v30
    v_mov_b32 v56, v29
    v_add_u32 v60, 65536, v56
    v_add_u32 v61, 65536, v57
    v_add_u32 v62, 65536, v58
    v_add_u32 v63, 65536, v59
    s_mul_i32 s49, s53, 4718592
    s_lshl_b32 s48, s62, 17
    s_add_u32 s49, s49, s48
    s_lshl_b32 s48, s54, 8
    s_add_u32 s49, s49, s48
    s_mul_i32 s58, s64, 262144
    s_add_u32 s58, s58, s49
    s_add_u32 s59, s49, 4718592
    s_cmp_ge_u32 s5, 27
    s_cbranch_scc1 L_m_101
    v_lshlrev_b32 v29, 1, v2
    v_xor_b32 v29, v29, v1
    v_xor_b32 v30, 8, v29
    v_mul_u32_u24 v28, 2359296, v2
    v_lshl_add_u32 v29, v29, 4, v28
    v_lshl_add_u32 v30, v30, 4, v28
    v_add_u32 v14, 16384, v29
    v_add_u32 v15, 24576, v30
    v_add_u32 v13, 8192, v30
    v_mov_b32 v12, v29
    v_add_u32 v16, 9437184, v12
    v_add_u32 v17, 9437184, v13
    v_add_u32 v18, 9437184, v14
    v_add_u32 v19, 9437184, v15
    s_mul_i32 s49, s62, 36864
    s_lshl_b32 s48, s51, 8
    s_add_u32 s49, s49, s48
    s_mul_i32 s60, s63, 73728
    s_add_u32 s60, s60, s49
    s_add_u32 s61, s49, 2359296
    s_branch L_stub_15
L_back_w1:
    s_add_u32 s50, s60, 0
    s_cmp_ge_u32 s50, s61
    s_cselect_b32 s48, 2359296, 0
    s_sub_u32 s50, s50, s48
    s_add_u32 m0, s68, 0
    s_nop 0
    buffer_load_dwordx4 v12, s[40:43], s50 offen offset:0  lds
    buffer_load_dwordx4 v13, s[40:43], s50 offen offset:1024  lds
    buffer_load_dwordx4 v14, s[40:43], s50 offen offset:2048  lds
    s_branch L_skip_15
L_stub_15:
    s_branch L_stub_16
L_skip_15:
    buffer_load_dwordx4 v15, s[40:43], s50 offen offset:3072  lds
    s_add_u32 m0, s68, 4096
    s_nop 0
    buffer_load_dwordx4 v16, s[40:43], s50 offen offset:0  lds
    buffer_load_dwordx4 v17, s[40:43], s50 offen offset:1024  lds
    buffer_load_dwordx4 v18, s[40:43], s50 offen offset:2048  lds
    buffer_load_dwordx4 v19, s[40:43], s50 offen offset:3072  lds
    s_add_u32 s50, s60, 73728
    s_cmp_ge_u32 s50, s61
    s_cselect_b32 s48, 2359296, 0
    s_sub_u32 s50, s50, s48
    s_add_u32 m0, s68, 16384
    s_nop 0
    buffer_load_dwordx4 v12, s[40:43], s50 offen offset:0  lds
    buffer_load_dwordx4 v13, s[40:43], s50 offen offset:1024  lds
    buffer_load_dwordx4 v14, s[40:43], s50 offen offset:2048  lds
    buffer_load_dwordx4 v15, s[40:43], s50 offen offset:3072  lds
    s_add_u32 m0, s68, 20480
    s_nop 0
    buffer_load_dwordx4 v16, s[40:43], s50 offen offset:0  lds
    buffer_load_dwordx4 v17, s[40:43], s50 offen offset:1024  lds
    buffer_load_dwordx4 v18, s[40:43], s50 offen offset:2048  lds
    buffer_load_dwordx4 v19, s[40:43], s50 offen offset:3072  lds
    s_barrier
    s_add_u32 s50, s60, 147456
    s_cmp_ge_u32 s50, s61
    s_cselect_b32 s48, 2359296, 0
    s_sub_u32 s50, s50, s48
    s_add_u32 m0, s68, 32768
    s_nop 0
    buffer_load_dwordx4 v12, s[40:43], s50 offen offset:0  lds
    buffer_load_dwordx4 v13, s[40:43], s50 offen offset:1024  lds
    buffer_load_dwordx4 v14, s[40:43], s50 offen offset:2048  lds
    buffer_load_dwordx4 v15, s[40:43], s50 offen offset:3072  lds
    s_add_u32 m0, s68, 36864
    s_nop 0
    buffer_load_dwordx4 v16, s[40:43], s50 offen offset:0  lds
    buffer_load_dwordx4 v17, s[40:43], s50 offen offset:1024  lds
    buffer_load_dwordx4 v18, s[40:43], s50 offen offset:2048  lds
    buffer_load_dwordx4 v19, s[40:43], s50 offen offset:3072  lds
    s_add_u32 s50, s60, 221184
    s_cmp_ge_u32 s50, s61
    s_cselect_b32 s48, 2359296, 0
    s_sub_u32 s50, s50, s48
    s_add_u32 m0, s68, 49152
    s_nop 0
    buffer_load_dwordx4 v12, s[40:43], s50 offen offset:0  lds
    buffer_load_dwordx4 v13, s[40:43], s50 offen offset:1024  lds
    buffer_load_dwordx4 v14, s[40:43], s50 offen offset:2048  lds
    buffer_load_dwordx4 v15, s[40:43], s50 offen offset:3072  lds
    s_add_u32 m0, s68, 53248
    s_nop 0
    buffer_load_dwordx4 v16, s[40:43], s50 offen offset:0  lds
    buffer_load_dwordx4 v17, s[40:43], s50 offen offset:1024  lds
    buffer_load_dwordx4 v18, s[40:43], s50 offen offset:2048  lds
    buffer_load_dwordx4 v19, s[40:43], s50 offen offset:3072  lds
    s_barrier
    s_add_u32 s50, s60, 294912
    s_cmp_ge_u32 s50, s61
    s_cselect_b32 s48, 2359296, 0
    s_sub_u32 s50, s50, s48
    s_add_u32 m0, s68, 65536
    s_nop 0
    buffer_load_dwordx4 v12, s[40:43], s50 offen offset:0  lds
    buffer_load_dwordx4 v13, s[40:43], s50 offen offset:1024  lds
    buffer_load_dwordx4 v14, s[40:43], s50 offen offset:2048  lds
    buffer_load_dwordx4 v15, s[40:43], s50 offen offset:3072  lds
    s_add_u32 m0, s68, 69632
    s_nop 0
    buffer_load_dwordx4 v16, s[40:43], s50 offen offset:0  lds
    buffer_load_dwordx4 v17, s[40:43], s50 offen offset:1024  lds
    buffer_load_dwordx4 v18, s[40:43], s50 offen offset:2048  lds
    buffer_load_dwordx4 v19, s[40:43], s50 offen offset:3072  lds
    s_add_u32 s50, s60, 368640
    s_cmp_ge_u32 s50, s61
    s_cselect_b32 s48, 2359296, 0
    s_sub_u32 s50, s50, s48
    s_add_u32 m0, s68, 81920
    s_nop 0
    buffer_load_dwordx4 v12, s[40:43], s50 offen offset:0  lds
    buffer_load_dwordx4 v13, s[40:43], s50 offen offset:1024  lds
    buffer_load_dwordx4 v14, s[40:43], s50 offen offset:2048  lds
    buffer_load_dwordx4 v15, s[40:43], s50 offen offset:3072  lds
    s_add_u32 m0, s68, 86016
    s_nop 0
    buffer_load_dwordx4 v16, s[40:43], s50 offen offset:0  lds
    buffer_load_dwordx4 v17, s[40:43], s50 offen offset:1024  lds
    buffer_load_dwordx4 v18, s[40:43], s50 offen offset:2048  lds
    buffer_load_dwordx4 v19, s[40:43], s50 offen offset:3072  lds
    s_barrier
    s_waitcnt vmcnt(0)
    s_barrier
    s_barrier
    s_add_u32 s50, s60, 442368
    s_cmp_ge_u32 s50, s61
    s_cselect_b32 s48, 2359296, 0
    s_sub_u32 s50, s50, s48
    s_add_u32 m0, s68, 0
    s_nop 0
    buffer_load_dwordx4 v12, s[40:43], s50 offen offset:0  lds
    buffer_load_dwordx4 v13, s[40:43], s50 offen offset:1024  lds
    buffer_load_dwordx4 v14, s[40:43], s50 offen offset:2048  lds
    buffer_load_dwordx4 v15, s[40:43], s50 offen offset:3072  lds
    s_add_u32 m0, s68, 4096
    s_nop 0
    buffer_load_dwordx4 v16, s[40:43], s50 offen offset:0  lds
    buffer_load_dwordx4 v17, s[40:43], s50 offen offset:1024  lds
    buffer_load_dwordx4 v18, s[40:43], s50 offen offset:2048  lds
    buffer_load_dwordx4 v19, s[40:43], s50 offen offset:3072  lds
    s_add_u32 s50, s60, 516096
    s_cmp_ge_u32 s50, s61
    s_cselect_b32 s48, 2359296, 0
    s_sub_u32 s50, s50, s48
    s_add_u32 m0, s68, 16384
    s_nop 0
    buffer_load_dwordx4 v12, s[40:43], s50 offen offset:0  lds
    buffer_load_dwordx4 v13, s[40:43], s50 offen offset:1024  lds
    buffer_load_dwordx4 v14, s[40:43], s50 offen offset:2048  lds
    buffer_load_dwordx4 v15, s[40:43], s50 offen offset:3072  lds
    s_add_u32 m0, s68, 20480
    s_nop 0
    buffer_load_dwordx4 v16, s[40:43], s50 offen offset:0  lds
    buffer_load_dwordx4 v17, s[40:43], s50 offen offset:1024  lds
    buffer_load_dwordx4 v18, s[40:43], s50 offen offset:2048  lds
    buffer_load_dwordx4 v19, s[40:43], s50 offen offset:3072  lds
    s_add_u32 s50, s60, 589824
    s_cmp_ge_u32 s50, s61
    s_cselect_b32 s48, 2359296, 0
    s_sub_u32 s50, s50, s48
    s_add_u32 m0, s68, 32768
    s_nop 0
    buffer_load_dwordx4 v12, s[40:43], s50 offen offset:0  lds
    buffer_load_dwordx4 v13, s[40:43], s50 offen offset:1024  lds
    buffer_load_dwordx4 v14, s[40:43], s50 offen offset:2048  lds
    buffer_load_dwordx4 v15, s[40:43], s50 offen offset:3072  lds
    s_add_u32 m0, s68, 36864
    s_nop 0
    buffer_load_dwordx4 v16, s[40:43], s50 offen offset:0  lds
    buffer_load_dwordx4 v17, s[40:43], s50 offen offset:1024  lds
    buffer_load_dwordx4 v18, s[40:43], s50 offen offset:2048  lds
    buffer_load_dwordx4 v19, s[40:43], s50 offen offset:3072  lds
    s_add_u32 s50, s60, 663552
    s_cmp_ge_u32 s50, s61
    s_cselect_b32 s48, 2359296, 0
    s_sub_u32 s50, s50, s48
    s_add_u32 m0, s68, 49152
    s_nop 0
    buffer_load_dwordx4 v12, s[40:43], s50 offen offset:0  lds
    buffer_load_dwordx4 v13, s[40:43], s50 offen offset:1024  lds
    buffer_load_dwordx4 v14, s[40:43], s50 offen offset:2048  lds
    buffer_load_dwordx4 v15, s[40:43], s50 offen offset:3072  lds
    s_waitcnt vmcnt(12)
    s_barrier
    s_add_u32 m0, s68, 53248
    s_nop 0
    buffer_load_dwordx4 v16, s[40:43], s50 offen offset:0  lds
    buffer_load_dwordx4 v17, s[40:43], s50 offen offset:1024  lds
    buffer_load_dwordx4 v18, s[40:43], s50 offen offset:2048  lds
    buffer_load_dwordx4 v19, s[40:43], s50 offen offset:3072  lds
    s_barrier
    s_add_u32 s50, s60, 737280
    s_cmp_ge_u32 s50, s61
    s_cselect_b32 s48, 2359296, 0
    s_sub_u32 s50, s50, s48
    s_add_u32 m0, s68, 65536
    s_nop 0
    buffer_load_dwordx4 v12, s[40:43], s50 offen offset:0  lds
    buffer_load_dwordx4 v13, s[40:43], s50 offen offset:1024  lds
    buffer_load_dwordx4 v14, s[40:43], s50 offen offset:2048  lds
    buffer_load_dwordx4 v15, s[40:43], s50 offen offset:3072  lds
    s_add_u32 m0, s68, 69632
    s_nop 0
    buffer_load_dwordx4 v16, s[40:43], s50 offen offset:0  lds
    buffer_load_dwordx4 v17, s[40:43], s50 offen offset:1024  lds
    buffer_load_dwordx4 v18, s[40:43], s50 offen offset:2048  lds
    buffer_load_dwordx4 v19, s[40:43], s50 offen offset:3072  lds
    s_add_u32 s50, s60, 811008
    s_cmp_ge_u32 s50, s61
    s_cselect_b32 s48, 2359296, 0
    s_sub_u32 s50, s50, s48
    s_add_u32 m0, s68, 81920
    s_nop 0
    buffer_load_dwordx4 v12, s[40:43], s50 offen offset:0  lds
    buffer_load_dwordx4 v13, s[40:43], s50 offen offset:1024  lds
    buffer_load_dwordx4 v14, s[40:43], s50 offen offset:2048  lds
    buffer_load_dwordx4 v15, s[40:43], s50 offen offset:3072  lds
    s_add_u32 m0, s68, 86016
    s_nop 0
    buffer_load_dwordx4 v16, s[40:43], s50 offen offset:0  lds
    buffer_load_dwordx4 v17, s[40:43], s50 offen offset:1024  lds
    buffer_load_dwordx4 v18, s[40:43], s50 offen offset:2048  lds
    buffer_load_dwordx4 v19, s[40:43], s50 offen offset:3072  lds
    s_waitcnt vmcnt(24)
    s_barrier
    s_add_u32 s50, s60, 884736
    s_cmp_ge_u32 s50, s61
    s_cselect_b32 s48, 2359296, 0
    s_sub_u32 s50, s50, s48
    s_add_u32 m0, s68, 0
    s_nop 0
    buffer_load_dwordx4 v12, s[40:43], s50 offen offset:0  lds
    buffer_load_dwordx4 v13, s[40:43], s50 offen offset:1024  lds
    buffer_load_dwordx4 v14, s[40:43], s50 offen offset:2048  lds
    buffer_load_dwordx4 v15, s[40:43], s50 offen offset:3072  lds
    s_add_u32 m0, s68, 4096
    s_nop 0
    buffer_load_dwordx4 v16, s[40:43], s50 offen offset:0  lds
    buffer_load_dwordx4 v17, s[40:43], s50 offen offset:1024  lds
    buffer_load_dwordx4 v18, s[40:43], s50 offen offset:2048  lds
    buffer_load_dwordx4 v19, s[40:43], s50 offen offset:3072  lds
    s_waitcnt vmcnt(24)
    s_barrier
    s_add_u32 s50, s60, 958464
    s_cmp_ge_u32 s50, s61
    s_cselect_b32 s48, 2359296, 0
    s_sub_u32 s50, s50, s48
    s_add_u32 m0, s68, 16384
    s_nop 0
    buffer_load_dwordx4 v12, s[40:43], s50 offen offset:0  lds
    buffer_load_dwordx4 v13, s[40:43], s50 offen offset:1024  lds
    buffer_load_dwordx4 v14, s[40:43], s50 offen offset:2048  lds
    buffer_load_dwordx4 v15, s[40:43], s50 offen offset:3072  lds
    s_add_u32 m0, s68, 20480
    s_nop 0
    buffer_load_dwordx4 v16, s[40:43], s50 offen offset:0  lds
    buffer_load_dwordx4 v17, s[40:43], s50 offen offset:1024  lds
    buffer_load_dwordx4 v18, s[40:43], s50 offen offset:2048  lds
    buffer_load_dwordx4 v19, s[40:43], s50 offen offset:3072  lds
    s_waitcnt vmcnt(24)
    s_barrier
    s_add_u32 s50, s60, 1032192
    s_cmp_ge_u32 s50, s61
    s_cselect_b32 s48, 2359296, 0
    s_sub_u32 s50, s50, s48
    s_add_u32 m0, s68, 32768
    s_nop 0
    buffer_load_dwordx4 v12, s[40:43], s50 offen offset:0  lds
    buffer_load_dwordx4 v13, s[40:43], s50 offen offset:1024  lds
    buffer_load_dwordx4 v14, s[40:43], s50 offen offset:2048  lds
    buffer_load_dwordx4 v15, s[40:43], s50 offen offset:3072  lds
    s_add_u32 m0, s68, 36864
    s_nop 0
    buffer_load_dwordx4 v16, s[40:43], s50 offen offset:0  lds
    buffer_load_dwordx4 v17, s[40:43], s50 offen offset:1024  lds
    buffer_load_dwordx4 v18, s[40:43], s50 offen offset:2048  lds
    buffer_load_dwordx4 v19, s[40:43], s50 offen offset:3072  lds
    s_waitcnt vmcnt(24)
    s_barrier
    s_add_u32 s50, s60, 1105920
    s_cmp_ge_u32 s50, s61
    s_cselect_b32 s48, 2359296, 0
    s_sub_u32 s50, s50, s48
    s_add_u32 m0, s68, 49152
    s_nop 0
    buffer_load_dwordx4 v12, s[40:43], s50 offen offset:0  lds
    buffer_load_dwordx4 v13, s[40:43], s50 offen offset:1024  lds
    buffer_load_dwordx4 v14, s[40:43], s50 offen offset:2048  lds
    buffer_load_dwordx4 v15, s[40:43], s50 offen offset:3072  lds
    s_add_u32 m0, s68, 53248
    s_nop 0
    buffer_load_dwordx4 v16, s[40:43], s50 offen offset:0  lds
    buffer_load_dwordx4 v17, s[40:43], s50 offen offset:1024  lds
    buffer_load_dwordx4 v18, s[40:43], s50 offen offset:2048  lds
    buffer_load_dwordx4 v19, s[40:43], s50 offen offset:3072  lds
    s_waitcnt vmcnt(24)
    s_barrier
    s_waitcnt vmcnt(16)
    s_barrier
    s_add_u32 s50, s60, 1179648
    s_cmp_ge_u32 s50, s61
    s_cselect_b32 s48, 2359296, 0
    s_sub_u32 s50, s50, s48
    s_add_u32 m0, s68, 65536
    s_nop 0
    buffer_load_dwordx4 v12, s[40:43], s50 offen offset:0  lds
    buffer_load_dwordx4 v13, s[40:43], s50 offen offset:1024  lds
    buffer_load_dwordx4 v14, s[40:43], s50 offen offset:2048  lds
    buffer_load_dwordx4 v15, s[40:43], s50 offen offset:3072  lds
    s_add_u32 m0, s68, 69632
    s_nop 0
    buffer_load_dwordx4 v16, s[40:43], s50 offen offset:0  lds
    buffer_load_dwordx4 v17, s[40:43], s50 offen offset:1024  lds
    buffer_load_dwordx4 v18, s[40:43], s50 offen offset:2048  lds
    buffer_load_dwordx4 v19, s[40:43], s50 offen offset:3072  lds
    s_barrier
    s_add_u32 s50, s60, 1253376
    s_cmp_ge_u32 s50, s61
    s_cselect_b32 s48, 2359296, 0
    s_sub_u32 s50, s50, s48
    s_add_u32 m0, s68, 81920
    s_nop 0
    buffer_load_dwordx4 v12, s[40:43], s50 offen offset:0  lds
    buffer_load_dwordx4 v13, s[40:43], s50 offen offset:1024  lds
    buffer_load_dwordx4 v14, s[40:43], s50 offen offset:2048  lds
    buffer_load_dwordx4 v15, s[40:43], s50 offen offset:3072  lds
    s_add_u32 m0, s68, 86016
    s_nop 0
    buffer_load_dwordx4 v16, s[40:43], s50 offen offset:0  lds
    buffer_load_dwordx4 v17, s[40:43], s50 offen offset:1024  lds
    buffer_load_dwordx4 v18, s[40:43], s50 offen offset:2048  lds
    buffer_load_dwordx4 v19, s[40:43], s50 offen offset:3072  lds
    s_waitcnt vmcnt(24)
    s_barrier
    s_waitcnt vmcnt(16)
    s_barrier
    s_add_u32 s50, s60, 1327104
    s_cmp_ge_u32 s50, s61
    s_cselect_b32 s48, 2359296, 0
    s_sub_u32 s50, s50, s48
    s_add_u32 m0, s68, 0
    s_nop 0
    buffer_load_dwordx4 v12, s[40:43], s50 offen offset:0  lds
    buffer_load_dwordx4 v13, s[40:43], s50 offen offset:1024  lds
    buffer_load_dwordx4 v14, s[40:43], s50 offen offset:2048  lds
    buffer_load_dwordx4 v15, s[40:43], s50 offen offset:3072  lds
    s_add_u32 m0, s68, 4096
    s_nop 0
    buffer_load_dwordx4 v16, s[40:43], s50 offen offset:0  lds
    buffer_load_dwordx4 v17, s[40:43], s50 offen offset:1024  lds
    buffer_load_dwordx4 v18, s[40:43], s50 offen offset:2048  lds
    buffer_load_dwordx4 v19, s[40:43], s50 offen offset:3072  lds
    s_barrier
    s_add_u32 s50, s60, 1400832
    s_cmp_ge_u32 s50, s61
    s_cselect_b32 s48, 2359296, 0
    s_sub_u32 s50, s50, s48
    s_add_u32 m0, s68, 16384
    s_nop 0
    buffer_load_dwordx4 v12, s[40:43], s50 offen offset:0  lds
    buffer_load_dwordx4 v13, s[40:43], s50 offen offset:1024  lds
    buffer_load_dwordx4 v14, s[40:43], s50 offen offset:2048  lds
    buffer_load_dwordx4 v15, s[40:43], s50 offen offset:3072  lds
    s_add_u32 m0, s68, 20480
    s_nop 0
    buffer_load_dwordx4 v16, s[40:43], s50 offen offset:0  lds
    buffer_load_dwordx4 v17, s[40:43], s50 offen offset:1024  lds
    buffer_load_dwordx4 v18, s[40:43], s50 offen offset:2048  lds
    buffer_load_dwordx4 v19, s[40:43], s50 offen offset:3072  lds
    s_waitcnt vmcnt(24)
    s_barrier
    s_waitcnt vmcnt(16)
    s_barrier
    s_add_u32 s50, s60, 1474560
    s_cmp_ge_u32 s50, s61
    s_cselect_b32 s48, 2359296, 0
    s_sub_u32 s50, s50, s48
    s_add_u32 m0, s68, 32768
    s_nop 0
    buffer_load_dwordx4 v12, s[40:43], s50 offen offset:0  lds
    buffer_load_dwordx4 v13, s[40:43], s50 offen offset:1024  lds
    buffer_load_dwordx4 v14, s[40:43], s50 offen offset:2048  lds
    buffer_load_dwordx4 v15, s[40:43], s50 offen offset:3072  lds
    s_add_u32 m0, s68, 36864
    s_nop 0
    buffer_load_dwordx4 v16, s[40:43], s50 offen offset:0  lds
    buffer_load_dwordx4 v17, s[40:43], s50 offen offset:1024  lds
    buffer_load_dwordx4 v18, s[40:43], s50 offen offset:2048  lds
    buffer_load_dwordx4 v19, s[40:43], s50 offen offset:3072  lds
    s_barrier
    s_add_u32 s50, s60, 1548288
    s_cmp_ge_u32 s50, s61
    s_cselect_b32 s48, 2359296, 0
    s_sub_u32 s50, s50, s48
    s_add_u32 m0, s68, 49152
    s_nop 0
    buffer_load_dwordx4 v12, s[40:43], s50 offen offset:0  lds
    buffer_load_dwordx4 v13, s[40:43], s50 offen offset:1024  lds
    buffer_load_dwordx4 v14, s[40:43], s50 offen offset:2048  lds
    buffer_load_dwordx4 v15, s[40:43], s50 offen offset:3072  lds
    s_add_u32 m0, s68, 53248
    s_nop 0
    buffer_load_dwordx4 v16, s[40:43], s50 offen offset:0  lds
    buffer_load_dwordx4 v17, s[40:43], s50 offen offset:1024  lds
    buffer_load_dwordx4 v18, s[40:43], s50 offen offset:2048  lds
    buffer_load_dwordx4 v19, s[40:43], s50 offen offset:3072  lds
    s_waitcnt vmcnt(24)
    s_barrier
    s_waitcnt vmcnt(16)
    s_barrier
    s_add_u32 s50, s60, 1622016
    s_cmp_ge_u32 s50, s61
    s_cselect_b32 s48, 2359296, 0
    s_sub_u32 s50, s50, s48
    s_add_u32 m0, s68, 65536
    s_nop 0
    buffer_load_dwordx4 v12, s[40:43], s50 offen offset:0  lds
    buffer_load_dwordx4 v13, s[40:43], s50 offen offset:1024  lds
    buffer_load_dwordx4 v14, s[40:43], s50 offen offset:2048  lds
    buffer_load_dwordx4 v15, s[40:43], s50 offen offset:3072  lds
    s_add_u32 m0, s68, 69632
    s_nop 0
    buffer_load_dwordx4 v16, s[40:43], s50 offen offset:0  lds
    buffer_load_dwordx4 v17, s[40:43], s50 offen offset:1024  lds
    buffer_load_dwordx4 v18, s[40:43], s50 offen offset:2048  lds
    buffer_load_dwordx4 v19, s[40:43], s50 offen offset:3072  lds
    s_barrier
    s_add_u32 s50, s60, 1695744
    s_cmp_ge_u32 s50, s61
    s_cselect_b32 s48, 2359296, 0
    s_sub_u32 s50, s50, s48
    s_add_u32 m0, s68, 81920
    s_nop 0
    buffer_load_dwordx4 v12, s[40:43], s50 offen offset:0  lds
    buffer_load_dwordx4 v13, s[40:43], s50 offen offset:1024  lds
    buffer_load_dwordx4 v14, s[40:43], s50 offen offset:2048  lds
    buffer_load_dwordx4 v15, s[40:43], s50 offen offset:3072  lds
    s_add_u32 m0, s68, 86016
    s_nop 0
    buffer_load_dwordx4 v16, s[40:43], s50 offen offset:0  lds
    buffer_load_dwordx4 v17, s[40:43], s50 offen offset:1024  lds
    buffer_load_dwordx4 v18, s[40:43], s50 offen offset:2048  lds
    buffer_load_dwordx4 v19, s[40:43], s50 offen offset:3072  lds
    s_waitcnt vmcnt(24)
    s_barrier
    s_waitcnt vmcnt(16)
    s_barrier
    s_add_u32 s50, s60, 1769472
    s_cmp_ge_u32 s50, s61
    s_cselect_b32 s48, 2359296, 0
    s_sub_u32 s50, s50, s48
    s_add_u32 m0, s68, 0
    s_nop 0
    buffer_load_dwordx4 v12, s[40:43], s50 offen offset:0  lds
    buffer_load_dwordx4 v13, s[40:43], s50 offen offset:1024  lds
    buffer_load_dwordx4 v14, s[40:43], s50 offen offset:2048  lds
    buffer_load_dwordx4 v15, s[40:43], s50 offen offset:3072  lds
    s_add_u32 m0, s68, 4096
    s_nop 0
    buffer_load_dwordx4 v16, s[40:43], s50 offen offset:0  lds
    buffer_load_dwordx4 v17, s[40:43], s50 offen offset:1024  lds
    buffer_load_dwordx4 v18, s[40:43], s50 offen offset:2048  lds
    buffer_load_dwordx4 v19, s[40:43], s50 offen offset:3072  lds
    s_barrier
    s_add_u32 s50, s60, 1843200
    s_cmp_ge_u32 s50, s61
    s_cselect_b32 s48, 2359296, 0
    s_sub_u32 s50, s50, s48
    s_add_u32 m0, s68, 16384
    s_nop 0
    buffer_load_dwordx4 v12, s[40:43], s50 offen offset:0  lds
    buffer_load_dwordx4 v13, s[40:43], s50 offen offset:1024  lds
    buffer_load_dwordx4 v14, s[40:43], s50 offen offset:2048  lds
    buffer_load_dwordx4 v15, s[40:43], s50 offen offset:3072  lds
    s_add_u32 m0, s68, 20480
    s_nop 0
    buffer_load_dwordx4 v16, s[40:43], s50 offen offset:0  lds
    buffer_load_dwordx4 v17, s[40:43], s50 offen offset:1024  lds
    buffer_load_dwordx4 v18, s[40:43], s50 offen offset:2048  lds
    buffer_load_dwordx4 v19, s[40:43], s50 offen offset:3072  lds
    s_waitcnt vmcnt(24)
    s_barrier
    s_waitcnt vmcnt(16)
    s_barrier
    s_add_u32 s50, s60, 1916928
    s_cmp_ge_u32 s50, s61
    s_cselect_b32 s48, 2359296, 0
    s_sub_u32 s50, s50, s48
    s_add_u32 m0, s68, 32768
    s_nop 0
    buffer_load_dwordx4 v12, s[40:43], s50 offen offset:0  lds
    buffer_load_dwordx4 v13, s[40:43], s50 offen offset:1024  lds
    buffer_load_dwordx4 v14, s[40:43], s50 offen offset:2048  lds
    buffer_load_dwordx4 v15, s[40:43], s50 offen offset:3072  lds
    s_add_u32 m0, s68, 36864
    s_nop 0
    buffer_load_dwordx4 v16, s[40:43], s50 offen offset:0  lds
    buffer_load_dwordx4 v17, s[40:43], s50 offen offset:1024  lds
    buffer_load_dwordx4 v18, s[40:43], s50 offen offset:2048  lds
    buffer_load_dwordx4 v19, s[40:43], s50 offen offset:3072  lds
    s_barrier
    s_add_u32 s50, s60, 1990656
    s_cmp_ge_u32 s50, s61
    s_cselect_b32 s48, 2359296, 0
    s_sub_u32 s50, s50, s48
    s_add_u32 m0, s68, 49152
    s_nop 0
    buffer_load_dwordx4 v12, s[40:43], s50 offen offset:0  lds
    buffer_load_dwordx4 v13, s[40:43], s50 offen offset:1024  lds
    buffer_load_dwordx4 v14, s[40:43], s50 offen offset:2048  lds
    buffer_load_dwordx4 v15, s[40:43], s50 offen offset:3072  lds
    s_add_u32 m0, s68, 53248
    s_nop 0
    buffer_load_dwordx4 v16, s[40:43], s50 offen offset:0  lds
    buffer_load_dwordx4 v17, s[40:43], s50 offen offset:1024  lds
    buffer_load_dwordx4 v18, s[40:43], s50 offen offset:2048  lds
    buffer_load_dwordx4 v19, s[40:43], s50 offen offset:3072  lds
    s_waitcnt vmcnt(24)
    s_barrier
    s_waitcnt vmcnt(16)
    s_barrier
    s_add_u32 s50, s60, 2064384
    s_cmp_ge_u32 s50, s61
    s_cselect_b32 s48, 2359296, 0
    s_sub_u32 s50, s50, s48
    s_add_u32 m0, s68, 65536
    s_nop 0
    buffer_load_dwordx4 v12, s[40:43], s50 offen offset:0  lds
    buffer_load_dwordx4 v13, s[40:43], s50 offen offset:1024  lds
    buffer_load_dwordx4 v14, s[40:43], s50 offen offset:2048  lds
    buffer_load_dwordx4 v15, s[40:43], s50 offen offset:3072  lds
    s_add_u32 m0, s68, 69632
    s_nop 0
    buffer_load_dwordx4 v16, s[40:43], s50 offen offset:0  lds
    buffer_load_dwordx4 v17, s[40:43], s50 offen offset:1024  lds
    buffer_load_dwordx4 v18, s[40:43], s50 offen offset:2048  lds
    buffer_load_dwordx4 v19, s[40:43], s50 offen offset:3072  lds
    s_barrier
    s_add_u32 s50, s60, 2138112
    s_cmp_ge_u32 s50, s61
    s_cselect_b32 s48, 2359296, 0
    s_sub_u32 s50, s50, s48
    s_add_u32 m0, s68, 81920
    s_nop 0
    buffer_load_dwordx4 v12, s[40:43], s50 offen offset:0  lds
    buffer_load_dwordx4 v13, s[40:43], s50 offen offset:1024  lds
    buffer_load_dwordx4 v14, s[40:43], s50 offen offset:2048  lds
    buffer_load_dwordx4 v15, s[40:43], s50 offen offset:3072  lds
    s_add_u32 m0, s68, 86016
    s_nop 0
    buffer_load_dwordx4 v16, s[40:43], s50 offen offset:0  lds
    buffer_load_dwordx4 v17, s[40:43], s50 offen offset:1024  lds
    buffer_load_dwordx4 v18, s[40:43], s50 offen offset:2048  lds
    buffer_load_dwordx4 v19, s[40:43], s50 offen offset:3072  lds
    s_waitcnt vmcnt(24)
    s_barrier
    s_add_u32 s50, s60, 2211840
    s_cmp_ge_u32 s50, s61
    s_cselect_b32 s48, 2359296, 0
    s_sub_u32 s50, s50, s48
    s_add_u32 m0, s68, 0
    s_nop 0
    buffer_load_dwordx4 v12, s[40:43], s50 offen offset:0  lds
    buffer_load_dwordx4 v13, s[40:43], s50 offen offset:1024  lds
    buffer_load_dwordx4 v14, s[40:43], s50 offen offset:2048  lds
    buffer_load_dwordx4 v15, s[40:43], s50 offen offset:3072  lds
    s_add_u32 m0, s68, 4096
    s_nop 0
    buffer_load_dwordx4 v16, s[40:43], s50 offen offset:0  lds
    buffer_load_dwordx4 v17, s[40:43], s50 offen offset:1024  lds
    buffer_load_dwordx4 v18, s[40:43], s50 offen offset:2048  lds
    buffer_load_dwordx4 v19, s[40:43], s50 offen offset:3072  lds
    s_waitcnt vmcnt(24)
    s_barrier
    s_add_u32 s50, s60, 2285568
    s_cmp_ge_u32 s50, s61
    s_cselect_b32 s48, 2359296, 0
    s_sub_u32 s50, s50, s48
    s_add_u32 m0, s68, 16384
    s_nop 0
    buffer_load_dwordx4 v12, s[40:43], s50 offen offset:0  lds
    buffer_load_dwordx4 v13, s[40:43], s50 offen offset:1024  lds
    buffer_load_dwordx4 v14, s[40:43], s50 offen offset:2048  lds
    buffer_load_dwordx4 v15, s[40:43], s50 offen offset:3072  lds
    s_add_u32 m0, s68, 20480
    s_nop 0
    buffer_load_dwordx4 v16, s[40:43], s50 offen offset:0  lds
    buffer_load_dwordx4 v17, s[40:43], s50 offen offset:1024  lds
    buffer_load_dwordx4 v18, s[40:43], s50 offen offset:2048  lds
    buffer_load_dwordx4 v19, s[40:43], s50 offen offset:3072  lds
    s_barrier
    s_waitcnt vmcnt(24)
    s_barrier
    s_waitcnt vmcnt(16)
    s_barrier
    s_add_u32 s50, s58, 0
    s_cmp_ge_u32 s50, s59
    s_cselect_b32 s48, 4718592, 0
    s_sub_u32 s50, s50, s48
    s_add_u32 m0, s68, 32768
    s_nop 0
    buffer_load_dwordx4 v56, s[44:47], s50 offen offset:0  lds
    buffer_load_dwordx4 v57, s[44:47], s50 offen offset:1024  lds
    buffer_load_dwordx4 v58, s[44:47], s50 offen offset:2048  lds
    buffer_load_dwordx4 v59, s[44:47], s50 offen offset:3072  lds
    s_add_u32 m0, s68, 36864
    s_nop 0
    buffer_load_dwordx4 v60, s[44:47], s50 offen offset:0  lds
    buffer_load_dwordx4 v61, s[44:47], s50 offen offset:1024  lds
    buffer_load_dwordx4 v62, s[44:47], s50 offen offset:2048  lds
    buffer_load_dwordx4 v63, s[44:47], s50 offen offset:3072  lds
    s_add_u32 s50, s58, 262144
    s_cmp_ge_u32 s50, s59
    s_cselect_b32 s48, 4718592, 0
    s_sub_u32 s50, s50, s48
    s_add_u32 m0, s68, 49152
    s_nop 0
    buffer_load_dwordx4 v56, s[44:47], s50 offen offset:0  lds
    buffer_load_dwordx4 v57, s[44:47], s50 offen offset:1024  lds
    s_waitcnt vmcnt(18)
    s_barrier
    buffer_load_dwordx4 v58, s[44:47], s50 offen offset:2048  lds
    buffer_load_dwordx4 v59, s[44:47], s50 offen offset:3072  lds
    s_add_u32 m0, s68, 53248
    s_nop 0
    buffer_load_dwordx4 v60, s[44:47], s50 offen offset:0  lds
    buffer_load_dwordx4 v61, s[44:47], s50 offen offset:1024  lds
    buffer_load_dwordx4 v62, s[44:47], s50 offen offset:2048  lds
    buffer_load_dwordx4 v63, s[44:47], s50 offen offset:3072  lds
    s_add_u32 s50, s58, 524288
    s_cmp_ge_u32 s50, s59
    s_cselect_b32 s48, 4718592, 0
    s_sub_u32 s50, s50, s48
    s_add_u32 m0, s68, 65536
    s_nop 0
    buffer_load_dwordx4 v56, s[44:47], s50 offen offset:0  lds
    buffer_load_dwordx4 v57, s[44:47], s50 offen offset:1024  lds
    buffer_load_dwordx4 v58, s[44:47], s50 offen offset:2048  lds
    buffer_load_dwordx4 v59, s[44:47], s50 offen offset:3072  lds
    s_add_u32 m0, s68, 69632
    s_nop 0
    buffer_load_dwordx4 v60, s[44:47], s50 offen offset:0  lds
    buffer_load_dwordx4 v61, s[44:47], s50 offen offset:1024  lds
    s_waitcnt vmcnt(22)
    s_barrier
    buffer_load_dwordx4 v62, s[44:47], s50 offen offset:2048  lds
    s_branch L_skip_16
L_stub_16:
    s_branch L_back_w1
L_skip_16:
    buffer_load_dwordx4 v63, s[44:47], s50 offen offset:3072  lds
    s_add_u32 s50, s58, 786432
    s_cmp_ge_u32 s50, s59
    s_cselect_b32 s48, 4718592, 0
    s_sub_u32 s50, s50, s48
    s_add_u32 m0, s68, 81920
    s_nop 0
    buffer_load_dwordx4 v56, s[44:47], s50 offen offset:0  lds
    buffer_load_dwordx4 v57, s[44:47], s50 offen offset:1024  lds
    buffer_load_dwordx4 v58, s[44:47], s50 offen offset:2048  lds
    buffer_load_dwordx4 v59, s[44:47], s50 offen offset:3072  lds
    s_add_u32 m0, s68, 86016
    s_nop 0
    buffer_load_dwordx4 v60, s[44:47], s50 offen offset:0  lds
    buffer_load_dwordx4 v61, s[44:47], s50 offen offset:1024  lds
    buffer_load_dwordx4 v62, s[44:47], s50 offen offset:2048  lds
    buffer_load_dwordx4 v63, s[44:47], s50 offen offset:3072  lds
    s_barrier
    s_branch L_m_102
L_m_101:
    s_sub_u32 s56, s5, 27
    s_lshl_b32 s56, s56, 1
    s_add_u32 s56, s56, s62
    s_add_u32 s56, s56, 96
    s_barrier
L_m_103:
    s_cmp_ge_u32 s56, 116
    s_cbranch_scc1 L_m_104
    s_mul_i32 s48, s56, 820
    s_lshr_b32 s48, s48, 13
    s_mul_i32 s49, s48, 10
    s_sub_u32 s49, s56, s49
    s_lshl_b32 s49, s49, 6
    v_add_u32 v22, s49, v0
    s_and_b32 s49, s4, 7
    s_mul_i32 s49, s49, 4
    s_add_u32 s48, s48, s49
    s_add_u32 s48, s48, 26
    s_and_b32 s48, s48, 31
    s_mul_i32 s48, s48, 73728
    s_mul_i32 s49, s4, 1152
    s_and_b32 s49, s49, -256
    s_add_u32 s48, s48, s49
    v_mul_u32_u24 v23, 820, v22
    v_lshrrev_b32 v23, 13, v23
    v_mul_u32_u24 v24, 10, v23
    v_sub_u32 v24, v22, v24
    v_and_b32 v22, 7, v23
    v_lshrrev_b32 v23, 3, v23
    v_lshl_add_u32 v22, v22, 8, v23
    v_mul_u32_u24 v22, 9216, v22
    v_lshl_add_u32 v22, v24, 7, v22
    buffer_load_dword v25, v22, s[40:43], s48 offen
    s_add_u32 s56, s56, 10
    s_branch L_m_103
L_m_104:
    s_barrier
    s_barrier
    s_barrier
    s_barrier
    s_barrier
    s_add_u32 s50, s58, 0
    s_cmp_ge_u32 s50, s59
    s_cselect_b32 s48, 4718592, 0
    s_sub_u32 s50, s50, s48
    s_add_u32 m0, s68, 32768
    s_nop 0
    buffer_load_dwordx4 v56, s[44:47], s50 offen offset:0  lds
    buffer_load_dwordx4 v57, s[44:47], s50 offen offset:1024  lds
    buffer_load_dwordx4 v58, s[44:47], s50 offen offset:2048  lds
    buffer_load_dwordx4 v59, s[44:47], s50 offen offset:3072  lds
    s_add_u32 m0, s68, 36864
    s_nop 0
    buffer_load_dwordx4 v60, s[44:47], s50 offen offset:0  lds
    buffer_load_dwordx4 v61, s[44:47], s50 offen offset:1024  lds
    buffer_load_dwordx4 v62, s[44:47], s50 offen offset:2048  lds
    buffer_load_dwordx4 v63, s[44:47], s50 offen offset:3072  lds
    s_add_u32 s50, s58, 262144
    s_cmp_ge_u32 s50, s59
    s_cselect_b32 s48, 4718592, 0
    s_sub_u32 s50, s50, s48
    s_add_u32 m0, s68, 49152
    s_nop 0
    buffer_load_dwordx4 v56, s[44:47], s50 offen offset:0  lds
    buffer_load_dwordx4 v57, s[44:47], s50 offen offset:1024  lds
    buffer_load_dwordx4 v58, s[44:47], s50 offen offset:2048  lds
    buffer_load_dwordx4 v59, s[44:47], s50 offen offset:3072  lds
    s_add_u32 m0, s68, 53248
    s_nop 0
    buffer_load_dwordx4 v60, s[44:47], s50 offen offset:0  lds
    buffer_load_dwordx4 v61, s[44:47], s50 offen offset:1024  lds
    buffer_load_dwordx4 v62, s[44:47], s50 offen offset:2048  lds
    buffer_load_dwordx4 v63, s[44:47], s50 offen offset:3072  lds
    s_add_u32 s50, s58, 524288
    s_cmp_ge_u32 s50, s59
    s_cselect_b32 s48, 4718592, 0
    s_sub_u32 s50, s50, s48
    s_add_u32 m0, s68, 65536
    s_nop 0
    buffer_load_dwordx4 v56, s[44:47], s50 offen offset:0  lds
    buffer_load_dwordx4 v57, s[44:47], s50 offen offset:1024  lds
    buffer_load_dwordx4 v58, s[44:47], s50 offen offset:2048  lds
    buffer_load_dwordx4 v59, s[44:47], s50 offen offset:3072  lds
    s_add_u32 m0, s68, 69632
    s_nop 0
    buffer_load_dwordx4 v60, s[44:47], s50 offen offset:0  lds
    buffer_load_dwordx4 v61, s[44:47], s50 offen offset:1024  lds
    buffer_load_dwordx4 v62, s[44:47], s50 offen offset:2048  lds
    buffer_load_dwordx4 v63, s[44:47], s50 offen offset:3072  lds
    s_add_u32 s50, s58, 786432
    s_cmp_ge_u32 s50, s59
    s_cselect_b32 s48, 4718592, 0
    s_sub_u32 s50, s50, s48
    s_add_u32 m0, s68, 81920
    s_nop 0
    buffer_load_dwordx4 v56, s[44:47], s50 offen offset:0  lds
    buffer_load_dwordx4 v57, s[44:47], s50 offen offset:1024  lds
    buffer_load_dwordx4 v58, s[44:47], s50 offen offset:2048  lds
    buffer_load_dwordx4 v59, s[44:47], s50 offen offset:3072  lds
    s_add_u32 m0, s68, 86016
    s_nop 0
    buffer_load_dwordx4 v60, s[44:47], s50 offen offset:0  lds
    buffer_load_dwordx4 v61, s[44:47], s50 offen offset:1024  lds
    buffer_load_dwordx4 v62, s[44:47], s50 offen offset:2048  lds
    buffer_load_dwordx4 v63, s[44:47], s50 offen offset:3072  lds
L_m_102:
    s_add_u32 s50, s58, 1048576
    s_cmp_ge_u32 s50, s59
    s_cselect_b32 s48, 4718592, 0
    s_sub_u32 s50, s50, s48
    s_add_u32 m0, s68, 0
    s_nop 0
    buffer_load_dwordx4 v56, s[44:47], s50 offen offset:0  lds
    buffer_load_dwordx4 v57, s[44:47], s50 offen offset:1024  lds
    buffer_load_dwordx4 v58, s[44:47], s50 offen offset:2048  lds
    buffer_load_dwordx4 v59, s[44:47], s50 offen offset:3072  lds
    s_add_u32 m0, s68, 4096
    s_nop 0
    buffer_load_dwordx4 v60, s[44:47], s50 offen offset:0  lds
    buffer_load_dwordx4 v61, s[44:47], s50 offen offset:1024  lds
    buffer_load_dwordx4 v62, s[44:47], s50 offen offset:2048  lds
    buffer_load_dwordx4 v63, s[44:47], s50 offen offset:3072  lds
    s_add_u32 s50, s58, 1310720
    s_cmp_ge_u32 s50, s59
    s_cselect_b32 s48, 4718592, 0
    s_sub_u32 s50, s50, s48
    s_add_u32 m0, s68, 16384
    s_nop 0
    buffer_load_dwordx4 v56, s[44:47], s50 offen offset:0  lds
    buffer_load_dwordx4 v57, s[44:47], s50 offen offset:1024  lds
    buffer_load_dwordx4 v58, s[44:47], s50 offen offset:2048  lds
    buffer_load_dwordx4 v59, s[44:47], s50 offen offset:3072  lds
    s_add_u32 m0, s68, 20480
    s_nop 0
    buffer_load_dwordx4 v60, s[44:47], s50 offen offset:0  lds
    buffer_load_dwordx4 v61, s[44:47], s50 offen offset:1024  lds
    buffer_load_dwordx4 v62, s[44:47], s50 offen offset:2048  lds
    buffer_load_dwordx4 v63, s[44:47], s50 offen offset:3072  lds
    s_nop 0
L_back_w2:
    s_waitcnt vmcnt(0)
    s_barrier
    s_barrier
    s_add_u32 s50, s58, 1572864
    s_cmp_ge_u32 s50, s59
    s_cselect_b32 s48, 4718592, 0
    s_sub_u32 s50, s50, s48
    s_add_u32 m0, s68, 0
    s_nop 0
    buffer_load_dwordx4 v56, s[44:47], s50 offen offset:0  lds
    buffer_load_dwordx4 v57, s[44:47], s50 offen offset:1024  lds
    buffer_load_dwordx4 v58, s[44:47], s50 offen offset:2048  lds
    buffer_load_dwordx4 v59, s[44:47], s50 offen offset:3072  lds
    s_add_u32 m0, s68, 4096
    s_nop 0
    buffer_load_dwordx4 v60, s[44:47], s50 offen offset:0  lds
    buffer_load_dwordx4 v61, s[44:47], s50 offen offset:1024  lds
    buffer_load_dwordx4 v62, s[44:47], s50 offen offset:2048  lds
    buffer_load_dwordx4 v63, s[44:47], s50 offen offset:3072  lds
    s_barrier
    s_add_u32 s50, s58, 1835008
    s_cmp_ge_u32 s50, s59
    s_cselect_b32 s48, 4718592, 0
    s_sub_u32 s50, s50, s48
    s_add_u32 m0, s68, 16384
    s_nop 0
    buffer_load_dwordx4 v56, s[44:47], s50 offen offset:0  lds
    buffer_load_dwordx4 v57, s[44:47], s50 offen offset:1024  lds
    buffer_load_dwordx4 v58, s[44:47], s50 offen offset:2048  lds
    buffer_load_dwordx4 v59, s[44:47], s50 offen offset:3072  lds
    s_add_u32 m0, s68, 20480
    s_nop 0
    buffer_load_dwordx4 v60, s[44:47], s50 offen offset:0  lds
    buffer_load_dwordx4 v61, s[44:47], s50 offen offset:1024  lds
    buffer_load_dwordx4 v62, s[44:47], s50 offen offset:2048  lds
    buffer_load_dwordx4 v63, s[44:47], s50 offen offset:3072  lds
    s_add_u32 s50, s58, 2097152
    s_cmp_ge_u32 s50, s59
    s_cselect_b32 s48, 4718592, 0
    s_sub_u32 s50, s50, s48
    s_add_u32 m0, s68, 32768
    s_nop 0
    buffer_load_dwordx4 v56, s[44:47], s50 offen offset:0  lds
    buffer_load_dwordx4 v57, s[44:47], s50 offen offset:1024  lds
    buffer_load_dwordx4 v58, s[44:47], s50 offen offset:2048  lds
    buffer_load_dwordx4 v59, s[44:47], s50 offen offset:3072  lds
    s_add_u32 m0, s68, 36864
    s_nop 0
    buffer_load_dwordx4 v60, s[44:47], s50 offen offset:0  lds
    buffer_load_dwordx4 v61, s[44:47], s50 offen offset:1024  lds
    buffer_load_dwordx4 v62, s[44:47], s50 offen offset:2048  lds
    buffer_load_dwordx4 v63, s[44:47], s50 offen offset:3072  lds
    s_add_u32 s50, s58, 2359296
    s_cmp_ge_u32 s50, s59
    s_cselect_b32 s48, 4718592, 0
    s_sub_u32 s50, s50, s48
    s_add_u32 m0, s68, 49152
    s_nop 0
    buffer_load_dwordx4 v56, s[44:47], s50 offen offset:0  lds
    buffer_load_dwordx4 v57, s[44:47], s50 offen offset:1024  lds
    buffer_load_dwordx4 v58, s[44:47], s50 offen offset:2048  lds
    buffer_load_dwordx4 v59, s[44:47], s50 offen offset:3072  lds
    s_add_u32 m0, s68, 53248
    s_nop 0
    buffer_load_dwordx4 v60, s[44:47], s50 offen offset:0  lds
    buffer_load_dwordx4 v61, s[44:47], s50 offen offset:1024  lds
    buffer_load_dwordx4 v62, s[44:47], s50 offen offset:2048  lds
    buffer_load_dwordx4 v63, s[44:47], s50 offen offset:3072  lds
    v_mov_b64 v[100:101], -1
    v_mov_b64 v[102:103], -1
    v_mov_b32 v104, v3
    v_mov_b32 v105, v3
    v_mov_b32 v106, v3
    v_mov_b32 v107, v3
    v_lshlrev_b32 v110, 4, v0
    s_lshl_b32 s48, s2, 7
    s_add_u32 s48, s48, 38797312
    v_add_u32 v108, s48, v110
    s_cmp_eq_u32 s62, 0
    s_cselect_b32 s48, 8, 0
    v_cmp_gt_u32 vcc, s48, v0
    v_mov_b32 v109, 2146435072
    s_nop 0
    v_cndmask_b32 v108, v109, v108, vcc
    v_min_u32 v109, 2, v0
    v_add_u32 v109, 1, v109
    v_lshlrev_b32 v109, 1, v109
    v_xor_b32 v109, s2, v109
    v_lshlrev_b32 v109, 7, v109
    v_add_u32 v109, 38797312, v109
    v_lshlrev_b32 v111, 4, v0
    s_mul_i32 s56, s2, 27648
    s_lshl_b32 s48, s62, 10
    s_add_u32 s56, s56, s48
    s_add_u32 s56, s56, 27262976
    s_waitcnt vmcnt(24)
    s_barrier
    s_add_u32 s50, s58, 2621440
    s_cmp_ge_u32 s50, s59
    s_cselect_b32 s48, 4718592, 0
    s_sub_u32 s50, s50, s48
    s_add_u32 m0, s68, 65536
    s_nop 0
    buffer_load_dwordx4 v56, s[44:47], s50 offen offset:0  lds
    buffer_load_dwordx4 v57, s[44:47], s50 offen offset:1024  lds
    buffer_load_dwordx4 v58, s[44:47], s50 offen offset:2048  lds
    buffer_load_dwordx4 v59, s[44:47], s50 offen offset:3072  lds
    s_waitcnt vmcnt(20)
    s_barrier
    s_add_u32 m0, s68, 69632
    s_nop 0
    buffer_load_dwordx4 v60, s[44:47], s50 offen offset:0  lds
    buffer_load_dwordx4 v61, s[44:47], s50 offen offset:1024  lds
    buffer_load_dwordx4 v62, s[44:47], s50 offen offset:2048  lds
    buffer_load_dwordx4 v63, s[44:47], s50 offen offset:3072  lds
    s_waitcnt vmcnt(16)
    s_barrier
    s_add_u32 s57, s56, 0
    buffer_store_dwordx4 v[100:103], v111, s[36:39], s57 offen sc1
    s_add_u32 s50, s58, 2883584
    s_cmp_ge_u32 s50, s59
    s_cselect_b32 s48, 4718592, 0
    s_sub_u32 s50, s50, s48
    s_add_u32 m0, s68, 0
    s_nop 0
    buffer_load_dwordx4 v56, s[44:47], s50 offen offset:0  lds
    buffer_load_dwordx4 v57, s[44:47], s50 offen offset:1024  lds
    buffer_load_dwordx4 v58, s[44:47], s50 offen offset:2048  lds
    buffer_load_dwordx4 v59, s[44:47], s50 offen offset:3072  lds
    s_waitcnt vmcnt(13)
    s_barrier
    s_add_u32 s57, s56, 2048
    buffer_store_dwordx4 v[100:103], v111, s[36:39], s57 offen sc1
    s_add_u32 s57, s56, 4096
    buffer_store_dwordx4 v[100:103], v111, s[36:39], s57 offen sc1
    s_add_u32 m0, s68, 4096
    s_nop 0
    buffer_load_dwordx4 v60, s[44:47], s50 offen offset:0  lds
    buffer_load_dwordx4 v61, s[44:47], s50 offen offset:1024  lds
    buffer_load_dwordx4 v62, s[44:47], s50 offen offset:2048  lds
    buffer_load_dwordx4 v63, s[44:47], s50 offen offset:3072  lds
    s_barrier
    s_add_u32 s57, s56, 6144
    buffer_store_dwordx4 v[100:103], v111, s[36:39], s57 offen sc1
    s_add_u32 s57, s56, 8192
    buffer_store_dwordx4 v[100:103], v111, s[36:39], s57 offen sc1
    s_add_u32 s50, s58, 3145728
    s_cmp_ge_u32 s50, s59
    s_cselect_b32 s48, 4718592, 0
    s_sub_u32 s50, s50, s48
    s_add_u32 m0, s68, 16384
    s_nop 0
    buffer_load_dwordx4 v56, s[44:47], s50 offen offset:0  lds
    buffer_load_dwordx4 v57, s[44:47], s50 offen offset:1024  lds
    buffer_load_dwordx4 v58, s[44:47], s50 offen offset:2048  lds
    buffer_load_dwordx4 v59, s[44:47], s50 offen offset:3072  lds
    s_waitcnt vmcnt(17)
    s_barrier
    s_add_u32 s57, s56, 10240
    buffer_store_dwordx4 v[100:103], v111, s[36:39], s57 offen sc1
    s_add_u32 s57, s56, 12288
    buffer_store_dwordx4 v[100:103], v111, s[36:39], s57 offen sc1
    s_add_u32 m0, s68, 20480
    s_nop 0
    buffer_load_dwordx4 v60, s[44:47], s50 offen offset:0  lds
    buffer_load_dwordx4 v61, s[44:47], s50 offen offset:1024  lds
    buffer_load_dwordx4 v62, s[44:47], s50 offen offset:2048  lds
    buffer_load_dwordx4 v63, s[44:47], s50 offen offset:3072  lds
    s_barrier
    s_add_u32 s57, s56, 14336
    buffer_store_dwordx4 v[100:103], v111, s[36:39], s57 offen sc1
    s_add_u32 s50, s58, 3407872
    s_cmp_ge_u32 s50, s59
    s_cselect_b32 s48, 4718592, 0
    s_sub_u32 s50, s50, s48
    s_add_u32 m0, s68, 32768
    s_nop 0
    buffer_load_dwordx4 v56, s[44:47], s50 offen offset:0  lds
    buffer_load_dwordx4 v57, s[44:47], s50 offen offset:1024  lds
    buffer_load_dwordx4 v58, s[44:47], s50 offen offset:2048  lds
    buffer_load_dwordx4 v59, s[44:47], s50 offen offset:3072  lds
    s_waitcnt vmcnt(17)
    s_barrier
    s_add_u32 s57, s56, 16384
    buffer_store_dwordx4 v[100:103], v111, s[36:39], s57 offen sc1
    s_add_u32 s57, s56, 18432
    buffer_store_dwordx4 v[100:103], v111, s[36:39], s57 offen sc1
    s_add_u32 m0, s68, 36864
    s_nop 0
    buffer_load_dwordx4 v60, s[44:47], s50 offen offset:0  lds
    buffer_load_dwordx4 v61, s[44:47], s50 offen offset:1024  lds
    buffer_load_dwordx4 v62, s[44:47], s50 offen offset:2048  lds
    buffer_load_dwordx4 v63, s[44:47], s50 offen offset:3072  lds
    s_barrier
    s_add_u32 s57, s56, 20480
    buffer_store_dwordx4 v[100:103], v111, s[36:39], s57 offen sc1
    s_add_u32 s57, s56, 22528
    buffer_store_dwordx4 v[100:103], v111, s[36:39], s57 offen sc1
    s_add_u32 s50, s58, 3670016
    s_cmp_ge_u32 s50, s59
    s_cselect_b32 s48, 4718592, 0
    s_sub_u32 s50, s50, s48
    s_add_u32 m0, s68, 49152
    s_nop 0
    buffer_load_dwordx4 v56, s[44:47], s50 offen offset:0  lds
    buffer_load_dwordx4 v57, s[44:47], s50 offen offset:1024  lds
    buffer_load_dwordx4 v58, s[44:47], s50 offen offset:2048  lds
    buffer_load_dwordx4 v59, s[44:47], s50 offen offset:3072  lds
    s_waitcnt vmcnt(17)
    s_barrier
    s_add_u32 s57, s56, 24576
    buffer_store_dwordx4 v[100:103], v111, s[36:39], s57 offen sc1
    s_mul_i32 s57, s62, -2048
    s_add_u32 s57, s57, 26624
    s_add_u32 s57, s57, s56
    buffer_store_dwordx4 v[100:103], v111, s[36:39], s57 offen sc1
    s_add_u32 m0, s68, 53248
    s_nop 0
    buffer_load_dwordx4 v60, s[44:47], s50 offen offset:0  lds
    buffer_load_dwordx4 v61, s[44:47], s50 offen offset:1024  lds
    buffer_load_dwordx4 v62, s[44:47], s50 offen offset:2048  lds
    buffer_load_dwordx4 v63, s[44:47], s50 offen offset:3072  lds
    s_barrier
    s_add_u32 s50, s58, 3932160
    s_cmp_ge_u32 s50, s59
    s_cselect_b32 s48, 4718592, 0
    s_sub_u32 s50, s50, s48
    s_add_u32 m0, s68, 65536
    s_nop 0
    buffer_load_dwordx4 v56, s[44:47], s50 offen offset:0  lds
    buffer_load_dwordx4 v57, s[44:47], s50 offen offset:1024  lds
    buffer_load_dwordx4 v58, s[44:47], s50 offen offset:2048  lds
    buffer_load_dwordx4 v59, s[44:47], s50 offen offset:3072  lds
    s_barrier
    s_add_u32 m0, s68, 69632
    s_nop 0
    buffer_load_dwordx4 v60, s[44:47], s50 offen offset:0  lds
    buffer_load_dwordx4 v61, s[44:47], s50 offen offset:1024  lds
    buffer_load_dwordx4 v62, s[44:47], s50 offen offset:2048  lds
    buffer_load_dwordx4 v63, s[44:47], s50 offen offset:3072  lds
    s_waitcnt vmcnt(12)
    s_barrier
    buffer_store_dwordx4 v[104:107], v108, s[36:39], 0 offen sc1
    s_add_u32 s50, s58, 4194304
    s_cmp_ge_u32 s50, s59
    s_cselect_b32 s48, 4718592, 0
    s_sub_u32 s50, s50, s48
    s_add_u32 m0, s68, 0
    s_nop 0
    buffer_load_dwordx4 v56, s[44:47], s50 offen offset:0  lds
    buffer_load_dwordx4 v57, s[44:47], s50 offen offset:1024  lds
    buffer_load_dwordx4 v58, s[44:47], s50 offen offset:2048  lds
    buffer_load_dwordx4 v59, s[44:47], s50 offen offset:3072  lds
    s_waitcnt vmcnt(25)
    s_barrier
    s_add_u32 m0, s68, 4096
    s_nop 0
    buffer_load_dwordx4 v60, s[44:47], s50 offen offset:0  lds
    buffer_load_dwordx4 v61, s[44:47], s50 offen offset:1024  lds
    buffer_load_dwordx4 v62, s[44:47], s50 offen offset:2048  lds
    buffer_load_dwordx4 v63, s[44:47], s50 offen offset:3072  lds
    s_waitcnt vmcnt(17)
    s_barrier
    s_add_u32 s50, s58, 4456448
    s_cmp_ge_u32 s50, s59
    s_cselect_b32 s48, 4718592, 0
    s_sub_u32 s50, s50, s48
    s_add_u32 m0, s68, 16384
    s_nop 0
    buffer_load_dwordx4 v56, s[44:47], s50 offen offset:0  lds
    buffer_load_dwordx4 v57, s[44:47], s50 offen offset:1024  lds
    buffer_load_dwordx4 v58, s[44:47], s50 offen offset:2048  lds
    buffer_load_dwordx4 v59, s[44:47], s50 offen offset:3072  lds
    s_waitcnt vmcnt(13)
    s_barrier
    buffer_load_dword v110, v109, s[36:39], 0 offen sc1
    s_add_u32 m0, s68, 20480
    s_nop 0
    buffer_load_dwordx4 v60, s[44:47], s50 offen offset:0  lds
    buffer_load_dwordx4 v61, s[44:47], s50 offen offset:1024  lds
    buffer_load_dwordx4 v62, s[44:47], s50 offen offset:2048  lds
    buffer_load_dwordx4 v63, s[44:47], s50 offen offset:3072  lds
    s_waitcnt vmcnt(9)
    s_barrier
    s_waitcnt vmcnt(0)
    s_waitcnt vmcnt(4)
    v_cmp_ne_u32 vcc, v3, v110
    s_nop 0
    s_cbranch_vccz L_m_105
Lp_m_106:
    buffer_load_dword v110, v109, s[36:39], 0 offen sc1
    s_waitcnt vmcnt(0)
    v_cmp_ne_u32 vcc, v3, v110
    s_nop 0
    s_cbranch_vccz Le_m_107
    s_sub_u32 s7, s7, 1
    s_cbranch_scc1 Le_m_107
    s_mov_b64 exec, vcc
    s_sleep 1
    s_branch Lp_m_106
Le_m_107:
    s_mov_b64 exec, -1
    s_max_i32 s7, s7, 0
L_m_105:
    s_barrier
    s_barrier
L_m_100:
    v_lshlrev_b32 v100, 4, v0
    v_lshlrev_b32 v101, 2, v0
    s_mul_i32 s48, s3, 2304
    s_mul_i32 s60, s2, 27648
    s_add_u32 s60, s60, s48
    s_add_u32 s60, s60, 27272192
    s_add_u32 s61, s60, 9216
    s_mul_i32 s63, s3, 4608
    s_add_u32 s63, s63, 49152
    v_add_u32 v102, s63, v100
    v_add_u32 v103, s63, v101
Lp_m_108:
    s_add_u32 m0, s63, 2304
    s_nop 0
    buffer_load_dwordx4 v100, s[36:39], s61 offen sc1 lds
    buffer_load_dwordx4 v100, s[36:39], s61 offen offset:1024 sc1 lds
    buffer_load_dword v101, s[36:39], s61 offen offset:2048 sc1 lds
    s_add_u32 m0, s63, 0
    s_nop 0
    buffer_load_dwordx4 v100, s[36:39], s60 offen sc1 lds
    buffer_load_dwordx4 v100, s[36:39], s60 offen offset:1024 sc1 lds
    buffer_load_dword v101, s[36:39], s60 offen offset:2048 sc1 lds
    s_waitcnt vmcnt(0)
    ds_read_b32 v104, v102 offset:0
    ds_read_b32 v105, v102 offset:1024
    ds_read_b32 v106, v103 offset:2048
    ds_read_b32 v107, v102 offset:2304
    ds_read_b32 v108, v102 offset:3328
    ds_read_b32 v109, v103 offset:4352
    s_waitcnt lgkmcnt(3)
    v_max3_u32 v110, v104, v105, v106
    s_waitcnt lgkmcnt(2)
    v_max_u32 v110, v110, v107
    s_waitcnt lgkmcnt(1)
    v_max_u32 v110, v110, v108
    s_waitcnt lgkmcnt(0)
    v_max_u32 v110, v110, v109
    v_cmp_eq_u32 vcc, -1, v110
    s_nop 0
    s_cbranch_vccz Le_m_109
    s_sub_u32 s7, s7, 1
    s_cbranch_scc1 Le_m_109
    s_sleep 1
    s_branch Lp_m_108
Le_m_109:
    s_max_i32 s7, s7, 0
    s_barrier
L_end:
L_exit:
    s_endpgm
L_code_end:
.section .rodata,"a"
.p2align 6
.amdhsa_kernel adaLN_cond__spectral_gfnet__mixer_token_mlp__prompt_kernel
  .amdhsa_next_free_vgpr 256
  .amdhsa_next_free_sgpr 70
  .amdhsa_accum_offset 256
  .amdhsa_group_segment_fixed_size 0
  .amdhsa_kernarg_size 104
  .amdhsa_user_sgpr_count 2
  .amdhsa_user_sgpr_kernarg_segment_ptr 1
  .amdhsa_system_sgpr_workgroup_id_x 1
.end_amdhsa_kernel
```
